```python
import torch

def _softmax(x, axis=-1):
    return torch.softmax(x, dim=axis)
def _gelu(x):
    return torch.nn.functional.gelu(x, approximate="tanh")
def _silu(x):
    return torch.nn.functional.silu(x)
def _sigmoid(x):
    return torch.sigmoid(x)
def _layernorm(x, axis=-1, eps=1e-5):
    m = x.mean(dim=axis, keepdim=True)
    v = x.var(dim=axis, keepdim=True, unbiased=False)
    return (x - m) / torch.sqrt(v + eps)
def _scatter_add(tgt, idx, src, axis=0):
    return tgt.clone().index_add_(axis, idx, src)
def _segment_sum(src, seg, n):
    out = torch.zeros((n,) + src.shape[1:], dtype=src.dtype)
    return out.index_add_(0, seg, src)
def _pad(x, pw):
    flat = tuple(v for pair in reversed(pw) for v in pair)
    return torch.nn.functional.pad(x, flat)

kernel_name = 'concat_heads__compressed_kv_cla__sliding_block__prompt'

def setup_inputs():

    _w = (lambda a: (lambda t: t.to(torch.bfloat16) if t.is_floating_point() else t)(torch.as_tensor(a)))
    def _A_setup():
        B, H, Sq, Sk, D, M = 1, 32, 2048, 2048, 128, 512
        Dc = 4 * D
        return {
            "x": _w((lambda *s: torch.randn(*s, dtype=torch.bfloat16) * 0.2)(B, Sq, M)),
            "c_kv": _w((lambda *s: torch.randn(*s, dtype=torch.bfloat16) * 1.6)(B, Sk, Dc)),
            "w_q": _w((lambda *s: torch.randn(*s, dtype=torch.bfloat16) * 3.2)(M, H, D) * (M ** -0.5)),
            "w_uk": _w((lambda *s: torch.randn(*s, dtype=torch.bfloat16) * 3.2)(Dc, H, D) * (Dc ** -0.5)),
            "w_uv": _w((lambda *s: torch.randn(*s, dtype=torch.bfloat16) * 1.6)(Dc, H, D) * (Dc ** -0.5)),
            "w_o": _w((lambda *s: torch.randn(*s, dtype=torch.bfloat16) * 1.6)(H, D, M) * ((H * D) ** -0.5)),
        }
    _A_in = _A_setup()

    def _B_setup():
        B, S, D = 1, 2048, 512
        return {
            "x": _w((lambda *s: torch.randn(*s, dtype=torch.bfloat16) * 0.4)(B, S, D)),
            "wqkv": _w((lambda *s: torch.randn(*s, dtype=torch.bfloat16) * 0.4)(D, 3 * D)),
            "wo": _w((lambda *s: torch.randn(*s, dtype=torch.bfloat16) * 0.05)(D, D)),
        }
    _B_in = _B_setup()

    return {
        "A_x": _A_in["x"],
        "A_c_kv": _A_in["c_kv"],
        "A_w_q": _A_in["w_q"],
        "A_w_uk": _A_in["w_uk"],
        "A_w_uv": _A_in["w_uv"],
        "A_w_o": _A_in["w_o"],
        "B_x": _B_in["x"],
        "B_wqkv": _B_in["wqkv"],
        "B_wo": _B_in["wo"],
    }

def reference(A_x, A_c_kv, A_w_q, A_w_uk, A_w_uv, A_w_o, B_x, B_wqkv, B_wo):
    def _A_ref(x, c_kv, w_q, w_uk, w_uv, w_o):
        B, Sq, M = x.shape[0], x.shape[1], x.shape[2]
        Sk = c_kv.shape[1]
        H, D = w_q.shape[1], w_q.shape[2]
        q = torch.einsum("bqm,mhd->bhqd", x, w_q)
        k = torch.einsum("bkc,chd->bhkd", c_kv, w_uk)
        v = torch.einsum("bkc,chd->bhkd", c_kv, w_uv)
        scores = torch.einsum("bhqd,bhkd->bhqk", q, k) * (D ** -0.5)
        off = Sk - Sq
        qi = torch.arange(Sq)[:, None]
        kj = torch.arange(Sk)[None, :]
        cmask = kj <= (qi + off)
        scores = torch.where(cmask[None, None], scores, -1e9)
        p = _softmax(scores, axis=-1)
        ctx = torch.einsum("bhqk,bhkd->bhqd", p, v)
        return torch.einsum("bhqd,hdm->bqm", ctx, w_o)

    def _B_ref(x, wqkv, wo):
        B, S, D = x.shape
        H = 32; Dh = D // H; W = 256
        qkv = (lambda x, *d: x.permute(*d))((x @ wqkv).reshape(B, S, 3, H, Dh), 2, 0, 3, 1, 4)
        q, k, v = qkv[0], qkv[1], qkv[2]
        scores = torch.einsum("bhqd,bhkd->bhqk", q, k) * (Dh ** -0.5)
        idx = torch.arange(S)
        mask = (idx[:, None] - idx[None, :] >= 0) & (idx[:, None] - idx[None, :] < W)
        scores = torch.where(mask[None, None], scores, -1e9)
        p = _softmax(scores, axis=-1)
        o = torch.einsum("bhqk,bhkd->bhqd", p, v)
        return (lambda x, *d: x.permute(*d))(o, 0, 2, 1, 3).reshape(B, S, D) @ wo

    a = _A_ref(A_x, A_c_kv, A_w_q, A_w_uk, A_w_uv, A_w_o)
    b = _B_ref(B_x, B_wqkv, B_wo)
    return torch.concatenate([a, b], axis=-1)
```

```asm
; @launch kernel=k1_kernel grid=(256,1,1) block=(256,1,1) lds=163840
; @launch kernel=k3_kernel grid=(512,1,1) block=(256,1,1) lds=65536
.amdgcn_target "amdgcn-amd-amdhsa--gfx950"
.text
.p2align 8
.type k1_kernel,@function
k1_kernel:
s_cmp_ge_u32 s2, 256
s_cbranch_scc1 K1_END
s_getpc_b64 s[90:91]
K1_PC:
s_sub_u32 s90, s90, K1_PC-k1_kernel
s_subb_u32 s91, s91, 0
s_lshr_b32 s92, s2, 3
s_and_b32 s92, s92, 15
s_lshl_b32 s92, s92, 13
v_and_b32 v98, 63, v0
v_lshlrev_b32 v98, 7, v98
v_add_u32 v98, s92, v98
v_min_u32 v98, CODE_END-k1_kernel-4, v98
global_load_dword v99, v98, s[90:91]
s_load_dwordx16 s[4:19], s[0:1], 0
s_load_dwordx8 s[20:27], s[0:1], 64
v_lshrrev_b32 v1, 6, v0
v_and_b32 v0, 63, v0
v_readfirstlane_b32 s40, v1
s_and_b32 s59, s2, 7
s_lshr_b32 s60, s2, 3
s_and_b32 s61, s59, 1
s_lshl_b32 s61, s61, 2
s_and_b32 s54, s60, 3
s_add_u32 s54, s54, s61
s_lshr_b32 s59, s59, 1
s_mul_i32 s59, s59, 8
s_lshr_b32 s60, s60, 2
s_add_u32 s59, s59, s60
s_and_b32 s69, s59, 7
s_lshl_b32 s69, s69, 7
s_sub_u32 s60, s59, 1
s_cmp_lt_u32 s59, 7
s_cselect_b32 s60, s59, s60
s_sub_u32 s61, s59, 24
s_cmp_lt_u32 s61, 3
s_cselect_b32 s61, 1, 0
s_sub_u32 s60, s60, s61
s_cmp_eq_u32 s59, 7
s_cselect_b32 s60, 31, s60
s_cmp_eq_u32 s59, 23
s_cselect_b32 s59, 25, s60
s_lshl_b32 s94, s59, 2
s_add_u32 s94, s94, 128
s_cmp_eq_u32 s59, 31
s_cbranch_scc1 K1_RELAY
s_lshl_b32 s55, s54, 18
s_lshl_b32 s60, s40, 16
s_add_u32 s55, s55, s60
s_lshl_b32 s54, s54, 3
s_lshl_b32 s60, s40, 1
s_add_u32 s54, s54, s60
s_mul_i32 s60, s59, 79
s_lshr_b32 s60, s60, 10
s_mul_i32 s61, s60, 13
s_sub_u32 s61, s59, s61
s_lshl_b32 s68, s61, 5
s_lshr_b32 s41, s55, 16
s_add_u32 s68, s68, s41
s_mul_i32 s68, s68, 10240
s_mov_b32 s43, 5
s_cmp_eq_u32 s61, 12
s_cselect_b32 s43, 4, s43
s_cmp_eq_u32 s59, 30
s_cselect_b32 s43, 4, s43
s_mul_i32 s61, s61, 5
s_lshl_b32 s41, s60, 6
s_add_u32 s41, s41, s61
s_lshl_b32 s56, s40, 12
s_lshl_b32 s57, s40, 14
s_add_u32 s57, s57, 98304
s_lshl_b32 s67, s40, 13
s_add_u32 s67, s67, 65536
v_lshlrev_b32 v16, 4, v0
v_lshrrev_b32 v100, 3, v0
v_lshlrev_b32 v101, 10, v100
v_lshrrev_b32 v102, 4, v0
v_and_b32 v103, 7, v0
v_xor_b32 v102, v102, v103
v_xor_b32 v104, 0, v102
v_lshl_add_u32 v104, v104, 4, v101
v_add_u32 v6, 0, v104
v_xor_b32 v104, 4, v102
v_lshl_add_u32 v104, v104, 4, v101
v_add_u32 v7, 7168, v104
v_xor_b32 v104, 0, v102
v_lshl_add_u32 v104, v104, 4, v101
v_add_u32 v8, 14336, v104
v_xor_b32 v104, 4, v102
v_lshl_add_u32 v104, v104, 4, v101
v_add_u32 v9, 21504, v104
v_and_b32 v100, 15, v0
v_lshrrev_b32 v101, 4, v0
v_bfe_u32 v102, v0, 1, 3
v_lshlrev_b32 v100, 7, v100
v_add_u32 v104, 0, v101
v_xor_b32 v104, v104, v102
v_lshl_add_u32 v104, v104, 4, v100
v_add_u32 v14, s57, v104
v_add_u32 v26, s67, v104
v_add_u32 v104, 4, v101
v_xor_b32 v104, v104, v102
v_lshl_add_u32 v104, v104, 4, v100
v_add_u32 v15, s57, v104
v_add_u32 v27, s67, v104
v_bfe_u32 v100, v0, 2, 2
v_lshrrev_b32 v101, 4, v0
v_lshl_add_u32 v101, v101, 3, v100
v_lshlrev_b32 v101, 7, v101
v_and_b32 v102, 3, v0
v_lshl_add_u32 v101, v102, 3, v101
v_bfe_u32 v102, v0, 3, 2
v_xor_b32 v103, 0, v102
v_lshl_add_u32 v10, v103, 5, v101
v_add_u32 v18, 65536, v10
v_add_u32 v22, 131072, v10
v_xor_b32 v103, 1, v102
v_lshl_add_u32 v11, v103, 5, v101
v_add_u32 v19, 65536, v11
v_add_u32 v23, 131072, v11
v_xor_b32 v103, 2, v102
v_lshl_add_u32 v12, v103, 5, v101
v_add_u32 v20, 65536, v12
v_add_u32 v24, 131072, v12
v_xor_b32 v103, 3, v102
v_lshl_add_u32 v13, v103, 5, v101
v_add_u32 v21, 65536, v13
v_add_u32 v25, 131072, v13
s_waitcnt lgkmcnt(0)
s_mov_b32 s36, s26
s_mov_b32 s37, s27
s_mov_b32 s38, 0x10000000
s_mov_b32 s39, 0x20000
s_mov_b32 s35, 0x20000
s_mov_b32 s30, 0x200000
s_mov_b32 s31, 0x20000
s_mov_b64 s[76:77], s[4:5]
s_mov_b32 s79, 0x20000
s_mov_b64 s[80:81], s[8:9]
s_mov_b32 s83, 0x20000
s_mov_b32 s78, 0
s_mov_b32 s82, 0
s_lshl_b32 s84, s2, 2
s_add_u32 s84, s84, s40
s_lshl_b32 s85, s84, 12
s_lshl_b32 s84, s84, 11
s_cmp_eq_u32 s60, 0
s_cselect_b64 s[32:33], s[10:11], s[12:13]
s_cselect_b32 s49, 0x3e0293ee, 1.0
s_cmp_eq_u32 s60, 2
s_cselect_b64 s[32:33], s[18:19], s[32:33]
s_cselect_b64 s[28:29], s[16:17], s[6:7]
s_movk_i32 s44, 8192
s_cselect_b32 s44, 3072, s44
s_mov_b32 s64, 0x400000
s_cselect_b32 s64, 0x180000, s64
s_lshl_b32 s46, s44, 7
s_lshl_b32 s42, s44, 6
v_lshrrev_b32 v100, 3, v0
v_mul_lo_u32 v100, v100, s44
v_bfe_u32 v101, v0, 4, 1
v_lshlrev_b32 v101, 1, v101
v_and_b32 v102, 7, v0
v_xor_b32 v101, v101, v102
s_lshl_b32 s60, s44, 3
s_sub_u32 s60, s60, 1024
v_xor_b32 v102, 0, v101
v_lshl_add_u32 v2, v102, 4, v100
v_add_u32 v100, s60, v100
v_xor_b32 v102, 4, v101
v_lshl_add_u32 v3, v102, 4, v100
v_add_u32 v100, s60, v100
v_xor_b32 v102, 0, v101
v_lshl_add_u32 v4, v102, 4, v100
v_add_u32 v100, s60, v100
v_xor_b32 v102, 4, v101
v_lshl_add_u32 v5, v102, 4, v100
s_mov_b32 s62, s41
s_mov_b32 s34, s64
s_add_u32 s96, s32, 128
s_addc_u32 s97, s33, 0
s_sub_u32 s98, s64, 128
s_mov_b32 s99, 0x20000
s_cmp_eq_u32 s43, 5
s_cselect_b32 s98, s98, 0
s_and_b32 s60, s41, 63
s_lshr_b32 s61, s40, 1
s_add_u32 s60, s60, s61
s_lshl_b32 s60, s60, 7
s_and_b32 s61, s40, 1
s_mul_i32 s95, s61, s44
s_lshl_b32 s95, s95, 5
s_add_u32 s95, s95, s60
s_add_u32 m0, s56, 0
s_nop 0
buffer_load_dwordx4 v2, s[32:35], s95 offen offset:0 lds
buffer_load_dwordx4 v3, s[32:35], s95 offen offset:1024 lds
buffer_load_dwordx4 v4, s[32:35], s95 offen offset:2048 lds
buffer_load_dwordx4 v5, s[32:35], s95 offen offset:3072 lds
s_add_u32 s95, s95, s42
s_add_u32 m0, s57, 0
s_add_u32 s59, s55, 0
buffer_load_dwordx4 v6, s[28:31], s59 offen offset:0 lds
buffer_load_dwordx4 v7, s[28:31], s59 offen offset:1024 lds
buffer_load_dwordx4 v8, s[28:31], s59 offen offset:2048 lds
buffer_load_dwordx4 v9, s[28:31], s59 offen offset:3072 lds
s_add_u32 m0, s57, 4096
s_add_u32 s59, s55, 32768
buffer_load_dwordx4 v6, s[28:31], s59 offen offset:0 lds
buffer_load_dwordx4 v7, s[28:31], s59 offen offset:1024 lds
buffer_load_dwordx4 v8, s[28:31], s59 offen offset:2048 lds
buffer_load_dwordx4 v9, s[28:31], s59 offen offset:3072 lds
v_lshlrev_b32 v97, 10, v0
s_add_u32 s60, s55, s69
buffer_load_dword v96, v97, s[28:31], s60 offen
s_add_u32 m0, s56, 16384
s_nop 0
buffer_load_dwordx4 v2, s[32:35], s95 offen offset:0 lds
buffer_load_dwordx4 v3, s[32:35], s95 offen offset:1024 lds
buffer_load_dwordx4 v4, s[32:35], s95 offen offset:2048 lds
buffer_load_dwordx4 v5, s[32:35], s95 offen offset:3072 lds
s_add_u32 s95, s95, s42
s_add_u32 m0, s57, 8192
s_add_u32 s59, s55, 128
buffer_load_dwordx4 v6, s[28:31], s59 offen offset:0 lds
buffer_load_dwordx4 v7, s[28:31], s59 offen offset:1024 lds
buffer_load_dwordx4 v8, s[28:31], s59 offen offset:2048 lds
buffer_load_dwordx4 v9, s[28:31], s59 offen offset:3072 lds
s_add_u32 m0, s57, 12288
s_add_u32 s59, s55, 32896
buffer_load_dwordx4 v6, s[28:31], s59 offen offset:0 lds
buffer_load_dwordx4 v7, s[28:31], s59 offen offset:1024 lds
buffer_load_dwordx4 v8, s[28:31], s59 offen offset:2048 lds
buffer_load_dwordx4 v9, s[28:31], s59 offen offset:3072 lds
s_lshr_b32 s60, s41, 1
s_lshl_b32 s60, s60, 19
s_and_b32 s61, s41, 1
s_lshl_b32 s61, s61, 12
s_add_u32 s60, s60, s61
s_lshl_b32 s61, s54, 13
s_add_u32 s50, s60, s61
s_add_u32 s51, s50, 8192
s_cmp_ge_u32 s41, 64
s_cselect_b32 s53, 1, 0
s_sub_u32 s60, s41, 128
s_cmp_lt_u32 s60, 16
s_cselect_b32 s53, 0, s53
s_waitcnt vmcnt(13)
s_barrier
ds_read_b64_tr_b16 v[32:33], v10 offset:0
ds_read_b64_tr_b16 v[34:35], v10 offset:512
ds_read_b64_tr_b16 v[36:37], v10 offset:4096
ds_read_b64_tr_b16 v[38:39], v10 offset:4608
ds_read_b128 a[0:3], v14 offset:0
ds_read_b128 a[4:7], v15 offset:0
ds_read_b128 a[64:67], v14 offset:2048
ds_read_b128 a[68:71], v15 offset:2048
ds_read_b128 a[128:131], v14 offset:4096
ds_read_b128 a[132:135], v15 offset:4096
ds_read_b128 a[192:195], v14 offset:6144
ds_read_b128 a[196:199], v15 offset:6144
ds_read_b64_tr_b16 v[40:41], v11 offset:0
ds_read_b64_tr_b16 v[42:43], v11 offset:512
ds_read_b64_tr_b16 v[44:45], v11 offset:4096
ds_read_b64_tr_b16 v[46:47], v11 offset:4608
ds_read_b64_tr_b16 v[48:49], v12 offset:0
ds_read_b64_tr_b16 v[50:51], v12 offset:512
ds_read_b64_tr_b16 v[52:53], v12 offset:4096
ds_read_b64_tr_b16 v[54:55], v12 offset:4608
ds_read_b64_tr_b16 v[56:57], v13 offset:0
ds_read_b64_tr_b16 v[58:59], v13 offset:512
s_add_u32 m0, s67, 0
s_add_u32 s59, s55, 256
buffer_load_dwordx4 v6, s[28:31], s59 offen offset:0 lds
buffer_load_dwordx4 v7, s[28:31], s59 offen offset:1024 lds
buffer_load_dwordx4 v8, s[28:31], s59 offen offset:2048 lds
buffer_load_dwordx4 v9, s[28:31], s59 offen offset:3072 lds
s_add_u32 m0, s67, 4096
s_add_u32 s59, s55, 33024
buffer_load_dwordx4 v6, s[28:31], s59 offen offset:0 lds
buffer_load_dwordx4 v7, s[28:31], s59 offen offset:1024 lds
buffer_load_dwordx4 v8, s[28:31], s59 offen offset:2048 lds
buffer_load_dwordx4 v9, s[28:31], s59 offen offset:3072 lds
s_cmp_eq_u32 s53, 1
s_cbranch_scc1 K1_D11
s_cmp_eq_u32 s41, 143
s_cbranch_scc1 K1_D01
.p2align 6
K1_D00:
s_waitcnt lgkmcnt(6)
v_mfma_f32_16x16x32_bf16 v[128:131], v[32:35], a[0:3], 0
ds_read_b64_tr_b16 v[60:61], v13 offset:4096
v_mfma_f32_16x16x32_bf16 v[128:131], v[36:39], a[4:7], v[128:131]
s_add_u32 m0, s57, 0
s_add_u32 s59, s55, 384
v_mfma_f32_16x16x32_bf16 v[132:135], v[32:35], a[64:67], 0
ds_read_b64_tr_b16 v[62:63], v13 offset:4608
v_mfma_f32_16x16x32_bf16 v[132:135], v[36:39], a[68:71], v[132:135]
buffer_load_dwordx4 v6, s[28:31], s59 offen offset:0 lds
v_mfma_f32_16x16x32_bf16 v[136:139], v[32:35], a[128:131], 0
ds_read_b64_tr_b16 v[64:65], v10 offset:8192
v_mfma_f32_16x16x32_bf16 v[136:139], v[36:39], a[132:135], v[136:139]
buffer_load_dwordx4 v7, s[28:31], s59 offen offset:1024 lds
v_mfma_f32_16x16x32_bf16 v[140:143], v[32:35], a[192:195], 0
ds_read_b64_tr_b16 v[66:67], v10 offset:8704
v_mfma_f32_16x16x32_bf16 v[140:143], v[36:39], a[196:199], v[140:143]
buffer_load_dwordx4 v8, s[28:31], s59 offen offset:2048 lds
v_mfma_f32_16x16x32_bf16 v[144:147], v[40:43], a[0:3], 0
ds_read_b64_tr_b16 v[68:69], v10 offset:12288
v_mfma_f32_16x16x32_bf16 v[144:147], v[44:47], a[4:7], v[144:147]
buffer_load_dwordx4 v9, s[28:31], s59 offen offset:3072 lds
v_mfma_f32_16x16x32_bf16 v[148:151], v[40:43], a[64:67], 0
ds_read_b64_tr_b16 v[70:71], v10 offset:12800
v_mfma_f32_16x16x32_bf16 v[148:151], v[44:47], a[68:71], v[148:151]
s_add_u32 m0, s57, 4096
s_add_u32 s59, s55, 33152
v_mfma_f32_16x16x32_bf16 v[152:155], v[40:43], a[128:131], 0
ds_read_b64_tr_b16 v[72:73], v11 offset:8192
v_mfma_f32_16x16x32_bf16 v[152:155], v[44:47], a[132:135], v[152:155]
buffer_load_dwordx4 v6, s[28:31], s59 offen offset:0 lds
v_mfma_f32_16x16x32_bf16 v[156:159], v[40:43], a[192:195], 0
ds_read_b64_tr_b16 v[74:75], v11 offset:8704
v_mfma_f32_16x16x32_bf16 v[156:159], v[44:47], a[196:199], v[156:159]
s_waitcnt lgkmcnt(6)
v_mfma_f32_16x16x32_bf16 v[160:163], v[48:51], a[0:3], 0
ds_read_b64_tr_b16 v[76:77], v11 offset:12288
v_mfma_f32_16x16x32_bf16 v[160:163], v[52:55], a[4:7], v[160:163]
buffer_load_dwordx4 v7, s[28:31], s59 offen offset:1024 lds
v_mfma_f32_16x16x32_bf16 v[164:167], v[48:51], a[64:67], 0
ds_read_b64_tr_b16 v[78:79], v11 offset:12800
v_mfma_f32_16x16x32_bf16 v[164:167], v[52:55], a[68:71], v[164:167]
buffer_load_dwordx4 v8, s[28:31], s59 offen offset:2048 lds
v_mfma_f32_16x16x32_bf16 v[168:171], v[48:51], a[128:131], 0
ds_read_b64_tr_b16 v[80:81], v12 offset:8192
v_mfma_f32_16x16x32_bf16 v[168:171], v[52:55], a[132:135], v[168:171]
buffer_load_dwordx4 v9, s[28:31], s59 offen offset:3072 lds
v_mfma_f32_16x16x32_bf16 v[172:175], v[48:51], a[192:195], 0
ds_read_b64_tr_b16 v[82:83], v12 offset:8704
v_mfma_f32_16x16x32_bf16 v[172:175], v[52:55], a[196:199], v[172:175]
s_add_u32 m0, s56, 32768
v_mfma_f32_16x16x32_bf16 v[176:179], v[56:59], a[0:3], 0
ds_read_b64_tr_b16 v[84:85], v12 offset:12288
v_mfma_f32_16x16x32_bf16 v[176:179], v[60:63], a[4:7], v[176:179]
buffer_load_dwordx4 v2, s[32:35], s95 offen offset:0 lds
v_mfma_f32_16x16x32_bf16 v[180:183], v[56:59], a[64:67], 0
ds_read_b64_tr_b16 v[86:87], v12 offset:12800
v_mfma_f32_16x16x32_bf16 v[180:183], v[60:63], a[68:71], v[180:183]
buffer_load_dwordx4 v3, s[32:35], s95 offen offset:1024 lds
v_mfma_f32_16x16x32_bf16 v[184:187], v[56:59], a[128:131], 0
ds_read_b64_tr_b16 v[88:89], v13 offset:8192
v_mfma_f32_16x16x32_bf16 v[184:187], v[60:63], a[132:135], v[184:187]
buffer_load_dwordx4 v4, s[32:35], s95 offen offset:2048 lds
v_mfma_f32_16x16x32_bf16 v[188:191], v[56:59], a[192:195], 0
ds_read_b64_tr_b16 v[90:91], v13 offset:8704
v_mfma_f32_16x16x32_bf16 v[188:191], v[60:63], a[196:199], v[188:191]
s_waitcnt lgkmcnt(6)
v_mfma_f32_16x16x32_bf16 v[192:195], v[64:67], a[0:3], 0
ds_read_b64_tr_b16 v[92:93], v13 offset:12288
v_mfma_f32_16x16x32_bf16 v[192:195], v[68:71], a[4:7], v[192:195]
buffer_load_dwordx4 v5, s[32:35], s95 offen offset:3072 lds
s_add_u32 s95, s95, s42
v_mfma_f32_16x16x32_bf16 v[196:199], v[64:67], a[64:67], 0
ds_read_b64_tr_b16 v[94:95], v13 offset:12800
v_mfma_f32_16x16x32_bf16 v[196:199], v[68:71], a[68:71], v[196:199]
s_waitcnt vmcnt(28)
s_barrier
v_mfma_f32_16x16x32_bf16 v[200:203], v[64:67], a[128:131], 0
ds_read_b64_tr_b16 v[32:33], v10 offset:16384
v_mfma_f32_16x16x32_bf16 v[200:203], v[68:71], a[132:135], v[200:203]
s_add_u32 m0, s56, 49152
v_mfma_f32_16x16x32_bf16 v[204:207], v[64:67], a[192:195], 0
ds_read_b64_tr_b16 v[34:35], v10 offset:16896
v_mfma_f32_16x16x32_bf16 v[204:207], v[68:71], a[196:199], v[204:207]
buffer_load_dwordx4 v2, s[32:35], s95 offen offset:0 lds
v_mfma_f32_16x16x32_bf16 v[208:211], v[72:75], a[0:3], 0
ds_read_b64_tr_b16 v[36:37], v10 offset:20480
v_mfma_f32_16x16x32_bf16 v[208:211], v[76:79], a[4:7], v[208:211]
buffer_load_dwordx4 v3, s[32:35], s95 offen offset:1024 lds
v_mfma_f32_16x16x32_bf16 v[212:215], v[72:75], a[64:67], 0
ds_read_b64_tr_b16 v[38:39], v10 offset:20992
v_mfma_f32_16x16x32_bf16 v[212:215], v[76:79], a[68:71], v[212:215]
buffer_load_dwordx4 v4, s[32:35], s95 offen offset:2048 lds
v_mfma_f32_16x16x32_bf16 v[216:219], v[72:75], a[128:131], 0
ds_read_b64_tr_b16 v[40:41], v11 offset:16384
v_mfma_f32_16x16x32_bf16 v[216:219], v[76:79], a[132:135], v[216:219]
buffer_load_dwordx4 v5, s[32:35], s95 offen offset:3072 lds
v_mfma_f32_16x16x32_bf16 v[220:223], v[72:75], a[192:195], 0
ds_read_b64_tr_b16 v[42:43], v11 offset:16896
v_mfma_f32_16x16x32_bf16 v[220:223], v[76:79], a[196:199], v[220:223]
s_waitcnt lgkmcnt(6)
v_mfma_f32_16x16x32_bf16 v[224:227], v[80:83], a[0:3], 0
ds_read_b64_tr_b16 v[44:45], v11 offset:20480
v_mfma_f32_16x16x32_bf16 v[224:227], v[84:87], a[4:7], v[224:227]
s_add_u32 s95, s95, s42
s_waitcnt vmcnt(24)
ds_read_b128 a[8:11], v14 offset:8192
v_mfma_f32_16x16x32_bf16 v[228:231], v[80:83], a[64:67], 0
ds_read_b64_tr_b16 v[46:47], v11 offset:20992
v_mfma_f32_16x16x32_bf16 v[228:231], v[84:87], a[68:71], v[228:231]
ds_read_b128 a[72:75], v14 offset:10240
v_mfma_f32_16x16x32_bf16 v[232:235], v[80:83], a[128:131], 0
ds_read_b64_tr_b16 v[48:49], v12 offset:16384
v_mfma_f32_16x16x32_bf16 v[232:235], v[84:87], a[132:135], v[232:235]
ds_read_b128 a[136:139], v14 offset:12288
v_mfma_f32_16x16x32_bf16 v[236:239], v[80:83], a[192:195], 0
ds_read_b64_tr_b16 v[50:51], v12 offset:16896
v_mfma_f32_16x16x32_bf16 v[236:239], v[84:87], a[196:199], v[236:239]
ds_read_b128 a[200:203], v14 offset:14336
v_mfma_f32_16x16x32_bf16 v[240:243], v[88:91], a[0:3], 0
ds_read_b64_tr_b16 v[52:53], v12 offset:20480
v_mfma_f32_16x16x32_bf16 v[240:243], v[92:95], a[4:7], v[240:243]
ds_read_b128 a[12:15], v15 offset:8192
v_mfma_f32_16x16x32_bf16 v[244:247], v[88:91], a[64:67], 0
ds_read_b64_tr_b16 v[54:55], v12 offset:20992
v_mfma_f32_16x16x32_bf16 v[244:247], v[92:95], a[68:71], v[244:247]
ds_read_b128 a[76:79], v15 offset:10240
v_mfma_f32_16x16x32_bf16 v[248:251], v[88:91], a[128:131], 0
ds_read_b64_tr_b16 v[56:57], v13 offset:16384
v_mfma_f32_16x16x32_bf16 v[248:251], v[92:95], a[132:135], v[248:251]
ds_read_b128 a[140:143], v15 offset:12288
ds_read_b128 a[204:207], v15 offset:14336
v_mfma_f32_16x16x32_bf16 v[252:255], v[88:91], a[192:195], 0
ds_read_b64_tr_b16 v[58:59], v13 offset:16896
v_mfma_f32_16x16x32_bf16 v[252:255], v[92:95], a[196:199], v[252:255]
s_waitcnt lgkmcnt(1)
v_mfma_f32_16x16x32_bf16 v[128:131], v[32:35], a[8:11], v[128:131]
ds_read_b64_tr_b16 v[60:61], v13 offset:20480
v_mfma_f32_16x16x32_bf16 v[128:131], v[36:39], a[12:15], v[128:131]
s_add_u32 m0, s57, 8192
s_add_u32 s59, s55, 512
v_mfma_f32_16x16x32_bf16 v[132:135], v[32:35], a[72:75], v[132:135]
ds_read_b64_tr_b16 v[62:63], v13 offset:20992
v_mfma_f32_16x16x32_bf16 v[132:135], v[36:39], a[76:79], v[132:135]
buffer_load_dwordx4 v6, s[28:31], s59 offen offset:0 lds
v_mfma_f32_16x16x32_bf16 v[136:139], v[32:35], a[136:139], v[136:139]
ds_read_b64_tr_b16 v[64:65], v10 offset:24576
v_mfma_f32_16x16x32_bf16 v[136:139], v[36:39], a[140:143], v[136:139]
buffer_load_dwordx4 v7, s[28:31], s59 offen offset:1024 lds
v_mfma_f32_16x16x32_bf16 v[140:143], v[32:35], a[200:203], v[140:143]
ds_read_b64_tr_b16 v[66:67], v10 offset:25088
v_mfma_f32_16x16x32_bf16 v[140:143], v[36:39], a[204:207], v[140:143]
buffer_load_dwordx4 v8, s[28:31], s59 offen offset:2048 lds
v_mfma_f32_16x16x32_bf16 v[144:147], v[40:43], a[8:11], v[144:147]
ds_read_b64_tr_b16 v[68:69], v10 offset:28672
v_mfma_f32_16x16x32_bf16 v[144:147], v[44:47], a[12:15], v[144:147]
buffer_load_dwordx4 v9, s[28:31], s59 offen offset:3072 lds
v_mfma_f32_16x16x32_bf16 v[148:151], v[40:43], a[72:75], v[148:151]
ds_read_b64_tr_b16 v[70:71], v10 offset:29184
v_mfma_f32_16x16x32_bf16 v[148:151], v[44:47], a[76:79], v[148:151]
s_add_u32 m0, s57, 12288
s_add_u32 s59, s55, 33280
v_mfma_f32_16x16x32_bf16 v[152:155], v[40:43], a[136:139], v[152:155]
ds_read_b64_tr_b16 v[72:73], v11 offset:24576
v_mfma_f32_16x16x32_bf16 v[152:155], v[44:47], a[140:143], v[152:155]
buffer_load_dwordx4 v6, s[28:31], s59 offen offset:0 lds
v_mfma_f32_16x16x32_bf16 v[156:159], v[40:43], a[200:203], v[156:159]
ds_read_b64_tr_b16 v[74:75], v11 offset:25088
v_mfma_f32_16x16x32_bf16 v[156:159], v[44:47], a[204:207], v[156:159]
s_waitcnt lgkmcnt(6)
v_mfma_f32_16x16x32_bf16 v[160:163], v[48:51], a[8:11], v[160:163]
ds_read_b64_tr_b16 v[76:77], v11 offset:28672
v_mfma_f32_16x16x32_bf16 v[160:163], v[52:55], a[12:15], v[160:163]
buffer_load_dwordx4 v7, s[28:31], s59 offen offset:1024 lds
v_mfma_f32_16x16x32_bf16 v[164:167], v[48:51], a[72:75], v[164:167]
ds_read_b64_tr_b16 v[78:79], v11 offset:29184
v_mfma_f32_16x16x32_bf16 v[164:167], v[52:55], a[76:79], v[164:167]
buffer_load_dwordx4 v8, s[28:31], s59 offen offset:2048 lds
v_mfma_f32_16x16x32_bf16 v[168:171], v[48:51], a[136:139], v[168:171]
ds_read_b64_tr_b16 v[80:81], v12 offset:24576
v_mfma_f32_16x16x32_bf16 v[168:171], v[52:55], a[140:143], v[168:171]
buffer_load_dwordx4 v9, s[28:31], s59 offen offset:3072 lds
v_mfma_f32_16x16x32_bf16 v[172:175], v[48:51], a[200:203], v[172:175]
ds_read_b64_tr_b16 v[82:83], v12 offset:25088
v_mfma_f32_16x16x32_bf16 v[172:175], v[52:55], a[204:207], v[172:175]
s_mov_b32 s47, s50
s_mov_b32 s48, s51
s_add_u32 s41, s41, 1
s_sub_u32 s43, s43, 1
v_mfma_f32_16x16x32_bf16 v[176:179], v[56:59], a[8:11], v[176:179]
ds_read_b64_tr_b16 v[84:85], v12 offset:28672
v_mfma_f32_16x16x32_bf16 v[176:179], v[60:63], a[12:15], v[176:179]
s_lshr_b32 s60, s41, 1
s_lshl_b32 s60, s60, 19
s_and_b32 s61, s41, 1
s_lshl_b32 s61, s61, 12
v_mfma_f32_16x16x32_bf16 v[180:183], v[56:59], a[72:75], v[180:183]
ds_read_b64_tr_b16 v[86:87], v12 offset:29184
v_mfma_f32_16x16x32_bf16 v[180:183], v[60:63], a[76:79], v[180:183]
s_add_u32 s60, s60, s61
s_lshl_b32 s61, s54, 13
s_add_u32 s50, s60, s61
s_add_u32 s51, s50, 8192
v_mfma_f32_16x16x32_bf16 v[184:187], v[56:59], a[136:139], v[184:187]
ds_read_b64_tr_b16 v[88:89], v13 offset:24576
v_mfma_f32_16x16x32_bf16 v[184:187], v[60:63], a[140:143], v[184:187]
s_cmp_ge_u32 s41, 64
s_cselect_b32 s53, 1, 0
s_sub_u32 s60, s41, 128
s_cmp_lt_u32 s60, 16
s_cselect_b32 s53, 0, s53
v_mfma_f32_16x16x32_bf16 v[188:191], v[56:59], a[200:203], v[188:191]
ds_read_b64_tr_b16 v[90:91], v13 offset:25088
v_mfma_f32_16x16x32_bf16 v[188:191], v[60:63], a[204:207], v[188:191]
s_waitcnt lgkmcnt(6)
v_mfma_f32_16x16x32_bf16 v[192:195], v[64:67], a[8:11], v[192:195]
ds_read_b64_tr_b16 v[92:93], v13 offset:28672
v_mfma_f32_16x16x32_bf16 v[192:195], v[68:71], a[12:15], v[192:195]
v_mfma_f32_16x16x32_bf16 v[196:199], v[64:67], a[72:75], v[196:199]
ds_read_b64_tr_b16 v[94:95], v13 offset:29184
v_mfma_f32_16x16x32_bf16 v[196:199], v[68:71], a[76:79], v[196:199]
s_waitcnt vmcnt(12)
s_barrier
v_mfma_f32_16x16x32_bf16 v[200:203], v[64:67], a[136:139], v[200:203]
ds_read_b64_tr_b16 v[32:33], v10 offset:32768
v_mfma_f32_16x16x32_bf16 v[200:203], v[68:71], a[140:143], v[200:203]
s_add_u32 m0, s56, 0
v_mfma_f32_16x16x32_bf16 v[204:207], v[64:67], a[200:203], v[204:207]
ds_read_b64_tr_b16 v[34:35], v10 offset:33280
v_mfma_f32_16x16x32_bf16 v[204:207], v[68:71], a[204:207], v[204:207]
buffer_load_dwordx4 v2, s[32:35], s95 offen offset:0 lds
v_mfma_f32_16x16x32_bf16 v[208:211], v[72:75], a[8:11], v[208:211]
ds_read_b64_tr_b16 v[36:37], v10 offset:36864
v_mfma_f32_16x16x32_bf16 v[208:211], v[76:79], a[12:15], v[208:211]
buffer_load_dwordx4 v3, s[32:35], s95 offen offset:1024 lds
v_mfma_f32_16x16x32_bf16 v[212:215], v[72:75], a[72:75], v[212:215]
ds_read_b64_tr_b16 v[38:39], v10 offset:37376
v_mfma_f32_16x16x32_bf16 v[212:215], v[76:79], a[76:79], v[212:215]
buffer_load_dwordx4 v4, s[32:35], s95 offen offset:2048 lds
v_mfma_f32_16x16x32_bf16 v[216:219], v[72:75], a[136:139], v[216:219]
ds_read_b64_tr_b16 v[40:41], v11 offset:32768
v_mfma_f32_16x16x32_bf16 v[216:219], v[76:79], a[140:143], v[216:219]
buffer_load_dwordx4 v5, s[32:35], s95 offen offset:3072 lds
v_mfma_f32_16x16x32_bf16 v[220:223], v[72:75], a[200:203], v[220:223]
ds_read_b64_tr_b16 v[42:43], v11 offset:33280
v_mfma_f32_16x16x32_bf16 v[220:223], v[76:79], a[204:207], v[220:223]
s_waitcnt lgkmcnt(6)
v_mfma_f32_16x16x32_bf16 v[224:227], v[80:83], a[8:11], v[224:227]
ds_read_b64_tr_b16 v[44:45], v11 offset:36864
v_mfma_f32_16x16x32_bf16 v[224:227], v[84:87], a[12:15], v[224:227]
s_add_u32 s95, s95, s42
ds_read_b128 a[16:19], v26 offset:0
v_mfma_f32_16x16x32_bf16 v[228:231], v[80:83], a[72:75], v[228:231]
ds_read_b64_tr_b16 v[46:47], v11 offset:37376
v_mfma_f32_16x16x32_bf16 v[228:231], v[84:87], a[76:79], v[228:231]
ds_read_b128 a[80:83], v26 offset:2048
v_mfma_f32_16x16x32_bf16 v[232:235], v[80:83], a[136:139], v[232:235]
ds_read_b64_tr_b16 v[48:49], v12 offset:32768
v_mfma_f32_16x16x32_bf16 v[232:235], v[84:87], a[140:143], v[232:235]
ds_read_b128 a[144:147], v26 offset:4096
v_mfma_f32_16x16x32_bf16 v[236:239], v[80:83], a[200:203], v[236:239]
ds_read_b64_tr_b16 v[50:51], v12 offset:33280
v_mfma_f32_16x16x32_bf16 v[236:239], v[84:87], a[204:207], v[236:239]
ds_read_b128 a[208:211], v26 offset:6144
v_mfma_f32_16x16x32_bf16 v[240:243], v[88:91], a[8:11], v[240:243]
ds_read_b64_tr_b16 v[52:53], v12 offset:36864
v_mfma_f32_16x16x32_bf16 v[240:243], v[92:95], a[12:15], v[240:243]
ds_read_b128 a[20:23], v27 offset:0
v_mfma_f32_16x16x32_bf16 v[244:247], v[88:91], a[72:75], v[244:247]
ds_read_b64_tr_b16 v[54:55], v12 offset:37376
v_mfma_f32_16x16x32_bf16 v[244:247], v[92:95], a[76:79], v[244:247]
ds_read_b128 a[84:87], v27 offset:2048
v_mfma_f32_16x16x32_bf16 v[248:251], v[88:91], a[136:139], v[248:251]
ds_read_b64_tr_b16 v[56:57], v13 offset:32768
v_mfma_f32_16x16x32_bf16 v[248:251], v[92:95], a[140:143], v[248:251]
ds_read_b128 a[148:151], v27 offset:4096
ds_read_b128 a[212:215], v27 offset:6144
v_mfma_f32_16x16x32_bf16 v[252:255], v[88:91], a[200:203], v[252:255]
ds_read_b64_tr_b16 v[58:59], v13 offset:33280
v_mfma_f32_16x16x32_bf16 v[252:255], v[92:95], a[204:207], v[252:255]
s_waitcnt lgkmcnt(1)
v_mfma_f32_16x16x32_bf16 v[128:131], v[32:35], a[16:19], v[128:131]
ds_read_b64_tr_b16 v[60:61], v13 offset:36864
v_mfma_f32_16x16x32_bf16 v[128:131], v[36:39], a[20:23], v[128:131]
s_add_u32 m0, s67, 0
s_add_u32 s59, s55, 640
v_mfma_f32_16x16x32_bf16 v[132:135], v[32:35], a[80:83], v[132:135]
ds_read_b64_tr_b16 v[62:63], v13 offset:37376
buffer_load_dwordx4 v[112:115], v16, s[32:35], s68 offen offset:0
v_mfma_f32_16x16x32_bf16 v[132:135], v[36:39], a[84:87], v[132:135]
buffer_load_dwordx4 v6, s[28:31], s59 offen offset:0 lds
v_mfma_f32_16x16x32_bf16 v[136:139], v[32:35], a[144:147], v[136:139]
ds_read_b64_tr_b16 v[64:65], v10 offset:40960
buffer_load_dwordx4 v[116:119], v16, s[32:35], s68 offen offset:1024
v_mfma_f32_16x16x32_bf16 v[136:139], v[36:39], a[148:151], v[136:139]
buffer_load_dwordx4 v7, s[28:31], s59 offen offset:1024 lds
v_mfma_f32_16x16x32_bf16 v[140:143], v[32:35], a[208:211], v[140:143]
ds_read_b64_tr_b16 v[66:67], v10 offset:41472
buffer_load_dwordx4 v[120:123], v16, s[32:35], s68 offen offset:2048
v_mfma_f32_16x16x32_bf16 v[140:143], v[36:39], a[212:215], v[140:143]
buffer_load_dwordx4 v8, s[28:31], s59 offen offset:2048 lds
v_mfma_f32_16x16x32_bf16 v[144:147], v[40:43], a[16:19], v[144:147]
ds_read_b64_tr_b16 v[68:69], v10 offset:45056
buffer_load_dwordx4 v[124:127], v16, s[32:35], s68 offen offset:3072
s_add_u32 s68, s68, 4096
v_mfma_f32_16x16x32_bf16 v[144:147], v[44:47], a[20:23], v[144:147]
buffer_load_dwordx4 v9, s[28:31], s59 offen offset:3072 lds
v_mfma_f32_16x16x32_bf16 v[148:151], v[40:43], a[80:83], v[148:151]
ds_read_b64_tr_b16 v[70:71], v10 offset:45568
buffer_load_dwordx4 v[112:115], v16, s[32:35], s68 offen offset:0
v_mfma_f32_16x16x32_bf16 v[148:151], v[44:47], a[84:87], v[148:151]
s_add_u32 m0, s67, 4096
s_add_u32 s59, s55, 33408
v_mfma_f32_16x16x32_bf16 v[152:155], v[40:43], a[144:147], v[152:155]
ds_read_b64_tr_b16 v[72:73], v11 offset:40960
buffer_load_dwordx4 v[116:119], v16, s[32:35], s68 offen offset:1024
v_mfma_f32_16x16x32_bf16 v[152:155], v[44:47], a[148:151], v[152:155]
buffer_load_dwordx4 v6, s[28:31], s59 offen offset:0 lds
v_mfma_f32_16x16x32_bf16 v[156:159], v[40:43], a[208:211], v[156:159]
ds_read_b64_tr_b16 v[74:75], v11 offset:41472
buffer_load_dwordx4 v[120:123], v16, s[32:35], s68 offen offset:2048
v_mfma_f32_16x16x32_bf16 v[156:159], v[44:47], a[212:215], v[156:159]
s_waitcnt lgkmcnt(6)
v_mfma_f32_16x16x32_bf16 v[160:163], v[48:51], a[16:19], v[160:163]
ds_read_b64_tr_b16 v[76:77], v11 offset:45056
buffer_load_dwordx4 v[124:127], v16, s[32:35], s68 offen offset:3072
s_add_u32 s68, s68, 4096
v_mfma_f32_16x16x32_bf16 v[160:163], v[52:55], a[20:23], v[160:163]
buffer_load_dwordx4 v7, s[28:31], s59 offen offset:1024 lds
v_mfma_f32_16x16x32_bf16 v[164:167], v[48:51], a[80:83], v[164:167]
ds_read_b64_tr_b16 v[78:79], v11 offset:45568
buffer_load_dwordx4 v[112:115], v16, s[32:35], s68 offen offset:0
v_mfma_f32_16x16x32_bf16 v[164:167], v[52:55], a[84:87], v[164:167]
buffer_load_dwordx4 v8, s[28:31], s59 offen offset:2048 lds
v_mfma_f32_16x16x32_bf16 v[168:171], v[48:51], a[144:147], v[168:171]
ds_read_b64_tr_b16 v[80:81], v12 offset:40960
buffer_load_dwordx4 v[116:119], v16, s[32:35], s68 offen offset:1024
v_mfma_f32_16x16x32_bf16 v[168:171], v[52:55], a[148:151], v[168:171]
buffer_load_dwordx4 v9, s[28:31], s59 offen offset:3072 lds
v_mfma_f32_16x16x32_bf16 v[172:175], v[48:51], a[208:211], v[172:175]
ds_read_b64_tr_b16 v[82:83], v12 offset:41472
v_mfma_f32_16x16x32_bf16 v[172:175], v[52:55], a[212:215], v[172:175]
v_mfma_f32_16x16x32_bf16 v[176:179], v[56:59], a[16:19], v[176:179]
ds_read_b64_tr_b16 v[84:85], v12 offset:45056
v_mfma_f32_16x16x32_bf16 v[176:179], v[60:63], a[20:23], v[176:179]
v_mfma_f32_16x16x32_bf16 v[180:183], v[56:59], a[80:83], v[180:183]
ds_read_b64_tr_b16 v[86:87], v12 offset:45568
v_mfma_f32_16x16x32_bf16 v[180:183], v[60:63], a[84:87], v[180:183]
v_mfma_f32_16x16x32_bf16 v[184:187], v[56:59], a[144:147], v[184:187]
ds_read_b64_tr_b16 v[88:89], v13 offset:40960
v_mfma_f32_16x16x32_bf16 v[184:187], v[60:63], a[148:151], v[184:187]
v_mfma_f32_16x16x32_bf16 v[188:191], v[56:59], a[208:211], v[188:191]
ds_read_b64_tr_b16 v[90:91], v13 offset:41472
v_mfma_f32_16x16x32_bf16 v[188:191], v[60:63], a[212:215], v[188:191]
s_waitcnt lgkmcnt(6)
v_mfma_f32_16x16x32_bf16 v[192:195], v[64:67], a[16:19], v[192:195]
ds_read_b64_tr_b16 v[92:93], v13 offset:45056
v_mfma_f32_16x16x32_bf16 v[192:195], v[68:71], a[20:23], v[192:195]
v_mfma_f32_16x16x32_bf16 v[196:199], v[64:67], a[80:83], v[196:199]
ds_read_b64_tr_b16 v[94:95], v13 offset:45568
v_mfma_f32_16x16x32_bf16 v[196:199], v[68:71], a[84:87], v[196:199]
s_waitcnt vmcnt(30)
s_barrier
v_mfma_f32_16x16x32_bf16 v[200:203], v[64:67], a[144:147], v[200:203]
ds_read_b64_tr_b16 v[32:33], v10 offset:49152
v_mfma_f32_16x16x32_bf16 v[200:203], v[68:71], a[148:151], v[200:203]
s_add_u32 m0, s56, 16384
v_mfma_f32_16x16x32_bf16 v[204:207], v[64:67], a[208:211], v[204:207]
ds_read_b64_tr_b16 v[34:35], v10 offset:49664
v_mfma_f32_16x16x32_bf16 v[204:207], v[68:71], a[212:215], v[204:207]
buffer_load_dwordx4 v2, s[32:35], s95 offen offset:0 lds
v_mfma_f32_16x16x32_bf16 v[208:211], v[72:75], a[16:19], v[208:211]
ds_read_b64_tr_b16 v[36:37], v10 offset:53248
v_mfma_f32_16x16x32_bf16 v[208:211], v[76:79], a[20:23], v[208:211]
buffer_load_dwordx4 v3, s[32:35], s95 offen offset:1024 lds
v_mfma_f32_16x16x32_bf16 v[212:215], v[72:75], a[80:83], v[212:215]
ds_read_b64_tr_b16 v[38:39], v10 offset:53760
v_mfma_f32_16x16x32_bf16 v[212:215], v[76:79], a[84:87], v[212:215]
buffer_load_dwordx4 v4, s[32:35], s95 offen offset:2048 lds
v_mfma_f32_16x16x32_bf16 v[216:219], v[72:75], a[144:147], v[216:219]
ds_read_b64_tr_b16 v[40:41], v11 offset:49152
v_mfma_f32_16x16x32_bf16 v[216:219], v[76:79], a[148:151], v[216:219]
buffer_load_dwordx4 v5, s[32:35], s95 offen offset:3072 lds
v_mfma_f32_16x16x32_bf16 v[220:223], v[72:75], a[208:211], v[220:223]
ds_read_b64_tr_b16 v[42:43], v11 offset:49664
v_mfma_f32_16x16x32_bf16 v[220:223], v[76:79], a[212:215], v[220:223]
s_waitcnt lgkmcnt(6)
v_mfma_f32_16x16x32_bf16 v[224:227], v[80:83], a[16:19], v[224:227]
ds_read_b64_tr_b16 v[44:45], v11 offset:53248
v_mfma_f32_16x16x32_bf16 v[224:227], v[84:87], a[20:23], v[224:227]
s_add_u32 s95, s95, s42
ds_read_b128 a[24:27], v14 offset:0
v_mfma_f32_16x16x32_bf16 v[228:231], v[80:83], a[80:83], v[228:231]
ds_read_b64_tr_b16 v[46:47], v11 offset:53760
v_mfma_f32_16x16x32_bf16 v[228:231], v[84:87], a[84:87], v[228:231]
ds_read_b128 a[88:91], v14 offset:2048
v_mfma_f32_16x16x32_bf16 v[232:235], v[80:83], a[144:147], v[232:235]
ds_read_b64_tr_b16 v[48:49], v12 offset:49152
v_mfma_f32_16x16x32_bf16 v[232:235], v[84:87], a[148:151], v[232:235]
ds_read_b128 a[152:155], v14 offset:4096
v_mfma_f32_16x16x32_bf16 v[236:239], v[80:83], a[208:211], v[236:239]
ds_read_b64_tr_b16 v[50:51], v12 offset:49664
v_mfma_f32_16x16x32_bf16 v[236:239], v[84:87], a[212:215], v[236:239]
ds_read_b128 a[216:219], v14 offset:6144
v_mfma_f32_16x16x32_bf16 v[240:243], v[88:91], a[16:19], v[240:243]
ds_read_b64_tr_b16 v[52:53], v12 offset:53248
v_mfma_f32_16x16x32_bf16 v[240:243], v[92:95], a[20:23], v[240:243]
ds_read_b128 a[28:31], v15 offset:0
v_mfma_f32_16x16x32_bf16 v[244:247], v[88:91], a[80:83], v[244:247]
ds_read_b64_tr_b16 v[54:55], v12 offset:53760
v_mfma_f32_16x16x32_bf16 v[244:247], v[92:95], a[84:87], v[244:247]
ds_read_b128 a[92:95], v15 offset:2048
v_mfma_f32_16x16x32_bf16 v[248:251], v[88:91], a[144:147], v[248:251]
ds_read_b64_tr_b16 v[56:57], v13 offset:49152
v_mfma_f32_16x16x32_bf16 v[248:251], v[92:95], a[148:151], v[248:251]
ds_read_b128 a[156:159], v15 offset:4096
ds_read_b128 a[220:223], v15 offset:6144
v_mfma_f32_16x16x32_bf16 v[252:255], v[88:91], a[208:211], v[252:255]
ds_read_b64_tr_b16 v[58:59], v13 offset:49664
v_mfma_f32_16x16x32_bf16 v[252:255], v[92:95], a[212:215], v[252:255]
s_waitcnt lgkmcnt(1)
v_mfma_f32_16x16x32_bf16 v[128:131], v[32:35], a[24:27], v[128:131]
ds_read_b64_tr_b16 v[60:61], v13 offset:53248
v_mfma_f32_16x16x32_bf16 v[128:131], v[36:39], a[28:31], v[128:131]
s_add_u32 m0, s57, 0
s_add_u32 s59, s55, 768
v_mfma_f32_16x16x32_bf16 v[132:135], v[32:35], a[88:91], v[132:135]
ds_read_b64_tr_b16 v[62:63], v13 offset:53760
v_mfma_f32_16x16x32_bf16 v[132:135], v[36:39], a[92:95], v[132:135]
buffer_load_dwordx4 v6, s[28:31], s59 offen offset:0 lds
v_mfma_f32_16x16x32_bf16 v[136:139], v[32:35], a[152:155], v[136:139]
ds_read_b64_tr_b16 v[64:65], v10 offset:57344
v_mfma_f32_16x16x32_bf16 v[136:139], v[36:39], a[156:159], v[136:139]
buffer_load_dwordx4 v7, s[28:31], s59 offen offset:1024 lds
v_mfma_f32_16x16x32_bf16 v[140:143], v[32:35], a[216:219], v[140:143]
ds_read_b64_tr_b16 v[66:67], v10 offset:57856
v_mfma_f32_16x16x32_bf16 v[140:143], v[36:39], a[220:223], v[140:143]
buffer_load_dwordx4 v8, s[28:31], s59 offen offset:2048 lds
v_mfma_f32_16x16x32_bf16 v[144:147], v[40:43], a[24:27], v[144:147]
ds_read_b64_tr_b16 v[68:69], v10 offset:61440
v_mfma_f32_16x16x32_bf16 v[144:147], v[44:47], a[28:31], v[144:147]
buffer_load_dwordx4 v9, s[28:31], s59 offen offset:3072 lds
v_mfma_f32_16x16x32_bf16 v[148:151], v[40:43], a[88:91], v[148:151]
ds_read_b64_tr_b16 v[70:71], v10 offset:61952
v_mfma_f32_16x16x32_bf16 v[148:151], v[44:47], a[92:95], v[148:151]
s_add_u32 m0, s57, 4096
s_add_u32 s59, s55, 33536
v_mfma_f32_16x16x32_bf16 v[152:155], v[40:43], a[152:155], v[152:155]
ds_read_b64_tr_b16 v[72:73], v11 offset:57344
v_mfma_f32_16x16x32_bf16 v[152:155], v[44:47], a[156:159], v[152:155]
buffer_load_dwordx4 v6, s[28:31], s59 offen offset:0 lds
v_mfma_f32_16x16x32_bf16 v[156:159], v[40:43], a[216:219], v[156:159]
ds_read_b64_tr_b16 v[74:75], v11 offset:57856
v_mfma_f32_16x16x32_bf16 v[156:159], v[44:47], a[220:223], v[156:159]
s_waitcnt lgkmcnt(6)
v_mfma_f32_16x16x32_bf16 v[160:163], v[48:51], a[24:27], v[160:163]
ds_read_b64_tr_b16 v[76:77], v11 offset:61440
v_mfma_f32_16x16x32_bf16 v[160:163], v[52:55], a[28:31], v[160:163]
buffer_load_dwordx4 v7, s[28:31], s59 offen offset:1024 lds
v_mfma_f32_16x16x32_bf16 v[164:167], v[48:51], a[88:91], v[164:167]
ds_read_b64_tr_b16 v[78:79], v11 offset:61952
v_mfma_f32_16x16x32_bf16 v[164:167], v[52:55], a[92:95], v[164:167]
buffer_load_dwordx4 v8, s[28:31], s59 offen offset:2048 lds
v_mfma_f32_16x16x32_bf16 v[168:171], v[48:51], a[152:155], v[168:171]
ds_read_b64_tr_b16 v[80:81], v12 offset:57344
v_mfma_f32_16x16x32_bf16 v[168:171], v[52:55], a[156:159], v[168:171]
buffer_load_dwordx4 v9, s[28:31], s59 offen offset:3072 lds
v_mfma_f32_16x16x32_bf16 v[172:175], v[48:51], a[216:219], v[172:175]
ds_read_b64_tr_b16 v[82:83], v12 offset:57856
v_mfma_f32_16x16x32_bf16 v[172:175], v[52:55], a[220:223], v[172:175]
v_mfma_f32_16x16x32_bf16 v[176:179], v[56:59], a[24:27], v[176:179]
ds_read_b64_tr_b16 v[84:85], v12 offset:61440
v_mfma_f32_16x16x32_bf16 v[176:179], v[60:63], a[28:31], v[176:179]
v_mfma_f32_16x16x32_bf16 v[180:183], v[56:59], a[88:91], v[180:183]
ds_read_b64_tr_b16 v[86:87], v12 offset:61952
v_mfma_f32_16x16x32_bf16 v[180:183], v[60:63], a[92:95], v[180:183]
v_mfma_f32_16x16x32_bf16 v[184:187], v[56:59], a[152:155], v[184:187]
ds_read_b64_tr_b16 v[88:89], v13 offset:57344
v_mfma_f32_16x16x32_bf16 v[184:187], v[60:63], a[156:159], v[184:187]
v_mfma_f32_16x16x32_bf16 v[188:191], v[56:59], a[216:219], v[188:191]
ds_read_b64_tr_b16 v[90:91], v13 offset:57856
v_mfma_f32_16x16x32_bf16 v[188:191], v[60:63], a[220:223], v[188:191]
s_waitcnt lgkmcnt(6)
v_mfma_f32_16x16x32_bf16 v[192:195], v[64:67], a[24:27], v[192:195]
ds_read_b64_tr_b16 v[92:93], v13 offset:61440
v_mfma_f32_16x16x32_bf16 v[192:195], v[68:71], a[28:31], v[192:195]
v_mfma_f32_16x16x32_bf16 v[196:199], v[64:67], a[88:91], v[196:199]
ds_read_b64_tr_b16 v[94:95], v13 offset:61952
v_mfma_f32_16x16x32_bf16 v[196:199], v[68:71], a[92:95], v[196:199]
s_waitcnt vmcnt(30)
s_barrier
v_mfma_f32_16x16x32_bf16 v[200:203], v[64:67], a[152:155], v[200:203]
ds_read_b64_tr_b16 v[32:33], v10 offset:0
v_mfma_f32_16x16x32_bf16 v[200:203], v[68:71], a[156:159], v[200:203]
s_add_u32 m0, s56, 32768
v_mfma_f32_16x16x32_bf16 v[204:207], v[64:67], a[216:219], v[204:207]
ds_read_b64_tr_b16 v[34:35], v10 offset:512
v_mfma_f32_16x16x32_bf16 v[204:207], v[68:71], a[220:223], v[204:207]
buffer_load_dwordx4 v2, s[32:35], s95 offen offset:0 lds
v_mfma_f32_16x16x32_bf16 v[208:211], v[72:75], a[24:27], v[208:211]
ds_read_b64_tr_b16 v[36:37], v10 offset:4096
v_mfma_f32_16x16x32_bf16 v[208:211], v[76:79], a[28:31], v[208:211]
buffer_load_dwordx4 v3, s[32:35], s95 offen offset:1024 lds
v_mfma_f32_16x16x32_bf16 v[212:215], v[72:75], a[88:91], v[212:215]
ds_read_b64_tr_b16 v[38:39], v10 offset:4608
v_mfma_f32_16x16x32_bf16 v[212:215], v[76:79], a[92:95], v[212:215]
buffer_load_dwordx4 v4, s[32:35], s95 offen offset:2048 lds
v_mfma_f32_16x16x32_bf16 v[216:219], v[72:75], a[152:155], v[216:219]
ds_read_b64_tr_b16 v[40:41], v11 offset:0
v_mfma_f32_16x16x32_bf16 v[216:219], v[76:79], a[156:159], v[216:219]
buffer_load_dwordx4 v5, s[32:35], s95 offen offset:3072 lds
v_mfma_f32_16x16x32_bf16 v[220:223], v[72:75], a[216:219], v[220:223]
ds_read_b64_tr_b16 v[42:43], v11 offset:512
v_mfma_f32_16x16x32_bf16 v[220:223], v[76:79], a[220:223], v[220:223]
s_waitcnt lgkmcnt(6)
v_mfma_f32_16x16x32_bf16 v[224:227], v[80:83], a[24:27], v[224:227]
ds_read_b64_tr_b16 v[44:45], v11 offset:4096
v_mfma_f32_16x16x32_bf16 v[224:227], v[84:87], a[28:31], v[224:227]
s_add_u32 s95, s95, s42
ds_read_b128 a[32:35], v14 offset:8192
v_mfma_f32_16x16x32_bf16 v[228:231], v[80:83], a[88:91], v[228:231]
ds_read_b64_tr_b16 v[46:47], v11 offset:4608
v_mfma_f32_16x16x32_bf16 v[228:231], v[84:87], a[92:95], v[228:231]
ds_read_b128 a[96:99], v14 offset:10240
v_mfma_f32_16x16x32_bf16 v[232:235], v[80:83], a[152:155], v[232:235]
ds_read_b64_tr_b16 v[48:49], v12 offset:0
v_mfma_f32_16x16x32_bf16 v[232:235], v[84:87], a[156:159], v[232:235]
ds_read_b128 a[160:163], v14 offset:12288
v_mfma_f32_16x16x32_bf16 v[236:239], v[80:83], a[216:219], v[236:239]
ds_read_b64_tr_b16 v[50:51], v12 offset:512
v_mfma_f32_16x16x32_bf16 v[236:239], v[84:87], a[220:223], v[236:239]
ds_read_b128 a[224:227], v14 offset:14336
v_mfma_f32_16x16x32_bf16 v[240:243], v[88:91], a[24:27], v[240:243]
ds_read_b64_tr_b16 v[52:53], v12 offset:4096
v_mfma_f32_16x16x32_bf16 v[240:243], v[92:95], a[28:31], v[240:243]
ds_read_b128 a[36:39], v15 offset:8192
v_mfma_f32_16x16x32_bf16 v[244:247], v[88:91], a[88:91], v[244:247]
ds_read_b64_tr_b16 v[54:55], v12 offset:4608
v_mfma_f32_16x16x32_bf16 v[244:247], v[92:95], a[92:95], v[244:247]
ds_read_b128 a[100:103], v15 offset:10240
v_mfma_f32_16x16x32_bf16 v[248:251], v[88:91], a[152:155], v[248:251]
ds_read_b64_tr_b16 v[56:57], v13 offset:0
v_mfma_f32_16x16x32_bf16 v[248:251], v[92:95], a[156:159], v[248:251]
ds_read_b128 a[164:167], v15 offset:12288
ds_read_b128 a[228:231], v15 offset:14336
v_mfma_f32_16x16x32_bf16 v[252:255], v[88:91], a[216:219], v[252:255]
ds_read_b64_tr_b16 v[58:59], v13 offset:512
v_mfma_f32_16x16x32_bf16 v[252:255], v[92:95], a[220:223], v[252:255]
s_waitcnt lgkmcnt(1)
v_mfma_f32_16x16x32_bf16 v[128:131], v[32:35], a[32:35], v[128:131]
ds_read_b64_tr_b16 v[60:61], v13 offset:4096
v_mfma_f32_16x16x32_bf16 v[128:131], v[36:39], a[36:39], v[128:131]
s_add_u32 m0, s57, 8192
s_add_u32 s59, s55, 896
v_mfma_f32_16x16x32_bf16 v[132:135], v[32:35], a[96:99], v[132:135]
ds_read_b64_tr_b16 v[62:63], v13 offset:4608
v_mfma_f32_16x16x32_bf16 v[132:135], v[36:39], a[100:103], v[132:135]
buffer_load_dwordx4 v6, s[28:31], s59 offen offset:0 lds
v_mfma_f32_16x16x32_bf16 v[136:139], v[32:35], a[160:163], v[136:139]
ds_read_b64_tr_b16 v[64:65], v10 offset:8192
v_mfma_f32_16x16x32_bf16 v[136:139], v[36:39], a[164:167], v[136:139]
buffer_load_dwordx4 v7, s[28:31], s59 offen offset:1024 lds
v_mfma_f32_16x16x32_bf16 v[140:143], v[32:35], a[224:227], v[140:143]
ds_read_b64_tr_b16 v[66:67], v10 offset:8704
v_mfma_f32_16x16x32_bf16 v[140:143], v[36:39], a[228:231], v[140:143]
buffer_load_dwordx4 v8, s[28:31], s59 offen offset:2048 lds
v_mfma_f32_16x16x32_bf16 v[144:147], v[40:43], a[32:35], v[144:147]
ds_read_b64_tr_b16 v[68:69], v10 offset:12288
v_mfma_f32_16x16x32_bf16 v[144:147], v[44:47], a[36:39], v[144:147]
buffer_load_dwordx4 v9, s[28:31], s59 offen offset:3072 lds
v_mfma_f32_16x16x32_bf16 v[148:151], v[40:43], a[96:99], v[148:151]
ds_read_b64_tr_b16 v[70:71], v10 offset:12800
v_mfma_f32_16x16x32_bf16 v[148:151], v[44:47], a[100:103], v[148:151]
s_add_u32 m0, s57, 12288
s_add_u32 s59, s55, 33664
v_mfma_f32_16x16x32_bf16 v[152:155], v[40:43], a[160:163], v[152:155]
ds_read_b64_tr_b16 v[72:73], v11 offset:8192
v_mfma_f32_16x16x32_bf16 v[152:155], v[44:47], a[164:167], v[152:155]
buffer_load_dwordx4 v6, s[28:31], s59 offen offset:0 lds
v_mfma_f32_16x16x32_bf16 v[156:159], v[40:43], a[224:227], v[156:159]
ds_read_b64_tr_b16 v[74:75], v11 offset:8704
v_mfma_f32_16x16x32_bf16 v[156:159], v[44:47], a[228:231], v[156:159]
s_waitcnt lgkmcnt(6)
v_mfma_f32_16x16x32_bf16 v[160:163], v[48:51], a[32:35], v[160:163]
ds_read_b64_tr_b16 v[76:77], v11 offset:12288
v_mfma_f32_16x16x32_bf16 v[160:163], v[52:55], a[36:39], v[160:163]
buffer_load_dwordx4 v7, s[28:31], s59 offen offset:1024 lds
v_mfma_f32_16x16x32_bf16 v[164:167], v[48:51], a[96:99], v[164:167]
ds_read_b64_tr_b16 v[78:79], v11 offset:12800
v_mfma_f32_16x16x32_bf16 v[164:167], v[52:55], a[100:103], v[164:167]
buffer_load_dwordx4 v8, s[28:31], s59 offen offset:2048 lds
v_mfma_f32_16x16x32_bf16 v[168:171], v[48:51], a[160:163], v[168:171]
ds_read_b64_tr_b16 v[80:81], v12 offset:8192
v_mfma_f32_16x16x32_bf16 v[168:171], v[52:55], a[164:167], v[168:171]
buffer_load_dwordx4 v9, s[28:31], s59 offen offset:3072 lds
v_mfma_f32_16x16x32_bf16 v[172:175], v[48:51], a[224:227], v[172:175]
ds_read_b64_tr_b16 v[82:83], v12 offset:8704
v_mfma_f32_16x16x32_bf16 v[172:175], v[52:55], a[228:231], v[172:175]
s_add_u32 s60, s62, 2
s_and_b32 s60, s60, 63
v_mfma_f32_16x16x32_bf16 v[176:179], v[56:59], a[32:35], v[176:179]
ds_read_b64_tr_b16 v[84:85], v12 offset:12288
v_mfma_f32_16x16x32_bf16 v[176:179], v[60:63], a[36:39], v[176:179]
s_lshl_b32 s60, s60, 7
s_mul_i32 s45, s40, s44
v_mfma_f32_16x16x32_bf16 v[180:183], v[56:59], a[96:99], v[180:183]
ds_read_b64_tr_b16 v[86:87], v12 offset:12800
v_mfma_f32_16x16x32_bf16 v[180:183], v[60:63], a[100:103], v[180:183]
s_lshl_b32 s45, s45, 5
s_add_u32 s45, s45, s60
v_mfma_f32_16x16x32_bf16 v[184:187], v[56:59], a[160:163], v[184:187]
ds_read_b64_tr_b16 v[88:89], v13 offset:8192
v_mfma_f32_16x16x32_bf16 v[184:187], v[60:63], a[164:167], v[184:187]
v_mfma_f32_16x16x32_bf16 v[188:191], v[56:59], a[224:227], v[188:191]
ds_read_b64_tr_b16 v[90:91], v13 offset:8704
v_mfma_f32_16x16x32_bf16 v[188:191], v[60:63], a[228:231], v[188:191]
s_waitcnt lgkmcnt(6)
v_mfma_f32_16x16x32_bf16 v[192:195], v[64:67], a[32:35], v[192:195]
ds_read_b64_tr_b16 v[92:93], v13 offset:12288
v_mfma_f32_16x16x32_bf16 v[192:195], v[68:71], a[36:39], v[192:195]
v_mfma_f32_16x16x32_bf16 v[196:199], v[64:67], a[96:99], v[196:199]
ds_read_b64_tr_b16 v[94:95], v13 offset:12800
v_mfma_f32_16x16x32_bf16 v[196:199], v[68:71], a[100:103], v[196:199]
s_waitcnt vmcnt(20)
s_barrier
v_mfma_f32_16x16x32_bf16 v[200:203], v[64:67], a[160:163], v[200:203]
ds_read_b64_tr_b16 v[32:33], v10 offset:16384
v_mfma_f32_16x16x32_bf16 v[200:203], v[68:71], a[164:167], v[200:203]
s_add_u32 m0, s56, 49152
v_mfma_f32_16x16x32_bf16 v[204:207], v[64:67], a[224:227], v[204:207]
ds_read_b64_tr_b16 v[34:35], v10 offset:16896
v_mfma_f32_16x16x32_bf16 v[204:207], v[68:71], a[228:231], v[204:207]
buffer_load_dwordx4 v2, s[32:35], s95 offen offset:0 lds
v_mfma_f32_16x16x32_bf16 v[208:211], v[72:75], a[32:35], v[208:211]
ds_read_b64_tr_b16 v[36:37], v10 offset:20480
v_mfma_f32_16x16x32_bf16 v[208:211], v[76:79], a[36:39], v[208:211]
buffer_load_dwordx4 v3, s[32:35], s95 offen offset:1024 lds
v_mfma_f32_16x16x32_bf16 v[212:215], v[72:75], a[96:99], v[212:215]
ds_read_b64_tr_b16 v[38:39], v10 offset:20992
v_mfma_f32_16x16x32_bf16 v[212:215], v[76:79], a[100:103], v[212:215]
buffer_load_dwordx4 v4, s[32:35], s95 offen offset:2048 lds
v_mfma_f32_16x16x32_bf16 v[216:219], v[72:75], a[160:163], v[216:219]
ds_read_b64_tr_b16 v[40:41], v11 offset:16384
v_mfma_f32_16x16x32_bf16 v[216:219], v[76:79], a[164:167], v[216:219]
buffer_load_dwordx4 v5, s[32:35], s95 offen offset:3072 lds
v_mfma_f32_16x16x32_bf16 v[220:223], v[72:75], a[224:227], v[220:223]
ds_read_b64_tr_b16 v[42:43], v11 offset:16896
v_mfma_f32_16x16x32_bf16 v[220:223], v[76:79], a[228:231], v[220:223]
s_waitcnt lgkmcnt(6)
v_mfma_f32_16x16x32_bf16 v[224:227], v[80:83], a[32:35], v[224:227]
ds_read_b64_tr_b16 v[44:45], v11 offset:20480
v_mfma_f32_16x16x32_bf16 v[224:227], v[84:87], a[36:39], v[224:227]
s_add_u32 s95, s95, s42
ds_read_b128 a[40:43], v26 offset:0
v_mfma_f32_16x16x32_bf16 v[228:231], v[80:83], a[96:99], v[228:231]
ds_read_b64_tr_b16 v[46:47], v11 offset:20992
v_mfma_f32_16x16x32_bf16 v[228:231], v[84:87], a[100:103], v[228:231]
ds_read_b128 a[104:107], v26 offset:2048
v_mfma_f32_16x16x32_bf16 v[232:235], v[80:83], a[160:163], v[232:235]
ds_read_b64_tr_b16 v[48:49], v12 offset:16384
v_mfma_f32_16x16x32_bf16 v[232:235], v[84:87], a[164:167], v[232:235]
ds_read_b128 a[168:171], v26 offset:4096
v_mfma_f32_16x16x32_bf16 v[236:239], v[80:83], a[224:227], v[236:239]
ds_read_b64_tr_b16 v[50:51], v12 offset:16896
v_mfma_f32_16x16x32_bf16 v[236:239], v[84:87], a[228:231], v[236:239]
ds_read_b128 a[232:235], v26 offset:6144
v_mfma_f32_16x16x32_bf16 v[240:243], v[88:91], a[32:35], v[240:243]
ds_read_b64_tr_b16 v[52:53], v12 offset:20480
v_mfma_f32_16x16x32_bf16 v[240:243], v[92:95], a[36:39], v[240:243]
ds_read_b128 a[44:47], v27 offset:0
v_mfma_f32_16x16x32_bf16 v[244:247], v[88:91], a[96:99], v[244:247]
ds_read_b64_tr_b16 v[54:55], v12 offset:20992
v_mfma_f32_16x16x32_bf16 v[244:247], v[92:95], a[100:103], v[244:247]
ds_read_b128 a[108:111], v27 offset:2048
v_mfma_f32_16x16x32_bf16 v[248:251], v[88:91], a[160:163], v[248:251]
ds_read_b64_tr_b16 v[56:57], v13 offset:16384
v_mfma_f32_16x16x32_bf16 v[248:251], v[92:95], a[164:167], v[248:251]
ds_read_b128 a[172:175], v27 offset:4096
ds_read_b128 a[236:239], v27 offset:6144
v_mfma_f32_16x16x32_bf16 v[252:255], v[88:91], a[224:227], v[252:255]
ds_read_b64_tr_b16 v[58:59], v13 offset:16896
v_mfma_f32_16x16x32_bf16 v[252:255], v[92:95], a[228:231], v[252:255]
s_waitcnt lgkmcnt(1)
v_mfma_f32_16x16x32_bf16 v[128:131], v[32:35], a[40:43], v[128:131]
ds_read_b64_tr_b16 v[60:61], v13 offset:20480
v_mfma_f32_16x16x32_bf16 v[128:131], v[36:39], a[44:47], v[128:131]
v_mfma_f32_16x16x32_bf16 v[132:135], v[32:35], a[104:107], v[132:135]
ds_read_b64_tr_b16 v[62:63], v13 offset:20992
v_mfma_f32_16x16x32_bf16 v[132:135], v[36:39], a[108:111], v[132:135]
v_mfma_f32_16x16x32_bf16 v[136:139], v[32:35], a[168:171], v[136:139]
ds_read_b64_tr_b16 v[64:65], v10 offset:24576
v_mfma_f32_16x16x32_bf16 v[136:139], v[36:39], a[172:175], v[136:139]
v_mfma_f32_16x16x32_bf16 v[140:143], v[32:35], a[232:235], v[140:143]
ds_read_b64_tr_b16 v[66:67], v10 offset:25088
v_mfma_f32_16x16x32_bf16 v[140:143], v[36:39], a[236:239], v[140:143]
v_mfma_f32_16x16x32_bf16 v[144:147], v[40:43], a[40:43], v[144:147]
ds_read_b64_tr_b16 v[68:69], v10 offset:28672
v_mfma_f32_16x16x32_bf16 v[144:147], v[44:47], a[44:47], v[144:147]
v_mfma_f32_16x16x32_bf16 v[148:151], v[40:43], a[104:107], v[148:151]
ds_read_b64_tr_b16 v[70:71], v10 offset:29184
v_mfma_f32_16x16x32_bf16 v[148:151], v[44:47], a[108:111], v[148:151]
v_mfma_f32_16x16x32_bf16 v[152:155], v[40:43], a[168:171], v[152:155]
ds_read_b64_tr_b16 v[72:73], v11 offset:24576
v_mfma_f32_16x16x32_bf16 v[152:155], v[44:47], a[172:175], v[152:155]
v_mfma_f32_16x16x32_bf16 v[156:159], v[40:43], a[232:235], v[156:159]
ds_read_b64_tr_b16 v[74:75], v11 offset:25088
v_mfma_f32_16x16x32_bf16 v[156:159], v[44:47], a[236:239], v[156:159]
s_waitcnt lgkmcnt(6)
v_mfma_f32_16x16x32_bf16 v[160:163], v[48:51], a[40:43], v[160:163]
ds_read_b64_tr_b16 v[76:77], v11 offset:28672
v_mfma_f32_16x16x32_bf16 v[160:163], v[52:55], a[44:47], v[160:163]
v_mfma_f32_16x16x32_bf16 v[164:167], v[48:51], a[104:107], v[164:167]
ds_read_b64_tr_b16 v[78:79], v11 offset:29184
v_mfma_f32_16x16x32_bf16 v[164:167], v[52:55], a[108:111], v[164:167]
v_mfma_f32_16x16x32_bf16 v[168:171], v[48:51], a[168:171], v[168:171]
ds_read_b64_tr_b16 v[80:81], v12 offset:24576
v_mfma_f32_16x16x32_bf16 v[168:171], v[52:55], a[172:175], v[168:171]
v_mfma_f32_16x16x32_bf16 v[172:175], v[48:51], a[232:235], v[172:175]
ds_read_b64_tr_b16 v[82:83], v12 offset:25088
v_mfma_f32_16x16x32_bf16 v[172:175], v[52:55], a[236:239], v[172:175]
v_mfma_f32_16x16x32_bf16 v[176:179], v[56:59], a[40:43], v[176:179]
ds_read_b64_tr_b16 v[84:85], v12 offset:28672
v_mfma_f32_16x16x32_bf16 v[176:179], v[60:63], a[44:47], v[176:179]
v_mfma_f32_16x16x32_bf16 v[180:183], v[56:59], a[104:107], v[180:183]
ds_read_b64_tr_b16 v[86:87], v12 offset:29184
v_mfma_f32_16x16x32_bf16 v[180:183], v[60:63], a[108:111], v[180:183]
v_mfma_f32_16x16x32_bf16 v[184:187], v[56:59], a[168:171], v[184:187]
ds_read_b64_tr_b16 v[88:89], v13 offset:24576
v_mfma_f32_16x16x32_bf16 v[184:187], v[60:63], a[172:175], v[184:187]
v_mfma_f32_16x16x32_bf16 v[188:191], v[56:59], a[232:235], v[188:191]
ds_read_b64_tr_b16 v[90:91], v13 offset:25088
v_mfma_f32_16x16x32_bf16 v[188:191], v[60:63], a[236:239], v[188:191]
s_waitcnt lgkmcnt(6)
v_mfma_f32_16x16x32_bf16 v[192:195], v[64:67], a[40:43], v[192:195]
ds_read_b64_tr_b16 v[92:93], v13 offset:28672
v_mfma_f32_16x16x32_bf16 v[192:195], v[68:71], a[44:47], v[192:195]
v_mfma_f32_16x16x32_bf16 v[196:199], v[64:67], a[104:107], v[196:199]
ds_read_b64_tr_b16 v[94:95], v13 offset:29184
v_mfma_f32_16x16x32_bf16 v[196:199], v[68:71], a[108:111], v[196:199]
s_waitcnt vmcnt(12)
s_barrier
v_mfma_f32_16x16x32_bf16 v[200:203], v[64:67], a[168:171], v[200:203]
ds_read_b64_tr_b16 v[32:33], v10 offset:32768
v_mfma_f32_16x16x32_bf16 v[200:203], v[68:71], a[172:175], v[200:203]
s_add_u32 m0, s56, 65536
v_mfma_f32_16x16x32_bf16 v[204:207], v[64:67], a[232:235], v[204:207]
ds_read_b64_tr_b16 v[34:35], v10 offset:33280
v_mfma_f32_16x16x32_bf16 v[204:207], v[68:71], a[236:239], v[204:207]
buffer_load_dwordx4 v2, s[32:35], s45 offen offset:0 lds
v_mfma_f32_16x16x32_bf16 v[208:211], v[72:75], a[40:43], v[208:211]
ds_read_b64_tr_b16 v[36:37], v10 offset:36864
v_mfma_f32_16x16x32_bf16 v[208:211], v[76:79], a[44:47], v[208:211]
buffer_load_dwordx4 v3, s[32:35], s45 offen offset:1024 lds
v_mfma_f32_16x16x32_bf16 v[212:215], v[72:75], a[104:107], v[212:215]
ds_read_b64_tr_b16 v[38:39], v10 offset:37376
v_mfma_f32_16x16x32_bf16 v[212:215], v[76:79], a[108:111], v[212:215]
buffer_load_dwordx4 v4, s[32:35], s45 offen offset:2048 lds
v_mfma_f32_16x16x32_bf16 v[216:219], v[72:75], a[168:171], v[216:219]
ds_read_b64_tr_b16 v[40:41], v11 offset:32768
v_mfma_f32_16x16x32_bf16 v[216:219], v[76:79], a[172:175], v[216:219]
buffer_load_dwordx4 v5, s[32:35], s45 offen offset:3072 lds
s_add_u32 s45, s45, s46
v_mfma_f32_16x16x32_bf16 v[220:223], v[72:75], a[232:235], v[220:223]
ds_read_b64_tr_b16 v[42:43], v11 offset:33280
v_mfma_f32_16x16x32_bf16 v[220:223], v[76:79], a[236:239], v[220:223]
s_waitcnt lgkmcnt(6)
v_mfma_f32_16x16x32_bf16 v[224:227], v[80:83], a[40:43], v[224:227]
ds_read_b64_tr_b16 v[44:45], v11 offset:36864
v_mfma_f32_16x16x32_bf16 v[224:227], v[84:87], a[44:47], v[224:227]
ds_read_b128 a[48:51], v14 offset:0
v_mfma_f32_16x16x32_bf16 v[228:231], v[80:83], a[104:107], v[228:231]
ds_read_b64_tr_b16 v[46:47], v11 offset:37376
v_mfma_f32_16x16x32_bf16 v[228:231], v[84:87], a[108:111], v[228:231]
ds_read_b128 a[112:115], v14 offset:2048
v_mfma_f32_16x16x32_bf16 v[232:235], v[80:83], a[168:171], v[232:235]
ds_read_b64_tr_b16 v[48:49], v12 offset:32768
v_mfma_f32_16x16x32_bf16 v[232:235], v[84:87], a[172:175], v[232:235]
ds_read_b128 a[176:179], v14 offset:4096
v_mfma_f32_16x16x32_bf16 v[236:239], v[80:83], a[232:235], v[236:239]
ds_read_b64_tr_b16 v[50:51], v12 offset:33280
v_mfma_f32_16x16x32_bf16 v[236:239], v[84:87], a[236:239], v[236:239]
ds_read_b128 a[240:243], v14 offset:6144
v_mfma_f32_16x16x32_bf16 v[240:243], v[88:91], a[40:43], v[240:243]
ds_read_b64_tr_b16 v[52:53], v12 offset:36864
v_mfma_f32_16x16x32_bf16 v[240:243], v[92:95], a[44:47], v[240:243]
ds_read_b128 a[52:55], v15 offset:0
v_mfma_f32_16x16x32_bf16 v[244:247], v[88:91], a[104:107], v[244:247]
ds_read_b64_tr_b16 v[54:55], v12 offset:37376
v_mfma_f32_16x16x32_bf16 v[244:247], v[92:95], a[108:111], v[244:247]
ds_read_b128 a[116:119], v15 offset:2048
v_mfma_f32_16x16x32_bf16 v[248:251], v[88:91], a[168:171], v[248:251]
ds_read_b64_tr_b16 v[56:57], v13 offset:32768
v_mfma_f32_16x16x32_bf16 v[248:251], v[92:95], a[172:175], v[248:251]
ds_read_b128 a[180:183], v15 offset:4096
ds_read_b128 a[244:247], v15 offset:6144
v_mfma_f32_16x16x32_bf16 v[252:255], v[88:91], a[232:235], v[252:255]
ds_read_b64_tr_b16 v[58:59], v13 offset:33280
v_mfma_f32_16x16x32_bf16 v[252:255], v[92:95], a[236:239], v[252:255]
s_waitcnt lgkmcnt(1)
v_mfma_f32_16x16x32_bf16 v[128:131], v[32:35], a[48:51], v[128:131]
ds_read_b64_tr_b16 v[60:61], v13 offset:36864
v_mfma_f32_16x16x32_bf16 v[128:131], v[36:39], a[52:55], v[128:131]
s_add_u32 m0, s56, 81920
v_mfma_f32_16x16x32_bf16 v[132:135], v[32:35], a[112:115], v[132:135]
ds_read_b64_tr_b16 v[62:63], v13 offset:37376
v_mfma_f32_16x16x32_bf16 v[132:135], v[36:39], a[116:119], v[132:135]
buffer_load_dwordx4 v2, s[32:35], s45 offen offset:0 lds
v_mfma_f32_16x16x32_bf16 v[136:139], v[32:35], a[176:179], v[136:139]
ds_read_b64_tr_b16 v[64:65], v10 offset:40960
v_mfma_f32_16x16x32_bf16 v[136:139], v[36:39], a[180:183], v[136:139]
buffer_load_dwordx4 v3, s[32:35], s45 offen offset:1024 lds
v_mfma_f32_16x16x32_bf16 v[140:143], v[32:35], a[240:243], v[140:143]
ds_read_b64_tr_b16 v[66:67], v10 offset:41472
v_mfma_f32_16x16x32_bf16 v[140:143], v[36:39], a[244:247], v[140:143]
buffer_load_dwordx4 v4, s[32:35], s45 offen offset:2048 lds
v_mfma_f32_16x16x32_bf16 v[144:147], v[40:43], a[48:51], v[144:147]
ds_read_b64_tr_b16 v[68:69], v10 offset:45056
v_mfma_f32_16x16x32_bf16 v[144:147], v[44:47], a[52:55], v[144:147]
buffer_load_dwordx4 v5, s[32:35], s45 offen offset:3072 lds
v_mfma_f32_16x16x32_bf16 v[148:151], v[40:43], a[112:115], v[148:151]
ds_read_b64_tr_b16 v[70:71], v10 offset:45568
v_mfma_f32_16x16x32_bf16 v[148:151], v[44:47], a[116:119], v[148:151]
s_add_u32 s45, s45, s46
v_mfma_f32_16x16x32_bf16 v[152:155], v[40:43], a[176:179], v[152:155]
ds_read_b64_tr_b16 v[72:73], v11 offset:40960
v_mfma_f32_16x16x32_bf16 v[152:155], v[44:47], a[180:183], v[152:155]
v_mfma_f32_16x16x32_bf16 v[156:159], v[40:43], a[240:243], v[156:159]
ds_read_b64_tr_b16 v[74:75], v11 offset:41472
v_mfma_f32_16x16x32_bf16 v[156:159], v[44:47], a[244:247], v[156:159]
s_waitcnt lgkmcnt(6)
v_mfma_f32_16x16x32_bf16 v[160:163], v[48:51], a[48:51], v[160:163]
ds_read_b64_tr_b16 v[76:77], v11 offset:45056
v_mfma_f32_16x16x32_bf16 v[160:163], v[52:55], a[52:55], v[160:163]
v_mfma_f32_16x16x32_bf16 v[164:167], v[48:51], a[112:115], v[164:167]
ds_read_b64_tr_b16 v[78:79], v11 offset:45568
v_mfma_f32_16x16x32_bf16 v[164:167], v[52:55], a[116:119], v[164:167]
s_add_u32 m0, s56, 0
v_mfma_f32_16x16x32_bf16 v[168:171], v[48:51], a[176:179], v[168:171]
ds_read_b64_tr_b16 v[80:81], v12 offset:40960
v_mfma_f32_16x16x32_bf16 v[168:171], v[52:55], a[180:183], v[168:171]
buffer_load_dwordx4 v2, s[32:35], s45 offen offset:0 lds
v_mfma_f32_16x16x32_bf16 v[172:175], v[48:51], a[240:243], v[172:175]
ds_read_b64_tr_b16 v[82:83], v12 offset:41472
v_mfma_f32_16x16x32_bf16 v[172:175], v[52:55], a[244:247], v[172:175]
buffer_load_dwordx4 v3, s[32:35], s45 offen offset:1024 lds
v_mfma_f32_16x16x32_bf16 v[176:179], v[56:59], a[48:51], v[176:179]
ds_read_b64_tr_b16 v[84:85], v12 offset:45056
v_mfma_f32_16x16x32_bf16 v[176:179], v[60:63], a[52:55], v[176:179]
buffer_load_dwordx4 v4, s[32:35], s45 offen offset:2048 lds
v_mfma_f32_16x16x32_bf16 v[180:183], v[56:59], a[112:115], v[180:183]
ds_read_b64_tr_b16 v[86:87], v12 offset:45568
v_mfma_f32_16x16x32_bf16 v[180:183], v[60:63], a[116:119], v[180:183]
buffer_load_dwordx4 v5, s[32:35], s45 offen offset:3072 lds
v_mfma_f32_16x16x32_bf16 v[184:187], v[56:59], a[176:179], v[184:187]
ds_read_b64_tr_b16 v[88:89], v13 offset:40960
v_mfma_f32_16x16x32_bf16 v[184:187], v[60:63], a[180:183], v[184:187]
s_add_u32 s45, s45, s46
v_mfma_f32_16x16x32_bf16 v[188:191], v[56:59], a[240:243], v[188:191]
ds_read_b64_tr_b16 v[90:91], v13 offset:41472
v_mfma_f32_16x16x32_bf16 v[188:191], v[60:63], a[244:247], v[188:191]
s_waitcnt lgkmcnt(6)
v_mfma_f32_16x16x32_bf16 v[192:195], v[64:67], a[48:51], v[192:195]
ds_read_b64_tr_b16 v[92:93], v13 offset:45056
v_mfma_f32_16x16x32_bf16 v[192:195], v[68:71], a[52:55], v[192:195]
v_mfma_f32_16x16x32_bf16 v[196:199], v[64:67], a[112:115], v[196:199]
ds_read_b64_tr_b16 v[94:95], v13 offset:45568
v_mfma_f32_16x16x32_bf16 v[196:199], v[68:71], a[116:119], v[196:199]
s_waitcnt vmcnt(12)
s_barrier
v_mfma_f32_16x16x32_bf16 v[200:203], v[64:67], a[176:179], v[200:203]
ds_read_b64_tr_b16 v[32:33], v10 offset:49152
v_mfma_f32_16x16x32_bf16 v[200:203], v[68:71], a[180:183], v[200:203]
s_add_u32 m0, s56, 16384
v_mfma_f32_16x16x32_bf16 v[204:207], v[64:67], a[240:243], v[204:207]
ds_read_b64_tr_b16 v[34:35], v10 offset:49664
v_mfma_f32_16x16x32_bf16 v[204:207], v[68:71], a[244:247], v[204:207]
buffer_load_dwordx4 v2, s[32:35], s45 offen offset:0 lds
v_mfma_f32_16x16x32_bf16 v[208:211], v[72:75], a[48:51], v[208:211]
ds_read_b64_tr_b16 v[36:37], v10 offset:53248
v_mfma_f32_16x16x32_bf16 v[208:211], v[76:79], a[52:55], v[208:211]
buffer_load_dwordx4 v3, s[32:35], s45 offen offset:1024 lds
v_mfma_f32_16x16x32_bf16 v[212:215], v[72:75], a[112:115], v[212:215]
ds_read_b64_tr_b16 v[38:39], v10 offset:53760
v_mfma_f32_16x16x32_bf16 v[212:215], v[76:79], a[116:119], v[212:215]
buffer_load_dwordx4 v4, s[32:35], s45 offen offset:2048 lds
v_mfma_f32_16x16x32_bf16 v[216:219], v[72:75], a[176:179], v[216:219]
ds_read_b64_tr_b16 v[40:41], v11 offset:49152
v_mfma_f32_16x16x32_bf16 v[216:219], v[76:79], a[180:183], v[216:219]
buffer_load_dwordx4 v5, s[32:35], s45 offen offset:3072 lds
v_mfma_f32_16x16x32_bf16 v[220:223], v[72:75], a[240:243], v[220:223]
ds_read_b64_tr_b16 v[42:43], v11 offset:49664
v_mfma_f32_16x16x32_bf16 v[220:223], v[76:79], a[244:247], v[220:223]
s_waitcnt lgkmcnt(6)
v_mfma_f32_16x16x32_bf16 v[224:227], v[80:83], a[48:51], v[224:227]
ds_read_b64_tr_b16 v[44:45], v11 offset:53248
v_mfma_f32_16x16x32_bf16 v[224:227], v[84:87], a[52:55], v[224:227]
ds_read_b128 a[56:59], v14 offset:8192
v_mfma_f32_16x16x32_bf16 v[228:231], v[80:83], a[112:115], v[228:231]
ds_read_b64_tr_b16 v[46:47], v11 offset:53760
v_mfma_f32_16x16x32_bf16 v[228:231], v[84:87], a[116:119], v[228:231]
ds_read_b128 a[120:123], v14 offset:10240
v_mfma_f32_16x16x32_bf16 v[232:235], v[80:83], a[176:179], v[232:235]
ds_read_b64_tr_b16 v[48:49], v12 offset:49152
v_mfma_f32_16x16x32_bf16 v[232:235], v[84:87], a[180:183], v[232:235]
ds_read_b128 a[184:187], v14 offset:12288
v_mfma_f32_16x16x32_bf16 v[236:239], v[80:83], a[240:243], v[236:239]
ds_read_b64_tr_b16 v[50:51], v12 offset:49664
v_mfma_f32_16x16x32_bf16 v[236:239], v[84:87], a[244:247], v[236:239]
ds_read_b128 a[248:251], v14 offset:14336
v_mfma_f32_16x16x32_bf16 v[240:243], v[88:91], a[48:51], v[240:243]
ds_read_b64_tr_b16 v[52:53], v12 offset:53248
v_mfma_f32_16x16x32_bf16 v[240:243], v[92:95], a[52:55], v[240:243]
ds_read_b128 a[60:63], v15 offset:8192
v_mfma_f32_16x16x32_bf16 v[244:247], v[88:91], a[112:115], v[244:247]
ds_read_b64_tr_b16 v[54:55], v12 offset:53760
v_mfma_f32_16x16x32_bf16 v[244:247], v[92:95], a[116:119], v[244:247]
ds_read_b128 a[124:127], v15 offset:10240
v_mfma_f32_16x16x32_bf16 v[248:251], v[88:91], a[176:179], v[248:251]
ds_read_b64_tr_b16 v[56:57], v13 offset:49152
v_mfma_f32_16x16x32_bf16 v[248:251], v[92:95], a[180:183], v[248:251]
ds_read_b128 a[188:191], v15 offset:12288
ds_read_b128 a[252:255], v15 offset:14336
v_mfma_f32_16x16x32_bf16 v[252:255], v[88:91], a[240:243], v[252:255]
ds_read_b64_tr_b16 v[58:59], v13 offset:49664
v_mfma_f32_16x16x32_bf16 v[252:255], v[92:95], a[244:247], v[252:255]
s_waitcnt lgkmcnt(1)
v_mfma_f32_16x16x32_bf16 v[128:131], v[32:35], a[56:59], v[128:131]
ds_read_b64_tr_b16 v[60:61], v13 offset:53248
v_mfma_f32_16x16x32_bf16 v[128:131], v[36:39], a[60:63], v[128:131]
s_add_u32 s60, s62, 3
s_and_b32 s60, s60, 63
v_mfma_f32_16x16x32_bf16 v[132:135], v[32:35], a[120:123], v[132:135]
ds_read_b64_tr_b16 v[62:63], v13 offset:53760
v_mfma_f32_16x16x32_bf16 v[132:135], v[36:39], a[124:127], v[132:135]
s_lshl_b32 s60, s60, 7
s_mul_i32 s45, s40, s44
v_mfma_f32_16x16x32_bf16 v[136:139], v[32:35], a[184:187], v[136:139]
ds_read_b64_tr_b16 v[64:65], v10 offset:57344
v_mfma_f32_16x16x32_bf16 v[136:139], v[36:39], a[188:191], v[136:139]
s_lshl_b32 s45, s45, 5
s_add_u32 s45, s45, s60
v_mfma_f32_16x16x32_bf16 v[140:143], v[32:35], a[248:251], v[140:143]
ds_read_b64_tr_b16 v[66:67], v10 offset:57856
v_mfma_f32_16x16x32_bf16 v[140:143], v[36:39], a[252:255], v[140:143]
v_mfma_f32_16x16x32_bf16 v[144:147], v[40:43], a[56:59], v[144:147]
ds_read_b64_tr_b16 v[68:69], v10 offset:61440
v_mfma_f32_16x16x32_bf16 v[144:147], v[44:47], a[60:63], v[144:147]
v_mfma_f32_16x16x32_bf16 v[148:151], v[40:43], a[120:123], v[148:151]
ds_read_b64_tr_b16 v[70:71], v10 offset:61952
v_mfma_f32_16x16x32_bf16 v[148:151], v[44:47], a[124:127], v[148:151]
s_mov_b32 s52, s50
s_mov_b32 s58, s51
v_mfma_f32_16x16x32_bf16 v[152:155], v[40:43], a[184:187], v[152:155]
ds_read_b64_tr_b16 v[72:73], v11 offset:57344
v_mfma_f32_16x16x32_bf16 v[152:155], v[44:47], a[188:191], v[152:155]
v_mfma_f32_16x16x32_bf16 v[156:159], v[40:43], a[248:251], v[156:159]
ds_read_b64_tr_b16 v[74:75], v11 offset:57856
v_mfma_f32_16x16x32_bf16 v[156:159], v[44:47], a[252:255], v[156:159]
s_waitcnt lgkmcnt(6)
v_mfma_f32_16x16x32_bf16 v[160:163], v[48:51], a[56:59], v[160:163]
ds_read_b64_tr_b16 v[76:77], v11 offset:61440
v_mfma_f32_16x16x32_bf16 v[160:163], v[52:55], a[60:63], v[160:163]
s_add_u32 s41, s41, 1
s_sub_u32 s43, s43, 1
s_lshr_b32 s60, s41, 1
v_mfma_f32_16x16x32_bf16 v[164:167], v[48:51], a[120:123], v[164:167]
ds_read_b64_tr_b16 v[78:79], v11 offset:61952
v_mfma_f32_16x16x32_bf16 v[164:167], v[52:55], a[124:127], v[164:167]
s_lshl_b32 s60, s60, 19
s_and_b32 s61, s41, 1
s_lshl_b32 s61, s61, 12
v_mfma_f32_16x16x32_bf16 v[168:171], v[48:51], a[184:187], v[168:171]
ds_read_b64_tr_b16 v[80:81], v12 offset:57344
v_mfma_f32_16x16x32_bf16 v[168:171], v[52:55], a[188:191], v[168:171]
s_add_u32 s60, s60, s61
s_lshl_b32 s61, s54, 13
s_add_u32 s50, s60, s61
v_mfma_f32_16x16x32_bf16 v[172:175], v[48:51], a[248:251], v[172:175]
ds_read_b64_tr_b16 v[82:83], v12 offset:57856
v_mfma_f32_16x16x32_bf16 v[172:175], v[52:55], a[252:255], v[172:175]
s_add_u32 s51, s50, 8192
s_cmp_ge_u32 s41, 64
s_cselect_b32 s53, 1, 0
s_sub_u32 s60, s41, 128
v_mfma_f32_16x16x32_bf16 v[176:179], v[56:59], a[56:59], v[176:179]
ds_read_b64_tr_b16 v[84:85], v12 offset:61440
v_mfma_f32_16x16x32_bf16 v[176:179], v[60:63], a[60:63], v[176:179]
s_cmp_lt_u32 s60, 16
s_cselect_b32 s53, 0, s53
v_mfma_f32_16x16x32_bf16 v[180:183], v[56:59], a[120:123], v[180:183]
ds_read_b64_tr_b16 v[86:87], v12 offset:61952
v_mfma_f32_16x16x32_bf16 v[180:183], v[60:63], a[124:127], v[180:183]
v_mfma_f32_16x16x32_bf16 v[184:187], v[56:59], a[184:187], v[184:187]
ds_read_b64_tr_b16 v[88:89], v13 offset:57344
v_mfma_f32_16x16x32_bf16 v[184:187], v[60:63], a[188:191], v[184:187]
v_mfma_f32_16x16x32_bf16 v[188:191], v[56:59], a[248:251], v[188:191]
ds_read_b64_tr_b16 v[90:91], v13 offset:57856
v_mfma_f32_16x16x32_bf16 v[188:191], v[60:63], a[252:255], v[188:191]
s_waitcnt lgkmcnt(6)
v_mfma_f32_16x16x32_bf16 v[192:195], v[64:67], a[56:59], v[192:195]
ds_read_b64_tr_b16 v[92:93], v13 offset:61440
v_mfma_f32_16x16x32_bf16 v[192:195], v[68:71], a[60:63], v[192:195]
v_mfma_f32_16x16x32_bf16 v[196:199], v[64:67], a[120:123], v[196:199]
ds_read_b64_tr_b16 v[94:95], v13 offset:61952
v_mfma_f32_16x16x32_bf16 v[196:199], v[68:71], a[124:127], v[196:199]
s_waitcnt vmcnt(12)
s_barrier
v_mfma_f32_16x16x32_bf16 v[200:203], v[64:67], a[184:187], v[200:203]
ds_read_b64_tr_b16 v[32:33], v18 offset:0
v_mfma_f32_16x16x32_bf16 v[200:203], v[68:71], a[188:191], v[200:203]
v_mul_f32 v128, s49, v128
v_mul_f32 v129, s49, v129
v_mul_f32 v130, s49, v130
v_mul_f32 v131, s49, v131
v_mul_f32 v144, s49, v144
v_mul_f32 v145, s49, v145
v_mfma_f32_16x16x32_bf16 v[204:207], v[64:67], a[248:251], v[204:207]
ds_read_b64_tr_b16 v[34:35], v18 offset:512
v_mul_f32 v146, s49, v146
v_mul_f32 v147, s49, v147
v_cvt_pk_bf16_f32 v96, v128, v129
v_cvt_pk_bf16_f32 v97, v130, v131
v_cvt_pk_bf16_f32 v98, v144, v145
v_cvt_pk_bf16_f32 v99, v146, v147
v_mfma_f32_16x16x32_bf16 v[204:207], v[68:71], a[252:255], v[204:207]
buffer_store_dwordx4 v[96:99], v16, s[36:39], s47 offen offset:0 sc1
v_mfma_f32_16x16x32_bf16 v[208:211], v[72:75], a[56:59], v[208:211]
ds_read_b64_tr_b16 v[36:37], v18 offset:4096
v_mul_f32 v132, s49, v132
v_mul_f32 v133, s49, v133
v_mul_f32 v134, s49, v134
v_mul_f32 v135, s49, v135
v_mul_f32 v148, s49, v148
v_mul_f32 v149, s49, v149
v_mfma_f32_16x16x32_bf16 v[208:211], v[76:79], a[60:63], v[208:211]
v_mul_f32 v150, s49, v150
v_mul_f32 v151, s49, v151
v_cvt_pk_bf16_f32 v100, v132, v133
v_cvt_pk_bf16_f32 v101, v134, v135
v_cvt_pk_bf16_f32 v102, v148, v149
v_cvt_pk_bf16_f32 v103, v150, v151
v_mfma_f32_16x16x32_bf16 v[212:215], v[72:75], a[120:123], v[212:215]
ds_read_b64_tr_b16 v[38:39], v18 offset:4608
buffer_store_dwordx4 v[100:103], v16, s[36:39], s47 offen offset:1024 sc1
v_mfma_f32_16x16x32_bf16 v[212:215], v[76:79], a[124:127], v[212:215]
v_mul_f32 v160, s49, v160
v_mul_f32 v161, s49, v161
v_mul_f32 v162, s49, v162
v_mul_f32 v163, s49, v163
v_mul_f32 v176, s49, v176
v_mul_f32 v177, s49, v177
v_mfma_f32_16x16x32_bf16 v[216:219], v[72:75], a[184:187], v[216:219]
ds_read_b64_tr_b16 v[40:41], v18 offset:8192
v_mul_f32 v178, s49, v178
v_mul_f32 v179, s49, v179
v_cvt_pk_bf16_f32 v104, v160, v161
v_cvt_pk_bf16_f32 v105, v162, v163
v_cvt_pk_bf16_f32 v106, v176, v177
v_cvt_pk_bf16_f32 v107, v178, v179
v_mfma_f32_16x16x32_bf16 v[216:219], v[76:79], a[188:191], v[216:219]
buffer_store_dwordx4 v[104:107], v16, s[36:39], s47 offen offset:2048 sc1
v_mfma_f32_16x16x32_bf16 v[220:223], v[72:75], a[248:251], v[220:223]
ds_read_b64_tr_b16 v[42:43], v18 offset:8704
v_mul_f32 v164, s49, v164
v_mul_f32 v165, s49, v165
v_mul_f32 v166, s49, v166
v_mul_f32 v167, s49, v167
v_mul_f32 v180, s49, v180
v_mul_f32 v181, s49, v181
v_mfma_f32_16x16x32_bf16 v[220:223], v[76:79], a[252:255], v[220:223]
s_waitcnt lgkmcnt(6)
v_mul_f32 v182, s49, v182
v_mul_f32 v183, s49, v183
v_cvt_pk_bf16_f32 v108, v164, v165
v_cvt_pk_bf16_f32 v109, v166, v167
v_cvt_pk_bf16_f32 v110, v180, v181
v_cvt_pk_bf16_f32 v111, v182, v183
v_mfma_f32_16x16x32_bf16 v[224:227], v[80:83], a[56:59], v[224:227]
ds_read_b64_tr_b16 v[44:45], v18 offset:12288
buffer_store_dwordx4 v[108:111], v16, s[36:39], s47 offen offset:3072 sc1
v_mfma_f32_16x16x32_bf16 v[224:227], v[84:87], a[60:63], v[224:227]
v_mul_f32 v136, s49, v136
v_mul_f32 v137, s49, v137
v_mul_f32 v138, s49, v138
v_mul_f32 v139, s49, v139
v_mul_f32 v152, s49, v152
v_mul_f32 v153, s49, v153
v_mfma_f32_16x16x32_bf16 v[228:231], v[80:83], a[120:123], v[228:231]
ds_read_b64_tr_b16 v[46:47], v18 offset:12800
v_mul_f32 v154, s49, v154
v_mul_f32 v155, s49, v155
v_cvt_pk_bf16_f32 v96, v136, v137
v_cvt_pk_bf16_f32 v97, v138, v139
v_cvt_pk_bf16_f32 v98, v152, v153
v_cvt_pk_bf16_f32 v99, v154, v155
v_mfma_f32_16x16x32_bf16 v[228:231], v[84:87], a[124:127], v[228:231]
buffer_store_dwordx4 v[96:99], v16, s[36:39], s48 offen offset:0 sc1
v_mfma_f32_16x16x32_bf16 v[232:235], v[80:83], a[184:187], v[232:235]
ds_read_b64_tr_b16 v[48:49], v19 offset:0
v_mul_f32 v140, s49, v140
v_mul_f32 v141, s49, v141
v_mul_f32 v142, s49, v142
v_mul_f32 v143, s49, v143
v_mul_f32 v156, s49, v156
v_mul_f32 v157, s49, v157
v_mfma_f32_16x16x32_bf16 v[232:235], v[84:87], a[188:191], v[232:235]
v_mul_f32 v158, s49, v158
v_mul_f32 v159, s49, v159
v_cvt_pk_bf16_f32 v100, v140, v141
v_cvt_pk_bf16_f32 v101, v142, v143
v_cvt_pk_bf16_f32 v102, v156, v157
v_cvt_pk_bf16_f32 v103, v158, v159
v_mfma_f32_16x16x32_bf16 v[236:239], v[80:83], a[248:251], v[236:239]
ds_read_b64_tr_b16 v[50:51], v19 offset:512
buffer_store_dwordx4 v[100:103], v16, s[36:39], s48 offen offset:1024 sc1
v_mfma_f32_16x16x32_bf16 v[236:239], v[84:87], a[252:255], v[236:239]
v_mul_f32 v168, s49, v168
v_mul_f32 v169, s49, v169
v_mul_f32 v170, s49, v170
v_mul_f32 v171, s49, v171
v_mul_f32 v184, s49, v184
v_mul_f32 v185, s49, v185
v_mfma_f32_16x16x32_bf16 v[240:243], v[88:91], a[56:59], v[240:243]
ds_read_b64_tr_b16 v[52:53], v19 offset:4096
v_mul_f32 v186, s49, v186
v_mul_f32 v187, s49, v187
v_cvt_pk_bf16_f32 v104, v168, v169
v_cvt_pk_bf16_f32 v105, v170, v171
v_cvt_pk_bf16_f32 v106, v184, v185
v_cvt_pk_bf16_f32 v107, v186, v187
v_mfma_f32_16x16x32_bf16 v[240:243], v[92:95], a[60:63], v[240:243]
buffer_store_dwordx4 v[104:107], v16, s[36:39], s48 offen offset:2048 sc1
v_mfma_f32_16x16x32_bf16 v[244:247], v[88:91], a[120:123], v[244:247]
ds_read_b64_tr_b16 v[54:55], v19 offset:4608
v_mul_f32 v172, s49, v172
v_mul_f32 v173, s49, v173
v_mul_f32 v174, s49, v174
v_mul_f32 v175, s49, v175
v_mul_f32 v188, s49, v188
v_mul_f32 v189, s49, v189
v_mfma_f32_16x16x32_bf16 v[244:247], v[92:95], a[124:127], v[244:247]
v_mul_f32 v190, s49, v190
v_mul_f32 v191, s49, v191
v_cvt_pk_bf16_f32 v108, v172, v173
v_cvt_pk_bf16_f32 v109, v174, v175
v_cvt_pk_bf16_f32 v110, v188, v189
v_cvt_pk_bf16_f32 v111, v190, v191
v_mfma_f32_16x16x32_bf16 v[248:251], v[88:91], a[184:187], v[248:251]
ds_read_b64_tr_b16 v[56:57], v19 offset:8192
buffer_store_dwordx4 v[108:111], v16, s[36:39], s48 offen offset:3072 sc1
v_mfma_f32_16x16x32_bf16 v[248:251], v[92:95], a[188:191], v[248:251]
v_mfma_f32_16x16x32_bf16 v[252:255], v[88:91], a[248:251], v[252:255]
ds_read_b64_tr_b16 v[58:59], v19 offset:8704
v_mfma_f32_16x16x32_bf16 v[252:255], v[92:95], a[252:255], v[252:255]
s_mov_b32 s47, s52
s_mov_b32 s48, s58
s_branch K1_P0
.p2align 6
K1_D01:
s_waitcnt lgkmcnt(6)
v_mfma_f32_16x16x32_bf16 v[128:131], v[32:35], a[0:3], 0
ds_read_b64_tr_b16 v[60:61], v13 offset:4096
v_mfma_f32_16x16x32_bf16 v[128:131], v[36:39], a[4:7], v[128:131]
s_add_u32 m0, s57, 0
s_add_u32 s59, s55, 384
v_mfma_f32_16x16x32_bf16 v[132:135], v[32:35], a[64:67], 0
ds_read_b64_tr_b16 v[62:63], v13 offset:4608
v_mfma_f32_16x16x32_bf16 v[132:135], v[36:39], a[68:71], v[132:135]
buffer_load_dwordx4 v6, s[28:31], s59 offen offset:0 lds
v_mfma_f32_16x16x32_bf16 v[136:139], v[32:35], a[128:131], 0
ds_read_b64_tr_b16 v[64:65], v10 offset:8192
v_mfma_f32_16x16x32_bf16 v[136:139], v[36:39], a[132:135], v[136:139]
buffer_load_dwordx4 v7, s[28:31], s59 offen offset:1024 lds
v_mfma_f32_16x16x32_bf16 v[140:143], v[32:35], a[192:195], 0
ds_read_b64_tr_b16 v[66:67], v10 offset:8704
v_mfma_f32_16x16x32_bf16 v[140:143], v[36:39], a[196:199], v[140:143]
buffer_load_dwordx4 v8, s[28:31], s59 offen offset:2048 lds
v_mfma_f32_16x16x32_bf16 v[144:147], v[40:43], a[0:3], 0
ds_read_b64_tr_b16 v[68:69], v10 offset:12288
v_mfma_f32_16x16x32_bf16 v[144:147], v[44:47], a[4:7], v[144:147]
buffer_load_dwordx4 v9, s[28:31], s59 offen offset:3072 lds
v_mfma_f32_16x16x32_bf16 v[148:151], v[40:43], a[64:67], 0
ds_read_b64_tr_b16 v[70:71], v10 offset:12800
v_mfma_f32_16x16x32_bf16 v[148:151], v[44:47], a[68:71], v[148:151]
s_add_u32 m0, s57, 4096
s_add_u32 s59, s55, 33152
v_mfma_f32_16x16x32_bf16 v[152:155], v[40:43], a[128:131], 0
ds_read_b64_tr_b16 v[72:73], v11 offset:8192
v_mfma_f32_16x16x32_bf16 v[152:155], v[44:47], a[132:135], v[152:155]
buffer_load_dwordx4 v6, s[28:31], s59 offen offset:0 lds
v_mfma_f32_16x16x32_bf16 v[156:159], v[40:43], a[192:195], 0
ds_read_b64_tr_b16 v[74:75], v11 offset:8704
v_mfma_f32_16x16x32_bf16 v[156:159], v[44:47], a[196:199], v[156:159]
s_waitcnt lgkmcnt(6)
v_mfma_f32_16x16x32_bf16 v[160:163], v[48:51], a[0:3], 0
ds_read_b64_tr_b16 v[76:77], v11 offset:12288
v_mfma_f32_16x16x32_bf16 v[160:163], v[52:55], a[4:7], v[160:163]
buffer_load_dwordx4 v7, s[28:31], s59 offen offset:1024 lds
v_mfma_f32_16x16x32_bf16 v[164:167], v[48:51], a[64:67], 0
ds_read_b64_tr_b16 v[78:79], v11 offset:12800
v_mfma_f32_16x16x32_bf16 v[164:167], v[52:55], a[68:71], v[164:167]
buffer_load_dwordx4 v8, s[28:31], s59 offen offset:2048 lds
v_mfma_f32_16x16x32_bf16 v[168:171], v[48:51], a[128:131], 0
ds_read_b64_tr_b16 v[80:81], v12 offset:8192
v_mfma_f32_16x16x32_bf16 v[168:171], v[52:55], a[132:135], v[168:171]
buffer_load_dwordx4 v9, s[28:31], s59 offen offset:3072 lds
v_mfma_f32_16x16x32_bf16 v[172:175], v[48:51], a[192:195], 0
ds_read_b64_tr_b16 v[82:83], v12 offset:8704
v_mfma_f32_16x16x32_bf16 v[172:175], v[52:55], a[196:199], v[172:175]
s_add_u32 m0, s56, 32768
v_mfma_f32_16x16x32_bf16 v[176:179], v[56:59], a[0:3], 0
ds_read_b64_tr_b16 v[84:85], v12 offset:12288
v_mfma_f32_16x16x32_bf16 v[176:179], v[60:63], a[4:7], v[176:179]
buffer_load_dwordx4 v2, s[32:35], s95 offen offset:0 lds
v_mfma_f32_16x16x32_bf16 v[180:183], v[56:59], a[64:67], 0
ds_read_b64_tr_b16 v[86:87], v12 offset:12800
v_mfma_f32_16x16x32_bf16 v[180:183], v[60:63], a[68:71], v[180:183]
buffer_load_dwordx4 v3, s[32:35], s95 offen offset:1024 lds
v_mfma_f32_16x16x32_bf16 v[184:187], v[56:59], a[128:131], 0
ds_read_b64_tr_b16 v[88:89], v13 offset:8192
v_mfma_f32_16x16x32_bf16 v[184:187], v[60:63], a[132:135], v[184:187]
buffer_load_dwordx4 v4, s[32:35], s95 offen offset:2048 lds
v_mfma_f32_16x16x32_bf16 v[188:191], v[56:59], a[192:195], 0
ds_read_b64_tr_b16 v[90:91], v13 offset:8704
v_mfma_f32_16x16x32_bf16 v[188:191], v[60:63], a[196:199], v[188:191]
s_waitcnt lgkmcnt(6)
v_mfma_f32_16x16x32_bf16 v[192:195], a[0:3], v[64:67], 0
ds_read_b64_tr_b16 v[92:93], v13 offset:12288
v_mfma_f32_16x16x32_bf16 v[192:195], a[4:7], v[68:71], v[192:195]
buffer_load_dwordx4 v5, s[32:35], s95 offen offset:3072 lds
s_add_u32 s95, s95, s42
v_mfma_f32_16x16x32_bf16 v[196:199], a[64:67], v[64:67], 0
ds_read_b64_tr_b16 v[94:95], v13 offset:12800
v_mfma_f32_16x16x32_bf16 v[196:199], a[68:71], v[68:71], v[196:199]
s_waitcnt vmcnt(28)
s_barrier
v_mfma_f32_16x16x32_bf16 v[200:203], a[128:131], v[64:67], 0
ds_read_b64_tr_b16 v[32:33], v10 offset:16384
v_mfma_f32_16x16x32_bf16 v[200:203], a[132:135], v[68:71], v[200:203]
s_add_u32 m0, s56, 49152
v_mfma_f32_16x16x32_bf16 v[204:207], a[192:195], v[64:67], 0
ds_read_b64_tr_b16 v[34:35], v10 offset:16896
v_mfma_f32_16x16x32_bf16 v[204:207], a[196:199], v[68:71], v[204:207]
buffer_load_dwordx4 v2, s[32:35], s95 offen offset:0 lds
v_mfma_f32_16x16x32_bf16 v[208:211], a[0:3], v[72:75], 0
ds_read_b64_tr_b16 v[36:37], v10 offset:20480
v_mfma_f32_16x16x32_bf16 v[208:211], a[4:7], v[76:79], v[208:211]
buffer_load_dwordx4 v3, s[32:35], s95 offen offset:1024 lds
v_mfma_f32_16x16x32_bf16 v[212:215], a[64:67], v[72:75], 0
ds_read_b64_tr_b16 v[38:39], v10 offset:20992
v_mfma_f32_16x16x32_bf16 v[212:215], a[68:71], v[76:79], v[212:215]
buffer_load_dwordx4 v4, s[32:35], s95 offen offset:2048 lds
v_mfma_f32_16x16x32_bf16 v[216:219], a[128:131], v[72:75], 0
ds_read_b64_tr_b16 v[40:41], v11 offset:16384
v_mfma_f32_16x16x32_bf16 v[216:219], a[132:135], v[76:79], v[216:219]
buffer_load_dwordx4 v5, s[32:35], s95 offen offset:3072 lds
v_mfma_f32_16x16x32_bf16 v[220:223], a[192:195], v[72:75], 0
ds_read_b64_tr_b16 v[42:43], v11 offset:16896
v_mfma_f32_16x16x32_bf16 v[220:223], a[196:199], v[76:79], v[220:223]
s_waitcnt lgkmcnt(6)
v_mfma_f32_16x16x32_bf16 v[224:227], a[0:3], v[80:83], 0
ds_read_b64_tr_b16 v[44:45], v11 offset:20480
v_mfma_f32_16x16x32_bf16 v[224:227], a[4:7], v[84:87], v[224:227]
s_add_u32 s95, s95, s42
s_waitcnt vmcnt(24)
ds_read_b128 a[8:11], v14 offset:8192
v_mfma_f32_16x16x32_bf16 v[228:231], a[64:67], v[80:83], 0
ds_read_b64_tr_b16 v[46:47], v11 offset:20992
v_mfma_f32_16x16x32_bf16 v[228:231], a[68:71], v[84:87], v[228:231]
ds_read_b128 a[72:75], v14 offset:10240
v_mfma_f32_16x16x32_bf16 v[232:235], a[128:131], v[80:83], 0
ds_read_b64_tr_b16 v[48:49], v12 offset:16384
v_mfma_f32_16x16x32_bf16 v[232:235], a[132:135], v[84:87], v[232:235]
ds_read_b128 a[136:139], v14 offset:12288
v_mfma_f32_16x16x32_bf16 v[236:239], a[192:195], v[80:83], 0
ds_read_b64_tr_b16 v[50:51], v12 offset:16896
v_mfma_f32_16x16x32_bf16 v[236:239], a[196:199], v[84:87], v[236:239]
ds_read_b128 a[200:203], v14 offset:14336
v_mfma_f32_16x16x32_bf16 v[240:243], a[0:3], v[88:91], 0
ds_read_b64_tr_b16 v[52:53], v12 offset:20480
v_mfma_f32_16x16x32_bf16 v[240:243], a[4:7], v[92:95], v[240:243]
ds_read_b128 a[12:15], v15 offset:8192
v_mfma_f32_16x16x32_bf16 v[244:247], a[64:67], v[88:91], 0
ds_read_b64_tr_b16 v[54:55], v12 offset:20992
v_mfma_f32_16x16x32_bf16 v[244:247], a[68:71], v[92:95], v[244:247]
ds_read_b128 a[76:79], v15 offset:10240
v_mfma_f32_16x16x32_bf16 v[248:251], a[128:131], v[88:91], 0
ds_read_b64_tr_b16 v[56:57], v13 offset:16384
v_mfma_f32_16x16x32_bf16 v[248:251], a[132:135], v[92:95], v[248:251]
ds_read_b128 a[140:143], v15 offset:12288
ds_read_b128 a[204:207], v15 offset:14336
v_mfma_f32_16x16x32_bf16 v[252:255], a[192:195], v[88:91], 0
ds_read_b64_tr_b16 v[58:59], v13 offset:16896
v_mfma_f32_16x16x32_bf16 v[252:255], a[196:199], v[92:95], v[252:255]
s_waitcnt lgkmcnt(1)
v_mfma_f32_16x16x32_bf16 v[128:131], v[32:35], a[8:11], v[128:131]
ds_read_b64_tr_b16 v[60:61], v13 offset:20480
v_mfma_f32_16x16x32_bf16 v[128:131], v[36:39], a[12:15], v[128:131]
s_add_u32 m0, s57, 8192
s_add_u32 s59, s55, 512
v_mfma_f32_16x16x32_bf16 v[132:135], v[32:35], a[72:75], v[132:135]
ds_read_b64_tr_b16 v[62:63], v13 offset:20992
v_mfma_f32_16x16x32_bf16 v[132:135], v[36:39], a[76:79], v[132:135]
buffer_load_dwordx4 v6, s[28:31], s59 offen offset:0 lds
v_mfma_f32_16x16x32_bf16 v[136:139], v[32:35], a[136:139], v[136:139]
ds_read_b64_tr_b16 v[64:65], v10 offset:24576
v_mfma_f32_16x16x32_bf16 v[136:139], v[36:39], a[140:143], v[136:139]
buffer_load_dwordx4 v7, s[28:31], s59 offen offset:1024 lds
v_mfma_f32_16x16x32_bf16 v[140:143], v[32:35], a[200:203], v[140:143]
ds_read_b64_tr_b16 v[66:67], v10 offset:25088
v_mfma_f32_16x16x32_bf16 v[140:143], v[36:39], a[204:207], v[140:143]
buffer_load_dwordx4 v8, s[28:31], s59 offen offset:2048 lds
v_mfma_f32_16x16x32_bf16 v[144:147], v[40:43], a[8:11], v[144:147]
ds_read_b64_tr_b16 v[68:69], v10 offset:28672
v_mfma_f32_16x16x32_bf16 v[144:147], v[44:47], a[12:15], v[144:147]
buffer_load_dwordx4 v9, s[28:31], s59 offen offset:3072 lds
v_mfma_f32_16x16x32_bf16 v[148:151], v[40:43], a[72:75], v[148:151]
ds_read_b64_tr_b16 v[70:71], v10 offset:29184
v_mfma_f32_16x16x32_bf16 v[148:151], v[44:47], a[76:79], v[148:151]
s_add_u32 m0, s57, 12288
s_add_u32 s59, s55, 33280
v_mfma_f32_16x16x32_bf16 v[152:155], v[40:43], a[136:139], v[152:155]
ds_read_b64_tr_b16 v[72:73], v11 offset:24576
v_mfma_f32_16x16x32_bf16 v[152:155], v[44:47], a[140:143], v[152:155]
buffer_load_dwordx4 v6, s[28:31], s59 offen offset:0 lds
v_mfma_f32_16x16x32_bf16 v[156:159], v[40:43], a[200:203], v[156:159]
ds_read_b64_tr_b16 v[74:75], v11 offset:25088
v_mfma_f32_16x16x32_bf16 v[156:159], v[44:47], a[204:207], v[156:159]
s_waitcnt lgkmcnt(6)
v_mfma_f32_16x16x32_bf16 v[160:163], v[48:51], a[8:11], v[160:163]
ds_read_b64_tr_b16 v[76:77], v11 offset:28672
v_mfma_f32_16x16x32_bf16 v[160:163], v[52:55], a[12:15], v[160:163]
buffer_load_dwordx4 v7, s[28:31], s59 offen offset:1024 lds
v_mfma_f32_16x16x32_bf16 v[164:167], v[48:51], a[72:75], v[164:167]
ds_read_b64_tr_b16 v[78:79], v11 offset:29184
v_mfma_f32_16x16x32_bf16 v[164:167], v[52:55], a[76:79], v[164:167]
buffer_load_dwordx4 v8, s[28:31], s59 offen offset:2048 lds
v_mfma_f32_16x16x32_bf16 v[168:171], v[48:51], a[136:139], v[168:171]
ds_read_b64_tr_b16 v[80:81], v12 offset:24576
v_mfma_f32_16x16x32_bf16 v[168:171], v[52:55], a[140:143], v[168:171]
buffer_load_dwordx4 v9, s[28:31], s59 offen offset:3072 lds
v_mfma_f32_16x16x32_bf16 v[172:175], v[48:51], a[200:203], v[172:175]
ds_read_b64_tr_b16 v[82:83], v12 offset:25088
v_mfma_f32_16x16x32_bf16 v[172:175], v[52:55], a[204:207], v[172:175]
s_mov_b32 s47, s50
s_mov_b32 s48, s51
s_add_u32 s41, s41, 1
s_sub_u32 s43, s43, 1
v_mfma_f32_16x16x32_bf16 v[176:179], v[56:59], a[8:11], v[176:179]
ds_read_b64_tr_b16 v[84:85], v12 offset:28672
v_mfma_f32_16x16x32_bf16 v[176:179], v[60:63], a[12:15], v[176:179]
s_lshr_b32 s60, s41, 1
s_lshl_b32 s60, s60, 19
s_and_b32 s61, s41, 1
s_lshl_b32 s61, s61, 12
v_mfma_f32_16x16x32_bf16 v[180:183], v[56:59], a[72:75], v[180:183]
ds_read_b64_tr_b16 v[86:87], v12 offset:29184
v_mfma_f32_16x16x32_bf16 v[180:183], v[60:63], a[76:79], v[180:183]
s_add_u32 s60, s60, s61
s_lshl_b32 s61, s54, 13
s_add_u32 s50, s60, s61
s_add_u32 s51, s50, 8192
v_mfma_f32_16x16x32_bf16 v[184:187], v[56:59], a[136:139], v[184:187]
ds_read_b64_tr_b16 v[88:89], v13 offset:24576
v_mfma_f32_16x16x32_bf16 v[184:187], v[60:63], a[140:143], v[184:187]
s_cmp_ge_u32 s41, 64
s_cselect_b32 s53, 1, 0
s_sub_u32 s60, s41, 128
s_cmp_lt_u32 s60, 16
s_cselect_b32 s53, 0, s53
v_mfma_f32_16x16x32_bf16 v[188:191], v[56:59], a[200:203], v[188:191]
ds_read_b64_tr_b16 v[90:91], v13 offset:25088
v_mfma_f32_16x16x32_bf16 v[188:191], v[60:63], a[204:207], v[188:191]
s_waitcnt lgkmcnt(6)
v_mfma_f32_16x16x32_bf16 v[192:195], a[8:11], v[64:67], v[192:195]
ds_read_b64_tr_b16 v[92:93], v13 offset:28672
v_mfma_f32_16x16x32_bf16 v[192:195], a[12:15], v[68:71], v[192:195]
v_mfma_f32_16x16x32_bf16 v[196:199], a[72:75], v[64:67], v[196:199]
ds_read_b64_tr_b16 v[94:95], v13 offset:29184
v_mfma_f32_16x16x32_bf16 v[196:199], a[76:79], v[68:71], v[196:199]
s_waitcnt vmcnt(12)
s_barrier
v_mfma_f32_16x16x32_bf16 v[200:203], a[136:139], v[64:67], v[200:203]
ds_read_b64_tr_b16 v[32:33], v10 offset:32768
v_mfma_f32_16x16x32_bf16 v[200:203], a[140:143], v[68:71], v[200:203]
s_add_u32 m0, s56, 0
v_mfma_f32_16x16x32_bf16 v[204:207], a[200:203], v[64:67], v[204:207]
ds_read_b64_tr_b16 v[34:35], v10 offset:33280
v_mfma_f32_16x16x32_bf16 v[204:207], a[204:207], v[68:71], v[204:207]
buffer_load_dwordx4 v2, s[32:35], s95 offen offset:0 lds
v_mfma_f32_16x16x32_bf16 v[208:211], a[8:11], v[72:75], v[208:211]
ds_read_b64_tr_b16 v[36:37], v10 offset:36864
v_mfma_f32_16x16x32_bf16 v[208:211], a[12:15], v[76:79], v[208:211]
buffer_load_dwordx4 v3, s[32:35], s95 offen offset:1024 lds
v_mfma_f32_16x16x32_bf16 v[212:215], a[72:75], v[72:75], v[212:215]
ds_read_b64_tr_b16 v[38:39], v10 offset:37376
v_mfma_f32_16x16x32_bf16 v[212:215], a[76:79], v[76:79], v[212:215]
buffer_load_dwordx4 v4, s[32:35], s95 offen offset:2048 lds
v_mfma_f32_16x16x32_bf16 v[216:219], a[136:139], v[72:75], v[216:219]
ds_read_b64_tr_b16 v[40:41], v11 offset:32768
v_mfma_f32_16x16x32_bf16 v[216:219], a[140:143], v[76:79], v[216:219]
buffer_load_dwordx4 v5, s[32:35], s95 offen offset:3072 lds
v_mfma_f32_16x16x32_bf16 v[220:223], a[200:203], v[72:75], v[220:223]
ds_read_b64_tr_b16 v[42:43], v11 offset:33280
v_mfma_f32_16x16x32_bf16 v[220:223], a[204:207], v[76:79], v[220:223]
s_waitcnt lgkmcnt(6)
v_mfma_f32_16x16x32_bf16 v[224:227], a[8:11], v[80:83], v[224:227]
ds_read_b64_tr_b16 v[44:45], v11 offset:36864
v_mfma_f32_16x16x32_bf16 v[224:227], a[12:15], v[84:87], v[224:227]
s_add_u32 s95, s95, s42
ds_read_b128 a[16:19], v26 offset:0
v_mfma_f32_16x16x32_bf16 v[228:231], a[72:75], v[80:83], v[228:231]
ds_read_b64_tr_b16 v[46:47], v11 offset:37376
v_mfma_f32_16x16x32_bf16 v[228:231], a[76:79], v[84:87], v[228:231]
ds_read_b128 a[80:83], v26 offset:2048
v_mfma_f32_16x16x32_bf16 v[232:235], a[136:139], v[80:83], v[232:235]
ds_read_b64_tr_b16 v[48:49], v12 offset:32768
v_mfma_f32_16x16x32_bf16 v[232:235], a[140:143], v[84:87], v[232:235]
ds_read_b128 a[144:147], v26 offset:4096
v_mfma_f32_16x16x32_bf16 v[236:239], a[200:203], v[80:83], v[236:239]
ds_read_b64_tr_b16 v[50:51], v12 offset:33280
v_mfma_f32_16x16x32_bf16 v[236:239], a[204:207], v[84:87], v[236:239]
ds_read_b128 a[208:211], v26 offset:6144
v_mfma_f32_16x16x32_bf16 v[240:243], a[8:11], v[88:91], v[240:243]
ds_read_b64_tr_b16 v[52:53], v12 offset:36864
v_mfma_f32_16x16x32_bf16 v[240:243], a[12:15], v[92:95], v[240:243]
ds_read_b128 a[20:23], v27 offset:0
v_mfma_f32_16x16x32_bf16 v[244:247], a[72:75], v[88:91], v[244:247]
ds_read_b64_tr_b16 v[54:55], v12 offset:37376
v_mfma_f32_16x16x32_bf16 v[244:247], a[76:79], v[92:95], v[244:247]
ds_read_b128 a[84:87], v27 offset:2048
v_mfma_f32_16x16x32_bf16 v[248:251], a[136:139], v[88:91], v[248:251]
ds_read_b64_tr_b16 v[56:57], v13 offset:32768
v_mfma_f32_16x16x32_bf16 v[248:251], a[140:143], v[92:95], v[248:251]
ds_read_b128 a[148:151], v27 offset:4096
ds_read_b128 a[212:215], v27 offset:6144
v_mfma_f32_16x16x32_bf16 v[252:255], a[200:203], v[88:91], v[252:255]
ds_read_b64_tr_b16 v[58:59], v13 offset:33280
v_mfma_f32_16x16x32_bf16 v[252:255], a[204:207], v[92:95], v[252:255]
s_waitcnt lgkmcnt(1)
v_mfma_f32_16x16x32_bf16 v[128:131], v[32:35], a[16:19], v[128:131]
ds_read_b64_tr_b16 v[60:61], v13 offset:36864
v_mfma_f32_16x16x32_bf16 v[128:131], v[36:39], a[20:23], v[128:131]
s_add_u32 m0, s67, 0
s_add_u32 s59, s55, 640
v_mfma_f32_16x16x32_bf16 v[132:135], v[32:35], a[80:83], v[132:135]
ds_read_b64_tr_b16 v[62:63], v13 offset:37376
buffer_load_dwordx4 v[112:115], v16, s[32:35], s68 offen offset:0
v_mfma_f32_16x16x32_bf16 v[132:135], v[36:39], a[84:87], v[132:135]
buffer_load_dwordx4 v6, s[28:31], s59 offen offset:0 lds
v_mfma_f32_16x16x32_bf16 v[136:139], v[32:35], a[144:147], v[136:139]
ds_read_b64_tr_b16 v[64:65], v10 offset:40960
buffer_load_dwordx4 v[116:119], v16, s[32:35], s68 offen offset:1024
v_mfma_f32_16x16x32_bf16 v[136:139], v[36:39], a[148:151], v[136:139]
buffer_load_dwordx4 v7, s[28:31], s59 offen offset:1024 lds
v_mfma_f32_16x16x32_bf16 v[140:143], v[32:35], a[208:211], v[140:143]
ds_read_b64_tr_b16 v[66:67], v10 offset:41472
buffer_load_dwordx4 v[120:123], v16, s[32:35], s68 offen offset:2048
v_mfma_f32_16x16x32_bf16 v[140:143], v[36:39], a[212:215], v[140:143]
buffer_load_dwordx4 v8, s[28:31], s59 offen offset:2048 lds
v_mfma_f32_16x16x32_bf16 v[144:147], v[40:43], a[16:19], v[144:147]
ds_read_b64_tr_b16 v[68:69], v10 offset:45056
buffer_load_dwordx4 v[124:127], v16, s[32:35], s68 offen offset:3072
s_add_u32 s68, s68, 4096
v_mfma_f32_16x16x32_bf16 v[144:147], v[44:47], a[20:23], v[144:147]
buffer_load_dwordx4 v9, s[28:31], s59 offen offset:3072 lds
v_mfma_f32_16x16x32_bf16 v[148:151], v[40:43], a[80:83], v[148:151]
ds_read_b64_tr_b16 v[70:71], v10 offset:45568
buffer_load_dwordx4 v[112:115], v16, s[32:35], s68 offen offset:0
v_mfma_f32_16x16x32_bf16 v[148:151], v[44:47], a[84:87], v[148:151]
s_add_u32 m0, s67, 4096
s_add_u32 s59, s55, 33408
v_mfma_f32_16x16x32_bf16 v[152:155], v[40:43], a[144:147], v[152:155]
ds_read_b64_tr_b16 v[72:73], v11 offset:40960
buffer_load_dwordx4 v[116:119], v16, s[32:35], s68 offen offset:1024
v_mfma_f32_16x16x32_bf16 v[152:155], v[44:47], a[148:151], v[152:155]
buffer_load_dwordx4 v6, s[28:31], s59 offen offset:0 lds
v_mfma_f32_16x16x32_bf16 v[156:159], v[40:43], a[208:211], v[156:159]
ds_read_b64_tr_b16 v[74:75], v11 offset:41472
buffer_load_dwordx4 v[120:123], v16, s[32:35], s68 offen offset:2048
v_mfma_f32_16x16x32_bf16 v[156:159], v[44:47], a[212:215], v[156:159]
s_waitcnt lgkmcnt(6)
v_mfma_f32_16x16x32_bf16 v[160:163], v[48:51], a[16:19], v[160:163]
ds_read_b64_tr_b16 v[76:77], v11 offset:45056
buffer_load_dwordx4 v[124:127], v16, s[32:35], s68 offen offset:3072
s_add_u32 s68, s68, 4096
v_mfma_f32_16x16x32_bf16 v[160:163], v[52:55], a[20:23], v[160:163]
buffer_load_dwordx4 v7, s[28:31], s59 offen offset:1024 lds
v_mfma_f32_16x16x32_bf16 v[164:167], v[48:51], a[80:83], v[164:167]
ds_read_b64_tr_b16 v[78:79], v11 offset:45568
buffer_load_dwordx4 v[112:115], v16, s[32:35], s68 offen offset:0
v_mfma_f32_16x16x32_bf16 v[164:167], v[52:55], a[84:87], v[164:167]
buffer_load_dwordx4 v8, s[28:31], s59 offen offset:2048 lds
v_mfma_f32_16x16x32_bf16 v[168:171], v[48:51], a[144:147], v[168:171]
ds_read_b64_tr_b16 v[80:81], v12 offset:40960
buffer_load_dwordx4 v[116:119], v16, s[32:35], s68 offen offset:1024
v_mfma_f32_16x16x32_bf16 v[168:171], v[52:55], a[148:151], v[168:171]
buffer_load_dwordx4 v9, s[28:31], s59 offen offset:3072 lds
v_mfma_f32_16x16x32_bf16 v[172:175], v[48:51], a[208:211], v[172:175]
ds_read_b64_tr_b16 v[82:83], v12 offset:41472
v_mfma_f32_16x16x32_bf16 v[172:175], v[52:55], a[212:215], v[172:175]
v_mfma_f32_16x16x32_bf16 v[176:179], v[56:59], a[16:19], v[176:179]
ds_read_b64_tr_b16 v[84:85], v12 offset:45056
v_mfma_f32_16x16x32_bf16 v[176:179], v[60:63], a[20:23], v[176:179]
v_mfma_f32_16x16x32_bf16 v[180:183], v[56:59], a[80:83], v[180:183]
ds_read_b64_tr_b16 v[86:87], v12 offset:45568
v_mfma_f32_16x16x32_bf16 v[180:183], v[60:63], a[84:87], v[180:183]
v_mfma_f32_16x16x32_bf16 v[184:187], v[56:59], a[144:147], v[184:187]
ds_read_b64_tr_b16 v[88:89], v13 offset:40960
v_mfma_f32_16x16x32_bf16 v[184:187], v[60:63], a[148:151], v[184:187]
v_mfma_f32_16x16x32_bf16 v[188:191], v[56:59], a[208:211], v[188:191]
ds_read_b64_tr_b16 v[90:91], v13 offset:41472
v_mfma_f32_16x16x32_bf16 v[188:191], v[60:63], a[212:215], v[188:191]
s_waitcnt lgkmcnt(6)
v_mfma_f32_16x16x32_bf16 v[192:195], a[16:19], v[64:67], v[192:195]
ds_read_b64_tr_b16 v[92:93], v13 offset:45056
v_mfma_f32_16x16x32_bf16 v[192:195], a[20:23], v[68:71], v[192:195]
v_mfma_f32_16x16x32_bf16 v[196:199], a[80:83], v[64:67], v[196:199]
ds_read_b64_tr_b16 v[94:95], v13 offset:45568
v_mfma_f32_16x16x32_bf16 v[196:199], a[84:87], v[68:71], v[196:199]
s_waitcnt vmcnt(30)
s_barrier
v_mfma_f32_16x16x32_bf16 v[200:203], a[144:147], v[64:67], v[200:203]
ds_read_b64_tr_b16 v[32:33], v10 offset:49152
v_mfma_f32_16x16x32_bf16 v[200:203], a[148:151], v[68:71], v[200:203]
s_add_u32 m0, s56, 16384
v_mfma_f32_16x16x32_bf16 v[204:207], a[208:211], v[64:67], v[204:207]
ds_read_b64_tr_b16 v[34:35], v10 offset:49664
v_mfma_f32_16x16x32_bf16 v[204:207], a[212:215], v[68:71], v[204:207]
buffer_load_dwordx4 v2, s[32:35], s95 offen offset:0 lds
v_mfma_f32_16x16x32_bf16 v[208:211], a[16:19], v[72:75], v[208:211]
ds_read_b64_tr_b16 v[36:37], v10 offset:53248
v_mfma_f32_16x16x32_bf16 v[208:211], a[20:23], v[76:79], v[208:211]
buffer_load_dwordx4 v3, s[32:35], s95 offen offset:1024 lds
v_mfma_f32_16x16x32_bf16 v[212:215], a[80:83], v[72:75], v[212:215]
ds_read_b64_tr_b16 v[38:39], v10 offset:53760
v_mfma_f32_16x16x32_bf16 v[212:215], a[84:87], v[76:79], v[212:215]
buffer_load_dwordx4 v4, s[32:35], s95 offen offset:2048 lds
v_mfma_f32_16x16x32_bf16 v[216:219], a[144:147], v[72:75], v[216:219]
ds_read_b64_tr_b16 v[40:41], v11 offset:49152
v_mfma_f32_16x16x32_bf16 v[216:219], a[148:151], v[76:79], v[216:219]
buffer_load_dwordx4 v5, s[32:35], s95 offen offset:3072 lds
v_mfma_f32_16x16x32_bf16 v[220:223], a[208:211], v[72:75], v[220:223]
ds_read_b64_tr_b16 v[42:43], v11 offset:49664
v_mfma_f32_16x16x32_bf16 v[220:223], a[212:215], v[76:79], v[220:223]
s_waitcnt lgkmcnt(6)
v_mfma_f32_16x16x32_bf16 v[224:227], a[16:19], v[80:83], v[224:227]
ds_read_b64_tr_b16 v[44:45], v11 offset:53248
v_mfma_f32_16x16x32_bf16 v[224:227], a[20:23], v[84:87], v[224:227]
s_add_u32 s95, s95, s42
ds_read_b128 a[24:27], v14 offset:0
v_mfma_f32_16x16x32_bf16 v[228:231], a[80:83], v[80:83], v[228:231]
ds_read_b64_tr_b16 v[46:47], v11 offset:53760
v_mfma_f32_16x16x32_bf16 v[228:231], a[84:87], v[84:87], v[228:231]
ds_read_b128 a[88:91], v14 offset:2048
v_mfma_f32_16x16x32_bf16 v[232:235], a[144:147], v[80:83], v[232:235]
ds_read_b64_tr_b16 v[48:49], v12 offset:49152
v_mfma_f32_16x16x32_bf16 v[232:235], a[148:151], v[84:87], v[232:235]
ds_read_b128 a[152:155], v14 offset:4096
v_mfma_f32_16x16x32_bf16 v[236:239], a[208:211], v[80:83], v[236:239]
ds_read_b64_tr_b16 v[50:51], v12 offset:49664
v_mfma_f32_16x16x32_bf16 v[236:239], a[212:215], v[84:87], v[236:239]
ds_read_b128 a[216:219], v14 offset:6144
v_mfma_f32_16x16x32_bf16 v[240:243], a[16:19], v[88:91], v[240:243]
ds_read_b64_tr_b16 v[52:53], v12 offset:53248
v_mfma_f32_16x16x32_bf16 v[240:243], a[20:23], v[92:95], v[240:243]
ds_read_b128 a[28:31], v15 offset:0
v_mfma_f32_16x16x32_bf16 v[244:247], a[80:83], v[88:91], v[244:247]
ds_read_b64_tr_b16 v[54:55], v12 offset:53760
v_mfma_f32_16x16x32_bf16 v[244:247], a[84:87], v[92:95], v[244:247]
ds_read_b128 a[92:95], v15 offset:2048
v_mfma_f32_16x16x32_bf16 v[248:251], a[144:147], v[88:91], v[248:251]
ds_read_b64_tr_b16 v[56:57], v13 offset:49152
v_mfma_f32_16x16x32_bf16 v[248:251], a[148:151], v[92:95], v[248:251]
ds_read_b128 a[156:159], v15 offset:4096
ds_read_b128 a[220:223], v15 offset:6144
v_mfma_f32_16x16x32_bf16 v[252:255], a[208:211], v[88:91], v[252:255]
ds_read_b64_tr_b16 v[58:59], v13 offset:49664
v_mfma_f32_16x16x32_bf16 v[252:255], a[212:215], v[92:95], v[252:255]
s_waitcnt lgkmcnt(1)
v_mfma_f32_16x16x32_bf16 v[128:131], v[32:35], a[24:27], v[128:131]
ds_read_b64_tr_b16 v[60:61], v13 offset:53248
v_mfma_f32_16x16x32_bf16 v[128:131], v[36:39], a[28:31], v[128:131]
s_add_u32 m0, s57, 0
s_add_u32 s59, s55, 768
v_mfma_f32_16x16x32_bf16 v[132:135], v[32:35], a[88:91], v[132:135]
ds_read_b64_tr_b16 v[62:63], v13 offset:53760
v_mfma_f32_16x16x32_bf16 v[132:135], v[36:39], a[92:95], v[132:135]
buffer_load_dwordx4 v6, s[28:31], s59 offen offset:0 lds
v_mfma_f32_16x16x32_bf16 v[136:139], v[32:35], a[152:155], v[136:139]
ds_read_b64_tr_b16 v[64:65], v10 offset:57344
v_mfma_f32_16x16x32_bf16 v[136:139], v[36:39], a[156:159], v[136:139]
buffer_load_dwordx4 v7, s[28:31], s59 offen offset:1024 lds
v_mfma_f32_16x16x32_bf16 v[140:143], v[32:35], a[216:219], v[140:143]
ds_read_b64_tr_b16 v[66:67], v10 offset:57856
v_mfma_f32_16x16x32_bf16 v[140:143], v[36:39], a[220:223], v[140:143]
buffer_load_dwordx4 v8, s[28:31], s59 offen offset:2048 lds
v_mfma_f32_16x16x32_bf16 v[144:147], v[40:43], a[24:27], v[144:147]
ds_read_b64_tr_b16 v[68:69], v10 offset:61440
v_mfma_f32_16x16x32_bf16 v[144:147], v[44:47], a[28:31], v[144:147]
buffer_load_dwordx4 v9, s[28:31], s59 offen offset:3072 lds
v_mfma_f32_16x16x32_bf16 v[148:151], v[40:43], a[88:91], v[148:151]
ds_read_b64_tr_b16 v[70:71], v10 offset:61952
v_mfma_f32_16x16x32_bf16 v[148:151], v[44:47], a[92:95], v[148:151]
s_add_u32 m0, s57, 4096
s_add_u32 s59, s55, 33536
v_mfma_f32_16x16x32_bf16 v[152:155], v[40:43], a[152:155], v[152:155]
ds_read_b64_tr_b16 v[72:73], v11 offset:57344
v_mfma_f32_16x16x32_bf16 v[152:155], v[44:47], a[156:159], v[152:155]
buffer_load_dwordx4 v6, s[28:31], s59 offen offset:0 lds
v_mfma_f32_16x16x32_bf16 v[156:159], v[40:43], a[216:219], v[156:159]
ds_read_b64_tr_b16 v[74:75], v11 offset:57856
v_mfma_f32_16x16x32_bf16 v[156:159], v[44:47], a[220:223], v[156:159]
s_waitcnt lgkmcnt(6)
v_mfma_f32_16x16x32_bf16 v[160:163], v[48:51], a[24:27], v[160:163]
ds_read_b64_tr_b16 v[76:77], v11 offset:61440
v_mfma_f32_16x16x32_bf16 v[160:163], v[52:55], a[28:31], v[160:163]
buffer_load_dwordx4 v7, s[28:31], s59 offen offset:1024 lds
v_mfma_f32_16x16x32_bf16 v[164:167], v[48:51], a[88:91], v[164:167]
ds_read_b64_tr_b16 v[78:79], v11 offset:61952
v_mfma_f32_16x16x32_bf16 v[164:167], v[52:55], a[92:95], v[164:167]
buffer_load_dwordx4 v8, s[28:31], s59 offen offset:2048 lds
v_mfma_f32_16x16x32_bf16 v[168:171], v[48:51], a[152:155], v[168:171]
ds_read_b64_tr_b16 v[80:81], v12 offset:57344
v_mfma_f32_16x16x32_bf16 v[168:171], v[52:55], a[156:159], v[168:171]
buffer_load_dwordx4 v9, s[28:31], s59 offen offset:3072 lds
v_mfma_f32_16x16x32_bf16 v[172:175], v[48:51], a[216:219], v[172:175]
ds_read_b64_tr_b16 v[82:83], v12 offset:57856
v_mfma_f32_16x16x32_bf16 v[172:175], v[52:55], a[220:223], v[172:175]
v_mfma_f32_16x16x32_bf16 v[176:179], v[56:59], a[24:27], v[176:179]
ds_read_b64_tr_b16 v[84:85], v12 offset:61440
v_mfma_f32_16x16x32_bf16 v[176:179], v[60:63], a[28:31], v[176:179]
v_mfma_f32_16x16x32_bf16 v[180:183], v[56:59], a[88:91], v[180:183]
ds_read_b64_tr_b16 v[86:87], v12 offset:61952
v_mfma_f32_16x16x32_bf16 v[180:183], v[60:63], a[92:95], v[180:183]
v_mfma_f32_16x16x32_bf16 v[184:187], v[56:59], a[152:155], v[184:187]
ds_read_b64_tr_b16 v[88:89], v13 offset:57344
v_mfma_f32_16x16x32_bf16 v[184:187], v[60:63], a[156:159], v[184:187]
v_mfma_f32_16x16x32_bf16 v[188:191], v[56:59], a[216:219], v[188:191]
ds_read_b64_tr_b16 v[90:91], v13 offset:57856
v_mfma_f32_16x16x32_bf16 v[188:191], v[60:63], a[220:223], v[188:191]
s_waitcnt lgkmcnt(6)
v_mfma_f32_16x16x32_bf16 v[192:195], a[24:27], v[64:67], v[192:195]
ds_read_b64_tr_b16 v[92:93], v13 offset:61440
v_mfma_f32_16x16x32_bf16 v[192:195], a[28:31], v[68:71], v[192:195]
v_mfma_f32_16x16x32_bf16 v[196:199], a[88:91], v[64:67], v[196:199]
ds_read_b64_tr_b16 v[94:95], v13 offset:61952
v_mfma_f32_16x16x32_bf16 v[196:199], a[92:95], v[68:71], v[196:199]
s_waitcnt vmcnt(30)
s_barrier
v_mfma_f32_16x16x32_bf16 v[200:203], a[152:155], v[64:67], v[200:203]
ds_read_b64_tr_b16 v[32:33], v10 offset:0
v_mfma_f32_16x16x32_bf16 v[200:203], a[156:159], v[68:71], v[200:203]
s_add_u32 m0, s56, 32768
v_mfma_f32_16x16x32_bf16 v[204:207], a[216:219], v[64:67], v[204:207]
ds_read_b64_tr_b16 v[34:35], v10 offset:512
v_mfma_f32_16x16x32_bf16 v[204:207], a[220:223], v[68:71], v[204:207]
buffer_load_dwordx4 v2, s[32:35], s95 offen offset:0 lds
v_mfma_f32_16x16x32_bf16 v[208:211], a[24:27], v[72:75], v[208:211]
ds_read_b64_tr_b16 v[36:37], v10 offset:4096
v_mfma_f32_16x16x32_bf16 v[208:211], a[28:31], v[76:79], v[208:211]
buffer_load_dwordx4 v3, s[32:35], s95 offen offset:1024 lds
v_mfma_f32_16x16x32_bf16 v[212:215], a[88:91], v[72:75], v[212:215]
ds_read_b64_tr_b16 v[38:39], v10 offset:4608
v_mfma_f32_16x16x32_bf16 v[212:215], a[92:95], v[76:79], v[212:215]
buffer_load_dwordx4 v4, s[32:35], s95 offen offset:2048 lds
v_mfma_f32_16x16x32_bf16 v[216:219], a[152:155], v[72:75], v[216:219]
ds_read_b64_tr_b16 v[40:41], v11 offset:0
v_mfma_f32_16x16x32_bf16 v[216:219], a[156:159], v[76:79], v[216:219]
buffer_load_dwordx4 v5, s[32:35], s95 offen offset:3072 lds
v_mfma_f32_16x16x32_bf16 v[220:223], a[216:219], v[72:75], v[220:223]
ds_read_b64_tr_b16 v[42:43], v11 offset:512
v_mfma_f32_16x16x32_bf16 v[220:223], a[220:223], v[76:79], v[220:223]
s_waitcnt lgkmcnt(6)
v_mfma_f32_16x16x32_bf16 v[224:227], a[24:27], v[80:83], v[224:227]
ds_read_b64_tr_b16 v[44:45], v11 offset:4096
v_mfma_f32_16x16x32_bf16 v[224:227], a[28:31], v[84:87], v[224:227]
s_add_u32 s95, s95, s42
ds_read_b128 a[32:35], v14 offset:8192
v_mfma_f32_16x16x32_bf16 v[228:231], a[88:91], v[80:83], v[228:231]
ds_read_b64_tr_b16 v[46:47], v11 offset:4608
v_mfma_f32_16x16x32_bf16 v[228:231], a[92:95], v[84:87], v[228:231]
ds_read_b128 a[96:99], v14 offset:10240
v_mfma_f32_16x16x32_bf16 v[232:235], a[152:155], v[80:83], v[232:235]
ds_read_b64_tr_b16 v[48:49], v12 offset:0
v_mfma_f32_16x16x32_bf16 v[232:235], a[156:159], v[84:87], v[232:235]
ds_read_b128 a[160:163], v14 offset:12288
v_mfma_f32_16x16x32_bf16 v[236:239], a[216:219], v[80:83], v[236:239]
ds_read_b64_tr_b16 v[50:51], v12 offset:512
v_mfma_f32_16x16x32_bf16 v[236:239], a[220:223], v[84:87], v[236:239]
ds_read_b128 a[224:227], v14 offset:14336
v_mfma_f32_16x16x32_bf16 v[240:243], a[24:27], v[88:91], v[240:243]
ds_read_b64_tr_b16 v[52:53], v12 offset:4096
v_mfma_f32_16x16x32_bf16 v[240:243], a[28:31], v[92:95], v[240:243]
ds_read_b128 a[36:39], v15 offset:8192
v_mfma_f32_16x16x32_bf16 v[244:247], a[88:91], v[88:91], v[244:247]
ds_read_b64_tr_b16 v[54:55], v12 offset:4608
v_mfma_f32_16x16x32_bf16 v[244:247], a[92:95], v[92:95], v[244:247]
ds_read_b128 a[100:103], v15 offset:10240
v_mfma_f32_16x16x32_bf16 v[248:251], a[152:155], v[88:91], v[248:251]
ds_read_b64_tr_b16 v[56:57], v13 offset:0
v_mfma_f32_16x16x32_bf16 v[248:251], a[156:159], v[92:95], v[248:251]
ds_read_b128 a[164:167], v15 offset:12288
ds_read_b128 a[228:231], v15 offset:14336
v_mfma_f32_16x16x32_bf16 v[252:255], a[216:219], v[88:91], v[252:255]
ds_read_b64_tr_b16 v[58:59], v13 offset:512
v_mfma_f32_16x16x32_bf16 v[252:255], a[220:223], v[92:95], v[252:255]
s_waitcnt lgkmcnt(1)
v_mfma_f32_16x16x32_bf16 v[128:131], v[32:35], a[32:35], v[128:131]
ds_read_b64_tr_b16 v[60:61], v13 offset:4096
v_mfma_f32_16x16x32_bf16 v[128:131], v[36:39], a[36:39], v[128:131]
s_add_u32 m0, s57, 8192
s_add_u32 s59, s55, 896
v_mfma_f32_16x16x32_bf16 v[132:135], v[32:35], a[96:99], v[132:135]
ds_read_b64_tr_b16 v[62:63], v13 offset:4608
v_mfma_f32_16x16x32_bf16 v[132:135], v[36:39], a[100:103], v[132:135]
buffer_load_dwordx4 v6, s[28:31], s59 offen offset:0 lds
v_mfma_f32_16x16x32_bf16 v[136:139], v[32:35], a[160:163], v[136:139]
ds_read_b64_tr_b16 v[64:65], v10 offset:8192
v_mfma_f32_16x16x32_bf16 v[136:139], v[36:39], a[164:167], v[136:139]
buffer_load_dwordx4 v7, s[28:31], s59 offen offset:1024 lds
v_mfma_f32_16x16x32_bf16 v[140:143], v[32:35], a[224:227], v[140:143]
ds_read_b64_tr_b16 v[66:67], v10 offset:8704
v_mfma_f32_16x16x32_bf16 v[140:143], v[36:39], a[228:231], v[140:143]
buffer_load_dwordx4 v8, s[28:31], s59 offen offset:2048 lds
v_mfma_f32_16x16x32_bf16 v[144:147], v[40:43], a[32:35], v[144:147]
ds_read_b64_tr_b16 v[68:69], v10 offset:12288
v_mfma_f32_16x16x32_bf16 v[144:147], v[44:47], a[36:39], v[144:147]
buffer_load_dwordx4 v9, s[28:31], s59 offen offset:3072 lds
v_mfma_f32_16x16x32_bf16 v[148:151], v[40:43], a[96:99], v[148:151]
ds_read_b64_tr_b16 v[70:71], v10 offset:12800
v_mfma_f32_16x16x32_bf16 v[148:151], v[44:47], a[100:103], v[148:151]
s_add_u32 m0, s57, 12288
s_add_u32 s59, s55, 33664
v_mfma_f32_16x16x32_bf16 v[152:155], v[40:43], a[160:163], v[152:155]
ds_read_b64_tr_b16 v[72:73], v11 offset:8192
v_mfma_f32_16x16x32_bf16 v[152:155], v[44:47], a[164:167], v[152:155]
buffer_load_dwordx4 v6, s[28:31], s59 offen offset:0 lds
v_mfma_f32_16x16x32_bf16 v[156:159], v[40:43], a[224:227], v[156:159]
ds_read_b64_tr_b16 v[74:75], v11 offset:8704
v_mfma_f32_16x16x32_bf16 v[156:159], v[44:47], a[228:231], v[156:159]
s_waitcnt lgkmcnt(6)
v_mfma_f32_16x16x32_bf16 v[160:163], v[48:51], a[32:35], v[160:163]
ds_read_b64_tr_b16 v[76:77], v11 offset:12288
v_mfma_f32_16x16x32_bf16 v[160:163], v[52:55], a[36:39], v[160:163]
buffer_load_dwordx4 v7, s[28:31], s59 offen offset:1024 lds
v_mfma_f32_16x16x32_bf16 v[164:167], v[48:51], a[96:99], v[164:167]
ds_read_b64_tr_b16 v[78:79], v11 offset:12800
v_mfma_f32_16x16x32_bf16 v[164:167], v[52:55], a[100:103], v[164:167]
buffer_load_dwordx4 v8, s[28:31], s59 offen offset:2048 lds
v_mfma_f32_16x16x32_bf16 v[168:171], v[48:51], a[160:163], v[168:171]
ds_read_b64_tr_b16 v[80:81], v12 offset:8192
v_mfma_f32_16x16x32_bf16 v[168:171], v[52:55], a[164:167], v[168:171]
buffer_load_dwordx4 v9, s[28:31], s59 offen offset:3072 lds
v_mfma_f32_16x16x32_bf16 v[172:175], v[48:51], a[224:227], v[172:175]
ds_read_b64_tr_b16 v[82:83], v12 offset:8704
v_mfma_f32_16x16x32_bf16 v[172:175], v[52:55], a[228:231], v[172:175]
s_add_u32 s60, s62, 2
s_and_b32 s60, s60, 63
v_mfma_f32_16x16x32_bf16 v[176:179], v[56:59], a[32:35], v[176:179]
ds_read_b64_tr_b16 v[84:85], v12 offset:12288
v_mfma_f32_16x16x32_bf16 v[176:179], v[60:63], a[36:39], v[176:179]
s_lshl_b32 s60, s60, 7
s_mul_i32 s45, s40, s44
v_mfma_f32_16x16x32_bf16 v[180:183], v[56:59], a[96:99], v[180:183]
ds_read_b64_tr_b16 v[86:87], v12 offset:12800
v_mfma_f32_16x16x32_bf16 v[180:183], v[60:63], a[100:103], v[180:183]
s_lshl_b32 s45, s45, 5
s_add_u32 s45, s45, s60
v_mfma_f32_16x16x32_bf16 v[184:187], v[56:59], a[160:163], v[184:187]
ds_read_b64_tr_b16 v[88:89], v13 offset:8192
v_mfma_f32_16x16x32_bf16 v[184:187], v[60:63], a[164:167], v[184:187]
v_mfma_f32_16x16x32_bf16 v[188:191], v[56:59], a[224:227], v[188:191]
ds_read_b64_tr_b16 v[90:91], v13 offset:8704
v_mfma_f32_16x16x32_bf16 v[188:191], v[60:63], a[228:231], v[188:191]
s_waitcnt lgkmcnt(6)
v_mfma_f32_16x16x32_bf16 v[192:195], a[32:35], v[64:67], v[192:195]
ds_read_b64_tr_b16 v[92:93], v13 offset:12288
v_mfma_f32_16x16x32_bf16 v[192:195], a[36:39], v[68:71], v[192:195]
v_mfma_f32_16x16x32_bf16 v[196:199], a[96:99], v[64:67], v[196:199]
ds_read_b64_tr_b16 v[94:95], v13 offset:12800
v_mfma_f32_16x16x32_bf16 v[196:199], a[100:103], v[68:71], v[196:199]
s_waitcnt vmcnt(20)
s_barrier
v_mfma_f32_16x16x32_bf16 v[200:203], a[160:163], v[64:67], v[200:203]
ds_read_b64_tr_b16 v[32:33], v10 offset:16384
v_mfma_f32_16x16x32_bf16 v[200:203], a[164:167], v[68:71], v[200:203]
s_add_u32 m0, s56, 49152
v_mfma_f32_16x16x32_bf16 v[204:207], a[224:227], v[64:67], v[204:207]
ds_read_b64_tr_b16 v[34:35], v10 offset:16896
v_mfma_f32_16x16x32_bf16 v[204:207], a[228:231], v[68:71], v[204:207]
buffer_load_dwordx4 v2, s[32:35], s95 offen offset:0 lds
v_mfma_f32_16x16x32_bf16 v[208:211], a[32:35], v[72:75], v[208:211]
ds_read_b64_tr_b16 v[36:37], v10 offset:20480
v_mfma_f32_16x16x32_bf16 v[208:211], a[36:39], v[76:79], v[208:211]
buffer_load_dwordx4 v3, s[32:35], s95 offen offset:1024 lds
v_mfma_f32_16x16x32_bf16 v[212:215], a[96:99], v[72:75], v[212:215]
ds_read_b64_tr_b16 v[38:39], v10 offset:20992
v_mfma_f32_16x16x32_bf16 v[212:215], a[100:103], v[76:79], v[212:215]
buffer_load_dwordx4 v4, s[32:35], s95 offen offset:2048 lds
v_mfma_f32_16x16x32_bf16 v[216:219], a[160:163], v[72:75], v[216:219]
ds_read_b64_tr_b16 v[40:41], v11 offset:16384
v_mfma_f32_16x16x32_bf16 v[216:219], a[164:167], v[76:79], v[216:219]
buffer_load_dwordx4 v5, s[32:35], s95 offen offset:3072 lds
v_mfma_f32_16x16x32_bf16 v[220:223], a[224:227], v[72:75], v[220:223]
ds_read_b64_tr_b16 v[42:43], v11 offset:16896
v_mfma_f32_16x16x32_bf16 v[220:223], a[228:231], v[76:79], v[220:223]
s_waitcnt lgkmcnt(6)
v_mfma_f32_16x16x32_bf16 v[224:227], a[32:35], v[80:83], v[224:227]
ds_read_b64_tr_b16 v[44:45], v11 offset:20480
v_mfma_f32_16x16x32_bf16 v[224:227], a[36:39], v[84:87], v[224:227]
s_add_u32 s95, s95, s42
ds_read_b128 a[40:43], v26 offset:0
v_mfma_f32_16x16x32_bf16 v[228:231], a[96:99], v[80:83], v[228:231]
ds_read_b64_tr_b16 v[46:47], v11 offset:20992
v_mfma_f32_16x16x32_bf16 v[228:231], a[100:103], v[84:87], v[228:231]
ds_read_b128 a[104:107], v26 offset:2048
v_mfma_f32_16x16x32_bf16 v[232:235], a[160:163], v[80:83], v[232:235]
ds_read_b64_tr_b16 v[48:49], v12 offset:16384
v_mfma_f32_16x16x32_bf16 v[232:235], a[164:167], v[84:87], v[232:235]
ds_read_b128 a[168:171], v26 offset:4096
v_mfma_f32_16x16x32_bf16 v[236:239], a[224:227], v[80:83], v[236:239]
ds_read_b64_tr_b16 v[50:51], v12 offset:16896
v_mfma_f32_16x16x32_bf16 v[236:239], a[228:231], v[84:87], v[236:239]
ds_read_b128 a[232:235], v26 offset:6144
v_mfma_f32_16x16x32_bf16 v[240:243], a[32:35], v[88:91], v[240:243]
ds_read_b64_tr_b16 v[52:53], v12 offset:20480
v_mfma_f32_16x16x32_bf16 v[240:243], a[36:39], v[92:95], v[240:243]
ds_read_b128 a[44:47], v27 offset:0
v_mfma_f32_16x16x32_bf16 v[244:247], a[96:99], v[88:91], v[244:247]
ds_read_b64_tr_b16 v[54:55], v12 offset:20992
v_mfma_f32_16x16x32_bf16 v[244:247], a[100:103], v[92:95], v[244:247]
ds_read_b128 a[108:111], v27 offset:2048
v_mfma_f32_16x16x32_bf16 v[248:251], a[160:163], v[88:91], v[248:251]
ds_read_b64_tr_b16 v[56:57], v13 offset:16384
v_mfma_f32_16x16x32_bf16 v[248:251], a[164:167], v[92:95], v[248:251]
ds_read_b128 a[172:175], v27 offset:4096
ds_read_b128 a[236:239], v27 offset:6144
v_mfma_f32_16x16x32_bf16 v[252:255], a[224:227], v[88:91], v[252:255]
ds_read_b64_tr_b16 v[58:59], v13 offset:16896
v_mfma_f32_16x16x32_bf16 v[252:255], a[228:231], v[92:95], v[252:255]
s_waitcnt lgkmcnt(1)
v_mfma_f32_16x16x32_bf16 v[128:131], v[32:35], a[40:43], v[128:131]
ds_read_b64_tr_b16 v[60:61], v13 offset:20480
v_mfma_f32_16x16x32_bf16 v[128:131], v[36:39], a[44:47], v[128:131]
v_mfma_f32_16x16x32_bf16 v[132:135], v[32:35], a[104:107], v[132:135]
ds_read_b64_tr_b16 v[62:63], v13 offset:20992
v_mfma_f32_16x16x32_bf16 v[132:135], v[36:39], a[108:111], v[132:135]
v_mfma_f32_16x16x32_bf16 v[136:139], v[32:35], a[168:171], v[136:139]
ds_read_b64_tr_b16 v[64:65], v10 offset:24576
v_mfma_f32_16x16x32_bf16 v[136:139], v[36:39], a[172:175], v[136:139]
v_mfma_f32_16x16x32_bf16 v[140:143], v[32:35], a[232:235], v[140:143]
ds_read_b64_tr_b16 v[66:67], v10 offset:25088
v_mfma_f32_16x16x32_bf16 v[140:143], v[36:39], a[236:239], v[140:143]
v_mfma_f32_16x16x32_bf16 v[144:147], v[40:43], a[40:43], v[144:147]
ds_read_b64_tr_b16 v[68:69], v10 offset:28672
v_mfma_f32_16x16x32_bf16 v[144:147], v[44:47], a[44:47], v[144:147]
v_mfma_f32_16x16x32_bf16 v[148:151], v[40:43], a[104:107], v[148:151]
ds_read_b64_tr_b16 v[70:71], v10 offset:29184
v_mfma_f32_16x16x32_bf16 v[148:151], v[44:47], a[108:111], v[148:151]
v_mfma_f32_16x16x32_bf16 v[152:155], v[40:43], a[168:171], v[152:155]
ds_read_b64_tr_b16 v[72:73], v11 offset:24576
v_mfma_f32_16x16x32_bf16 v[152:155], v[44:47], a[172:175], v[152:155]
v_mfma_f32_16x16x32_bf16 v[156:159], v[40:43], a[232:235], v[156:159]
ds_read_b64_tr_b16 v[74:75], v11 offset:25088
v_mfma_f32_16x16x32_bf16 v[156:159], v[44:47], a[236:239], v[156:159]
s_waitcnt lgkmcnt(6)
v_mfma_f32_16x16x32_bf16 v[160:163], v[48:51], a[40:43], v[160:163]
ds_read_b64_tr_b16 v[76:77], v11 offset:28672
v_mfma_f32_16x16x32_bf16 v[160:163], v[52:55], a[44:47], v[160:163]
v_mfma_f32_16x16x32_bf16 v[164:167], v[48:51], a[104:107], v[164:167]
ds_read_b64_tr_b16 v[78:79], v11 offset:29184
v_mfma_f32_16x16x32_bf16 v[164:167], v[52:55], a[108:111], v[164:167]
v_mfma_f32_16x16x32_bf16 v[168:171], v[48:51], a[168:171], v[168:171]
ds_read_b64_tr_b16 v[80:81], v12 offset:24576
v_mfma_f32_16x16x32_bf16 v[168:171], v[52:55], a[172:175], v[168:171]
v_mfma_f32_16x16x32_bf16 v[172:175], v[48:51], a[232:235], v[172:175]
ds_read_b64_tr_b16 v[82:83], v12 offset:25088
v_mfma_f32_16x16x32_bf16 v[172:175], v[52:55], a[236:239], v[172:175]
v_mfma_f32_16x16x32_bf16 v[176:179], v[56:59], a[40:43], v[176:179]
ds_read_b64_tr_b16 v[84:85], v12 offset:28672
v_mfma_f32_16x16x32_bf16 v[176:179], v[60:63], a[44:47], v[176:179]
v_mfma_f32_16x16x32_bf16 v[180:183], v[56:59], a[104:107], v[180:183]
ds_read_b64_tr_b16 v[86:87], v12 offset:29184
v_mfma_f32_16x16x32_bf16 v[180:183], v[60:63], a[108:111], v[180:183]
v_mfma_f32_16x16x32_bf16 v[184:187], v[56:59], a[168:171], v[184:187]
ds_read_b64_tr_b16 v[88:89], v13 offset:24576
v_mfma_f32_16x16x32_bf16 v[184:187], v[60:63], a[172:175], v[184:187]
v_mfma_f32_16x16x32_bf16 v[188:191], v[56:59], a[232:235], v[188:191]
ds_read_b64_tr_b16 v[90:91], v13 offset:25088
v_mfma_f32_16x16x32_bf16 v[188:191], v[60:63], a[236:239], v[188:191]
s_waitcnt lgkmcnt(6)
v_mfma_f32_16x16x32_bf16 v[192:195], a[40:43], v[64:67], v[192:195]
ds_read_b64_tr_b16 v[92:93], v13 offset:28672
v_mfma_f32_16x16x32_bf16 v[192:195], a[44:47], v[68:71], v[192:195]
v_mfma_f32_16x16x32_bf16 v[196:199], a[104:107], v[64:67], v[196:199]
ds_read_b64_tr_b16 v[94:95], v13 offset:29184
v_mfma_f32_16x16x32_bf16 v[196:199], a[108:111], v[68:71], v[196:199]
s_waitcnt vmcnt(12)
s_barrier
v_mfma_f32_16x16x32_bf16 v[200:203], a[168:171], v[64:67], v[200:203]
ds_read_b64_tr_b16 v[32:33], v10 offset:32768
v_mfma_f32_16x16x32_bf16 v[200:203], a[172:175], v[68:71], v[200:203]
s_add_u32 m0, s56, 65536
v_mfma_f32_16x16x32_bf16 v[204:207], a[232:235], v[64:67], v[204:207]
ds_read_b64_tr_b16 v[34:35], v10 offset:33280
v_mfma_f32_16x16x32_bf16 v[204:207], a[236:239], v[68:71], v[204:207]
buffer_load_dwordx4 v2, s[32:35], s45 offen offset:0 lds
v_mfma_f32_16x16x32_bf16 v[208:211], a[40:43], v[72:75], v[208:211]
ds_read_b64_tr_b16 v[36:37], v10 offset:36864
v_mfma_f32_16x16x32_bf16 v[208:211], a[44:47], v[76:79], v[208:211]
buffer_load_dwordx4 v3, s[32:35], s45 offen offset:1024 lds
v_mfma_f32_16x16x32_bf16 v[212:215], a[104:107], v[72:75], v[212:215]
ds_read_b64_tr_b16 v[38:39], v10 offset:37376
v_mfma_f32_16x16x32_bf16 v[212:215], a[108:111], v[76:79], v[212:215]
buffer_load_dwordx4 v4, s[32:35], s45 offen offset:2048 lds
v_mfma_f32_16x16x32_bf16 v[216:219], a[168:171], v[72:75], v[216:219]
ds_read_b64_tr_b16 v[40:41], v11 offset:32768
v_mfma_f32_16x16x32_bf16 v[216:219], a[172:175], v[76:79], v[216:219]
buffer_load_dwordx4 v5, s[32:35], s45 offen offset:3072 lds
s_add_u32 s45, s45, s46
v_mfma_f32_16x16x32_bf16 v[220:223], a[232:235], v[72:75], v[220:223]
ds_read_b64_tr_b16 v[42:43], v11 offset:33280
v_mfma_f32_16x16x32_bf16 v[220:223], a[236:239], v[76:79], v[220:223]
s_waitcnt lgkmcnt(6)
v_mfma_f32_16x16x32_bf16 v[224:227], a[40:43], v[80:83], v[224:227]
ds_read_b64_tr_b16 v[44:45], v11 offset:36864
v_mfma_f32_16x16x32_bf16 v[224:227], a[44:47], v[84:87], v[224:227]
ds_read_b128 a[48:51], v14 offset:0
v_mfma_f32_16x16x32_bf16 v[228:231], a[104:107], v[80:83], v[228:231]
ds_read_b64_tr_b16 v[46:47], v11 offset:37376
v_mfma_f32_16x16x32_bf16 v[228:231], a[108:111], v[84:87], v[228:231]
ds_read_b128 a[112:115], v14 offset:2048
v_mfma_f32_16x16x32_bf16 v[232:235], a[168:171], v[80:83], v[232:235]
ds_read_b64_tr_b16 v[48:49], v12 offset:32768
v_mfma_f32_16x16x32_bf16 v[232:235], a[172:175], v[84:87], v[232:235]
ds_read_b128 a[176:179], v14 offset:4096
v_mfma_f32_16x16x32_bf16 v[236:239], a[232:235], v[80:83], v[236:239]
ds_read_b64_tr_b16 v[50:51], v12 offset:33280
v_mfma_f32_16x16x32_bf16 v[236:239], a[236:239], v[84:87], v[236:239]
ds_read_b128 a[240:243], v14 offset:6144
v_mfma_f32_16x16x32_bf16 v[240:243], a[40:43], v[88:91], v[240:243]
ds_read_b64_tr_b16 v[52:53], v12 offset:36864
v_mfma_f32_16x16x32_bf16 v[240:243], a[44:47], v[92:95], v[240:243]
ds_read_b128 a[52:55], v15 offset:0
v_mfma_f32_16x16x32_bf16 v[244:247], a[104:107], v[88:91], v[244:247]
ds_read_b64_tr_b16 v[54:55], v12 offset:37376
v_mfma_f32_16x16x32_bf16 v[244:247], a[108:111], v[92:95], v[244:247]
ds_read_b128 a[116:119], v15 offset:2048
v_mfma_f32_16x16x32_bf16 v[248:251], a[168:171], v[88:91], v[248:251]
ds_read_b64_tr_b16 v[56:57], v13 offset:32768
v_mfma_f32_16x16x32_bf16 v[248:251], a[172:175], v[92:95], v[248:251]
ds_read_b128 a[180:183], v15 offset:4096
ds_read_b128 a[244:247], v15 offset:6144
v_mfma_f32_16x16x32_bf16 v[252:255], a[232:235], v[88:91], v[252:255]
ds_read_b64_tr_b16 v[58:59], v13 offset:33280
v_mfma_f32_16x16x32_bf16 v[252:255], a[236:239], v[92:95], v[252:255]
s_waitcnt lgkmcnt(1)
v_mfma_f32_16x16x32_bf16 v[128:131], v[32:35], a[48:51], v[128:131]
ds_read_b64_tr_b16 v[60:61], v13 offset:36864
v_mfma_f32_16x16x32_bf16 v[128:131], v[36:39], a[52:55], v[128:131]
s_add_u32 m0, s56, 81920
v_mfma_f32_16x16x32_bf16 v[132:135], v[32:35], a[112:115], v[132:135]
ds_read_b64_tr_b16 v[62:63], v13 offset:37376
v_mfma_f32_16x16x32_bf16 v[132:135], v[36:39], a[116:119], v[132:135]
buffer_load_dwordx4 v2, s[32:35], s45 offen offset:0 lds
v_mfma_f32_16x16x32_bf16 v[136:139], v[32:35], a[176:179], v[136:139]
ds_read_b64_tr_b16 v[64:65], v10 offset:40960
v_mfma_f32_16x16x32_bf16 v[136:139], v[36:39], a[180:183], v[136:139]
buffer_load_dwordx4 v3, s[32:35], s45 offen offset:1024 lds
v_mfma_f32_16x16x32_bf16 v[140:143], v[32:35], a[240:243], v[140:143]
ds_read_b64_tr_b16 v[66:67], v10 offset:41472
v_mfma_f32_16x16x32_bf16 v[140:143], v[36:39], a[244:247], v[140:143]
buffer_load_dwordx4 v4, s[32:35], s45 offen offset:2048 lds
v_mfma_f32_16x16x32_bf16 v[144:147], v[40:43], a[48:51], v[144:147]
ds_read_b64_tr_b16 v[68:69], v10 offset:45056
v_mfma_f32_16x16x32_bf16 v[144:147], v[44:47], a[52:55], v[144:147]
buffer_load_dwordx4 v5, s[32:35], s45 offen offset:3072 lds
v_mfma_f32_16x16x32_bf16 v[148:151], v[40:43], a[112:115], v[148:151]
ds_read_b64_tr_b16 v[70:71], v10 offset:45568
v_mfma_f32_16x16x32_bf16 v[148:151], v[44:47], a[116:119], v[148:151]
s_add_u32 s45, s45, s46
v_mfma_f32_16x16x32_bf16 v[152:155], v[40:43], a[176:179], v[152:155]
ds_read_b64_tr_b16 v[72:73], v11 offset:40960
v_mfma_f32_16x16x32_bf16 v[152:155], v[44:47], a[180:183], v[152:155]
v_mfma_f32_16x16x32_bf16 v[156:159], v[40:43], a[240:243], v[156:159]
ds_read_b64_tr_b16 v[74:75], v11 offset:41472
v_mfma_f32_16x16x32_bf16 v[156:159], v[44:47], a[244:247], v[156:159]
s_waitcnt lgkmcnt(6)
v_mfma_f32_16x16x32_bf16 v[160:163], v[48:51], a[48:51], v[160:163]
ds_read_b64_tr_b16 v[76:77], v11 offset:45056
v_mfma_f32_16x16x32_bf16 v[160:163], v[52:55], a[52:55], v[160:163]
v_mfma_f32_16x16x32_bf16 v[164:167], v[48:51], a[112:115], v[164:167]
ds_read_b64_tr_b16 v[78:79], v11 offset:45568
v_mfma_f32_16x16x32_bf16 v[164:167], v[52:55], a[116:119], v[164:167]
s_add_u32 m0, s56, 0
v_mfma_f32_16x16x32_bf16 v[168:171], v[48:51], a[176:179], v[168:171]
ds_read_b64_tr_b16 v[80:81], v12 offset:40960
v_mfma_f32_16x16x32_bf16 v[168:171], v[52:55], a[180:183], v[168:171]
buffer_load_dwordx4 v2, s[32:35], s45 offen offset:0 lds
v_mfma_f32_16x16x32_bf16 v[172:175], v[48:51], a[240:243], v[172:175]
ds_read_b64_tr_b16 v[82:83], v12 offset:41472
v_mfma_f32_16x16x32_bf16 v[172:175], v[52:55], a[244:247], v[172:175]
buffer_load_dwordx4 v3, s[32:35], s45 offen offset:1024 lds
v_mfma_f32_16x16x32_bf16 v[176:179], v[56:59], a[48:51], v[176:179]
ds_read_b64_tr_b16 v[84:85], v12 offset:45056
v_mfma_f32_16x16x32_bf16 v[176:179], v[60:63], a[52:55], v[176:179]
buffer_load_dwordx4 v4, s[32:35], s45 offen offset:2048 lds
v_mfma_f32_16x16x32_bf16 v[180:183], v[56:59], a[112:115], v[180:183]
ds_read_b64_tr_b16 v[86:87], v12 offset:45568
v_mfma_f32_16x16x32_bf16 v[180:183], v[60:63], a[116:119], v[180:183]
buffer_load_dwordx4 v5, s[32:35], s45 offen offset:3072 lds
v_mfma_f32_16x16x32_bf16 v[184:187], v[56:59], a[176:179], v[184:187]
ds_read_b64_tr_b16 v[88:89], v13 offset:40960
v_mfma_f32_16x16x32_bf16 v[184:187], v[60:63], a[180:183], v[184:187]
s_add_u32 s45, s45, s46
v_mfma_f32_16x16x32_bf16 v[188:191], v[56:59], a[240:243], v[188:191]
ds_read_b64_tr_b16 v[90:91], v13 offset:41472
v_mfma_f32_16x16x32_bf16 v[188:191], v[60:63], a[244:247], v[188:191]
s_waitcnt lgkmcnt(6)
v_mfma_f32_16x16x32_bf16 v[192:195], a[48:51], v[64:67], v[192:195]
ds_read_b64_tr_b16 v[92:93], v13 offset:45056
v_mfma_f32_16x16x32_bf16 v[192:195], a[52:55], v[68:71], v[192:195]
v_mfma_f32_16x16x32_bf16 v[196:199], a[112:115], v[64:67], v[196:199]
ds_read_b64_tr_b16 v[94:95], v13 offset:45568
v_mfma_f32_16x16x32_bf16 v[196:199], a[116:119], v[68:71], v[196:199]
s_waitcnt vmcnt(12)
s_barrier
v_mfma_f32_16x16x32_bf16 v[200:203], a[176:179], v[64:67], v[200:203]
ds_read_b64_tr_b16 v[32:33], v10 offset:49152
v_mfma_f32_16x16x32_bf16 v[200:203], a[180:183], v[68:71], v[200:203]
s_add_u32 m0, s56, 16384
v_mfma_f32_16x16x32_bf16 v[204:207], a[240:243], v[64:67], v[204:207]
ds_read_b64_tr_b16 v[34:35], v10 offset:49664
v_mfma_f32_16x16x32_bf16 v[204:207], a[244:247], v[68:71], v[204:207]
buffer_load_dwordx4 v2, s[32:35], s45 offen offset:0 lds
v_mfma_f32_16x16x32_bf16 v[208:211], a[48:51], v[72:75], v[208:211]
ds_read_b64_tr_b16 v[36:37], v10 offset:53248
v_mfma_f32_16x16x32_bf16 v[208:211], a[52:55], v[76:79], v[208:211]
buffer_load_dwordx4 v3, s[32:35], s45 offen offset:1024 lds
v_mfma_f32_16x16x32_bf16 v[212:215], a[112:115], v[72:75], v[212:215]
ds_read_b64_tr_b16 v[38:39], v10 offset:53760
v_mfma_f32_16x16x32_bf16 v[212:215], a[116:119], v[76:79], v[212:215]
buffer_load_dwordx4 v4, s[32:35], s45 offen offset:2048 lds
v_mfma_f32_16x16x32_bf16 v[216:219], a[176:179], v[72:75], v[216:219]
ds_read_b64_tr_b16 v[40:41], v11 offset:49152
v_mfma_f32_16x16x32_bf16 v[216:219], a[180:183], v[76:79], v[216:219]
buffer_load_dwordx4 v5, s[32:35], s45 offen offset:3072 lds
v_mfma_f32_16x16x32_bf16 v[220:223], a[240:243], v[72:75], v[220:223]
ds_read_b64_tr_b16 v[42:43], v11 offset:49664
v_mfma_f32_16x16x32_bf16 v[220:223], a[244:247], v[76:79], v[220:223]
s_waitcnt lgkmcnt(6)
v_mfma_f32_16x16x32_bf16 v[224:227], a[48:51], v[80:83], v[224:227]
ds_read_b64_tr_b16 v[44:45], v11 offset:53248
v_mfma_f32_16x16x32_bf16 v[224:227], a[52:55], v[84:87], v[224:227]
ds_read_b128 a[56:59], v14 offset:8192
v_mfma_f32_16x16x32_bf16 v[228:231], a[112:115], v[80:83], v[228:231]
ds_read_b64_tr_b16 v[46:47], v11 offset:53760
v_mfma_f32_16x16x32_bf16 v[228:231], a[116:119], v[84:87], v[228:231]
ds_read_b128 a[120:123], v14 offset:10240
v_mfma_f32_16x16x32_bf16 v[232:235], a[176:179], v[80:83], v[232:235]
ds_read_b64_tr_b16 v[48:49], v12 offset:49152
v_mfma_f32_16x16x32_bf16 v[232:235], a[180:183], v[84:87], v[232:235]
ds_read_b128 a[184:187], v14 offset:12288
v_mfma_f32_16x16x32_bf16 v[236:239], a[240:243], v[80:83], v[236:239]
ds_read_b64_tr_b16 v[50:51], v12 offset:49664
v_mfma_f32_16x16x32_bf16 v[236:239], a[244:247], v[84:87], v[236:239]
ds_read_b128 a[248:251], v14 offset:14336
v_mfma_f32_16x16x32_bf16 v[240:243], a[48:51], v[88:91], v[240:243]
ds_read_b64_tr_b16 v[52:53], v12 offset:53248
v_mfma_f32_16x16x32_bf16 v[240:243], a[52:55], v[92:95], v[240:243]
ds_read_b128 a[60:63], v15 offset:8192
v_mfma_f32_16x16x32_bf16 v[244:247], a[112:115], v[88:91], v[244:247]
ds_read_b64_tr_b16 v[54:55], v12 offset:53760
v_mfma_f32_16x16x32_bf16 v[244:247], a[116:119], v[92:95], v[244:247]
ds_read_b128 a[124:127], v15 offset:10240
v_mfma_f32_16x16x32_bf16 v[248:251], a[176:179], v[88:91], v[248:251]
ds_read_b64_tr_b16 v[56:57], v13 offset:49152
v_mfma_f32_16x16x32_bf16 v[248:251], a[180:183], v[92:95], v[248:251]
ds_read_b128 a[188:191], v15 offset:12288
ds_read_b128 a[252:255], v15 offset:14336
v_mfma_f32_16x16x32_bf16 v[252:255], a[240:243], v[88:91], v[252:255]
ds_read_b64_tr_b16 v[58:59], v13 offset:49664
v_mfma_f32_16x16x32_bf16 v[252:255], a[244:247], v[92:95], v[252:255]
s_waitcnt lgkmcnt(1)
v_mfma_f32_16x16x32_bf16 v[128:131], v[32:35], a[56:59], v[128:131]
ds_read_b64_tr_b16 v[60:61], v13 offset:53248
v_mfma_f32_16x16x32_bf16 v[128:131], v[36:39], a[60:63], v[128:131]
s_add_u32 s60, s62, 3
s_and_b32 s60, s60, 63
v_mfma_f32_16x16x32_bf16 v[132:135], v[32:35], a[120:123], v[132:135]
ds_read_b64_tr_b16 v[62:63], v13 offset:53760
v_mfma_f32_16x16x32_bf16 v[132:135], v[36:39], a[124:127], v[132:135]
s_lshl_b32 s60, s60, 7
s_mul_i32 s45, s40, s44
v_mfma_f32_16x16x32_bf16 v[136:139], v[32:35], a[184:187], v[136:139]
ds_read_b64_tr_b16 v[64:65], v10 offset:57344
v_mfma_f32_16x16x32_bf16 v[136:139], v[36:39], a[188:191], v[136:139]
s_lshl_b32 s45, s45, 5
s_add_u32 s45, s45, s60
v_mfma_f32_16x16x32_bf16 v[140:143], v[32:35], a[248:251], v[140:143]
ds_read_b64_tr_b16 v[66:67], v10 offset:57856
v_mfma_f32_16x16x32_bf16 v[140:143], v[36:39], a[252:255], v[140:143]
v_mfma_f32_16x16x32_bf16 v[144:147], v[40:43], a[56:59], v[144:147]
ds_read_b64_tr_b16 v[68:69], v10 offset:61440
v_mfma_f32_16x16x32_bf16 v[144:147], v[44:47], a[60:63], v[144:147]
v_mfma_f32_16x16x32_bf16 v[148:151], v[40:43], a[120:123], v[148:151]
ds_read_b64_tr_b16 v[70:71], v10 offset:61952
v_mfma_f32_16x16x32_bf16 v[148:151], v[44:47], a[124:127], v[148:151]
s_mov_b32 s52, s50
s_mov_b32 s58, s51
v_mfma_f32_16x16x32_bf16 v[152:155], v[40:43], a[184:187], v[152:155]
ds_read_b64_tr_b16 v[72:73], v11 offset:57344
v_mfma_f32_16x16x32_bf16 v[152:155], v[44:47], a[188:191], v[152:155]
v_mfma_f32_16x16x32_bf16 v[156:159], v[40:43], a[248:251], v[156:159]
ds_read_b64_tr_b16 v[74:75], v11 offset:57856
v_mfma_f32_16x16x32_bf16 v[156:159], v[44:47], a[252:255], v[156:159]
s_waitcnt lgkmcnt(6)
v_mfma_f32_16x16x32_bf16 v[160:163], v[48:51], a[56:59], v[160:163]
ds_read_b64_tr_b16 v[76:77], v11 offset:61440
v_mfma_f32_16x16x32_bf16 v[160:163], v[52:55], a[60:63], v[160:163]
s_add_u32 s41, s41, 1
s_sub_u32 s43, s43, 1
s_lshr_b32 s60, s41, 1
v_mfma_f32_16x16x32_bf16 v[164:167], v[48:51], a[120:123], v[164:167]
ds_read_b64_tr_b16 v[78:79], v11 offset:61952
v_mfma_f32_16x16x32_bf16 v[164:167], v[52:55], a[124:127], v[164:167]
s_lshl_b32 s60, s60, 19
s_and_b32 s61, s41, 1
s_lshl_b32 s61, s61, 12
v_mfma_f32_16x16x32_bf16 v[168:171], v[48:51], a[184:187], v[168:171]
ds_read_b64_tr_b16 v[80:81], v12 offset:57344
v_mfma_f32_16x16x32_bf16 v[168:171], v[52:55], a[188:191], v[168:171]
s_add_u32 s60, s60, s61
s_lshl_b32 s61, s54, 13
s_add_u32 s50, s60, s61
v_mfma_f32_16x16x32_bf16 v[172:175], v[48:51], a[248:251], v[172:175]
ds_read_b64_tr_b16 v[82:83], v12 offset:57856
v_mfma_f32_16x16x32_bf16 v[172:175], v[52:55], a[252:255], v[172:175]
s_add_u32 s51, s50, 8192
s_cmp_ge_u32 s41, 64
s_cselect_b32 s53, 1, 0
s_sub_u32 s60, s41, 128
v_mfma_f32_16x16x32_bf16 v[176:179], v[56:59], a[56:59], v[176:179]
ds_read_b64_tr_b16 v[84:85], v12 offset:61440
v_mfma_f32_16x16x32_bf16 v[176:179], v[60:63], a[60:63], v[176:179]
s_cmp_lt_u32 s60, 16
s_cselect_b32 s53, 0, s53
v_mfma_f32_16x16x32_bf16 v[180:183], v[56:59], a[120:123], v[180:183]
ds_read_b64_tr_b16 v[86:87], v12 offset:61952
v_mfma_f32_16x16x32_bf16 v[180:183], v[60:63], a[124:127], v[180:183]
v_mfma_f32_16x16x32_bf16 v[184:187], v[56:59], a[184:187], v[184:187]
ds_read_b64_tr_b16 v[88:89], v13 offset:57344
v_mfma_f32_16x16x32_bf16 v[184:187], v[60:63], a[188:191], v[184:187]
v_mfma_f32_16x16x32_bf16 v[188:191], v[56:59], a[248:251], v[188:191]
ds_read_b64_tr_b16 v[90:91], v13 offset:57856
v_mfma_f32_16x16x32_bf16 v[188:191], v[60:63], a[252:255], v[188:191]
s_waitcnt lgkmcnt(6)
v_mfma_f32_16x16x32_bf16 v[192:195], a[56:59], v[64:67], v[192:195]
ds_read_b64_tr_b16 v[92:93], v13 offset:61440
v_mfma_f32_16x16x32_bf16 v[192:195], a[60:63], v[68:71], v[192:195]
v_mfma_f32_16x16x32_bf16 v[196:199], a[120:123], v[64:67], v[196:199]
ds_read_b64_tr_b16 v[94:95], v13 offset:61952
v_mfma_f32_16x16x32_bf16 v[196:199], a[124:127], v[68:71], v[196:199]
s_waitcnt vmcnt(12)
s_barrier
v_mfma_f32_16x16x32_bf16 v[200:203], a[184:187], v[64:67], v[200:203]
ds_read_b64_tr_b16 v[32:33], v18 offset:0
v_mfma_f32_16x16x32_bf16 v[200:203], a[188:191], v[68:71], v[200:203]
v_mul_f32 v128, s49, v128
v_mul_f32 v129, s49, v129
v_mul_f32 v130, s49, v130
v_mul_f32 v131, s49, v131
v_mul_f32 v144, s49, v144
v_mul_f32 v145, s49, v145
v_mfma_f32_16x16x32_bf16 v[204:207], a[248:251], v[64:67], v[204:207]
ds_read_b64_tr_b16 v[34:35], v18 offset:512
v_mul_f32 v146, s49, v146
v_mul_f32 v147, s49, v147
v_cvt_pk_bf16_f32 v96, v128, v129
v_cvt_pk_bf16_f32 v97, v130, v131
v_cvt_pk_bf16_f32 v98, v144, v145
v_cvt_pk_bf16_f32 v99, v146, v147
v_mfma_f32_16x16x32_bf16 v[204:207], a[252:255], v[68:71], v[204:207]
buffer_store_dwordx4 v[96:99], v16, s[36:39], s47 offen offset:0 sc1
v_mfma_f32_16x16x32_bf16 v[208:211], a[56:59], v[72:75], v[208:211]
ds_read_b64_tr_b16 v[36:37], v18 offset:4096
v_mul_f32 v132, s49, v132
v_mul_f32 v133, s49, v133
v_mul_f32 v134, s49, v134
v_mul_f32 v135, s49, v135
v_mul_f32 v148, s49, v148
v_mul_f32 v149, s49, v149
v_mfma_f32_16x16x32_bf16 v[208:211], a[60:63], v[76:79], v[208:211]
v_mul_f32 v150, s49, v150
v_mul_f32 v151, s49, v151
v_cvt_pk_bf16_f32 v100, v132, v133
v_cvt_pk_bf16_f32 v101, v134, v135
v_cvt_pk_bf16_f32 v102, v148, v149
v_cvt_pk_bf16_f32 v103, v150, v151
v_mfma_f32_16x16x32_bf16 v[212:215], a[120:123], v[72:75], v[212:215]
ds_read_b64_tr_b16 v[38:39], v18 offset:4608
buffer_store_dwordx4 v[100:103], v16, s[36:39], s47 offen offset:1024 sc1
v_mfma_f32_16x16x32_bf16 v[212:215], a[124:127], v[76:79], v[212:215]
v_mul_f32 v160, s49, v160
v_mul_f32 v161, s49, v161
v_mul_f32 v162, s49, v162
v_mul_f32 v163, s49, v163
v_mul_f32 v176, s49, v176
v_mul_f32 v177, s49, v177
v_mfma_f32_16x16x32_bf16 v[216:219], a[184:187], v[72:75], v[216:219]
ds_read_b64_tr_b16 v[40:41], v18 offset:8192
v_mul_f32 v178, s49, v178
v_mul_f32 v179, s49, v179
v_cvt_pk_bf16_f32 v104, v160, v161
v_cvt_pk_bf16_f32 v105, v162, v163
v_cvt_pk_bf16_f32 v106, v176, v177
v_cvt_pk_bf16_f32 v107, v178, v179
v_mfma_f32_16x16x32_bf16 v[216:219], a[188:191], v[76:79], v[216:219]
buffer_store_dwordx4 v[104:107], v16, s[36:39], s47 offen offset:2048 sc1
v_mfma_f32_16x16x32_bf16 v[220:223], a[248:251], v[72:75], v[220:223]
ds_read_b64_tr_b16 v[42:43], v18 offset:8704
v_mul_f32 v164, s49, v164
v_mul_f32 v165, s49, v165
v_mul_f32 v166, s49, v166
v_mul_f32 v167, s49, v167
v_mul_f32 v180, s49, v180
v_mul_f32 v181, s49, v181
v_mfma_f32_16x16x32_bf16 v[220:223], a[252:255], v[76:79], v[220:223]
s_waitcnt lgkmcnt(6)
v_mul_f32 v182, s49, v182
v_mul_f32 v183, s49, v183
v_cvt_pk_bf16_f32 v108, v164, v165
v_cvt_pk_bf16_f32 v109, v166, v167
v_cvt_pk_bf16_f32 v110, v180, v181
v_cvt_pk_bf16_f32 v111, v182, v183
v_mfma_f32_16x16x32_bf16 v[224:227], a[56:59], v[80:83], v[224:227]
ds_read_b64_tr_b16 v[44:45], v18 offset:12288
buffer_store_dwordx4 v[108:111], v16, s[36:39], s47 offen offset:3072 sc1
v_mfma_f32_16x16x32_bf16 v[224:227], a[60:63], v[84:87], v[224:227]
v_mul_f32 v136, s49, v136
v_mul_f32 v137, s49, v137
v_mul_f32 v138, s49, v138
v_mul_f32 v139, s49, v139
v_mul_f32 v152, s49, v152
v_mul_f32 v153, s49, v153
v_mfma_f32_16x16x32_bf16 v[228:231], a[120:123], v[80:83], v[228:231]
ds_read_b64_tr_b16 v[46:47], v18 offset:12800
v_mul_f32 v154, s49, v154
v_mul_f32 v155, s49, v155
v_cvt_pk_bf16_f32 v96, v136, v137
v_cvt_pk_bf16_f32 v97, v138, v139
v_cvt_pk_bf16_f32 v98, v152, v153
v_cvt_pk_bf16_f32 v99, v154, v155
v_mfma_f32_16x16x32_bf16 v[228:231], a[124:127], v[84:87], v[228:231]
buffer_store_dwordx4 v[96:99], v16, s[36:39], s48 offen offset:0 sc1
v_mfma_f32_16x16x32_bf16 v[232:235], a[184:187], v[80:83], v[232:235]
ds_read_b64_tr_b16 v[48:49], v19 offset:0
v_mul_f32 v140, s49, v140
v_mul_f32 v141, s49, v141
v_mul_f32 v142, s49, v142
v_mul_f32 v143, s49, v143
v_mul_f32 v156, s49, v156
v_mul_f32 v157, s49, v157
v_mfma_f32_16x16x32_bf16 v[232:235], a[188:191], v[84:87], v[232:235]
v_mul_f32 v158, s49, v158
v_mul_f32 v159, s49, v159
v_cvt_pk_bf16_f32 v100, v140, v141
v_cvt_pk_bf16_f32 v101, v142, v143
v_cvt_pk_bf16_f32 v102, v156, v157
v_cvt_pk_bf16_f32 v103, v158, v159
v_mfma_f32_16x16x32_bf16 v[236:239], a[248:251], v[80:83], v[236:239]
ds_read_b64_tr_b16 v[50:51], v19 offset:512
buffer_store_dwordx4 v[100:103], v16, s[36:39], s48 offen offset:1024 sc1
v_mfma_f32_16x16x32_bf16 v[236:239], a[252:255], v[84:87], v[236:239]
v_mul_f32 v168, s49, v168
v_mul_f32 v169, s49, v169
v_mul_f32 v170, s49, v170
v_mul_f32 v171, s49, v171
v_mul_f32 v184, s49, v184
v_mul_f32 v185, s49, v185
v_mfma_f32_16x16x32_bf16 v[240:243], a[56:59], v[88:91], v[240:243]
ds_read_b64_tr_b16 v[52:53], v19 offset:4096
v_mul_f32 v186, s49, v186
v_mul_f32 v187, s49, v187
v_cvt_pk_bf16_f32 v104, v168, v169
v_cvt_pk_bf16_f32 v105, v170, v171
v_cvt_pk_bf16_f32 v106, v184, v185
v_cvt_pk_bf16_f32 v107, v186, v187
v_mfma_f32_16x16x32_bf16 v[240:243], a[60:63], v[92:95], v[240:243]
buffer_store_dwordx4 v[104:107], v16, s[36:39], s48 offen offset:2048 sc1
v_mfma_f32_16x16x32_bf16 v[244:247], a[120:123], v[88:91], v[244:247]
ds_read_b64_tr_b16 v[54:55], v19 offset:4608
v_mul_f32 v172, s49, v172
v_mul_f32 v173, s49, v173
v_mul_f32 v174, s49, v174
v_mul_f32 v175, s49, v175
v_mul_f32 v188, s49, v188
v_mul_f32 v189, s49, v189
v_mfma_f32_16x16x32_bf16 v[244:247], a[124:127], v[92:95], v[244:247]
v_mul_f32 v190, s49, v190
v_mul_f32 v191, s49, v191
v_cvt_pk_bf16_f32 v108, v172, v173
v_cvt_pk_bf16_f32 v109, v174, v175
v_cvt_pk_bf16_f32 v110, v188, v189
v_cvt_pk_bf16_f32 v111, v190, v191
v_mfma_f32_16x16x32_bf16 v[248:251], a[184:187], v[88:91], v[248:251]
ds_read_b64_tr_b16 v[56:57], v19 offset:8192
buffer_store_dwordx4 v[108:111], v16, s[36:39], s48 offen offset:3072 sc1
v_mfma_f32_16x16x32_bf16 v[248:251], a[188:191], v[92:95], v[248:251]
v_mfma_f32_16x16x32_bf16 v[252:255], a[248:251], v[88:91], v[252:255]
ds_read_b64_tr_b16 v[58:59], v19 offset:8704
v_mfma_f32_16x16x32_bf16 v[252:255], a[252:255], v[92:95], v[252:255]
s_mov_b32 s47, s52
s_mov_b32 s48, s58
s_branch K1_P1
.p2align 6
K1_D11:
s_waitcnt lgkmcnt(6)
v_mfma_f32_16x16x32_bf16 v[128:131], a[0:3], v[32:35], 0
ds_read_b64_tr_b16 v[60:61], v13 offset:4096
v_mfma_f32_16x16x32_bf16 v[128:131], a[4:7], v[36:39], v[128:131]
s_add_u32 m0, s57, 0
s_add_u32 s59, s55, 384
v_mfma_f32_16x16x32_bf16 v[132:135], a[64:67], v[32:35], 0
ds_read_b64_tr_b16 v[62:63], v13 offset:4608
v_mfma_f32_16x16x32_bf16 v[132:135], a[68:71], v[36:39], v[132:135]
buffer_load_dwordx4 v6, s[28:31], s59 offen offset:0 lds
v_mfma_f32_16x16x32_bf16 v[136:139], a[128:131], v[32:35], 0
ds_read_b64_tr_b16 v[64:65], v10 offset:8192
v_mfma_f32_16x16x32_bf16 v[136:139], a[132:135], v[36:39], v[136:139]
buffer_load_dwordx4 v7, s[28:31], s59 offen offset:1024 lds
v_mfma_f32_16x16x32_bf16 v[140:143], a[192:195], v[32:35], 0
ds_read_b64_tr_b16 v[66:67], v10 offset:8704
v_mfma_f32_16x16x32_bf16 v[140:143], a[196:199], v[36:39], v[140:143]
buffer_load_dwordx4 v8, s[28:31], s59 offen offset:2048 lds
v_mfma_f32_16x16x32_bf16 v[144:147], a[0:3], v[40:43], 0
ds_read_b64_tr_b16 v[68:69], v10 offset:12288
v_mfma_f32_16x16x32_bf16 v[144:147], a[4:7], v[44:47], v[144:147]
buffer_load_dwordx4 v9, s[28:31], s59 offen offset:3072 lds
v_mfma_f32_16x16x32_bf16 v[148:151], a[64:67], v[40:43], 0
ds_read_b64_tr_b16 v[70:71], v10 offset:12800
v_mfma_f32_16x16x32_bf16 v[148:151], a[68:71], v[44:47], v[148:151]
s_add_u32 m0, s57, 4096
s_add_u32 s59, s55, 33152
v_mfma_f32_16x16x32_bf16 v[152:155], a[128:131], v[40:43], 0
ds_read_b64_tr_b16 v[72:73], v11 offset:8192
v_mfma_f32_16x16x32_bf16 v[152:155], a[132:135], v[44:47], v[152:155]
buffer_load_dwordx4 v6, s[28:31], s59 offen offset:0 lds
v_mfma_f32_16x16x32_bf16 v[156:159], a[192:195], v[40:43], 0
ds_read_b64_tr_b16 v[74:75], v11 offset:8704
v_mfma_f32_16x16x32_bf16 v[156:159], a[196:199], v[44:47], v[156:159]
s_waitcnt lgkmcnt(6)
v_mfma_f32_16x16x32_bf16 v[160:163], a[0:3], v[48:51], 0
ds_read_b64_tr_b16 v[76:77], v11 offset:12288
v_mfma_f32_16x16x32_bf16 v[160:163], a[4:7], v[52:55], v[160:163]
buffer_load_dwordx4 v7, s[28:31], s59 offen offset:1024 lds
v_mfma_f32_16x16x32_bf16 v[164:167], a[64:67], v[48:51], 0
ds_read_b64_tr_b16 v[78:79], v11 offset:12800
v_mfma_f32_16x16x32_bf16 v[164:167], a[68:71], v[52:55], v[164:167]
buffer_load_dwordx4 v8, s[28:31], s59 offen offset:2048 lds
v_mfma_f32_16x16x32_bf16 v[168:171], a[128:131], v[48:51], 0
ds_read_b64_tr_b16 v[80:81], v12 offset:8192
v_mfma_f32_16x16x32_bf16 v[168:171], a[132:135], v[52:55], v[168:171]
buffer_load_dwordx4 v9, s[28:31], s59 offen offset:3072 lds
v_mfma_f32_16x16x32_bf16 v[172:175], a[192:195], v[48:51], 0
ds_read_b64_tr_b16 v[82:83], v12 offset:8704
v_mfma_f32_16x16x32_bf16 v[172:175], a[196:199], v[52:55], v[172:175]
s_add_u32 m0, s56, 32768
v_mfma_f32_16x16x32_bf16 v[176:179], a[0:3], v[56:59], 0
ds_read_b64_tr_b16 v[84:85], v12 offset:12288
v_mfma_f32_16x16x32_bf16 v[176:179], a[4:7], v[60:63], v[176:179]
buffer_load_dwordx4 v2, s[32:35], s95 offen offset:0 lds
v_mfma_f32_16x16x32_bf16 v[180:183], a[64:67], v[56:59], 0
ds_read_b64_tr_b16 v[86:87], v12 offset:12800
v_mfma_f32_16x16x32_bf16 v[180:183], a[68:71], v[60:63], v[180:183]
buffer_load_dwordx4 v3, s[32:35], s95 offen offset:1024 lds
v_mfma_f32_16x16x32_bf16 v[184:187], a[128:131], v[56:59], 0
ds_read_b64_tr_b16 v[88:89], v13 offset:8192
v_mfma_f32_16x16x32_bf16 v[184:187], a[132:135], v[60:63], v[184:187]
buffer_load_dwordx4 v4, s[32:35], s95 offen offset:2048 lds
v_mfma_f32_16x16x32_bf16 v[188:191], a[192:195], v[56:59], 0
ds_read_b64_tr_b16 v[90:91], v13 offset:8704
v_mfma_f32_16x16x32_bf16 v[188:191], a[196:199], v[60:63], v[188:191]
s_waitcnt lgkmcnt(6)
v_mfma_f32_16x16x32_bf16 v[192:195], a[0:3], v[64:67], 0
ds_read_b64_tr_b16 v[92:93], v13 offset:12288
v_mfma_f32_16x16x32_bf16 v[192:195], a[4:7], v[68:71], v[192:195]
buffer_load_dwordx4 v5, s[32:35], s95 offen offset:3072 lds
s_add_u32 s95, s95, s42
v_mfma_f32_16x16x32_bf16 v[196:199], a[64:67], v[64:67], 0
ds_read_b64_tr_b16 v[94:95], v13 offset:12800
v_mfma_f32_16x16x32_bf16 v[196:199], a[68:71], v[68:71], v[196:199]
s_waitcnt vmcnt(28)
s_barrier
v_mfma_f32_16x16x32_bf16 v[200:203], a[128:131], v[64:67], 0
ds_read_b64_tr_b16 v[32:33], v10 offset:16384
v_mfma_f32_16x16x32_bf16 v[200:203], a[132:135], v[68:71], v[200:203]
s_add_u32 m0, s56, 49152
v_mfma_f32_16x16x32_bf16 v[204:207], a[192:195], v[64:67], 0
ds_read_b64_tr_b16 v[34:35], v10 offset:16896
v_mfma_f32_16x16x32_bf16 v[204:207], a[196:199], v[68:71], v[204:207]
buffer_load_dwordx4 v2, s[32:35], s95 offen offset:0 lds
v_mfma_f32_16x16x32_bf16 v[208:211], a[0:3], v[72:75], 0
ds_read_b64_tr_b16 v[36:37], v10 offset:20480
v_mfma_f32_16x16x32_bf16 v[208:211], a[4:7], v[76:79], v[208:211]
buffer_load_dwordx4 v3, s[32:35], s95 offen offset:1024 lds
v_mfma_f32_16x16x32_bf16 v[212:215], a[64:67], v[72:75], 0
ds_read_b64_tr_b16 v[38:39], v10 offset:20992
v_mfma_f32_16x16x32_bf16 v[212:215], a[68:71], v[76:79], v[212:215]
buffer_load_dwordx4 v4, s[32:35], s95 offen offset:2048 lds
v_mfma_f32_16x16x32_bf16 v[216:219], a[128:131], v[72:75], 0
ds_read_b64_tr_b16 v[40:41], v11 offset:16384
v_mfma_f32_16x16x32_bf16 v[216:219], a[132:135], v[76:79], v[216:219]
buffer_load_dwordx4 v5, s[32:35], s95 offen offset:3072 lds
v_mfma_f32_16x16x32_bf16 v[220:223], a[192:195], v[72:75], 0
ds_read_b64_tr_b16 v[42:43], v11 offset:16896
v_mfma_f32_16x16x32_bf16 v[220:223], a[196:199], v[76:79], v[220:223]
s_waitcnt lgkmcnt(6)
v_mfma_f32_16x16x32_bf16 v[224:227], a[0:3], v[80:83], 0
ds_read_b64_tr_b16 v[44:45], v11 offset:20480
v_mfma_f32_16x16x32_bf16 v[224:227], a[4:7], v[84:87], v[224:227]
s_add_u32 s95, s95, s42
s_waitcnt vmcnt(24)
ds_read_b128 a[8:11], v14 offset:8192
v_mfma_f32_16x16x32_bf16 v[228:231], a[64:67], v[80:83], 0
ds_read_b64_tr_b16 v[46:47], v11 offset:20992
v_mfma_f32_16x16x32_bf16 v[228:231], a[68:71], v[84:87], v[228:231]
ds_read_b128 a[72:75], v14 offset:10240
v_mfma_f32_16x16x32_bf16 v[232:235], a[128:131], v[80:83], 0
ds_read_b64_tr_b16 v[48:49], v12 offset:16384
v_mfma_f32_16x16x32_bf16 v[232:235], a[132:135], v[84:87], v[232:235]
ds_read_b128 a[136:139], v14 offset:12288
v_mfma_f32_16x16x32_bf16 v[236:239], a[192:195], v[80:83], 0
ds_read_b64_tr_b16 v[50:51], v12 offset:16896
v_mfma_f32_16x16x32_bf16 v[236:239], a[196:199], v[84:87], v[236:239]
ds_read_b128 a[200:203], v14 offset:14336
v_mfma_f32_16x16x32_bf16 v[240:243], a[0:3], v[88:91], 0
ds_read_b64_tr_b16 v[52:53], v12 offset:20480
v_mfma_f32_16x16x32_bf16 v[240:243], a[4:7], v[92:95], v[240:243]
ds_read_b128 a[12:15], v15 offset:8192
v_mfma_f32_16x16x32_bf16 v[244:247], a[64:67], v[88:91], 0
ds_read_b64_tr_b16 v[54:55], v12 offset:20992
v_mfma_f32_16x16x32_bf16 v[244:247], a[68:71], v[92:95], v[244:247]
ds_read_b128 a[76:79], v15 offset:10240
v_mfma_f32_16x16x32_bf16 v[248:251], a[128:131], v[88:91], 0
ds_read_b64_tr_b16 v[56:57], v13 offset:16384
v_mfma_f32_16x16x32_bf16 v[248:251], a[132:135], v[92:95], v[248:251]
ds_read_b128 a[140:143], v15 offset:12288
ds_read_b128 a[204:207], v15 offset:14336
v_mfma_f32_16x16x32_bf16 v[252:255], a[192:195], v[88:91], 0
ds_read_b64_tr_b16 v[58:59], v13 offset:16896
v_mfma_f32_16x16x32_bf16 v[252:255], a[196:199], v[92:95], v[252:255]
s_waitcnt lgkmcnt(1)
v_mfma_f32_16x16x32_bf16 v[128:131], a[8:11], v[32:35], v[128:131]
ds_read_b64_tr_b16 v[60:61], v13 offset:20480
v_mfma_f32_16x16x32_bf16 v[128:131], a[12:15], v[36:39], v[128:131]
s_add_u32 m0, s57, 8192
s_add_u32 s59, s55, 512
v_mfma_f32_16x16x32_bf16 v[132:135], a[72:75], v[32:35], v[132:135]
ds_read_b64_tr_b16 v[62:63], v13 offset:20992
v_mfma_f32_16x16x32_bf16 v[132:135], a[76:79], v[36:39], v[132:135]
buffer_load_dwordx4 v6, s[28:31], s59 offen offset:0 lds
v_mfma_f32_16x16x32_bf16 v[136:139], a[136:139], v[32:35], v[136:139]
ds_read_b64_tr_b16 v[64:65], v10 offset:24576
v_mfma_f32_16x16x32_bf16 v[136:139], a[140:143], v[36:39], v[136:139]
buffer_load_dwordx4 v7, s[28:31], s59 offen offset:1024 lds
v_mfma_f32_16x16x32_bf16 v[140:143], a[200:203], v[32:35], v[140:143]
ds_read_b64_tr_b16 v[66:67], v10 offset:25088
v_mfma_f32_16x16x32_bf16 v[140:143], a[204:207], v[36:39], v[140:143]
buffer_load_dwordx4 v8, s[28:31], s59 offen offset:2048 lds
v_mfma_f32_16x16x32_bf16 v[144:147], a[8:11], v[40:43], v[144:147]
ds_read_b64_tr_b16 v[68:69], v10 offset:28672
v_mfma_f32_16x16x32_bf16 v[144:147], a[12:15], v[44:47], v[144:147]
buffer_load_dwordx4 v9, s[28:31], s59 offen offset:3072 lds
v_mfma_f32_16x16x32_bf16 v[148:151], a[72:75], v[40:43], v[148:151]
ds_read_b64_tr_b16 v[70:71], v10 offset:29184
v_mfma_f32_16x16x32_bf16 v[148:151], a[76:79], v[44:47], v[148:151]
s_add_u32 m0, s57, 12288
s_add_u32 s59, s55, 33280
v_mfma_f32_16x16x32_bf16 v[152:155], a[136:139], v[40:43], v[152:155]
ds_read_b64_tr_b16 v[72:73], v11 offset:24576
v_mfma_f32_16x16x32_bf16 v[152:155], a[140:143], v[44:47], v[152:155]
buffer_load_dwordx4 v6, s[28:31], s59 offen offset:0 lds
v_mfma_f32_16x16x32_bf16 v[156:159], a[200:203], v[40:43], v[156:159]
ds_read_b64_tr_b16 v[74:75], v11 offset:25088
v_mfma_f32_16x16x32_bf16 v[156:159], a[204:207], v[44:47], v[156:159]
s_waitcnt lgkmcnt(6)
v_mfma_f32_16x16x32_bf16 v[160:163], a[8:11], v[48:51], v[160:163]
ds_read_b64_tr_b16 v[76:77], v11 offset:28672
v_mfma_f32_16x16x32_bf16 v[160:163], a[12:15], v[52:55], v[160:163]
buffer_load_dwordx4 v7, s[28:31], s59 offen offset:1024 lds
v_mfma_f32_16x16x32_bf16 v[164:167], a[72:75], v[48:51], v[164:167]
ds_read_b64_tr_b16 v[78:79], v11 offset:29184
v_mfma_f32_16x16x32_bf16 v[164:167], a[76:79], v[52:55], v[164:167]
buffer_load_dwordx4 v8, s[28:31], s59 offen offset:2048 lds
v_mfma_f32_16x16x32_bf16 v[168:171], a[136:139], v[48:51], v[168:171]
ds_read_b64_tr_b16 v[80:81], v12 offset:24576
v_mfma_f32_16x16x32_bf16 v[168:171], a[140:143], v[52:55], v[168:171]
buffer_load_dwordx4 v9, s[28:31], s59 offen offset:3072 lds
v_mfma_f32_16x16x32_bf16 v[172:175], a[200:203], v[48:51], v[172:175]
ds_read_b64_tr_b16 v[82:83], v12 offset:25088
v_mfma_f32_16x16x32_bf16 v[172:175], a[204:207], v[52:55], v[172:175]
s_mov_b32 s47, s50
s_mov_b32 s48, s51
s_add_u32 s41, s41, 1
s_sub_u32 s43, s43, 1
v_mfma_f32_16x16x32_bf16 v[176:179], a[8:11], v[56:59], v[176:179]
ds_read_b64_tr_b16 v[84:85], v12 offset:28672
v_mfma_f32_16x16x32_bf16 v[176:179], a[12:15], v[60:63], v[176:179]
s_lshr_b32 s60, s41, 1
s_lshl_b32 s60, s60, 19
s_and_b32 s61, s41, 1
s_lshl_b32 s61, s61, 12
v_mfma_f32_16x16x32_bf16 v[180:183], a[72:75], v[56:59], v[180:183]
ds_read_b64_tr_b16 v[86:87], v12 offset:29184
v_mfma_f32_16x16x32_bf16 v[180:183], a[76:79], v[60:63], v[180:183]
s_add_u32 s60, s60, s61
s_lshl_b32 s61, s54, 13
s_add_u32 s50, s60, s61
s_add_u32 s51, s50, 8192
v_mfma_f32_16x16x32_bf16 v[184:187], a[136:139], v[56:59], v[184:187]
ds_read_b64_tr_b16 v[88:89], v13 offset:24576
v_mfma_f32_16x16x32_bf16 v[184:187], a[140:143], v[60:63], v[184:187]
s_cmp_ge_u32 s41, 64
s_cselect_b32 s53, 1, 0
s_sub_u32 s60, s41, 128
s_cmp_lt_u32 s60, 16
s_cselect_b32 s53, 0, s53
v_mfma_f32_16x16x32_bf16 v[188:191], a[200:203], v[56:59], v[188:191]
ds_read_b64_tr_b16 v[90:91], v13 offset:25088
v_mfma_f32_16x16x32_bf16 v[188:191], a[204:207], v[60:63], v[188:191]
s_waitcnt lgkmcnt(6)
v_mfma_f32_16x16x32_bf16 v[192:195], a[8:11], v[64:67], v[192:195]
ds_read_b64_tr_b16 v[92:93], v13 offset:28672
v_mfma_f32_16x16x32_bf16 v[192:195], a[12:15], v[68:71], v[192:195]
v_mfma_f32_16x16x32_bf16 v[196:199], a[72:75], v[64:67], v[196:199]
ds_read_b64_tr_b16 v[94:95], v13 offset:29184
v_mfma_f32_16x16x32_bf16 v[196:199], a[76:79], v[68:71], v[196:199]
s_waitcnt vmcnt(12)
s_barrier
v_mfma_f32_16x16x32_bf16 v[200:203], a[136:139], v[64:67], v[200:203]
ds_read_b64_tr_b16 v[32:33], v10 offset:32768
v_mfma_f32_16x16x32_bf16 v[200:203], a[140:143], v[68:71], v[200:203]
s_add_u32 m0, s56, 0
v_mfma_f32_16x16x32_bf16 v[204:207], a[200:203], v[64:67], v[204:207]
ds_read_b64_tr_b16 v[34:35], v10 offset:33280
v_mfma_f32_16x16x32_bf16 v[204:207], a[204:207], v[68:71], v[204:207]
buffer_load_dwordx4 v2, s[32:35], s95 offen offset:0 lds
v_mfma_f32_16x16x32_bf16 v[208:211], a[8:11], v[72:75], v[208:211]
ds_read_b64_tr_b16 v[36:37], v10 offset:36864
v_mfma_f32_16x16x32_bf16 v[208:211], a[12:15], v[76:79], v[208:211]
buffer_load_dwordx4 v3, s[32:35], s95 offen offset:1024 lds
v_mfma_f32_16x16x32_bf16 v[212:215], a[72:75], v[72:75], v[212:215]
ds_read_b64_tr_b16 v[38:39], v10 offset:37376
v_mfma_f32_16x16x32_bf16 v[212:215], a[76:79], v[76:79], v[212:215]
buffer_load_dwordx4 v4, s[32:35], s95 offen offset:2048 lds
v_mfma_f32_16x16x32_bf16 v[216:219], a[136:139], v[72:75], v[216:219]
ds_read_b64_tr_b16 v[40:41], v11 offset:32768
v_mfma_f32_16x16x32_bf16 v[216:219], a[140:143], v[76:79], v[216:219]
buffer_load_dwordx4 v5, s[32:35], s95 offen offset:3072 lds
v_mfma_f32_16x16x32_bf16 v[220:223], a[200:203], v[72:75], v[220:223]
ds_read_b64_tr_b16 v[42:43], v11 offset:33280
v_mfma_f32_16x16x32_bf16 v[220:223], a[204:207], v[76:79], v[220:223]
s_waitcnt lgkmcnt(6)
v_mfma_f32_16x16x32_bf16 v[224:227], a[8:11], v[80:83], v[224:227]
ds_read_b64_tr_b16 v[44:45], v11 offset:36864
v_mfma_f32_16x16x32_bf16 v[224:227], a[12:15], v[84:87], v[224:227]
s_add_u32 s95, s95, s42
ds_read_b128 a[16:19], v26 offset:0
v_mfma_f32_16x16x32_bf16 v[228:231], a[72:75], v[80:83], v[228:231]
ds_read_b64_tr_b16 v[46:47], v11 offset:37376
v_mfma_f32_16x16x32_bf16 v[228:231], a[76:79], v[84:87], v[228:231]
ds_read_b128 a[80:83], v26 offset:2048
v_mfma_f32_16x16x32_bf16 v[232:235], a[136:139], v[80:83], v[232:235]
ds_read_b64_tr_b16 v[48:49], v12 offset:32768
v_mfma_f32_16x16x32_bf16 v[232:235], a[140:143], v[84:87], v[232:235]
ds_read_b128 a[144:147], v26 offset:4096
v_mfma_f32_16x16x32_bf16 v[236:239], a[200:203], v[80:83], v[236:239]
ds_read_b64_tr_b16 v[50:51], v12 offset:33280
v_mfma_f32_16x16x32_bf16 v[236:239], a[204:207], v[84:87], v[236:239]
ds_read_b128 a[208:211], v26 offset:6144
v_mfma_f32_16x16x32_bf16 v[240:243], a[8:11], v[88:91], v[240:243]
ds_read_b64_tr_b16 v[52:53], v12 offset:36864
v_mfma_f32_16x16x32_bf16 v[240:243], a[12:15], v[92:95], v[240:243]
ds_read_b128 a[20:23], v27 offset:0
v_mfma_f32_16x16x32_bf16 v[244:247], a[72:75], v[88:91], v[244:247]
ds_read_b64_tr_b16 v[54:55], v12 offset:37376
v_mfma_f32_16x16x32_bf16 v[244:247], a[76:79], v[92:95], v[244:247]
ds_read_b128 a[84:87], v27 offset:2048
v_mfma_f32_16x16x32_bf16 v[248:251], a[136:139], v[88:91], v[248:251]
ds_read_b64_tr_b16 v[56:57], v13 offset:32768
v_mfma_f32_16x16x32_bf16 v[248:251], a[140:143], v[92:95], v[248:251]
ds_read_b128 a[148:151], v27 offset:4096
ds_read_b128 a[212:215], v27 offset:6144
v_mfma_f32_16x16x32_bf16 v[252:255], a[200:203], v[88:91], v[252:255]
ds_read_b64_tr_b16 v[58:59], v13 offset:33280
v_mfma_f32_16x16x32_bf16 v[252:255], a[204:207], v[92:95], v[252:255]
s_waitcnt lgkmcnt(1)
v_mfma_f32_16x16x32_bf16 v[128:131], a[16:19], v[32:35], v[128:131]
ds_read_b64_tr_b16 v[60:61], v13 offset:36864
v_mfma_f32_16x16x32_bf16 v[128:131], a[20:23], v[36:39], v[128:131]
s_add_u32 m0, s67, 0
s_add_u32 s59, s55, 640
v_mfma_f32_16x16x32_bf16 v[132:135], a[80:83], v[32:35], v[132:135]
ds_read_b64_tr_b16 v[62:63], v13 offset:37376
buffer_load_dwordx4 v[112:115], v16, s[32:35], s68 offen offset:0
v_mfma_f32_16x16x32_bf16 v[132:135], a[84:87], v[36:39], v[132:135]
buffer_load_dwordx4 v6, s[28:31], s59 offen offset:0 lds
v_mfma_f32_16x16x32_bf16 v[136:139], a[144:147], v[32:35], v[136:139]
ds_read_b64_tr_b16 v[64:65], v10 offset:40960
buffer_load_dwordx4 v[116:119], v16, s[32:35], s68 offen offset:1024
v_mfma_f32_16x16x32_bf16 v[136:139], a[148:151], v[36:39], v[136:139]
buffer_load_dwordx4 v7, s[28:31], s59 offen offset:1024 lds
v_mfma_f32_16x16x32_bf16 v[140:143], a[208:211], v[32:35], v[140:143]
ds_read_b64_tr_b16 v[66:67], v10 offset:41472
buffer_load_dwordx4 v[120:123], v16, s[32:35], s68 offen offset:2048
v_mfma_f32_16x16x32_bf16 v[140:143], a[212:215], v[36:39], v[140:143]
buffer_load_dwordx4 v8, s[28:31], s59 offen offset:2048 lds
v_mfma_f32_16x16x32_bf16 v[144:147], a[16:19], v[40:43], v[144:147]
ds_read_b64_tr_b16 v[68:69], v10 offset:45056
buffer_load_dwordx4 v[124:127], v16, s[32:35], s68 offen offset:3072
s_add_u32 s68, s68, 4096
v_mfma_f32_16x16x32_bf16 v[144:147], a[20:23], v[44:47], v[144:147]
buffer_load_dwordx4 v9, s[28:31], s59 offen offset:3072 lds
v_mfma_f32_16x16x32_bf16 v[148:151], a[80:83], v[40:43], v[148:151]
ds_read_b64_tr_b16 v[70:71], v10 offset:45568
buffer_load_dwordx4 v[112:115], v16, s[32:35], s68 offen offset:0
v_mfma_f32_16x16x32_bf16 v[148:151], a[84:87], v[44:47], v[148:151]
s_add_u32 m0, s67, 4096
s_add_u32 s59, s55, 33408
v_mfma_f32_16x16x32_bf16 v[152:155], a[144:147], v[40:43], v[152:155]
ds_read_b64_tr_b16 v[72:73], v11 offset:40960
buffer_load_dwordx4 v[116:119], v16, s[32:35], s68 offen offset:1024
v_mfma_f32_16x16x32_bf16 v[152:155], a[148:151], v[44:47], v[152:155]
buffer_load_dwordx4 v6, s[28:31], s59 offen offset:0 lds
v_mfma_f32_16x16x32_bf16 v[156:159], a[208:211], v[40:43], v[156:159]
ds_read_b64_tr_b16 v[74:75], v11 offset:41472
buffer_load_dwordx4 v[120:123], v16, s[32:35], s68 offen offset:2048
v_mfma_f32_16x16x32_bf16 v[156:159], a[212:215], v[44:47], v[156:159]
s_waitcnt lgkmcnt(6)
v_mfma_f32_16x16x32_bf16 v[160:163], a[16:19], v[48:51], v[160:163]
ds_read_b64_tr_b16 v[76:77], v11 offset:45056
buffer_load_dwordx4 v[124:127], v16, s[32:35], s68 offen offset:3072
s_add_u32 s68, s68, 4096
v_mfma_f32_16x16x32_bf16 v[160:163], a[20:23], v[52:55], v[160:163]
buffer_load_dwordx4 v7, s[28:31], s59 offen offset:1024 lds
v_mfma_f32_16x16x32_bf16 v[164:167], a[80:83], v[48:51], v[164:167]
ds_read_b64_tr_b16 v[78:79], v11 offset:45568
buffer_load_dwordx4 v[112:115], v16, s[32:35], s68 offen offset:0
v_mfma_f32_16x16x32_bf16 v[164:167], a[84:87], v[52:55], v[164:167]
buffer_load_dwordx4 v8, s[28:31], s59 offen offset:2048 lds
v_mfma_f32_16x16x32_bf16 v[168:171], a[144:147], v[48:51], v[168:171]
ds_read_b64_tr_b16 v[80:81], v12 offset:40960
buffer_load_dwordx4 v[116:119], v16, s[32:35], s68 offen offset:1024
v_mfma_f32_16x16x32_bf16 v[168:171], a[148:151], v[52:55], v[168:171]
buffer_load_dwordx4 v9, s[28:31], s59 offen offset:3072 lds
v_mfma_f32_16x16x32_bf16 v[172:175], a[208:211], v[48:51], v[172:175]
ds_read_b64_tr_b16 v[82:83], v12 offset:41472
v_mfma_f32_16x16x32_bf16 v[172:175], a[212:215], v[52:55], v[172:175]
v_mfma_f32_16x16x32_bf16 v[176:179], a[16:19], v[56:59], v[176:179]
ds_read_b64_tr_b16 v[84:85], v12 offset:45056
v_mfma_f32_16x16x32_bf16 v[176:179], a[20:23], v[60:63], v[176:179]
v_mfma_f32_16x16x32_bf16 v[180:183], a[80:83], v[56:59], v[180:183]
ds_read_b64_tr_b16 v[86:87], v12 offset:45568
v_mfma_f32_16x16x32_bf16 v[180:183], a[84:87], v[60:63], v[180:183]
v_mfma_f32_16x16x32_bf16 v[184:187], a[144:147], v[56:59], v[184:187]
ds_read_b64_tr_b16 v[88:89], v13 offset:40960
v_mfma_f32_16x16x32_bf16 v[184:187], a[148:151], v[60:63], v[184:187]
v_mfma_f32_16x16x32_bf16 v[188:191], a[208:211], v[56:59], v[188:191]
ds_read_b64_tr_b16 v[90:91], v13 offset:41472
v_mfma_f32_16x16x32_bf16 v[188:191], a[212:215], v[60:63], v[188:191]
s_waitcnt lgkmcnt(6)
v_mfma_f32_16x16x32_bf16 v[192:195], a[16:19], v[64:67], v[192:195]
ds_read_b64_tr_b16 v[92:93], v13 offset:45056
v_mfma_f32_16x16x32_bf16 v[192:195], a[20:23], v[68:71], v[192:195]
v_mfma_f32_16x16x32_bf16 v[196:199], a[80:83], v[64:67], v[196:199]
ds_read_b64_tr_b16 v[94:95], v13 offset:45568
v_mfma_f32_16x16x32_bf16 v[196:199], a[84:87], v[68:71], v[196:199]
s_waitcnt vmcnt(30)
s_barrier
v_mfma_f32_16x16x32_bf16 v[200:203], a[144:147], v[64:67], v[200:203]
ds_read_b64_tr_b16 v[32:33], v10 offset:49152
v_mfma_f32_16x16x32_bf16 v[200:203], a[148:151], v[68:71], v[200:203]
s_add_u32 m0, s56, 16384
v_mfma_f32_16x16x32_bf16 v[204:207], a[208:211], v[64:67], v[204:207]
ds_read_b64_tr_b16 v[34:35], v10 offset:49664
v_mfma_f32_16x16x32_bf16 v[204:207], a[212:215], v[68:71], v[204:207]
buffer_load_dwordx4 v2, s[32:35], s95 offen offset:0 lds
v_mfma_f32_16x16x32_bf16 v[208:211], a[16:19], v[72:75], v[208:211]
ds_read_b64_tr_b16 v[36:37], v10 offset:53248
v_mfma_f32_16x16x32_bf16 v[208:211], a[20:23], v[76:79], v[208:211]
buffer_load_dwordx4 v3, s[32:35], s95 offen offset:1024 lds
v_mfma_f32_16x16x32_bf16 v[212:215], a[80:83], v[72:75], v[212:215]
ds_read_b64_tr_b16 v[38:39], v10 offset:53760
v_mfma_f32_16x16x32_bf16 v[212:215], a[84:87], v[76:79], v[212:215]
buffer_load_dwordx4 v4, s[32:35], s95 offen offset:2048 lds
v_mfma_f32_16x16x32_bf16 v[216:219], a[144:147], v[72:75], v[216:219]
ds_read_b64_tr_b16 v[40:41], v11 offset:49152
v_mfma_f32_16x16x32_bf16 v[216:219], a[148:151], v[76:79], v[216:219]
buffer_load_dwordx4 v5, s[32:35], s95 offen offset:3072 lds
v_mfma_f32_16x16x32_bf16 v[220:223], a[208:211], v[72:75], v[220:223]
ds_read_b64_tr_b16 v[42:43], v11 offset:49664
v_mfma_f32_16x16x32_bf16 v[220:223], a[212:215], v[76:79], v[220:223]
s_waitcnt lgkmcnt(6)
v_mfma_f32_16x16x32_bf16 v[224:227], a[16:19], v[80:83], v[224:227]
ds_read_b64_tr_b16 v[44:45], v11 offset:53248
v_mfma_f32_16x16x32_bf16 v[224:227], a[20:23], v[84:87], v[224:227]
s_add_u32 s95, s95, s42
ds_read_b128 a[24:27], v14 offset:0
v_mfma_f32_16x16x32_bf16 v[228:231], a[80:83], v[80:83], v[228:231]
ds_read_b64_tr_b16 v[46:47], v11 offset:53760
v_mfma_f32_16x16x32_bf16 v[228:231], a[84:87], v[84:87], v[228:231]
ds_read_b128 a[88:91], v14 offset:2048
v_mfma_f32_16x16x32_bf16 v[232:235], a[144:147], v[80:83], v[232:235]
ds_read_b64_tr_b16 v[48:49], v12 offset:49152
v_mfma_f32_16x16x32_bf16 v[232:235], a[148:151], v[84:87], v[232:235]
ds_read_b128 a[152:155], v14 offset:4096
v_mfma_f32_16x16x32_bf16 v[236:239], a[208:211], v[80:83], v[236:239]
ds_read_b64_tr_b16 v[50:51], v12 offset:49664
v_mfma_f32_16x16x32_bf16 v[236:239], a[212:215], v[84:87], v[236:239]
ds_read_b128 a[216:219], v14 offset:6144
v_mfma_f32_16x16x32_bf16 v[240:243], a[16:19], v[88:91], v[240:243]
ds_read_b64_tr_b16 v[52:53], v12 offset:53248
v_mfma_f32_16x16x32_bf16 v[240:243], a[20:23], v[92:95], v[240:243]
ds_read_b128 a[28:31], v15 offset:0
v_mfma_f32_16x16x32_bf16 v[244:247], a[80:83], v[88:91], v[244:247]
ds_read_b64_tr_b16 v[54:55], v12 offset:53760
v_mfma_f32_16x16x32_bf16 v[244:247], a[84:87], v[92:95], v[244:247]
ds_read_b128 a[92:95], v15 offset:2048
v_mfma_f32_16x16x32_bf16 v[248:251], a[144:147], v[88:91], v[248:251]
ds_read_b64_tr_b16 v[56:57], v13 offset:49152
v_mfma_f32_16x16x32_bf16 v[248:251], a[148:151], v[92:95], v[248:251]
ds_read_b128 a[156:159], v15 offset:4096
ds_read_b128 a[220:223], v15 offset:6144
v_mfma_f32_16x16x32_bf16 v[252:255], a[208:211], v[88:91], v[252:255]
ds_read_b64_tr_b16 v[58:59], v13 offset:49664
v_mfma_f32_16x16x32_bf16 v[252:255], a[212:215], v[92:95], v[252:255]
s_waitcnt lgkmcnt(1)
v_mfma_f32_16x16x32_bf16 v[128:131], a[24:27], v[32:35], v[128:131]
ds_read_b64_tr_b16 v[60:61], v13 offset:53248
v_mfma_f32_16x16x32_bf16 v[128:131], a[28:31], v[36:39], v[128:131]
s_add_u32 m0, s57, 0
s_add_u32 s59, s55, 768
v_mfma_f32_16x16x32_bf16 v[132:135], a[88:91], v[32:35], v[132:135]
ds_read_b64_tr_b16 v[62:63], v13 offset:53760
v_mfma_f32_16x16x32_bf16 v[132:135], a[92:95], v[36:39], v[132:135]
buffer_load_dwordx4 v6, s[28:31], s59 offen offset:0 lds
v_mfma_f32_16x16x32_bf16 v[136:139], a[152:155], v[32:35], v[136:139]
ds_read_b64_tr_b16 v[64:65], v10 offset:57344
v_mfma_f32_16x16x32_bf16 v[136:139], a[156:159], v[36:39], v[136:139]
buffer_load_dwordx4 v7, s[28:31], s59 offen offset:1024 lds
v_mfma_f32_16x16x32_bf16 v[140:143], a[216:219], v[32:35], v[140:143]
ds_read_b64_tr_b16 v[66:67], v10 offset:57856
v_mfma_f32_16x16x32_bf16 v[140:143], a[220:223], v[36:39], v[140:143]
buffer_load_dwordx4 v8, s[28:31], s59 offen offset:2048 lds
v_mfma_f32_16x16x32_bf16 v[144:147], a[24:27], v[40:43], v[144:147]
ds_read_b64_tr_b16 v[68:69], v10 offset:61440
v_mfma_f32_16x16x32_bf16 v[144:147], a[28:31], v[44:47], v[144:147]
buffer_load_dwordx4 v9, s[28:31], s59 offen offset:3072 lds
v_mfma_f32_16x16x32_bf16 v[148:151], a[88:91], v[40:43], v[148:151]
ds_read_b64_tr_b16 v[70:71], v10 offset:61952
v_mfma_f32_16x16x32_bf16 v[148:151], a[92:95], v[44:47], v[148:151]
s_add_u32 m0, s57, 4096
s_add_u32 s59, s55, 33536
v_mfma_f32_16x16x32_bf16 v[152:155], a[152:155], v[40:43], v[152:155]
ds_read_b64_tr_b16 v[72:73], v11 offset:57344
v_mfma_f32_16x16x32_bf16 v[152:155], a[156:159], v[44:47], v[152:155]
buffer_load_dwordx4 v6, s[28:31], s59 offen offset:0 lds
v_mfma_f32_16x16x32_bf16 v[156:159], a[216:219], v[40:43], v[156:159]
ds_read_b64_tr_b16 v[74:75], v11 offset:57856
v_mfma_f32_16x16x32_bf16 v[156:159], a[220:223], v[44:47], v[156:159]
s_waitcnt lgkmcnt(6)
v_mfma_f32_16x16x32_bf16 v[160:163], a[24:27], v[48:51], v[160:163]
ds_read_b64_tr_b16 v[76:77], v11 offset:61440
v_mfma_f32_16x16x32_bf16 v[160:163], a[28:31], v[52:55], v[160:163]
buffer_load_dwordx4 v7, s[28:31], s59 offen offset:1024 lds
v_mfma_f32_16x16x32_bf16 v[164:167], a[88:91], v[48:51], v[164:167]
ds_read_b64_tr_b16 v[78:79], v11 offset:61952
v_mfma_f32_16x16x32_bf16 v[164:167], a[92:95], v[52:55], v[164:167]
buffer_load_dwordx4 v8, s[28:31], s59 offen offset:2048 lds
v_mfma_f32_16x16x32_bf16 v[168:171], a[152:155], v[48:51], v[168:171]
ds_read_b64_tr_b16 v[80:81], v12 offset:57344
v_mfma_f32_16x16x32_bf16 v[168:171], a[156:159], v[52:55], v[168:171]
buffer_load_dwordx4 v9, s[28:31], s59 offen offset:3072 lds
v_mfma_f32_16x16x32_bf16 v[172:175], a[216:219], v[48:51], v[172:175]
ds_read_b64_tr_b16 v[82:83], v12 offset:57856
v_mfma_f32_16x16x32_bf16 v[172:175], a[220:223], v[52:55], v[172:175]
v_mfma_f32_16x16x32_bf16 v[176:179], a[24:27], v[56:59], v[176:179]
ds_read_b64_tr_b16 v[84:85], v12 offset:61440
v_mfma_f32_16x16x32_bf16 v[176:179], a[28:31], v[60:63], v[176:179]
v_mfma_f32_16x16x32_bf16 v[180:183], a[88:91], v[56:59], v[180:183]
ds_read_b64_tr_b16 v[86:87], v12 offset:61952
v_mfma_f32_16x16x32_bf16 v[180:183], a[92:95], v[60:63], v[180:183]
v_mfma_f32_16x16x32_bf16 v[184:187], a[152:155], v[56:59], v[184:187]
ds_read_b64_tr_b16 v[88:89], v13 offset:57344
v_mfma_f32_16x16x32_bf16 v[184:187], a[156:159], v[60:63], v[184:187]
v_mfma_f32_16x16x32_bf16 v[188:191], a[216:219], v[56:59], v[188:191]
ds_read_b64_tr_b16 v[90:91], v13 offset:57856
v_mfma_f32_16x16x32_bf16 v[188:191], a[220:223], v[60:63], v[188:191]
s_waitcnt lgkmcnt(6)
v_mfma_f32_16x16x32_bf16 v[192:195], a[24:27], v[64:67], v[192:195]
ds_read_b64_tr_b16 v[92:93], v13 offset:61440
v_mfma_f32_16x16x32_bf16 v[192:195], a[28:31], v[68:71], v[192:195]
v_mfma_f32_16x16x32_bf16 v[196:199], a[88:91], v[64:67], v[196:199]
ds_read_b64_tr_b16 v[94:95], v13 offset:61952
v_mfma_f32_16x16x32_bf16 v[196:199], a[92:95], v[68:71], v[196:199]
s_waitcnt vmcnt(30)
s_barrier
v_mfma_f32_16x16x32_bf16 v[200:203], a[152:155], v[64:67], v[200:203]
ds_read_b64_tr_b16 v[32:33], v10 offset:0
v_mfma_f32_16x16x32_bf16 v[200:203], a[156:159], v[68:71], v[200:203]
s_add_u32 m0, s56, 32768
v_mfma_f32_16x16x32_bf16 v[204:207], a[216:219], v[64:67], v[204:207]
ds_read_b64_tr_b16 v[34:35], v10 offset:512
v_mfma_f32_16x16x32_bf16 v[204:207], a[220:223], v[68:71], v[204:207]
buffer_load_dwordx4 v2, s[32:35], s95 offen offset:0 lds
v_mfma_f32_16x16x32_bf16 v[208:211], a[24:27], v[72:75], v[208:211]
ds_read_b64_tr_b16 v[36:37], v10 offset:4096
v_mfma_f32_16x16x32_bf16 v[208:211], a[28:31], v[76:79], v[208:211]
buffer_load_dwordx4 v3, s[32:35], s95 offen offset:1024 lds
v_mfma_f32_16x16x32_bf16 v[212:215], a[88:91], v[72:75], v[212:215]
ds_read_b64_tr_b16 v[38:39], v10 offset:4608
v_mfma_f32_16x16x32_bf16 v[212:215], a[92:95], v[76:79], v[212:215]
buffer_load_dwordx4 v4, s[32:35], s95 offen offset:2048 lds
v_mfma_f32_16x16x32_bf16 v[216:219], a[152:155], v[72:75], v[216:219]
ds_read_b64_tr_b16 v[40:41], v11 offset:0
v_mfma_f32_16x16x32_bf16 v[216:219], a[156:159], v[76:79], v[216:219]
buffer_load_dwordx4 v5, s[32:35], s95 offen offset:3072 lds
v_mfma_f32_16x16x32_bf16 v[220:223], a[216:219], v[72:75], v[220:223]
ds_read_b64_tr_b16 v[42:43], v11 offset:512
v_mfma_f32_16x16x32_bf16 v[220:223], a[220:223], v[76:79], v[220:223]
s_waitcnt lgkmcnt(6)
v_mfma_f32_16x16x32_bf16 v[224:227], a[24:27], v[80:83], v[224:227]
ds_read_b64_tr_b16 v[44:45], v11 offset:4096
v_mfma_f32_16x16x32_bf16 v[224:227], a[28:31], v[84:87], v[224:227]
s_add_u32 s95, s95, s42
ds_read_b128 a[32:35], v14 offset:8192
v_mfma_f32_16x16x32_bf16 v[228:231], a[88:91], v[80:83], v[228:231]
ds_read_b64_tr_b16 v[46:47], v11 offset:4608
v_mfma_f32_16x16x32_bf16 v[228:231], a[92:95], v[84:87], v[228:231]
ds_read_b128 a[96:99], v14 offset:10240
v_mfma_f32_16x16x32_bf16 v[232:235], a[152:155], v[80:83], v[232:235]
ds_read_b64_tr_b16 v[48:49], v12 offset:0
v_mfma_f32_16x16x32_bf16 v[232:235], a[156:159], v[84:87], v[232:235]
ds_read_b128 a[160:163], v14 offset:12288
v_mfma_f32_16x16x32_bf16 v[236:239], a[216:219], v[80:83], v[236:239]
ds_read_b64_tr_b16 v[50:51], v12 offset:512
v_mfma_f32_16x16x32_bf16 v[236:239], a[220:223], v[84:87], v[236:239]
ds_read_b128 a[224:227], v14 offset:14336
v_mfma_f32_16x16x32_bf16 v[240:243], a[24:27], v[88:91], v[240:243]
ds_read_b64_tr_b16 v[52:53], v12 offset:4096
v_mfma_f32_16x16x32_bf16 v[240:243], a[28:31], v[92:95], v[240:243]
ds_read_b128 a[36:39], v15 offset:8192
v_mfma_f32_16x16x32_bf16 v[244:247], a[88:91], v[88:91], v[244:247]
ds_read_b64_tr_b16 v[54:55], v12 offset:4608
v_mfma_f32_16x16x32_bf16 v[244:247], a[92:95], v[92:95], v[244:247]
ds_read_b128 a[100:103], v15 offset:10240
v_mfma_f32_16x16x32_bf16 v[248:251], a[152:155], v[88:91], v[248:251]
ds_read_b64_tr_b16 v[56:57], v13 offset:0
v_mfma_f32_16x16x32_bf16 v[248:251], a[156:159], v[92:95], v[248:251]
ds_read_b128 a[164:167], v15 offset:12288
ds_read_b128 a[228:231], v15 offset:14336
v_mfma_f32_16x16x32_bf16 v[252:255], a[216:219], v[88:91], v[252:255]
ds_read_b64_tr_b16 v[58:59], v13 offset:512
v_mfma_f32_16x16x32_bf16 v[252:255], a[220:223], v[92:95], v[252:255]
s_waitcnt lgkmcnt(1)
v_mfma_f32_16x16x32_bf16 v[128:131], a[32:35], v[32:35], v[128:131]
ds_read_b64_tr_b16 v[60:61], v13 offset:4096
v_mfma_f32_16x16x32_bf16 v[128:131], a[36:39], v[36:39], v[128:131]
s_add_u32 m0, s57, 8192
s_add_u32 s59, s55, 896
v_mfma_f32_16x16x32_bf16 v[132:135], a[96:99], v[32:35], v[132:135]
ds_read_b64_tr_b16 v[62:63], v13 offset:4608
v_mfma_f32_16x16x32_bf16 v[132:135], a[100:103], v[36:39], v[132:135]
buffer_load_dwordx4 v6, s[28:31], s59 offen offset:0 lds
v_mfma_f32_16x16x32_bf16 v[136:139], a[160:163], v[32:35], v[136:139]
ds_read_b64_tr_b16 v[64:65], v10 offset:8192
v_mfma_f32_16x16x32_bf16 v[136:139], a[164:167], v[36:39], v[136:139]
buffer_load_dwordx4 v7, s[28:31], s59 offen offset:1024 lds
v_mfma_f32_16x16x32_bf16 v[140:143], a[224:227], v[32:35], v[140:143]
ds_read_b64_tr_b16 v[66:67], v10 offset:8704
v_mfma_f32_16x16x32_bf16 v[140:143], a[228:231], v[36:39], v[140:143]
buffer_load_dwordx4 v8, s[28:31], s59 offen offset:2048 lds
v_mfma_f32_16x16x32_bf16 v[144:147], a[32:35], v[40:43], v[144:147]
ds_read_b64_tr_b16 v[68:69], v10 offset:12288
v_mfma_f32_16x16x32_bf16 v[144:147], a[36:39], v[44:47], v[144:147]
buffer_load_dwordx4 v9, s[28:31], s59 offen offset:3072 lds
v_mfma_f32_16x16x32_bf16 v[148:151], a[96:99], v[40:43], v[148:151]
ds_read_b64_tr_b16 v[70:71], v10 offset:12800
v_mfma_f32_16x16x32_bf16 v[148:151], a[100:103], v[44:47], v[148:151]
s_add_u32 m0, s57, 12288
s_add_u32 s59, s55, 33664
v_mfma_f32_16x16x32_bf16 v[152:155], a[160:163], v[40:43], v[152:155]
ds_read_b64_tr_b16 v[72:73], v11 offset:8192
v_mfma_f32_16x16x32_bf16 v[152:155], a[164:167], v[44:47], v[152:155]
buffer_load_dwordx4 v6, s[28:31], s59 offen offset:0 lds
v_mfma_f32_16x16x32_bf16 v[156:159], a[224:227], v[40:43], v[156:159]
ds_read_b64_tr_b16 v[74:75], v11 offset:8704
v_mfma_f32_16x16x32_bf16 v[156:159], a[228:231], v[44:47], v[156:159]
s_waitcnt lgkmcnt(6)
v_mfma_f32_16x16x32_bf16 v[160:163], a[32:35], v[48:51], v[160:163]
ds_read_b64_tr_b16 v[76:77], v11 offset:12288
v_mfma_f32_16x16x32_bf16 v[160:163], a[36:39], v[52:55], v[160:163]
buffer_load_dwordx4 v7, s[28:31], s59 offen offset:1024 lds
v_mfma_f32_16x16x32_bf16 v[164:167], a[96:99], v[48:51], v[164:167]
ds_read_b64_tr_b16 v[78:79], v11 offset:12800
v_mfma_f32_16x16x32_bf16 v[164:167], a[100:103], v[52:55], v[164:167]
buffer_load_dwordx4 v8, s[28:31], s59 offen offset:2048 lds
v_mfma_f32_16x16x32_bf16 v[168:171], a[160:163], v[48:51], v[168:171]
ds_read_b64_tr_b16 v[80:81], v12 offset:8192
v_mfma_f32_16x16x32_bf16 v[168:171], a[164:167], v[52:55], v[168:171]
buffer_load_dwordx4 v9, s[28:31], s59 offen offset:3072 lds
v_mfma_f32_16x16x32_bf16 v[172:175], a[224:227], v[48:51], v[172:175]
ds_read_b64_tr_b16 v[82:83], v12 offset:8704
v_mfma_f32_16x16x32_bf16 v[172:175], a[228:231], v[52:55], v[172:175]
s_add_u32 s60, s62, 2
s_and_b32 s60, s60, 63
v_mfma_f32_16x16x32_bf16 v[176:179], a[32:35], v[56:59], v[176:179]
ds_read_b64_tr_b16 v[84:85], v12 offset:12288
v_mfma_f32_16x16x32_bf16 v[176:179], a[36:39], v[60:63], v[176:179]
s_lshl_b32 s60, s60, 7
s_mul_i32 s45, s40, s44
v_mfma_f32_16x16x32_bf16 v[180:183], a[96:99], v[56:59], v[180:183]
ds_read_b64_tr_b16 v[86:87], v12 offset:12800
v_mfma_f32_16x16x32_bf16 v[180:183], a[100:103], v[60:63], v[180:183]
s_lshl_b32 s45, s45, 5
s_add_u32 s45, s45, s60
v_mfma_f32_16x16x32_bf16 v[184:187], a[160:163], v[56:59], v[184:187]
ds_read_b64_tr_b16 v[88:89], v13 offset:8192
v_mfma_f32_16x16x32_bf16 v[184:187], a[164:167], v[60:63], v[184:187]
v_mfma_f32_16x16x32_bf16 v[188:191], a[224:227], v[56:59], v[188:191]
ds_read_b64_tr_b16 v[90:91], v13 offset:8704
v_mfma_f32_16x16x32_bf16 v[188:191], a[228:231], v[60:63], v[188:191]
s_waitcnt lgkmcnt(6)
v_mfma_f32_16x16x32_bf16 v[192:195], a[32:35], v[64:67], v[192:195]
ds_read_b64_tr_b16 v[92:93], v13 offset:12288
v_mfma_f32_16x16x32_bf16 v[192:195], a[36:39], v[68:71], v[192:195]
v_mfma_f32_16x16x32_bf16 v[196:199], a[96:99], v[64:67], v[196:199]
ds_read_b64_tr_b16 v[94:95], v13 offset:12800
v_mfma_f32_16x16x32_bf16 v[196:199], a[100:103], v[68:71], v[196:199]
s_waitcnt vmcnt(20)
s_barrier
v_mfma_f32_16x16x32_bf16 v[200:203], a[160:163], v[64:67], v[200:203]
ds_read_b64_tr_b16 v[32:33], v10 offset:16384
v_mfma_f32_16x16x32_bf16 v[200:203], a[164:167], v[68:71], v[200:203]
s_add_u32 m0, s56, 49152
v_mfma_f32_16x16x32_bf16 v[204:207], a[224:227], v[64:67], v[204:207]
ds_read_b64_tr_b16 v[34:35], v10 offset:16896
v_mfma_f32_16x16x32_bf16 v[204:207], a[228:231], v[68:71], v[204:207]
buffer_load_dwordx4 v2, s[32:35], s95 offen offset:0 lds
v_mfma_f32_16x16x32_bf16 v[208:211], a[32:35], v[72:75], v[208:211]
ds_read_b64_tr_b16 v[36:37], v10 offset:20480
v_mfma_f32_16x16x32_bf16 v[208:211], a[36:39], v[76:79], v[208:211]
buffer_load_dwordx4 v3, s[32:35], s95 offen offset:1024 lds
v_mfma_f32_16x16x32_bf16 v[212:215], a[96:99], v[72:75], v[212:215]
ds_read_b64_tr_b16 v[38:39], v10 offset:20992
v_mfma_f32_16x16x32_bf16 v[212:215], a[100:103], v[76:79], v[212:215]
buffer_load_dwordx4 v4, s[32:35], s95 offen offset:2048 lds
v_mfma_f32_16x16x32_bf16 v[216:219], a[160:163], v[72:75], v[216:219]
ds_read_b64_tr_b16 v[40:41], v11 offset:16384
v_mfma_f32_16x16x32_bf16 v[216:219], a[164:167], v[76:79], v[216:219]
buffer_load_dwordx4 v5, s[32:35], s95 offen offset:3072 lds
v_mfma_f32_16x16x32_bf16 v[220:223], a[224:227], v[72:75], v[220:223]
ds_read_b64_tr_b16 v[42:43], v11 offset:16896
v_mfma_f32_16x16x32_bf16 v[220:223], a[228:231], v[76:79], v[220:223]
s_waitcnt lgkmcnt(6)
v_mfma_f32_16x16x32_bf16 v[224:227], a[32:35], v[80:83], v[224:227]
ds_read_b64_tr_b16 v[44:45], v11 offset:20480
v_mfma_f32_16x16x32_bf16 v[224:227], a[36:39], v[84:87], v[224:227]
s_add_u32 s95, s95, s42
ds_read_b128 a[40:43], v26 offset:0
v_mfma_f32_16x16x32_bf16 v[228:231], a[96:99], v[80:83], v[228:231]
ds_read_b64_tr_b16 v[46:47], v11 offset:20992
v_mfma_f32_16x16x32_bf16 v[228:231], a[100:103], v[84:87], v[228:231]
ds_read_b128 a[104:107], v26 offset:2048
v_mfma_f32_16x16x32_bf16 v[232:235], a[160:163], v[80:83], v[232:235]
ds_read_b64_tr_b16 v[48:49], v12 offset:16384
v_mfma_f32_16x16x32_bf16 v[232:235], a[164:167], v[84:87], v[232:235]
ds_read_b128 a[168:171], v26 offset:4096
v_mfma_f32_16x16x32_bf16 v[236:239], a[224:227], v[80:83], v[236:239]
ds_read_b64_tr_b16 v[50:51], v12 offset:16896
v_mfma_f32_16x16x32_bf16 v[236:239], a[228:231], v[84:87], v[236:239]
ds_read_b128 a[232:235], v26 offset:6144
v_mfma_f32_16x16x32_bf16 v[240:243], a[32:35], v[88:91], v[240:243]
ds_read_b64_tr_b16 v[52:53], v12 offset:20480
v_mfma_f32_16x16x32_bf16 v[240:243], a[36:39], v[92:95], v[240:243]
ds_read_b128 a[44:47], v27 offset:0
v_mfma_f32_16x16x32_bf16 v[244:247], a[96:99], v[88:91], v[244:247]
ds_read_b64_tr_b16 v[54:55], v12 offset:20992
v_mfma_f32_16x16x32_bf16 v[244:247], a[100:103], v[92:95], v[244:247]
ds_read_b128 a[108:111], v27 offset:2048
v_mfma_f32_16x16x32_bf16 v[248:251], a[160:163], v[88:91], v[248:251]
ds_read_b64_tr_b16 v[56:57], v13 offset:16384
v_mfma_f32_16x16x32_bf16 v[248:251], a[164:167], v[92:95], v[248:251]
ds_read_b128 a[172:175], v27 offset:4096
ds_read_b128 a[236:239], v27 offset:6144
v_mfma_f32_16x16x32_bf16 v[252:255], a[224:227], v[88:91], v[252:255]
ds_read_b64_tr_b16 v[58:59], v13 offset:16896
v_mfma_f32_16x16x32_bf16 v[252:255], a[228:231], v[92:95], v[252:255]
s_waitcnt lgkmcnt(1)
v_mfma_f32_16x16x32_bf16 v[128:131], a[40:43], v[32:35], v[128:131]
ds_read_b64_tr_b16 v[60:61], v13 offset:20480
v_mfma_f32_16x16x32_bf16 v[128:131], a[44:47], v[36:39], v[128:131]
v_mfma_f32_16x16x32_bf16 v[132:135], a[104:107], v[32:35], v[132:135]
ds_read_b64_tr_b16 v[62:63], v13 offset:20992
v_mfma_f32_16x16x32_bf16 v[132:135], a[108:111], v[36:39], v[132:135]
v_mfma_f32_16x16x32_bf16 v[136:139], a[168:171], v[32:35], v[136:139]
ds_read_b64_tr_b16 v[64:65], v10 offset:24576
v_mfma_f32_16x16x32_bf16 v[136:139], a[172:175], v[36:39], v[136:139]
v_mfma_f32_16x16x32_bf16 v[140:143], a[232:235], v[32:35], v[140:143]
ds_read_b64_tr_b16 v[66:67], v10 offset:25088
v_mfma_f32_16x16x32_bf16 v[140:143], a[236:239], v[36:39], v[140:143]
v_mfma_f32_16x16x32_bf16 v[144:147], a[40:43], v[40:43], v[144:147]
ds_read_b64_tr_b16 v[68:69], v10 offset:28672
v_mfma_f32_16x16x32_bf16 v[144:147], a[44:47], v[44:47], v[144:147]
v_mfma_f32_16x16x32_bf16 v[148:151], a[104:107], v[40:43], v[148:151]
ds_read_b64_tr_b16 v[70:71], v10 offset:29184
v_mfma_f32_16x16x32_bf16 v[148:151], a[108:111], v[44:47], v[148:151]
v_mfma_f32_16x16x32_bf16 v[152:155], a[168:171], v[40:43], v[152:155]
ds_read_b64_tr_b16 v[72:73], v11 offset:24576
v_mfma_f32_16x16x32_bf16 v[152:155], a[172:175], v[44:47], v[152:155]
v_mfma_f32_16x16x32_bf16 v[156:159], a[232:235], v[40:43], v[156:159]
ds_read_b64_tr_b16 v[74:75], v11 offset:25088
v_mfma_f32_16x16x32_bf16 v[156:159], a[236:239], v[44:47], v[156:159]
s_waitcnt lgkmcnt(6)
v_mfma_f32_16x16x32_bf16 v[160:163], a[40:43], v[48:51], v[160:163]
ds_read_b64_tr_b16 v[76:77], v11 offset:28672
v_mfma_f32_16x16x32_bf16 v[160:163], a[44:47], v[52:55], v[160:163]
v_mfma_f32_16x16x32_bf16 v[164:167], a[104:107], v[48:51], v[164:167]
ds_read_b64_tr_b16 v[78:79], v11 offset:29184
v_mfma_f32_16x16x32_bf16 v[164:167], a[108:111], v[52:55], v[164:167]
v_mfma_f32_16x16x32_bf16 v[168:171], a[168:171], v[48:51], v[168:171]
ds_read_b64_tr_b16 v[80:81], v12 offset:24576
v_mfma_f32_16x16x32_bf16 v[168:171], a[172:175], v[52:55], v[168:171]
v_mfma_f32_16x16x32_bf16 v[172:175], a[232:235], v[48:51], v[172:175]
ds_read_b64_tr_b16 v[82:83], v12 offset:25088
v_mfma_f32_16x16x32_bf16 v[172:175], a[236:239], v[52:55], v[172:175]
v_mfma_f32_16x16x32_bf16 v[176:179], a[40:43], v[56:59], v[176:179]
ds_read_b64_tr_b16 v[84:85], v12 offset:28672
v_mfma_f32_16x16x32_bf16 v[176:179], a[44:47], v[60:63], v[176:179]
v_mfma_f32_16x16x32_bf16 v[180:183], a[104:107], v[56:59], v[180:183]
ds_read_b64_tr_b16 v[86:87], v12 offset:29184
v_mfma_f32_16x16x32_bf16 v[180:183], a[108:111], v[60:63], v[180:183]
v_mfma_f32_16x16x32_bf16 v[184:187], a[168:171], v[56:59], v[184:187]
ds_read_b64_tr_b16 v[88:89], v13 offset:24576
v_mfma_f32_16x16x32_bf16 v[184:187], a[172:175], v[60:63], v[184:187]
v_mfma_f32_16x16x32_bf16 v[188:191], a[232:235], v[56:59], v[188:191]
ds_read_b64_tr_b16 v[90:91], v13 offset:25088
v_mfma_f32_16x16x32_bf16 v[188:191], a[236:239], v[60:63], v[188:191]
s_waitcnt lgkmcnt(6)
v_mfma_f32_16x16x32_bf16 v[192:195], a[40:43], v[64:67], v[192:195]
ds_read_b64_tr_b16 v[92:93], v13 offset:28672
v_mfma_f32_16x16x32_bf16 v[192:195], a[44:47], v[68:71], v[192:195]
v_mfma_f32_16x16x32_bf16 v[196:199], a[104:107], v[64:67], v[196:199]
ds_read_b64_tr_b16 v[94:95], v13 offset:29184
v_mfma_f32_16x16x32_bf16 v[196:199], a[108:111], v[68:71], v[196:199]
s_waitcnt vmcnt(12)
s_barrier
v_mfma_f32_16x16x32_bf16 v[200:203], a[168:171], v[64:67], v[200:203]
ds_read_b64_tr_b16 v[32:33], v10 offset:32768
v_mfma_f32_16x16x32_bf16 v[200:203], a[172:175], v[68:71], v[200:203]
s_add_u32 m0, s56, 65536
v_mfma_f32_16x16x32_bf16 v[204:207], a[232:235], v[64:67], v[204:207]
ds_read_b64_tr_b16 v[34:35], v10 offset:33280
v_mfma_f32_16x16x32_bf16 v[204:207], a[236:239], v[68:71], v[204:207]
buffer_load_dwordx4 v2, s[32:35], s45 offen offset:0 lds
v_mfma_f32_16x16x32_bf16 v[208:211], a[40:43], v[72:75], v[208:211]
ds_read_b64_tr_b16 v[36:37], v10 offset:36864
v_mfma_f32_16x16x32_bf16 v[208:211], a[44:47], v[76:79], v[208:211]
buffer_load_dwordx4 v3, s[32:35], s45 offen offset:1024 lds
v_mfma_f32_16x16x32_bf16 v[212:215], a[104:107], v[72:75], v[212:215]
ds_read_b64_tr_b16 v[38:39], v10 offset:37376
v_mfma_f32_16x16x32_bf16 v[212:215], a[108:111], v[76:79], v[212:215]
buffer_load_dwordx4 v4, s[32:35], s45 offen offset:2048 lds
v_mfma_f32_16x16x32_bf16 v[216:219], a[168:171], v[72:75], v[216:219]
ds_read_b64_tr_b16 v[40:41], v11 offset:32768
v_mfma_f32_16x16x32_bf16 v[216:219], a[172:175], v[76:79], v[216:219]
buffer_load_dwordx4 v5, s[32:35], s45 offen offset:3072 lds
s_add_u32 s45, s45, s46
v_mfma_f32_16x16x32_bf16 v[220:223], a[232:235], v[72:75], v[220:223]
ds_read_b64_tr_b16 v[42:43], v11 offset:33280
v_mfma_f32_16x16x32_bf16 v[220:223], a[236:239], v[76:79], v[220:223]
s_waitcnt lgkmcnt(6)
v_mfma_f32_16x16x32_bf16 v[224:227], a[40:43], v[80:83], v[224:227]
ds_read_b64_tr_b16 v[44:45], v11 offset:36864
v_mfma_f32_16x16x32_bf16 v[224:227], a[44:47], v[84:87], v[224:227]
ds_read_b128 a[48:51], v14 offset:0
v_mfma_f32_16x16x32_bf16 v[228:231], a[104:107], v[80:83], v[228:231]
ds_read_b64_tr_b16 v[46:47], v11 offset:37376
v_mfma_f32_16x16x32_bf16 v[228:231], a[108:111], v[84:87], v[228:231]
ds_read_b128 a[112:115], v14 offset:2048
v_mfma_f32_16x16x32_bf16 v[232:235], a[168:171], v[80:83], v[232:235]
ds_read_b64_tr_b16 v[48:49], v12 offset:32768
v_mfma_f32_16x16x32_bf16 v[232:235], a[172:175], v[84:87], v[232:235]
ds_read_b128 a[176:179], v14 offset:4096
v_mfma_f32_16x16x32_bf16 v[236:239], a[232:235], v[80:83], v[236:239]
ds_read_b64_tr_b16 v[50:51], v12 offset:33280
v_mfma_f32_16x16x32_bf16 v[236:239], a[236:239], v[84:87], v[236:239]
ds_read_b128 a[240:243], v14 offset:6144
v_mfma_f32_16x16x32_bf16 v[240:243], a[40:43], v[88:91], v[240:243]
ds_read_b64_tr_b16 v[52:53], v12 offset:36864
v_mfma_f32_16x16x32_bf16 v[240:243], a[44:47], v[92:95], v[240:243]
ds_read_b128 a[52:55], v15 offset:0
v_mfma_f32_16x16x32_bf16 v[244:247], a[104:107], v[88:91], v[244:247]
ds_read_b64_tr_b16 v[54:55], v12 offset:37376
v_mfma_f32_16x16x32_bf16 v[244:247], a[108:111], v[92:95], v[244:247]
ds_read_b128 a[116:119], v15 offset:2048
v_mfma_f32_16x16x32_bf16 v[248:251], a[168:171], v[88:91], v[248:251]
ds_read_b64_tr_b16 v[56:57], v13 offset:32768
v_mfma_f32_16x16x32_bf16 v[248:251], a[172:175], v[92:95], v[248:251]
ds_read_b128 a[180:183], v15 offset:4096
ds_read_b128 a[244:247], v15 offset:6144
v_mfma_f32_16x16x32_bf16 v[252:255], a[232:235], v[88:91], v[252:255]
ds_read_b64_tr_b16 v[58:59], v13 offset:33280
v_mfma_f32_16x16x32_bf16 v[252:255], a[236:239], v[92:95], v[252:255]
s_waitcnt lgkmcnt(1)
v_mfma_f32_16x16x32_bf16 v[128:131], a[48:51], v[32:35], v[128:131]
ds_read_b64_tr_b16 v[60:61], v13 offset:36864
v_mfma_f32_16x16x32_bf16 v[128:131], a[52:55], v[36:39], v[128:131]
s_add_u32 m0, s56, 81920
v_mfma_f32_16x16x32_bf16 v[132:135], a[112:115], v[32:35], v[132:135]
ds_read_b64_tr_b16 v[62:63], v13 offset:37376
v_mfma_f32_16x16x32_bf16 v[132:135], a[116:119], v[36:39], v[132:135]
buffer_load_dwordx4 v2, s[32:35], s45 offen offset:0 lds
v_mfma_f32_16x16x32_bf16 v[136:139], a[176:179], v[32:35], v[136:139]
ds_read_b64_tr_b16 v[64:65], v10 offset:40960
v_mfma_f32_16x16x32_bf16 v[136:139], a[180:183], v[36:39], v[136:139]
buffer_load_dwordx4 v3, s[32:35], s45 offen offset:1024 lds
v_mfma_f32_16x16x32_bf16 v[140:143], a[240:243], v[32:35], v[140:143]
ds_read_b64_tr_b16 v[66:67], v10 offset:41472
v_mfma_f32_16x16x32_bf16 v[140:143], a[244:247], v[36:39], v[140:143]
buffer_load_dwordx4 v4, s[32:35], s45 offen offset:2048 lds
v_mfma_f32_16x16x32_bf16 v[144:147], a[48:51], v[40:43], v[144:147]
ds_read_b64_tr_b16 v[68:69], v10 offset:45056
v_mfma_f32_16x16x32_bf16 v[144:147], a[52:55], v[44:47], v[144:147]
buffer_load_dwordx4 v5, s[32:35], s45 offen offset:3072 lds
v_mfma_f32_16x16x32_bf16 v[148:151], a[112:115], v[40:43], v[148:151]
ds_read_b64_tr_b16 v[70:71], v10 offset:45568
v_mfma_f32_16x16x32_bf16 v[148:151], a[116:119], v[44:47], v[148:151]
s_add_u32 s45, s45, s46
v_mfma_f32_16x16x32_bf16 v[152:155], a[176:179], v[40:43], v[152:155]
ds_read_b64_tr_b16 v[72:73], v11 offset:40960
v_mfma_f32_16x16x32_bf16 v[152:155], a[180:183], v[44:47], v[152:155]
v_mfma_f32_16x16x32_bf16 v[156:159], a[240:243], v[40:43], v[156:159]
ds_read_b64_tr_b16 v[74:75], v11 offset:41472
v_mfma_f32_16x16x32_bf16 v[156:159], a[244:247], v[44:47], v[156:159]
s_waitcnt lgkmcnt(6)
v_mfma_f32_16x16x32_bf16 v[160:163], a[48:51], v[48:51], v[160:163]
ds_read_b64_tr_b16 v[76:77], v11 offset:45056
v_mfma_f32_16x16x32_bf16 v[160:163], a[52:55], v[52:55], v[160:163]
v_mfma_f32_16x16x32_bf16 v[164:167], a[112:115], v[48:51], v[164:167]
ds_read_b64_tr_b16 v[78:79], v11 offset:45568
v_mfma_f32_16x16x32_bf16 v[164:167], a[116:119], v[52:55], v[164:167]
s_add_u32 m0, s56, 0
v_mfma_f32_16x16x32_bf16 v[168:171], a[176:179], v[48:51], v[168:171]
ds_read_b64_tr_b16 v[80:81], v12 offset:40960
v_mfma_f32_16x16x32_bf16 v[168:171], a[180:183], v[52:55], v[168:171]
buffer_load_dwordx4 v2, s[32:35], s45 offen offset:0 lds
v_mfma_f32_16x16x32_bf16 v[172:175], a[240:243], v[48:51], v[172:175]
ds_read_b64_tr_b16 v[82:83], v12 offset:41472
v_mfma_f32_16x16x32_bf16 v[172:175], a[244:247], v[52:55], v[172:175]
buffer_load_dwordx4 v3, s[32:35], s45 offen offset:1024 lds
v_mfma_f32_16x16x32_bf16 v[176:179], a[48:51], v[56:59], v[176:179]
ds_read_b64_tr_b16 v[84:85], v12 offset:45056
v_mfma_f32_16x16x32_bf16 v[176:179], a[52:55], v[60:63], v[176:179]
buffer_load_dwordx4 v4, s[32:35], s45 offen offset:2048 lds
v_mfma_f32_16x16x32_bf16 v[180:183], a[112:115], v[56:59], v[180:183]
ds_read_b64_tr_b16 v[86:87], v12 offset:45568
v_mfma_f32_16x16x32_bf16 v[180:183], a[116:119], v[60:63], v[180:183]
buffer_load_dwordx4 v5, s[32:35], s45 offen offset:3072 lds
v_mfma_f32_16x16x32_bf16 v[184:187], a[176:179], v[56:59], v[184:187]
ds_read_b64_tr_b16 v[88:89], v13 offset:40960
v_mfma_f32_16x16x32_bf16 v[184:187], a[180:183], v[60:63], v[184:187]
s_add_u32 s45, s45, s46
v_mfma_f32_16x16x32_bf16 v[188:191], a[240:243], v[56:59], v[188:191]
ds_read_b64_tr_b16 v[90:91], v13 offset:41472
v_mfma_f32_16x16x32_bf16 v[188:191], a[244:247], v[60:63], v[188:191]
s_waitcnt lgkmcnt(6)
v_mfma_f32_16x16x32_bf16 v[192:195], a[48:51], v[64:67], v[192:195]
ds_read_b64_tr_b16 v[92:93], v13 offset:45056
v_mfma_f32_16x16x32_bf16 v[192:195], a[52:55], v[68:71], v[192:195]
v_mfma_f32_16x16x32_bf16 v[196:199], a[112:115], v[64:67], v[196:199]
ds_read_b64_tr_b16 v[94:95], v13 offset:45568
v_mfma_f32_16x16x32_bf16 v[196:199], a[116:119], v[68:71], v[196:199]
s_waitcnt vmcnt(12)
s_barrier
v_mfma_f32_16x16x32_bf16 v[200:203], a[176:179], v[64:67], v[200:203]
ds_read_b64_tr_b16 v[32:33], v10 offset:49152
v_mfma_f32_16x16x32_bf16 v[200:203], a[180:183], v[68:71], v[200:203]
s_add_u32 m0, s56, 16384
v_mfma_f32_16x16x32_bf16 v[204:207], a[240:243], v[64:67], v[204:207]
ds_read_b64_tr_b16 v[34:35], v10 offset:49664
v_mfma_f32_16x16x32_bf16 v[204:207], a[244:247], v[68:71], v[204:207]
buffer_load_dwordx4 v2, s[32:35], s45 offen offset:0 lds
v_mfma_f32_16x16x32_bf16 v[208:211], a[48:51], v[72:75], v[208:211]
ds_read_b64_tr_b16 v[36:37], v10 offset:53248
v_mfma_f32_16x16x32_bf16 v[208:211], a[52:55], v[76:79], v[208:211]
buffer_load_dwordx4 v3, s[32:35], s45 offen offset:1024 lds
v_mfma_f32_16x16x32_bf16 v[212:215], a[112:115], v[72:75], v[212:215]
ds_read_b64_tr_b16 v[38:39], v10 offset:53760
v_mfma_f32_16x16x32_bf16 v[212:215], a[116:119], v[76:79], v[212:215]
buffer_load_dwordx4 v4, s[32:35], s45 offen offset:2048 lds
v_mfma_f32_16x16x32_bf16 v[216:219], a[176:179], v[72:75], v[216:219]
ds_read_b64_tr_b16 v[40:41], v11 offset:49152
v_mfma_f32_16x16x32_bf16 v[216:219], a[180:183], v[76:79], v[216:219]
buffer_load_dwordx4 v5, s[32:35], s45 offen offset:3072 lds
v_mfma_f32_16x16x32_bf16 v[220:223], a[240:243], v[72:75], v[220:223]
ds_read_b64_tr_b16 v[42:43], v11 offset:49664
v_mfma_f32_16x16x32_bf16 v[220:223], a[244:247], v[76:79], v[220:223]
s_waitcnt lgkmcnt(6)
v_mfma_f32_16x16x32_bf16 v[224:227], a[48:51], v[80:83], v[224:227]
ds_read_b64_tr_b16 v[44:45], v11 offset:53248
v_mfma_f32_16x16x32_bf16 v[224:227], a[52:55], v[84:87], v[224:227]
ds_read_b128 a[56:59], v14 offset:8192
v_mfma_f32_16x16x32_bf16 v[228:231], a[112:115], v[80:83], v[228:231]
ds_read_b64_tr_b16 v[46:47], v11 offset:53760
v_mfma_f32_16x16x32_bf16 v[228:231], a[116:119], v[84:87], v[228:231]
ds_read_b128 a[120:123], v14 offset:10240
v_mfma_f32_16x16x32_bf16 v[232:235], a[176:179], v[80:83], v[232:235]
ds_read_b64_tr_b16 v[48:49], v12 offset:49152
v_mfma_f32_16x16x32_bf16 v[232:235], a[180:183], v[84:87], v[232:235]
ds_read_b128 a[184:187], v14 offset:12288
v_mfma_f32_16x16x32_bf16 v[236:239], a[240:243], v[80:83], v[236:239]
ds_read_b64_tr_b16 v[50:51], v12 offset:49664
v_mfma_f32_16x16x32_bf16 v[236:239], a[244:247], v[84:87], v[236:239]
ds_read_b128 a[248:251], v14 offset:14336
v_mfma_f32_16x16x32_bf16 v[240:243], a[48:51], v[88:91], v[240:243]
ds_read_b64_tr_b16 v[52:53], v12 offset:53248
v_mfma_f32_16x16x32_bf16 v[240:243], a[52:55], v[92:95], v[240:243]
ds_read_b128 a[60:63], v15 offset:8192
v_mfma_f32_16x16x32_bf16 v[244:247], a[112:115], v[88:91], v[244:247]
ds_read_b64_tr_b16 v[54:55], v12 offset:53760
v_mfma_f32_16x16x32_bf16 v[244:247], a[116:119], v[92:95], v[244:247]
ds_read_b128 a[124:127], v15 offset:10240
v_mfma_f32_16x16x32_bf16 v[248:251], a[176:179], v[88:91], v[248:251]
ds_read_b64_tr_b16 v[56:57], v13 offset:49152
v_mfma_f32_16x16x32_bf16 v[248:251], a[180:183], v[92:95], v[248:251]
ds_read_b128 a[188:191], v15 offset:12288
ds_read_b128 a[252:255], v15 offset:14336
v_mfma_f32_16x16x32_bf16 v[252:255], a[240:243], v[88:91], v[252:255]
ds_read_b64_tr_b16 v[58:59], v13 offset:49664
v_mfma_f32_16x16x32_bf16 v[252:255], a[244:247], v[92:95], v[252:255]
s_waitcnt lgkmcnt(1)
v_mfma_f32_16x16x32_bf16 v[128:131], a[56:59], v[32:35], v[128:131]
ds_read_b64_tr_b16 v[60:61], v13 offset:53248
v_mfma_f32_16x16x32_bf16 v[128:131], a[60:63], v[36:39], v[128:131]
s_add_u32 s60, s62, 3
s_and_b32 s60, s60, 63
v_mfma_f32_16x16x32_bf16 v[132:135], a[120:123], v[32:35], v[132:135]
ds_read_b64_tr_b16 v[62:63], v13 offset:53760
v_mfma_f32_16x16x32_bf16 v[132:135], a[124:127], v[36:39], v[132:135]
s_lshl_b32 s60, s60, 7
s_mul_i32 s45, s40, s44
v_mfma_f32_16x16x32_bf16 v[136:139], a[184:187], v[32:35], v[136:139]
ds_read_b64_tr_b16 v[64:65], v10 offset:57344
v_mfma_f32_16x16x32_bf16 v[136:139], a[188:191], v[36:39], v[136:139]
s_lshl_b32 s45, s45, 5
s_add_u32 s45, s45, s60
v_mfma_f32_16x16x32_bf16 v[140:143], a[248:251], v[32:35], v[140:143]
ds_read_b64_tr_b16 v[66:67], v10 offset:57856
v_mfma_f32_16x16x32_bf16 v[140:143], a[252:255], v[36:39], v[140:143]
v_mfma_f32_16x16x32_bf16 v[144:147], a[56:59], v[40:43], v[144:147]
ds_read_b64_tr_b16 v[68:69], v10 offset:61440
v_mfma_f32_16x16x32_bf16 v[144:147], a[60:63], v[44:47], v[144:147]
v_mfma_f32_16x16x32_bf16 v[148:151], a[120:123], v[40:43], v[148:151]
ds_read_b64_tr_b16 v[70:71], v10 offset:61952
v_mfma_f32_16x16x32_bf16 v[148:151], a[124:127], v[44:47], v[148:151]
s_mov_b32 s52, s50
s_mov_b32 s58, s51
v_mfma_f32_16x16x32_bf16 v[152:155], a[184:187], v[40:43], v[152:155]
ds_read_b64_tr_b16 v[72:73], v11 offset:57344
v_mfma_f32_16x16x32_bf16 v[152:155], a[188:191], v[44:47], v[152:155]
v_mfma_f32_16x16x32_bf16 v[156:159], a[248:251], v[40:43], v[156:159]
ds_read_b64_tr_b16 v[74:75], v11 offset:57856
v_mfma_f32_16x16x32_bf16 v[156:159], a[252:255], v[44:47], v[156:159]
s_waitcnt lgkmcnt(6)
v_mfma_f32_16x16x32_bf16 v[160:163], a[56:59], v[48:51], v[160:163]
ds_read_b64_tr_b16 v[76:77], v11 offset:61440
v_mfma_f32_16x16x32_bf16 v[160:163], a[60:63], v[52:55], v[160:163]
s_add_u32 s41, s41, 1
s_sub_u32 s43, s43, 1
s_lshr_b32 s60, s41, 1
v_mfma_f32_16x16x32_bf16 v[164:167], a[120:123], v[48:51], v[164:167]
ds_read_b64_tr_b16 v[78:79], v11 offset:61952
v_mfma_f32_16x16x32_bf16 v[164:167], a[124:127], v[52:55], v[164:167]
s_lshl_b32 s60, s60, 19
s_and_b32 s61, s41, 1
s_lshl_b32 s61, s61, 12
v_mfma_f32_16x16x32_bf16 v[168:171], a[184:187], v[48:51], v[168:171]
ds_read_b64_tr_b16 v[80:81], v12 offset:57344
v_mfma_f32_16x16x32_bf16 v[168:171], a[188:191], v[52:55], v[168:171]
s_add_u32 s60, s60, s61
s_lshl_b32 s61, s54, 13
s_add_u32 s50, s60, s61
v_mfma_f32_16x16x32_bf16 v[172:175], a[248:251], v[48:51], v[172:175]
ds_read_b64_tr_b16 v[82:83], v12 offset:57856
v_mfma_f32_16x16x32_bf16 v[172:175], a[252:255], v[52:55], v[172:175]
s_add_u32 s51, s50, 8192
s_cmp_ge_u32 s41, 64
s_cselect_b32 s53, 1, 0
s_sub_u32 s60, s41, 128
v_mfma_f32_16x16x32_bf16 v[176:179], a[56:59], v[56:59], v[176:179]
ds_read_b64_tr_b16 v[84:85], v12 offset:61440
v_mfma_f32_16x16x32_bf16 v[176:179], a[60:63], v[60:63], v[176:179]
s_cmp_lt_u32 s60, 16
s_cselect_b32 s53, 0, s53
v_mfma_f32_16x16x32_bf16 v[180:183], a[120:123], v[56:59], v[180:183]
ds_read_b64_tr_b16 v[86:87], v12 offset:61952
v_mfma_f32_16x16x32_bf16 v[180:183], a[124:127], v[60:63], v[180:183]
v_mfma_f32_16x16x32_bf16 v[184:187], a[184:187], v[56:59], v[184:187]
ds_read_b64_tr_b16 v[88:89], v13 offset:57344
v_mfma_f32_16x16x32_bf16 v[184:187], a[188:191], v[60:63], v[184:187]
v_mfma_f32_16x16x32_bf16 v[188:191], a[248:251], v[56:59], v[188:191]
ds_read_b64_tr_b16 v[90:91], v13 offset:57856
v_mfma_f32_16x16x32_bf16 v[188:191], a[252:255], v[60:63], v[188:191]
s_waitcnt lgkmcnt(6)
v_mfma_f32_16x16x32_bf16 v[192:195], a[56:59], v[64:67], v[192:195]
ds_read_b64_tr_b16 v[92:93], v13 offset:61440
v_mfma_f32_16x16x32_bf16 v[192:195], a[60:63], v[68:71], v[192:195]
v_mfma_f32_16x16x32_bf16 v[196:199], a[120:123], v[64:67], v[196:199]
ds_read_b64_tr_b16 v[94:95], v13 offset:61952
v_mfma_f32_16x16x32_bf16 v[196:199], a[124:127], v[68:71], v[196:199]
s_waitcnt vmcnt(12)
s_barrier
v_mfma_f32_16x16x32_bf16 v[200:203], a[184:187], v[64:67], v[200:203]
ds_read_b64_tr_b16 v[32:33], v18 offset:0
v_mfma_f32_16x16x32_bf16 v[200:203], a[188:191], v[68:71], v[200:203]
v_cvt_pk_bf16_f32 v96, v128, v129
v_cvt_pk_bf16_f32 v97, v130, v131
v_mfma_f32_16x16x32_bf16 v[204:207], a[248:251], v[64:67], v[204:207]
ds_read_b64_tr_b16 v[34:35], v18 offset:512
v_cvt_pk_bf16_f32 v98, v132, v133
v_cvt_pk_bf16_f32 v99, v134, v135
v_mfma_f32_16x16x32_bf16 v[204:207], a[252:255], v[68:71], v[204:207]
buffer_store_dwordx4 v[96:99], v16, s[36:39], s47 offen offset:0 sc1
v_mfma_f32_16x16x32_bf16 v[208:211], a[56:59], v[72:75], v[208:211]
ds_read_b64_tr_b16 v[36:37], v18 offset:4096
v_cvt_pk_bf16_f32 v100, v144, v145
v_cvt_pk_bf16_f32 v101, v146, v147
v_mfma_f32_16x16x32_bf16 v[208:211], a[60:63], v[76:79], v[208:211]
v_cvt_pk_bf16_f32 v102, v148, v149
v_cvt_pk_bf16_f32 v103, v150, v151
v_mfma_f32_16x16x32_bf16 v[212:215], a[120:123], v[72:75], v[212:215]
ds_read_b64_tr_b16 v[38:39], v18 offset:4608
buffer_store_dwordx4 v[100:103], v16, s[36:39], s47 offen offset:1024 sc1
v_mfma_f32_16x16x32_bf16 v[212:215], a[124:127], v[76:79], v[212:215]
v_cvt_pk_bf16_f32 v104, v160, v161
v_cvt_pk_bf16_f32 v105, v162, v163
v_mfma_f32_16x16x32_bf16 v[216:219], a[184:187], v[72:75], v[216:219]
ds_read_b64_tr_b16 v[40:41], v18 offset:8192
v_cvt_pk_bf16_f32 v106, v164, v165
v_cvt_pk_bf16_f32 v107, v166, v167
v_mfma_f32_16x16x32_bf16 v[216:219], a[188:191], v[76:79], v[216:219]
buffer_store_dwordx4 v[104:107], v16, s[36:39], s47 offen offset:2048 sc1
v_mfma_f32_16x16x32_bf16 v[220:223], a[248:251], v[72:75], v[220:223]
ds_read_b64_tr_b16 v[42:43], v18 offset:8704
v_cvt_pk_bf16_f32 v108, v176, v177
v_cvt_pk_bf16_f32 v109, v178, v179
v_mfma_f32_16x16x32_bf16 v[220:223], a[252:255], v[76:79], v[220:223]
s_waitcnt lgkmcnt(6)
v_cvt_pk_bf16_f32 v110, v180, v181
v_cvt_pk_bf16_f32 v111, v182, v183
v_mfma_f32_16x16x32_bf16 v[224:227], a[56:59], v[80:83], v[224:227]
ds_read_b64_tr_b16 v[44:45], v18 offset:12288
buffer_store_dwordx4 v[108:111], v16, s[36:39], s47 offen offset:3072 sc1
v_mfma_f32_16x16x32_bf16 v[224:227], a[60:63], v[84:87], v[224:227]
v_cvt_pk_bf16_f32 v96, v136, v137
v_cvt_pk_bf16_f32 v97, v138, v139
v_mfma_f32_16x16x32_bf16 v[228:231], a[120:123], v[80:83], v[228:231]
ds_read_b64_tr_b16 v[46:47], v18 offset:12800
v_cvt_pk_bf16_f32 v98, v140, v141
v_cvt_pk_bf16_f32 v99, v142, v143
v_mfma_f32_16x16x32_bf16 v[228:231], a[124:127], v[84:87], v[228:231]
buffer_store_dwordx4 v[96:99], v16, s[36:39], s48 offen offset:0 sc1
v_mfma_f32_16x16x32_bf16 v[232:235], a[184:187], v[80:83], v[232:235]
ds_read_b64_tr_b16 v[48:49], v19 offset:0
v_cvt_pk_bf16_f32 v100, v152, v153
v_cvt_pk_bf16_f32 v101, v154, v155
v_mfma_f32_16x16x32_bf16 v[232:235], a[188:191], v[84:87], v[232:235]
v_cvt_pk_bf16_f32 v102, v156, v157
v_cvt_pk_bf16_f32 v103, v158, v159
v_mfma_f32_16x16x32_bf16 v[236:239], a[248:251], v[80:83], v[236:239]
ds_read_b64_tr_b16 v[50:51], v19 offset:512
buffer_store_dwordx4 v[100:103], v16, s[36:39], s48 offen offset:1024 sc1
v_mfma_f32_16x16x32_bf16 v[236:239], a[252:255], v[84:87], v[236:239]
v_cvt_pk_bf16_f32 v104, v168, v169
v_cvt_pk_bf16_f32 v105, v170, v171
v_mfma_f32_16x16x32_bf16 v[240:243], a[56:59], v[88:91], v[240:243]
ds_read_b64_tr_b16 v[52:53], v19 offset:4096
v_cvt_pk_bf16_f32 v106, v172, v173
v_cvt_pk_bf16_f32 v107, v174, v175
v_mfma_f32_16x16x32_bf16 v[240:243], a[60:63], v[92:95], v[240:243]
buffer_store_dwordx4 v[104:107], v16, s[36:39], s48 offen offset:2048 sc1
v_mfma_f32_16x16x32_bf16 v[244:247], a[120:123], v[88:91], v[244:247]
ds_read_b64_tr_b16 v[54:55], v19 offset:4608
v_cvt_pk_bf16_f32 v108, v184, v185
v_cvt_pk_bf16_f32 v109, v186, v187
v_mfma_f32_16x16x32_bf16 v[244:247], a[124:127], v[92:95], v[244:247]
v_cvt_pk_bf16_f32 v110, v188, v189
v_cvt_pk_bf16_f32 v111, v190, v191
v_mfma_f32_16x16x32_bf16 v[248:251], a[184:187], v[88:91], v[248:251]
ds_read_b64_tr_b16 v[56:57], v19 offset:8192
buffer_store_dwordx4 v[108:111], v16, s[36:39], s48 offen offset:3072 sc1
v_mfma_f32_16x16x32_bf16 v[248:251], a[188:191], v[92:95], v[248:251]
v_mfma_f32_16x16x32_bf16 v[252:255], a[248:251], v[88:91], v[252:255]
ds_read_b64_tr_b16 v[58:59], v19 offset:8704
v_mfma_f32_16x16x32_bf16 v[252:255], a[252:255], v[92:95], v[252:255]
s_mov_b32 s47, s52
s_mov_b32 s48, s58
K1_P1:
s_waitcnt lgkmcnt(6)
v_mfma_f32_16x16x32_bf16 v[128:131], a[0:3], v[32:35], 0
ds_read_b64_tr_b16 v[60:61], v19 offset:12288
v_mfma_f32_16x16x32_bf16 v[128:131], a[4:7], v[36:39], v[128:131]
s_add_u32 m0, s56, 98304
v_mfma_f32_16x16x32_bf16 v[128:131], a[8:11], v[40:43], v[128:131]
ds_read_b64_tr_b16 v[62:63], v19 offset:12800
v_mfma_f32_16x16x32_bf16 v[128:131], a[12:15], v[44:47], v[128:131]
buffer_load_dwordx4 v2, s[32:35], s45 offen offset:0 lds
v_mfma_f32_16x16x32_bf16 v[132:135], a[64:67], v[32:35], 0
ds_read_b64_tr_b16 v[64:65], v20 offset:0
v_mfma_f32_16x16x32_bf16 v[132:135], a[68:71], v[36:39], v[132:135]
v_mfma_f32_16x16x32_bf16 v[132:135], a[72:75], v[40:43], v[132:135]
ds_read_b64_tr_b16 v[66:67], v20 offset:512
v_mfma_f32_16x16x32_bf16 v[132:135], a[76:79], v[44:47], v[132:135]
buffer_load_dwordx4 v3, s[32:35], s45 offen offset:1024 lds
v_mfma_f32_16x16x32_bf16 v[136:139], a[128:131], v[32:35], 0
ds_read_b64_tr_b16 v[68:69], v20 offset:4096
v_mfma_f32_16x16x32_bf16 v[136:139], a[132:135], v[36:39], v[136:139]
v_cvt_pk_bf16_f32 v96, v192, v193
v_cvt_pk_bf16_f32 v97, v194, v195
v_mfma_f32_16x16x32_bf16 v[136:139], a[136:139], v[40:43], v[136:139]
ds_read_b64_tr_b16 v[70:71], v20 offset:4608
v_mfma_f32_16x16x32_bf16 v[136:139], a[140:143], v[44:47], v[136:139]
buffer_load_dwordx4 v4, s[32:35], s45 offen offset:2048 lds
v_mfma_f32_16x16x32_bf16 v[140:143], a[192:195], v[32:35], 0
ds_read_b64_tr_b16 v[72:73], v20 offset:8192
v_mfma_f32_16x16x32_bf16 v[140:143], a[196:199], v[36:39], v[140:143]
v_cvt_pk_bf16_f32 v98, v196, v197
v_cvt_pk_bf16_f32 v99, v198, v199
v_mfma_f32_16x16x32_bf16 v[140:143], a[200:203], v[40:43], v[140:143]
ds_read_b64_tr_b16 v[74:75], v20 offset:8704
v_mfma_f32_16x16x32_bf16 v[140:143], a[204:207], v[44:47], v[140:143]
s_waitcnt lgkmcnt(6)
buffer_load_dwordx4 v5, s[32:35], s45 offen offset:3072 lds
v_mfma_f32_16x16x32_bf16 v[144:147], a[0:3], v[48:51], 0
ds_read_b64_tr_b16 v[76:77], v20 offset:12288
v_mfma_f32_16x16x32_bf16 v[144:147], a[4:7], v[52:55], v[144:147]
s_add_u32 m0, s56, 114688
v_cvt_pk_bf16_f32 v100, v208, v209
v_cvt_pk_bf16_f32 v101, v210, v211
v_mfma_f32_16x16x32_bf16 v[144:147], a[8:11], v[56:59], v[144:147]
ds_read_b64_tr_b16 v[78:79], v20 offset:12800
v_mfma_f32_16x16x32_bf16 v[144:147], a[12:15], v[60:63], v[144:147]
buffer_load_dwordx4 v2, s[96:99], s45 offen offset:0 lds
v_mfma_f32_16x16x32_bf16 v[148:151], a[64:67], v[48:51], 0
ds_read_b64_tr_b16 v[80:81], v21 offset:0
v_mfma_f32_16x16x32_bf16 v[148:151], a[68:71], v[52:55], v[148:151]
v_cvt_pk_bf16_f32 v102, v212, v213
v_cvt_pk_bf16_f32 v103, v214, v215
v_mfma_f32_16x16x32_bf16 v[148:151], a[72:75], v[56:59], v[148:151]
ds_read_b64_tr_b16 v[82:83], v21 offset:512
v_mfma_f32_16x16x32_bf16 v[148:151], a[76:79], v[60:63], v[148:151]
buffer_load_dwordx4 v3, s[96:99], s45 offen offset:1024 lds
v_mfma_f32_16x16x32_bf16 v[152:155], a[128:131], v[48:51], 0
ds_read_b64_tr_b16 v[84:85], v21 offset:4096
v_mfma_f32_16x16x32_bf16 v[152:155], a[132:135], v[52:55], v[152:155]
v_mfma_f32_16x16x32_bf16 v[152:155], a[136:139], v[56:59], v[152:155]
ds_read_b64_tr_b16 v[86:87], v21 offset:4608
v_mfma_f32_16x16x32_bf16 v[152:155], a[140:143], v[60:63], v[152:155]
buffer_load_dwordx4 v4, s[96:99], s45 offen offset:2048 lds
v_mfma_f32_16x16x32_bf16 v[156:159], a[192:195], v[48:51], 0
ds_read_b64_tr_b16 v[88:89], v21 offset:8192
v_mfma_f32_16x16x32_bf16 v[156:159], a[196:199], v[52:55], v[156:159]
v_mfma_f32_16x16x32_bf16 v[156:159], a[200:203], v[56:59], v[156:159]
ds_read_b64_tr_b16 v[90:91], v21 offset:8704
v_mfma_f32_16x16x32_bf16 v[156:159], a[204:207], v[60:63], v[156:159]
s_waitcnt lgkmcnt(6)
buffer_load_dwordx4 v5, s[96:99], s45 offen offset:3072 lds
v_mfma_f32_16x16x32_bf16 v[160:163], a[0:3], v[64:67], 0
ds_read_b64_tr_b16 v[92:93], v21 offset:12288
v_mfma_f32_16x16x32_bf16 v[160:163], a[4:7], v[68:71], v[160:163]
s_add_u32 s45, s45, s46
v_mfma_f32_16x16x32_bf16 v[160:163], a[8:11], v[72:75], v[160:163]
ds_read_b64_tr_b16 v[94:95], v21 offset:12800
v_mfma_f32_16x16x32_bf16 v[160:163], a[12:15], v[76:79], v[160:163]
s_waitcnt vmcnt(24)
s_barrier
v_mfma_f32_16x16x32_bf16 v[164:167], a[64:67], v[64:67], 0
ds_read_b64_tr_b16 v[32:33], v18 offset:16384
v_mfma_f32_16x16x32_bf16 v[164:167], a[68:71], v[68:71], v[164:167]
v_mfma_f32_16x16x32_bf16 v[164:167], a[72:75], v[72:75], v[164:167]
ds_read_b64_tr_b16 v[34:35], v18 offset:16896
v_mfma_f32_16x16x32_bf16 v[164:167], a[76:79], v[76:79], v[164:167]
buffer_store_dwordx4 v[96:99], v16, s[36:39], s47 offen offset:0 sc1
v_mfma_f32_16x16x32_bf16 v[168:171], a[128:131], v[64:67], 0
ds_read_b64_tr_b16 v[36:37], v18 offset:20480
v_mfma_f32_16x16x32_bf16 v[168:171], a[132:135], v[68:71], v[168:171]
v_mfma_f32_16x16x32_bf16 v[168:171], a[136:139], v[72:75], v[168:171]
ds_read_b64_tr_b16 v[38:39], v18 offset:20992
v_mfma_f32_16x16x32_bf16 v[168:171], a[140:143], v[76:79], v[168:171]
v_mfma_f32_16x16x32_bf16 v[172:175], a[192:195], v[64:67], 0
ds_read_b64_tr_b16 v[40:41], v18 offset:24576
v_mfma_f32_16x16x32_bf16 v[172:175], a[196:199], v[68:71], v[172:175]
v_mfma_f32_16x16x32_bf16 v[172:175], a[200:203], v[72:75], v[172:175]
ds_read_b64_tr_b16 v[42:43], v18 offset:25088
v_mfma_f32_16x16x32_bf16 v[172:175], a[204:207], v[76:79], v[172:175]
s_waitcnt lgkmcnt(6)
v_mfma_f32_16x16x32_bf16 v[176:179], a[0:3], v[80:83], 0
ds_read_b64_tr_b16 v[44:45], v18 offset:28672
v_mfma_f32_16x16x32_bf16 v[176:179], a[4:7], v[84:87], v[176:179]
v_mfma_f32_16x16x32_bf16 v[176:179], a[8:11], v[88:91], v[176:179]
ds_read_b64_tr_b16 v[46:47], v18 offset:29184
v_mfma_f32_16x16x32_bf16 v[176:179], a[12:15], v[92:95], v[176:179]
v_mfma_f32_16x16x32_bf16 v[180:183], a[64:67], v[80:83], 0
ds_read_b64_tr_b16 v[48:49], v19 offset:16384
v_mfma_f32_16x16x32_bf16 v[180:183], a[68:71], v[84:87], v[180:183]
v_mfma_f32_16x16x32_bf16 v[180:183], a[72:75], v[88:91], v[180:183]
ds_read_b64_tr_b16 v[50:51], v19 offset:16896
v_mfma_f32_16x16x32_bf16 v[180:183], a[76:79], v[92:95], v[180:183]
v_mfma_f32_16x16x32_bf16 v[184:187], a[128:131], v[80:83], 0
ds_read_b64_tr_b16 v[52:53], v19 offset:20480
v_mfma_f32_16x16x32_bf16 v[184:187], a[132:135], v[84:87], v[184:187]
v_mfma_f32_16x16x32_bf16 v[184:187], a[136:139], v[88:91], v[184:187]
ds_read_b64_tr_b16 v[54:55], v19 offset:20992
v_mfma_f32_16x16x32_bf16 v[184:187], a[140:143], v[92:95], v[184:187]
buffer_store_dwordx4 v[100:103], v16, s[36:39], s47 offen offset:1024 sc1
v_mfma_f32_16x16x32_bf16 v[188:191], a[192:195], v[80:83], 0
ds_read_b64_tr_b16 v[56:57], v19 offset:24576
v_mfma_f32_16x16x32_bf16 v[188:191], a[196:199], v[84:87], v[188:191]
v_mfma_f32_16x16x32_bf16 v[188:191], a[200:203], v[88:91], v[188:191]
ds_read_b64_tr_b16 v[58:59], v19 offset:25088
v_mfma_f32_16x16x32_bf16 v[188:191], a[204:207], v[92:95], v[188:191]
s_waitcnt lgkmcnt(6)
v_mfma_f32_16x16x32_bf16 v[128:131], a[16:19], v[32:35], v[128:131]
ds_read_b64_tr_b16 v[60:61], v19 offset:28672
v_mfma_f32_16x16x32_bf16 v[128:131], a[20:23], v[36:39], v[128:131]
s_add_u32 m0, s56, 32768
v_mfma_f32_16x16x32_bf16 v[128:131], a[24:27], v[40:43], v[128:131]
ds_read_b64_tr_b16 v[62:63], v19 offset:29184
v_mfma_f32_16x16x32_bf16 v[128:131], a[28:31], v[44:47], v[128:131]
buffer_load_dwordx4 v2, s[32:35], s45 offen offset:0 lds
v_mfma_f32_16x16x32_bf16 v[132:135], a[80:83], v[32:35], v[132:135]
ds_read_b64_tr_b16 v[64:65], v20 offset:16384
v_mfma_f32_16x16x32_bf16 v[132:135], a[84:87], v[36:39], v[132:135]
v_mfma_f32_16x16x32_bf16 v[132:135], a[88:91], v[40:43], v[132:135]
ds_read_b64_tr_b16 v[66:67], v20 offset:16896
v_mfma_f32_16x16x32_bf16 v[132:135], a[92:95], v[44:47], v[132:135]
buffer_load_dwordx4 v3, s[32:35], s45 offen offset:1024 lds
v_mfma_f32_16x16x32_bf16 v[136:139], a[144:147], v[32:35], v[136:139]
ds_read_b64_tr_b16 v[68:69], v20 offset:20480
v_mfma_f32_16x16x32_bf16 v[136:139], a[148:151], v[36:39], v[136:139]
v_cvt_pk_bf16_f32 v104, v224, v225
v_cvt_pk_bf16_f32 v105, v226, v227
v_mfma_f32_16x16x32_bf16 v[136:139], a[152:155], v[40:43], v[136:139]
ds_read_b64_tr_b16 v[70:71], v20 offset:20992
v_mfma_f32_16x16x32_bf16 v[136:139], a[156:159], v[44:47], v[136:139]
buffer_load_dwordx4 v4, s[32:35], s45 offen offset:2048 lds
v_mfma_f32_16x16x32_bf16 v[140:143], a[208:211], v[32:35], v[140:143]
ds_read_b64_tr_b16 v[72:73], v20 offset:24576
v_mfma_f32_16x16x32_bf16 v[140:143], a[212:215], v[36:39], v[140:143]
v_cvt_pk_bf16_f32 v106, v228, v229
v_cvt_pk_bf16_f32 v107, v230, v231
v_mfma_f32_16x16x32_bf16 v[140:143], a[216:219], v[40:43], v[140:143]
ds_read_b64_tr_b16 v[74:75], v20 offset:25088
v_mfma_f32_16x16x32_bf16 v[140:143], a[220:223], v[44:47], v[140:143]
s_waitcnt lgkmcnt(6)
buffer_load_dwordx4 v5, s[32:35], s45 offen offset:3072 lds
v_mfma_f32_16x16x32_bf16 v[144:147], a[16:19], v[48:51], v[144:147]
ds_read_b64_tr_b16 v[76:77], v20 offset:28672
v_mfma_f32_16x16x32_bf16 v[144:147], a[20:23], v[52:55], v[144:147]
s_add_u32 m0, s56, 49152
v_cvt_pk_bf16_f32 v108, v240, v241
v_cvt_pk_bf16_f32 v109, v242, v243
v_mfma_f32_16x16x32_bf16 v[144:147], a[24:27], v[56:59], v[144:147]
ds_read_b64_tr_b16 v[78:79], v20 offset:29184
v_mfma_f32_16x16x32_bf16 v[144:147], a[28:31], v[60:63], v[144:147]
buffer_load_dwordx4 v2, s[96:99], s45 offen offset:0 lds
v_mfma_f32_16x16x32_bf16 v[148:151], a[80:83], v[48:51], v[148:151]
ds_read_b64_tr_b16 v[80:81], v21 offset:16384
v_mfma_f32_16x16x32_bf16 v[148:151], a[84:87], v[52:55], v[148:151]
v_cvt_pk_bf16_f32 v110, v244, v245
v_cvt_pk_bf16_f32 v111, v246, v247
v_mfma_f32_16x16x32_bf16 v[148:151], a[88:91], v[56:59], v[148:151]
ds_read_b64_tr_b16 v[82:83], v21 offset:16896
v_mfma_f32_16x16x32_bf16 v[148:151], a[92:95], v[60:63], v[148:151]
buffer_load_dwordx4 v3, s[96:99], s45 offen offset:1024 lds
v_mfma_f32_16x16x32_bf16 v[152:155], a[144:147], v[48:51], v[152:155]
ds_read_b64_tr_b16 v[84:85], v21 offset:20480
v_mfma_f32_16x16x32_bf16 v[152:155], a[148:151], v[52:55], v[152:155]
v_mfma_f32_16x16x32_bf16 v[152:155], a[152:155], v[56:59], v[152:155]
ds_read_b64_tr_b16 v[86:87], v21 offset:20992
v_mfma_f32_16x16x32_bf16 v[152:155], a[156:159], v[60:63], v[152:155]
buffer_load_dwordx4 v4, s[96:99], s45 offen offset:2048 lds
v_mfma_f32_16x16x32_bf16 v[156:159], a[208:211], v[48:51], v[156:159]
ds_read_b64_tr_b16 v[88:89], v21 offset:24576
v_mfma_f32_16x16x32_bf16 v[156:159], a[212:215], v[52:55], v[156:159]
v_mfma_f32_16x16x32_bf16 v[156:159], a[216:219], v[56:59], v[156:159]
ds_read_b64_tr_b16 v[90:91], v21 offset:25088
v_mfma_f32_16x16x32_bf16 v[156:159], a[220:223], v[60:63], v[156:159]
s_waitcnt lgkmcnt(6)
buffer_load_dwordx4 v5, s[96:99], s45 offen offset:3072 lds
v_mfma_f32_16x16x32_bf16 v[160:163], a[16:19], v[64:67], v[160:163]
ds_read_b64_tr_b16 v[92:93], v21 offset:28672
v_mfma_f32_16x16x32_bf16 v[160:163], a[20:23], v[68:71], v[160:163]
s_add_u32 s45, s45, s46
v_mfma_f32_16x16x32_bf16 v[160:163], a[24:27], v[72:75], v[160:163]
ds_read_b64_tr_b16 v[94:95], v21 offset:29184
v_mfma_f32_16x16x32_bf16 v[160:163], a[28:31], v[76:79], v[160:163]
s_waitcnt vmcnt(30)
s_barrier
v_mfma_f32_16x16x32_bf16 v[164:167], a[80:83], v[64:67], v[164:167]
ds_read_b64_tr_b16 v[32:33], v10 offset:0
v_mfma_f32_16x16x32_bf16 v[164:167], a[84:87], v[68:71], v[164:167]
v_mfma_f32_16x16x32_bf16 v[164:167], a[88:91], v[72:75], v[164:167]
ds_read_b64_tr_b16 v[34:35], v10 offset:512
v_mfma_f32_16x16x32_bf16 v[164:167], a[92:95], v[76:79], v[164:167]
buffer_store_dwordx4 v[104:107], v16, s[36:39], s47 offen offset:2048 sc1
v_mfma_f32_16x16x32_bf16 v[168:171], a[144:147], v[64:67], v[168:171]
ds_read_b64_tr_b16 v[36:37], v10 offset:4096
v_mfma_f32_16x16x32_bf16 v[168:171], a[148:151], v[68:71], v[168:171]
v_mfma_f32_16x16x32_bf16 v[168:171], a[152:155], v[72:75], v[168:171]
ds_read_b64_tr_b16 v[38:39], v10 offset:4608
v_mfma_f32_16x16x32_bf16 v[168:171], a[156:159], v[76:79], v[168:171]
v_mfma_f32_16x16x32_bf16 v[172:175], a[208:211], v[64:67], v[172:175]
ds_read_b64_tr_b16 v[40:41], v10 offset:8192
v_mfma_f32_16x16x32_bf16 v[172:175], a[212:215], v[68:71], v[172:175]
v_mfma_f32_16x16x32_bf16 v[172:175], a[216:219], v[72:75], v[172:175]
ds_read_b64_tr_b16 v[42:43], v10 offset:8704
v_mfma_f32_16x16x32_bf16 v[172:175], a[220:223], v[76:79], v[172:175]
s_waitcnt lgkmcnt(6)
v_mfma_f32_16x16x32_bf16 v[176:179], a[16:19], v[80:83], v[176:179]
ds_read_b64_tr_b16 v[44:45], v10 offset:12288
v_mfma_f32_16x16x32_bf16 v[176:179], a[20:23], v[84:87], v[176:179]
v_mfma_f32_16x16x32_bf16 v[176:179], a[24:27], v[88:91], v[176:179]
ds_read_b64_tr_b16 v[46:47], v10 offset:12800
v_mfma_f32_16x16x32_bf16 v[176:179], a[28:31], v[92:95], v[176:179]
v_mfma_f32_16x16x32_bf16 v[180:183], a[80:83], v[80:83], v[180:183]
ds_read_b64_tr_b16 v[48:49], v11 offset:0
v_mfma_f32_16x16x32_bf16 v[180:183], a[84:87], v[84:87], v[180:183]
v_mfma_f32_16x16x32_bf16 v[180:183], a[88:91], v[88:91], v[180:183]
ds_read_b64_tr_b16 v[50:51], v11 offset:512
v_mfma_f32_16x16x32_bf16 v[180:183], a[92:95], v[92:95], v[180:183]
v_mfma_f32_16x16x32_bf16 v[184:187], a[144:147], v[80:83], v[184:187]
ds_read_b64_tr_b16 v[52:53], v11 offset:4096
v_mfma_f32_16x16x32_bf16 v[184:187], a[148:151], v[84:87], v[184:187]
v_mfma_f32_16x16x32_bf16 v[184:187], a[152:155], v[88:91], v[184:187]
ds_read_b64_tr_b16 v[54:55], v11 offset:4608
v_mfma_f32_16x16x32_bf16 v[184:187], a[156:159], v[92:95], v[184:187]
buffer_store_dwordx4 v[108:111], v16, s[36:39], s47 offen offset:3072 sc1
v_mfma_f32_16x16x32_bf16 v[188:191], a[208:211], v[80:83], v[188:191]
ds_read_b64_tr_b16 v[56:57], v11 offset:8192
v_mfma_f32_16x16x32_bf16 v[188:191], a[212:215], v[84:87], v[188:191]
s_mov_b32 s52, s50
s_mov_b32 s58, s51
v_mfma_f32_16x16x32_bf16 v[188:191], a[216:219], v[88:91], v[188:191]
ds_read_b64_tr_b16 v[58:59], v11 offset:8704
v_mfma_f32_16x16x32_bf16 v[188:191], a[220:223], v[92:95], v[188:191]
s_waitcnt lgkmcnt(6)
v_mfma_f32_16x16x32_bf16 v[128:131], a[32:35], v[32:35], v[128:131]
ds_read_b64_tr_b16 v[60:61], v11 offset:12288
v_mfma_f32_16x16x32_bf16 v[128:131], a[36:39], v[36:39], v[128:131]
s_add_u32 m0, s56, 131072
v_mfma_f32_16x16x32_bf16 v[128:131], a[40:43], v[40:43], v[128:131]
ds_read_b64_tr_b16 v[62:63], v11 offset:12800
v_mfma_f32_16x16x32_bf16 v[128:131], a[44:47], v[44:47], v[128:131]
buffer_load_dwordx4 v2, s[32:35], s45 offen offset:0 lds
v_mfma_f32_16x16x32_bf16 v[132:135], a[96:99], v[32:35], v[132:135]
ds_read_b64_tr_b16 v[64:65], v12 offset:0
v_mfma_f32_16x16x32_bf16 v[132:135], a[100:103], v[36:39], v[132:135]
s_add_u32 s41, s41, 1
v_mfma_f32_16x16x32_bf16 v[132:135], a[104:107], v[40:43], v[132:135]
ds_read_b64_tr_b16 v[66:67], v12 offset:512
v_mfma_f32_16x16x32_bf16 v[132:135], a[108:111], v[44:47], v[132:135]
buffer_load_dwordx4 v3, s[32:35], s45 offen offset:1024 lds
v_mfma_f32_16x16x32_bf16 v[136:139], a[160:163], v[32:35], v[136:139]
ds_read_b64_tr_b16 v[68:69], v12 offset:4096
v_mfma_f32_16x16x32_bf16 v[136:139], a[164:167], v[36:39], v[136:139]
s_sub_u32 s43, s43, 1
v_cvt_pk_bf16_f32 v96, v200, v201
v_cvt_pk_bf16_f32 v97, v202, v203
v_mfma_f32_16x16x32_bf16 v[136:139], a[168:171], v[40:43], v[136:139]
ds_read_b64_tr_b16 v[70:71], v12 offset:4608
v_mfma_f32_16x16x32_bf16 v[136:139], a[172:175], v[44:47], v[136:139]
buffer_load_dwordx4 v4, s[32:35], s45 offen offset:2048 lds
v_mfma_f32_16x16x32_bf16 v[140:143], a[224:227], v[32:35], v[140:143]
ds_read_b64_tr_b16 v[72:73], v12 offset:8192
v_mfma_f32_16x16x32_bf16 v[140:143], a[228:231], v[36:39], v[140:143]
s_lshr_b32 s60, s41, 1
v_cvt_pk_bf16_f32 v98, v204, v205
v_cvt_pk_bf16_f32 v99, v206, v207
v_mfma_f32_16x16x32_bf16 v[140:143], a[232:235], v[40:43], v[140:143]
ds_read_b64_tr_b16 v[74:75], v12 offset:8704
v_mfma_f32_16x16x32_bf16 v[140:143], a[236:239], v[44:47], v[140:143]
s_waitcnt lgkmcnt(6)
buffer_load_dwordx4 v5, s[32:35], s45 offen offset:3072 lds
v_mfma_f32_16x16x32_bf16 v[144:147], a[32:35], v[48:51], v[144:147]
ds_read_b64_tr_b16 v[76:77], v12 offset:12288
v_mfma_f32_16x16x32_bf16 v[144:147], a[36:39], v[52:55], v[144:147]
s_add_u32 m0, s56, 147456
v_cvt_pk_bf16_f32 v100, v216, v217
v_cvt_pk_bf16_f32 v101, v218, v219
v_mfma_f32_16x16x32_bf16 v[144:147], a[40:43], v[56:59], v[144:147]
ds_read_b64_tr_b16 v[78:79], v12 offset:12800
v_mfma_f32_16x16x32_bf16 v[144:147], a[44:47], v[60:63], v[144:147]
buffer_load_dwordx4 v2, s[96:99], s45 offen offset:0 lds
v_mfma_f32_16x16x32_bf16 v[148:151], a[96:99], v[48:51], v[148:151]
ds_read_b64_tr_b16 v[80:81], v13 offset:0
v_mfma_f32_16x16x32_bf16 v[148:151], a[100:103], v[52:55], v[148:151]
s_lshl_b32 s60, s60, 19
v_cvt_pk_bf16_f32 v102, v220, v221
v_cvt_pk_bf16_f32 v103, v222, v223
v_mfma_f32_16x16x32_bf16 v[148:151], a[104:107], v[56:59], v[148:151]
ds_read_b64_tr_b16 v[82:83], v13 offset:512
v_mfma_f32_16x16x32_bf16 v[148:151], a[108:111], v[60:63], v[148:151]
buffer_load_dwordx4 v3, s[96:99], s45 offen offset:1024 lds
v_mfma_f32_16x16x32_bf16 v[152:155], a[160:163], v[48:51], v[152:155]
ds_read_b64_tr_b16 v[84:85], v13 offset:4096
v_mfma_f32_16x16x32_bf16 v[152:155], a[164:167], v[52:55], v[152:155]
s_and_b32 s61, s41, 1
v_mfma_f32_16x16x32_bf16 v[152:155], a[168:171], v[56:59], v[152:155]
ds_read_b64_tr_b16 v[86:87], v13 offset:4608
v_mfma_f32_16x16x32_bf16 v[152:155], a[172:175], v[60:63], v[152:155]
buffer_load_dwordx4 v4, s[96:99], s45 offen offset:2048 lds
v_mfma_f32_16x16x32_bf16 v[156:159], a[224:227], v[48:51], v[156:159]
ds_read_b64_tr_b16 v[88:89], v13 offset:8192
v_mfma_f32_16x16x32_bf16 v[156:159], a[228:231], v[52:55], v[156:159]
s_lshl_b32 s61, s61, 12
v_mfma_f32_16x16x32_bf16 v[156:159], a[232:235], v[56:59], v[156:159]
ds_read_b64_tr_b16 v[90:91], v13 offset:8704
v_mfma_f32_16x16x32_bf16 v[156:159], a[236:239], v[60:63], v[156:159]
s_waitcnt lgkmcnt(6)
buffer_load_dwordx4 v5, s[96:99], s45 offen offset:3072 lds
v_mfma_f32_16x16x32_bf16 v[160:163], a[32:35], v[64:67], v[160:163]
ds_read_b64_tr_b16 v[92:93], v13 offset:12288
v_mfma_f32_16x16x32_bf16 v[160:163], a[36:39], v[68:71], v[160:163]
s_add_u32 s45, s45, s46
v_mfma_f32_16x16x32_bf16 v[160:163], a[40:43], v[72:75], v[160:163]
ds_read_b64_tr_b16 v[94:95], v13 offset:12800
v_mfma_f32_16x16x32_bf16 v[160:163], a[44:47], v[76:79], v[160:163]
s_waitcnt vmcnt(36)
s_barrier
v_mfma_f32_16x16x32_bf16 v[164:167], a[96:99], v[64:67], v[164:167]
ds_read_b64_tr_b16 v[32:33], v10 offset:16384
v_mfma_f32_16x16x32_bf16 v[164:167], a[100:103], v[68:71], v[164:167]
s_add_u32 s60, s60, s61
v_mfma_f32_16x16x32_bf16 v[164:167], a[104:107], v[72:75], v[164:167]
ds_read_b64_tr_b16 v[34:35], v10 offset:16896
v_mfma_f32_16x16x32_bf16 v[164:167], a[108:111], v[76:79], v[164:167]
buffer_store_dwordx4 v[96:99], v16, s[36:39], s48 offen offset:0 sc1
v_mfma_f32_16x16x32_bf16 v[168:171], a[160:163], v[64:67], v[168:171]
ds_read_b64_tr_b16 v[36:37], v10 offset:20480
v_mfma_f32_16x16x32_bf16 v[168:171], a[164:167], v[68:71], v[168:171]
s_lshl_b32 s61, s54, 13
v_mfma_f32_16x16x32_bf16 v[168:171], a[168:171], v[72:75], v[168:171]
ds_read_b64_tr_b16 v[38:39], v10 offset:20992
v_mfma_f32_16x16x32_bf16 v[168:171], a[172:175], v[76:79], v[168:171]
s_add_u32 s50, s60, s61
v_mfma_f32_16x16x32_bf16 v[172:175], a[224:227], v[64:67], v[172:175]
ds_read_b64_tr_b16 v[40:41], v10 offset:24576
v_mfma_f32_16x16x32_bf16 v[172:175], a[228:231], v[68:71], v[172:175]
s_add_u32 s51, s50, 8192
v_mfma_f32_16x16x32_bf16 v[172:175], a[232:235], v[72:75], v[172:175]
ds_read_b64_tr_b16 v[42:43], v10 offset:25088
v_mfma_f32_16x16x32_bf16 v[172:175], a[236:239], v[76:79], v[172:175]
s_waitcnt lgkmcnt(6)
v_mfma_f32_16x16x32_bf16 v[176:179], a[32:35], v[80:83], v[176:179]
ds_read_b64_tr_b16 v[44:45], v10 offset:28672
v_mfma_f32_16x16x32_bf16 v[176:179], a[36:39], v[84:87], v[176:179]
s_cmp_ge_u32 s41, 64
s_cselect_b32 s53, 1, 0
v_mfma_f32_16x16x32_bf16 v[176:179], a[40:43], v[88:91], v[176:179]
ds_read_b64_tr_b16 v[46:47], v10 offset:29184
v_mfma_f32_16x16x32_bf16 v[176:179], a[44:47], v[92:95], v[176:179]
s_sub_u32 s60, s41, 128
v_mfma_f32_16x16x32_bf16 v[180:183], a[96:99], v[80:83], v[180:183]
ds_read_b64_tr_b16 v[48:49], v11 offset:16384
v_mfma_f32_16x16x32_bf16 v[180:183], a[100:103], v[84:87], v[180:183]
s_cmp_lt_u32 s60, 16
s_cselect_b32 s53, 0, s53
v_mfma_f32_16x16x32_bf16 v[180:183], a[104:107], v[88:91], v[180:183]
ds_read_b64_tr_b16 v[50:51], v11 offset:16896
v_mfma_f32_16x16x32_bf16 v[180:183], a[108:111], v[92:95], v[180:183]
v_mfma_f32_16x16x32_bf16 v[184:187], a[160:163], v[80:83], v[184:187]
ds_read_b64_tr_b16 v[52:53], v11 offset:20480
v_mfma_f32_16x16x32_bf16 v[184:187], a[164:167], v[84:87], v[184:187]
v_mfma_f32_16x16x32_bf16 v[184:187], a[168:171], v[88:91], v[184:187]
ds_read_b64_tr_b16 v[54:55], v11 offset:20992
v_mfma_f32_16x16x32_bf16 v[184:187], a[172:175], v[92:95], v[184:187]
buffer_store_dwordx4 v[100:103], v16, s[36:39], s48 offen offset:1024 sc1
v_mfma_f32_16x16x32_bf16 v[188:191], a[224:227], v[80:83], v[188:191]
ds_read_b64_tr_b16 v[56:57], v11 offset:24576
v_mfma_f32_16x16x32_bf16 v[188:191], a[228:231], v[84:87], v[188:191]
v_mfma_f32_16x16x32_bf16 v[188:191], a[232:235], v[88:91], v[188:191]
ds_read_b64_tr_b16 v[58:59], v11 offset:25088
v_mfma_f32_16x16x32_bf16 v[188:191], a[236:239], v[92:95], v[188:191]
s_waitcnt lgkmcnt(6)
v_mfma_f32_16x16x32_bf16 v[128:131], a[48:51], v[32:35], v[128:131]
ds_read_b64_tr_b16 v[60:61], v11 offset:28672
v_mfma_f32_16x16x32_bf16 v[128:131], a[52:55], v[36:39], v[128:131]
s_add_u32 m0, s56, 65536
v_mfma_f32_16x16x32_bf16 v[128:131], a[56:59], v[40:43], v[128:131]
ds_read_b64_tr_b16 v[62:63], v11 offset:29184
v_mfma_f32_16x16x32_bf16 v[128:131], a[60:63], v[44:47], v[128:131]
buffer_load_dwordx4 v2, s[32:35], s45 offen offset:0 lds
v_mfma_f32_16x16x32_bf16 v[132:135], a[112:115], v[32:35], v[132:135]
ds_read_b64_tr_b16 v[64:65], v12 offset:16384
v_mfma_f32_16x16x32_bf16 v[132:135], a[116:119], v[36:39], v[132:135]
v_mfma_f32_16x16x32_bf16 v[132:135], a[120:123], v[40:43], v[132:135]
ds_read_b64_tr_b16 v[66:67], v12 offset:16896
v_mfma_f32_16x16x32_bf16 v[132:135], a[124:127], v[44:47], v[132:135]
buffer_load_dwordx4 v3, s[32:35], s45 offen offset:1024 lds
v_mfma_f32_16x16x32_bf16 v[136:139], a[176:179], v[32:35], v[136:139]
ds_read_b64_tr_b16 v[68:69], v12 offset:20480
v_mfma_f32_16x16x32_bf16 v[136:139], a[180:183], v[36:39], v[136:139]
v_cvt_pk_bf16_f32 v104, v232, v233
v_cvt_pk_bf16_f32 v105, v234, v235
v_mfma_f32_16x16x32_bf16 v[136:139], a[184:187], v[40:43], v[136:139]
ds_read_b64_tr_b16 v[70:71], v12 offset:20992
v_mfma_f32_16x16x32_bf16 v[136:139], a[188:191], v[44:47], v[136:139]
buffer_load_dwordx4 v4, s[32:35], s45 offen offset:2048 lds
v_mfma_f32_16x16x32_bf16 v[140:143], a[240:243], v[32:35], v[140:143]
ds_read_b64_tr_b16 v[72:73], v12 offset:24576
v_mfma_f32_16x16x32_bf16 v[140:143], a[244:247], v[36:39], v[140:143]
v_cvt_pk_bf16_f32 v106, v236, v237
v_cvt_pk_bf16_f32 v107, v238, v239
v_mfma_f32_16x16x32_bf16 v[140:143], a[248:251], v[40:43], v[140:143]
ds_read_b64_tr_b16 v[74:75], v12 offset:25088
v_mfma_f32_16x16x32_bf16 v[140:143], a[252:255], v[44:47], v[140:143]
s_waitcnt lgkmcnt(6)
buffer_load_dwordx4 v5, s[32:35], s45 offen offset:3072 lds
v_mfma_f32_16x16x32_bf16 v[144:147], a[48:51], v[48:51], v[144:147]
ds_read_b64_tr_b16 v[76:77], v12 offset:28672
v_mfma_f32_16x16x32_bf16 v[144:147], a[52:55], v[52:55], v[144:147]
s_add_u32 m0, s56, 81920
v_cvt_pk_bf16_f32 v108, v248, v249
v_cvt_pk_bf16_f32 v109, v250, v251
v_mfma_f32_16x16x32_bf16 v[144:147], a[56:59], v[56:59], v[144:147]
ds_read_b64_tr_b16 v[78:79], v12 offset:29184
v_mfma_f32_16x16x32_bf16 v[144:147], a[60:63], v[60:63], v[144:147]
buffer_load_dwordx4 v2, s[96:99], s45 offen offset:0 lds
v_mfma_f32_16x16x32_bf16 v[148:151], a[112:115], v[48:51], v[148:151]
ds_read_b64_tr_b16 v[80:81], v13 offset:16384
v_mfma_f32_16x16x32_bf16 v[148:151], a[116:119], v[52:55], v[148:151]
v_cvt_pk_bf16_f32 v110, v252, v253
v_cvt_pk_bf16_f32 v111, v254, v255
v_mfma_f32_16x16x32_bf16 v[148:151], a[120:123], v[56:59], v[148:151]
ds_read_b64_tr_b16 v[82:83], v13 offset:16896
v_mfma_f32_16x16x32_bf16 v[148:151], a[124:127], v[60:63], v[148:151]
buffer_load_dwordx4 v3, s[96:99], s45 offen offset:1024 lds
v_mfma_f32_16x16x32_bf16 v[152:155], a[176:179], v[48:51], v[152:155]
ds_read_b64_tr_b16 v[84:85], v13 offset:20480
v_mfma_f32_16x16x32_bf16 v[152:155], a[180:183], v[52:55], v[152:155]
v_mfma_f32_16x16x32_bf16 v[152:155], a[184:187], v[56:59], v[152:155]
ds_read_b64_tr_b16 v[86:87], v13 offset:20992
v_mfma_f32_16x16x32_bf16 v[152:155], a[188:191], v[60:63], v[152:155]
buffer_load_dwordx4 v4, s[96:99], s45 offen offset:2048 lds
v_mfma_f32_16x16x32_bf16 v[156:159], a[240:243], v[48:51], v[156:159]
ds_read_b64_tr_b16 v[88:89], v13 offset:24576
v_mfma_f32_16x16x32_bf16 v[156:159], a[244:247], v[52:55], v[156:159]
v_mfma_f32_16x16x32_bf16 v[156:159], a[248:251], v[56:59], v[156:159]
ds_read_b64_tr_b16 v[90:91], v13 offset:25088
v_mfma_f32_16x16x32_bf16 v[156:159], a[252:255], v[60:63], v[156:159]
s_waitcnt lgkmcnt(6)
buffer_load_dwordx4 v5, s[96:99], s45 offen offset:3072 lds
v_mfma_f32_16x16x32_bf16 v[160:163], a[48:51], v[64:67], v[160:163]
ds_read_b64_tr_b16 v[92:93], v13 offset:28672
v_mfma_f32_16x16x32_bf16 v[160:163], a[52:55], v[68:71], v[160:163]
v_mfma_f32_16x16x32_bf16 v[160:163], a[56:59], v[72:75], v[160:163]
ds_read_b64_tr_b16 v[94:95], v13 offset:29184
v_mfma_f32_16x16x32_bf16 v[160:163], a[60:63], v[76:79], v[160:163]
s_waitcnt vmcnt(34)
s_barrier
v_mfma_f32_16x16x32_bf16 v[164:167], a[112:115], v[64:67], v[164:167]
ds_read_b64_tr_b16 v[32:33], v18 offset:32768
v_mfma_f32_16x16x32_bf16 v[164:167], a[116:119], v[68:71], v[164:167]
v_mfma_f32_16x16x32_bf16 v[164:167], a[120:123], v[72:75], v[164:167]
ds_read_b64_tr_b16 v[34:35], v18 offset:33280
v_mfma_f32_16x16x32_bf16 v[164:167], a[124:127], v[76:79], v[164:167]
buffer_store_dwordx4 v[104:107], v16, s[36:39], s48 offen offset:2048 sc1
v_mfma_f32_16x16x32_bf16 v[168:171], a[176:179], v[64:67], v[168:171]
ds_read_b64_tr_b16 v[36:37], v18 offset:36864
v_mfma_f32_16x16x32_bf16 v[168:171], a[180:183], v[68:71], v[168:171]
v_mfma_f32_16x16x32_bf16 v[168:171], a[184:187], v[72:75], v[168:171]
ds_read_b64_tr_b16 v[38:39], v18 offset:37376
v_mfma_f32_16x16x32_bf16 v[168:171], a[188:191], v[76:79], v[168:171]
v_mfma_f32_16x16x32_bf16 v[172:175], a[240:243], v[64:67], v[172:175]
ds_read_b64_tr_b16 v[40:41], v18 offset:40960
v_mfma_f32_16x16x32_bf16 v[172:175], a[244:247], v[68:71], v[172:175]
v_mfma_f32_16x16x32_bf16 v[172:175], a[248:251], v[72:75], v[172:175]
ds_read_b64_tr_b16 v[42:43], v18 offset:41472
v_mfma_f32_16x16x32_bf16 v[172:175], a[252:255], v[76:79], v[172:175]
s_waitcnt lgkmcnt(6)
v_mfma_f32_16x16x32_bf16 v[176:179], a[48:51], v[80:83], v[176:179]
ds_read_b64_tr_b16 v[44:45], v18 offset:45056
v_mfma_f32_16x16x32_bf16 v[176:179], a[52:55], v[84:87], v[176:179]
v_mfma_f32_16x16x32_bf16 v[176:179], a[56:59], v[88:91], v[176:179]
ds_read_b64_tr_b16 v[46:47], v18 offset:45568
v_mfma_f32_16x16x32_bf16 v[176:179], a[60:63], v[92:95], v[176:179]
v_mfma_f32_16x16x32_bf16 v[180:183], a[112:115], v[80:83], v[180:183]
ds_read_b64_tr_b16 v[48:49], v19 offset:32768
v_mfma_f32_16x16x32_bf16 v[180:183], a[116:119], v[84:87], v[180:183]
v_mfma_f32_16x16x32_bf16 v[180:183], a[120:123], v[88:91], v[180:183]
ds_read_b64_tr_b16 v[50:51], v19 offset:33280
v_mfma_f32_16x16x32_bf16 v[180:183], a[124:127], v[92:95], v[180:183]
v_mfma_f32_16x16x32_bf16 v[184:187], a[176:179], v[80:83], v[184:187]
ds_read_b64_tr_b16 v[52:53], v19 offset:36864
v_mfma_f32_16x16x32_bf16 v[184:187], a[180:183], v[84:87], v[184:187]
v_mfma_f32_16x16x32_bf16 v[184:187], a[184:187], v[88:91], v[184:187]
ds_read_b64_tr_b16 v[54:55], v19 offset:37376
v_mfma_f32_16x16x32_bf16 v[184:187], a[188:191], v[92:95], v[184:187]
buffer_store_dwordx4 v[108:111], v16, s[36:39], s48 offen offset:3072 sc1
v_mfma_f32_16x16x32_bf16 v[188:191], a[240:243], v[80:83], v[188:191]
ds_read_b64_tr_b16 v[56:57], v19 offset:40960
v_mfma_f32_16x16x32_bf16 v[188:191], a[244:247], v[84:87], v[188:191]
s_mov_b32 s47, s52
v_mfma_f32_16x16x32_bf16 v[188:191], a[248:251], v[88:91], v[188:191]
ds_read_b64_tr_b16 v[58:59], v19 offset:41472
v_mfma_f32_16x16x32_bf16 v[188:191], a[252:255], v[92:95], v[188:191]
s_mov_b32 s48, s58
s_waitcnt lgkmcnt(6)
v_mfma_f32_16x16x32_bf16 v[192:195], a[0:3], v[32:35], 0
ds_read_b64_tr_b16 v[60:61], v19 offset:45056
v_mfma_f32_16x16x32_bf16 v[192:195], a[4:7], v[36:39], v[192:195]
v_mfma_f32_16x16x32_bf16 v[192:195], a[8:11], v[40:43], v[192:195]
ds_read_b64_tr_b16 v[62:63], v19 offset:45568
v_mfma_f32_16x16x32_bf16 v[192:195], a[12:15], v[44:47], v[192:195]
v_mfma_f32_16x16x32_bf16 v[196:199], a[64:67], v[32:35], 0
ds_read_b64_tr_b16 v[64:65], v20 offset:32768
v_mfma_f32_16x16x32_bf16 v[196:199], a[68:71], v[36:39], v[196:199]
v_mfma_f32_16x16x32_bf16 v[196:199], a[72:75], v[40:43], v[196:199]
ds_read_b64_tr_b16 v[66:67], v20 offset:33280
v_mfma_f32_16x16x32_bf16 v[196:199], a[76:79], v[44:47], v[196:199]
v_mfma_f32_16x16x32_bf16 v[200:203], a[128:131], v[32:35], 0
ds_read_b64_tr_b16 v[68:69], v20 offset:36864
v_mfma_f32_16x16x32_bf16 v[200:203], a[132:135], v[36:39], v[200:203]
v_cvt_pk_bf16_f32 v96, v128, v129
v_cvt_pk_bf16_f32 v97, v130, v131
v_mfma_f32_16x16x32_bf16 v[200:203], a[136:139], v[40:43], v[200:203]
ds_read_b64_tr_b16 v[70:71], v20 offset:37376
v_mfma_f32_16x16x32_bf16 v[200:203], a[140:143], v[44:47], v[200:203]
v_mfma_f32_16x16x32_bf16 v[204:207], a[192:195], v[32:35], 0
ds_read_b64_tr_b16 v[72:73], v20 offset:40960
v_mfma_f32_16x16x32_bf16 v[204:207], a[196:199], v[36:39], v[204:207]
v_cvt_pk_bf16_f32 v98, v132, v133
v_cvt_pk_bf16_f32 v99, v134, v135
v_mfma_f32_16x16x32_bf16 v[204:207], a[200:203], v[40:43], v[204:207]
ds_read_b64_tr_b16 v[74:75], v20 offset:41472
v_mfma_f32_16x16x32_bf16 v[204:207], a[204:207], v[44:47], v[204:207]
s_waitcnt lgkmcnt(6)
v_mfma_f32_16x16x32_bf16 v[208:211], a[0:3], v[48:51], 0
ds_read_b64_tr_b16 v[76:77], v20 offset:45056
v_mfma_f32_16x16x32_bf16 v[208:211], a[4:7], v[52:55], v[208:211]
v_cvt_pk_bf16_f32 v100, v144, v145
v_cvt_pk_bf16_f32 v101, v146, v147
v_mfma_f32_16x16x32_bf16 v[208:211], a[8:11], v[56:59], v[208:211]
ds_read_b64_tr_b16 v[78:79], v20 offset:45568
v_mfma_f32_16x16x32_bf16 v[208:211], a[12:15], v[60:63], v[208:211]
v_mfma_f32_16x16x32_bf16 v[212:215], a[64:67], v[48:51], 0
ds_read_b64_tr_b16 v[80:81], v21 offset:32768
v_mfma_f32_16x16x32_bf16 v[212:215], a[68:71], v[52:55], v[212:215]
v_cvt_pk_bf16_f32 v102, v148, v149
v_cvt_pk_bf16_f32 v103, v150, v151
v_mfma_f32_16x16x32_bf16 v[212:215], a[72:75], v[56:59], v[212:215]
ds_read_b64_tr_b16 v[82:83], v21 offset:33280
v_mfma_f32_16x16x32_bf16 v[212:215], a[76:79], v[60:63], v[212:215]
v_mfma_f32_16x16x32_bf16 v[216:219], a[128:131], v[48:51], 0
ds_read_b64_tr_b16 v[84:85], v21 offset:36864
v_mfma_f32_16x16x32_bf16 v[216:219], a[132:135], v[52:55], v[216:219]
v_mfma_f32_16x16x32_bf16 v[216:219], a[136:139], v[56:59], v[216:219]
ds_read_b64_tr_b16 v[86:87], v21 offset:37376
v_mfma_f32_16x16x32_bf16 v[216:219], a[140:143], v[60:63], v[216:219]
v_mfma_f32_16x16x32_bf16 v[220:223], a[192:195], v[48:51], 0
ds_read_b64_tr_b16 v[88:89], v21 offset:40960
v_mfma_f32_16x16x32_bf16 v[220:223], a[196:199], v[52:55], v[220:223]
v_mfma_f32_16x16x32_bf16 v[220:223], a[200:203], v[56:59], v[220:223]
ds_read_b64_tr_b16 v[90:91], v21 offset:41472
v_mfma_f32_16x16x32_bf16 v[220:223], a[204:207], v[60:63], v[220:223]
s_waitcnt lgkmcnt(6)
v_mfma_f32_16x16x32_bf16 v[224:227], a[0:3], v[64:67], 0
ds_read_b64_tr_b16 v[92:93], v21 offset:45056
v_mfma_f32_16x16x32_bf16 v[224:227], a[4:7], v[68:71], v[224:227]
v_mfma_f32_16x16x32_bf16 v[224:227], a[8:11], v[72:75], v[224:227]
ds_read_b64_tr_b16 v[94:95], v21 offset:45568
v_mfma_f32_16x16x32_bf16 v[224:227], a[12:15], v[76:79], v[224:227]
s_waitcnt vmcnt(26)
s_barrier
v_mfma_f32_16x16x32_bf16 v[228:231], a[64:67], v[64:67], 0
ds_read_b64_tr_b16 v[32:33], v10 offset:32768
v_mfma_f32_16x16x32_bf16 v[228:231], a[68:71], v[68:71], v[228:231]
v_mfma_f32_16x16x32_bf16 v[228:231], a[72:75], v[72:75], v[228:231]
ds_read_b64_tr_b16 v[34:35], v10 offset:33280
v_mfma_f32_16x16x32_bf16 v[228:231], a[76:79], v[76:79], v[228:231]
buffer_store_dwordx4 v[96:99], v16, s[36:39], s47 offen offset:0 sc1
v_mfma_f32_16x16x32_bf16 v[232:235], a[128:131], v[64:67], 0
ds_read_b64_tr_b16 v[36:37], v10 offset:36864
v_mfma_f32_16x16x32_bf16 v[232:235], a[132:135], v[68:71], v[232:235]
s_mov_b32 s52, s50
s_mov_b32 s58, s51
v_mfma_f32_16x16x32_bf16 v[232:235], a[136:139], v[72:75], v[232:235]
ds_read_b64_tr_b16 v[38:39], v10 offset:37376
v_mfma_f32_16x16x32_bf16 v[232:235], a[140:143], v[76:79], v[232:235]
s_add_u32 s41, s41, 1
v_mfma_f32_16x16x32_bf16 v[236:239], a[192:195], v[64:67], 0
ds_read_b64_tr_b16 v[40:41], v10 offset:40960
v_mfma_f32_16x16x32_bf16 v[236:239], a[196:199], v[68:71], v[236:239]
s_sub_u32 s43, s43, 1
v_mfma_f32_16x16x32_bf16 v[236:239], a[200:203], v[72:75], v[236:239]
ds_read_b64_tr_b16 v[42:43], v10 offset:41472
v_mfma_f32_16x16x32_bf16 v[236:239], a[204:207], v[76:79], v[236:239]
s_waitcnt lgkmcnt(6)
v_mfma_f32_16x16x32_bf16 v[240:243], a[0:3], v[80:83], 0
ds_read_b64_tr_b16 v[44:45], v10 offset:45056
v_mfma_f32_16x16x32_bf16 v[240:243], a[4:7], v[84:87], v[240:243]
s_lshr_b32 s60, s41, 1
v_mfma_f32_16x16x32_bf16 v[240:243], a[8:11], v[88:91], v[240:243]
ds_read_b64_tr_b16 v[46:47], v10 offset:45568
v_mfma_f32_16x16x32_bf16 v[240:243], a[12:15], v[92:95], v[240:243]
s_lshl_b32 s60, s60, 19
v_mfma_f32_16x16x32_bf16 v[244:247], a[64:67], v[80:83], 0
ds_read_b64_tr_b16 v[48:49], v11 offset:32768
v_mfma_f32_16x16x32_bf16 v[244:247], a[68:71], v[84:87], v[244:247]
s_and_b32 s61, s41, 1
v_mfma_f32_16x16x32_bf16 v[244:247], a[72:75], v[88:91], v[244:247]
ds_read_b64_tr_b16 v[50:51], v11 offset:33280
v_mfma_f32_16x16x32_bf16 v[244:247], a[76:79], v[92:95], v[244:247]
s_lshl_b32 s61, s61, 12
v_mfma_f32_16x16x32_bf16 v[248:251], a[128:131], v[80:83], 0
ds_read_b64_tr_b16 v[52:53], v11 offset:36864
v_mfma_f32_16x16x32_bf16 v[248:251], a[132:135], v[84:87], v[248:251]
s_add_u32 s60, s60, s61
v_mfma_f32_16x16x32_bf16 v[248:251], a[136:139], v[88:91], v[248:251]
ds_read_b64_tr_b16 v[54:55], v11 offset:37376
v_mfma_f32_16x16x32_bf16 v[248:251], a[140:143], v[92:95], v[248:251]
buffer_store_dwordx4 v[100:103], v16, s[36:39], s47 offen offset:1024 sc1
v_mfma_f32_16x16x32_bf16 v[252:255], a[192:195], v[80:83], 0
ds_read_b64_tr_b16 v[56:57], v11 offset:40960
v_mfma_f32_16x16x32_bf16 v[252:255], a[196:199], v[84:87], v[252:255]
s_lshl_b32 s61, s54, 13
v_mfma_f32_16x16x32_bf16 v[252:255], a[200:203], v[88:91], v[252:255]
ds_read_b64_tr_b16 v[58:59], v11 offset:41472
v_mfma_f32_16x16x32_bf16 v[252:255], a[204:207], v[92:95], v[252:255]
s_waitcnt lgkmcnt(6)
v_mfma_f32_16x16x32_bf16 v[192:195], a[16:19], v[32:35], v[192:195]
ds_read_b64_tr_b16 v[60:61], v11 offset:45056
v_mfma_f32_16x16x32_bf16 v[192:195], a[20:23], v[36:39], v[192:195]
s_add_u32 s50, s60, s61
v_mfma_f32_16x16x32_bf16 v[192:195], a[24:27], v[40:43], v[192:195]
ds_read_b64_tr_b16 v[62:63], v11 offset:45568
v_mfma_f32_16x16x32_bf16 v[192:195], a[28:31], v[44:47], v[192:195]
s_add_u32 s51, s50, 8192
v_mfma_f32_16x16x32_bf16 v[196:199], a[80:83], v[32:35], v[196:199]
ds_read_b64_tr_b16 v[64:65], v12 offset:32768
v_mfma_f32_16x16x32_bf16 v[196:199], a[84:87], v[36:39], v[196:199]
s_cmp_ge_u32 s41, 64
s_cselect_b32 s53, 1, 0
v_mfma_f32_16x16x32_bf16 v[196:199], a[88:91], v[40:43], v[196:199]
ds_read_b64_tr_b16 v[66:67], v12 offset:33280
v_mfma_f32_16x16x32_bf16 v[196:199], a[92:95], v[44:47], v[196:199]
s_sub_u32 s60, s41, 128
v_mfma_f32_16x16x32_bf16 v[200:203], a[144:147], v[32:35], v[200:203]
ds_read_b64_tr_b16 v[68:69], v12 offset:36864
v_mfma_f32_16x16x32_bf16 v[200:203], a[148:151], v[36:39], v[200:203]
s_cmp_lt_u32 s60, 16
s_cselect_b32 s53, 0, s53
v_cvt_pk_bf16_f32 v104, v160, v161
v_cvt_pk_bf16_f32 v105, v162, v163
v_mfma_f32_16x16x32_bf16 v[200:203], a[152:155], v[40:43], v[200:203]
ds_read_b64_tr_b16 v[70:71], v12 offset:37376
v_mfma_f32_16x16x32_bf16 v[200:203], a[156:159], v[44:47], v[200:203]
v_mfma_f32_16x16x32_bf16 v[204:207], a[208:211], v[32:35], v[204:207]
ds_read_b64_tr_b16 v[72:73], v12 offset:40960
v_mfma_f32_16x16x32_bf16 v[204:207], a[212:215], v[36:39], v[204:207]
v_cvt_pk_bf16_f32 v106, v164, v165
v_cvt_pk_bf16_f32 v107, v166, v167
v_mfma_f32_16x16x32_bf16 v[204:207], a[216:219], v[40:43], v[204:207]
ds_read_b64_tr_b16 v[74:75], v12 offset:41472
v_mfma_f32_16x16x32_bf16 v[204:207], a[220:223], v[44:47], v[204:207]
s_waitcnt lgkmcnt(6)
v_mfma_f32_16x16x32_bf16 v[208:211], a[16:19], v[48:51], v[208:211]
ds_read_b64_tr_b16 v[76:77], v12 offset:45056
v_mfma_f32_16x16x32_bf16 v[208:211], a[20:23], v[52:55], v[208:211]
v_cvt_pk_bf16_f32 v108, v176, v177
v_cvt_pk_bf16_f32 v109, v178, v179
v_mfma_f32_16x16x32_bf16 v[208:211], a[24:27], v[56:59], v[208:211]
ds_read_b64_tr_b16 v[78:79], v12 offset:45568
v_mfma_f32_16x16x32_bf16 v[208:211], a[28:31], v[60:63], v[208:211]
v_mfma_f32_16x16x32_bf16 v[212:215], a[80:83], v[48:51], v[212:215]
ds_read_b64_tr_b16 v[80:81], v13 offset:32768
v_mfma_f32_16x16x32_bf16 v[212:215], a[84:87], v[52:55], v[212:215]
v_cvt_pk_bf16_f32 v110, v180, v181
v_cvt_pk_bf16_f32 v111, v182, v183
v_mfma_f32_16x16x32_bf16 v[212:215], a[88:91], v[56:59], v[212:215]
ds_read_b64_tr_b16 v[82:83], v13 offset:33280
v_mfma_f32_16x16x32_bf16 v[212:215], a[92:95], v[60:63], v[212:215]
v_mfma_f32_16x16x32_bf16 v[216:219], a[144:147], v[48:51], v[216:219]
ds_read_b64_tr_b16 v[84:85], v13 offset:36864
v_mfma_f32_16x16x32_bf16 v[216:219], a[148:151], v[52:55], v[216:219]
v_mfma_f32_16x16x32_bf16 v[216:219], a[152:155], v[56:59], v[216:219]
ds_read_b64_tr_b16 v[86:87], v13 offset:37376
v_mfma_f32_16x16x32_bf16 v[216:219], a[156:159], v[60:63], v[216:219]
v_mfma_f32_16x16x32_bf16 v[220:223], a[208:211], v[48:51], v[220:223]
ds_read_b64_tr_b16 v[88:89], v13 offset:40960
v_mfma_f32_16x16x32_bf16 v[220:223], a[212:215], v[52:55], v[220:223]
v_mfma_f32_16x16x32_bf16 v[220:223], a[216:219], v[56:59], v[220:223]
ds_read_b64_tr_b16 v[90:91], v13 offset:41472
v_mfma_f32_16x16x32_bf16 v[220:223], a[220:223], v[60:63], v[220:223]
s_waitcnt lgkmcnt(6)
v_mfma_f32_16x16x32_bf16 v[224:227], a[16:19], v[64:67], v[224:227]
ds_read_b64_tr_b16 v[92:93], v13 offset:45056
v_mfma_f32_16x16x32_bf16 v[224:227], a[20:23], v[68:71], v[224:227]
v_mfma_f32_16x16x32_bf16 v[224:227], a[24:27], v[72:75], v[224:227]
ds_read_b64_tr_b16 v[94:95], v13 offset:45568
v_mfma_f32_16x16x32_bf16 v[224:227], a[28:31], v[76:79], v[224:227]
s_waitcnt vmcnt(18)
s_barrier
v_mfma_f32_16x16x32_bf16 v[228:231], a[80:83], v[64:67], v[228:231]
ds_read_b64_tr_b16 v[32:33], v22 offset:0
v_mfma_f32_16x16x32_bf16 v[228:231], a[84:87], v[68:71], v[228:231]
v_mfma_f32_16x16x32_bf16 v[228:231], a[88:91], v[72:75], v[228:231]
ds_read_b64_tr_b16 v[34:35], v22 offset:512
v_mfma_f32_16x16x32_bf16 v[228:231], a[92:95], v[76:79], v[228:231]
buffer_store_dwordx4 v[104:107], v16, s[36:39], s47 offen offset:2048 sc1
v_mfma_f32_16x16x32_bf16 v[232:235], a[144:147], v[64:67], v[232:235]
ds_read_b64_tr_b16 v[36:37], v22 offset:4096
v_mfma_f32_16x16x32_bf16 v[232:235], a[148:151], v[68:71], v[232:235]
v_mfma_f32_16x16x32_bf16 v[232:235], a[152:155], v[72:75], v[232:235]
ds_read_b64_tr_b16 v[38:39], v22 offset:4608
v_mfma_f32_16x16x32_bf16 v[232:235], a[156:159], v[76:79], v[232:235]
v_mfma_f32_16x16x32_bf16 v[236:239], a[208:211], v[64:67], v[236:239]
ds_read_b64_tr_b16 v[40:41], v22 offset:8192
v_mfma_f32_16x16x32_bf16 v[236:239], a[212:215], v[68:71], v[236:239]
v_mfma_f32_16x16x32_bf16 v[236:239], a[216:219], v[72:75], v[236:239]
ds_read_b64_tr_b16 v[42:43], v22 offset:8704
v_mfma_f32_16x16x32_bf16 v[236:239], a[220:223], v[76:79], v[236:239]
s_waitcnt lgkmcnt(6)
v_mfma_f32_16x16x32_bf16 v[240:243], a[16:19], v[80:83], v[240:243]
ds_read_b64_tr_b16 v[44:45], v22 offset:12288
v_mfma_f32_16x16x32_bf16 v[240:243], a[20:23], v[84:87], v[240:243]
v_mfma_f32_16x16x32_bf16 v[240:243], a[24:27], v[88:91], v[240:243]
ds_read_b64_tr_b16 v[46:47], v22 offset:12800
v_mfma_f32_16x16x32_bf16 v[240:243], a[28:31], v[92:95], v[240:243]
v_mfma_f32_16x16x32_bf16 v[244:247], a[80:83], v[80:83], v[244:247]
ds_read_b64_tr_b16 v[48:49], v23 offset:0
v_mfma_f32_16x16x32_bf16 v[244:247], a[84:87], v[84:87], v[244:247]
v_mfma_f32_16x16x32_bf16 v[244:247], a[88:91], v[88:91], v[244:247]
ds_read_b64_tr_b16 v[50:51], v23 offset:512
v_mfma_f32_16x16x32_bf16 v[244:247], a[92:95], v[92:95], v[244:247]
v_mfma_f32_16x16x32_bf16 v[248:251], a[144:147], v[80:83], v[248:251]
ds_read_b64_tr_b16 v[52:53], v23 offset:4096
v_mfma_f32_16x16x32_bf16 v[248:251], a[148:151], v[84:87], v[248:251]
v_mfma_f32_16x16x32_bf16 v[248:251], a[152:155], v[88:91], v[248:251]
ds_read_b64_tr_b16 v[54:55], v23 offset:4608
v_mfma_f32_16x16x32_bf16 v[248:251], a[156:159], v[92:95], v[248:251]
buffer_store_dwordx4 v[108:111], v16, s[36:39], s47 offen offset:3072 sc1
v_mfma_f32_16x16x32_bf16 v[252:255], a[208:211], v[80:83], v[252:255]
ds_read_b64_tr_b16 v[56:57], v23 offset:8192
v_mfma_f32_16x16x32_bf16 v[252:255], a[212:215], v[84:87], v[252:255]
v_mfma_f32_16x16x32_bf16 v[252:255], a[216:219], v[88:91], v[252:255]
ds_read_b64_tr_b16 v[58:59], v23 offset:8704
v_mfma_f32_16x16x32_bf16 v[252:255], a[220:223], v[92:95], v[252:255]
s_waitcnt lgkmcnt(6)
v_mfma_f32_16x16x32_bf16 v[192:195], a[32:35], v[32:35], v[192:195]
ds_read_b64_tr_b16 v[60:61], v23 offset:12288
v_mfma_f32_16x16x32_bf16 v[192:195], a[36:39], v[36:39], v[192:195]
v_mfma_f32_16x16x32_bf16 v[192:195], a[40:43], v[40:43], v[192:195]
ds_read_b64_tr_b16 v[62:63], v23 offset:12800
v_mfma_f32_16x16x32_bf16 v[192:195], a[44:47], v[44:47], v[192:195]
v_mfma_f32_16x16x32_bf16 v[196:199], a[96:99], v[32:35], v[196:199]
ds_read_b64_tr_b16 v[64:65], v24 offset:0
v_mfma_f32_16x16x32_bf16 v[196:199], a[100:103], v[36:39], v[196:199]
v_mfma_f32_16x16x32_bf16 v[196:199], a[104:107], v[40:43], v[196:199]
ds_read_b64_tr_b16 v[66:67], v24 offset:512
v_mfma_f32_16x16x32_bf16 v[196:199], a[108:111], v[44:47], v[196:199]
v_mfma_f32_16x16x32_bf16 v[200:203], a[160:163], v[32:35], v[200:203]
ds_read_b64_tr_b16 v[68:69], v24 offset:4096
v_mfma_f32_16x16x32_bf16 v[200:203], a[164:167], v[36:39], v[200:203]
v_cvt_pk_bf16_f32 v96, v136, v137
v_cvt_pk_bf16_f32 v97, v138, v139
v_mfma_f32_16x16x32_bf16 v[200:203], a[168:171], v[40:43], v[200:203]
ds_read_b64_tr_b16 v[70:71], v24 offset:4608
v_mfma_f32_16x16x32_bf16 v[200:203], a[172:175], v[44:47], v[200:203]
v_mfma_f32_16x16x32_bf16 v[204:207], a[224:227], v[32:35], v[204:207]
ds_read_b64_tr_b16 v[72:73], v24 offset:8192
v_mfma_f32_16x16x32_bf16 v[204:207], a[228:231], v[36:39], v[204:207]
v_cvt_pk_bf16_f32 v98, v140, v141
v_cvt_pk_bf16_f32 v99, v142, v143
v_mfma_f32_16x16x32_bf16 v[204:207], a[232:235], v[40:43], v[204:207]
ds_read_b64_tr_b16 v[74:75], v24 offset:8704
v_mfma_f32_16x16x32_bf16 v[204:207], a[236:239], v[44:47], v[204:207]
s_waitcnt lgkmcnt(6)
v_mfma_f32_16x16x32_bf16 v[208:211], a[32:35], v[48:51], v[208:211]
ds_read_b64_tr_b16 v[76:77], v24 offset:12288
v_mfma_f32_16x16x32_bf16 v[208:211], a[36:39], v[52:55], v[208:211]
v_cvt_pk_bf16_f32 v100, v152, v153
v_cvt_pk_bf16_f32 v101, v154, v155
v_mfma_f32_16x16x32_bf16 v[208:211], a[40:43], v[56:59], v[208:211]
ds_read_b64_tr_b16 v[78:79], v24 offset:12800
v_mfma_f32_16x16x32_bf16 v[208:211], a[44:47], v[60:63], v[208:211]
v_mfma_f32_16x16x32_bf16 v[212:215], a[96:99], v[48:51], v[212:215]
ds_read_b64_tr_b16 v[80:81], v25 offset:0
v_mfma_f32_16x16x32_bf16 v[212:215], a[100:103], v[52:55], v[212:215]
v_cvt_pk_bf16_f32 v102, v156, v157
v_cvt_pk_bf16_f32 v103, v158, v159
v_mfma_f32_16x16x32_bf16 v[212:215], a[104:107], v[56:59], v[212:215]
ds_read_b64_tr_b16 v[82:83], v25 offset:512
v_mfma_f32_16x16x32_bf16 v[212:215], a[108:111], v[60:63], v[212:215]
v_mfma_f32_16x16x32_bf16 v[216:219], a[160:163], v[48:51], v[216:219]
ds_read_b64_tr_b16 v[84:85], v25 offset:4096
v_mfma_f32_16x16x32_bf16 v[216:219], a[164:167], v[52:55], v[216:219]
v_mfma_f32_16x16x32_bf16 v[216:219], a[168:171], v[56:59], v[216:219]
ds_read_b64_tr_b16 v[86:87], v25 offset:4608
v_mfma_f32_16x16x32_bf16 v[216:219], a[172:175], v[60:63], v[216:219]
v_mfma_f32_16x16x32_bf16 v[220:223], a[224:227], v[48:51], v[220:223]
ds_read_b64_tr_b16 v[88:89], v25 offset:8192
v_mfma_f32_16x16x32_bf16 v[220:223], a[228:231], v[52:55], v[220:223]
v_mfma_f32_16x16x32_bf16 v[220:223], a[232:235], v[56:59], v[220:223]
ds_read_b64_tr_b16 v[90:91], v25 offset:8704
v_mfma_f32_16x16x32_bf16 v[220:223], a[236:239], v[60:63], v[220:223]
s_waitcnt lgkmcnt(6)
v_mfma_f32_16x16x32_bf16 v[224:227], a[32:35], v[64:67], v[224:227]
ds_read_b64_tr_b16 v[92:93], v25 offset:12288
v_mfma_f32_16x16x32_bf16 v[224:227], a[36:39], v[68:71], v[224:227]
v_mfma_f32_16x16x32_bf16 v[224:227], a[40:43], v[72:75], v[224:227]
ds_read_b64_tr_b16 v[94:95], v25 offset:12800
v_mfma_f32_16x16x32_bf16 v[224:227], a[44:47], v[76:79], v[224:227]
s_waitcnt vmcnt(6)
s_barrier
v_mfma_f32_16x16x32_bf16 v[228:231], a[96:99], v[64:67], v[228:231]
ds_read_b64_tr_b16 v[32:33], v18 offset:0
v_mfma_f32_16x16x32_bf16 v[228:231], a[100:103], v[68:71], v[228:231]
v_mfma_f32_16x16x32_bf16 v[228:231], a[104:107], v[72:75], v[228:231]
ds_read_b64_tr_b16 v[34:35], v18 offset:512
v_mfma_f32_16x16x32_bf16 v[228:231], a[108:111], v[76:79], v[228:231]
buffer_store_dwordx4 v[96:99], v16, s[36:39], s48 offen offset:0 sc1
v_mfma_f32_16x16x32_bf16 v[232:235], a[160:163], v[64:67], v[232:235]
ds_read_b64_tr_b16 v[36:37], v18 offset:4096
v_mfma_f32_16x16x32_bf16 v[232:235], a[164:167], v[68:71], v[232:235]
v_mfma_f32_16x16x32_bf16 v[232:235], a[168:171], v[72:75], v[232:235]
ds_read_b64_tr_b16 v[38:39], v18 offset:4608
v_mfma_f32_16x16x32_bf16 v[232:235], a[172:175], v[76:79], v[232:235]
v_mfma_f32_16x16x32_bf16 v[236:239], a[224:227], v[64:67], v[236:239]
ds_read_b64_tr_b16 v[40:41], v18 offset:8192
v_mfma_f32_16x16x32_bf16 v[236:239], a[228:231], v[68:71], v[236:239]
v_mfma_f32_16x16x32_bf16 v[236:239], a[232:235], v[72:75], v[236:239]
ds_read_b64_tr_b16 v[42:43], v18 offset:8704
v_mfma_f32_16x16x32_bf16 v[236:239], a[236:239], v[76:79], v[236:239]
s_waitcnt lgkmcnt(6)
v_mfma_f32_16x16x32_bf16 v[240:243], a[32:35], v[80:83], v[240:243]
ds_read_b64_tr_b16 v[44:45], v18 offset:12288
v_mfma_f32_16x16x32_bf16 v[240:243], a[36:39], v[84:87], v[240:243]
v_mfma_f32_16x16x32_bf16 v[240:243], a[40:43], v[88:91], v[240:243]
ds_read_b64_tr_b16 v[46:47], v18 offset:12800
v_mfma_f32_16x16x32_bf16 v[240:243], a[44:47], v[92:95], v[240:243]
v_mfma_f32_16x16x32_bf16 v[244:247], a[96:99], v[80:83], v[244:247]
ds_read_b64_tr_b16 v[48:49], v19 offset:0
v_mfma_f32_16x16x32_bf16 v[244:247], a[100:103], v[84:87], v[244:247]
v_mfma_f32_16x16x32_bf16 v[244:247], a[104:107], v[88:91], v[244:247]
ds_read_b64_tr_b16 v[50:51], v19 offset:512
v_mfma_f32_16x16x32_bf16 v[244:247], a[108:111], v[92:95], v[244:247]
v_mfma_f32_16x16x32_bf16 v[248:251], a[160:163], v[80:83], v[248:251]
ds_read_b64_tr_b16 v[52:53], v19 offset:4096
v_mfma_f32_16x16x32_bf16 v[248:251], a[164:167], v[84:87], v[248:251]
v_mfma_f32_16x16x32_bf16 v[248:251], a[168:171], v[88:91], v[248:251]
ds_read_b64_tr_b16 v[54:55], v19 offset:4608
v_mfma_f32_16x16x32_bf16 v[248:251], a[172:175], v[92:95], v[248:251]
buffer_store_dwordx4 v[100:103], v16, s[36:39], s48 offen offset:1024 sc1
v_mfma_f32_16x16x32_bf16 v[252:255], a[224:227], v[80:83], v[252:255]
ds_read_b64_tr_b16 v[56:57], v19 offset:8192
v_mfma_f32_16x16x32_bf16 v[252:255], a[228:231], v[84:87], v[252:255]
v_mfma_f32_16x16x32_bf16 v[252:255], a[232:235], v[88:91], v[252:255]
ds_read_b64_tr_b16 v[58:59], v19 offset:8704
v_mfma_f32_16x16x32_bf16 v[252:255], a[236:239], v[92:95], v[252:255]
s_waitcnt lgkmcnt(6)
v_mfma_f32_16x16x32_bf16 v[192:195], a[48:51], v[32:35], v[192:195]
ds_read_b64_tr_b16 v[60:61], v19 offset:12288
v_mfma_f32_16x16x32_bf16 v[192:195], a[52:55], v[36:39], v[192:195]
s_mov_b32 s78, 0x200000
s_mov_b32 s82, 0x400000
v_mfma_f32_16x16x32_bf16 v[192:195], a[56:59], v[40:43], v[192:195]
ds_read_b64_tr_b16 v[62:63], v19 offset:12800
v_mfma_f32_16x16x32_bf16 v[192:195], a[60:63], v[44:47], v[192:195]
buffer_load_dwordx4 v[112:115], v16, s[76:79], s84 offen offset:0
v_mfma_f32_16x16x32_bf16 v[196:199], a[112:115], v[32:35], v[196:199]
ds_read_b64_tr_b16 v[64:65], v20 offset:0
v_mfma_f32_16x16x32_bf16 v[196:199], a[116:119], v[36:39], v[196:199]
buffer_load_dwordx4 v[116:119], v16, s[76:79], s84 offen offset:1024
v_mfma_f32_16x16x32_bf16 v[196:199], a[120:123], v[40:43], v[196:199]
ds_read_b64_tr_b16 v[66:67], v20 offset:512
v_mfma_f32_16x16x32_bf16 v[196:199], a[124:127], v[44:47], v[196:199]
buffer_load_dwordx4 v[112:115], v16, s[80:83], s85 offen offset:0
v_mfma_f32_16x16x32_bf16 v[200:203], a[176:179], v[32:35], v[200:203]
ds_read_b64_tr_b16 v[68:69], v20 offset:4096
v_mfma_f32_16x16x32_bf16 v[200:203], a[180:183], v[36:39], v[200:203]
buffer_load_dwordx4 v[116:119], v16, s[80:83], s85 offen offset:1024
v_cvt_pk_bf16_f32 v104, v168, v169
v_cvt_pk_bf16_f32 v105, v170, v171
v_mfma_f32_16x16x32_bf16 v[200:203], a[184:187], v[40:43], v[200:203]
ds_read_b64_tr_b16 v[70:71], v20 offset:4608
v_mfma_f32_16x16x32_bf16 v[200:203], a[188:191], v[44:47], v[200:203]
buffer_load_dwordx4 v[120:123], v16, s[80:83], s85 offen offset:2048
v_mfma_f32_16x16x32_bf16 v[204:207], a[240:243], v[32:35], v[204:207]
ds_read_b64_tr_b16 v[72:73], v20 offset:8192
v_mfma_f32_16x16x32_bf16 v[204:207], a[244:247], v[36:39], v[204:207]
buffer_load_dwordx4 v[124:127], v16, s[80:83], s85 offen offset:3072
v_cvt_pk_bf16_f32 v106, v172, v173
v_cvt_pk_bf16_f32 v107, v174, v175
v_mfma_f32_16x16x32_bf16 v[204:207], a[248:251], v[40:43], v[204:207]
ds_read_b64_tr_b16 v[74:75], v20 offset:8704
v_mfma_f32_16x16x32_bf16 v[204:207], a[252:255], v[44:47], v[204:207]
s_waitcnt lgkmcnt(6)
v_mfma_f32_16x16x32_bf16 v[208:211], a[48:51], v[48:51], v[208:211]
ds_read_b64_tr_b16 v[76:77], v20 offset:12288
v_mfma_f32_16x16x32_bf16 v[208:211], a[52:55], v[52:55], v[208:211]
v_cvt_pk_bf16_f32 v108, v184, v185
v_cvt_pk_bf16_f32 v109, v186, v187
v_mfma_f32_16x16x32_bf16 v[208:211], a[56:59], v[56:59], v[208:211]
ds_read_b64_tr_b16 v[78:79], v20 offset:12800
v_mfma_f32_16x16x32_bf16 v[208:211], a[60:63], v[60:63], v[208:211]
v_mfma_f32_16x16x32_bf16 v[212:215], a[112:115], v[48:51], v[212:215]
ds_read_b64_tr_b16 v[80:81], v21 offset:0
v_mfma_f32_16x16x32_bf16 v[212:215], a[116:119], v[52:55], v[212:215]
v_cvt_pk_bf16_f32 v110, v188, v189
v_cvt_pk_bf16_f32 v111, v190, v191
v_mfma_f32_16x16x32_bf16 v[212:215], a[120:123], v[56:59], v[212:215]
ds_read_b64_tr_b16 v[82:83], v21 offset:512
v_mfma_f32_16x16x32_bf16 v[212:215], a[124:127], v[60:63], v[212:215]
v_mfma_f32_16x16x32_bf16 v[216:219], a[176:179], v[48:51], v[216:219]
ds_read_b64_tr_b16 v[84:85], v21 offset:4096
v_mfma_f32_16x16x32_bf16 v[216:219], a[180:183], v[52:55], v[216:219]
v_mfma_f32_16x16x32_bf16 v[216:219], a[184:187], v[56:59], v[216:219]
ds_read_b64_tr_b16 v[86:87], v21 offset:4608
v_mfma_f32_16x16x32_bf16 v[216:219], a[188:191], v[60:63], v[216:219]
v_mfma_f32_16x16x32_bf16 v[220:223], a[240:243], v[48:51], v[220:223]
ds_read_b64_tr_b16 v[88:89], v21 offset:8192
v_mfma_f32_16x16x32_bf16 v[220:223], a[244:247], v[52:55], v[220:223]
v_mfma_f32_16x16x32_bf16 v[220:223], a[248:251], v[56:59], v[220:223]
ds_read_b64_tr_b16 v[90:91], v21 offset:8704
v_mfma_f32_16x16x32_bf16 v[220:223], a[252:255], v[60:63], v[220:223]
s_waitcnt lgkmcnt(6)
v_mfma_f32_16x16x32_bf16 v[224:227], a[48:51], v[64:67], v[224:227]
ds_read_b64_tr_b16 v[92:93], v21 offset:12288
v_mfma_f32_16x16x32_bf16 v[224:227], a[52:55], v[68:71], v[224:227]
v_mfma_f32_16x16x32_bf16 v[224:227], a[56:59], v[72:75], v[224:227]
ds_read_b64_tr_b16 v[94:95], v21 offset:12800
v_mfma_f32_16x16x32_bf16 v[224:227], a[60:63], v[76:79], v[224:227]
v_mfma_f32_16x16x32_bf16 v[228:231], a[112:115], v[64:67], v[228:231]
ds_read_b64_tr_b16 v[32:33], v18 offset:49152
v_mfma_f32_16x16x32_bf16 v[228:231], a[116:119], v[68:71], v[228:231]
v_mfma_f32_16x16x32_bf16 v[228:231], a[120:123], v[72:75], v[228:231]
ds_read_b64_tr_b16 v[34:35], v18 offset:49664
v_mfma_f32_16x16x32_bf16 v[228:231], a[124:127], v[76:79], v[228:231]
buffer_store_dwordx4 v[104:107], v16, s[36:39], s48 offen offset:2048 sc1
v_mfma_f32_16x16x32_bf16 v[232:235], a[176:179], v[64:67], v[232:235]
ds_read_b64_tr_b16 v[36:37], v18 offset:53248
v_mfma_f32_16x16x32_bf16 v[232:235], a[180:183], v[68:71], v[232:235]
v_mfma_f32_16x16x32_bf16 v[232:235], a[184:187], v[72:75], v[232:235]
ds_read_b64_tr_b16 v[38:39], v18 offset:53760
v_mfma_f32_16x16x32_bf16 v[232:235], a[188:191], v[76:79], v[232:235]
v_mfma_f32_16x16x32_bf16 v[236:239], a[240:243], v[64:67], v[236:239]
ds_read_b64_tr_b16 v[40:41], v18 offset:57344
v_mfma_f32_16x16x32_bf16 v[236:239], a[244:247], v[68:71], v[236:239]
v_mfma_f32_16x16x32_bf16 v[236:239], a[248:251], v[72:75], v[236:239]
ds_read_b64_tr_b16 v[42:43], v18 offset:57856
v_mfma_f32_16x16x32_bf16 v[236:239], a[252:255], v[76:79], v[236:239]
s_waitcnt lgkmcnt(6)
v_mfma_f32_16x16x32_bf16 v[240:243], a[48:51], v[80:83], v[240:243]
ds_read_b64_tr_b16 v[44:45], v18 offset:61440
v_mfma_f32_16x16x32_bf16 v[240:243], a[52:55], v[84:87], v[240:243]
v_mfma_f32_16x16x32_bf16 v[240:243], a[56:59], v[88:91], v[240:243]
ds_read_b64_tr_b16 v[46:47], v18 offset:61952
v_mfma_f32_16x16x32_bf16 v[240:243], a[60:63], v[92:95], v[240:243]
v_mfma_f32_16x16x32_bf16 v[244:247], a[112:115], v[80:83], v[244:247]
ds_read_b64_tr_b16 v[48:49], v19 offset:49152
v_mfma_f32_16x16x32_bf16 v[244:247], a[116:119], v[84:87], v[244:247]
v_mfma_f32_16x16x32_bf16 v[244:247], a[120:123], v[88:91], v[244:247]
ds_read_b64_tr_b16 v[50:51], v19 offset:49664
v_mfma_f32_16x16x32_bf16 v[244:247], a[124:127], v[92:95], v[244:247]
v_mfma_f32_16x16x32_bf16 v[248:251], a[176:179], v[80:83], v[248:251]
ds_read_b64_tr_b16 v[52:53], v19 offset:53248
v_mfma_f32_16x16x32_bf16 v[248:251], a[180:183], v[84:87], v[248:251]
v_mfma_f32_16x16x32_bf16 v[248:251], a[184:187], v[88:91], v[248:251]
ds_read_b64_tr_b16 v[54:55], v19 offset:53760
v_mfma_f32_16x16x32_bf16 v[248:251], a[188:191], v[92:95], v[248:251]
buffer_store_dwordx4 v[108:111], v16, s[36:39], s48 offen offset:3072 sc1
v_mfma_f32_16x16x32_bf16 v[252:255], a[240:243], v[80:83], v[252:255]
ds_read_b64_tr_b16 v[56:57], v19 offset:57344
v_mfma_f32_16x16x32_bf16 v[252:255], a[244:247], v[84:87], v[252:255]
s_mov_b32 s47, s52
v_mfma_f32_16x16x32_bf16 v[252:255], a[248:251], v[88:91], v[252:255]
ds_read_b64_tr_b16 v[58:59], v19 offset:57856
v_mfma_f32_16x16x32_bf16 v[252:255], a[252:255], v[92:95], v[252:255]
s_mov_b32 s48, s58
s_cmp_eq_u32 s43, 0
s_cbranch_scc1 K1_FIN11
s_waitcnt lgkmcnt(6)
v_mfma_f32_16x16x32_bf16 v[128:131], a[0:3], v[32:35], 0
ds_read_b64_tr_b16 v[60:61], v19 offset:61440
v_mfma_f32_16x16x32_bf16 v[128:131], a[4:7], v[36:39], v[128:131]
s_barrier
v_mfma_f32_16x16x32_bf16 v[128:131], a[8:11], v[40:43], v[128:131]
ds_read_b64_tr_b16 v[62:63], v19 offset:61952
v_mfma_f32_16x16x32_bf16 v[128:131], a[12:15], v[44:47], v[128:131]
s_mov_b32 s78, 0x200000
s_mov_b32 s82, 0x400000
v_mfma_f32_16x16x32_bf16 v[132:135], a[64:67], v[32:35], 0
ds_read_b64_tr_b16 v[64:65], v20 offset:49152
v_mfma_f32_16x16x32_bf16 v[132:135], a[68:71], v[36:39], v[132:135]
s_lshr_b32 s90, s2, 5
s_bfe_u32 s91, s2, 0x20001
s_mov_b32 s92, 0x06543217
s_cmp_eq_u32 s91, 1
s_cselect_b32 s92, 0x76043215, s92
s_cmp_eq_u32 s91, 3
s_cselect_b32 s92, 0x04567321, s92
s_lshl_b32 s90, s90, 2
s_lshr_b32 s90, s92, s90
s_and_b32 s90, s90, 7
s_lshl_b32 s90, s90, 17
v_mfma_f32_16x16x32_bf16 v[132:135], a[72:75], v[40:43], v[132:135]
ds_read_b64_tr_b16 v[66:67], v20 offset:49664
v_mfma_f32_16x16x32_bf16 v[132:135], a[76:79], v[44:47], v[132:135]
s_lshl_b32 s91, s40, 15
s_sub_u32 s92, 1966080, s90
v_mfma_f32_16x16x32_bf16 v[136:139], a[128:131], v[32:35], 0
ds_read_b64_tr_b16 v[68:69], v20 offset:53248
v_mfma_f32_16x16x32_bf16 v[136:139], a[132:135], v[36:39], v[136:139]
v_cvt_pk_bf16_f32 v96, v192, v193
v_cvt_pk_bf16_f32 v97, v194, v195
v_mfma_f32_16x16x32_bf16 v[136:139], a[136:139], v[40:43], v[136:139]
ds_read_b64_tr_b16 v[70:71], v20 offset:53760
v_mfma_f32_16x16x32_bf16 v[136:139], a[140:143], v[44:47], v[136:139]
s_add_u32 s90, s90, s91
s_add_u32 s92, s92, s91
v_mfma_f32_16x16x32_bf16 v[140:143], a[192:195], v[32:35], 0
ds_read_b64_tr_b16 v[72:73], v20 offset:57344
v_mfma_f32_16x16x32_bf16 v[140:143], a[196:199], v[36:39], v[140:143]
v_cvt_pk_bf16_f32 v98, v196, v197
v_cvt_pk_bf16_f32 v99, v198, v199
v_mfma_f32_16x16x32_bf16 v[140:143], a[200:203], v[40:43], v[140:143]
ds_read_b64_tr_b16 v[74:75], v20 offset:57856
v_mfma_f32_16x16x32_bf16 v[140:143], a[204:207], v[44:47], v[140:143]
s_waitcnt lgkmcnt(6)
v_mfma_f32_16x16x32_bf16 v[144:147], a[0:3], v[48:51], 0
ds_read_b64_tr_b16 v[76:77], v20 offset:61440
v_mfma_f32_16x16x32_bf16 v[144:147], a[4:7], v[52:55], v[144:147]
v_cvt_pk_bf16_f32 v100, v208, v209
v_cvt_pk_bf16_f32 v101, v210, v211
v_mfma_f32_16x16x32_bf16 v[144:147], a[8:11], v[56:59], v[144:147]
ds_read_b64_tr_b16 v[78:79], v20 offset:61952
v_mfma_f32_16x16x32_bf16 v[144:147], a[12:15], v[60:63], v[144:147]
s_mov_b32 s93, 98304
v_mfma_f32_16x16x32_bf16 v[148:151], a[64:67], v[48:51], 0
ds_read_b64_tr_b16 v[80:81], v21 offset:49152
v_mfma_f32_16x16x32_bf16 v[148:151], a[68:71], v[52:55], v[148:151]
v_cvt_pk_bf16_f32 v102, v212, v213
v_cvt_pk_bf16_f32 v103, v214, v215
v_mfma_f32_16x16x32_bf16 v[148:151], a[72:75], v[56:59], v[148:151]
ds_read_b64_tr_b16 v[82:83], v21 offset:49664
v_mfma_f32_16x16x32_bf16 v[148:151], a[76:79], v[60:63], v[148:151]
s_cmp_eq_u32 s40, 1
s_cselect_b32 s93, 106496, s93
v_mfma_f32_16x16x32_bf16 v[152:155], a[128:131], v[48:51], 0
ds_read_b64_tr_b16 v[84:85], v21 offset:53248
v_mfma_f32_16x16x32_bf16 v[152:155], a[132:135], v[52:55], v[152:155]
s_cmp_eq_u32 s40, 2
s_cselect_b32 s93, 32768, s93
v_mfma_f32_16x16x32_bf16 v[152:155], a[136:139], v[56:59], v[152:155]
ds_read_b64_tr_b16 v[86:87], v21 offset:53760
v_mfma_f32_16x16x32_bf16 v[152:155], a[140:143], v[60:63], v[152:155]
s_cmp_eq_u32 s40, 3
s_cselect_b32 s93, 40960, s93
v_mfma_f32_16x16x32_bf16 v[156:159], a[192:195], v[48:51], 0
ds_read_b64_tr_b16 v[88:89], v21 offset:57344
v_mfma_f32_16x16x32_bf16 v[156:159], a[196:199], v[52:55], v[156:159]
s_add_u32 m0, s93, 0
s_nop 0
v_mfma_f32_16x16x32_bf16 v[156:159], a[200:203], v[56:59], v[156:159]
ds_read_b64_tr_b16 v[90:91], v21 offset:57856
v_mfma_f32_16x16x32_bf16 v[156:159], a[204:207], v[60:63], v[156:159]
s_waitcnt lgkmcnt(6)
v_mfma_f32_16x16x32_bf16 v[160:163], a[0:3], v[64:67], 0
ds_read_b64_tr_b16 v[92:93], v21 offset:61440
v_mfma_f32_16x16x32_bf16 v[160:163], a[4:7], v[68:71], v[160:163]
buffer_load_dwordx4 v6, s[76:79], s90 offen offset:0 lds
v_mfma_f32_16x16x32_bf16 v[160:163], a[8:11], v[72:75], v[160:163]
ds_read_b64_tr_b16 v[94:95], v21 offset:61952
v_mfma_f32_16x16x32_bf16 v[160:163], a[12:15], v[76:79], v[160:163]
v_mfma_f32_16x16x32_bf16 v[164:167], a[64:67], v[64:67], 0
ds_read_b64_tr_b16 v[32:33], v10 offset:49152
v_mfma_f32_16x16x32_bf16 v[164:167], a[68:71], v[68:71], v[164:167]
buffer_load_dwordx4 v7, s[76:79], s90 offen offset:1024 lds
v_mfma_f32_16x16x32_bf16 v[164:167], a[72:75], v[72:75], v[164:167]
ds_read_b64_tr_b16 v[34:35], v10 offset:49664
v_mfma_f32_16x16x32_bf16 v[164:167], a[76:79], v[76:79], v[164:167]
buffer_store_dwordx4 v[96:99], v16, s[36:39], s47 offen offset:0 sc1
v_mfma_f32_16x16x32_bf16 v[168:171], a[128:131], v[64:67], 0
ds_read_b64_tr_b16 v[36:37], v10 offset:53248
v_mfma_f32_16x16x32_bf16 v[168:171], a[132:135], v[68:71], v[168:171]
s_mov_b32 s52, s50
s_mov_b32 s58, s51
v_mfma_f32_16x16x32_bf16 v[168:171], a[136:139], v[72:75], v[168:171]
ds_read_b64_tr_b16 v[38:39], v10 offset:53760
v_mfma_f32_16x16x32_bf16 v[168:171], a[140:143], v[76:79], v[168:171]
s_add_u32 s41, s41, 1
v_mfma_f32_16x16x32_bf16 v[172:175], a[192:195], v[64:67], 0
ds_read_b64_tr_b16 v[40:41], v10 offset:57344
v_mfma_f32_16x16x32_bf16 v[172:175], a[196:199], v[68:71], v[172:175]
s_sub_u32 s43, s43, 1
v_mfma_f32_16x16x32_bf16 v[172:175], a[200:203], v[72:75], v[172:175]
ds_read_b64_tr_b16 v[42:43], v10 offset:57856
v_mfma_f32_16x16x32_bf16 v[172:175], a[204:207], v[76:79], v[172:175]
s_waitcnt lgkmcnt(6)
v_mfma_f32_16x16x32_bf16 v[176:179], a[0:3], v[80:83], 0
ds_read_b64_tr_b16 v[44:45], v10 offset:61440
v_mfma_f32_16x16x32_bf16 v[176:179], a[4:7], v[84:87], v[176:179]
s_lshr_b32 s60, s41, 1
v_mfma_f32_16x16x32_bf16 v[176:179], a[8:11], v[88:91], v[176:179]
ds_read_b64_tr_b16 v[46:47], v10 offset:61952
v_mfma_f32_16x16x32_bf16 v[176:179], a[12:15], v[92:95], v[176:179]
s_lshl_b32 s60, s60, 19
v_mfma_f32_16x16x32_bf16 v[180:183], a[64:67], v[80:83], 0
ds_read_b64_tr_b16 v[48:49], v11 offset:49152
v_mfma_f32_16x16x32_bf16 v[180:183], a[68:71], v[84:87], v[180:183]
s_and_b32 s61, s41, 1
v_mfma_f32_16x16x32_bf16 v[180:183], a[72:75], v[88:91], v[180:183]
ds_read_b64_tr_b16 v[50:51], v11 offset:49664
v_mfma_f32_16x16x32_bf16 v[180:183], a[76:79], v[92:95], v[180:183]
s_lshl_b32 s61, s61, 12
v_mfma_f32_16x16x32_bf16 v[184:187], a[128:131], v[80:83], 0
ds_read_b64_tr_b16 v[52:53], v11 offset:53248
v_mfma_f32_16x16x32_bf16 v[184:187], a[132:135], v[84:87], v[184:187]
s_add_u32 s60, s60, s61
v_mfma_f32_16x16x32_bf16 v[184:187], a[136:139], v[88:91], v[184:187]
ds_read_b64_tr_b16 v[54:55], v11 offset:53760
v_mfma_f32_16x16x32_bf16 v[184:187], a[140:143], v[92:95], v[184:187]
buffer_store_dwordx4 v[100:103], v16, s[36:39], s47 offen offset:1024 sc1
v_mfma_f32_16x16x32_bf16 v[188:191], a[192:195], v[80:83], 0
ds_read_b64_tr_b16 v[56:57], v11 offset:57344
v_mfma_f32_16x16x32_bf16 v[188:191], a[196:199], v[84:87], v[188:191]
s_lshl_b32 s61, s54, 13
v_mfma_f32_16x16x32_bf16 v[188:191], a[200:203], v[88:91], v[188:191]
ds_read_b64_tr_b16 v[58:59], v11 offset:57856
v_mfma_f32_16x16x32_bf16 v[188:191], a[204:207], v[92:95], v[188:191]
s_waitcnt lgkmcnt(6)
v_mfma_f32_16x16x32_bf16 v[128:131], a[16:19], v[32:35], v[128:131]
ds_read_b64_tr_b16 v[60:61], v11 offset:61440
v_mfma_f32_16x16x32_bf16 v[128:131], a[20:23], v[36:39], v[128:131]
s_add_u32 s50, s60, s61
v_mfma_f32_16x16x32_bf16 v[128:131], a[24:27], v[40:43], v[128:131]
ds_read_b64_tr_b16 v[62:63], v11 offset:61952
v_mfma_f32_16x16x32_bf16 v[128:131], a[28:31], v[44:47], v[128:131]
s_add_u32 s51, s50, 8192
v_mfma_f32_16x16x32_bf16 v[132:135], a[80:83], v[32:35], v[132:135]
ds_read_b64_tr_b16 v[64:65], v12 offset:49152
v_mfma_f32_16x16x32_bf16 v[132:135], a[84:87], v[36:39], v[132:135]
s_cmp_ge_u32 s41, 64
s_cselect_b32 s53, 1, 0
v_mfma_f32_16x16x32_bf16 v[132:135], a[88:91], v[40:43], v[132:135]
ds_read_b64_tr_b16 v[66:67], v12 offset:49664
v_mfma_f32_16x16x32_bf16 v[132:135], a[92:95], v[44:47], v[132:135]
s_sub_u32 s60, s41, 128
v_mfma_f32_16x16x32_bf16 v[136:139], a[144:147], v[32:35], v[136:139]
ds_read_b64_tr_b16 v[68:69], v12 offset:53248
v_mfma_f32_16x16x32_bf16 v[136:139], a[148:151], v[36:39], v[136:139]
s_cmp_lt_u32 s60, 16
s_cselect_b32 s53, 0, s53
v_cvt_pk_bf16_f32 v104, v224, v225
v_cvt_pk_bf16_f32 v105, v226, v227
v_mfma_f32_16x16x32_bf16 v[136:139], a[152:155], v[40:43], v[136:139]
ds_read_b64_tr_b16 v[70:71], v12 offset:53760
v_mfma_f32_16x16x32_bf16 v[136:139], a[156:159], v[44:47], v[136:139]
buffer_load_dwordx4 v8, s[76:79], s90 offen offset:2048 lds
v_mfma_f32_16x16x32_bf16 v[140:143], a[208:211], v[32:35], v[140:143]
ds_read_b64_tr_b16 v[72:73], v12 offset:57344
v_mfma_f32_16x16x32_bf16 v[140:143], a[212:215], v[36:39], v[140:143]
v_cvt_pk_bf16_f32 v106, v228, v229
v_cvt_pk_bf16_f32 v107, v230, v231
v_mfma_f32_16x16x32_bf16 v[140:143], a[216:219], v[40:43], v[140:143]
ds_read_b64_tr_b16 v[74:75], v12 offset:57856
v_mfma_f32_16x16x32_bf16 v[140:143], a[220:223], v[44:47], v[140:143]
s_waitcnt lgkmcnt(6)
v_mfma_f32_16x16x32_bf16 v[144:147], a[16:19], v[48:51], v[144:147]
ds_read_b64_tr_b16 v[76:77], v12 offset:61440
v_mfma_f32_16x16x32_bf16 v[144:147], a[20:23], v[52:55], v[144:147]
v_cvt_pk_bf16_f32 v108, v240, v241
v_cvt_pk_bf16_f32 v109, v242, v243
v_mfma_f32_16x16x32_bf16 v[144:147], a[24:27], v[56:59], v[144:147]
ds_read_b64_tr_b16 v[78:79], v12 offset:61952
v_mfma_f32_16x16x32_bf16 v[144:147], a[28:31], v[60:63], v[144:147]
buffer_load_dwordx4 v9, s[76:79], s90 offen offset:3072 lds
v_mfma_f32_16x16x32_bf16 v[148:151], a[80:83], v[48:51], v[148:151]
ds_read_b64_tr_b16 v[80:81], v13 offset:49152
v_mfma_f32_16x16x32_bf16 v[148:151], a[84:87], v[52:55], v[148:151]
v_cvt_pk_bf16_f32 v110, v244, v245
v_cvt_pk_bf16_f32 v111, v246, v247
v_mfma_f32_16x16x32_bf16 v[148:151], a[88:91], v[56:59], v[148:151]
ds_read_b64_tr_b16 v[82:83], v13 offset:49664
v_mfma_f32_16x16x32_bf16 v[148:151], a[92:95], v[60:63], v[148:151]
s_add_u32 m0, s93, 4096
s_nop 0
v_mfma_f32_16x16x32_bf16 v[152:155], a[144:147], v[48:51], v[152:155]
ds_read_b64_tr_b16 v[84:85], v13 offset:53248
v_mfma_f32_16x16x32_bf16 v[152:155], a[148:151], v[52:55], v[152:155]
buffer_load_dwordx4 v6, s[76:79], s92 offen offset:0 lds
v_mfma_f32_16x16x32_bf16 v[152:155], a[152:155], v[56:59], v[152:155]
ds_read_b64_tr_b16 v[86:87], v13 offset:53760
v_mfma_f32_16x16x32_bf16 v[152:155], a[156:159], v[60:63], v[152:155]
v_mfma_f32_16x16x32_bf16 v[156:159], a[208:211], v[48:51], v[156:159]
ds_read_b64_tr_b16 v[88:89], v13 offset:57344
v_mfma_f32_16x16x32_bf16 v[156:159], a[212:215], v[52:55], v[156:159]
buffer_load_dwordx4 v7, s[76:79], s92 offen offset:1024 lds
v_mfma_f32_16x16x32_bf16 v[156:159], a[216:219], v[56:59], v[156:159]
ds_read_b64_tr_b16 v[90:91], v13 offset:57856
v_mfma_f32_16x16x32_bf16 v[156:159], a[220:223], v[60:63], v[156:159]
s_waitcnt lgkmcnt(6)
v_mfma_f32_16x16x32_bf16 v[160:163], a[16:19], v[64:67], v[160:163]
ds_read_b64_tr_b16 v[92:93], v13 offset:61440
v_mfma_f32_16x16x32_bf16 v[160:163], a[20:23], v[68:71], v[160:163]
buffer_load_dwordx4 v8, s[76:79], s92 offen offset:2048 lds
v_mfma_f32_16x16x32_bf16 v[160:163], a[24:27], v[72:75], v[160:163]
ds_read_b64_tr_b16 v[94:95], v13 offset:61952
v_mfma_f32_16x16x32_bf16 v[160:163], a[28:31], v[76:79], v[160:163]
v_mfma_f32_16x16x32_bf16 v[164:167], a[80:83], v[64:67], v[164:167]
ds_read_b64_tr_b16 v[32:33], v22 offset:16384
v_mfma_f32_16x16x32_bf16 v[164:167], a[84:87], v[68:71], v[164:167]
buffer_load_dwordx4 v9, s[76:79], s92 offen offset:3072 lds
v_mfma_f32_16x16x32_bf16 v[164:167], a[88:91], v[72:75], v[164:167]
ds_read_b64_tr_b16 v[34:35], v22 offset:16896
v_mfma_f32_16x16x32_bf16 v[164:167], a[92:95], v[76:79], v[164:167]
buffer_store_dwordx4 v[104:107], v16, s[36:39], s47 offen offset:2048 sc1
v_mfma_f32_16x16x32_bf16 v[168:171], a[144:147], v[64:67], v[168:171]
ds_read_b64_tr_b16 v[36:37], v22 offset:20480
v_mfma_f32_16x16x32_bf16 v[168:171], a[148:151], v[68:71], v[168:171]
s_and_b32 s90, s2, 31
s_lshl_b32 s90, s90, 8
v_mfma_f32_16x16x32_bf16 v[168:171], a[152:155], v[72:75], v[168:171]
ds_read_b64_tr_b16 v[38:39], v22 offset:20992
v_mfma_f32_16x16x32_bf16 v[168:171], a[156:159], v[76:79], v[168:171]
s_lshl_b32 s91, s40, 17
s_add_u32 s90, s90, s91
v_mfma_f32_16x16x32_bf16 v[172:175], a[208:211], v[64:67], v[172:175]
ds_read_b64_tr_b16 v[40:41], v22 offset:24576
v_mfma_f32_16x16x32_bf16 v[172:175], a[212:215], v[68:71], v[172:175]
s_lshl_b32 s91, s40, 12
s_add_u32 m0, s91, 131072
v_mfma_f32_16x16x32_bf16 v[172:175], a[216:219], v[72:75], v[172:175]
ds_read_b64_tr_b16 v[42:43], v22 offset:25088
v_mfma_f32_16x16x32_bf16 v[172:175], a[220:223], v[76:79], v[172:175]
s_waitcnt lgkmcnt(6)
v_mfma_f32_16x16x32_bf16 v[176:179], a[16:19], v[80:83], v[176:179]
ds_read_b64_tr_b16 v[44:45], v22 offset:28672
v_mfma_f32_16x16x32_bf16 v[176:179], a[20:23], v[84:87], v[176:179]
v_lshrrev_b32 v14, 4, v0
v_lshlrev_b32 v15, 13, v14
v_mfma_f32_16x16x32_bf16 v[176:179], a[24:27], v[88:91], v[176:179]
ds_read_b64_tr_b16 v[46:47], v22 offset:29184
v_mfma_f32_16x16x32_bf16 v[176:179], a[28:31], v[92:95], v[176:179]
v_lshlrev_b32 v14, 1, v14
v_and_b32 v26, 15, v0
v_mfma_f32_16x16x32_bf16 v[180:183], a[80:83], v[80:83], v[180:183]
ds_read_b64_tr_b16 v[48:49], v23 offset:16384
v_mfma_f32_16x16x32_bf16 v[180:183], a[84:87], v[84:87], v[180:183]
v_xor_b32 v26, v26, v14
v_mfma_f32_16x16x32_bf16 v[180:183], a[88:91], v[88:91], v[180:183]
ds_read_b64_tr_b16 v[50:51], v23 offset:16896
v_mfma_f32_16x16x32_bf16 v[180:183], a[92:95], v[92:95], v[180:183]
v_xor_b32 v2, 0, v26
v_lshl_add_u32 v2, v2, 4, v15
v_mfma_f32_16x16x32_bf16 v[184:187], a[144:147], v[80:83], v[184:187]
ds_read_b64_tr_b16 v[52:53], v23 offset:20480
v_mfma_f32_16x16x32_bf16 v[184:187], a[148:151], v[84:87], v[184:187]
v_add_u32 v2, 0, v2
v_mfma_f32_16x16x32_bf16 v[184:187], a[152:155], v[88:91], v[184:187]
ds_read_b64_tr_b16 v[54:55], v23 offset:20992
v_mfma_f32_16x16x32_bf16 v[184:187], a[156:159], v[92:95], v[184:187]
buffer_store_dwordx4 v[108:111], v16, s[36:39], s47 offen offset:3072 sc1
v_mfma_f32_16x16x32_bf16 v[188:191], a[208:211], v[80:83], v[188:191]
ds_read_b64_tr_b16 v[56:57], v23 offset:24576
v_mfma_f32_16x16x32_bf16 v[188:191], a[212:215], v[84:87], v[188:191]
buffer_load_dwordx4 v2, s[80:83], s90 offen offset:0 lds
v_mfma_f32_16x16x32_bf16 v[188:191], a[216:219], v[88:91], v[188:191]
ds_read_b64_tr_b16 v[58:59], v23 offset:25088
v_mfma_f32_16x16x32_bf16 v[188:191], a[220:223], v[92:95], v[188:191]
s_waitcnt lgkmcnt(6)
v_mfma_f32_16x16x32_bf16 v[128:131], a[32:35], v[32:35], v[128:131]
ds_read_b64_tr_b16 v[60:61], v23 offset:28672
v_mfma_f32_16x16x32_bf16 v[128:131], a[36:39], v[36:39], v[128:131]
v_xor_b32 v3, 0, v26
v_lshl_add_u32 v3, v3, 4, v15
v_mfma_f32_16x16x32_bf16 v[128:131], a[40:43], v[40:43], v[128:131]
ds_read_b64_tr_b16 v[62:63], v23 offset:29184
v_mfma_f32_16x16x32_bf16 v[128:131], a[44:47], v[44:47], v[128:131]
v_add_u32 v3, 31744, v3
v_mfma_f32_16x16x32_bf16 v[132:135], a[96:99], v[32:35], v[132:135]
ds_read_b64_tr_b16 v[64:65], v24 offset:16384
v_mfma_f32_16x16x32_bf16 v[132:135], a[100:103], v[36:39], v[132:135]
buffer_load_dwordx4 v3, s[80:83], s90 offen offset:1024 lds
v_mfma_f32_16x16x32_bf16 v[132:135], a[104:107], v[40:43], v[132:135]
ds_read_b64_tr_b16 v[66:67], v24 offset:16896
v_mfma_f32_16x16x32_bf16 v[132:135], a[108:111], v[44:47], v[132:135]
v_mfma_f32_16x16x32_bf16 v[136:139], a[160:163], v[32:35], v[136:139]
ds_read_b64_tr_b16 v[68:69], v24 offset:20480
v_mfma_f32_16x16x32_bf16 v[136:139], a[164:167], v[36:39], v[136:139]
v_cvt_pk_bf16_f32 v96, v200, v201
v_cvt_pk_bf16_f32 v97, v202, v203
v_mfma_f32_16x16x32_bf16 v[136:139], a[168:171], v[40:43], v[136:139]
ds_read_b64_tr_b16 v[70:71], v24 offset:20992
v_mfma_f32_16x16x32_bf16 v[136:139], a[172:175], v[44:47], v[136:139]
v_xor_b32 v4, 8, v26
v_lshl_add_u32 v4, v4, 4, v15
v_mfma_f32_16x16x32_bf16 v[140:143], a[224:227], v[32:35], v[140:143]
ds_read_b64_tr_b16 v[72:73], v24 offset:24576
v_mfma_f32_16x16x32_bf16 v[140:143], a[228:231], v[36:39], v[140:143]
v_cvt_pk_bf16_f32 v98, v204, v205
v_cvt_pk_bf16_f32 v99, v206, v207
v_mfma_f32_16x16x32_bf16 v[140:143], a[232:235], v[40:43], v[140:143]
ds_read_b64_tr_b16 v[74:75], v24 offset:25088
v_mfma_f32_16x16x32_bf16 v[140:143], a[236:239], v[44:47], v[140:143]
s_waitcnt lgkmcnt(6)
v_mfma_f32_16x16x32_bf16 v[144:147], a[32:35], v[48:51], v[144:147]
ds_read_b64_tr_b16 v[76:77], v24 offset:28672
v_mfma_f32_16x16x32_bf16 v[144:147], a[36:39], v[52:55], v[144:147]
v_cvt_pk_bf16_f32 v100, v216, v217
v_cvt_pk_bf16_f32 v101, v218, v219
v_mfma_f32_16x16x32_bf16 v[144:147], a[40:43], v[56:59], v[144:147]
ds_read_b64_tr_b16 v[78:79], v24 offset:29184
v_mfma_f32_16x16x32_bf16 v[144:147], a[44:47], v[60:63], v[144:147]
v_add_u32 v4, 63488, v4
v_mfma_f32_16x16x32_bf16 v[148:151], a[96:99], v[48:51], v[148:151]
ds_read_b64_tr_b16 v[80:81], v25 offset:16384
v_mfma_f32_16x16x32_bf16 v[148:151], a[100:103], v[52:55], v[148:151]
v_cvt_pk_bf16_f32 v102, v220, v221
v_cvt_pk_bf16_f32 v103, v222, v223
v_mfma_f32_16x16x32_bf16 v[148:151], a[104:107], v[56:59], v[148:151]
ds_read_b64_tr_b16 v[82:83], v25 offset:16896
v_mfma_f32_16x16x32_bf16 v[148:151], a[108:111], v[60:63], v[148:151]
buffer_load_dwordx4 v4, s[80:83], s90 offen offset:2048 lds
v_mfma_f32_16x16x32_bf16 v[152:155], a[160:163], v[48:51], v[152:155]
ds_read_b64_tr_b16 v[84:85], v25 offset:20480
v_mfma_f32_16x16x32_bf16 v[152:155], a[164:167], v[52:55], v[152:155]
v_mfma_f32_16x16x32_bf16 v[152:155], a[168:171], v[56:59], v[152:155]
ds_read_b64_tr_b16 v[86:87], v25 offset:20992
v_mfma_f32_16x16x32_bf16 v[152:155], a[172:175], v[60:63], v[152:155]
v_xor_b32 v5, 8, v26
v_lshl_add_u32 v5, v5, 4, v15
v_mfma_f32_16x16x32_bf16 v[156:159], a[224:227], v[48:51], v[156:159]
ds_read_b64_tr_b16 v[88:89], v25 offset:24576
v_mfma_f32_16x16x32_bf16 v[156:159], a[228:231], v[52:55], v[156:159]
v_add_u32 v5, 95232, v5
v_mfma_f32_16x16x32_bf16 v[156:159], a[232:235], v[56:59], v[156:159]
ds_read_b64_tr_b16 v[90:91], v25 offset:25088
v_mfma_f32_16x16x32_bf16 v[156:159], a[236:239], v[60:63], v[156:159]
s_waitcnt lgkmcnt(6)
v_mfma_f32_16x16x32_bf16 v[160:163], a[32:35], v[64:67], v[160:163]
ds_read_b64_tr_b16 v[92:93], v25 offset:28672
v_mfma_f32_16x16x32_bf16 v[160:163], a[36:39], v[68:71], v[160:163]
buffer_load_dwordx4 v5, s[80:83], s90 offen offset:3072 lds
v_mfma_f32_16x16x32_bf16 v[160:163], a[40:43], v[72:75], v[160:163]
ds_read_b64_tr_b16 v[94:95], v25 offset:29184
v_mfma_f32_16x16x32_bf16 v[160:163], a[44:47], v[76:79], v[160:163]
v_mfma_f32_16x16x32_bf16 v[164:167], a[96:99], v[64:67], v[164:167]
ds_read_b64_tr_b16 v[32:33], v18 offset:16384
v_mfma_f32_16x16x32_bf16 v[164:167], a[100:103], v[68:71], v[164:167]
v_mfma_f32_16x16x32_bf16 v[164:167], a[104:107], v[72:75], v[164:167]
ds_read_b64_tr_b16 v[34:35], v18 offset:16896
v_mfma_f32_16x16x32_bf16 v[164:167], a[108:111], v[76:79], v[164:167]
buffer_store_dwordx4 v[96:99], v16, s[36:39], s48 offen offset:0 sc1
v_mfma_f32_16x16x32_bf16 v[168:171], a[160:163], v[64:67], v[168:171]
ds_read_b64_tr_b16 v[36:37], v18 offset:20480
v_mfma_f32_16x16x32_bf16 v[168:171], a[164:167], v[68:71], v[168:171]
v_mfma_f32_16x16x32_bf16 v[168:171], a[168:171], v[72:75], v[168:171]
ds_read_b64_tr_b16 v[38:39], v18 offset:20992
v_mfma_f32_16x16x32_bf16 v[168:171], a[172:175], v[76:79], v[168:171]
v_mfma_f32_16x16x32_bf16 v[172:175], a[224:227], v[64:67], v[172:175]
ds_read_b64_tr_b16 v[40:41], v18 offset:24576
v_mfma_f32_16x16x32_bf16 v[172:175], a[228:231], v[68:71], v[172:175]
v_mfma_f32_16x16x32_bf16 v[172:175], a[232:235], v[72:75], v[172:175]
ds_read_b64_tr_b16 v[42:43], v18 offset:25088
v_mfma_f32_16x16x32_bf16 v[172:175], a[236:239], v[76:79], v[172:175]
s_waitcnt lgkmcnt(6)
v_mfma_f32_16x16x32_bf16 v[176:179], a[32:35], v[80:83], v[176:179]
ds_read_b64_tr_b16 v[44:45], v18 offset:28672
v_mfma_f32_16x16x32_bf16 v[176:179], a[36:39], v[84:87], v[176:179]
v_mfma_f32_16x16x32_bf16 v[176:179], a[40:43], v[88:91], v[176:179]
ds_read_b64_tr_b16 v[46:47], v18 offset:29184
v_mfma_f32_16x16x32_bf16 v[176:179], a[44:47], v[92:95], v[176:179]
v_mfma_f32_16x16x32_bf16 v[180:183], a[96:99], v[80:83], v[180:183]
ds_read_b64_tr_b16 v[48:49], v19 offset:16384
v_mfma_f32_16x16x32_bf16 v[180:183], a[100:103], v[84:87], v[180:183]
v_mfma_f32_16x16x32_bf16 v[180:183], a[104:107], v[88:91], v[180:183]
ds_read_b64_tr_b16 v[50:51], v19 offset:16896
v_mfma_f32_16x16x32_bf16 v[180:183], a[108:111], v[92:95], v[180:183]
v_mfma_f32_16x16x32_bf16 v[184:187], a[160:163], v[80:83], v[184:187]
ds_read_b64_tr_b16 v[52:53], v19 offset:20480
v_mfma_f32_16x16x32_bf16 v[184:187], a[164:167], v[84:87], v[184:187]
v_mfma_f32_16x16x32_bf16 v[184:187], a[168:171], v[88:91], v[184:187]
ds_read_b64_tr_b16 v[54:55], v19 offset:20992
v_mfma_f32_16x16x32_bf16 v[184:187], a[172:175], v[92:95], v[184:187]
buffer_store_dwordx4 v[100:103], v16, s[36:39], s48 offen offset:1024 sc1
v_mfma_f32_16x16x32_bf16 v[188:191], a[224:227], v[80:83], v[188:191]
ds_read_b64_tr_b16 v[56:57], v19 offset:24576
v_mfma_f32_16x16x32_bf16 v[188:191], a[228:231], v[84:87], v[188:191]
v_mfma_f32_16x16x32_bf16 v[188:191], a[232:235], v[88:91], v[188:191]
ds_read_b64_tr_b16 v[58:59], v19 offset:25088
v_mfma_f32_16x16x32_bf16 v[188:191], a[236:239], v[92:95], v[188:191]
s_waitcnt lgkmcnt(6)
v_mfma_f32_16x16x32_bf16 v[128:131], a[48:51], v[32:35], v[128:131]
ds_read_b64_tr_b16 v[60:61], v19 offset:28672
v_mfma_f32_16x16x32_bf16 v[128:131], a[52:55], v[36:39], v[128:131]
v_mfma_f32_16x16x32_bf16 v[128:131], a[56:59], v[40:43], v[128:131]
ds_read_b64_tr_b16 v[62:63], v19 offset:29184
v_mfma_f32_16x16x32_bf16 v[128:131], a[60:63], v[44:47], v[128:131]
v_mfma_f32_16x16x32_bf16 v[132:135], a[112:115], v[32:35], v[132:135]
ds_read_b64_tr_b16 v[64:65], v20 offset:16384
v_mfma_f32_16x16x32_bf16 v[132:135], a[116:119], v[36:39], v[132:135]
v_mfma_f32_16x16x32_bf16 v[132:135], a[120:123], v[40:43], v[132:135]
ds_read_b64_tr_b16 v[66:67], v20 offset:16896
v_mfma_f32_16x16x32_bf16 v[132:135], a[124:127], v[44:47], v[132:135]
v_mfma_f32_16x16x32_bf16 v[136:139], a[176:179], v[32:35], v[136:139]
ds_read_b64_tr_b16 v[68:69], v20 offset:20480
v_mfma_f32_16x16x32_bf16 v[136:139], a[180:183], v[36:39], v[136:139]
v_cvt_pk_bf16_f32 v104, v232, v233
v_cvt_pk_bf16_f32 v105, v234, v235
v_mfma_f32_16x16x32_bf16 v[136:139], a[184:187], v[40:43], v[136:139]
ds_read_b64_tr_b16 v[70:71], v20 offset:20992
v_mfma_f32_16x16x32_bf16 v[136:139], a[188:191], v[44:47], v[136:139]
v_mfma_f32_16x16x32_bf16 v[140:143], a[240:243], v[32:35], v[140:143]
ds_read_b64_tr_b16 v[72:73], v20 offset:24576
v_mfma_f32_16x16x32_bf16 v[140:143], a[244:247], v[36:39], v[140:143]
v_cvt_pk_bf16_f32 v106, v236, v237
v_cvt_pk_bf16_f32 v107, v238, v239
v_mfma_f32_16x16x32_bf16 v[140:143], a[248:251], v[40:43], v[140:143]
ds_read_b64_tr_b16 v[74:75], v20 offset:25088
v_mfma_f32_16x16x32_bf16 v[140:143], a[252:255], v[44:47], v[140:143]
s_waitcnt lgkmcnt(6)
v_mfma_f32_16x16x32_bf16 v[144:147], a[48:51], v[48:51], v[144:147]
ds_read_b64_tr_b16 v[76:77], v20 offset:28672
v_mfma_f32_16x16x32_bf16 v[144:147], a[52:55], v[52:55], v[144:147]
v_cvt_pk_bf16_f32 v108, v248, v249
v_cvt_pk_bf16_f32 v109, v250, v251
v_mfma_f32_16x16x32_bf16 v[144:147], a[56:59], v[56:59], v[144:147]
ds_read_b64_tr_b16 v[78:79], v20 offset:29184
v_mfma_f32_16x16x32_bf16 v[144:147], a[60:63], v[60:63], v[144:147]
v_mfma_f32_16x16x32_bf16 v[148:151], a[112:115], v[48:51], v[148:151]
ds_read_b64_tr_b16 v[80:81], v21 offset:16384
v_mfma_f32_16x16x32_bf16 v[148:151], a[116:119], v[52:55], v[148:151]
v_cvt_pk_bf16_f32 v110, v252, v253
v_cvt_pk_bf16_f32 v111, v254, v255
v_mfma_f32_16x16x32_bf16 v[148:151], a[120:123], v[56:59], v[148:151]
ds_read_b64_tr_b16 v[82:83], v21 offset:16896
v_mfma_f32_16x16x32_bf16 v[148:151], a[124:127], v[60:63], v[148:151]
v_mfma_f32_16x16x32_bf16 v[152:155], a[176:179], v[48:51], v[152:155]
ds_read_b64_tr_b16 v[84:85], v21 offset:20480
v_mfma_f32_16x16x32_bf16 v[152:155], a[180:183], v[52:55], v[152:155]
v_mfma_f32_16x16x32_bf16 v[152:155], a[184:187], v[56:59], v[152:155]
ds_read_b64_tr_b16 v[86:87], v21 offset:20992
v_mfma_f32_16x16x32_bf16 v[152:155], a[188:191], v[60:63], v[152:155]
v_mfma_f32_16x16x32_bf16 v[156:159], a[240:243], v[48:51], v[156:159]
ds_read_b64_tr_b16 v[88:89], v21 offset:24576
v_mfma_f32_16x16x32_bf16 v[156:159], a[244:247], v[52:55], v[156:159]
v_mfma_f32_16x16x32_bf16 v[156:159], a[248:251], v[56:59], v[156:159]
ds_read_b64_tr_b16 v[90:91], v21 offset:25088
v_mfma_f32_16x16x32_bf16 v[156:159], a[252:255], v[60:63], v[156:159]
s_waitcnt lgkmcnt(6)
v_mfma_f32_16x16x32_bf16 v[160:163], a[48:51], v[64:67], v[160:163]
ds_read_b64_tr_b16 v[92:93], v21 offset:28672
v_mfma_f32_16x16x32_bf16 v[160:163], a[52:55], v[68:71], v[160:163]
v_mfma_f32_16x16x32_bf16 v[160:163], a[56:59], v[72:75], v[160:163]
ds_read_b64_tr_b16 v[94:95], v21 offset:29184
v_mfma_f32_16x16x32_bf16 v[160:163], a[60:63], v[76:79], v[160:163]
v_mfma_f32_16x16x32_bf16 v[164:167], a[112:115], v[64:67], v[164:167]
v_mfma_f32_16x16x32_bf16 v[164:167], a[116:119], v[68:71], v[164:167]
v_mfma_f32_16x16x32_bf16 v[164:167], a[120:123], v[72:75], v[164:167]
v_mfma_f32_16x16x32_bf16 v[164:167], a[124:127], v[76:79], v[164:167]
buffer_store_dwordx4 v[104:107], v16, s[36:39], s48 offen offset:2048 sc1
v_mfma_f32_16x16x32_bf16 v[168:171], a[176:179], v[64:67], v[168:171]
v_mfma_f32_16x16x32_bf16 v[168:171], a[180:183], v[68:71], v[168:171]
v_mfma_f32_16x16x32_bf16 v[168:171], a[184:187], v[72:75], v[168:171]
v_mfma_f32_16x16x32_bf16 v[168:171], a[188:191], v[76:79], v[168:171]
v_mfma_f32_16x16x32_bf16 v[172:175], a[240:243], v[64:67], v[172:175]
v_mfma_f32_16x16x32_bf16 v[172:175], a[244:247], v[68:71], v[172:175]
v_mfma_f32_16x16x32_bf16 v[172:175], a[248:251], v[72:75], v[172:175]
v_mfma_f32_16x16x32_bf16 v[172:175], a[252:255], v[76:79], v[172:175]
s_waitcnt lgkmcnt(0)
v_mfma_f32_16x16x32_bf16 v[176:179], a[48:51], v[80:83], v[176:179]
v_mfma_f32_16x16x32_bf16 v[176:179], a[52:55], v[84:87], v[176:179]
v_mfma_f32_16x16x32_bf16 v[176:179], a[56:59], v[88:91], v[176:179]
v_mfma_f32_16x16x32_bf16 v[176:179], a[60:63], v[92:95], v[176:179]
v_mfma_f32_16x16x32_bf16 v[180:183], a[112:115], v[80:83], v[180:183]
v_mfma_f32_16x16x32_bf16 v[180:183], a[116:119], v[84:87], v[180:183]
v_mfma_f32_16x16x32_bf16 v[180:183], a[120:123], v[88:91], v[180:183]
v_mfma_f32_16x16x32_bf16 v[180:183], a[124:127], v[92:95], v[180:183]
v_mfma_f32_16x16x32_bf16 v[184:187], a[176:179], v[80:83], v[184:187]
v_mfma_f32_16x16x32_bf16 v[184:187], a[180:183], v[84:87], v[184:187]
v_mfma_f32_16x16x32_bf16 v[184:187], a[184:187], v[88:91], v[184:187]
v_mfma_f32_16x16x32_bf16 v[184:187], a[188:191], v[92:95], v[184:187]
buffer_store_dwordx4 v[108:111], v16, s[36:39], s48 offen offset:3072 sc1
v_mfma_f32_16x16x32_bf16 v[188:191], a[240:243], v[80:83], v[188:191]
v_mfma_f32_16x16x32_bf16 v[188:191], a[244:247], v[84:87], v[188:191]
s_mov_b32 s47, s52
v_mfma_f32_16x16x32_bf16 v[188:191], a[248:251], v[88:91], v[188:191]
v_mfma_f32_16x16x32_bf16 v[188:191], a[252:255], v[92:95], v[188:191]
s_mov_b32 s48, s58
s_nop 7
v_cvt_pk_bf16_f32 v96, v128, v129
v_cvt_pk_bf16_f32 v97, v130, v131
v_cvt_pk_bf16_f32 v98, v132, v133
v_cvt_pk_bf16_f32 v99, v134, v135
buffer_store_dwordx4 v[96:99], v16, s[36:39], s47 offen offset:0 sc1
v_cvt_pk_bf16_f32 v100, v144, v145
v_cvt_pk_bf16_f32 v101, v146, v147
v_cvt_pk_bf16_f32 v102, v148, v149
v_cvt_pk_bf16_f32 v103, v150, v151
buffer_store_dwordx4 v[100:103], v16, s[36:39], s47 offen offset:1024 sc1
v_cvt_pk_bf16_f32 v104, v160, v161
v_cvt_pk_bf16_f32 v105, v162, v163
v_cvt_pk_bf16_f32 v106, v164, v165
v_cvt_pk_bf16_f32 v107, v166, v167
buffer_store_dwordx4 v[104:107], v16, s[36:39], s47 offen offset:2048 sc1
v_cvt_pk_bf16_f32 v108, v176, v177
v_cvt_pk_bf16_f32 v109, v178, v179
v_cvt_pk_bf16_f32 v110, v180, v181
v_cvt_pk_bf16_f32 v111, v182, v183
buffer_store_dwordx4 v[108:111], v16, s[36:39], s47 offen offset:3072 sc1
v_cvt_pk_bf16_f32 v96, v136, v137
v_cvt_pk_bf16_f32 v97, v138, v139
v_cvt_pk_bf16_f32 v98, v140, v141
v_cvt_pk_bf16_f32 v99, v142, v143
buffer_store_dwordx4 v[96:99], v16, s[36:39], s48 offen offset:0 sc1
v_cvt_pk_bf16_f32 v100, v152, v153
v_cvt_pk_bf16_f32 v101, v154, v155
v_cvt_pk_bf16_f32 v102, v156, v157
v_cvt_pk_bf16_f32 v103, v158, v159
buffer_store_dwordx4 v[100:103], v16, s[36:39], s48 offen offset:1024 sc1
v_cvt_pk_bf16_f32 v104, v168, v169
v_cvt_pk_bf16_f32 v105, v170, v171
v_cvt_pk_bf16_f32 v106, v172, v173
v_cvt_pk_bf16_f32 v107, v174, v175
buffer_store_dwordx4 v[104:107], v16, s[36:39], s48 offen offset:2048 sc1
v_cvt_pk_bf16_f32 v108, v184, v185
v_cvt_pk_bf16_f32 v109, v186, v187
v_cvt_pk_bf16_f32 v110, v188, v189
v_cvt_pk_bf16_f32 v111, v190, v191
buffer_store_dwordx4 v[108:111], v16, s[36:39], s48 offen offset:3072 sc1
s_branch K1_END2
K1_FIN11:
s_barrier
s_call_b64 s[88:89], K1_Q0
s_nop 7
v_cvt_pk_bf16_f32 v96, v192, v193
v_cvt_pk_bf16_f32 v97, v194, v195
v_cvt_pk_bf16_f32 v98, v196, v197
v_cvt_pk_bf16_f32 v99, v198, v199
buffer_store_dwordx4 v[96:99], v16, s[36:39], s47 offen offset:0 sc1
v_cvt_pk_bf16_f32 v100, v208, v209
v_cvt_pk_bf16_f32 v101, v210, v211
v_cvt_pk_bf16_f32 v102, v212, v213
v_cvt_pk_bf16_f32 v103, v214, v215
buffer_store_dwordx4 v[100:103], v16, s[36:39], s47 offen offset:1024 sc1
v_cvt_pk_bf16_f32 v104, v224, v225
v_cvt_pk_bf16_f32 v105, v226, v227
v_cvt_pk_bf16_f32 v106, v228, v229
v_cvt_pk_bf16_f32 v107, v230, v231
buffer_store_dwordx4 v[104:107], v16, s[36:39], s47 offen offset:2048 sc1
v_cvt_pk_bf16_f32 v108, v240, v241
v_cvt_pk_bf16_f32 v109, v242, v243
v_cvt_pk_bf16_f32 v110, v244, v245
v_cvt_pk_bf16_f32 v111, v246, v247
buffer_store_dwordx4 v[108:111], v16, s[36:39], s47 offen offset:3072 sc1
v_cvt_pk_bf16_f32 v96, v200, v201
v_cvt_pk_bf16_f32 v97, v202, v203
v_cvt_pk_bf16_f32 v98, v204, v205
v_cvt_pk_bf16_f32 v99, v206, v207
buffer_store_dwordx4 v[96:99], v16, s[36:39], s48 offen offset:0 sc1
v_cvt_pk_bf16_f32 v100, v216, v217
v_cvt_pk_bf16_f32 v101, v218, v219
v_cvt_pk_bf16_f32 v102, v220, v221
v_cvt_pk_bf16_f32 v103, v222, v223
buffer_store_dwordx4 v[100:103], v16, s[36:39], s48 offen offset:1024 sc1
v_cvt_pk_bf16_f32 v104, v232, v233
v_cvt_pk_bf16_f32 v105, v234, v235
v_cvt_pk_bf16_f32 v106, v236, v237
v_cvt_pk_bf16_f32 v107, v238, v239
buffer_store_dwordx4 v[104:107], v16, s[36:39], s48 offen offset:2048 sc1
v_cvt_pk_bf16_f32 v108, v248, v249
v_cvt_pk_bf16_f32 v109, v250, v251
v_cvt_pk_bf16_f32 v110, v252, v253
v_cvt_pk_bf16_f32 v111, v254, v255
buffer_store_dwordx4 v[108:111], v16, s[36:39], s48 offen offset:3072 sc1
s_waitcnt vmcnt(0)
s_branch K1_END2
K1_P0:
s_waitcnt lgkmcnt(6)
v_mfma_f32_16x16x32_bf16 v[128:131], v[32:35], a[0:3], 0
ds_read_b64_tr_b16 v[60:61], v19 offset:12288
v_mfma_f32_16x16x32_bf16 v[128:131], v[36:39], a[4:7], v[128:131]
s_add_u32 m0, s56, 98304
v_mfma_f32_16x16x32_bf16 v[128:131], v[40:43], a[8:11], v[128:131]
ds_read_b64_tr_b16 v[62:63], v19 offset:12800
v_mfma_f32_16x16x32_bf16 v[128:131], v[44:47], a[12:15], v[128:131]
buffer_load_dwordx4 v2, s[32:35], s45 offen offset:0 lds
v_mfma_f32_16x16x32_bf16 v[132:135], v[32:35], a[64:67], 0
ds_read_b64_tr_b16 v[64:65], v20 offset:0
v_mfma_f32_16x16x32_bf16 v[132:135], v[36:39], a[68:71], v[132:135]
v_mfma_f32_16x16x32_bf16 v[132:135], v[40:43], a[72:75], v[132:135]
ds_read_b64_tr_b16 v[66:67], v20 offset:512
v_mfma_f32_16x16x32_bf16 v[132:135], v[44:47], a[76:79], v[132:135]
buffer_load_dwordx4 v3, s[32:35], s45 offen offset:1024 lds
v_mfma_f32_16x16x32_bf16 v[136:139], v[32:35], a[128:131], 0
ds_read_b64_tr_b16 v[68:69], v20 offset:4096
v_mfma_f32_16x16x32_bf16 v[136:139], v[36:39], a[132:135], v[136:139]
v_mul_f32 v192, s49, v192
v_mul_f32 v193, s49, v193
v_mfma_f32_16x16x32_bf16 v[136:139], v[40:43], a[136:139], v[136:139]
ds_read_b64_tr_b16 v[70:71], v20 offset:4608
v_mfma_f32_16x16x32_bf16 v[136:139], v[44:47], a[140:143], v[136:139]
buffer_load_dwordx4 v4, s[32:35], s45 offen offset:2048 lds
v_mfma_f32_16x16x32_bf16 v[140:143], v[32:35], a[192:195], 0
ds_read_b64_tr_b16 v[72:73], v20 offset:8192
v_mfma_f32_16x16x32_bf16 v[140:143], v[36:39], a[196:199], v[140:143]
v_mul_f32 v194, s49, v194
v_mul_f32 v195, s49, v195
v_mfma_f32_16x16x32_bf16 v[140:143], v[40:43], a[200:203], v[140:143]
ds_read_b64_tr_b16 v[74:75], v20 offset:8704
v_mfma_f32_16x16x32_bf16 v[140:143], v[44:47], a[204:207], v[140:143]
s_waitcnt lgkmcnt(6)
buffer_load_dwordx4 v5, s[32:35], s45 offen offset:3072 lds
v_mfma_f32_16x16x32_bf16 v[144:147], v[48:51], a[0:3], 0
ds_read_b64_tr_b16 v[76:77], v20 offset:12288
v_mfma_f32_16x16x32_bf16 v[144:147], v[52:55], a[4:7], v[144:147]
s_add_u32 m0, s56, 114688
v_mul_f32 v208, s49, v208
v_mul_f32 v209, s49, v209
v_mfma_f32_16x16x32_bf16 v[144:147], v[56:59], a[8:11], v[144:147]
ds_read_b64_tr_b16 v[78:79], v20 offset:12800
v_mfma_f32_16x16x32_bf16 v[144:147], v[60:63], a[12:15], v[144:147]
buffer_load_dwordx4 v2, s[96:99], s45 offen offset:0 lds
v_mfma_f32_16x16x32_bf16 v[148:151], v[48:51], a[64:67], 0
ds_read_b64_tr_b16 v[80:81], v21 offset:0
v_mfma_f32_16x16x32_bf16 v[148:151], v[52:55], a[68:71], v[148:151]
v_mul_f32 v210, s49, v210
v_mul_f32 v211, s49, v211
v_mfma_f32_16x16x32_bf16 v[148:151], v[56:59], a[72:75], v[148:151]
ds_read_b64_tr_b16 v[82:83], v21 offset:512
v_mfma_f32_16x16x32_bf16 v[148:151], v[60:63], a[76:79], v[148:151]
buffer_load_dwordx4 v3, s[96:99], s45 offen offset:1024 lds
v_mfma_f32_16x16x32_bf16 v[152:155], v[48:51], a[128:131], 0
ds_read_b64_tr_b16 v[84:85], v21 offset:4096
v_mfma_f32_16x16x32_bf16 v[152:155], v[52:55], a[132:135], v[152:155]
v_cvt_pk_bf16_f32 v96, v192, v193
v_cvt_pk_bf16_f32 v97, v194, v195
v_mfma_f32_16x16x32_bf16 v[152:155], v[56:59], a[136:139], v[152:155]
ds_read_b64_tr_b16 v[86:87], v21 offset:4608
v_mfma_f32_16x16x32_bf16 v[152:155], v[60:63], a[140:143], v[152:155]
buffer_load_dwordx4 v4, s[96:99], s45 offen offset:2048 lds
v_mfma_f32_16x16x32_bf16 v[156:159], v[48:51], a[192:195], 0
ds_read_b64_tr_b16 v[88:89], v21 offset:8192
v_mfma_f32_16x16x32_bf16 v[156:159], v[52:55], a[196:199], v[156:159]
v_cvt_pk_bf16_f32 v98, v208, v209
v_cvt_pk_bf16_f32 v99, v210, v211
v_mfma_f32_16x16x32_bf16 v[156:159], v[56:59], a[200:203], v[156:159]
ds_read_b64_tr_b16 v[90:91], v21 offset:8704
v_mfma_f32_16x16x32_bf16 v[156:159], v[60:63], a[204:207], v[156:159]
s_waitcnt lgkmcnt(6)
buffer_load_dwordx4 v5, s[96:99], s45 offen offset:3072 lds
v_mfma_f32_16x16x32_bf16 v[160:163], v[64:67], a[0:3], 0
ds_read_b64_tr_b16 v[92:93], v21 offset:12288
v_mfma_f32_16x16x32_bf16 v[160:163], v[68:71], a[4:7], v[160:163]
s_add_u32 s45, s45, s46
v_mul_f32 v196, s49, v196
v_mul_f32 v197, s49, v197
v_mfma_f32_16x16x32_bf16 v[160:163], v[72:75], a[8:11], v[160:163]
ds_read_b64_tr_b16 v[94:95], v21 offset:12800
v_mfma_f32_16x16x32_bf16 v[160:163], v[76:79], a[12:15], v[160:163]
s_waitcnt vmcnt(24)
s_barrier
v_mfma_f32_16x16x32_bf16 v[164:167], v[64:67], a[64:67], 0
ds_read_b64_tr_b16 v[32:33], v18 offset:16384
v_mfma_f32_16x16x32_bf16 v[164:167], v[68:71], a[68:71], v[164:167]
v_mul_f32 v198, s49, v198
v_mul_f32 v199, s49, v199
v_mfma_f32_16x16x32_bf16 v[164:167], v[72:75], a[72:75], v[164:167]
ds_read_b64_tr_b16 v[34:35], v18 offset:16896
v_mfma_f32_16x16x32_bf16 v[164:167], v[76:79], a[76:79], v[164:167]
buffer_store_dwordx4 v[96:99], v16, s[36:39], s47 offen offset:0 sc1
v_mfma_f32_16x16x32_bf16 v[168:171], v[64:67], a[128:131], 0
ds_read_b64_tr_b16 v[36:37], v18 offset:20480
v_mfma_f32_16x16x32_bf16 v[168:171], v[68:71], a[132:135], v[168:171]
v_mul_f32 v212, s49, v212
v_mul_f32 v213, s49, v213
v_mfma_f32_16x16x32_bf16 v[168:171], v[72:75], a[136:139], v[168:171]
ds_read_b64_tr_b16 v[38:39], v18 offset:20992
v_mfma_f32_16x16x32_bf16 v[168:171], v[76:79], a[140:143], v[168:171]
v_mfma_f32_16x16x32_bf16 v[172:175], v[64:67], a[192:195], 0
ds_read_b64_tr_b16 v[40:41], v18 offset:24576
v_mfma_f32_16x16x32_bf16 v[172:175], v[68:71], a[196:199], v[172:175]
v_mul_f32 v214, s49, v214
v_mul_f32 v215, s49, v215
v_mfma_f32_16x16x32_bf16 v[172:175], v[72:75], a[200:203], v[172:175]
ds_read_b64_tr_b16 v[42:43], v18 offset:25088
v_mfma_f32_16x16x32_bf16 v[172:175], v[76:79], a[204:207], v[172:175]
s_waitcnt lgkmcnt(6)
v_mfma_f32_16x16x32_bf16 v[176:179], v[80:83], a[0:3], 0
ds_read_b64_tr_b16 v[44:45], v18 offset:28672
v_mfma_f32_16x16x32_bf16 v[176:179], v[84:87], a[4:7], v[176:179]
v_cvt_pk_bf16_f32 v100, v196, v197
v_cvt_pk_bf16_f32 v101, v198, v199
v_mfma_f32_16x16x32_bf16 v[176:179], v[88:91], a[8:11], v[176:179]
ds_read_b64_tr_b16 v[46:47], v18 offset:29184
v_mfma_f32_16x16x32_bf16 v[176:179], v[92:95], a[12:15], v[176:179]
v_mfma_f32_16x16x32_bf16 v[180:183], v[80:83], a[64:67], 0
ds_read_b64_tr_b16 v[48:49], v19 offset:16384
v_mfma_f32_16x16x32_bf16 v[180:183], v[84:87], a[68:71], v[180:183]
v_cvt_pk_bf16_f32 v102, v212, v213
v_cvt_pk_bf16_f32 v103, v214, v215
v_mfma_f32_16x16x32_bf16 v[180:183], v[88:91], a[72:75], v[180:183]
ds_read_b64_tr_b16 v[50:51], v19 offset:16896
v_mfma_f32_16x16x32_bf16 v[180:183], v[92:95], a[76:79], v[180:183]
v_mfma_f32_16x16x32_bf16 v[184:187], v[80:83], a[128:131], 0
ds_read_b64_tr_b16 v[52:53], v19 offset:20480
v_mfma_f32_16x16x32_bf16 v[184:187], v[84:87], a[132:135], v[184:187]
v_mfma_f32_16x16x32_bf16 v[184:187], v[88:91], a[136:139], v[184:187]
ds_read_b64_tr_b16 v[54:55], v19 offset:20992
v_mfma_f32_16x16x32_bf16 v[184:187], v[92:95], a[140:143], v[184:187]
buffer_store_dwordx4 v[100:103], v16, s[36:39], s47 offen offset:1024 sc1
v_mfma_f32_16x16x32_bf16 v[188:191], v[80:83], a[192:195], 0
ds_read_b64_tr_b16 v[56:57], v19 offset:24576
v_mfma_f32_16x16x32_bf16 v[188:191], v[84:87], a[196:199], v[188:191]
v_mfma_f32_16x16x32_bf16 v[188:191], v[88:91], a[200:203], v[188:191]
ds_read_b64_tr_b16 v[58:59], v19 offset:25088
v_mfma_f32_16x16x32_bf16 v[188:191], v[92:95], a[204:207], v[188:191]
s_waitcnt lgkmcnt(6)
v_mfma_f32_16x16x32_bf16 v[128:131], v[32:35], a[16:19], v[128:131]
ds_read_b64_tr_b16 v[60:61], v19 offset:28672
v_mfma_f32_16x16x32_bf16 v[128:131], v[36:39], a[20:23], v[128:131]
s_add_u32 m0, s56, 32768
v_mfma_f32_16x16x32_bf16 v[128:131], v[40:43], a[24:27], v[128:131]
ds_read_b64_tr_b16 v[62:63], v19 offset:29184
v_mfma_f32_16x16x32_bf16 v[128:131], v[44:47], a[28:31], v[128:131]
buffer_load_dwordx4 v2, s[32:35], s45 offen offset:0 lds
v_mfma_f32_16x16x32_bf16 v[132:135], v[32:35], a[80:83], v[132:135]
ds_read_b64_tr_b16 v[64:65], v20 offset:16384
v_mfma_f32_16x16x32_bf16 v[132:135], v[36:39], a[84:87], v[132:135]
v_mfma_f32_16x16x32_bf16 v[132:135], v[40:43], a[88:91], v[132:135]
ds_read_b64_tr_b16 v[66:67], v20 offset:16896
v_mfma_f32_16x16x32_bf16 v[132:135], v[44:47], a[92:95], v[132:135]
buffer_load_dwordx4 v3, s[32:35], s45 offen offset:1024 lds
v_mfma_f32_16x16x32_bf16 v[136:139], v[32:35], a[144:147], v[136:139]
ds_read_b64_tr_b16 v[68:69], v20 offset:20480
v_mfma_f32_16x16x32_bf16 v[136:139], v[36:39], a[148:151], v[136:139]
v_mul_f32 v224, s49, v224
v_mul_f32 v225, s49, v225
v_mfma_f32_16x16x32_bf16 v[136:139], v[40:43], a[152:155], v[136:139]
ds_read_b64_tr_b16 v[70:71], v20 offset:20992
v_mfma_f32_16x16x32_bf16 v[136:139], v[44:47], a[156:159], v[136:139]
buffer_load_dwordx4 v4, s[32:35], s45 offen offset:2048 lds
v_mfma_f32_16x16x32_bf16 v[140:143], v[32:35], a[208:211], v[140:143]
ds_read_b64_tr_b16 v[72:73], v20 offset:24576
v_mfma_f32_16x16x32_bf16 v[140:143], v[36:39], a[212:215], v[140:143]
v_mul_f32 v226, s49, v226
v_mul_f32 v227, s49, v227
v_mfma_f32_16x16x32_bf16 v[140:143], v[40:43], a[216:219], v[140:143]
ds_read_b64_tr_b16 v[74:75], v20 offset:25088
v_mfma_f32_16x16x32_bf16 v[140:143], v[44:47], a[220:223], v[140:143]
s_waitcnt lgkmcnt(6)
buffer_load_dwordx4 v5, s[32:35], s45 offen offset:3072 lds
v_mfma_f32_16x16x32_bf16 v[144:147], v[48:51], a[16:19], v[144:147]
ds_read_b64_tr_b16 v[76:77], v20 offset:28672
v_mfma_f32_16x16x32_bf16 v[144:147], v[52:55], a[20:23], v[144:147]
s_add_u32 m0, s56, 49152
v_mul_f32 v240, s49, v240
v_mul_f32 v241, s49, v241
v_mfma_f32_16x16x32_bf16 v[144:147], v[56:59], a[24:27], v[144:147]
ds_read_b64_tr_b16 v[78:79], v20 offset:29184
v_mfma_f32_16x16x32_bf16 v[144:147], v[60:63], a[28:31], v[144:147]
buffer_load_dwordx4 v2, s[96:99], s45 offen offset:0 lds
v_mfma_f32_16x16x32_bf16 v[148:151], v[48:51], a[80:83], v[148:151]
ds_read_b64_tr_b16 v[80:81], v21 offset:16384
v_mfma_f32_16x16x32_bf16 v[148:151], v[52:55], a[84:87], v[148:151]
v_mul_f32 v242, s49, v242
v_mul_f32 v243, s49, v243
v_mfma_f32_16x16x32_bf16 v[148:151], v[56:59], a[88:91], v[148:151]
ds_read_b64_tr_b16 v[82:83], v21 offset:16896
v_mfma_f32_16x16x32_bf16 v[148:151], v[60:63], a[92:95], v[148:151]
buffer_load_dwordx4 v3, s[96:99], s45 offen offset:1024 lds
v_mfma_f32_16x16x32_bf16 v[152:155], v[48:51], a[144:147], v[152:155]
ds_read_b64_tr_b16 v[84:85], v21 offset:20480
v_mfma_f32_16x16x32_bf16 v[152:155], v[52:55], a[148:151], v[152:155]
v_cvt_pk_bf16_f32 v104, v224, v225
v_cvt_pk_bf16_f32 v105, v226, v227
v_mfma_f32_16x16x32_bf16 v[152:155], v[56:59], a[152:155], v[152:155]
ds_read_b64_tr_b16 v[86:87], v21 offset:20992
v_mfma_f32_16x16x32_bf16 v[152:155], v[60:63], a[156:159], v[152:155]
buffer_load_dwordx4 v4, s[96:99], s45 offen offset:2048 lds
v_mfma_f32_16x16x32_bf16 v[156:159], v[48:51], a[208:211], v[156:159]
ds_read_b64_tr_b16 v[88:89], v21 offset:24576
v_mfma_f32_16x16x32_bf16 v[156:159], v[52:55], a[212:215], v[156:159]
v_cvt_pk_bf16_f32 v106, v240, v241
v_cvt_pk_bf16_f32 v107, v242, v243
v_mfma_f32_16x16x32_bf16 v[156:159], v[56:59], a[216:219], v[156:159]
ds_read_b64_tr_b16 v[90:91], v21 offset:25088
v_mfma_f32_16x16x32_bf16 v[156:159], v[60:63], a[220:223], v[156:159]
s_waitcnt lgkmcnt(6)
buffer_load_dwordx4 v5, s[96:99], s45 offen offset:3072 lds
v_mfma_f32_16x16x32_bf16 v[160:163], v[64:67], a[16:19], v[160:163]
ds_read_b64_tr_b16 v[92:93], v21 offset:28672
v_mfma_f32_16x16x32_bf16 v[160:163], v[68:71], a[20:23], v[160:163]
s_add_u32 s45, s45, s46
v_mul_f32 v228, s49, v228
v_mul_f32 v229, s49, v229
v_mfma_f32_16x16x32_bf16 v[160:163], v[72:75], a[24:27], v[160:163]
ds_read_b64_tr_b16 v[94:95], v21 offset:29184
v_mfma_f32_16x16x32_bf16 v[160:163], v[76:79], a[28:31], v[160:163]
s_waitcnt vmcnt(30)
s_barrier
v_mfma_f32_16x16x32_bf16 v[164:167], v[64:67], a[80:83], v[164:167]
ds_read_b64_tr_b16 v[32:33], v10 offset:0
v_mfma_f32_16x16x32_bf16 v[164:167], v[68:71], a[84:87], v[164:167]
v_mul_f32 v230, s49, v230
v_mul_f32 v231, s49, v231
v_mfma_f32_16x16x32_bf16 v[164:167], v[72:75], a[88:91], v[164:167]
ds_read_b64_tr_b16 v[34:35], v10 offset:512
v_mfma_f32_16x16x32_bf16 v[164:167], v[76:79], a[92:95], v[164:167]
buffer_store_dwordx4 v[104:107], v16, s[36:39], s47 offen offset:2048 sc1
v_mfma_f32_16x16x32_bf16 v[168:171], v[64:67], a[144:147], v[168:171]
ds_read_b64_tr_b16 v[36:37], v10 offset:4096
v_mfma_f32_16x16x32_bf16 v[168:171], v[68:71], a[148:151], v[168:171]
v_mul_f32 v244, s49, v244
v_mul_f32 v245, s49, v245
v_mfma_f32_16x16x32_bf16 v[168:171], v[72:75], a[152:155], v[168:171]
ds_read_b64_tr_b16 v[38:39], v10 offset:4608
v_mfma_f32_16x16x32_bf16 v[168:171], v[76:79], a[156:159], v[168:171]
v_mfma_f32_16x16x32_bf16 v[172:175], v[64:67], a[208:211], v[172:175]
ds_read_b64_tr_b16 v[40:41], v10 offset:8192
v_mfma_f32_16x16x32_bf16 v[172:175], v[68:71], a[212:215], v[172:175]
v_mul_f32 v246, s49, v246
v_mul_f32 v247, s49, v247
v_mfma_f32_16x16x32_bf16 v[172:175], v[72:75], a[216:219], v[172:175]
ds_read_b64_tr_b16 v[42:43], v10 offset:8704
v_mfma_f32_16x16x32_bf16 v[172:175], v[76:79], a[220:223], v[172:175]
s_waitcnt lgkmcnt(6)
v_mfma_f32_16x16x32_bf16 v[176:179], v[80:83], a[16:19], v[176:179]
ds_read_b64_tr_b16 v[44:45], v10 offset:12288
v_mfma_f32_16x16x32_bf16 v[176:179], v[84:87], a[20:23], v[176:179]
v_cvt_pk_bf16_f32 v108, v228, v229
v_cvt_pk_bf16_f32 v109, v230, v231
v_mfma_f32_16x16x32_bf16 v[176:179], v[88:91], a[24:27], v[176:179]
ds_read_b64_tr_b16 v[46:47], v10 offset:12800
v_mfma_f32_16x16x32_bf16 v[176:179], v[92:95], a[28:31], v[176:179]
v_mfma_f32_16x16x32_bf16 v[180:183], v[80:83], a[80:83], v[180:183]
ds_read_b64_tr_b16 v[48:49], v11 offset:0
v_mfma_f32_16x16x32_bf16 v[180:183], v[84:87], a[84:87], v[180:183]
v_cvt_pk_bf16_f32 v110, v244, v245
v_cvt_pk_bf16_f32 v111, v246, v247
v_mfma_f32_16x16x32_bf16 v[180:183], v[88:91], a[88:91], v[180:183]
ds_read_b64_tr_b16 v[50:51], v11 offset:512
v_mfma_f32_16x16x32_bf16 v[180:183], v[92:95], a[92:95], v[180:183]
v_mfma_f32_16x16x32_bf16 v[184:187], v[80:83], a[144:147], v[184:187]
ds_read_b64_tr_b16 v[52:53], v11 offset:4096
v_mfma_f32_16x16x32_bf16 v[184:187], v[84:87], a[148:151], v[184:187]
v_mfma_f32_16x16x32_bf16 v[184:187], v[88:91], a[152:155], v[184:187]
ds_read_b64_tr_b16 v[54:55], v11 offset:4608
v_mfma_f32_16x16x32_bf16 v[184:187], v[92:95], a[156:159], v[184:187]
buffer_store_dwordx4 v[108:111], v16, s[36:39], s47 offen offset:3072 sc1
v_mfma_f32_16x16x32_bf16 v[188:191], v[80:83], a[208:211], v[188:191]
ds_read_b64_tr_b16 v[56:57], v11 offset:8192
v_mfma_f32_16x16x32_bf16 v[188:191], v[84:87], a[212:215], v[188:191]
s_mov_b32 s52, s50
s_mov_b32 s58, s51
v_mfma_f32_16x16x32_bf16 v[188:191], v[88:91], a[216:219], v[188:191]
ds_read_b64_tr_b16 v[58:59], v11 offset:8704
v_mfma_f32_16x16x32_bf16 v[188:191], v[92:95], a[220:223], v[188:191]
s_waitcnt lgkmcnt(6)
v_mfma_f32_16x16x32_bf16 v[128:131], v[32:35], a[32:35], v[128:131]
ds_read_b64_tr_b16 v[60:61], v11 offset:12288
v_mfma_f32_16x16x32_bf16 v[128:131], v[36:39], a[36:39], v[128:131]
s_add_u32 m0, s56, 131072
v_mfma_f32_16x16x32_bf16 v[128:131], v[40:43], a[40:43], v[128:131]
ds_read_b64_tr_b16 v[62:63], v11 offset:12800
v_mfma_f32_16x16x32_bf16 v[128:131], v[44:47], a[44:47], v[128:131]
buffer_load_dwordx4 v2, s[32:35], s45 offen offset:0 lds
v_mfma_f32_16x16x32_bf16 v[132:135], v[32:35], a[96:99], v[132:135]
ds_read_b64_tr_b16 v[64:65], v12 offset:0
v_mfma_f32_16x16x32_bf16 v[132:135], v[36:39], a[100:103], v[132:135]
s_add_u32 s41, s41, 1
v_mfma_f32_16x16x32_bf16 v[132:135], v[40:43], a[104:107], v[132:135]
ds_read_b64_tr_b16 v[66:67], v12 offset:512
v_mfma_f32_16x16x32_bf16 v[132:135], v[44:47], a[108:111], v[132:135]
buffer_load_dwordx4 v3, s[32:35], s45 offen offset:1024 lds
v_mfma_f32_16x16x32_bf16 v[136:139], v[32:35], a[160:163], v[136:139]
ds_read_b64_tr_b16 v[68:69], v12 offset:4096
v_mfma_f32_16x16x32_bf16 v[136:139], v[36:39], a[164:167], v[136:139]
s_sub_u32 s43, s43, 1
v_mul_f32 v200, s49, v200
v_mul_f32 v201, s49, v201
v_mfma_f32_16x16x32_bf16 v[136:139], v[40:43], a[168:171], v[136:139]
ds_read_b64_tr_b16 v[70:71], v12 offset:4608
v_mfma_f32_16x16x32_bf16 v[136:139], v[44:47], a[172:175], v[136:139]
buffer_load_dwordx4 v4, s[32:35], s45 offen offset:2048 lds
v_mfma_f32_16x16x32_bf16 v[140:143], v[32:35], a[224:227], v[140:143]
ds_read_b64_tr_b16 v[72:73], v12 offset:8192
v_mfma_f32_16x16x32_bf16 v[140:143], v[36:39], a[228:231], v[140:143]
s_lshr_b32 s60, s41, 1
v_mul_f32 v202, s49, v202
v_mul_f32 v203, s49, v203
v_mfma_f32_16x16x32_bf16 v[140:143], v[40:43], a[232:235], v[140:143]
ds_read_b64_tr_b16 v[74:75], v12 offset:8704
v_mfma_f32_16x16x32_bf16 v[140:143], v[44:47], a[236:239], v[140:143]
s_waitcnt lgkmcnt(6)
buffer_load_dwordx4 v5, s[32:35], s45 offen offset:3072 lds
v_mfma_f32_16x16x32_bf16 v[144:147], v[48:51], a[32:35], v[144:147]
ds_read_b64_tr_b16 v[76:77], v12 offset:12288
v_mfma_f32_16x16x32_bf16 v[144:147], v[52:55], a[36:39], v[144:147]
s_add_u32 m0, s56, 147456
v_mul_f32 v216, s49, v216
v_mul_f32 v217, s49, v217
v_mfma_f32_16x16x32_bf16 v[144:147], v[56:59], a[40:43], v[144:147]
ds_read_b64_tr_b16 v[78:79], v12 offset:12800
v_mfma_f32_16x16x32_bf16 v[144:147], v[60:63], a[44:47], v[144:147]
buffer_load_dwordx4 v2, s[96:99], s45 offen offset:0 lds
v_mfma_f32_16x16x32_bf16 v[148:151], v[48:51], a[96:99], v[148:151]
ds_read_b64_tr_b16 v[80:81], v13 offset:0
v_mfma_f32_16x16x32_bf16 v[148:151], v[52:55], a[100:103], v[148:151]
s_lshl_b32 s60, s60, 19
v_mul_f32 v218, s49, v218
v_mul_f32 v219, s49, v219
v_mfma_f32_16x16x32_bf16 v[148:151], v[56:59], a[104:107], v[148:151]
ds_read_b64_tr_b16 v[82:83], v13 offset:512
v_mfma_f32_16x16x32_bf16 v[148:151], v[60:63], a[108:111], v[148:151]
buffer_load_dwordx4 v3, s[96:99], s45 offen offset:1024 lds
v_mfma_f32_16x16x32_bf16 v[152:155], v[48:51], a[160:163], v[152:155]
ds_read_b64_tr_b16 v[84:85], v13 offset:4096
v_mfma_f32_16x16x32_bf16 v[152:155], v[52:55], a[164:167], v[152:155]
s_and_b32 s61, s41, 1
v_cvt_pk_bf16_f32 v96, v200, v201
v_cvt_pk_bf16_f32 v97, v202, v203
v_mfma_f32_16x16x32_bf16 v[152:155], v[56:59], a[168:171], v[152:155]
ds_read_b64_tr_b16 v[86:87], v13 offset:4608
v_mfma_f32_16x16x32_bf16 v[152:155], v[60:63], a[172:175], v[152:155]
buffer_load_dwordx4 v4, s[96:99], s45 offen offset:2048 lds
v_mfma_f32_16x16x32_bf16 v[156:159], v[48:51], a[224:227], v[156:159]
ds_read_b64_tr_b16 v[88:89], v13 offset:8192
v_mfma_f32_16x16x32_bf16 v[156:159], v[52:55], a[228:231], v[156:159]
s_lshl_b32 s61, s61, 12
v_cvt_pk_bf16_f32 v98, v216, v217
v_cvt_pk_bf16_f32 v99, v218, v219
v_mfma_f32_16x16x32_bf16 v[156:159], v[56:59], a[232:235], v[156:159]
ds_read_b64_tr_b16 v[90:91], v13 offset:8704
v_mfma_f32_16x16x32_bf16 v[156:159], v[60:63], a[236:239], v[156:159]
s_waitcnt lgkmcnt(6)
buffer_load_dwordx4 v5, s[96:99], s45 offen offset:3072 lds
v_mfma_f32_16x16x32_bf16 v[160:163], v[64:67], a[32:35], v[160:163]
ds_read_b64_tr_b16 v[92:93], v13 offset:12288
v_mfma_f32_16x16x32_bf16 v[160:163], v[68:71], a[36:39], v[160:163]
s_add_u32 s45, s45, s46
v_mul_f32 v204, s49, v204
v_mul_f32 v205, s49, v205
v_mfma_f32_16x16x32_bf16 v[160:163], v[72:75], a[40:43], v[160:163]
ds_read_b64_tr_b16 v[94:95], v13 offset:12800
v_mfma_f32_16x16x32_bf16 v[160:163], v[76:79], a[44:47], v[160:163]
s_waitcnt vmcnt(36)
s_barrier
v_mfma_f32_16x16x32_bf16 v[164:167], v[64:67], a[96:99], v[164:167]
ds_read_b64_tr_b16 v[32:33], v10 offset:16384
v_mfma_f32_16x16x32_bf16 v[164:167], v[68:71], a[100:103], v[164:167]
s_add_u32 s60, s60, s61
v_mul_f32 v206, s49, v206
v_mul_f32 v207, s49, v207
v_mfma_f32_16x16x32_bf16 v[164:167], v[72:75], a[104:107], v[164:167]
ds_read_b64_tr_b16 v[34:35], v10 offset:16896
v_mfma_f32_16x16x32_bf16 v[164:167], v[76:79], a[108:111], v[164:167]
buffer_store_dwordx4 v[96:99], v16, s[36:39], s48 offen offset:0 sc1
v_mfma_f32_16x16x32_bf16 v[168:171], v[64:67], a[160:163], v[168:171]
ds_read_b64_tr_b16 v[36:37], v10 offset:20480
v_mfma_f32_16x16x32_bf16 v[168:171], v[68:71], a[164:167], v[168:171]
s_lshl_b32 s61, s54, 13
v_mul_f32 v220, s49, v220
v_mul_f32 v221, s49, v221
v_mfma_f32_16x16x32_bf16 v[168:171], v[72:75], a[168:171], v[168:171]
ds_read_b64_tr_b16 v[38:39], v10 offset:20992
v_mfma_f32_16x16x32_bf16 v[168:171], v[76:79], a[172:175], v[168:171]
s_add_u32 s50, s60, s61
v_mfma_f32_16x16x32_bf16 v[172:175], v[64:67], a[224:227], v[172:175]
ds_read_b64_tr_b16 v[40:41], v10 offset:24576
v_mfma_f32_16x16x32_bf16 v[172:175], v[68:71], a[228:231], v[172:175]
s_add_u32 s51, s50, 8192
v_mul_f32 v222, s49, v222
v_mul_f32 v223, s49, v223
v_mfma_f32_16x16x32_bf16 v[172:175], v[72:75], a[232:235], v[172:175]
ds_read_b64_tr_b16 v[42:43], v10 offset:25088
v_mfma_f32_16x16x32_bf16 v[172:175], v[76:79], a[236:239], v[172:175]
s_waitcnt lgkmcnt(6)
v_mfma_f32_16x16x32_bf16 v[176:179], v[80:83], a[32:35], v[176:179]
ds_read_b64_tr_b16 v[44:45], v10 offset:28672
v_mfma_f32_16x16x32_bf16 v[176:179], v[84:87], a[36:39], v[176:179]
s_cmp_ge_u32 s41, 64
s_cselect_b32 s53, 1, 0
v_cvt_pk_bf16_f32 v100, v204, v205
v_cvt_pk_bf16_f32 v101, v206, v207
v_mfma_f32_16x16x32_bf16 v[176:179], v[88:91], a[40:43], v[176:179]
ds_read_b64_tr_b16 v[46:47], v10 offset:29184
v_mfma_f32_16x16x32_bf16 v[176:179], v[92:95], a[44:47], v[176:179]
s_sub_u32 s60, s41, 128
v_mfma_f32_16x16x32_bf16 v[180:183], v[80:83], a[96:99], v[180:183]
ds_read_b64_tr_b16 v[48:49], v11 offset:16384
v_mfma_f32_16x16x32_bf16 v[180:183], v[84:87], a[100:103], v[180:183]
s_cmp_lt_u32 s60, 16
s_cselect_b32 s53, 0, s53
v_cvt_pk_bf16_f32 v102, v220, v221
v_cvt_pk_bf16_f32 v103, v222, v223
v_mfma_f32_16x16x32_bf16 v[180:183], v[88:91], a[104:107], v[180:183]
ds_read_b64_tr_b16 v[50:51], v11 offset:16896
v_mfma_f32_16x16x32_bf16 v[180:183], v[92:95], a[108:111], v[180:183]
v_mfma_f32_16x16x32_bf16 v[184:187], v[80:83], a[160:163], v[184:187]
ds_read_b64_tr_b16 v[52:53], v11 offset:20480
v_mfma_f32_16x16x32_bf16 v[184:187], v[84:87], a[164:167], v[184:187]
v_mfma_f32_16x16x32_bf16 v[184:187], v[88:91], a[168:171], v[184:187]
ds_read_b64_tr_b16 v[54:55], v11 offset:20992
v_mfma_f32_16x16x32_bf16 v[184:187], v[92:95], a[172:175], v[184:187]
buffer_store_dwordx4 v[100:103], v16, s[36:39], s48 offen offset:1024 sc1
v_mfma_f32_16x16x32_bf16 v[188:191], v[80:83], a[224:227], v[188:191]
ds_read_b64_tr_b16 v[56:57], v11 offset:24576
v_mfma_f32_16x16x32_bf16 v[188:191], v[84:87], a[228:231], v[188:191]
v_mfma_f32_16x16x32_bf16 v[188:191], v[88:91], a[232:235], v[188:191]
ds_read_b64_tr_b16 v[58:59], v11 offset:25088
v_mfma_f32_16x16x32_bf16 v[188:191], v[92:95], a[236:239], v[188:191]
s_waitcnt lgkmcnt(6)
v_mfma_f32_16x16x32_bf16 v[128:131], v[32:35], a[48:51], v[128:131]
ds_read_b64_tr_b16 v[60:61], v11 offset:28672
v_mfma_f32_16x16x32_bf16 v[128:131], v[36:39], a[52:55], v[128:131]
s_add_u32 m0, s56, 65536
v_mfma_f32_16x16x32_bf16 v[128:131], v[40:43], a[56:59], v[128:131]
ds_read_b64_tr_b16 v[62:63], v11 offset:29184
v_mfma_f32_16x16x32_bf16 v[128:131], v[44:47], a[60:63], v[128:131]
buffer_load_dwordx4 v2, s[32:35], s45 offen offset:0 lds
v_mfma_f32_16x16x32_bf16 v[132:135], v[32:35], a[112:115], v[132:135]
ds_read_b64_tr_b16 v[64:65], v12 offset:16384
v_mfma_f32_16x16x32_bf16 v[132:135], v[36:39], a[116:119], v[132:135]
v_mfma_f32_16x16x32_bf16 v[132:135], v[40:43], a[120:123], v[132:135]
ds_read_b64_tr_b16 v[66:67], v12 offset:16896
v_mfma_f32_16x16x32_bf16 v[132:135], v[44:47], a[124:127], v[132:135]
buffer_load_dwordx4 v3, s[32:35], s45 offen offset:1024 lds
v_mfma_f32_16x16x32_bf16 v[136:139], v[32:35], a[176:179], v[136:139]
ds_read_b64_tr_b16 v[68:69], v12 offset:20480
v_mfma_f32_16x16x32_bf16 v[136:139], v[36:39], a[180:183], v[136:139]
v_mul_f32 v232, s49, v232
v_mul_f32 v233, s49, v233
v_mfma_f32_16x16x32_bf16 v[136:139], v[40:43], a[184:187], v[136:139]
ds_read_b64_tr_b16 v[70:71], v12 offset:20992
v_mfma_f32_16x16x32_bf16 v[136:139], v[44:47], a[188:191], v[136:139]
buffer_load_dwordx4 v4, s[32:35], s45 offen offset:2048 lds
v_mfma_f32_16x16x32_bf16 v[140:143], v[32:35], a[240:243], v[140:143]
ds_read_b64_tr_b16 v[72:73], v12 offset:24576
v_mfma_f32_16x16x32_bf16 v[140:143], v[36:39], a[244:247], v[140:143]
v_mul_f32 v234, s49, v234
v_mul_f32 v235, s49, v235
v_mfma_f32_16x16x32_bf16 v[140:143], v[40:43], a[248:251], v[140:143]
ds_read_b64_tr_b16 v[74:75], v12 offset:25088
v_mfma_f32_16x16x32_bf16 v[140:143], v[44:47], a[252:255], v[140:143]
s_waitcnt lgkmcnt(6)
buffer_load_dwordx4 v5, s[32:35], s45 offen offset:3072 lds
v_mfma_f32_16x16x32_bf16 v[144:147], v[48:51], a[48:51], v[144:147]
ds_read_b64_tr_b16 v[76:77], v12 offset:28672
v_mfma_f32_16x16x32_bf16 v[144:147], v[52:55], a[52:55], v[144:147]
s_add_u32 m0, s56, 81920
v_mul_f32 v248, s49, v248
v_mul_f32 v249, s49, v249
v_mfma_f32_16x16x32_bf16 v[144:147], v[56:59], a[56:59], v[144:147]
ds_read_b64_tr_b16 v[78:79], v12 offset:29184
v_mfma_f32_16x16x32_bf16 v[144:147], v[60:63], a[60:63], v[144:147]
buffer_load_dwordx4 v2, s[96:99], s45 offen offset:0 lds
v_mfma_f32_16x16x32_bf16 v[148:151], v[48:51], a[112:115], v[148:151]
ds_read_b64_tr_b16 v[80:81], v13 offset:16384
v_mfma_f32_16x16x32_bf16 v[148:151], v[52:55], a[116:119], v[148:151]
v_mul_f32 v250, s49, v250
v_mul_f32 v251, s49, v251
v_mfma_f32_16x16x32_bf16 v[148:151], v[56:59], a[120:123], v[148:151]
ds_read_b64_tr_b16 v[82:83], v13 offset:16896
v_mfma_f32_16x16x32_bf16 v[148:151], v[60:63], a[124:127], v[148:151]
buffer_load_dwordx4 v3, s[96:99], s45 offen offset:1024 lds
v_mfma_f32_16x16x32_bf16 v[152:155], v[48:51], a[176:179], v[152:155]
ds_read_b64_tr_b16 v[84:85], v13 offset:20480
v_mfma_f32_16x16x32_bf16 v[152:155], v[52:55], a[180:183], v[152:155]
v_cvt_pk_bf16_f32 v104, v232, v233
v_cvt_pk_bf16_f32 v105, v234, v235
v_mfma_f32_16x16x32_bf16 v[152:155], v[56:59], a[184:187], v[152:155]
ds_read_b64_tr_b16 v[86:87], v13 offset:20992
v_mfma_f32_16x16x32_bf16 v[152:155], v[60:63], a[188:191], v[152:155]
buffer_load_dwordx4 v4, s[96:99], s45 offen offset:2048 lds
v_mfma_f32_16x16x32_bf16 v[156:159], v[48:51], a[240:243], v[156:159]
ds_read_b64_tr_b16 v[88:89], v13 offset:24576
v_mfma_f32_16x16x32_bf16 v[156:159], v[52:55], a[244:247], v[156:159]
v_cvt_pk_bf16_f32 v106, v248, v249
v_cvt_pk_bf16_f32 v107, v250, v251
v_mfma_f32_16x16x32_bf16 v[156:159], v[56:59], a[248:251], v[156:159]
ds_read_b64_tr_b16 v[90:91], v13 offset:25088
v_mfma_f32_16x16x32_bf16 v[156:159], v[60:63], a[252:255], v[156:159]
s_waitcnt lgkmcnt(6)
buffer_load_dwordx4 v5, s[96:99], s45 offen offset:3072 lds
v_mfma_f32_16x16x32_bf16 v[160:163], v[64:67], a[48:51], v[160:163]
ds_read_b64_tr_b16 v[92:93], v13 offset:28672
v_mfma_f32_16x16x32_bf16 v[160:163], v[68:71], a[52:55], v[160:163]
v_mul_f32 v236, s49, v236
v_mul_f32 v237, s49, v237
v_mfma_f32_16x16x32_bf16 v[160:163], v[72:75], a[56:59], v[160:163]
ds_read_b64_tr_b16 v[94:95], v13 offset:29184
v_mfma_f32_16x16x32_bf16 v[160:163], v[76:79], a[60:63], v[160:163]
s_waitcnt vmcnt(34)
s_barrier
v_mfma_f32_16x16x32_bf16 v[164:167], v[64:67], a[112:115], v[164:167]
ds_read_b64_tr_b16 v[32:33], v18 offset:32768
v_mfma_f32_16x16x32_bf16 v[164:167], v[68:71], a[116:119], v[164:167]
v_mul_f32 v238, s49, v238
v_mul_f32 v239, s49, v239
v_mfma_f32_16x16x32_bf16 v[164:167], v[72:75], a[120:123], v[164:167]
ds_read_b64_tr_b16 v[34:35], v18 offset:33280
v_mfma_f32_16x16x32_bf16 v[164:167], v[76:79], a[124:127], v[164:167]
buffer_store_dwordx4 v[104:107], v16, s[36:39], s48 offen offset:2048 sc1
v_mfma_f32_16x16x32_bf16 v[168:171], v[64:67], a[176:179], v[168:171]
ds_read_b64_tr_b16 v[36:37], v18 offset:36864
v_mfma_f32_16x16x32_bf16 v[168:171], v[68:71], a[180:183], v[168:171]
v_mul_f32 v252, s49, v252
v_mul_f32 v253, s49, v253
v_mfma_f32_16x16x32_bf16 v[168:171], v[72:75], a[184:187], v[168:171]
ds_read_b64_tr_b16 v[38:39], v18 offset:37376
v_mfma_f32_16x16x32_bf16 v[168:171], v[76:79], a[188:191], v[168:171]
v_mfma_f32_16x16x32_bf16 v[172:175], v[64:67], a[240:243], v[172:175]
ds_read_b64_tr_b16 v[40:41], v18 offset:40960
v_mfma_f32_16x16x32_bf16 v[172:175], v[68:71], a[244:247], v[172:175]
v_mul_f32 v254, s49, v254
v_mul_f32 v255, s49, v255
v_mfma_f32_16x16x32_bf16 v[172:175], v[72:75], a[248:251], v[172:175]
ds_read_b64_tr_b16 v[42:43], v18 offset:41472
v_mfma_f32_16x16x32_bf16 v[172:175], v[76:79], a[252:255], v[172:175]
s_waitcnt lgkmcnt(6)
v_mfma_f32_16x16x32_bf16 v[176:179], v[80:83], a[48:51], v[176:179]
ds_read_b64_tr_b16 v[44:45], v18 offset:45056
v_mfma_f32_16x16x32_bf16 v[176:179], v[84:87], a[52:55], v[176:179]
v_cvt_pk_bf16_f32 v108, v236, v237
v_cvt_pk_bf16_f32 v109, v238, v239
v_mfma_f32_16x16x32_bf16 v[176:179], v[88:91], a[56:59], v[176:179]
ds_read_b64_tr_b16 v[46:47], v18 offset:45568
v_mfma_f32_16x16x32_bf16 v[176:179], v[92:95], a[60:63], v[176:179]
v_mfma_f32_16x16x32_bf16 v[180:183], v[80:83], a[112:115], v[180:183]
ds_read_b64_tr_b16 v[48:49], v19 offset:32768
v_mfma_f32_16x16x32_bf16 v[180:183], v[84:87], a[116:119], v[180:183]
v_cvt_pk_bf16_f32 v110, v252, v253
v_cvt_pk_bf16_f32 v111, v254, v255
v_mfma_f32_16x16x32_bf16 v[180:183], v[88:91], a[120:123], v[180:183]
ds_read_b64_tr_b16 v[50:51], v19 offset:33280
v_mfma_f32_16x16x32_bf16 v[180:183], v[92:95], a[124:127], v[180:183]
v_mfma_f32_16x16x32_bf16 v[184:187], v[80:83], a[176:179], v[184:187]
ds_read_b64_tr_b16 v[52:53], v19 offset:36864
v_mfma_f32_16x16x32_bf16 v[184:187], v[84:87], a[180:183], v[184:187]
v_mfma_f32_16x16x32_bf16 v[184:187], v[88:91], a[184:187], v[184:187]
ds_read_b64_tr_b16 v[54:55], v19 offset:37376
v_mfma_f32_16x16x32_bf16 v[184:187], v[92:95], a[188:191], v[184:187]
buffer_store_dwordx4 v[108:111], v16, s[36:39], s48 offen offset:3072 sc1
v_mfma_f32_16x16x32_bf16 v[188:191], v[80:83], a[240:243], v[188:191]
ds_read_b64_tr_b16 v[56:57], v19 offset:40960
v_mfma_f32_16x16x32_bf16 v[188:191], v[84:87], a[244:247], v[188:191]
s_mov_b32 s47, s52
v_mfma_f32_16x16x32_bf16 v[188:191], v[88:91], a[248:251], v[188:191]
ds_read_b64_tr_b16 v[58:59], v19 offset:41472
v_mfma_f32_16x16x32_bf16 v[188:191], v[92:95], a[252:255], v[188:191]
s_mov_b32 s48, s58
s_waitcnt lgkmcnt(6)
v_mfma_f32_16x16x32_bf16 v[192:195], v[32:35], a[0:3], 0
ds_read_b64_tr_b16 v[60:61], v19 offset:45056
v_mfma_f32_16x16x32_bf16 v[192:195], v[36:39], a[4:7], v[192:195]
v_mfma_f32_16x16x32_bf16 v[192:195], v[40:43], a[8:11], v[192:195]
ds_read_b64_tr_b16 v[62:63], v19 offset:45568
v_mfma_f32_16x16x32_bf16 v[192:195], v[44:47], a[12:15], v[192:195]
v_mfma_f32_16x16x32_bf16 v[196:199], v[32:35], a[64:67], 0
ds_read_b64_tr_b16 v[64:65], v20 offset:32768
v_mfma_f32_16x16x32_bf16 v[196:199], v[36:39], a[68:71], v[196:199]
v_mfma_f32_16x16x32_bf16 v[196:199], v[40:43], a[72:75], v[196:199]
ds_read_b64_tr_b16 v[66:67], v20 offset:33280
v_mfma_f32_16x16x32_bf16 v[196:199], v[44:47], a[76:79], v[196:199]
v_mfma_f32_16x16x32_bf16 v[200:203], v[32:35], a[128:131], 0
ds_read_b64_tr_b16 v[68:69], v20 offset:36864
v_mfma_f32_16x16x32_bf16 v[200:203], v[36:39], a[132:135], v[200:203]
v_mul_f32 v128, s49, v128
v_mul_f32 v129, s49, v129
v_mfma_f32_16x16x32_bf16 v[200:203], v[40:43], a[136:139], v[200:203]
ds_read_b64_tr_b16 v[70:71], v20 offset:37376
v_mfma_f32_16x16x32_bf16 v[200:203], v[44:47], a[140:143], v[200:203]
v_mfma_f32_16x16x32_bf16 v[204:207], v[32:35], a[192:195], 0
ds_read_b64_tr_b16 v[72:73], v20 offset:40960
v_mfma_f32_16x16x32_bf16 v[204:207], v[36:39], a[196:199], v[204:207]
v_mul_f32 v130, s49, v130
v_mul_f32 v131, s49, v131
v_mfma_f32_16x16x32_bf16 v[204:207], v[40:43], a[200:203], v[204:207]
ds_read_b64_tr_b16 v[74:75], v20 offset:41472
v_mfma_f32_16x16x32_bf16 v[204:207], v[44:47], a[204:207], v[204:207]
s_waitcnt lgkmcnt(6)
v_mfma_f32_16x16x32_bf16 v[208:211], v[48:51], a[0:3], 0
ds_read_b64_tr_b16 v[76:77], v20 offset:45056
v_mfma_f32_16x16x32_bf16 v[208:211], v[52:55], a[4:7], v[208:211]
v_mul_f32 v144, s49, v144
v_mul_f32 v145, s49, v145
v_mfma_f32_16x16x32_bf16 v[208:211], v[56:59], a[8:11], v[208:211]
ds_read_b64_tr_b16 v[78:79], v20 offset:45568
v_mfma_f32_16x16x32_bf16 v[208:211], v[60:63], a[12:15], v[208:211]
v_mfma_f32_16x16x32_bf16 v[212:215], v[48:51], a[64:67], 0
ds_read_b64_tr_b16 v[80:81], v21 offset:32768
v_mfma_f32_16x16x32_bf16 v[212:215], v[52:55], a[68:71], v[212:215]
v_mul_f32 v146, s49, v146
v_mul_f32 v147, s49, v147
v_mfma_f32_16x16x32_bf16 v[212:215], v[56:59], a[72:75], v[212:215]
ds_read_b64_tr_b16 v[82:83], v21 offset:33280
v_mfma_f32_16x16x32_bf16 v[212:215], v[60:63], a[76:79], v[212:215]
v_mfma_f32_16x16x32_bf16 v[216:219], v[48:51], a[128:131], 0
ds_read_b64_tr_b16 v[84:85], v21 offset:36864
v_mfma_f32_16x16x32_bf16 v[216:219], v[52:55], a[132:135], v[216:219]
v_cvt_pk_bf16_f32 v96, v128, v129
v_cvt_pk_bf16_f32 v97, v130, v131
v_mfma_f32_16x16x32_bf16 v[216:219], v[56:59], a[136:139], v[216:219]
ds_read_b64_tr_b16 v[86:87], v21 offset:37376
v_mfma_f32_16x16x32_bf16 v[216:219], v[60:63], a[140:143], v[216:219]
v_mfma_f32_16x16x32_bf16 v[220:223], v[48:51], a[192:195], 0
ds_read_b64_tr_b16 v[88:89], v21 offset:40960
v_mfma_f32_16x16x32_bf16 v[220:223], v[52:55], a[196:199], v[220:223]
v_cvt_pk_bf16_f32 v98, v144, v145
v_cvt_pk_bf16_f32 v99, v146, v147
v_mfma_f32_16x16x32_bf16 v[220:223], v[56:59], a[200:203], v[220:223]
ds_read_b64_tr_b16 v[90:91], v21 offset:41472
v_mfma_f32_16x16x32_bf16 v[220:223], v[60:63], a[204:207], v[220:223]
s_waitcnt lgkmcnt(6)
v_mfma_f32_16x16x32_bf16 v[224:227], v[64:67], a[0:3], 0
ds_read_b64_tr_b16 v[92:93], v21 offset:45056
v_mfma_f32_16x16x32_bf16 v[224:227], v[68:71], a[4:7], v[224:227]
v_mul_f32 v132, s49, v132
v_mul_f32 v133, s49, v133
v_mfma_f32_16x16x32_bf16 v[224:227], v[72:75], a[8:11], v[224:227]
ds_read_b64_tr_b16 v[94:95], v21 offset:45568
v_mfma_f32_16x16x32_bf16 v[224:227], v[76:79], a[12:15], v[224:227]
s_waitcnt vmcnt(26)
s_barrier
v_mfma_f32_16x16x32_bf16 v[228:231], v[64:67], a[64:67], 0
ds_read_b64_tr_b16 v[32:33], v10 offset:32768
v_mfma_f32_16x16x32_bf16 v[228:231], v[68:71], a[68:71], v[228:231]
v_mul_f32 v134, s49, v134
v_mul_f32 v135, s49, v135
v_mfma_f32_16x16x32_bf16 v[228:231], v[72:75], a[72:75], v[228:231]
ds_read_b64_tr_b16 v[34:35], v10 offset:33280
v_mfma_f32_16x16x32_bf16 v[228:231], v[76:79], a[76:79], v[228:231]
buffer_store_dwordx4 v[96:99], v16, s[36:39], s47 offen offset:0 sc1
v_mfma_f32_16x16x32_bf16 v[232:235], v[64:67], a[128:131], 0
ds_read_b64_tr_b16 v[36:37], v10 offset:36864
v_mfma_f32_16x16x32_bf16 v[232:235], v[68:71], a[132:135], v[232:235]
s_mov_b32 s52, s50
s_mov_b32 s58, s51
v_mul_f32 v148, s49, v148
v_mul_f32 v149, s49, v149
v_mfma_f32_16x16x32_bf16 v[232:235], v[72:75], a[136:139], v[232:235]
ds_read_b64_tr_b16 v[38:39], v10 offset:37376
v_mfma_f32_16x16x32_bf16 v[232:235], v[76:79], a[140:143], v[232:235]
s_add_u32 s41, s41, 1
v_mfma_f32_16x16x32_bf16 v[236:239], v[64:67], a[192:195], 0
ds_read_b64_tr_b16 v[40:41], v10 offset:40960
v_mfma_f32_16x16x32_bf16 v[236:239], v[68:71], a[196:199], v[236:239]
s_sub_u32 s43, s43, 1
v_mul_f32 v150, s49, v150
v_mul_f32 v151, s49, v151
v_mfma_f32_16x16x32_bf16 v[236:239], v[72:75], a[200:203], v[236:239]
ds_read_b64_tr_b16 v[42:43], v10 offset:41472
v_mfma_f32_16x16x32_bf16 v[236:239], v[76:79], a[204:207], v[236:239]
s_waitcnt lgkmcnt(6)
v_mfma_f32_16x16x32_bf16 v[240:243], v[80:83], a[0:3], 0
ds_read_b64_tr_b16 v[44:45], v10 offset:45056
v_mfma_f32_16x16x32_bf16 v[240:243], v[84:87], a[4:7], v[240:243]
s_lshr_b32 s60, s41, 1
v_cvt_pk_bf16_f32 v100, v132, v133
v_cvt_pk_bf16_f32 v101, v134, v135
v_mfma_f32_16x16x32_bf16 v[240:243], v[88:91], a[8:11], v[240:243]
ds_read_b64_tr_b16 v[46:47], v10 offset:45568
v_mfma_f32_16x16x32_bf16 v[240:243], v[92:95], a[12:15], v[240:243]
s_lshl_b32 s60, s60, 19
v_mfma_f32_16x16x32_bf16 v[244:247], v[80:83], a[64:67], 0
ds_read_b64_tr_b16 v[48:49], v11 offset:32768
v_mfma_f32_16x16x32_bf16 v[244:247], v[84:87], a[68:71], v[244:247]
s_and_b32 s61, s41, 1
v_cvt_pk_bf16_f32 v102, v148, v149
v_cvt_pk_bf16_f32 v103, v150, v151
v_mfma_f32_16x16x32_bf16 v[244:247], v[88:91], a[72:75], v[244:247]
ds_read_b64_tr_b16 v[50:51], v11 offset:33280
v_mfma_f32_16x16x32_bf16 v[244:247], v[92:95], a[76:79], v[244:247]
s_lshl_b32 s61, s61, 12
v_mfma_f32_16x16x32_bf16 v[248:251], v[80:83], a[128:131], 0
ds_read_b64_tr_b16 v[52:53], v11 offset:36864
v_mfma_f32_16x16x32_bf16 v[248:251], v[84:87], a[132:135], v[248:251]
s_add_u32 s60, s60, s61
v_mfma_f32_16x16x32_bf16 v[248:251], v[88:91], a[136:139], v[248:251]
ds_read_b64_tr_b16 v[54:55], v11 offset:37376
v_mfma_f32_16x16x32_bf16 v[248:251], v[92:95], a[140:143], v[248:251]
buffer_store_dwordx4 v[100:103], v16, s[36:39], s47 offen offset:1024 sc1
v_mfma_f32_16x16x32_bf16 v[252:255], v[80:83], a[192:195], 0
ds_read_b64_tr_b16 v[56:57], v11 offset:40960
v_mfma_f32_16x16x32_bf16 v[252:255], v[84:87], a[196:199], v[252:255]
s_lshl_b32 s61, s54, 13
v_mfma_f32_16x16x32_bf16 v[252:255], v[88:91], a[200:203], v[252:255]
ds_read_b64_tr_b16 v[58:59], v11 offset:41472
v_mfma_f32_16x16x32_bf16 v[252:255], v[92:95], a[204:207], v[252:255]
s_waitcnt lgkmcnt(6)
v_mfma_f32_16x16x32_bf16 v[192:195], v[32:35], a[16:19], v[192:195]
ds_read_b64_tr_b16 v[60:61], v11 offset:45056
v_mfma_f32_16x16x32_bf16 v[192:195], v[36:39], a[20:23], v[192:195]
s_add_u32 s50, s60, s61
v_mfma_f32_16x16x32_bf16 v[192:195], v[40:43], a[24:27], v[192:195]
ds_read_b64_tr_b16 v[62:63], v11 offset:45568
v_mfma_f32_16x16x32_bf16 v[192:195], v[44:47], a[28:31], v[192:195]
s_add_u32 s51, s50, 8192
v_mfma_f32_16x16x32_bf16 v[196:199], v[32:35], a[80:83], v[196:199]
ds_read_b64_tr_b16 v[64:65], v12 offset:32768
v_mfma_f32_16x16x32_bf16 v[196:199], v[36:39], a[84:87], v[196:199]
s_cmp_ge_u32 s41, 64
s_cselect_b32 s53, 1, 0
v_mfma_f32_16x16x32_bf16 v[196:199], v[40:43], a[88:91], v[196:199]
ds_read_b64_tr_b16 v[66:67], v12 offset:33280
v_mfma_f32_16x16x32_bf16 v[196:199], v[44:47], a[92:95], v[196:199]
s_sub_u32 s60, s41, 128
v_mfma_f32_16x16x32_bf16 v[200:203], v[32:35], a[144:147], v[200:203]
ds_read_b64_tr_b16 v[68:69], v12 offset:36864
v_mfma_f32_16x16x32_bf16 v[200:203], v[36:39], a[148:151], v[200:203]
s_cmp_lt_u32 s60, 16
s_cselect_b32 s53, 0, s53
v_mul_f32 v160, s49, v160
v_mul_f32 v161, s49, v161
v_mfma_f32_16x16x32_bf16 v[200:203], v[40:43], a[152:155], v[200:203]
ds_read_b64_tr_b16 v[70:71], v12 offset:37376
v_mfma_f32_16x16x32_bf16 v[200:203], v[44:47], a[156:159], v[200:203]
v_mfma_f32_16x16x32_bf16 v[204:207], v[32:35], a[208:211], v[204:207]
ds_read_b64_tr_b16 v[72:73], v12 offset:40960
v_mfma_f32_16x16x32_bf16 v[204:207], v[36:39], a[212:215], v[204:207]
v_mul_f32 v162, s49, v162
v_mul_f32 v163, s49, v163
v_mfma_f32_16x16x32_bf16 v[204:207], v[40:43], a[216:219], v[204:207]
ds_read_b64_tr_b16 v[74:75], v12 offset:41472
v_mfma_f32_16x16x32_bf16 v[204:207], v[44:47], a[220:223], v[204:207]
s_waitcnt lgkmcnt(6)
v_mfma_f32_16x16x32_bf16 v[208:211], v[48:51], a[16:19], v[208:211]
ds_read_b64_tr_b16 v[76:77], v12 offset:45056
v_mfma_f32_16x16x32_bf16 v[208:211], v[52:55], a[20:23], v[208:211]
v_mul_f32 v176, s49, v176
v_mul_f32 v177, s49, v177
v_mfma_f32_16x16x32_bf16 v[208:211], v[56:59], a[24:27], v[208:211]
ds_read_b64_tr_b16 v[78:79], v12 offset:45568
v_mfma_f32_16x16x32_bf16 v[208:211], v[60:63], a[28:31], v[208:211]
v_mfma_f32_16x16x32_bf16 v[212:215], v[48:51], a[80:83], v[212:215]
ds_read_b64_tr_b16 v[80:81], v13 offset:32768
v_mfma_f32_16x16x32_bf16 v[212:215], v[52:55], a[84:87], v[212:215]
v_mul_f32 v178, s49, v178
v_mul_f32 v179, s49, v179
v_mfma_f32_16x16x32_bf16 v[212:215], v[56:59], a[88:91], v[212:215]
ds_read_b64_tr_b16 v[82:83], v13 offset:33280
v_mfma_f32_16x16x32_bf16 v[212:215], v[60:63], a[92:95], v[212:215]
v_mfma_f32_16x16x32_bf16 v[216:219], v[48:51], a[144:147], v[216:219]
ds_read_b64_tr_b16 v[84:85], v13 offset:36864
v_mfma_f32_16x16x32_bf16 v[216:219], v[52:55], a[148:151], v[216:219]
v_cvt_pk_bf16_f32 v104, v160, v161
v_cvt_pk_bf16_f32 v105, v162, v163
v_mfma_f32_16x16x32_bf16 v[216:219], v[56:59], a[152:155], v[216:219]
ds_read_b64_tr_b16 v[86:87], v13 offset:37376
v_mfma_f32_16x16x32_bf16 v[216:219], v[60:63], a[156:159], v[216:219]
v_mfma_f32_16x16x32_bf16 v[220:223], v[48:51], a[208:211], v[220:223]
ds_read_b64_tr_b16 v[88:89], v13 offset:40960
v_mfma_f32_16x16x32_bf16 v[220:223], v[52:55], a[212:215], v[220:223]
v_cvt_pk_bf16_f32 v106, v176, v177
v_cvt_pk_bf16_f32 v107, v178, v179
v_mfma_f32_16x16x32_bf16 v[220:223], v[56:59], a[216:219], v[220:223]
ds_read_b64_tr_b16 v[90:91], v13 offset:41472
v_mfma_f32_16x16x32_bf16 v[220:223], v[60:63], a[220:223], v[220:223]
s_waitcnt lgkmcnt(6)
v_mfma_f32_16x16x32_bf16 v[224:227], v[64:67], a[16:19], v[224:227]
ds_read_b64_tr_b16 v[92:93], v13 offset:45056
v_mfma_f32_16x16x32_bf16 v[224:227], v[68:71], a[20:23], v[224:227]
v_mul_f32 v164, s49, v164
v_mul_f32 v165, s49, v165
v_mfma_f32_16x16x32_bf16 v[224:227], v[72:75], a[24:27], v[224:227]
ds_read_b64_tr_b16 v[94:95], v13 offset:45568
v_mfma_f32_16x16x32_bf16 v[224:227], v[76:79], a[28:31], v[224:227]
s_waitcnt vmcnt(18)
s_barrier
v_mfma_f32_16x16x32_bf16 v[228:231], v[64:67], a[80:83], v[228:231]
ds_read_b64_tr_b16 v[32:33], v22 offset:0
v_mfma_f32_16x16x32_bf16 v[228:231], v[68:71], a[84:87], v[228:231]
v_mul_f32 v166, s49, v166
v_mul_f32 v167, s49, v167
v_mfma_f32_16x16x32_bf16 v[228:231], v[72:75], a[88:91], v[228:231]
ds_read_b64_tr_b16 v[34:35], v22 offset:512
v_mfma_f32_16x16x32_bf16 v[228:231], v[76:79], a[92:95], v[228:231]
buffer_store_dwordx4 v[104:107], v16, s[36:39], s47 offen offset:2048 sc1
v_mfma_f32_16x16x32_bf16 v[232:235], v[64:67], a[144:147], v[232:235]
ds_read_b64_tr_b16 v[36:37], v22 offset:4096
v_mfma_f32_16x16x32_bf16 v[232:235], v[68:71], a[148:151], v[232:235]
v_mul_f32 v180, s49, v180
v_mul_f32 v181, s49, v181
v_mfma_f32_16x16x32_bf16 v[232:235], v[72:75], a[152:155], v[232:235]
ds_read_b64_tr_b16 v[38:39], v22 offset:4608
v_mfma_f32_16x16x32_bf16 v[232:235], v[76:79], a[156:159], v[232:235]
v_mfma_f32_16x16x32_bf16 v[236:239], v[64:67], a[208:211], v[236:239]
ds_read_b64_tr_b16 v[40:41], v22 offset:8192
v_mfma_f32_16x16x32_bf16 v[236:239], v[68:71], a[212:215], v[236:239]
v_mul_f32 v182, s49, v182
v_mul_f32 v183, s49, v183
v_mfma_f32_16x16x32_bf16 v[236:239], v[72:75], a[216:219], v[236:239]
ds_read_b64_tr_b16 v[42:43], v22 offset:8704
v_mfma_f32_16x16x32_bf16 v[236:239], v[76:79], a[220:223], v[236:239]
s_waitcnt lgkmcnt(6)
v_mfma_f32_16x16x32_bf16 v[240:243], v[80:83], a[16:19], v[240:243]
ds_read_b64_tr_b16 v[44:45], v22 offset:12288
v_mfma_f32_16x16x32_bf16 v[240:243], v[84:87], a[20:23], v[240:243]
v_cvt_pk_bf16_f32 v108, v164, v165
v_cvt_pk_bf16_f32 v109, v166, v167
v_mfma_f32_16x16x32_bf16 v[240:243], v[88:91], a[24:27], v[240:243]
ds_read_b64_tr_b16 v[46:47], v22 offset:12800
v_mfma_f32_16x16x32_bf16 v[240:243], v[92:95], a[28:31], v[240:243]
v_mfma_f32_16x16x32_bf16 v[244:247], v[80:83], a[80:83], v[244:247]
ds_read_b64_tr_b16 v[48:49], v23 offset:0
v_mfma_f32_16x16x32_bf16 v[244:247], v[84:87], a[84:87], v[244:247]
v_cvt_pk_bf16_f32 v110, v180, v181
v_cvt_pk_bf16_f32 v111, v182, v183
v_mfma_f32_16x16x32_bf16 v[244:247], v[88:91], a[88:91], v[244:247]
ds_read_b64_tr_b16 v[50:51], v23 offset:512
v_mfma_f32_16x16x32_bf16 v[244:247], v[92:95], a[92:95], v[244:247]
v_mfma_f32_16x16x32_bf16 v[248:251], v[80:83], a[144:147], v[248:251]
ds_read_b64_tr_b16 v[52:53], v23 offset:4096
v_mfma_f32_16x16x32_bf16 v[248:251], v[84:87], a[148:151], v[248:251]
v_mfma_f32_16x16x32_bf16 v[248:251], v[88:91], a[152:155], v[248:251]
ds_read_b64_tr_b16 v[54:55], v23 offset:4608
v_mfma_f32_16x16x32_bf16 v[248:251], v[92:95], a[156:159], v[248:251]
buffer_store_dwordx4 v[108:111], v16, s[36:39], s47 offen offset:3072 sc1
v_mfma_f32_16x16x32_bf16 v[252:255], v[80:83], a[208:211], v[252:255]
ds_read_b64_tr_b16 v[56:57], v23 offset:8192
v_mfma_f32_16x16x32_bf16 v[252:255], v[84:87], a[212:215], v[252:255]
v_mfma_f32_16x16x32_bf16 v[252:255], v[88:91], a[216:219], v[252:255]
ds_read_b64_tr_b16 v[58:59], v23 offset:8704
v_mfma_f32_16x16x32_bf16 v[252:255], v[92:95], a[220:223], v[252:255]
s_waitcnt lgkmcnt(6)
v_mfma_f32_16x16x32_bf16 v[192:195], v[32:35], a[32:35], v[192:195]
ds_read_b64_tr_b16 v[60:61], v23 offset:12288
v_mfma_f32_16x16x32_bf16 v[192:195], v[36:39], a[36:39], v[192:195]
v_mfma_f32_16x16x32_bf16 v[192:195], v[40:43], a[40:43], v[192:195]
ds_read_b64_tr_b16 v[62:63], v23 offset:12800
v_mfma_f32_16x16x32_bf16 v[192:195], v[44:47], a[44:47], v[192:195]
v_mfma_f32_16x16x32_bf16 v[196:199], v[32:35], a[96:99], v[196:199]
ds_read_b64_tr_b16 v[64:65], v24 offset:0
v_mfma_f32_16x16x32_bf16 v[196:199], v[36:39], a[100:103], v[196:199]
v_mfma_f32_16x16x32_bf16 v[196:199], v[40:43], a[104:107], v[196:199]
ds_read_b64_tr_b16 v[66:67], v24 offset:512
v_mfma_f32_16x16x32_bf16 v[196:199], v[44:47], a[108:111], v[196:199]
v_mfma_f32_16x16x32_bf16 v[200:203], v[32:35], a[160:163], v[200:203]
ds_read_b64_tr_b16 v[68:69], v24 offset:4096
v_mfma_f32_16x16x32_bf16 v[200:203], v[36:39], a[164:167], v[200:203]
v_mul_f32 v136, s49, v136
v_mul_f32 v137, s49, v137
v_mfma_f32_16x16x32_bf16 v[200:203], v[40:43], a[168:171], v[200:203]
ds_read_b64_tr_b16 v[70:71], v24 offset:4608
v_mfma_f32_16x16x32_bf16 v[200:203], v[44:47], a[172:175], v[200:203]
v_mfma_f32_16x16x32_bf16 v[204:207], v[32:35], a[224:227], v[204:207]
ds_read_b64_tr_b16 v[72:73], v24 offset:8192
v_mfma_f32_16x16x32_bf16 v[204:207], v[36:39], a[228:231], v[204:207]
v_mul_f32 v138, s49, v138
v_mul_f32 v139, s49, v139
v_mfma_f32_16x16x32_bf16 v[204:207], v[40:43], a[232:235], v[204:207]
ds_read_b64_tr_b16 v[74:75], v24 offset:8704
v_mfma_f32_16x16x32_bf16 v[204:207], v[44:47], a[236:239], v[204:207]
s_waitcnt lgkmcnt(6)
v_mfma_f32_16x16x32_bf16 v[208:211], v[48:51], a[32:35], v[208:211]
ds_read_b64_tr_b16 v[76:77], v24 offset:12288
v_mfma_f32_16x16x32_bf16 v[208:211], v[52:55], a[36:39], v[208:211]
v_mul_f32 v152, s49, v152
v_mul_f32 v153, s49, v153
v_mfma_f32_16x16x32_bf16 v[208:211], v[56:59], a[40:43], v[208:211]
ds_read_b64_tr_b16 v[78:79], v24 offset:12800
v_mfma_f32_16x16x32_bf16 v[208:211], v[60:63], a[44:47], v[208:211]
v_mfma_f32_16x16x32_bf16 v[212:215], v[48:51], a[96:99], v[212:215]
ds_read_b64_tr_b16 v[80:81], v25 offset:0
v_mfma_f32_16x16x32_bf16 v[212:215], v[52:55], a[100:103], v[212:215]
v_mul_f32 v154, s49, v154
v_mul_f32 v155, s49, v155
v_mfma_f32_16x16x32_bf16 v[212:215], v[56:59], a[104:107], v[212:215]
ds_read_b64_tr_b16 v[82:83], v25 offset:512
v_mfma_f32_16x16x32_bf16 v[212:215], v[60:63], a[108:111], v[212:215]
v_mfma_f32_16x16x32_bf16 v[216:219], v[48:51], a[160:163], v[216:219]
ds_read_b64_tr_b16 v[84:85], v25 offset:4096
v_mfma_f32_16x16x32_bf16 v[216:219], v[52:55], a[164:167], v[216:219]
v_cvt_pk_bf16_f32 v96, v136, v137
v_cvt_pk_bf16_f32 v97, v138, v139
v_mfma_f32_16x16x32_bf16 v[216:219], v[56:59], a[168:171], v[216:219]
ds_read_b64_tr_b16 v[86:87], v25 offset:4608
v_mfma_f32_16x16x32_bf16 v[216:219], v[60:63], a[172:175], v[216:219]
v_mfma_f32_16x16x32_bf16 v[220:223], v[48:51], a[224:227], v[220:223]
ds_read_b64_tr_b16 v[88:89], v25 offset:8192
v_mfma_f32_16x16x32_bf16 v[220:223], v[52:55], a[228:231], v[220:223]
v_cvt_pk_bf16_f32 v98, v152, v153
v_cvt_pk_bf16_f32 v99, v154, v155
v_mfma_f32_16x16x32_bf16 v[220:223], v[56:59], a[232:235], v[220:223]
ds_read_b64_tr_b16 v[90:91], v25 offset:8704
v_mfma_f32_16x16x32_bf16 v[220:223], v[60:63], a[236:239], v[220:223]
s_waitcnt lgkmcnt(6)
v_mfma_f32_16x16x32_bf16 v[224:227], v[64:67], a[32:35], v[224:227]
ds_read_b64_tr_b16 v[92:93], v25 offset:12288
v_mfma_f32_16x16x32_bf16 v[224:227], v[68:71], a[36:39], v[224:227]
v_mul_f32 v140, s49, v140
v_mul_f32 v141, s49, v141
v_mfma_f32_16x16x32_bf16 v[224:227], v[72:75], a[40:43], v[224:227]
ds_read_b64_tr_b16 v[94:95], v25 offset:12800
v_mfma_f32_16x16x32_bf16 v[224:227], v[76:79], a[44:47], v[224:227]
s_waitcnt vmcnt(6)
s_barrier
v_mfma_f32_16x16x32_bf16 v[228:231], v[64:67], a[96:99], v[228:231]
ds_read_b64_tr_b16 v[32:33], v18 offset:0
v_mfma_f32_16x16x32_bf16 v[228:231], v[68:71], a[100:103], v[228:231]
v_mul_f32 v142, s49, v142
v_mul_f32 v143, s49, v143
v_mfma_f32_16x16x32_bf16 v[228:231], v[72:75], a[104:107], v[228:231]
ds_read_b64_tr_b16 v[34:35], v18 offset:512
v_mfma_f32_16x16x32_bf16 v[228:231], v[76:79], a[108:111], v[228:231]
buffer_store_dwordx4 v[96:99], v16, s[36:39], s48 offen offset:0 sc1
v_mfma_f32_16x16x32_bf16 v[232:235], v[64:67], a[160:163], v[232:235]
ds_read_b64_tr_b16 v[36:37], v18 offset:4096
v_mfma_f32_16x16x32_bf16 v[232:235], v[68:71], a[164:167], v[232:235]
v_mul_f32 v156, s49, v156
v_mul_f32 v157, s49, v157
v_mfma_f32_16x16x32_bf16 v[232:235], v[72:75], a[168:171], v[232:235]
ds_read_b64_tr_b16 v[38:39], v18 offset:4608
v_mfma_f32_16x16x32_bf16 v[232:235], v[76:79], a[172:175], v[232:235]
v_mfma_f32_16x16x32_bf16 v[236:239], v[64:67], a[224:227], v[236:239]
ds_read_b64_tr_b16 v[40:41], v18 offset:8192
v_mfma_f32_16x16x32_bf16 v[236:239], v[68:71], a[228:231], v[236:239]
v_mul_f32 v158, s49, v158
v_mul_f32 v159, s49, v159
v_mfma_f32_16x16x32_bf16 v[236:239], v[72:75], a[232:235], v[236:239]
ds_read_b64_tr_b16 v[42:43], v18 offset:8704
v_mfma_f32_16x16x32_bf16 v[236:239], v[76:79], a[236:239], v[236:239]
s_waitcnt lgkmcnt(6)
v_mfma_f32_16x16x32_bf16 v[240:243], v[80:83], a[32:35], v[240:243]
ds_read_b64_tr_b16 v[44:45], v18 offset:12288
v_mfma_f32_16x16x32_bf16 v[240:243], v[84:87], a[36:39], v[240:243]
v_cvt_pk_bf16_f32 v100, v140, v141
v_cvt_pk_bf16_f32 v101, v142, v143
v_mfma_f32_16x16x32_bf16 v[240:243], v[88:91], a[40:43], v[240:243]
ds_read_b64_tr_b16 v[46:47], v18 offset:12800
v_mfma_f32_16x16x32_bf16 v[240:243], v[92:95], a[44:47], v[240:243]
v_mfma_f32_16x16x32_bf16 v[244:247], v[80:83], a[96:99], v[244:247]
ds_read_b64_tr_b16 v[48:49], v19 offset:0
v_mfma_f32_16x16x32_bf16 v[244:247], v[84:87], a[100:103], v[244:247]
v_cvt_pk_bf16_f32 v102, v156, v157
v_cvt_pk_bf16_f32 v103, v158, v159
v_mfma_f32_16x16x32_bf16 v[244:247], v[88:91], a[104:107], v[244:247]
ds_read_b64_tr_b16 v[50:51], v19 offset:512
v_mfma_f32_16x16x32_bf16 v[244:247], v[92:95], a[108:111], v[244:247]
v_mfma_f32_16x16x32_bf16 v[248:251], v[80:83], a[160:163], v[248:251]
ds_read_b64_tr_b16 v[52:53], v19 offset:4096
v_mfma_f32_16x16x32_bf16 v[248:251], v[84:87], a[164:167], v[248:251]
v_mfma_f32_16x16x32_bf16 v[248:251], v[88:91], a[168:171], v[248:251]
ds_read_b64_tr_b16 v[54:55], v19 offset:4608
v_mfma_f32_16x16x32_bf16 v[248:251], v[92:95], a[172:175], v[248:251]
buffer_store_dwordx4 v[100:103], v16, s[36:39], s48 offen offset:1024 sc1
v_mfma_f32_16x16x32_bf16 v[252:255], v[80:83], a[224:227], v[252:255]
ds_read_b64_tr_b16 v[56:57], v19 offset:8192
v_mfma_f32_16x16x32_bf16 v[252:255], v[84:87], a[228:231], v[252:255]
v_mfma_f32_16x16x32_bf16 v[252:255], v[88:91], a[232:235], v[252:255]
ds_read_b64_tr_b16 v[58:59], v19 offset:8704
v_mfma_f32_16x16x32_bf16 v[252:255], v[92:95], a[236:239], v[252:255]
s_waitcnt lgkmcnt(6)
v_mfma_f32_16x16x32_bf16 v[192:195], v[32:35], a[48:51], v[192:195]
ds_read_b64_tr_b16 v[60:61], v19 offset:12288
v_mfma_f32_16x16x32_bf16 v[192:195], v[36:39], a[52:55], v[192:195]
s_mov_b32 s78, 0x200000
s_mov_b32 s82, 0x400000
v_mfma_f32_16x16x32_bf16 v[192:195], v[40:43], a[56:59], v[192:195]
ds_read_b64_tr_b16 v[62:63], v19 offset:12800
v_mfma_f32_16x16x32_bf16 v[192:195], v[44:47], a[60:63], v[192:195]
buffer_load_dwordx4 v[112:115], v16, s[76:79], s84 offen offset:0
v_mfma_f32_16x16x32_bf16 v[196:199], v[32:35], a[112:115], v[196:199]
ds_read_b64_tr_b16 v[64:65], v20 offset:0
v_mfma_f32_16x16x32_bf16 v[196:199], v[36:39], a[116:119], v[196:199]
buffer_load_dwordx4 v[116:119], v16, s[76:79], s84 offen offset:1024
v_mfma_f32_16x16x32_bf16 v[196:199], v[40:43], a[120:123], v[196:199]
ds_read_b64_tr_b16 v[66:67], v20 offset:512
v_mfma_f32_16x16x32_bf16 v[196:199], v[44:47], a[124:127], v[196:199]
buffer_load_dwordx4 v[112:115], v16, s[80:83], s85 offen offset:0
v_mfma_f32_16x16x32_bf16 v[200:203], v[32:35], a[176:179], v[200:203]
ds_read_b64_tr_b16 v[68:69], v20 offset:4096
v_mfma_f32_16x16x32_bf16 v[200:203], v[36:39], a[180:183], v[200:203]
buffer_load_dwordx4 v[116:119], v16, s[80:83], s85 offen offset:1024
v_mul_f32 v168, s49, v168
v_mul_f32 v169, s49, v169
v_mfma_f32_16x16x32_bf16 v[200:203], v[40:43], a[184:187], v[200:203]
ds_read_b64_tr_b16 v[70:71], v20 offset:4608
v_mfma_f32_16x16x32_bf16 v[200:203], v[44:47], a[188:191], v[200:203]
buffer_load_dwordx4 v[120:123], v16, s[80:83], s85 offen offset:2048
v_mfma_f32_16x16x32_bf16 v[204:207], v[32:35], a[240:243], v[204:207]
ds_read_b64_tr_b16 v[72:73], v20 offset:8192
v_mfma_f32_16x16x32_bf16 v[204:207], v[36:39], a[244:247], v[204:207]
buffer_load_dwordx4 v[124:127], v16, s[80:83], s85 offen offset:3072
v_mul_f32 v170, s49, v170
v_mul_f32 v171, s49, v171
v_mfma_f32_16x16x32_bf16 v[204:207], v[40:43], a[248:251], v[204:207]
ds_read_b64_tr_b16 v[74:75], v20 offset:8704
v_mfma_f32_16x16x32_bf16 v[204:207], v[44:47], a[252:255], v[204:207]
s_waitcnt lgkmcnt(6)
v_mfma_f32_16x16x32_bf16 v[208:211], v[48:51], a[48:51], v[208:211]
ds_read_b64_tr_b16 v[76:77], v20 offset:12288
v_mfma_f32_16x16x32_bf16 v[208:211], v[52:55], a[52:55], v[208:211]
v_mul_f32 v184, s49, v184
v_mul_f32 v185, s49, v185
v_mfma_f32_16x16x32_bf16 v[208:211], v[56:59], a[56:59], v[208:211]
ds_read_b64_tr_b16 v[78:79], v20 offset:12800
v_mfma_f32_16x16x32_bf16 v[208:211], v[60:63], a[60:63], v[208:211]
v_mfma_f32_16x16x32_bf16 v[212:215], v[48:51], a[112:115], v[212:215]
ds_read_b64_tr_b16 v[80:81], v21 offset:0
v_mfma_f32_16x16x32_bf16 v[212:215], v[52:55], a[116:119], v[212:215]
v_mul_f32 v186, s49, v186
v_mul_f32 v187, s49, v187
v_mfma_f32_16x16x32_bf16 v[212:215], v[56:59], a[120:123], v[212:215]
ds_read_b64_tr_b16 v[82:83], v21 offset:512
v_mfma_f32_16x16x32_bf16 v[212:215], v[60:63], a[124:127], v[212:215]
v_mfma_f32_16x16x32_bf16 v[216:219], v[48:51], a[176:179], v[216:219]
ds_read_b64_tr_b16 v[84:85], v21 offset:4096
v_mfma_f32_16x16x32_bf16 v[216:219], v[52:55], a[180:183], v[216:219]
v_cvt_pk_bf16_f32 v104, v168, v169
v_cvt_pk_bf16_f32 v105, v170, v171
v_mfma_f32_16x16x32_bf16 v[216:219], v[56:59], a[184:187], v[216:219]
ds_read_b64_tr_b16 v[86:87], v21 offset:4608
v_mfma_f32_16x16x32_bf16 v[216:219], v[60:63], a[188:191], v[216:219]
v_mfma_f32_16x16x32_bf16 v[220:223], v[48:51], a[240:243], v[220:223]
ds_read_b64_tr_b16 v[88:89], v21 offset:8192
v_mfma_f32_16x16x32_bf16 v[220:223], v[52:55], a[244:247], v[220:223]
v_cvt_pk_bf16_f32 v106, v184, v185
v_cvt_pk_bf16_f32 v107, v186, v187
v_mfma_f32_16x16x32_bf16 v[220:223], v[56:59], a[248:251], v[220:223]
ds_read_b64_tr_b16 v[90:91], v21 offset:8704
v_mfma_f32_16x16x32_bf16 v[220:223], v[60:63], a[252:255], v[220:223]
s_waitcnt lgkmcnt(6)
v_mfma_f32_16x16x32_bf16 v[224:227], v[64:67], a[48:51], v[224:227]
ds_read_b64_tr_b16 v[92:93], v21 offset:12288
v_mfma_f32_16x16x32_bf16 v[224:227], v[68:71], a[52:55], v[224:227]
v_mul_f32 v172, s49, v172
v_mul_f32 v173, s49, v173
v_mfma_f32_16x16x32_bf16 v[224:227], v[72:75], a[56:59], v[224:227]
ds_read_b64_tr_b16 v[94:95], v21 offset:12800
v_mfma_f32_16x16x32_bf16 v[224:227], v[76:79], a[60:63], v[224:227]
v_mfma_f32_16x16x32_bf16 v[228:231], v[64:67], a[112:115], v[228:231]
ds_read_b64_tr_b16 v[32:33], v18 offset:49152
v_mfma_f32_16x16x32_bf16 v[228:231], v[68:71], a[116:119], v[228:231]
v_mul_f32 v174, s49, v174
v_mul_f32 v175, s49, v175
v_mfma_f32_16x16x32_bf16 v[228:231], v[72:75], a[120:123], v[228:231]
ds_read_b64_tr_b16 v[34:35], v18 offset:49664
v_mfma_f32_16x16x32_bf16 v[228:231], v[76:79], a[124:127], v[228:231]
buffer_store_dwordx4 v[104:107], v16, s[36:39], s48 offen offset:2048 sc1
v_mfma_f32_16x16x32_bf16 v[232:235], v[64:67], a[176:179], v[232:235]
ds_read_b64_tr_b16 v[36:37], v18 offset:53248
v_mfma_f32_16x16x32_bf16 v[232:235], v[68:71], a[180:183], v[232:235]
v_mul_f32 v188, s49, v188
v_mul_f32 v189, s49, v189
v_mfma_f32_16x16x32_bf16 v[232:235], v[72:75], a[184:187], v[232:235]
ds_read_b64_tr_b16 v[38:39], v18 offset:53760
v_mfma_f32_16x16x32_bf16 v[232:235], v[76:79], a[188:191], v[232:235]
v_mfma_f32_16x16x32_bf16 v[236:239], v[64:67], a[240:243], v[236:239]
ds_read_b64_tr_b16 v[40:41], v18 offset:57344
v_mfma_f32_16x16x32_bf16 v[236:239], v[68:71], a[244:247], v[236:239]
v_mul_f32 v190, s49, v190
v_mul_f32 v191, s49, v191
v_mfma_f32_16x16x32_bf16 v[236:239], v[72:75], a[248:251], v[236:239]
ds_read_b64_tr_b16 v[42:43], v18 offset:57856
v_mfma_f32_16x16x32_bf16 v[236:239], v[76:79], a[252:255], v[236:239]
s_waitcnt lgkmcnt(6)
v_mfma_f32_16x16x32_bf16 v[240:243], v[80:83], a[48:51], v[240:243]
ds_read_b64_tr_b16 v[44:45], v18 offset:61440
v_mfma_f32_16x16x32_bf16 v[240:243], v[84:87], a[52:55], v[240:243]
v_cvt_pk_bf16_f32 v108, v172, v173
v_cvt_pk_bf16_f32 v109, v174, v175
v_mfma_f32_16x16x32_bf16 v[240:243], v[88:91], a[56:59], v[240:243]
ds_read_b64_tr_b16 v[46:47], v18 offset:61952
v_mfma_f32_16x16x32_bf16 v[240:243], v[92:95], a[60:63], v[240:243]
v_mfma_f32_16x16x32_bf16 v[244:247], v[80:83], a[112:115], v[244:247]
ds_read_b64_tr_b16 v[48:49], v19 offset:49152
v_mfma_f32_16x16x32_bf16 v[244:247], v[84:87], a[116:119], v[244:247]
v_cvt_pk_bf16_f32 v110, v188, v189
v_cvt_pk_bf16_f32 v111, v190, v191
v_mfma_f32_16x16x32_bf16 v[244:247], v[88:91], a[120:123], v[244:247]
ds_read_b64_tr_b16 v[50:51], v19 offset:49664
v_mfma_f32_16x16x32_bf16 v[244:247], v[92:95], a[124:127], v[244:247]
v_mfma_f32_16x16x32_bf16 v[248:251], v[80:83], a[176:179], v[248:251]
ds_read_b64_tr_b16 v[52:53], v19 offset:53248
v_mfma_f32_16x16x32_bf16 v[248:251], v[84:87], a[180:183], v[248:251]
v_mfma_f32_16x16x32_bf16 v[248:251], v[88:91], a[184:187], v[248:251]
ds_read_b64_tr_b16 v[54:55], v19 offset:53760
v_mfma_f32_16x16x32_bf16 v[248:251], v[92:95], a[188:191], v[248:251]
buffer_store_dwordx4 v[108:111], v16, s[36:39], s48 offen offset:3072 sc1
v_mfma_f32_16x16x32_bf16 v[252:255], v[80:83], a[240:243], v[252:255]
ds_read_b64_tr_b16 v[56:57], v19 offset:57344
v_mfma_f32_16x16x32_bf16 v[252:255], v[84:87], a[244:247], v[252:255]
s_mov_b32 s47, s52
v_mfma_f32_16x16x32_bf16 v[252:255], v[88:91], a[248:251], v[252:255]
ds_read_b64_tr_b16 v[58:59], v19 offset:57856
v_mfma_f32_16x16x32_bf16 v[252:255], v[92:95], a[252:255], v[252:255]
s_mov_b32 s48, s58
s_cmp_eq_u32 s43, 0
s_cbranch_scc1 K1_FIN01
s_waitcnt lgkmcnt(6)
v_mfma_f32_16x16x32_bf16 v[128:131], v[32:35], a[0:3], 0
ds_read_b64_tr_b16 v[60:61], v19 offset:61440
v_mfma_f32_16x16x32_bf16 v[128:131], v[36:39], a[4:7], v[128:131]
s_barrier
v_mfma_f32_16x16x32_bf16 v[128:131], v[40:43], a[8:11], v[128:131]
ds_read_b64_tr_b16 v[62:63], v19 offset:61952
v_mfma_f32_16x16x32_bf16 v[128:131], v[44:47], a[12:15], v[128:131]
s_mov_b32 s78, 0x200000
s_mov_b32 s82, 0x400000
v_mfma_f32_16x16x32_bf16 v[132:135], v[32:35], a[64:67], 0
ds_read_b64_tr_b16 v[64:65], v20 offset:49152
v_mfma_f32_16x16x32_bf16 v[132:135], v[36:39], a[68:71], v[132:135]
s_lshr_b32 s90, s2, 5
s_bfe_u32 s91, s2, 0x20001
s_mov_b32 s92, 0x06543217
s_cmp_eq_u32 s91, 1
s_cselect_b32 s92, 0x76043215, s92
s_cmp_eq_u32 s91, 3
s_cselect_b32 s92, 0x04567321, s92
s_lshl_b32 s90, s90, 2
s_lshr_b32 s90, s92, s90
s_and_b32 s90, s90, 7
s_lshl_b32 s90, s90, 17
v_mfma_f32_16x16x32_bf16 v[132:135], v[40:43], a[72:75], v[132:135]
ds_read_b64_tr_b16 v[66:67], v20 offset:49664
v_mfma_f32_16x16x32_bf16 v[132:135], v[44:47], a[76:79], v[132:135]
s_lshl_b32 s91, s40, 15
s_sub_u32 s92, 1966080, s90
v_mfma_f32_16x16x32_bf16 v[136:139], v[32:35], a[128:131], 0
ds_read_b64_tr_b16 v[68:69], v20 offset:53248
v_mfma_f32_16x16x32_bf16 v[136:139], v[36:39], a[132:135], v[136:139]
v_mul_f32 v192, s49, v192
v_mul_f32 v193, s49, v193
v_mfma_f32_16x16x32_bf16 v[136:139], v[40:43], a[136:139], v[136:139]
ds_read_b64_tr_b16 v[70:71], v20 offset:53760
v_mfma_f32_16x16x32_bf16 v[136:139], v[44:47], a[140:143], v[136:139]
s_add_u32 s90, s90, s91
s_add_u32 s92, s92, s91
v_mfma_f32_16x16x32_bf16 v[140:143], v[32:35], a[192:195], 0
ds_read_b64_tr_b16 v[72:73], v20 offset:57344
v_mfma_f32_16x16x32_bf16 v[140:143], v[36:39], a[196:199], v[140:143]
v_mul_f32 v194, s49, v194
v_mul_f32 v195, s49, v195
v_mfma_f32_16x16x32_bf16 v[140:143], v[40:43], a[200:203], v[140:143]
ds_read_b64_tr_b16 v[74:75], v20 offset:57856
v_mfma_f32_16x16x32_bf16 v[140:143], v[44:47], a[204:207], v[140:143]
s_waitcnt lgkmcnt(6)
v_mfma_f32_16x16x32_bf16 v[144:147], v[48:51], a[0:3], 0
ds_read_b64_tr_b16 v[76:77], v20 offset:61440
v_mfma_f32_16x16x32_bf16 v[144:147], v[52:55], a[4:7], v[144:147]
v_mul_f32 v208, s49, v208
v_mul_f32 v209, s49, v209
v_mfma_f32_16x16x32_bf16 v[144:147], v[56:59], a[8:11], v[144:147]
ds_read_b64_tr_b16 v[78:79], v20 offset:61952
v_mfma_f32_16x16x32_bf16 v[144:147], v[60:63], a[12:15], v[144:147]
s_mov_b32 s93, 98304
v_mfma_f32_16x16x32_bf16 v[148:151], v[48:51], a[64:67], 0
ds_read_b64_tr_b16 v[80:81], v21 offset:49152
v_mfma_f32_16x16x32_bf16 v[148:151], v[52:55], a[68:71], v[148:151]
v_mul_f32 v210, s49, v210
v_mul_f32 v211, s49, v211
v_mfma_f32_16x16x32_bf16 v[148:151], v[56:59], a[72:75], v[148:151]
ds_read_b64_tr_b16 v[82:83], v21 offset:49664
v_mfma_f32_16x16x32_bf16 v[148:151], v[60:63], a[76:79], v[148:151]
s_cmp_eq_u32 s40, 1
s_cselect_b32 s93, 106496, s93
v_mfma_f32_16x16x32_bf16 v[152:155], v[48:51], a[128:131], 0
ds_read_b64_tr_b16 v[84:85], v21 offset:53248
v_mfma_f32_16x16x32_bf16 v[152:155], v[52:55], a[132:135], v[152:155]
v_cvt_pk_bf16_f32 v96, v192, v193
v_cvt_pk_bf16_f32 v97, v194, v195
v_mfma_f32_16x16x32_bf16 v[152:155], v[56:59], a[136:139], v[152:155]
ds_read_b64_tr_b16 v[86:87], v21 offset:53760
v_mfma_f32_16x16x32_bf16 v[152:155], v[60:63], a[140:143], v[152:155]
s_cmp_eq_u32 s40, 2
s_cselect_b32 s93, 32768, s93
v_mfma_f32_16x16x32_bf16 v[156:159], v[48:51], a[192:195], 0
ds_read_b64_tr_b16 v[88:89], v21 offset:57344
v_mfma_f32_16x16x32_bf16 v[156:159], v[52:55], a[196:199], v[156:159]
v_cvt_pk_bf16_f32 v98, v208, v209
v_cvt_pk_bf16_f32 v99, v210, v211
v_mfma_f32_16x16x32_bf16 v[156:159], v[56:59], a[200:203], v[156:159]
ds_read_b64_tr_b16 v[90:91], v21 offset:57856
v_mfma_f32_16x16x32_bf16 v[156:159], v[60:63], a[204:207], v[156:159]
s_waitcnt lgkmcnt(6)
v_mfma_f32_16x16x32_bf16 v[160:163], v[64:67], a[0:3], 0
ds_read_b64_tr_b16 v[92:93], v21 offset:61440
v_mfma_f32_16x16x32_bf16 v[160:163], v[68:71], a[4:7], v[160:163]
v_mul_f32 v196, s49, v196
v_mul_f32 v197, s49, v197
v_mfma_f32_16x16x32_bf16 v[160:163], v[72:75], a[8:11], v[160:163]
ds_read_b64_tr_b16 v[94:95], v21 offset:61952
v_mfma_f32_16x16x32_bf16 v[160:163], v[76:79], a[12:15], v[160:163]
s_cmp_eq_u32 s40, 3
s_cselect_b32 s93, 40960, s93
v_mfma_f32_16x16x32_bf16 v[164:167], v[64:67], a[64:67], 0
ds_read_b64_tr_b16 v[32:33], v10 offset:49152
v_mfma_f32_16x16x32_bf16 v[164:167], v[68:71], a[68:71], v[164:167]
v_mul_f32 v198, s49, v198
v_mul_f32 v199, s49, v199
v_mfma_f32_16x16x32_bf16 v[164:167], v[72:75], a[72:75], v[164:167]
ds_read_b64_tr_b16 v[34:35], v10 offset:49664
v_mfma_f32_16x16x32_bf16 v[164:167], v[76:79], a[76:79], v[164:167]
buffer_store_dwordx4 v[96:99], v16, s[36:39], s47 offen offset:0 sc1
v_mfma_f32_16x16x32_bf16 v[168:171], v[64:67], a[128:131], 0
ds_read_b64_tr_b16 v[36:37], v10 offset:53248
v_mfma_f32_16x16x32_bf16 v[168:171], v[68:71], a[132:135], v[168:171]
s_mov_b32 s52, s50
s_mov_b32 s58, s51
v_mul_f32 v212, s49, v212
v_mul_f32 v213, s49, v213
v_mfma_f32_16x16x32_bf16 v[168:171], v[72:75], a[136:139], v[168:171]
ds_read_b64_tr_b16 v[38:39], v10 offset:53760
v_mfma_f32_16x16x32_bf16 v[168:171], v[76:79], a[140:143], v[168:171]
s_add_u32 s41, s41, 1
v_mfma_f32_16x16x32_bf16 v[172:175], v[64:67], a[192:195], 0
ds_read_b64_tr_b16 v[40:41], v10 offset:57344
v_mfma_f32_16x16x32_bf16 v[172:175], v[68:71], a[196:199], v[172:175]
s_sub_u32 s43, s43, 1
v_mul_f32 v214, s49, v214
v_mul_f32 v215, s49, v215
v_mfma_f32_16x16x32_bf16 v[172:175], v[72:75], a[200:203], v[172:175]
ds_read_b64_tr_b16 v[42:43], v10 offset:57856
v_mfma_f32_16x16x32_bf16 v[172:175], v[76:79], a[204:207], v[172:175]
s_waitcnt lgkmcnt(6)
v_mfma_f32_16x16x32_bf16 v[176:179], v[80:83], a[0:3], 0
ds_read_b64_tr_b16 v[44:45], v10 offset:61440
v_mfma_f32_16x16x32_bf16 v[176:179], v[84:87], a[4:7], v[176:179]
s_lshr_b32 s60, s41, 1
v_cvt_pk_bf16_f32 v100, v196, v197
v_cvt_pk_bf16_f32 v101, v198, v199
v_mfma_f32_16x16x32_bf16 v[176:179], v[88:91], a[8:11], v[176:179]
ds_read_b64_tr_b16 v[46:47], v10 offset:61952
v_mfma_f32_16x16x32_bf16 v[176:179], v[92:95], a[12:15], v[176:179]
s_lshl_b32 s60, s60, 19
v_mfma_f32_16x16x32_bf16 v[180:183], v[80:83], a[64:67], 0
ds_read_b64_tr_b16 v[48:49], v11 offset:49152
v_mfma_f32_16x16x32_bf16 v[180:183], v[84:87], a[68:71], v[180:183]
s_and_b32 s61, s41, 1
v_cvt_pk_bf16_f32 v102, v212, v213
v_cvt_pk_bf16_f32 v103, v214, v215
v_mfma_f32_16x16x32_bf16 v[180:183], v[88:91], a[72:75], v[180:183]
ds_read_b64_tr_b16 v[50:51], v11 offset:49664
v_mfma_f32_16x16x32_bf16 v[180:183], v[92:95], a[76:79], v[180:183]
s_lshl_b32 s61, s61, 12
v_mfma_f32_16x16x32_bf16 v[184:187], v[80:83], a[128:131], 0
ds_read_b64_tr_b16 v[52:53], v11 offset:53248
v_mfma_f32_16x16x32_bf16 v[184:187], v[84:87], a[132:135], v[184:187]
s_add_u32 s60, s60, s61
v_mfma_f32_16x16x32_bf16 v[184:187], v[88:91], a[136:139], v[184:187]
ds_read_b64_tr_b16 v[54:55], v11 offset:53760
v_mfma_f32_16x16x32_bf16 v[184:187], v[92:95], a[140:143], v[184:187]
buffer_store_dwordx4 v[100:103], v16, s[36:39], s47 offen offset:1024 sc1
v_mfma_f32_16x16x32_bf16 v[188:191], v[80:83], a[192:195], 0
ds_read_b64_tr_b16 v[56:57], v11 offset:57344
v_mfma_f32_16x16x32_bf16 v[188:191], v[84:87], a[196:199], v[188:191]
s_lshl_b32 s61, s54, 13
v_mfma_f32_16x16x32_bf16 v[188:191], v[88:91], a[200:203], v[188:191]
ds_read_b64_tr_b16 v[58:59], v11 offset:57856
v_mfma_f32_16x16x32_bf16 v[188:191], v[92:95], a[204:207], v[188:191]
s_waitcnt lgkmcnt(6)
v_mfma_f32_16x16x32_bf16 v[128:131], v[32:35], a[16:19], v[128:131]
ds_read_b64_tr_b16 v[60:61], v11 offset:61440
v_mfma_f32_16x16x32_bf16 v[128:131], v[36:39], a[20:23], v[128:131]
s_add_u32 s50, s60, s61
v_mfma_f32_16x16x32_bf16 v[128:131], v[40:43], a[24:27], v[128:131]
ds_read_b64_tr_b16 v[62:63], v11 offset:61952
v_mfma_f32_16x16x32_bf16 v[128:131], v[44:47], a[28:31], v[128:131]
s_add_u32 s51, s50, 8192
v_mfma_f32_16x16x32_bf16 v[132:135], v[32:35], a[80:83], v[132:135]
ds_read_b64_tr_b16 v[64:65], v12 offset:49152
v_mfma_f32_16x16x32_bf16 v[132:135], v[36:39], a[84:87], v[132:135]
s_cmp_ge_u32 s41, 64
s_cselect_b32 s53, 1, 0
v_mfma_f32_16x16x32_bf16 v[132:135], v[40:43], a[88:91], v[132:135]
ds_read_b64_tr_b16 v[66:67], v12 offset:49664
v_mfma_f32_16x16x32_bf16 v[132:135], v[44:47], a[92:95], v[132:135]
s_sub_u32 s60, s41, 128
v_mfma_f32_16x16x32_bf16 v[136:139], v[32:35], a[144:147], v[136:139]
ds_read_b64_tr_b16 v[68:69], v12 offset:53248
v_mfma_f32_16x16x32_bf16 v[136:139], v[36:39], a[148:151], v[136:139]
s_cmp_lt_u32 s60, 16
s_cselect_b32 s53, 0, s53
v_mul_f32 v224, s49, v224
v_mul_f32 v225, s49, v225
v_mfma_f32_16x16x32_bf16 v[136:139], v[40:43], a[152:155], v[136:139]
ds_read_b64_tr_b16 v[70:71], v12 offset:53760
v_mfma_f32_16x16x32_bf16 v[136:139], v[44:47], a[156:159], v[136:139]
s_add_u32 m0, s93, 0
s_nop 0
v_mfma_f32_16x16x32_bf16 v[140:143], v[32:35], a[208:211], v[140:143]
ds_read_b64_tr_b16 v[72:73], v12 offset:57344
v_mfma_f32_16x16x32_bf16 v[140:143], v[36:39], a[212:215], v[140:143]
v_mul_f32 v226, s49, v226
v_mul_f32 v227, s49, v227
v_mfma_f32_16x16x32_bf16 v[140:143], v[40:43], a[216:219], v[140:143]
ds_read_b64_tr_b16 v[74:75], v12 offset:57856
v_mfma_f32_16x16x32_bf16 v[140:143], v[44:47], a[220:223], v[140:143]
s_waitcnt lgkmcnt(6)
v_mfma_f32_16x16x32_bf16 v[144:147], v[48:51], a[16:19], v[144:147]
ds_read_b64_tr_b16 v[76:77], v12 offset:61440
v_mfma_f32_16x16x32_bf16 v[144:147], v[52:55], a[20:23], v[144:147]
v_mul_f32 v240, s49, v240
v_mul_f32 v241, s49, v241
v_mfma_f32_16x16x32_bf16 v[144:147], v[56:59], a[24:27], v[144:147]
ds_read_b64_tr_b16 v[78:79], v12 offset:61952
v_mfma_f32_16x16x32_bf16 v[144:147], v[60:63], a[28:31], v[144:147]
buffer_load_dwordx4 v6, s[76:79], s90 offen offset:0 lds
v_mfma_f32_16x16x32_bf16 v[148:151], v[48:51], a[80:83], v[148:151]
ds_read_b64_tr_b16 v[80:81], v13 offset:49152
v_mfma_f32_16x16x32_bf16 v[148:151], v[52:55], a[84:87], v[148:151]
v_mul_f32 v242, s49, v242
v_mul_f32 v243, s49, v243
v_mfma_f32_16x16x32_bf16 v[148:151], v[56:59], a[88:91], v[148:151]
ds_read_b64_tr_b16 v[82:83], v13 offset:49664
v_mfma_f32_16x16x32_bf16 v[148:151], v[60:63], a[92:95], v[148:151]
buffer_load_dwordx4 v7, s[76:79], s90 offen offset:1024 lds
v_mfma_f32_16x16x32_bf16 v[152:155], v[48:51], a[144:147], v[152:155]
ds_read_b64_tr_b16 v[84:85], v13 offset:53248
v_mfma_f32_16x16x32_bf16 v[152:155], v[52:55], a[148:151], v[152:155]
v_cvt_pk_bf16_f32 v104, v224, v225
v_cvt_pk_bf16_f32 v105, v226, v227
v_mfma_f32_16x16x32_bf16 v[152:155], v[56:59], a[152:155], v[152:155]
ds_read_b64_tr_b16 v[86:87], v13 offset:53760
v_mfma_f32_16x16x32_bf16 v[152:155], v[60:63], a[156:159], v[152:155]
buffer_load_dwordx4 v8, s[76:79], s90 offen offset:2048 lds
v_mfma_f32_16x16x32_bf16 v[156:159], v[48:51], a[208:211], v[156:159]
ds_read_b64_tr_b16 v[88:89], v13 offset:57344
v_mfma_f32_16x16x32_bf16 v[156:159], v[52:55], a[212:215], v[156:159]
v_cvt_pk_bf16_f32 v106, v240, v241
v_cvt_pk_bf16_f32 v107, v242, v243
v_mfma_f32_16x16x32_bf16 v[156:159], v[56:59], a[216:219], v[156:159]
ds_read_b64_tr_b16 v[90:91], v13 offset:57856
v_mfma_f32_16x16x32_bf16 v[156:159], v[60:63], a[220:223], v[156:159]
s_waitcnt lgkmcnt(6)
v_mfma_f32_16x16x32_bf16 v[160:163], v[64:67], a[16:19], v[160:163]
ds_read_b64_tr_b16 v[92:93], v13 offset:61440
v_mfma_f32_16x16x32_bf16 v[160:163], v[68:71], a[20:23], v[160:163]
v_mul_f32 v228, s49, v228
v_mul_f32 v229, s49, v229
v_mfma_f32_16x16x32_bf16 v[160:163], v[72:75], a[24:27], v[160:163]
ds_read_b64_tr_b16 v[94:95], v13 offset:61952
v_mfma_f32_16x16x32_bf16 v[160:163], v[76:79], a[28:31], v[160:163]
buffer_load_dwordx4 v9, s[76:79], s90 offen offset:3072 lds
v_mfma_f32_16x16x32_bf16 v[164:167], v[64:67], a[80:83], v[164:167]
ds_read_b64_tr_b16 v[32:33], v22 offset:16384
v_mfma_f32_16x16x32_bf16 v[164:167], v[68:71], a[84:87], v[164:167]
v_mul_f32 v230, s49, v230
v_mul_f32 v231, s49, v231
v_mfma_f32_16x16x32_bf16 v[164:167], v[72:75], a[88:91], v[164:167]
ds_read_b64_tr_b16 v[34:35], v22 offset:16896
v_mfma_f32_16x16x32_bf16 v[164:167], v[76:79], a[92:95], v[164:167]
buffer_store_dwordx4 v[104:107], v16, s[36:39], s47 offen offset:2048 sc1
v_mfma_f32_16x16x32_bf16 v[168:171], v[64:67], a[144:147], v[168:171]
ds_read_b64_tr_b16 v[36:37], v22 offset:20480
v_mfma_f32_16x16x32_bf16 v[168:171], v[68:71], a[148:151], v[168:171]
v_mul_f32 v244, s49, v244
v_mul_f32 v245, s49, v245
v_mfma_f32_16x16x32_bf16 v[168:171], v[72:75], a[152:155], v[168:171]
ds_read_b64_tr_b16 v[38:39], v22 offset:20992
v_mfma_f32_16x16x32_bf16 v[168:171], v[76:79], a[156:159], v[168:171]
s_add_u32 m0, s93, 4096
s_nop 0
v_mfma_f32_16x16x32_bf16 v[172:175], v[64:67], a[208:211], v[172:175]
ds_read_b64_tr_b16 v[40:41], v22 offset:24576
v_mfma_f32_16x16x32_bf16 v[172:175], v[68:71], a[212:215], v[172:175]
v_mul_f32 v246, s49, v246
v_mul_f32 v247, s49, v247
v_mfma_f32_16x16x32_bf16 v[172:175], v[72:75], a[216:219], v[172:175]
ds_read_b64_tr_b16 v[42:43], v22 offset:25088
v_mfma_f32_16x16x32_bf16 v[172:175], v[76:79], a[220:223], v[172:175]
s_waitcnt lgkmcnt(6)
v_mfma_f32_16x16x32_bf16 v[176:179], v[80:83], a[16:19], v[176:179]
ds_read_b64_tr_b16 v[44:45], v22 offset:28672
v_mfma_f32_16x16x32_bf16 v[176:179], v[84:87], a[20:23], v[176:179]
v_cvt_pk_bf16_f32 v108, v228, v229
v_cvt_pk_bf16_f32 v109, v230, v231
v_mfma_f32_16x16x32_bf16 v[176:179], v[88:91], a[24:27], v[176:179]
ds_read_b64_tr_b16 v[46:47], v22 offset:29184
v_mfma_f32_16x16x32_bf16 v[176:179], v[92:95], a[28:31], v[176:179]
buffer_load_dwordx4 v6, s[76:79], s92 offen offset:0 lds
v_mfma_f32_16x16x32_bf16 v[180:183], v[80:83], a[80:83], v[180:183]
ds_read_b64_tr_b16 v[48:49], v23 offset:16384
v_mfma_f32_16x16x32_bf16 v[180:183], v[84:87], a[84:87], v[180:183]
v_cvt_pk_bf16_f32 v110, v244, v245
v_cvt_pk_bf16_f32 v111, v246, v247
v_mfma_f32_16x16x32_bf16 v[180:183], v[88:91], a[88:91], v[180:183]
ds_read_b64_tr_b16 v[50:51], v23 offset:16896
v_mfma_f32_16x16x32_bf16 v[180:183], v[92:95], a[92:95], v[180:183]
buffer_load_dwordx4 v7, s[76:79], s92 offen offset:1024 lds
v_mfma_f32_16x16x32_bf16 v[184:187], v[80:83], a[144:147], v[184:187]
ds_read_b64_tr_b16 v[52:53], v23 offset:20480
v_mfma_f32_16x16x32_bf16 v[184:187], v[84:87], a[148:151], v[184:187]
v_mfma_f32_16x16x32_bf16 v[184:187], v[88:91], a[152:155], v[184:187]
ds_read_b64_tr_b16 v[54:55], v23 offset:20992
v_mfma_f32_16x16x32_bf16 v[184:187], v[92:95], a[156:159], v[184:187]
buffer_store_dwordx4 v[108:111], v16, s[36:39], s47 offen offset:3072 sc1
v_mfma_f32_16x16x32_bf16 v[188:191], v[80:83], a[208:211], v[188:191]
ds_read_b64_tr_b16 v[56:57], v23 offset:24576
v_mfma_f32_16x16x32_bf16 v[188:191], v[84:87], a[212:215], v[188:191]
buffer_load_dwordx4 v8, s[76:79], s92 offen offset:2048 lds
v_mfma_f32_16x16x32_bf16 v[188:191], v[88:91], a[216:219], v[188:191]
ds_read_b64_tr_b16 v[58:59], v23 offset:25088
v_mfma_f32_16x16x32_bf16 v[188:191], v[92:95], a[220:223], v[188:191]
s_waitcnt lgkmcnt(6)
v_mfma_f32_16x16x32_bf16 v[128:131], v[32:35], a[32:35], v[128:131]
ds_read_b64_tr_b16 v[60:61], v23 offset:28672
v_mfma_f32_16x16x32_bf16 v[128:131], v[36:39], a[36:39], v[128:131]
buffer_load_dwordx4 v9, s[76:79], s92 offen offset:3072 lds
v_mfma_f32_16x16x32_bf16 v[128:131], v[40:43], a[40:43], v[128:131]
ds_read_b64_tr_b16 v[62:63], v23 offset:29184
v_mfma_f32_16x16x32_bf16 v[128:131], v[44:47], a[44:47], v[128:131]
v_mfma_f32_16x16x32_bf16 v[132:135], v[32:35], a[96:99], v[132:135]
ds_read_b64_tr_b16 v[64:65], v24 offset:16384
v_mfma_f32_16x16x32_bf16 v[132:135], v[36:39], a[100:103], v[132:135]
s_and_b32 s90, s2, 31
s_lshl_b32 s90, s90, 8
v_mfma_f32_16x16x32_bf16 v[132:135], v[40:43], a[104:107], v[132:135]
ds_read_b64_tr_b16 v[66:67], v24 offset:16896
v_mfma_f32_16x16x32_bf16 v[132:135], v[44:47], a[108:111], v[132:135]
s_lshl_b32 s91, s40, 17
s_add_u32 s90, s90, s91
v_mfma_f32_16x16x32_bf16 v[136:139], v[32:35], a[160:163], v[136:139]
ds_read_b64_tr_b16 v[68:69], v24 offset:20480
v_mfma_f32_16x16x32_bf16 v[136:139], v[36:39], a[164:167], v[136:139]
v_mul_f32 v200, s49, v200
v_mul_f32 v201, s49, v201
v_mfma_f32_16x16x32_bf16 v[136:139], v[40:43], a[168:171], v[136:139]
ds_read_b64_tr_b16 v[70:71], v24 offset:20992
v_mfma_f32_16x16x32_bf16 v[136:139], v[44:47], a[172:175], v[136:139]
s_lshl_b32 s91, s40, 12
s_add_u32 m0, s91, 131072
v_mfma_f32_16x16x32_bf16 v[140:143], v[32:35], a[224:227], v[140:143]
ds_read_b64_tr_b16 v[72:73], v24 offset:24576
v_mfma_f32_16x16x32_bf16 v[140:143], v[36:39], a[228:231], v[140:143]
v_mul_f32 v202, s49, v202
v_mul_f32 v203, s49, v203
v_mfma_f32_16x16x32_bf16 v[140:143], v[40:43], a[232:235], v[140:143]
ds_read_b64_tr_b16 v[74:75], v24 offset:25088
v_mfma_f32_16x16x32_bf16 v[140:143], v[44:47], a[236:239], v[140:143]
s_waitcnt lgkmcnt(6)
v_mfma_f32_16x16x32_bf16 v[144:147], v[48:51], a[32:35], v[144:147]
ds_read_b64_tr_b16 v[76:77], v24 offset:28672
v_mfma_f32_16x16x32_bf16 v[144:147], v[52:55], a[36:39], v[144:147]
v_mul_f32 v216, s49, v216
v_mul_f32 v217, s49, v217
v_mfma_f32_16x16x32_bf16 v[144:147], v[56:59], a[40:43], v[144:147]
ds_read_b64_tr_b16 v[78:79], v24 offset:29184
v_mfma_f32_16x16x32_bf16 v[144:147], v[60:63], a[44:47], v[144:147]
v_lshrrev_b32 v14, 4, v0
v_lshlrev_b32 v15, 13, v14
v_mfma_f32_16x16x32_bf16 v[148:151], v[48:51], a[96:99], v[148:151]
ds_read_b64_tr_b16 v[80:81], v25 offset:16384
v_mfma_f32_16x16x32_bf16 v[148:151], v[52:55], a[100:103], v[148:151]
v_mul_f32 v218, s49, v218
v_mul_f32 v219, s49, v219
v_mfma_f32_16x16x32_bf16 v[148:151], v[56:59], a[104:107], v[148:151]
ds_read_b64_tr_b16 v[82:83], v25 offset:16896
v_mfma_f32_16x16x32_bf16 v[148:151], v[60:63], a[108:111], v[148:151]
v_lshlrev_b32 v14, 1, v14
v_and_b32 v26, 15, v0
v_mfma_f32_16x16x32_bf16 v[152:155], v[48:51], a[160:163], v[152:155]
ds_read_b64_tr_b16 v[84:85], v25 offset:20480
v_mfma_f32_16x16x32_bf16 v[152:155], v[52:55], a[164:167], v[152:155]
v_cvt_pk_bf16_f32 v96, v200, v201
v_cvt_pk_bf16_f32 v97, v202, v203
v_mfma_f32_16x16x32_bf16 v[152:155], v[56:59], a[168:171], v[152:155]
ds_read_b64_tr_b16 v[86:87], v25 offset:20992
v_mfma_f32_16x16x32_bf16 v[152:155], v[60:63], a[172:175], v[152:155]
v_xor_b32 v26, v26, v14
v_mfma_f32_16x16x32_bf16 v[156:159], v[48:51], a[224:227], v[156:159]
ds_read_b64_tr_b16 v[88:89], v25 offset:24576
v_mfma_f32_16x16x32_bf16 v[156:159], v[52:55], a[228:231], v[156:159]
v_cvt_pk_bf16_f32 v98, v216, v217
v_cvt_pk_bf16_f32 v99, v218, v219
v_mfma_f32_16x16x32_bf16 v[156:159], v[56:59], a[232:235], v[156:159]
ds_read_b64_tr_b16 v[90:91], v25 offset:25088
v_mfma_f32_16x16x32_bf16 v[156:159], v[60:63], a[236:239], v[156:159]
s_waitcnt lgkmcnt(6)
v_mfma_f32_16x16x32_bf16 v[160:163], v[64:67], a[32:35], v[160:163]
ds_read_b64_tr_b16 v[92:93], v25 offset:28672
v_mfma_f32_16x16x32_bf16 v[160:163], v[68:71], a[36:39], v[160:163]
v_mul_f32 v204, s49, v204
v_mul_f32 v205, s49, v205
v_mfma_f32_16x16x32_bf16 v[160:163], v[72:75], a[40:43], v[160:163]
ds_read_b64_tr_b16 v[94:95], v25 offset:29184
v_mfma_f32_16x16x32_bf16 v[160:163], v[76:79], a[44:47], v[160:163]
v_xor_b32 v2, 0, v26
v_lshl_add_u32 v2, v2, 4, v15
v_mfma_f32_16x16x32_bf16 v[164:167], v[64:67], a[96:99], v[164:167]
ds_read_b64_tr_b16 v[32:33], v18 offset:16384
v_mfma_f32_16x16x32_bf16 v[164:167], v[68:71], a[100:103], v[164:167]
v_mul_f32 v206, s49, v206
v_mul_f32 v207, s49, v207
v_mfma_f32_16x16x32_bf16 v[164:167], v[72:75], a[104:107], v[164:167]
ds_read_b64_tr_b16 v[34:35], v18 offset:16896
v_mfma_f32_16x16x32_bf16 v[164:167], v[76:79], a[108:111], v[164:167]
buffer_store_dwordx4 v[96:99], v16, s[36:39], s48 offen offset:0 sc1
v_mfma_f32_16x16x32_bf16 v[168:171], v[64:67], a[160:163], v[168:171]
ds_read_b64_tr_b16 v[36:37], v18 offset:20480
v_mfma_f32_16x16x32_bf16 v[168:171], v[68:71], a[164:167], v[168:171]
v_mul_f32 v220, s49, v220
v_mul_f32 v221, s49, v221
v_mfma_f32_16x16x32_bf16 v[168:171], v[72:75], a[168:171], v[168:171]
ds_read_b64_tr_b16 v[38:39], v18 offset:20992
v_mfma_f32_16x16x32_bf16 v[168:171], v[76:79], a[172:175], v[168:171]
v_add_u32 v2, 0, v2
v_mfma_f32_16x16x32_bf16 v[172:175], v[64:67], a[224:227], v[172:175]
ds_read_b64_tr_b16 v[40:41], v18 offset:24576
v_mfma_f32_16x16x32_bf16 v[172:175], v[68:71], a[228:231], v[172:175]
v_mul_f32 v222, s49, v222
v_mul_f32 v223, s49, v223
v_mfma_f32_16x16x32_bf16 v[172:175], v[72:75], a[232:235], v[172:175]
ds_read_b64_tr_b16 v[42:43], v18 offset:25088
v_mfma_f32_16x16x32_bf16 v[172:175], v[76:79], a[236:239], v[172:175]
s_waitcnt lgkmcnt(6)
v_mfma_f32_16x16x32_bf16 v[176:179], v[80:83], a[32:35], v[176:179]
ds_read_b64_tr_b16 v[44:45], v18 offset:28672
v_mfma_f32_16x16x32_bf16 v[176:179], v[84:87], a[36:39], v[176:179]
v_cvt_pk_bf16_f32 v100, v204, v205
v_cvt_pk_bf16_f32 v101, v206, v207
v_mfma_f32_16x16x32_bf16 v[176:179], v[88:91], a[40:43], v[176:179]
ds_read_b64_tr_b16 v[46:47], v18 offset:29184
v_mfma_f32_16x16x32_bf16 v[176:179], v[92:95], a[44:47], v[176:179]
buffer_load_dwordx4 v2, s[80:83], s90 offen offset:0 lds
v_mfma_f32_16x16x32_bf16 v[180:183], v[80:83], a[96:99], v[180:183]
ds_read_b64_tr_b16 v[48:49], v19 offset:16384
v_mfma_f32_16x16x32_bf16 v[180:183], v[84:87], a[100:103], v[180:183]
v_cvt_pk_bf16_f32 v102, v220, v221
v_cvt_pk_bf16_f32 v103, v222, v223
v_mfma_f32_16x16x32_bf16 v[180:183], v[88:91], a[104:107], v[180:183]
ds_read_b64_tr_b16 v[50:51], v19 offset:16896
v_mfma_f32_16x16x32_bf16 v[180:183], v[92:95], a[108:111], v[180:183]
v_xor_b32 v3, 0, v26
v_lshl_add_u32 v3, v3, 4, v15
v_mfma_f32_16x16x32_bf16 v[184:187], v[80:83], a[160:163], v[184:187]
ds_read_b64_tr_b16 v[52:53], v19 offset:20480
v_mfma_f32_16x16x32_bf16 v[184:187], v[84:87], a[164:167], v[184:187]
v_add_u32 v3, 31744, v3
v_mfma_f32_16x16x32_bf16 v[184:187], v[88:91], a[168:171], v[184:187]
ds_read_b64_tr_b16 v[54:55], v19 offset:20992
v_mfma_f32_16x16x32_bf16 v[184:187], v[92:95], a[172:175], v[184:187]
buffer_store_dwordx4 v[100:103], v16, s[36:39], s48 offen offset:1024 sc1
v_mfma_f32_16x16x32_bf16 v[188:191], v[80:83], a[224:227], v[188:191]
ds_read_b64_tr_b16 v[56:57], v19 offset:24576
v_mfma_f32_16x16x32_bf16 v[188:191], v[84:87], a[228:231], v[188:191]
buffer_load_dwordx4 v3, s[80:83], s90 offen offset:1024 lds
v_mfma_f32_16x16x32_bf16 v[188:191], v[88:91], a[232:235], v[188:191]
ds_read_b64_tr_b16 v[58:59], v19 offset:25088
v_mfma_f32_16x16x32_bf16 v[188:191], v[92:95], a[236:239], v[188:191]
s_waitcnt lgkmcnt(6)
v_mfma_f32_16x16x32_bf16 v[128:131], v[32:35], a[48:51], v[128:131]
ds_read_b64_tr_b16 v[60:61], v19 offset:28672
v_mfma_f32_16x16x32_bf16 v[128:131], v[36:39], a[52:55], v[128:131]
v_xor_b32 v4, 8, v26
v_lshl_add_u32 v4, v4, 4, v15
v_mfma_f32_16x16x32_bf16 v[128:131], v[40:43], a[56:59], v[128:131]
ds_read_b64_tr_b16 v[62:63], v19 offset:29184
v_mfma_f32_16x16x32_bf16 v[128:131], v[44:47], a[60:63], v[128:131]
v_add_u32 v4, 63488, v4
v_mfma_f32_16x16x32_bf16 v[132:135], v[32:35], a[112:115], v[132:135]
ds_read_b64_tr_b16 v[64:65], v20 offset:16384
v_mfma_f32_16x16x32_bf16 v[132:135], v[36:39], a[116:119], v[132:135]
buffer_load_dwordx4 v4, s[80:83], s90 offen offset:2048 lds
v_mfma_f32_16x16x32_bf16 v[132:135], v[40:43], a[120:123], v[132:135]
ds_read_b64_tr_b16 v[66:67], v20 offset:16896
v_mfma_f32_16x16x32_bf16 v[132:135], v[44:47], a[124:127], v[132:135]
v_mfma_f32_16x16x32_bf16 v[136:139], v[32:35], a[176:179], v[136:139]
ds_read_b64_tr_b16 v[68:69], v20 offset:20480
v_mfma_f32_16x16x32_bf16 v[136:139], v[36:39], a[180:183], v[136:139]
v_mul_f32 v232, s49, v232
v_mul_f32 v233, s49, v233
v_mfma_f32_16x16x32_bf16 v[136:139], v[40:43], a[184:187], v[136:139]
ds_read_b64_tr_b16 v[70:71], v20 offset:20992
v_mfma_f32_16x16x32_bf16 v[136:139], v[44:47], a[188:191], v[136:139]
v_xor_b32 v5, 8, v26
v_lshl_add_u32 v5, v5, 4, v15
v_mfma_f32_16x16x32_bf16 v[140:143], v[32:35], a[240:243], v[140:143]
ds_read_b64_tr_b16 v[72:73], v20 offset:24576
v_mfma_f32_16x16x32_bf16 v[140:143], v[36:39], a[244:247], v[140:143]
v_mul_f32 v234, s49, v234
v_mul_f32 v235, s49, v235
v_mfma_f32_16x16x32_bf16 v[140:143], v[40:43], a[248:251], v[140:143]
ds_read_b64_tr_b16 v[74:75], v20 offset:25088
v_mfma_f32_16x16x32_bf16 v[140:143], v[44:47], a[252:255], v[140:143]
s_waitcnt lgkmcnt(6)
v_mfma_f32_16x16x32_bf16 v[144:147], v[48:51], a[48:51], v[144:147]
ds_read_b64_tr_b16 v[76:77], v20 offset:28672
v_mfma_f32_16x16x32_bf16 v[144:147], v[52:55], a[52:55], v[144:147]
v_mul_f32 v248, s49, v248
v_mul_f32 v249, s49, v249
v_mfma_f32_16x16x32_bf16 v[144:147], v[56:59], a[56:59], v[144:147]
ds_read_b64_tr_b16 v[78:79], v20 offset:29184
v_mfma_f32_16x16x32_bf16 v[144:147], v[60:63], a[60:63], v[144:147]
v_add_u32 v5, 95232, v5
v_mfma_f32_16x16x32_bf16 v[148:151], v[48:51], a[112:115], v[148:151]
ds_read_b64_tr_b16 v[80:81], v21 offset:16384
v_mfma_f32_16x16x32_bf16 v[148:151], v[52:55], a[116:119], v[148:151]
v_mul_f32 v250, s49, v250
v_mul_f32 v251, s49, v251
v_mfma_f32_16x16x32_bf16 v[148:151], v[56:59], a[120:123], v[148:151]
ds_read_b64_tr_b16 v[82:83], v21 offset:16896
v_mfma_f32_16x16x32_bf16 v[148:151], v[60:63], a[124:127], v[148:151]
buffer_load_dwordx4 v5, s[80:83], s90 offen offset:3072 lds
v_mfma_f32_16x16x32_bf16 v[152:155], v[48:51], a[176:179], v[152:155]
ds_read_b64_tr_b16 v[84:85], v21 offset:20480
v_mfma_f32_16x16x32_bf16 v[152:155], v[52:55], a[180:183], v[152:155]
v_cvt_pk_bf16_f32 v104, v232, v233
v_cvt_pk_bf16_f32 v105, v234, v235
v_mfma_f32_16x16x32_bf16 v[152:155], v[56:59], a[184:187], v[152:155]
ds_read_b64_tr_b16 v[86:87], v21 offset:20992
v_mfma_f32_16x16x32_bf16 v[152:155], v[60:63], a[188:191], v[152:155]
v_mfma_f32_16x16x32_bf16 v[156:159], v[48:51], a[240:243], v[156:159]
ds_read_b64_tr_b16 v[88:89], v21 offset:24576
v_mfma_f32_16x16x32_bf16 v[156:159], v[52:55], a[244:247], v[156:159]
v_cvt_pk_bf16_f32 v106, v248, v249
v_cvt_pk_bf16_f32 v107, v250, v251
v_mfma_f32_16x16x32_bf16 v[156:159], v[56:59], a[248:251], v[156:159]
ds_read_b64_tr_b16 v[90:91], v21 offset:25088
v_mfma_f32_16x16x32_bf16 v[156:159], v[60:63], a[252:255], v[156:159]
s_waitcnt lgkmcnt(6)
v_mfma_f32_16x16x32_bf16 v[160:163], v[64:67], a[48:51], v[160:163]
ds_read_b64_tr_b16 v[92:93], v21 offset:28672
v_mfma_f32_16x16x32_bf16 v[160:163], v[68:71], a[52:55], v[160:163]
v_mul_f32 v236, s49, v236
v_mul_f32 v237, s49, v237
v_mfma_f32_16x16x32_bf16 v[160:163], v[72:75], a[56:59], v[160:163]
ds_read_b64_tr_b16 v[94:95], v21 offset:29184
v_mfma_f32_16x16x32_bf16 v[160:163], v[76:79], a[60:63], v[160:163]
v_mfma_f32_16x16x32_bf16 v[164:167], v[64:67], a[112:115], v[164:167]
v_mfma_f32_16x16x32_bf16 v[164:167], v[68:71], a[116:119], v[164:167]
v_mul_f32 v238, s49, v238
v_mul_f32 v239, s49, v239
v_mfma_f32_16x16x32_bf16 v[164:167], v[72:75], a[120:123], v[164:167]
v_mfma_f32_16x16x32_bf16 v[164:167], v[76:79], a[124:127], v[164:167]
buffer_store_dwordx4 v[104:107], v16, s[36:39], s48 offen offset:2048 sc1
v_mfma_f32_16x16x32_bf16 v[168:171], v[64:67], a[176:179], v[168:171]
v_mfma_f32_16x16x32_bf16 v[168:171], v[68:71], a[180:183], v[168:171]
v_mul_f32 v252, s49, v252
v_mul_f32 v253, s49, v253
v_mfma_f32_16x16x32_bf16 v[168:171], v[72:75], a[184:187], v[168:171]
v_mfma_f32_16x16x32_bf16 v[168:171], v[76:79], a[188:191], v[168:171]
v_mfma_f32_16x16x32_bf16 v[172:175], v[64:67], a[240:243], v[172:175]
v_mfma_f32_16x16x32_bf16 v[172:175], v[68:71], a[244:247], v[172:175]
v_mul_f32 v254, s49, v254
v_mul_f32 v255, s49, v255
v_mfma_f32_16x16x32_bf16 v[172:175], v[72:75], a[248:251], v[172:175]
v_mfma_f32_16x16x32_bf16 v[172:175], v[76:79], a[252:255], v[172:175]
s_waitcnt lgkmcnt(0)
v_mfma_f32_16x16x32_bf16 v[176:179], v[80:83], a[48:51], v[176:179]
v_mfma_f32_16x16x32_bf16 v[176:179], v[84:87], a[52:55], v[176:179]
v_cvt_pk_bf16_f32 v108, v236, v237
v_cvt_pk_bf16_f32 v109, v238, v239
v_mfma_f32_16x16x32_bf16 v[176:179], v[88:91], a[56:59], v[176:179]
v_mfma_f32_16x16x32_bf16 v[176:179], v[92:95], a[60:63], v[176:179]
v_mfma_f32_16x16x32_bf16 v[180:183], v[80:83], a[112:115], v[180:183]
v_mfma_f32_16x16x32_bf16 v[180:183], v[84:87], a[116:119], v[180:183]
v_cvt_pk_bf16_f32 v110, v252, v253
v_cvt_pk_bf16_f32 v111, v254, v255
v_mfma_f32_16x16x32_bf16 v[180:183], v[88:91], a[120:123], v[180:183]
v_mfma_f32_16x16x32_bf16 v[180:183], v[92:95], a[124:127], v[180:183]
v_mfma_f32_16x16x32_bf16 v[184:187], v[80:83], a[176:179], v[184:187]
v_mfma_f32_16x16x32_bf16 v[184:187], v[84:87], a[180:183], v[184:187]
v_mfma_f32_16x16x32_bf16 v[184:187], v[88:91], a[184:187], v[184:187]
v_mfma_f32_16x16x32_bf16 v[184:187], v[92:95], a[188:191], v[184:187]
buffer_store_dwordx4 v[108:111], v16, s[36:39], s48 offen offset:3072 sc1
v_mfma_f32_16x16x32_bf16 v[188:191], v[80:83], a[240:243], v[188:191]
v_mfma_f32_16x16x32_bf16 v[188:191], v[84:87], a[244:247], v[188:191]
s_mov_b32 s47, s52
v_mfma_f32_16x16x32_bf16 v[188:191], v[88:91], a[248:251], v[188:191]
v_mfma_f32_16x16x32_bf16 v[188:191], v[92:95], a[252:255], v[188:191]
s_mov_b32 s48, s58
s_nop 7
v_mul_f32 v128, s49, v128
v_mul_f32 v129, s49, v129
v_mul_f32 v130, s49, v130
v_mul_f32 v131, s49, v131
v_mul_f32 v144, s49, v144
v_mul_f32 v145, s49, v145
v_mul_f32 v146, s49, v146
v_mul_f32 v147, s49, v147
v_cvt_pk_bf16_f32 v96, v128, v129
v_cvt_pk_bf16_f32 v97, v130, v131
v_cvt_pk_bf16_f32 v98, v144, v145
v_cvt_pk_bf16_f32 v99, v146, v147
buffer_store_dwordx4 v[96:99], v16, s[36:39], s47 offen offset:0 sc1
v_mul_f32 v132, s49, v132
v_mul_f32 v133, s49, v133
v_mul_f32 v134, s49, v134
v_mul_f32 v135, s49, v135
v_mul_f32 v148, s49, v148
v_mul_f32 v149, s49, v149
v_mul_f32 v150, s49, v150
v_mul_f32 v151, s49, v151
v_cvt_pk_bf16_f32 v100, v132, v133
v_cvt_pk_bf16_f32 v101, v134, v135
v_cvt_pk_bf16_f32 v102, v148, v149
v_cvt_pk_bf16_f32 v103, v150, v151
buffer_store_dwordx4 v[100:103], v16, s[36:39], s47 offen offset:1024 sc1
v_mul_f32 v160, s49, v160
v_mul_f32 v161, s49, v161
v_mul_f32 v162, s49, v162
v_mul_f32 v163, s49, v163
v_mul_f32 v176, s49, v176
v_mul_f32 v177, s49, v177
v_mul_f32 v178, s49, v178
v_mul_f32 v179, s49, v179
v_cvt_pk_bf16_f32 v104, v160, v161
v_cvt_pk_bf16_f32 v105, v162, v163
v_cvt_pk_bf16_f32 v106, v176, v177
v_cvt_pk_bf16_f32 v107, v178, v179
buffer_store_dwordx4 v[104:107], v16, s[36:39], s47 offen offset:2048 sc1
v_mul_f32 v164, s49, v164
v_mul_f32 v165, s49, v165
v_mul_f32 v166, s49, v166
v_mul_f32 v167, s49, v167
v_mul_f32 v180, s49, v180
v_mul_f32 v181, s49, v181
v_mul_f32 v182, s49, v182
v_mul_f32 v183, s49, v183
v_cvt_pk_bf16_f32 v108, v164, v165
v_cvt_pk_bf16_f32 v109, v166, v167
v_cvt_pk_bf16_f32 v110, v180, v181
v_cvt_pk_bf16_f32 v111, v182, v183
buffer_store_dwordx4 v[108:111], v16, s[36:39], s47 offen offset:3072 sc1
v_mul_f32 v136, s49, v136
v_mul_f32 v137, s49, v137
v_mul_f32 v138, s49, v138
v_mul_f32 v139, s49, v139
v_mul_f32 v152, s49, v152
v_mul_f32 v153, s49, v153
v_mul_f32 v154, s49, v154
v_mul_f32 v155, s49, v155
v_cvt_pk_bf16_f32 v96, v136, v137
v_cvt_pk_bf16_f32 v97, v138, v139
v_cvt_pk_bf16_f32 v98, v152, v153
v_cvt_pk_bf16_f32 v99, v154, v155
buffer_store_dwordx4 v[96:99], v16, s[36:39], s48 offen offset:0 sc1
v_mul_f32 v140, s49, v140
v_mul_f32 v141, s49, v141
v_mul_f32 v142, s49, v142
v_mul_f32 v143, s49, v143
v_mul_f32 v156, s49, v156
v_mul_f32 v157, s49, v157
v_mul_f32 v158, s49, v158
v_mul_f32 v159, s49, v159
v_cvt_pk_bf16_f32 v100, v140, v141
v_cvt_pk_bf16_f32 v101, v142, v143
v_cvt_pk_bf16_f32 v102, v156, v157
v_cvt_pk_bf16_f32 v103, v158, v159
buffer_store_dwordx4 v[100:103], v16, s[36:39], s48 offen offset:1024 sc1
v_mul_f32 v168, s49, v168
v_mul_f32 v169, s49, v169
v_mul_f32 v170, s49, v170
v_mul_f32 v171, s49, v171
v_mul_f32 v184, s49, v184
v_mul_f32 v185, s49, v185
v_mul_f32 v186, s49, v186
v_mul_f32 v187, s49, v187
v_cvt_pk_bf16_f32 v104, v168, v169
v_cvt_pk_bf16_f32 v105, v170, v171
v_cvt_pk_bf16_f32 v106, v184, v185
v_cvt_pk_bf16_f32 v107, v186, v187
buffer_store_dwordx4 v[104:107], v16, s[36:39], s48 offen offset:2048 sc1
v_mul_f32 v172, s49, v172
v_mul_f32 v173, s49, v173
v_mul_f32 v174, s49, v174
v_mul_f32 v175, s49, v175
v_mul_f32 v188, s49, v188
v_mul_f32 v189, s49, v189
v_mul_f32 v190, s49, v190
v_mul_f32 v191, s49, v191
v_cvt_pk_bf16_f32 v108, v172, v173
v_cvt_pk_bf16_f32 v109, v174, v175
v_cvt_pk_bf16_f32 v110, v188, v189
v_cvt_pk_bf16_f32 v111, v190, v191
buffer_store_dwordx4 v[108:111], v16, s[36:39], s48 offen offset:3072 sc1
s_branch K1_END2
K1_FIN01:
s_barrier
s_call_b64 s[88:89], K1_Q0
s_nop 7
v_mul_f32 v192, s49, v192
v_mul_f32 v193, s49, v193
v_mul_f32 v194, s49, v194
v_mul_f32 v195, s49, v195
v_mul_f32 v208, s49, v208
v_mul_f32 v209, s49, v209
v_mul_f32 v210, s49, v210
v_mul_f32 v211, s49, v211
v_cvt_pk_bf16_f32 v96, v192, v193
v_cvt_pk_bf16_f32 v97, v194, v195
v_cvt_pk_bf16_f32 v98, v208, v209
v_cvt_pk_bf16_f32 v99, v210, v211
buffer_store_dwordx4 v[96:99], v16, s[36:39], s47 offen offset:0 sc1
v_mul_f32 v196, s49, v196
v_mul_f32 v197, s49, v197
v_mul_f32 v198, s49, v198
v_mul_f32 v199, s49, v199
v_mul_f32 v212, s49, v212
v_mul_f32 v213, s49, v213
v_mul_f32 v214, s49, v214
v_mul_f32 v215, s49, v215
v_cvt_pk_bf16_f32 v100, v196, v197
v_cvt_pk_bf16_f32 v101, v198, v199
v_cvt_pk_bf16_f32 v102, v212, v213
v_cvt_pk_bf16_f32 v103, v214, v215
buffer_store_dwordx4 v[100:103], v16, s[36:39], s47 offen offset:1024 sc1
v_mul_f32 v224, s49, v224
v_mul_f32 v225, s49, v225
v_mul_f32 v226, s49, v226
v_mul_f32 v227, s49, v227
v_mul_f32 v240, s49, v240
v_mul_f32 v241, s49, v241
v_mul_f32 v242, s49, v242
v_mul_f32 v243, s49, v243
v_cvt_pk_bf16_f32 v104, v224, v225
v_cvt_pk_bf16_f32 v105, v226, v227
v_cvt_pk_bf16_f32 v106, v240, v241
v_cvt_pk_bf16_f32 v107, v242, v243
buffer_store_dwordx4 v[104:107], v16, s[36:39], s47 offen offset:2048 sc1
v_mul_f32 v228, s49, v228
v_mul_f32 v229, s49, v229
v_mul_f32 v230, s49, v230
v_mul_f32 v231, s49, v231
v_mul_f32 v244, s49, v244
v_mul_f32 v245, s49, v245
v_mul_f32 v246, s49, v246
v_mul_f32 v247, s49, v247
v_cvt_pk_bf16_f32 v108, v228, v229
v_cvt_pk_bf16_f32 v109, v230, v231
v_cvt_pk_bf16_f32 v110, v244, v245
v_cvt_pk_bf16_f32 v111, v246, v247
buffer_store_dwordx4 v[108:111], v16, s[36:39], s47 offen offset:3072 sc1
v_mul_f32 v200, s49, v200
v_mul_f32 v201, s49, v201
v_mul_f32 v202, s49, v202
v_mul_f32 v203, s49, v203
v_mul_f32 v216, s49, v216
v_mul_f32 v217, s49, v217
v_mul_f32 v218, s49, v218
v_mul_f32 v219, s49, v219
v_cvt_pk_bf16_f32 v96, v200, v201
v_cvt_pk_bf16_f32 v97, v202, v203
v_cvt_pk_bf16_f32 v98, v216, v217
v_cvt_pk_bf16_f32 v99, v218, v219
buffer_store_dwordx4 v[96:99], v16, s[36:39], s48 offen offset:0 sc1
v_mul_f32 v204, s49, v204
v_mul_f32 v205, s49, v205
v_mul_f32 v206, s49, v206
v_mul_f32 v207, s49, v207
v_mul_f32 v220, s49, v220
v_mul_f32 v221, s49, v221
v_mul_f32 v222, s49, v222
v_mul_f32 v223, s49, v223
v_cvt_pk_bf16_f32 v100, v204, v205
v_cvt_pk_bf16_f32 v101, v206, v207
v_cvt_pk_bf16_f32 v102, v220, v221
v_cvt_pk_bf16_f32 v103, v222, v223
buffer_store_dwordx4 v[100:103], v16, s[36:39], s48 offen offset:1024 sc1
v_mul_f32 v232, s49, v232
v_mul_f32 v233, s49, v233
v_mul_f32 v234, s49, v234
v_mul_f32 v235, s49, v235
v_mul_f32 v248, s49, v248
v_mul_f32 v249, s49, v249
v_mul_f32 v250, s49, v250
v_mul_f32 v251, s49, v251
v_cvt_pk_bf16_f32 v104, v232, v233
v_cvt_pk_bf16_f32 v105, v234, v235
v_cvt_pk_bf16_f32 v106, v248, v249
v_cvt_pk_bf16_f32 v107, v250, v251
buffer_store_dwordx4 v[104:107], v16, s[36:39], s48 offen offset:2048 sc1
v_mul_f32 v236, s49, v236
v_mul_f32 v237, s49, v237
v_mul_f32 v238, s49, v238
v_mul_f32 v239, s49, v239
v_mul_f32 v252, s49, v252
v_mul_f32 v253, s49, v253
v_mul_f32 v254, s49, v254
v_mul_f32 v255, s49, v255
v_cvt_pk_bf16_f32 v108, v236, v237
v_cvt_pk_bf16_f32 v109, v238, v239
v_cvt_pk_bf16_f32 v110, v252, v253
v_cvt_pk_bf16_f32 v111, v254, v255
buffer_store_dwordx4 v[108:111], v16, s[36:39], s48 offen offset:3072 sc1
s_waitcnt vmcnt(0)
s_branch K1_END2
K1_RELAY:
s_waitcnt lgkmcnt(0)
s_mov_b32 s36, s26
s_mov_b32 s37, s27
s_mov_b32 s38, 0x10000000
s_mov_b32 s39, 0x20000
s_mov_b64 s[76:77], s[4:5]
s_mov_b32 s79, 0x20000
s_mov_b64 s[80:81], s[8:9]
s_mov_b32 s83, 0x20000
s_mov_b32 s78, 0
s_mov_b32 s82, 0
s_lshl_b32 s84, s2, 2
s_add_u32 s84, s84, s40
s_lshl_b32 s85, s84, 12
s_lshl_b32 s84, s84, 11
s_mov_b32 s78, 0x200000
s_mov_b32 s82, 0x400000
v_lshlrev_b32 v16, 4, v0
v_mov_b32 v56, 0
v_mov_b32 v57, 0
v_mov_b32 v58, 0
v_mov_b32 v59, 0
s_lshl_b32 s48, s54, 2
s_add_u32 s48, s48, s40
s_lshl_b32 s48, s48, 10
s_add_u32 s48, s48, 115343360
buffer_store_dwordx4 v[56:59], v16, s[36:39], s48 offen sc1
buffer_load_dwordx4 v[112:115], v16, s[76:79], s84 offen offset:0
buffer_load_dwordx4 v[116:119], v16, s[76:79], s84 offen offset:1024
buffer_load_dwordx4 v[112:115], v16, s[80:83], s85 offen offset:0
buffer_load_dwordx4 v[116:119], v16, s[80:83], s85 offen offset:1024
buffer_load_dwordx4 v[120:123], v16, s[80:83], s85 offen offset:2048
buffer_load_dwordx4 v[124:127], v16, s[80:83], s85 offen offset:3072
v_lshrrev_b32 v100, 3, v0
v_lshlrev_b32 v101, 10, v100
v_lshrrev_b32 v102, 4, v0
v_and_b32 v103, 7, v0
v_xor_b32 v102, v102, v103
v_xor_b32 v104, 0, v102
v_lshl_add_u32 v104, v104, 4, v101
v_add_u32 v6, 0, v104
v_xor_b32 v104, 4, v102
v_lshl_add_u32 v104, v104, 4, v101
v_add_u32 v7, 7168, v104
v_xor_b32 v104, 0, v102
v_lshl_add_u32 v104, v104, 4, v101
v_add_u32 v8, 14336, v104
v_xor_b32 v104, 4, v102
v_lshl_add_u32 v104, v104, 4, v101
v_add_u32 v9, 21504, v104
s_call_b64 s[88:89], K1_Q0
s_waitcnt vmcnt(0)
s_branch K1_END2
K1_Q0:
s_mov_b32 s78, 0x200000
s_mov_b32 s82, 0x400000
s_lshr_b32 s90, s2, 5
s_bfe_u32 s91, s2, 0x20001
s_mov_b32 s92, 0x06543217
s_cmp_eq_u32 s91, 1
s_cselect_b32 s92, 0x76043215, s92
s_cmp_eq_u32 s91, 3
s_cselect_b32 s92, 0x04567321, s92
s_lshl_b32 s90, s90, 2
s_lshr_b32 s90, s92, s90
s_and_b32 s90, s90, 7
s_lshl_b32 s90, s90, 17
s_lshl_b32 s91, s40, 15
s_sub_u32 s92, 1966080, s90
s_add_u32 s90, s90, s91
s_add_u32 s92, s92, s91
s_mov_b32 s93, 98304
s_cmp_eq_u32 s40, 1
s_cselect_b32 s93, 106496, s93
s_cmp_eq_u32 s40, 2
s_cselect_b32 s93, 32768, s93
s_cmp_eq_u32 s40, 3
s_cselect_b32 s93, 40960, s93
s_add_u32 m0, s93, 0
s_nop 0
buffer_load_dwordx4 v6, s[76:79], s90 offen offset:0 lds
buffer_load_dwordx4 v7, s[76:79], s90 offen offset:1024 lds
buffer_load_dwordx4 v8, s[76:79], s90 offen offset:2048 lds
buffer_load_dwordx4 v9, s[76:79], s90 offen offset:3072 lds
s_add_u32 m0, s93, 4096
s_nop 0
buffer_load_dwordx4 v6, s[76:79], s92 offen offset:0 lds
buffer_load_dwordx4 v7, s[76:79], s92 offen offset:1024 lds
buffer_load_dwordx4 v8, s[76:79], s92 offen offset:2048 lds
buffer_load_dwordx4 v9, s[76:79], s92 offen offset:3072 lds
s_and_b32 s90, s2, 31
s_lshl_b32 s90, s90, 8
s_lshl_b32 s91, s40, 17
s_add_u32 s90, s90, s91
s_lshl_b32 s91, s40, 12
s_add_u32 m0, s91, 131072
v_lshrrev_b32 v14, 4, v0
v_lshlrev_b32 v15, 13, v14
v_lshlrev_b32 v14, 1, v14
v_and_b32 v26, 15, v0
v_xor_b32 v26, v26, v14
v_xor_b32 v2, 0, v26
v_lshl_add_u32 v2, v2, 4, v15
v_add_u32 v2, 0, v2
buffer_load_dwordx4 v2, s[80:83], s90 offen offset:0 lds
v_xor_b32 v3, 0, v26
v_lshl_add_u32 v3, v3, 4, v15
v_add_u32 v3, 31744, v3
buffer_load_dwordx4 v3, s[80:83], s90 offen offset:1024 lds
v_xor_b32 v4, 8, v26
v_lshl_add_u32 v4, v4, 4, v15
v_add_u32 v4, 63488, v4
buffer_load_dwordx4 v4, s[80:83], s90 offen offset:2048 lds
v_xor_b32 v5, 8, v26
v_lshl_add_u32 v5, v5, 4, v15
v_add_u32 v5, 95232, v5
buffer_load_dwordx4 v5, s[80:83], s90 offen offset:3072 lds
s_setpc_b64 s[88:89]
K1_END:
s_endpgm
K1_END2:
s_waitcnt vmcnt(8) lgkmcnt(0)
s_mov_b32 s60, s14
s_mov_b32 s61, s15
s_mov_b32 s62, 0x400000
s_mov_b32 s63, 0x20000
s_mov_b32 s64, s20
s_mov_b32 s65, s21
s_mov_b32 s66, 0x80000
s_mov_b32 s67, 0x20000
s_mov_b32 s80, s24
s_mov_b32 s81, s25
s_mov_b32 s82, 0x100
s_mov_b32 s83, 0x20000
s_mov_b32 s16, s8
s_mov_b32 s17, s9
s_mov_b32 s18, 0x400000
s_mov_b32 s19, 0x20000
s_mov_b32 s12, s4
s_mov_b32 s13, s5
s_mov_b32 s14, 0x200000
s_mov_b32 s15, 0x20000
s_mov_b32 s8, s26
s_mov_b32 s9, s27
s_mov_b32 s10, 0x10000000
s_mov_b32 s11, 0x20000
s_mov_b64 s[96:97], s[22:23]
s_mov_b32 s20, s40
v_lshlrev_b32 v1, 4, v0
s_and_b32 s21, s2, 31
s_lshr_b32 s22, s2, 5
s_bfe_u32 s32, s2, 0x20001
s_mov_b32 s33, 0x06543217
s_cmp_eq_u32 s32, 1
s_cselect_b32 s33, 0x76043215, s33
s_cmp_eq_u32 s32, 3
s_cselect_b32 s33, 0x04567321, s33
s_lshl_b32 s22, s22, 2
s_lshr_b32 s22, s33, s22
s_and_b32 s22, s22, 7
s_lshl_b32 s48, s20, 11
s_lshl_b32 s49, s20, 12
s_add_u32 s58, s48, 16384
s_add_u32 s59, s49, 16384
v_mov_b32 v5, 0xf149f2ca
v_and_b32 v4, 15, v0
v_lshrrev_b32 v16, 4, v0
v_lshlrev_b32 v16, 2, v16
v_sub_u32 v4, v4, v16
s_waitcnt lgkmcnt(0)
s_lshl_b32 s50, s22, 17
s_lshl_b32 s32, s20, 15
s_sub_u32 s51, 1966080, s50
s_add_u32 s50, s50, s32
s_add_u32 s51, s51, s32
s_lshl_b32 s52, s21, 8
s_lshl_b32 s32, s20, 17
s_add_u32 s52, s52, s32
s_mov_b32 s56, 128
s_mov_b32 s53, 98304
s_cmp_eq_u32 s20, 1
s_cselect_b32 s53, 106496, s53
s_cmp_eq_u32 s20, 2
s_cselect_b32 s53, 32768, s53
s_cmp_eq_u32 s20, 3
s_cselect_b32 s53, 40960, s53
s_mov_b32 s54, 8192
s_cmp_eq_u32 s20, 1
s_cselect_b32 s54, 24576, s54
s_cmp_eq_u32 s20, 2
s_cselect_b32 s54, 90112, s54
s_cmp_eq_u32 s20, 3
s_cselect_b32 s54, 122880, s54
s_mov_b32 s55, 0
s_cmp_eq_u32 s20, 1
s_cselect_b32 s55, 16384, s55
s_cmp_eq_u32 s20, 2
s_cselect_b32 s55, 81920, s55
s_cmp_eq_u32 s20, 3
s_cselect_b32 s55, 114688, s55
v_lshrrev_b32 v240, 3, v0
v_lshlrev_b32 v241, 10, v240
v_lshrrev_b32 v242, 4, v0
v_and_b32 v243, 7, v0
v_xor_b32 v242, v242, v243
v_xor_b32 v244, 0, v242
v_lshl_add_u32 v244, v244, 4, v241
v_add_u32 v208, 0, v244
v_xor_b32 v244, 4, v242
v_lshl_add_u32 v244, v244, 4, v241
v_add_u32 v209, 7168, v244
v_xor_b32 v244, 0, v242
v_lshl_add_u32 v244, v244, 4, v241
v_add_u32 v210, 14336, v244
v_xor_b32 v244, 4, v242
v_lshl_add_u32 v244, v244, 4, v241
v_add_u32 v211, 21504, v244
v_lshrrev_b32 v240, 4, v0
v_lshlrev_b32 v241, 13, v240
v_lshlrev_b32 v240, 1, v240
v_and_b32 v242, 15, v0
v_xor_b32 v242, v242, v240
v_xor_b32 v244, 0, v242
v_lshl_add_u32 v244, v244, 4, v241
v_add_u32 v212, 0, v244
v_xor_b32 v244, 0, v242
v_lshl_add_u32 v244, v244, 4, v241
v_add_u32 v213, 31744, v244
v_xor_b32 v244, 8, v242
v_lshl_add_u32 v244, v244, 4, v241
v_add_u32 v214, 63488, v244
v_xor_b32 v244, 8, v242
v_lshl_add_u32 v244, v244, 4, v241
v_add_u32 v215, 95232, v244
v_and_b32 v240, 15, v0
v_lshrrev_b32 v241, 4, v0
v_bfe_u32 v242, v0, 1, 3
v_lshlrev_b32 v240, 7, v240
v_add_u32 v244, 0, v241
v_xor_b32 v244, v244, v242
v_lshl_add_u32 v244, v244, 4, v240
v_add_u32 v216, s53, v244
v_add_u32 v218, s54, v244
v_add_u32 v220, s55, v244
v_add_u32 v244, 4, v241
v_xor_b32 v244, v244, v242
v_lshl_add_u32 v244, v244, 4, v240
v_add_u32 v217, s53, v244
v_add_u32 v219, s54, v244
v_add_u32 v221, s55, v244
v_bfe_u32 v240, v0, 2, 2
v_lshl_add_u32 v241, v241, 3, v240
v_lshlrev_b32 v241, 8, v241
v_and_b32 v242, 3, v0
v_lshl_add_u32 v241, v242, 3, v241
v_bfe_u32 v242, v0, 2, 3
v_xor_b32 v243, 0, v242
v_lshl_add_u32 v243, v243, 5, v241
v_add_u32 v222, 49152, v243
v_add_u32 v230, 131072, v243
v_xor_b32 v243, 1, v242
v_lshl_add_u32 v243, v243, 5, v241
v_add_u32 v223, 49152, v243
v_add_u32 v231, 131072, v243
v_xor_b32 v243, 2, v242
v_lshl_add_u32 v243, v243, 5, v241
v_add_u32 v224, 49152, v243
v_add_u32 v232, 131072, v243
v_xor_b32 v243, 3, v242
v_lshl_add_u32 v243, v243, 5, v241
v_add_u32 v225, 49152, v243
v_add_u32 v233, 131072, v243
v_xor_b32 v243, 4, v242
v_lshl_add_u32 v243, v243, 5, v241
v_add_u32 v226, 49152, v243
v_add_u32 v234, 131072, v243
v_xor_b32 v243, 5, v242
v_lshl_add_u32 v243, v243, 5, v241
v_add_u32 v227, 49152, v243
v_add_u32 v235, 131072, v243
v_xor_b32 v243, 6, v242
v_lshl_add_u32 v243, v243, 5, v241
v_add_u32 v228, 49152, v243
v_add_u32 v236, 131072, v243
v_xor_b32 v243, 7, v242
v_lshl_add_u32 v243, v243, 5, v241
v_add_u32 v229, 49152, v243
v_add_u32 v237, 131072, v243
s_barrier
ds_read_b64_tr_b16 a[64:65], v230 offset:0
ds_read_b64_tr_b16 a[66:67], v230 offset:1024
ds_read_b64_tr_b16 a[96:97], v230 offset:8192
ds_read_b64_tr_b16 a[98:99], v230 offset:9216
ds_read_b128 a[0:3], v216 offset:0
ds_read_b128 a[16:19], v217 offset:0
ds_read_b128 a[4:7], v216 offset:2048
ds_read_b128 a[20:23], v217 offset:2048
ds_read_b128 a[8:11], v216 offset:4096
ds_read_b128 a[24:27], v217 offset:4096
ds_read_b128 a[12:15], v216 offset:6144
ds_read_b128 a[28:31], v217 offset:6144
ds_read_b64_tr_b16 a[68:69], v231 offset:0
ds_read_b64_tr_b16 a[70:71], v231 offset:1024
ds_read_b64_tr_b16 a[100:101], v231 offset:8192
ds_read_b64_tr_b16 a[102:103], v231 offset:9216
ds_read_b64_tr_b16 a[72:73], v232 offset:0
ds_read_b64_tr_b16 a[74:75], v232 offset:1024
ds_read_b64_tr_b16 a[104:105], v232 offset:8192
ds_read_b64_tr_b16 a[106:107], v232 offset:9216
ds_read_b64_tr_b16 a[76:77], v233 offset:0
ds_read_b64_tr_b16 a[78:79], v233 offset:1024
ds_read_b64_tr_b16 a[108:109], v233 offset:8192
ds_read_b64_tr_b16 a[110:111], v233 offset:9216
ds_read_b64_tr_b16 a[80:81], v234 offset:0
ds_read_b64_tr_b16 a[82:83], v234 offset:1024
ds_read_b64_tr_b16 a[112:113], v234 offset:8192
ds_read_b64_tr_b16 a[114:115], v234 offset:9216
ds_read_b64_tr_b16 a[84:85], v235 offset:0
ds_read_b64_tr_b16 a[86:87], v235 offset:1024
ds_read_b64_tr_b16 a[116:117], v235 offset:8192
ds_read_b64_tr_b16 a[118:119], v235 offset:9216
ds_read_b64_tr_b16 a[88:89], v236 offset:0
ds_read_b64_tr_b16 a[90:91], v236 offset:1024
ds_read_b64_tr_b16 a[120:121], v236 offset:8192
ds_read_b64_tr_b16 a[122:123], v236 offset:9216
ds_read_b64_tr_b16 a[92:93], v237 offset:0
ds_read_b64_tr_b16 a[94:95], v237 offset:1024
ds_read_b64_tr_b16 a[124:125], v237 offset:8192
ds_read_b64_tr_b16 a[126:127], v237 offset:9216
s_add_u32 m0, s54, 0
s_add_u32 s32, s50, s56
buffer_load_dwordx4 v208, s[12:15], s32 offen offset:0 lds
buffer_load_dwordx4 v209, s[12:15], s32 offen offset:1024 lds
buffer_load_dwordx4 v210, s[12:15], s32 offen offset:2048 lds
buffer_load_dwordx4 v211, s[12:15], s32 offen offset:3072 lds
s_add_u32 m0, s54, 4096
s_add_u32 s32, s51, s56
buffer_load_dwordx4 v208, s[12:15], s32 offen offset:0 lds
buffer_load_dwordx4 v209, s[12:15], s32 offen offset:1024 lds
buffer_load_dwordx4 v210, s[12:15], s32 offen offset:2048 lds
buffer_load_dwordx4 v211, s[12:15], s32 offen offset:3072 lds
s_lshl_b32 s32, s56, 12
s_add_u32 m0, s49, 65536
s_add_u32 s32, s32, s52
buffer_load_dwordx4 v212, s[16:19], s32 offen offset:0 lds
buffer_load_dwordx4 v213, s[16:19], s32 offen offset:1024 lds
buffer_load_dwordx4 v214, s[16:19], s32 offen offset:2048 lds
buffer_load_dwordx4 v215, s[16:19], s32 offen offset:3072 lds
s_add_u32 s56, s56, 128
s_and_b32 s56, s56, 1023
s_lshl_b32 s36, s21, 19
s_add_u32 s23, s36, 0
s_add_u32 s24, s36, 16777216
s_mov_b32 s28, s23
s_add_u32 s23, s23, s48
s_add_u32 s24, s24, s48
s_add_u32 s84, s8, s23
s_addc_u32 s85, s9, 0
s_add_u32 s86, s8, s24
s_addc_u32 s87, s9, 0
s_waitcnt lgkmcnt(15)
v_mfma_f32_16x16x32_bf16 v[48:51], a[64:67], a[0:3], 0
s_add_u32 m0, s55, 0
s_add_u32 s32, s50, s56
v_mfma_f32_16x16x32_bf16 v[48:51], a[96:99], a[16:19], v[48:51]
buffer_load_dwordx4 v208, s[12:15], s32 offen offset:0 lds
v_mfma_f32_16x16x32_bf16 v[52:55], a[64:67], a[4:7], 0
buffer_load_dwordx4 v209, s[12:15], s32 offen offset:1024 lds
v_mfma_f32_16x16x32_bf16 v[52:55], a[96:99], a[20:23], v[52:55]
buffer_load_dwordx4 v210, s[12:15], s32 offen offset:2048 lds
v_mfma_f32_16x16x32_bf16 v[56:59], a[64:67], a[8:11], 0
buffer_load_dwordx4 v211, s[12:15], s32 offen offset:3072 lds
v_mfma_f32_16x16x32_bf16 v[56:59], a[96:99], a[24:27], v[56:59]
s_add_u32 m0, s55, 4096
s_add_u32 s32, s51, s56
v_mfma_f32_16x16x32_bf16 v[60:63], a[64:67], a[12:15], 0
buffer_load_dwordx4 v208, s[12:15], s32 offen offset:0 lds
v_mfma_f32_16x16x32_bf16 v[60:63], a[96:99], a[28:31], v[60:63]
buffer_load_dwordx4 v209, s[12:15], s32 offen offset:1024 lds
v_mfma_f32_16x16x32_bf16 v[64:67], a[68:71], a[0:3], 0
buffer_load_dwordx4 v210, s[12:15], s32 offen offset:2048 lds
v_mfma_f32_16x16x32_bf16 v[64:67], a[100:103], a[16:19], v[64:67]
buffer_load_dwordx4 v211, s[12:15], s32 offen offset:3072 lds
v_mfma_f32_16x16x32_bf16 v[68:71], a[68:71], a[4:7], 0
s_lshl_b32 s32, s56, 12
s_add_u32 m0, s49, 49152
s_add_u32 s32, s32, s52
v_mfma_f32_16x16x32_bf16 v[68:71], a[100:103], a[20:23], v[68:71]
buffer_load_dwordx4 v212, s[16:19], s32 offen offset:0 lds
v_mfma_f32_16x16x32_bf16 v[72:75], a[68:71], a[8:11], 0
buffer_load_dwordx4 v213, s[16:19], s32 offen offset:1024 lds
v_mfma_f32_16x16x32_bf16 v[72:75], a[100:103], a[24:27], v[72:75]
buffer_load_dwordx4 v214, s[16:19], s32 offen offset:2048 lds
v_mfma_f32_16x16x32_bf16 v[76:79], a[68:71], a[12:15], 0
buffer_load_dwordx4 v215, s[16:19], s32 offen offset:3072 lds
s_add_u32 s56, s56, 128
s_and_b32 s56, s56, 1023
v_mfma_f32_16x16x32_bf16 v[76:79], a[100:103], a[28:31], v[76:79]
v_mfma_f32_16x16x32_bf16 v[80:83], a[72:75], a[0:3], 0
v_mfma_f32_16x16x32_bf16 v[80:83], a[104:107], a[16:19], v[80:83]
v_mfma_f32_16x16x32_bf16 v[84:87], a[72:75], a[4:7], 0
v_mfma_f32_16x16x32_bf16 v[84:87], a[104:107], a[20:23], v[84:87]
v_mfma_f32_16x16x32_bf16 v[88:91], a[72:75], a[8:11], 0
v_mfma_f32_16x16x32_bf16 v[88:91], a[104:107], a[24:27], v[88:91]
v_mfma_f32_16x16x32_bf16 v[92:95], a[72:75], a[12:15], 0
v_mfma_f32_16x16x32_bf16 v[92:95], a[104:107], a[28:31], v[92:95]
v_mfma_f32_16x16x32_bf16 v[96:99], a[76:79], a[0:3], 0
v_mfma_f32_16x16x32_bf16 v[96:99], a[108:111], a[16:19], v[96:99]
v_mfma_f32_16x16x32_bf16 v[100:103], a[76:79], a[4:7], 0
s_waitcnt vmcnt(12)
s_barrier
s_cmp_lg_u32 s20, 0
s_cbranch_scc1 K2_NOSIG
v_mov_b32 v245, 1
v_lshlrev_b32 v246, 7, v0
v_sub_u32 v246, s94, v246
s_mov_b64 exec, 1
buffer_atomic_add v245, v246, s[80:83], 0 offen sc1
s_mov_b64 exec, -1
K2_NOSIG:
s_lshl_b32 s36, s21, 1
v_and_b32 v246, 1, v0
v_add_u32 v246, s36, v246
v_mul_u32_u24 v246, 205, v246
v_lshrrev_b32 v246, 10, v246
v_bfe_u32 v245, v0, 1, 1
v_mul_u32_u24 v245, 13, v245
v_add_lshl_u32 v246, v246, v245, 2
v_add_u32 v246, 128, v246
v_mfma_f32_16x16x32_bf16 v[100:103], a[108:111], a[20:23], v[100:103]
ds_read_b64_tr_b16 a[128:129], v222 offset:16384
ds_read_b64_tr_b16 a[130:131], v222 offset:17408
v_mfma_f32_16x16x32_bf16 v[104:107], a[76:79], a[8:11], 0
ds_read_b64_tr_b16 a[160:161], v222 offset:24576
v_mfma_f32_16x16x32_bf16 v[104:107], a[108:111], a[24:27], v[104:107]
ds_read_b64_tr_b16 a[162:163], v222 offset:25600
v_mfma_f32_16x16x32_bf16 v[108:111], a[76:79], a[12:15], 0
ds_read_b128 a[32:35], v218 offset:0
v_mfma_f32_16x16x32_bf16 v[108:111], a[108:111], a[28:31], v[108:111]
s_waitcnt lgkmcnt(13)
ds_read_b128 a[48:51], v219 offset:0
v_mfma_f32_16x16x32_bf16 v[112:115], a[80:83], a[0:3], 0
ds_read_b128 a[36:39], v218 offset:2048
v_mfma_f32_16x16x32_bf16 v[112:115], a[112:115], a[16:19], v[112:115]
ds_read_b128 a[52:55], v219 offset:2048
v_mfma_f32_16x16x32_bf16 v[116:119], a[80:83], a[4:7], 0
ds_read_b128 a[40:43], v218 offset:4096
v_mfma_f32_16x16x32_bf16 v[116:119], a[112:115], a[20:23], v[116:119]
ds_read_b128 a[56:59], v219 offset:4096
v_mfma_f32_16x16x32_bf16 v[120:123], a[80:83], a[8:11], 0
ds_read_b128 a[44:47], v218 offset:6144
ds_read_b128 a[60:63], v219 offset:6144
v_mfma_f32_16x16x32_bf16 v[120:123], a[112:115], a[24:27], v[120:123]
ds_read_b64_tr_b16 a[132:133], v223 offset:16384
v_mfma_f32_16x16x32_bf16 v[124:127], a[80:83], a[12:15], 0
ds_read_b64_tr_b16 a[134:135], v223 offset:17408
v_mfma_f32_16x16x32_bf16 v[124:127], a[112:115], a[28:31], v[124:127]
ds_read_b64_tr_b16 a[164:165], v223 offset:24576
v_mfma_f32_16x16x32_bf16 v[128:131], a[84:87], a[0:3], 0
ds_read_b64_tr_b16 a[166:167], v223 offset:25600
v_mfma_f32_16x16x32_bf16 v[128:131], a[116:119], a[16:19], v[128:131]
ds_read_b64_tr_b16 a[136:137], v224 offset:16384
v_mfma_f32_16x16x32_bf16 v[132:135], a[84:87], a[4:7], 0
ds_read_b64_tr_b16 a[138:139], v224 offset:17408
v_mfma_f32_16x16x32_bf16 v[132:135], a[116:119], a[20:23], v[132:135]
ds_read_b64_tr_b16 a[168:169], v224 offset:24576
v_mfma_f32_16x16x32_bf16 v[136:139], a[84:87], a[8:11], 0
ds_read_b64_tr_b16 a[170:171], v224 offset:25600
v_mfma_f32_16x16x32_bf16 v[136:139], a[116:119], a[24:27], v[136:139]
ds_read_b64_tr_b16 a[140:141], v225 offset:16384
ds_read_b64_tr_b16 a[142:143], v225 offset:17408
v_mfma_f32_16x16x32_bf16 v[140:143], a[84:87], a[12:15], 0
ds_read_b64_tr_b16 a[172:173], v225 offset:24576
v_mfma_f32_16x16x32_bf16 v[140:143], a[116:119], a[28:31], v[140:143]
s_waitcnt lgkmcnt(15)
ds_read_b64_tr_b16 a[174:175], v225 offset:25600
v_mfma_f32_16x16x32_bf16 v[144:147], a[88:91], a[0:3], 0
ds_read_b64_tr_b16 a[144:145], v226 offset:16384
v_mfma_f32_16x16x32_bf16 v[144:147], a[120:123], a[16:19], v[144:147]
ds_read_b64_tr_b16 a[146:147], v226 offset:17408
v_mfma_f32_16x16x32_bf16 v[148:151], a[88:91], a[4:7], 0
ds_read_b64_tr_b16 a[176:177], v226 offset:24576
v_mfma_f32_16x16x32_bf16 v[148:151], a[120:123], a[20:23], v[148:151]
ds_read_b64_tr_b16 a[178:179], v226 offset:25600
v_mfma_f32_16x16x32_bf16 v[152:155], a[88:91], a[8:11], 0
ds_read_b64_tr_b16 a[148:149], v227 offset:16384
v_mfma_f32_16x16x32_bf16 v[152:155], a[120:123], a[24:27], v[152:155]
ds_read_b64_tr_b16 a[150:151], v227 offset:17408
v_mfma_f32_16x16x32_bf16 v[156:159], a[88:91], a[12:15], 0
ds_read_b64_tr_b16 a[180:181], v227 offset:24576
ds_read_b64_tr_b16 a[182:183], v227 offset:25600
v_mfma_f32_16x16x32_bf16 v[156:159], a[120:123], a[28:31], v[156:159]
ds_read_b64_tr_b16 a[152:153], v228 offset:16384
v_mfma_f32_16x16x32_bf16 v[160:163], a[92:95], a[0:3], 0
ds_read_b64_tr_b16 a[154:155], v228 offset:17408
v_mfma_f32_16x16x32_bf16 v[160:163], a[124:127], a[16:19], v[160:163]
ds_read_b64_tr_b16 a[184:185], v228 offset:24576
v_mfma_f32_16x16x32_bf16 v[164:167], a[92:95], a[4:7], 0
ds_read_b64_tr_b16 a[186:187], v228 offset:25600
v_mfma_f32_16x16x32_bf16 v[164:167], a[124:127], a[20:23], v[164:167]
ds_read_b64_tr_b16 a[156:157], v229 offset:16384
v_mfma_f32_16x16x32_bf16 v[168:171], a[92:95], a[8:11], 0
ds_read_b64_tr_b16 a[158:159], v229 offset:17408
v_mfma_f32_16x16x32_bf16 v[168:171], a[124:127], a[24:27], v[168:171]
ds_read_b64_tr_b16 a[188:189], v229 offset:24576
v_mfma_f32_16x16x32_bf16 v[172:175], a[92:95], a[12:15], 0
ds_read_b64_tr_b16 a[190:191], v229 offset:25600
v_mfma_f32_16x16x32_bf16 v[172:175], a[124:127], a[28:31], v[172:175]
s_waitcnt lgkmcnt(15)
v_mfma_f32_16x16x32_bf16 v[48:51], a[128:131], a[32:35], v[48:51]
s_waitcnt vmcnt(0)
s_barrier
v_mfma_f32_16x16x32_bf16 v[48:51], a[160:163], a[48:51], v[48:51]
s_add_u32 m0, s53, 0
s_add_u32 s32, s50, s56
v_mfma_f32_16x16x32_bf16 v[52:55], a[128:131], a[36:39], v[52:55]
buffer_load_dwordx4 v208, s[12:15], s32 offen offset:0 lds
v_mfma_f32_16x16x32_bf16 v[52:55], a[160:163], a[52:55], v[52:55]
buffer_load_dwordx4 v209, s[12:15], s32 offen offset:1024 lds
v_mfma_f32_16x16x32_bf16 v[56:59], a[128:131], a[40:43], v[56:59]
buffer_load_dwordx4 v210, s[12:15], s32 offen offset:2048 lds
v_mfma_f32_16x16x32_bf16 v[56:59], a[160:163], a[56:59], v[56:59]
buffer_load_dwordx4 v211, s[12:15], s32 offen offset:3072 lds
v_mfma_f32_16x16x32_bf16 v[60:63], a[128:131], a[44:47], v[60:63]
s_add_u32 m0, s53, 4096
s_add_u32 s32, s51, s56
v_mfma_f32_16x16x32_bf16 v[60:63], a[160:163], a[60:63], v[60:63]
buffer_load_dwordx4 v208, s[12:15], s32 offen offset:0 lds
v_mfma_f32_16x16x32_bf16 v[64:67], a[132:135], a[32:35], v[64:67]
buffer_load_dwordx4 v209, s[12:15], s32 offen offset:1024 lds
v_mfma_f32_16x16x32_bf16 v[64:67], a[164:167], a[48:51], v[64:67]
v_mfma_f32_16x16x32_bf16 v[68:71], a[132:135], a[36:39], v[68:71]
buffer_load_dwordx4 v210, s[12:15], s32 offen offset:2048 lds
v_mfma_f32_16x16x32_bf16 v[68:71], a[164:167], a[52:55], v[68:71]
buffer_load_dwordx4 v211, s[12:15], s32 offen offset:3072 lds
v_mfma_f32_16x16x32_bf16 v[72:75], a[132:135], a[40:43], v[72:75]
s_lshl_b32 s32, s56, 12
s_add_u32 m0, s49, 131072
s_add_u32 s32, s32, s52
v_mfma_f32_16x16x32_bf16 v[72:75], a[164:167], a[56:59], v[72:75]
buffer_load_dwordx4 v212, s[16:19], s32 offen offset:0 lds
v_mfma_f32_16x16x32_bf16 v[76:79], a[132:135], a[44:47], v[76:79]
buffer_load_dwordx4 v213, s[16:19], s32 offen offset:1024 lds
v_mfma_f32_16x16x32_bf16 v[76:79], a[164:167], a[60:63], v[76:79]
buffer_load_dwordx4 v214, s[16:19], s32 offen offset:2048 lds
v_mfma_f32_16x16x32_bf16 v[80:83], a[136:139], a[32:35], v[80:83]
buffer_load_dwordx4 v215, s[16:19], s32 offen offset:3072 lds
s_add_u32 s56, s56, 128
s_and_b32 s56, s56, 1023
v_mfma_f32_16x16x32_bf16 v[80:83], a[168:171], a[48:51], v[80:83]
ds_read_b64_tr_b16 a[64:65], v222 offset:0
v_mfma_f32_16x16x32_bf16 v[84:87], a[136:139], a[36:39], v[84:87]
v_mfma_f32_16x16x32_bf16 v[84:87], a[168:171], a[52:55], v[84:87]
ds_read_b64_tr_b16 a[66:67], v222 offset:1024
v_mfma_f32_16x16x32_bf16 v[88:91], a[136:139], a[40:43], v[88:91]
ds_read_b64_tr_b16 a[96:97], v222 offset:8192
v_mfma_f32_16x16x32_bf16 v[88:91], a[168:171], a[56:59], v[88:91]
ds_read_b64_tr_b16 a[98:99], v222 offset:9216
v_mfma_f32_16x16x32_bf16 v[92:95], a[136:139], a[44:47], v[92:95]
ds_read_b128 a[0:3], v220 offset:0
v_mfma_f32_16x16x32_bf16 v[92:95], a[168:171], a[60:63], v[92:95]
ds_read_b128 a[16:19], v221 offset:0
v_mfma_f32_16x16x32_bf16 v[96:99], a[140:143], a[32:35], v[96:99]
ds_read_b128 a[4:7], v220 offset:2048
v_mfma_f32_16x16x32_bf16 v[96:99], a[172:175], a[48:51], v[96:99]
ds_read_b128 a[20:23], v221 offset:2048
v_mfma_f32_16x16x32_bf16 v[100:103], a[140:143], a[36:39], v[100:103]
ds_read_b128 a[8:11], v220 offset:4096
v_mfma_f32_16x16x32_bf16 v[100:103], a[172:175], a[52:55], v[100:103]
v_mfma_f32_16x16x32_bf16 v[104:107], a[140:143], a[40:43], v[104:107]
ds_read_b128 a[24:27], v221 offset:4096
v_mfma_f32_16x16x32_bf16 v[104:107], a[172:175], a[56:59], v[104:107]
ds_read_b128 a[12:15], v220 offset:6144
v_mfma_f32_16x16x32_bf16 v[108:111], a[140:143], a[44:47], v[108:111]
ds_read_b128 a[28:31], v221 offset:6144
v_mfma_f32_16x16x32_bf16 v[108:111], a[172:175], a[60:63], v[108:111]
s_waitcnt lgkmcnt(15)
ds_read_b64_tr_b16 a[68:69], v223 offset:0
v_mfma_f32_16x16x32_bf16 v[112:115], a[144:147], a[32:35], v[112:115]
ds_read_b64_tr_b16 a[70:71], v223 offset:1024
v_mfma_f32_16x16x32_bf16 v[112:115], a[176:179], a[48:51], v[112:115]
ds_read_b64_tr_b16 a[100:101], v223 offset:8192
v_mfma_f32_16x16x32_bf16 v[116:119], a[144:147], a[36:39], v[116:119]
ds_read_b64_tr_b16 a[102:103], v223 offset:9216
v_mfma_f32_16x16x32_bf16 v[116:119], a[176:179], a[52:55], v[116:119]
ds_read_b64_tr_b16 a[72:73], v224 offset:0
v_mfma_f32_16x16x32_bf16 v[120:123], a[144:147], a[40:43], v[120:123]
v_mfma_f32_16x16x32_bf16 v[120:123], a[176:179], a[56:59], v[120:123]
ds_read_b64_tr_b16 a[74:75], v224 offset:1024
v_mfma_f32_16x16x32_bf16 v[124:127], a[144:147], a[44:47], v[124:127]
ds_read_b64_tr_b16 a[104:105], v224 offset:8192
v_mfma_f32_16x16x32_bf16 v[124:127], a[176:179], a[60:63], v[124:127]
ds_read_b64_tr_b16 a[106:107], v224 offset:9216
v_mfma_f32_16x16x32_bf16 v[128:131], a[148:151], a[32:35], v[128:131]
ds_read_b64_tr_b16 a[76:77], v225 offset:0
v_mfma_f32_16x16x32_bf16 v[128:131], a[180:183], a[48:51], v[128:131]
ds_read_b64_tr_b16 a[78:79], v225 offset:1024
v_mfma_f32_16x16x32_bf16 v[132:135], a[148:151], a[36:39], v[132:135]
ds_read_b64_tr_b16 a[108:109], v225 offset:8192
v_mfma_f32_16x16x32_bf16 v[132:135], a[180:183], a[52:55], v[132:135]
ds_read_b64_tr_b16 a[110:111], v225 offset:9216
v_mfma_f32_16x16x32_bf16 v[136:139], a[148:151], a[40:43], v[136:139]
ds_read_b64_tr_b16 a[80:81], v226 offset:0
v_mfma_f32_16x16x32_bf16 v[136:139], a[180:183], a[56:59], v[136:139]
v_mfma_f32_16x16x32_bf16 v[140:143], a[148:151], a[44:47], v[140:143]
ds_read_b64_tr_b16 a[82:83], v226 offset:1024
v_mfma_f32_16x16x32_bf16 v[140:143], a[180:183], a[60:63], v[140:143]
s_waitcnt lgkmcnt(15)
ds_read_b64_tr_b16 a[112:113], v226 offset:8192
v_mfma_f32_16x16x32_bf16 v[144:147], a[152:155], a[32:35], v[144:147]
ds_read_b64_tr_b16 a[114:115], v226 offset:9216
v_mfma_f32_16x16x32_bf16 v[144:147], a[184:187], a[48:51], v[144:147]
ds_read_b64_tr_b16 a[84:85], v227 offset:0
v_mfma_f32_16x16x32_bf16 v[148:151], a[152:155], a[36:39], v[148:151]
ds_read_b64_tr_b16 a[86:87], v227 offset:1024
v_mfma_f32_16x16x32_bf16 v[148:151], a[184:187], a[52:55], v[148:151]
ds_read_b64_tr_b16 a[116:117], v227 offset:8192
v_mfma_f32_16x16x32_bf16 v[152:155], a[152:155], a[40:43], v[152:155]
ds_read_b64_tr_b16 a[118:119], v227 offset:9216
v_mfma_f32_16x16x32_bf16 v[152:155], a[184:187], a[56:59], v[152:155]
ds_read_b64_tr_b16 a[88:89], v228 offset:0
v_mfma_f32_16x16x32_bf16 v[156:159], a[152:155], a[44:47], v[156:159]
v_mfma_f32_16x16x32_bf16 v[156:159], a[184:187], a[60:63], v[156:159]
ds_read_b64_tr_b16 a[90:91], v228 offset:1024
v_mfma_f32_16x16x32_bf16 v[160:163], a[156:159], a[32:35], v[160:163]
ds_read_b64_tr_b16 a[120:121], v228 offset:8192
v_mfma_f32_16x16x32_bf16 v[160:163], a[188:191], a[48:51], v[160:163]
ds_read_b64_tr_b16 a[122:123], v228 offset:9216
v_mfma_f32_16x16x32_bf16 v[164:167], a[156:159], a[36:39], v[164:167]
ds_read_b64_tr_b16 a[92:93], v229 offset:0
v_mfma_f32_16x16x32_bf16 v[164:167], a[188:191], a[52:55], v[164:167]
ds_read_b64_tr_b16 a[94:95], v229 offset:1024
v_mfma_f32_16x16x32_bf16 v[168:171], a[156:159], a[40:43], v[168:171]
ds_read_b64_tr_b16 a[124:125], v229 offset:8192
v_mfma_f32_16x16x32_bf16 v[168:171], a[188:191], a[56:59], v[168:171]
ds_read_b64_tr_b16 a[126:127], v229 offset:9216
v_mfma_f32_16x16x32_bf16 v[172:175], a[156:159], a[44:47], v[172:175]
v_mfma_f32_16x16x32_bf16 v[172:175], a[188:191], a[60:63], v[172:175]
s_waitcnt lgkmcnt(15)
v_mfma_f32_16x16x32_bf16 v[48:51], a[64:67], a[0:3], v[48:51]
s_waitcnt vmcnt(0)
s_barrier
v_mfma_f32_16x16x32_bf16 v[48:51], a[96:99], a[16:19], v[48:51]
s_add_u32 m0, s54, 0
s_add_u32 s32, s50, s56
v_mfma_f32_16x16x32_bf16 v[52:55], a[64:67], a[4:7], v[52:55]
buffer_load_dwordx4 v208, s[12:15], s32 offen offset:0 lds
v_mfma_f32_16x16x32_bf16 v[52:55], a[96:99], a[20:23], v[52:55]
buffer_load_dwordx4 v209, s[12:15], s32 offen offset:1024 lds
v_mfma_f32_16x16x32_bf16 v[56:59], a[64:67], a[8:11], v[56:59]
buffer_load_dwordx4 v210, s[12:15], s32 offen offset:2048 lds
v_mfma_f32_16x16x32_bf16 v[56:59], a[96:99], a[24:27], v[56:59]
buffer_load_dwordx4 v211, s[12:15], s32 offen offset:3072 lds
v_mfma_f32_16x16x32_bf16 v[60:63], a[64:67], a[12:15], v[60:63]
s_add_u32 m0, s54, 4096
s_add_u32 s32, s51, s56
v_mfma_f32_16x16x32_bf16 v[60:63], a[96:99], a[28:31], v[60:63]
buffer_load_dwordx4 v208, s[12:15], s32 offen offset:0 lds
v_mfma_f32_16x16x32_bf16 v[64:67], a[68:71], a[0:3], v[64:67]
buffer_load_dwordx4 v209, s[12:15], s32 offen offset:1024 lds
v_mfma_f32_16x16x32_bf16 v[64:67], a[100:103], a[16:19], v[64:67]
v_mfma_f32_16x16x32_bf16 v[68:71], a[68:71], a[4:7], v[68:71]
buffer_load_dwordx4 v210, s[12:15], s32 offen offset:2048 lds
v_mfma_f32_16x16x32_bf16 v[68:71], a[100:103], a[20:23], v[68:71]
buffer_load_dwordx4 v211, s[12:15], s32 offen offset:3072 lds
v_mfma_f32_16x16x32_bf16 v[72:75], a[68:71], a[8:11], v[72:75]
s_lshl_b32 s32, s56, 12
s_add_u32 m0, s49, 65536
s_add_u32 s32, s32, s52
v_mfma_f32_16x16x32_bf16 v[72:75], a[100:103], a[24:27], v[72:75]
buffer_load_dwordx4 v212, s[16:19], s32 offen offset:0 lds
v_mfma_f32_16x16x32_bf16 v[76:79], a[68:71], a[12:15], v[76:79]
buffer_load_dwordx4 v213, s[16:19], s32 offen offset:1024 lds
v_mfma_f32_16x16x32_bf16 v[76:79], a[100:103], a[28:31], v[76:79]
buffer_load_dwordx4 v214, s[16:19], s32 offen offset:2048 lds
v_mfma_f32_16x16x32_bf16 v[80:83], a[72:75], a[0:3], v[80:83]
buffer_load_dwordx4 v215, s[16:19], s32 offen offset:3072 lds
s_add_u32 s56, s56, 128
s_and_b32 s56, s56, 1023
v_mfma_f32_16x16x32_bf16 v[80:83], a[104:107], a[16:19], v[80:83]
ds_read_b64_tr_b16 a[128:129], v230 offset:0
v_mfma_f32_16x16x32_bf16 v[84:87], a[72:75], a[4:7], v[84:87]
v_mfma_f32_16x16x32_bf16 v[84:87], a[104:107], a[20:23], v[84:87]
ds_read_b64_tr_b16 a[130:131], v230 offset:1024
v_mfma_f32_16x16x32_bf16 v[88:91], a[72:75], a[8:11], v[88:91]
ds_read_b64_tr_b16 a[160:161], v230 offset:8192
v_mfma_f32_16x16x32_bf16 v[88:91], a[104:107], a[24:27], v[88:91]
ds_read_b64_tr_b16 a[162:163], v230 offset:9216
v_mfma_f32_16x16x32_bf16 v[92:95], a[72:75], a[12:15], v[92:95]
ds_read_b128 a[32:35], v216 offset:0
v_mfma_f32_16x16x32_bf16 v[92:95], a[104:107], a[28:31], v[92:95]
ds_read_b128 a[48:51], v217 offset:0
v_mfma_f32_16x16x32_bf16 v[96:99], a[76:79], a[0:3], v[96:99]
ds_read_b128 a[36:39], v216 offset:2048
v_mfma_f32_16x16x32_bf16 v[96:99], a[108:111], a[16:19], v[96:99]
ds_read_b128 a[52:55], v217 offset:2048
v_mfma_f32_16x16x32_bf16 v[100:103], a[76:79], a[4:7], v[100:103]
ds_read_b128 a[40:43], v216 offset:4096
v_mfma_f32_16x16x32_bf16 v[100:103], a[108:111], a[20:23], v[100:103]
v_mfma_f32_16x16x32_bf16 v[104:107], a[76:79], a[8:11], v[104:107]
ds_read_b128 a[56:59], v217 offset:4096
v_mfma_f32_16x16x32_bf16 v[104:107], a[108:111], a[24:27], v[104:107]
ds_read_b128 a[44:47], v216 offset:6144
v_mfma_f32_16x16x32_bf16 v[108:111], a[76:79], a[12:15], v[108:111]
ds_read_b128 a[60:63], v217 offset:6144
v_mfma_f32_16x16x32_bf16 v[108:111], a[108:111], a[28:31], v[108:111]
s_waitcnt lgkmcnt(15)
ds_read_b64_tr_b16 a[132:133], v231 offset:0
v_mfma_f32_16x16x32_bf16 v[112:115], a[80:83], a[0:3], v[112:115]
ds_read_b64_tr_b16 a[134:135], v231 offset:1024
v_mfma_f32_16x16x32_bf16 v[112:115], a[112:115], a[16:19], v[112:115]
ds_read_b64_tr_b16 a[164:165], v231 offset:8192
v_mfma_f32_16x16x32_bf16 v[116:119], a[80:83], a[4:7], v[116:119]
ds_read_b64_tr_b16 a[166:167], v231 offset:9216
v_mfma_f32_16x16x32_bf16 v[116:119], a[112:115], a[20:23], v[116:119]
ds_read_b64_tr_b16 a[136:137], v232 offset:0
v_mfma_f32_16x16x32_bf16 v[120:123], a[80:83], a[8:11], v[120:123]
v_mfma_f32_16x16x32_bf16 v[120:123], a[112:115], a[24:27], v[120:123]
ds_read_b64_tr_b16 a[138:139], v232 offset:1024
v_mfma_f32_16x16x32_bf16 v[124:127], a[80:83], a[12:15], v[124:127]
ds_read_b64_tr_b16 a[168:169], v232 offset:8192
v_mfma_f32_16x16x32_bf16 v[124:127], a[112:115], a[28:31], v[124:127]
ds_read_b64_tr_b16 a[170:171], v232 offset:9216
v_mfma_f32_16x16x32_bf16 v[128:131], a[84:87], a[0:3], v[128:131]
ds_read_b64_tr_b16 a[140:141], v233 offset:0
v_mfma_f32_16x16x32_bf16 v[128:131], a[116:119], a[16:19], v[128:131]
ds_read_b64_tr_b16 a[142:143], v233 offset:1024
v_mfma_f32_16x16x32_bf16 v[132:135], a[84:87], a[4:7], v[132:135]
ds_read_b64_tr_b16 a[172:173], v233 offset:8192
v_mfma_f32_16x16x32_bf16 v[132:135], a[116:119], a[20:23], v[132:135]
ds_read_b64_tr_b16 a[174:175], v233 offset:9216
v_mfma_f32_16x16x32_bf16 v[136:139], a[84:87], a[8:11], v[136:139]
ds_read_b64_tr_b16 a[144:145], v234 offset:0
v_mfma_f32_16x16x32_bf16 v[136:139], a[116:119], a[24:27], v[136:139]
v_mfma_f32_16x16x32_bf16 v[140:143], a[84:87], a[12:15], v[140:143]
ds_read_b64_tr_b16 a[146:147], v234 offset:1024
v_mfma_f32_16x16x32_bf16 v[140:143], a[116:119], a[28:31], v[140:143]
s_waitcnt lgkmcnt(15)
ds_read_b64_tr_b16 a[176:177], v234 offset:8192
v_mfma_f32_16x16x32_bf16 v[144:147], a[88:91], a[0:3], v[144:147]
ds_read_b64_tr_b16 a[178:179], v234 offset:9216
v_mfma_f32_16x16x32_bf16 v[144:147], a[120:123], a[16:19], v[144:147]
ds_read_b64_tr_b16 a[148:149], v235 offset:0
v_mfma_f32_16x16x32_bf16 v[148:151], a[88:91], a[4:7], v[148:151]
ds_read_b64_tr_b16 a[150:151], v235 offset:1024
v_mfma_f32_16x16x32_bf16 v[148:151], a[120:123], a[20:23], v[148:151]
ds_read_b64_tr_b16 a[180:181], v235 offset:8192
v_mfma_f32_16x16x32_bf16 v[152:155], a[88:91], a[8:11], v[152:155]
ds_read_b64_tr_b16 a[182:183], v235 offset:9216
v_mfma_f32_16x16x32_bf16 v[152:155], a[120:123], a[24:27], v[152:155]
ds_read_b64_tr_b16 a[152:153], v236 offset:0
v_mfma_f32_16x16x32_bf16 v[156:159], a[88:91], a[12:15], v[156:159]
v_mfma_f32_16x16x32_bf16 v[156:159], a[120:123], a[28:31], v[156:159]
ds_read_b64_tr_b16 a[154:155], v236 offset:1024
v_mfma_f32_16x16x32_bf16 v[160:163], a[92:95], a[0:3], v[160:163]
ds_read_b64_tr_b16 a[184:185], v236 offset:8192
v_mfma_f32_16x16x32_bf16 v[160:163], a[124:127], a[16:19], v[160:163]
ds_read_b64_tr_b16 a[186:187], v236 offset:9216
v_mfma_f32_16x16x32_bf16 v[164:167], a[92:95], a[4:7], v[164:167]
ds_read_b64_tr_b16 a[156:157], v237 offset:0
v_mfma_f32_16x16x32_bf16 v[164:167], a[124:127], a[20:23], v[164:167]
ds_read_b64_tr_b16 a[158:159], v237 offset:1024
v_mfma_f32_16x16x32_bf16 v[168:171], a[92:95], a[8:11], v[168:171]
ds_read_b64_tr_b16 a[188:189], v237 offset:8192
v_mfma_f32_16x16x32_bf16 v[168:171], a[124:127], a[24:27], v[168:171]
ds_read_b64_tr_b16 a[190:191], v237 offset:9216
v_mfma_f32_16x16x32_bf16 v[172:175], a[92:95], a[12:15], v[172:175]
v_mfma_f32_16x16x32_bf16 v[172:175], a[124:127], a[28:31], v[172:175]
s_waitcnt lgkmcnt(15)
v_mfma_f32_16x16x32_bf16 v[48:51], a[128:131], a[32:35], v[48:51]
s_waitcnt vmcnt(0)
s_barrier
v_mfma_f32_16x16x32_bf16 v[48:51], a[160:163], a[48:51], v[48:51]
s_add_u32 m0, s55, 0
s_add_u32 s32, s50, s56
v_mfma_f32_16x16x32_bf16 v[52:55], a[128:131], a[36:39], v[52:55]
buffer_load_dwordx4 v208, s[12:15], s32 offen offset:0 lds
v_mfma_f32_16x16x32_bf16 v[52:55], a[160:163], a[52:55], v[52:55]
buffer_load_dwordx4 v209, s[12:15], s32 offen offset:1024 lds
v_mfma_f32_16x16x32_bf16 v[56:59], a[128:131], a[40:43], v[56:59]
buffer_load_dwordx4 v210, s[12:15], s32 offen offset:2048 lds
v_mfma_f32_16x16x32_bf16 v[56:59], a[160:163], a[56:59], v[56:59]
buffer_load_dwordx4 v211, s[12:15], s32 offen offset:3072 lds
v_mfma_f32_16x16x32_bf16 v[60:63], a[128:131], a[44:47], v[60:63]
s_add_u32 m0, s55, 4096
s_add_u32 s32, s51, s56
v_mfma_f32_16x16x32_bf16 v[60:63], a[160:163], a[60:63], v[60:63]
buffer_load_dwordx4 v208, s[12:15], s32 offen offset:0 lds
v_mfma_f32_16x16x32_bf16 v[64:67], a[132:135], a[32:35], v[64:67]
buffer_load_dwordx4 v209, s[12:15], s32 offen offset:1024 lds
v_mfma_f32_16x16x32_bf16 v[64:67], a[164:167], a[48:51], v[64:67]
v_mfma_f32_16x16x32_bf16 v[68:71], a[132:135], a[36:39], v[68:71]
buffer_load_dwordx4 v210, s[12:15], s32 offen offset:2048 lds
v_mfma_f32_16x16x32_bf16 v[68:71], a[164:167], a[52:55], v[68:71]
buffer_load_dwordx4 v211, s[12:15], s32 offen offset:3072 lds
v_mfma_f32_16x16x32_bf16 v[72:75], a[132:135], a[40:43], v[72:75]
s_lshl_b32 s32, s56, 12
s_add_u32 m0, s49, 49152
s_add_u32 s32, s32, s52
v_mfma_f32_16x16x32_bf16 v[72:75], a[164:167], a[56:59], v[72:75]
buffer_load_dwordx4 v212, s[16:19], s32 offen offset:0 lds
v_mfma_f32_16x16x32_bf16 v[76:79], a[132:135], a[44:47], v[76:79]
buffer_load_dwordx4 v213, s[16:19], s32 offen offset:1024 lds
v_mfma_f32_16x16x32_bf16 v[76:79], a[164:167], a[60:63], v[76:79]
buffer_load_dwordx4 v214, s[16:19], s32 offen offset:2048 lds
v_mfma_f32_16x16x32_bf16 v[80:83], a[136:139], a[32:35], v[80:83]
buffer_load_dwordx4 v215, s[16:19], s32 offen offset:3072 lds
s_add_u32 s56, s56, 128
s_and_b32 s56, s56, 1023
v_mfma_f32_16x16x32_bf16 v[80:83], a[168:171], a[48:51], v[80:83]
ds_read_b64_tr_b16 a[64:65], v222 offset:16384
v_mfma_f32_16x16x32_bf16 v[84:87], a[136:139], a[36:39], v[84:87]
v_mfma_f32_16x16x32_bf16 v[84:87], a[168:171], a[52:55], v[84:87]
ds_read_b64_tr_b16 a[66:67], v222 offset:17408
v_mfma_f32_16x16x32_bf16 v[88:91], a[136:139], a[40:43], v[88:91]
ds_read_b64_tr_b16 a[96:97], v222 offset:24576
v_mfma_f32_16x16x32_bf16 v[88:91], a[168:171], a[56:59], v[88:91]
ds_read_b64_tr_b16 a[98:99], v222 offset:25600
v_mfma_f32_16x16x32_bf16 v[92:95], a[136:139], a[44:47], v[92:95]
ds_read_b128 a[0:3], v218 offset:0
v_mfma_f32_16x16x32_bf16 v[92:95], a[168:171], a[60:63], v[92:95]
ds_read_b128 a[16:19], v219 offset:0
v_mfma_f32_16x16x32_bf16 v[96:99], a[140:143], a[32:35], v[96:99]
ds_read_b128 a[4:7], v218 offset:2048
v_mfma_f32_16x16x32_bf16 v[96:99], a[172:175], a[48:51], v[96:99]
ds_read_b128 a[20:23], v219 offset:2048
v_mfma_f32_16x16x32_bf16 v[100:103], a[140:143], a[36:39], v[100:103]
ds_read_b128 a[8:11], v218 offset:4096
v_mfma_f32_16x16x32_bf16 v[100:103], a[172:175], a[52:55], v[100:103]
v_mfma_f32_16x16x32_bf16 v[104:107], a[140:143], a[40:43], v[104:107]
ds_read_b128 a[24:27], v219 offset:4096
v_mfma_f32_16x16x32_bf16 v[104:107], a[172:175], a[56:59], v[104:107]
ds_read_b128 a[12:15], v218 offset:6144
v_mfma_f32_16x16x32_bf16 v[108:111], a[140:143], a[44:47], v[108:111]
ds_read_b128 a[28:31], v219 offset:6144
v_mfma_f32_16x16x32_bf16 v[108:111], a[172:175], a[60:63], v[108:111]
s_waitcnt lgkmcnt(15)
ds_read_b64_tr_b16 a[68:69], v223 offset:16384
v_mfma_f32_16x16x32_bf16 v[112:115], a[144:147], a[32:35], v[112:115]
ds_read_b64_tr_b16 a[70:71], v223 offset:17408
v_mfma_f32_16x16x32_bf16 v[112:115], a[176:179], a[48:51], v[112:115]
ds_read_b64_tr_b16 a[100:101], v223 offset:24576
v_mfma_f32_16x16x32_bf16 v[116:119], a[144:147], a[36:39], v[116:119]
ds_read_b64_tr_b16 a[102:103], v223 offset:25600
v_mfma_f32_16x16x32_bf16 v[116:119], a[176:179], a[52:55], v[116:119]
ds_read_b64_tr_b16 a[72:73], v224 offset:16384
v_mfma_f32_16x16x32_bf16 v[120:123], a[144:147], a[40:43], v[120:123]
v_mfma_f32_16x16x32_bf16 v[120:123], a[176:179], a[56:59], v[120:123]
ds_read_b64_tr_b16 a[74:75], v224 offset:17408
v_mfma_f32_16x16x32_bf16 v[124:127], a[144:147], a[44:47], v[124:127]
ds_read_b64_tr_b16 a[104:105], v224 offset:24576
v_mfma_f32_16x16x32_bf16 v[124:127], a[176:179], a[60:63], v[124:127]
ds_read_b64_tr_b16 a[106:107], v224 offset:25600
v_mfma_f32_16x16x32_bf16 v[128:131], a[148:151], a[32:35], v[128:131]
ds_read_b64_tr_b16 a[76:77], v225 offset:16384
v_mfma_f32_16x16x32_bf16 v[128:131], a[180:183], a[48:51], v[128:131]
ds_read_b64_tr_b16 a[78:79], v225 offset:17408
v_mfma_f32_16x16x32_bf16 v[132:135], a[148:151], a[36:39], v[132:135]
ds_read_b64_tr_b16 a[108:109], v225 offset:24576
v_mfma_f32_16x16x32_bf16 v[132:135], a[180:183], a[52:55], v[132:135]
ds_read_b64_tr_b16 a[110:111], v225 offset:25600
v_mfma_f32_16x16x32_bf16 v[136:139], a[148:151], a[40:43], v[136:139]
ds_read_b64_tr_b16 a[80:81], v226 offset:16384
v_mfma_f32_16x16x32_bf16 v[136:139], a[180:183], a[56:59], v[136:139]
v_mfma_f32_16x16x32_bf16 v[140:143], a[148:151], a[44:47], v[140:143]
ds_read_b64_tr_b16 a[82:83], v226 offset:17408
v_mfma_f32_16x16x32_bf16 v[140:143], a[180:183], a[60:63], v[140:143]
s_waitcnt lgkmcnt(15)
ds_read_b64_tr_b16 a[112:113], v226 offset:24576
v_mfma_f32_16x16x32_bf16 v[144:147], a[152:155], a[32:35], v[144:147]
ds_read_b64_tr_b16 a[114:115], v226 offset:25600
v_mfma_f32_16x16x32_bf16 v[144:147], a[184:187], a[48:51], v[144:147]
ds_read_b64_tr_b16 a[84:85], v227 offset:16384
v_mfma_f32_16x16x32_bf16 v[148:151], a[152:155], a[36:39], v[148:151]
ds_read_b64_tr_b16 a[86:87], v227 offset:17408
v_mfma_f32_16x16x32_bf16 v[148:151], a[184:187], a[52:55], v[148:151]
ds_read_b64_tr_b16 a[116:117], v227 offset:24576
v_mfma_f32_16x16x32_bf16 v[152:155], a[152:155], a[40:43], v[152:155]
ds_read_b64_tr_b16 a[118:119], v227 offset:25600
v_mfma_f32_16x16x32_bf16 v[152:155], a[184:187], a[56:59], v[152:155]
ds_read_b64_tr_b16 a[88:89], v228 offset:16384
v_mfma_f32_16x16x32_bf16 v[156:159], a[152:155], a[44:47], v[156:159]
v_mfma_f32_16x16x32_bf16 v[156:159], a[184:187], a[60:63], v[156:159]
ds_read_b64_tr_b16 a[90:91], v228 offset:17408
v_mfma_f32_16x16x32_bf16 v[160:163], a[156:159], a[32:35], v[160:163]
ds_read_b64_tr_b16 a[120:121], v228 offset:24576
v_mfma_f32_16x16x32_bf16 v[160:163], a[188:191], a[48:51], v[160:163]
ds_read_b64_tr_b16 a[122:123], v228 offset:25600
v_mfma_f32_16x16x32_bf16 v[164:167], a[156:159], a[36:39], v[164:167]
ds_read_b64_tr_b16 a[92:93], v229 offset:16384
v_mfma_f32_16x16x32_bf16 v[164:167], a[188:191], a[52:55], v[164:167]
ds_read_b64_tr_b16 a[94:95], v229 offset:17408
v_mfma_f32_16x16x32_bf16 v[168:171], a[156:159], a[40:43], v[168:171]
ds_read_b64_tr_b16 a[124:125], v229 offset:24576
v_mfma_f32_16x16x32_bf16 v[168:171], a[188:191], a[56:59], v[168:171]
ds_read_b64_tr_b16 a[126:127], v229 offset:25600
v_mfma_f32_16x16x32_bf16 v[172:175], a[156:159], a[44:47], v[172:175]
v_mfma_f32_16x16x32_bf16 v[172:175], a[188:191], a[60:63], v[172:175]
s_waitcnt lgkmcnt(15)
v_mfma_f32_16x16x32_bf16 v[48:51], a[64:67], a[0:3], v[48:51]
s_waitcnt vmcnt(0)
s_barrier
v_mfma_f32_16x16x32_bf16 v[48:51], a[96:99], a[16:19], v[48:51]
s_add_u32 m0, s53, 0
s_add_u32 s32, s50, s56
v_mfma_f32_16x16x32_bf16 v[52:55], a[64:67], a[4:7], v[52:55]
buffer_load_dwordx4 v208, s[12:15], s32 offen offset:0 lds
v_mfma_f32_16x16x32_bf16 v[52:55], a[96:99], a[20:23], v[52:55]
buffer_load_dwordx4 v209, s[12:15], s32 offen offset:1024 lds
v_mfma_f32_16x16x32_bf16 v[56:59], a[64:67], a[8:11], v[56:59]
buffer_load_dwordx4 v210, s[12:15], s32 offen offset:2048 lds
v_mfma_f32_16x16x32_bf16 v[56:59], a[96:99], a[24:27], v[56:59]
buffer_load_dwordx4 v211, s[12:15], s32 offen offset:3072 lds
v_mfma_f32_16x16x32_bf16 v[60:63], a[64:67], a[12:15], v[60:63]
s_add_u32 m0, s53, 4096
s_add_u32 s32, s51, s56
v_mfma_f32_16x16x32_bf16 v[60:63], a[96:99], a[28:31], v[60:63]
buffer_load_dwordx4 v208, s[12:15], s32 offen offset:0 lds
v_mfma_f32_16x16x32_bf16 v[64:67], a[68:71], a[0:3], v[64:67]
buffer_load_dwordx4 v209, s[12:15], s32 offen offset:1024 lds
v_mfma_f32_16x16x32_bf16 v[64:67], a[100:103], a[16:19], v[64:67]
v_mfma_f32_16x16x32_bf16 v[68:71], a[68:71], a[4:7], v[68:71]
buffer_load_dwordx4 v210, s[12:15], s32 offen offset:2048 lds
v_mfma_f32_16x16x32_bf16 v[68:71], a[100:103], a[20:23], v[68:71]
buffer_load_dwordx4 v211, s[12:15], s32 offen offset:3072 lds
v_mfma_f32_16x16x32_bf16 v[72:75], a[68:71], a[8:11], v[72:75]
s_lshl_b32 s32, s56, 12
s_add_u32 m0, s49, 131072
s_add_u32 s32, s32, s52
v_mfma_f32_16x16x32_bf16 v[72:75], a[100:103], a[24:27], v[72:75]
buffer_load_dwordx4 v212, s[16:19], s32 offen offset:0 lds
v_mfma_f32_16x16x32_bf16 v[76:79], a[68:71], a[12:15], v[76:79]
buffer_load_dwordx4 v213, s[16:19], s32 offen offset:1024 lds
v_mfma_f32_16x16x32_bf16 v[76:79], a[100:103], a[28:31], v[76:79]
buffer_load_dwordx4 v214, s[16:19], s32 offen offset:2048 lds
v_mfma_f32_16x16x32_bf16 v[80:83], a[72:75], a[0:3], v[80:83]
buffer_load_dwordx4 v215, s[16:19], s32 offen offset:3072 lds
s_add_u32 s56, s56, 128
s_and_b32 s56, s56, 1023
v_mfma_f32_16x16x32_bf16 v[80:83], a[104:107], a[16:19], v[80:83]
ds_read_b64_tr_b16 a[128:129], v222 offset:0
v_mfma_f32_16x16x32_bf16 v[84:87], a[72:75], a[4:7], v[84:87]
v_mfma_f32_16x16x32_bf16 v[84:87], a[104:107], a[20:23], v[84:87]
ds_read_b64_tr_b16 a[130:131], v222 offset:1024
v_mfma_f32_16x16x32_bf16 v[88:91], a[72:75], a[8:11], v[88:91]
ds_read_b64_tr_b16 a[160:161], v222 offset:8192
v_mfma_f32_16x16x32_bf16 v[88:91], a[104:107], a[24:27], v[88:91]
ds_read_b64_tr_b16 a[162:163], v222 offset:9216
v_mfma_f32_16x16x32_bf16 v[92:95], a[72:75], a[12:15], v[92:95]
ds_read_b128 a[32:35], v220 offset:0
v_mfma_f32_16x16x32_bf16 v[92:95], a[104:107], a[28:31], v[92:95]
ds_read_b128 a[48:51], v221 offset:0
v_mfma_f32_16x16x32_bf16 v[96:99], a[76:79], a[0:3], v[96:99]
ds_read_b128 a[36:39], v220 offset:2048
v_mfma_f32_16x16x32_bf16 v[96:99], a[108:111], a[16:19], v[96:99]
ds_read_b128 a[52:55], v221 offset:2048
v_mfma_f32_16x16x32_bf16 v[100:103], a[76:79], a[4:7], v[100:103]
ds_read_b128 a[40:43], v220 offset:4096
v_mfma_f32_16x16x32_bf16 v[100:103], a[108:111], a[20:23], v[100:103]
v_mfma_f32_16x16x32_bf16 v[104:107], a[76:79], a[8:11], v[104:107]
ds_read_b128 a[56:59], v221 offset:4096
v_mfma_f32_16x16x32_bf16 v[104:107], a[108:111], a[24:27], v[104:107]
ds_read_b128 a[44:47], v220 offset:6144
v_mfma_f32_16x16x32_bf16 v[108:111], a[76:79], a[12:15], v[108:111]
ds_read_b128 a[60:63], v221 offset:6144
v_mfma_f32_16x16x32_bf16 v[108:111], a[108:111], a[28:31], v[108:111]
s_waitcnt lgkmcnt(15)
ds_read_b64_tr_b16 a[132:133], v223 offset:0
v_mfma_f32_16x16x32_bf16 v[112:115], a[80:83], a[0:3], v[112:115]
ds_read_b64_tr_b16 a[134:135], v223 offset:1024
v_mfma_f32_16x16x32_bf16 v[112:115], a[112:115], a[16:19], v[112:115]
ds_read_b64_tr_b16 a[164:165], v223 offset:8192
v_mfma_f32_16x16x32_bf16 v[116:119], a[80:83], a[4:7], v[116:119]
ds_read_b64_tr_b16 a[166:167], v223 offset:9216
v_mfma_f32_16x16x32_bf16 v[116:119], a[112:115], a[20:23], v[116:119]
ds_read_b64_tr_b16 a[136:137], v224 offset:0
v_mfma_f32_16x16x32_bf16 v[120:123], a[80:83], a[8:11], v[120:123]
v_mfma_f32_16x16x32_bf16 v[120:123], a[112:115], a[24:27], v[120:123]
ds_read_b64_tr_b16 a[138:139], v224 offset:1024
v_mfma_f32_16x16x32_bf16 v[124:127], a[80:83], a[12:15], v[124:127]
ds_read_b64_tr_b16 a[168:169], v224 offset:8192
v_mfma_f32_16x16x32_bf16 v[124:127], a[112:115], a[28:31], v[124:127]
ds_read_b64_tr_b16 a[170:171], v224 offset:9216
v_mfma_f32_16x16x32_bf16 v[128:131], a[84:87], a[0:3], v[128:131]
ds_read_b64_tr_b16 a[140:141], v225 offset:0
v_mfma_f32_16x16x32_bf16 v[128:131], a[116:119], a[16:19], v[128:131]
ds_read_b64_tr_b16 a[142:143], v225 offset:1024
v_mfma_f32_16x16x32_bf16 v[132:135], a[84:87], a[4:7], v[132:135]
ds_read_b64_tr_b16 a[172:173], v225 offset:8192
v_mfma_f32_16x16x32_bf16 v[132:135], a[116:119], a[20:23], v[132:135]
ds_read_b64_tr_b16 a[174:175], v225 offset:9216
v_mfma_f32_16x16x32_bf16 v[136:139], a[84:87], a[8:11], v[136:139]
ds_read_b64_tr_b16 a[144:145], v226 offset:0
v_mfma_f32_16x16x32_bf16 v[136:139], a[116:119], a[24:27], v[136:139]
v_mfma_f32_16x16x32_bf16 v[140:143], a[84:87], a[12:15], v[140:143]
ds_read_b64_tr_b16 a[146:147], v226 offset:1024
v_mfma_f32_16x16x32_bf16 v[140:143], a[116:119], a[28:31], v[140:143]
s_waitcnt lgkmcnt(15)
ds_read_b64_tr_b16 a[176:177], v226 offset:8192
v_mfma_f32_16x16x32_bf16 v[144:147], a[88:91], a[0:3], v[144:147]
ds_read_b64_tr_b16 a[178:179], v226 offset:9216
v_mfma_f32_16x16x32_bf16 v[144:147], a[120:123], a[16:19], v[144:147]
ds_read_b64_tr_b16 a[148:149], v227 offset:0
v_mfma_f32_16x16x32_bf16 v[148:151], a[88:91], a[4:7], v[148:151]
ds_read_b64_tr_b16 a[150:151], v227 offset:1024
v_mfma_f32_16x16x32_bf16 v[148:151], a[120:123], a[20:23], v[148:151]
ds_read_b64_tr_b16 a[180:181], v227 offset:8192
v_mfma_f32_16x16x32_bf16 v[152:155], a[88:91], a[8:11], v[152:155]
ds_read_b64_tr_b16 a[182:183], v227 offset:9216
v_mfma_f32_16x16x32_bf16 v[152:155], a[120:123], a[24:27], v[152:155]
ds_read_b64_tr_b16 a[152:153], v228 offset:0
v_mfma_f32_16x16x32_bf16 v[156:159], a[88:91], a[12:15], v[156:159]
v_mfma_f32_16x16x32_bf16 v[156:159], a[120:123], a[28:31], v[156:159]
ds_read_b64_tr_b16 a[154:155], v228 offset:1024
v_mfma_f32_16x16x32_bf16 v[160:163], a[92:95], a[0:3], v[160:163]
ds_read_b64_tr_b16 a[184:185], v228 offset:8192
v_mfma_f32_16x16x32_bf16 v[160:163], a[124:127], a[16:19], v[160:163]
ds_read_b64_tr_b16 a[186:187], v228 offset:9216
v_mfma_f32_16x16x32_bf16 v[164:167], a[92:95], a[4:7], v[164:167]
ds_read_b64_tr_b16 a[156:157], v229 offset:0
v_mfma_f32_16x16x32_bf16 v[164:167], a[124:127], a[20:23], v[164:167]
ds_read_b64_tr_b16 a[158:159], v229 offset:1024
v_mfma_f32_16x16x32_bf16 v[168:171], a[92:95], a[8:11], v[168:171]
ds_read_b64_tr_b16 a[188:189], v229 offset:8192
v_mfma_f32_16x16x32_bf16 v[168:171], a[124:127], a[24:27], v[168:171]
ds_read_b64_tr_b16 a[190:191], v229 offset:9216
v_mfma_f32_16x16x32_bf16 v[172:175], a[92:95], a[12:15], v[172:175]
v_mfma_f32_16x16x32_bf16 v[172:175], a[124:127], a[28:31], v[172:175]
s_waitcnt lgkmcnt(15)
v_mfma_f32_16x16x32_bf16 v[48:51], a[128:131], a[32:35], v[48:51]
s_waitcnt vmcnt(0)
s_barrier
v_mfma_f32_16x16x32_bf16 v[48:51], a[160:163], a[48:51], v[48:51]
s_cmp_lg_u32 s20, 0
s_cbranch_scc1 K2_NOPOLL
buffer_load_dword v247, v246, s[80:83], 0 offen sc1
K2_NOPOLL:
v_mfma_f32_16x16x32_bf16 v[52:55], a[128:131], a[36:39], v[52:55]
s_add_u32 m0, s54, 0
s_add_u32 s32, s50, s56
v_mfma_f32_16x16x32_bf16 v[52:55], a[160:163], a[52:55], v[52:55]
buffer_load_dwordx4 v208, s[12:15], s32 offen offset:0 lds
v_mfma_f32_16x16x32_bf16 v[56:59], a[128:131], a[40:43], v[56:59]
buffer_load_dwordx4 v209, s[12:15], s32 offen offset:1024 lds
v_mfma_f32_16x16x32_bf16 v[56:59], a[160:163], a[56:59], v[56:59]
buffer_load_dwordx4 v210, s[12:15], s32 offen offset:2048 lds
v_mfma_f32_16x16x32_bf16 v[60:63], a[128:131], a[44:47], v[60:63]
buffer_load_dwordx4 v211, s[12:15], s32 offen offset:3072 lds
v_mfma_f32_16x16x32_bf16 v[60:63], a[160:163], a[60:63], v[60:63]
s_add_u32 m0, s54, 4096
s_add_u32 s32, s51, s56
v_mfma_f32_16x16x32_bf16 v[64:67], a[132:135], a[32:35], v[64:67]
buffer_load_dwordx4 v208, s[12:15], s32 offen offset:0 lds
v_mfma_f32_16x16x32_bf16 v[64:67], a[164:167], a[48:51], v[64:67]
buffer_load_dwordx4 v209, s[12:15], s32 offen offset:1024 lds
v_mfma_f32_16x16x32_bf16 v[68:71], a[132:135], a[36:39], v[68:71]
buffer_load_dwordx4 v210, s[12:15], s32 offen offset:2048 lds
v_mfma_f32_16x16x32_bf16 v[68:71], a[164:167], a[52:55], v[68:71]
v_mfma_f32_16x16x32_bf16 v[72:75], a[132:135], a[40:43], v[72:75]
buffer_load_dwordx4 v211, s[12:15], s32 offen offset:3072 lds
v_mfma_f32_16x16x32_bf16 v[72:75], a[164:167], a[56:59], v[72:75]
s_lshl_b32 s32, s56, 12
s_add_u32 m0, s49, 65536
s_add_u32 s32, s32, s52
v_mfma_f32_16x16x32_bf16 v[76:79], a[132:135], a[44:47], v[76:79]
buffer_load_dwordx4 v212, s[16:19], s32 offen offset:0 lds
v_mfma_f32_16x16x32_bf16 v[76:79], a[164:167], a[60:63], v[76:79]
buffer_load_dwordx4 v213, s[16:19], s32 offen offset:1024 lds
v_mfma_f32_16x16x32_bf16 v[80:83], a[136:139], a[32:35], v[80:83]
buffer_load_dwordx4 v214, s[16:19], s32 offen offset:2048 lds
v_mfma_f32_16x16x32_bf16 v[80:83], a[168:171], a[48:51], v[80:83]
buffer_load_dwordx4 v215, s[16:19], s32 offen offset:3072 lds
s_add_u32 s56, s56, 128
s_and_b32 s56, s56, 1023
v_mfma_f32_16x16x32_bf16 v[84:87], a[136:139], a[36:39], v[84:87]
ds_read_b64_tr_b16 a[64:65], v230 offset:0
v_mfma_f32_16x16x32_bf16 v[84:87], a[168:171], a[52:55], v[84:87]
ds_read_b64_tr_b16 a[66:67], v230 offset:1024
v_mfma_f32_16x16x32_bf16 v[88:91], a[136:139], a[40:43], v[88:91]
ds_read_b64_tr_b16 a[96:97], v230 offset:8192
v_mfma_f32_16x16x32_bf16 v[88:91], a[168:171], a[56:59], v[88:91]
v_mfma_f32_16x16x32_bf16 v[92:95], a[136:139], a[44:47], v[92:95]
ds_read_b64_tr_b16 a[98:99], v230 offset:9216
v_mfma_f32_16x16x32_bf16 v[92:95], a[168:171], a[60:63], v[92:95]
ds_read_b128 a[0:3], v216 offset:0
v_mfma_f32_16x16x32_bf16 v[96:99], a[140:143], a[32:35], v[96:99]
ds_read_b128 a[16:19], v217 offset:0
v_mfma_f32_16x16x32_bf16 v[96:99], a[172:175], a[48:51], v[96:99]
ds_read_b128 a[4:7], v216 offset:2048
v_mfma_f32_16x16x32_bf16 v[100:103], a[140:143], a[36:39], v[100:103]
ds_read_b128 a[20:23], v217 offset:2048
v_mfma_f32_16x16x32_bf16 v[100:103], a[172:175], a[52:55], v[100:103]
ds_read_b128 a[8:11], v216 offset:4096
v_mfma_f32_16x16x32_bf16 v[104:107], a[140:143], a[40:43], v[104:107]
ds_read_b128 a[24:27], v217 offset:4096
v_mfma_f32_16x16x32_bf16 v[104:107], a[172:175], a[56:59], v[104:107]
ds_read_b128 a[12:15], v216 offset:6144
v_mfma_f32_16x16x32_bf16 v[108:111], a[140:143], a[44:47], v[108:111]
ds_read_b128 a[28:31], v217 offset:6144
v_mfma_f32_16x16x32_bf16 v[108:111], a[172:175], a[60:63], v[108:111]
s_waitcnt lgkmcnt(15)
v_mfma_f32_16x16x32_bf16 v[112:115], a[144:147], a[32:35], v[112:115]
ds_read_b64_tr_b16 a[68:69], v231 offset:0
v_mfma_f32_16x16x32_bf16 v[112:115], a[176:179], a[48:51], v[112:115]
ds_read_b64_tr_b16 a[70:71], v231 offset:1024
v_mfma_f32_16x16x32_bf16 v[116:119], a[144:147], a[36:39], v[116:119]
ds_read_b64_tr_b16 a[100:101], v231 offset:8192
v_mfma_f32_16x16x32_bf16 v[116:119], a[176:179], a[52:55], v[116:119]
ds_read_b64_tr_b16 a[102:103], v231 offset:9216
v_mfma_f32_16x16x32_bf16 v[120:123], a[144:147], a[40:43], v[120:123]
ds_read_b64_tr_b16 a[72:73], v232 offset:0
v_mfma_f32_16x16x32_bf16 v[120:123], a[176:179], a[56:59], v[120:123]
ds_read_b64_tr_b16 a[74:75], v232 offset:1024
v_mfma_f32_16x16x32_bf16 v[124:127], a[144:147], a[44:47], v[124:127]
ds_read_b64_tr_b16 a[104:105], v232 offset:8192
v_mfma_f32_16x16x32_bf16 v[124:127], a[176:179], a[60:63], v[124:127]
ds_read_b64_tr_b16 a[106:107], v232 offset:9216
v_mfma_f32_16x16x32_bf16 v[128:131], a[148:151], a[32:35], v[128:131]
ds_read_b64_tr_b16 a[76:77], v233 offset:0
v_mfma_f32_16x16x32_bf16 v[128:131], a[180:183], a[48:51], v[128:131]
ds_read_b64_tr_b16 a[78:79], v233 offset:1024
v_mfma_f32_16x16x32_bf16 v[132:135], a[148:151], a[36:39], v[132:135]
v_mfma_f32_16x16x32_bf16 v[132:135], a[180:183], a[52:55], v[132:135]
ds_read_b64_tr_b16 a[108:109], v233 offset:8192
v_mfma_f32_16x16x32_bf16 v[136:139], a[148:151], a[40:43], v[136:139]
ds_read_b64_tr_b16 a[110:111], v233 offset:9216
v_mfma_f32_16x16x32_bf16 v[136:139], a[180:183], a[56:59], v[136:139]
ds_read_b64_tr_b16 a[80:81], v234 offset:0
v_mfma_f32_16x16x32_bf16 v[140:143], a[148:151], a[44:47], v[140:143]
ds_read_b64_tr_b16 a[82:83], v234 offset:1024
v_mfma_f32_16x16x32_bf16 v[140:143], a[180:183], a[60:63], v[140:143]
s_waitcnt lgkmcnt(15)
ds_read_b64_tr_b16 a[112:113], v234 offset:8192
v_mfma_f32_16x16x32_bf16 v[144:147], a[152:155], a[32:35], v[144:147]
ds_read_b64_tr_b16 a[114:115], v234 offset:9216
v_mfma_f32_16x16x32_bf16 v[144:147], a[184:187], a[48:51], v[144:147]
ds_read_b64_tr_b16 a[84:85], v235 offset:0
v_mfma_f32_16x16x32_bf16 v[148:151], a[152:155], a[36:39], v[148:151]
ds_read_b64_tr_b16 a[86:87], v235 offset:1024
v_mfma_f32_16x16x32_bf16 v[148:151], a[184:187], a[52:55], v[148:151]
ds_read_b64_tr_b16 a[116:117], v235 offset:8192
v_mfma_f32_16x16x32_bf16 v[152:155], a[152:155], a[40:43], v[152:155]
v_mfma_f32_16x16x32_bf16 v[152:155], a[184:187], a[56:59], v[152:155]
ds_read_b64_tr_b16 a[118:119], v235 offset:9216
v_mfma_f32_16x16x32_bf16 v[156:159], a[152:155], a[44:47], v[156:159]
ds_read_b64_tr_b16 a[88:89], v236 offset:0
v_mfma_f32_16x16x32_bf16 v[156:159], a[184:187], a[60:63], v[156:159]
ds_read_b64_tr_b16 a[90:91], v236 offset:1024
v_mfma_f32_16x16x32_bf16 v[160:163], a[156:159], a[32:35], v[160:163]
ds_read_b64_tr_b16 a[120:121], v236 offset:8192
v_mfma_f32_16x16x32_bf16 v[160:163], a[188:191], a[48:51], v[160:163]
ds_read_b64_tr_b16 a[122:123], v236 offset:9216
v_mfma_f32_16x16x32_bf16 v[164:167], a[156:159], a[36:39], v[164:167]
ds_read_b64_tr_b16 a[92:93], v237 offset:0
v_mfma_f32_16x16x32_bf16 v[164:167], a[188:191], a[52:55], v[164:167]
ds_read_b64_tr_b16 a[94:95], v237 offset:1024
v_mfma_f32_16x16x32_bf16 v[168:171], a[156:159], a[40:43], v[168:171]
ds_read_b64_tr_b16 a[124:125], v237 offset:8192
v_mfma_f32_16x16x32_bf16 v[168:171], a[188:191], a[56:59], v[168:171]
ds_read_b64_tr_b16 a[126:127], v237 offset:9216
v_mfma_f32_16x16x32_bf16 v[172:175], a[156:159], a[44:47], v[172:175]
v_mfma_f32_16x16x32_bf16 v[172:175], a[188:191], a[60:63], v[172:175]
s_waitcnt lgkmcnt(15)
s_cmp_lg_u32 s20, 0
s_cbranch_scc1 K2_POLLED
s_waitcnt vmcnt(12)
v_cmp_gt_u32 vcc, 8, v247
s_cbranch_vccnz K2_SLOWP
K2_POLLED:
v_mfma_f32_16x16x32_bf16 v[48:51], a[64:67], a[0:3], v[48:51]
s_waitcnt vmcnt(0)
s_barrier
v_mfma_f32_16x16x32_bf16 v[48:51], a[96:99], a[16:19], v[48:51]
s_mov_b32 s26, 65536
v_mfma_f32_16x16x32_bf16 v[52:55], a[64:67], a[4:7], v[52:55]
s_add_u32 m0, s26, s58
v_mfma_f32_16x16x32_bf16 v[52:55], a[96:99], a[20:23], v[52:55]
global_load_lds_dwordx4 v1, s[84:85] offset:0 sc1
v_mfma_f32_16x16x32_bf16 v[56:59], a[64:67], a[8:11], v[56:59]
global_load_lds_dwordx4 v1, s[84:85] offset:1024 sc1
v_mfma_f32_16x16x32_bf16 v[56:59], a[96:99], a[24:27], v[56:59]
s_add_u32 s84, s84, 8192
s_addc_u32 s85, s85, 0
v_mfma_f32_16x16x32_bf16 v[60:63], a[64:67], a[12:15], v[60:63]
s_mov_b32 s26, 98304
v_mfma_f32_16x16x32_bf16 v[60:63], a[96:99], a[28:31], v[60:63]
s_add_u32 m0, s26, s58
v_mfma_f32_16x16x32_bf16 v[64:67], a[68:71], a[0:3], v[64:67]
global_load_lds_dwordx4 v1, s[84:85] offset:0 sc1
v_mfma_f32_16x16x32_bf16 v[64:67], a[100:103], a[16:19], v[64:67]
global_load_lds_dwordx4 v1, s[84:85] offset:1024 sc1
v_mfma_f32_16x16x32_bf16 v[68:71], a[68:71], a[4:7], v[68:71]
s_add_u32 s84, s84, 8192
s_addc_u32 s85, s85, 0
v_mfma_f32_16x16x32_bf16 v[68:71], a[100:103], a[20:23], v[68:71]
s_mov_b32 s26, 0
v_mfma_f32_16x16x32_bf16 v[72:75], a[68:71], a[8:11], v[72:75]
s_add_u32 m0, s26, s48
v_mfma_f32_16x16x32_bf16 v[72:75], a[100:103], a[24:27], v[72:75]
global_load_lds_dwordx4 v1, s[86:87] offset:0 sc1
v_mfma_f32_16x16x32_bf16 v[76:79], a[68:71], a[12:15], v[76:79]
global_load_lds_dwordx4 v1, s[86:87] offset:1024 sc1
v_mfma_f32_16x16x32_bf16 v[76:79], a[100:103], a[28:31], v[76:79]
s_add_u32 s86, s86, 8192
s_addc_u32 s87, s87, 0
v_mfma_f32_16x16x32_bf16 v[80:83], a[72:75], a[0:3], v[80:83]
s_add_u32 m0, s26, s58
v_mfma_f32_16x16x32_bf16 v[80:83], a[104:107], a[16:19], v[80:83]
global_load_lds_dwordx4 v1, s[84:85] offset:0 sc1
v_mfma_f32_16x16x32_bf16 v[84:87], a[72:75], a[4:7], v[84:87]
global_load_lds_dwordx4 v1, s[84:85] offset:1024 sc1
v_mfma_f32_16x16x32_bf16 v[84:87], a[104:107], a[20:23], v[84:87]
s_add_u32 s84, s84, 8192
s_addc_u32 s85, s85, 0
v_mfma_f32_16x16x32_bf16 v[88:91], a[72:75], a[8:11], v[88:91]
ds_read_b64_tr_b16 a[128:129], v222 offset:16384
v_mfma_f32_16x16x32_bf16 v[88:91], a[104:107], a[24:27], v[88:91]
v_mfma_f32_16x16x32_bf16 v[92:95], a[72:75], a[12:15], v[92:95]
ds_read_b64_tr_b16 a[130:131], v222 offset:17408
v_mfma_f32_16x16x32_bf16 v[92:95], a[104:107], a[28:31], v[92:95]
ds_read_b64_tr_b16 a[160:161], v222 offset:24576
v_mfma_f32_16x16x32_bf16 v[96:99], a[76:79], a[0:3], v[96:99]
ds_read_b64_tr_b16 a[162:163], v222 offset:25600
v_mfma_f32_16x16x32_bf16 v[96:99], a[108:111], a[16:19], v[96:99]
ds_read_b128 a[32:35], v218 offset:0
v_mfma_f32_16x16x32_bf16 v[100:103], a[76:79], a[4:7], v[100:103]
ds_read_b128 a[48:51], v219 offset:0
v_mfma_f32_16x16x32_bf16 v[100:103], a[108:111], a[20:23], v[100:103]
ds_read_b128 a[36:39], v218 offset:2048
v_mfma_f32_16x16x32_bf16 v[104:107], a[76:79], a[8:11], v[104:107]
ds_read_b128 a[52:55], v219 offset:2048
v_mfma_f32_16x16x32_bf16 v[104:107], a[108:111], a[24:27], v[104:107]
ds_read_b128 a[40:43], v218 offset:4096
v_mfma_f32_16x16x32_bf16 v[108:111], a[76:79], a[12:15], v[108:111]
ds_read_b128 a[56:59], v219 offset:4096
v_mfma_f32_16x16x32_bf16 v[108:111], a[108:111], a[28:31], v[108:111]
s_waitcnt lgkmcnt(15)
ds_read_b128 a[44:47], v218 offset:6144
v_mfma_f32_16x16x32_bf16 v[112:115], a[80:83], a[0:3], v[112:115]
ds_read_b128 a[60:63], v219 offset:6144
v_mfma_f32_16x16x32_bf16 v[112:115], a[112:115], a[16:19], v[112:115]
ds_read_b64_tr_b16 a[132:133], v223 offset:16384
v_mfma_f32_16x16x32_bf16 v[116:119], a[80:83], a[4:7], v[116:119]
ds_read_b64_tr_b16 a[134:135], v223 offset:17408
v_mfma_f32_16x16x32_bf16 v[116:119], a[112:115], a[20:23], v[116:119]
ds_read_b64_tr_b16 a[164:165], v223 offset:24576
v_mfma_f32_16x16x32_bf16 v[120:123], a[80:83], a[8:11], v[120:123]
ds_read_b64_tr_b16 a[166:167], v223 offset:25600
v_mfma_f32_16x16x32_bf16 v[120:123], a[112:115], a[24:27], v[120:123]
ds_read_b64_tr_b16 a[136:137], v224 offset:16384
v_mfma_f32_16x16x32_bf16 v[124:127], a[80:83], a[12:15], v[124:127]
ds_read_b64_tr_b16 a[138:139], v224 offset:17408
v_mfma_f32_16x16x32_bf16 v[124:127], a[112:115], a[28:31], v[124:127]
ds_read_b64_tr_b16 a[168:169], v224 offset:24576
v_mfma_f32_16x16x32_bf16 v[128:131], a[84:87], a[0:3], v[128:131]
ds_read_b64_tr_b16 a[170:171], v224 offset:25600
v_mfma_f32_16x16x32_bf16 v[128:131], a[116:119], a[16:19], v[128:131]
ds_read_b64_tr_b16 a[140:141], v225 offset:16384
v_mfma_f32_16x16x32_bf16 v[132:135], a[84:87], a[4:7], v[132:135]
v_mfma_f32_16x16x32_bf16 v[132:135], a[116:119], a[20:23], v[132:135]
ds_read_b64_tr_b16 a[142:143], v225 offset:17408
v_mfma_f32_16x16x32_bf16 v[136:139], a[84:87], a[8:11], v[136:139]
ds_read_b64_tr_b16 a[172:173], v225 offset:24576
v_mfma_f32_16x16x32_bf16 v[136:139], a[116:119], a[24:27], v[136:139]
ds_read_b64_tr_b16 a[174:175], v225 offset:25600
v_mfma_f32_16x16x32_bf16 v[140:143], a[84:87], a[12:15], v[140:143]
ds_read_b64_tr_b16 a[144:145], v226 offset:16384
v_mfma_f32_16x16x32_bf16 v[140:143], a[116:119], a[28:31], v[140:143]
s_waitcnt lgkmcnt(15)
ds_read_b64_tr_b16 a[146:147], v226 offset:17408
v_mfma_f32_16x16x32_bf16 v[144:147], a[88:91], a[0:3], v[144:147]
ds_read_b64_tr_b16 a[176:177], v226 offset:24576
v_mfma_f32_16x16x32_bf16 v[144:147], a[120:123], a[16:19], v[144:147]
ds_read_b64_tr_b16 a[178:179], v226 offset:25600
v_mfma_f32_16x16x32_bf16 v[148:151], a[88:91], a[4:7], v[148:151]
ds_read_b64_tr_b16 a[148:149], v227 offset:16384
v_mfma_f32_16x16x32_bf16 v[148:151], a[120:123], a[20:23], v[148:151]
ds_read_b64_tr_b16 a[150:151], v227 offset:17408
v_mfma_f32_16x16x32_bf16 v[152:155], a[88:91], a[8:11], v[152:155]
ds_read_b64_tr_b16 a[180:181], v227 offset:24576
v_mfma_f32_16x16x32_bf16 v[152:155], a[120:123], a[24:27], v[152:155]
ds_read_b64_tr_b16 a[182:183], v227 offset:25600
v_mfma_f32_16x16x32_bf16 v[156:159], a[88:91], a[12:15], v[156:159]
ds_read_b64_tr_b16 a[152:153], v228 offset:16384
v_mfma_f32_16x16x32_bf16 v[156:159], a[120:123], a[28:31], v[156:159]
ds_read_b64_tr_b16 a[154:155], v228 offset:17408
v_mfma_f32_16x16x32_bf16 v[160:163], a[92:95], a[0:3], v[160:163]
ds_read_b64_tr_b16 a[184:185], v228 offset:24576
v_mfma_f32_16x16x32_bf16 v[160:163], a[124:127], a[16:19], v[160:163]
ds_read_b64_tr_b16 a[186:187], v228 offset:25600
v_mfma_f32_16x16x32_bf16 v[164:167], a[92:95], a[4:7], v[164:167]
ds_read_b64_tr_b16 a[156:157], v229 offset:16384
v_mfma_f32_16x16x32_bf16 v[164:167], a[124:127], a[20:23], v[164:167]
ds_read_b64_tr_b16 a[158:159], v229 offset:17408
v_mfma_f32_16x16x32_bf16 v[168:171], a[92:95], a[8:11], v[168:171]
ds_read_b64_tr_b16 a[188:189], v229 offset:24576
v_mfma_f32_16x16x32_bf16 v[168:171], a[124:127], a[24:27], v[168:171]
ds_read_b64_tr_b16 a[190:191], v229 offset:25600
v_mfma_f32_16x16x32_bf16 v[172:175], a[92:95], a[12:15], v[172:175]
v_mfma_f32_16x16x32_bf16 v[172:175], a[124:127], a[28:31], v[172:175]
s_waitcnt lgkmcnt(15)
v_mfma_f32_16x16x32_bf16 v[48:51], a[128:131], a[32:35], v[48:51]
s_barrier
v_mfma_f32_16x16x32_bf16 v[48:51], a[160:163], a[48:51], v[48:51]
s_mov_b32 s26, 32768
v_mfma_f32_16x16x32_bf16 v[52:55], a[128:131], a[36:39], v[52:55]
v_mfma_f32_16x16x32_bf16 v[52:55], a[160:163], a[52:55], v[52:55]
v_mfma_f32_16x16x32_bf16 v[56:59], a[128:131], a[40:43], v[56:59]
s_add_u32 m0, s26, s48
v_mfma_f32_16x16x32_bf16 v[56:59], a[160:163], a[56:59], v[56:59]
v_mfma_f32_16x16x32_bf16 v[60:63], a[128:131], a[44:47], v[60:63]
v_mfma_f32_16x16x32_bf16 v[60:63], a[160:163], a[60:63], v[60:63]
global_load_lds_dwordx4 v1, s[86:87] offset:0 sc1
v_mfma_f32_16x16x32_bf16 v[64:67], a[132:135], a[32:35], v[64:67]
v_mfma_f32_16x16x32_bf16 v[64:67], a[164:167], a[48:51], v[64:67]
v_mfma_f32_16x16x32_bf16 v[68:71], a[132:135], a[36:39], v[68:71]
global_load_lds_dwordx4 v1, s[86:87] offset:1024 sc1
v_mfma_f32_16x16x32_bf16 v[68:71], a[164:167], a[52:55], v[68:71]
v_mfma_f32_16x16x32_bf16 v[72:75], a[132:135], a[40:43], v[72:75]
v_mfma_f32_16x16x32_bf16 v[72:75], a[164:167], a[56:59], v[72:75]
s_add_u32 s86, s86, 8192
s_addc_u32 s87, s87, 0
v_mfma_f32_16x16x32_bf16 v[76:79], a[132:135], a[44:47], v[76:79]
v_mfma_f32_16x16x32_bf16 v[76:79], a[164:167], a[60:63], v[76:79]
v_mfma_f32_16x16x32_bf16 v[80:83], a[136:139], a[32:35], v[80:83]
s_add_u32 m0, s26, s58
v_mfma_f32_16x16x32_bf16 v[80:83], a[168:171], a[48:51], v[80:83]
v_mfma_f32_16x16x32_bf16 v[84:87], a[136:139], a[36:39], v[84:87]
v_mfma_f32_16x16x32_bf16 v[84:87], a[168:171], a[52:55], v[84:87]
global_load_lds_dwordx4 v1, s[84:85] offset:0 sc1
v_mfma_f32_16x16x32_bf16 v[88:91], a[136:139], a[40:43], v[88:91]
v_cvt_pk_bf16_f32 v176, v48, v49
v_cvt_pk_bf16_f32 v177, v50, v51
v_mfma_f32_16x16x32_bf16 v[88:91], a[168:171], a[56:59], v[88:91]
v_cvt_pk_bf16_f32 v178, v64, v65
v_cvt_pk_bf16_f32 v179, v66, v67
v_mfma_f32_16x16x32_bf16 v[92:95], a[136:139], a[44:47], v[92:95]
global_load_lds_dwordx4 v1, s[84:85] offset:1024 sc1
v_cvt_pk_bf16_f32 v192, v52, v53
v_cvt_pk_bf16_f32 v193, v54, v55
v_mfma_f32_16x16x32_bf16 v[92:95], a[168:171], a[60:63], v[92:95]
v_cvt_pk_bf16_f32 v194, v68, v69
v_cvt_pk_bf16_f32 v195, v70, v71
v_mfma_f32_16x16x32_bf16 v[96:99], a[140:143], a[32:35], v[96:99]
v_cvt_pk_bf16_f32 v208, v56, v57
v_cvt_pk_bf16_f32 v209, v58, v59
v_mfma_f32_16x16x32_bf16 v[96:99], a[172:175], a[48:51], v[96:99]
s_add_u32 s84, s84, 8192
s_addc_u32 s85, s85, 0
v_cvt_pk_bf16_f32 v210, v72, v73
v_cvt_pk_bf16_f32 v211, v74, v75
v_mfma_f32_16x16x32_bf16 v[100:103], a[140:143], a[36:39], v[100:103]
v_cvt_pk_bf16_f32 v224, v60, v61
v_cvt_pk_bf16_f32 v225, v62, v63
v_mfma_f32_16x16x32_bf16 v[100:103], a[172:175], a[52:55], v[100:103]
v_cvt_pk_bf16_f32 v226, v76, v77
v_cvt_pk_bf16_f32 v227, v78, v79
v_mfma_f32_16x16x32_bf16 v[104:107], a[140:143], a[40:43], v[104:107]
s_mov_b32 s26, 65536
v_mfma_f32_16x16x32_bf16 v[104:107], a[172:175], a[56:59], v[104:107]
v_mfma_f32_16x16x32_bf16 v[108:111], a[140:143], a[44:47], v[108:111]
v_mfma_f32_16x16x32_bf16 v[108:111], a[172:175], a[60:63], v[108:111]
s_waitcnt lgkmcnt(8)
s_mov_b32 s25, 32768
v_mfma_f32_16x16x32_bf16 v[112:115], a[144:147], a[32:35], v[112:115]
v_mfma_f32_16x16x32_bf16 v[112:115], a[176:179], a[48:51], v[112:115]
v_mfma_f32_16x16x32_bf16 v[116:119], a[144:147], a[36:39], v[116:119]
v_lshrrev_b32 v240, 5, v0
v_bfe_u32 v241, v0, 1, 4
v_xor_b32 v241, v241, v240
v_and_b32 v242, 1, v0
v_lshlrev_b32 v242, 4, v242
v_lshl_add_u32 v242, v240, 10, v242
v_mfma_f32_16x16x32_bf16 v[116:119], a[176:179], a[52:55], v[116:119]
v_mfma_f32_16x16x32_bf16 v[120:123], a[144:147], a[40:43], v[120:123]
v_cvt_pk_bf16_f32 v180, v80, v81
v_cvt_pk_bf16_f32 v181, v82, v83
v_mfma_f32_16x16x32_bf16 v[120:123], a[176:179], a[56:59], v[120:123]
s_lshr_b32 s36, s2, 1
s_lshl_b32 s36, s36, 15
s_and_b32 s37, s2, 1
s_lshl_b32 s37, s37, 9
v_cvt_pk_bf16_f32 v182, v96, v97
v_cvt_pk_bf16_f32 v183, v98, v99
v_mfma_f32_16x16x32_bf16 v[124:127], a[144:147], a[44:47], v[124:127]
v_cvt_pk_bf16_f32 v196, v84, v85
v_cvt_pk_bf16_f32 v197, v86, v87
v_mfma_f32_16x16x32_bf16 v[124:127], a[176:179], a[60:63], v[124:127]
v_cvt_pk_bf16_f32 v198, v100, v101
v_cvt_pk_bf16_f32 v199, v102, v103
v_mfma_f32_16x16x32_bf16 v[128:131], a[148:151], a[32:35], v[128:131]
s_add_u32 s36, s36, s37
s_lshl_b32 s37, s20, 13
s_add_u32 s36, s36, s37
v_cvt_pk_bf16_f32 v212, v88, v89
v_cvt_pk_bf16_f32 v213, v90, v91
v_mfma_f32_16x16x32_bf16 v[128:131], a[180:183], a[48:51], v[128:131]
v_cvt_pk_bf16_f32 v214, v104, v105
v_cvt_pk_bf16_f32 v215, v106, v107
v_mfma_f32_16x16x32_bf16 v[132:135], a[148:151], a[36:39], v[132:135]
v_cvt_pk_bf16_f32 v228, v92, v93
v_cvt_pk_bf16_f32 v229, v94, v95
v_mfma_f32_16x16x32_bf16 v[132:135], a[180:183], a[52:55], v[132:135]
v_xor_b32 v243, 0, v241
v_lshl_add_u32 v243, v243, 5, v242
s_add_u32 m0, s49, 131072
s_add_u32 s37, s36, 0
buffer_load_dwordx4 v243, s[60:63], s37 offen offset:0 lds
v_cvt_pk_bf16_f32 v230, v108, v109
v_cvt_pk_bf16_f32 v231, v110, v111
v_mfma_f32_16x16x32_bf16 v[136:139], a[148:151], a[40:43], v[136:139]
v_mfma_f32_16x16x32_bf16 v[136:139], a[180:183], a[56:59], v[136:139]
v_mfma_f32_16x16x32_bf16 v[140:143], a[148:151], a[44:47], v[140:143]
v_xor_b32 v243, 2, v241
v_lshl_add_u32 v243, v243, 5, v242
s_add_u32 m0, s49, 131072
s_add_u32 s37, s36, 1024
buffer_load_dwordx4 v243, s[60:63], s37 offen offset:1024 lds
v_mfma_f32_16x16x32_bf16 v[140:143], a[180:183], a[60:63], v[140:143]
s_waitcnt lgkmcnt(0)
v_mfma_f32_16x16x32_bf16 v[144:147], a[152:155], a[32:35], v[144:147]
v_mfma_f32_16x16x32_bf16 v[144:147], a[184:187], a[48:51], v[144:147]
v_xor_b32 v243, 4, v241
v_lshl_add_u32 v243, v243, 5, v242
s_add_u32 m0, s49, 131072
s_add_u32 s37, s36, 2048
buffer_load_dwordx4 v243, s[60:63], s37 offen offset:2048 lds
v_mfma_f32_16x16x32_bf16 v[148:151], a[152:155], a[36:39], v[148:151]
v_mfma_f32_16x16x32_bf16 v[148:151], a[184:187], a[52:55], v[148:151]
v_mfma_f32_16x16x32_bf16 v[152:155], a[152:155], a[40:43], v[152:155]
v_xor_b32 v243, 6, v241
v_lshl_add_u32 v243, v243, 5, v242
s_add_u32 m0, s49, 131072
s_add_u32 s37, s36, 3072
buffer_load_dwordx4 v243, s[60:63], s37 offen offset:3072 lds
v_cvt_pk_bf16_f32 v184, v112, v113
v_cvt_pk_bf16_f32 v185, v114, v115
v_mfma_f32_16x16x32_bf16 v[152:155], a[184:187], a[56:59], v[152:155]
v_cvt_pk_bf16_f32 v186, v128, v129
v_cvt_pk_bf16_f32 v187, v130, v131
v_mfma_f32_16x16x32_bf16 v[156:159], a[152:155], a[44:47], v[156:159]
v_cvt_pk_bf16_f32 v200, v116, v117
v_cvt_pk_bf16_f32 v201, v118, v119
v_mfma_f32_16x16x32_bf16 v[156:159], a[184:187], a[60:63], v[156:159]
v_lshrrev_b32 v240, 2, v0
v_lshlrev_b32 v240, 10, v240
v_and_b32 v241, 3, v0
v_lshl_add_u32 v240, v241, 4, v240
s_lshr_b32 s36, s2, 4
s_lshl_b32 s36, s36, 15
s_and_b32 s37, s2, 15
s_lshl_b32 s37, s37, 6
s_add_u32 s36, s36, s37
s_and_b32 s37, s20, 1
s_lshl_b32 s38, s37, 14
s_add_u32 s36, s36, s38
s_lshl_b32 s37, s37, 10
s_add_u32 m0, s37, 147456
s_nop 0
buffer_load_dwordx4 v240, s[64:67], s36 offen lds
v_cvt_pk_bf16_f32 v202, v132, v133
v_cvt_pk_bf16_f32 v203, v134, v135
v_mfma_f32_16x16x32_bf16 v[160:163], a[156:159], a[32:35], v[160:163]
v_cvt_pk_bf16_f32 v216, v120, v121
v_cvt_pk_bf16_f32 v217, v122, v123
v_mfma_f32_16x16x32_bf16 v[160:163], a[188:191], a[48:51], v[160:163]
v_cvt_pk_bf16_f32 v218, v136, v137
v_cvt_pk_bf16_f32 v219, v138, v139
v_mfma_f32_16x16x32_bf16 v[164:167], a[156:159], a[36:39], v[164:167]
v_cvt_pk_bf16_f32 v232, v124, v125
v_cvt_pk_bf16_f32 v233, v126, v127
v_mfma_f32_16x16x32_bf16 v[164:167], a[188:191], a[52:55], v[164:167]
v_cvt_pk_bf16_f32 v234, v140, v141
v_cvt_pk_bf16_f32 v235, v142, v143
v_mfma_f32_16x16x32_bf16 v[168:171], a[156:159], a[40:43], v[168:171]
s_waitcnt vmcnt(9)
s_barrier
v_add_u32 v2, 65536, v1
v_add_u32 v3, 98304, v1
v_mfma_f32_16x16x32_bf16 v[168:171], a[188:191], a[56:59], v[168:171]
v_mfma_f32_16x16x32_bf16 v[172:175], a[156:159], a[44:47], v[172:175]
v_mfma_f32_16x16x32_bf16 v[172:175], a[188:191], a[60:63], v[172:175]
ds_read_b128 a[128:131], v2 offset:16384
ds_read_b128 a[136:139], v2 offset:18432
ds_read_b128 a[144:147], v2 offset:20480
ds_read_b128 a[152:155], v2 offset:22528
ds_read_b128 a[160:163], v2 offset:17408
ds_read_b128 a[168:171], v2 offset:19456
ds_read_b128 a[176:179], v2 offset:21504
ds_read_b128 a[184:187], v2 offset:23552
ds_read_b128 a[132:135], v3 offset:16384
ds_read_b128 a[140:143], v3 offset:18432
ds_read_b128 a[148:151], v3 offset:20480
ds_read_b128 a[156:159], v3 offset:22528
ds_read_b128 a[164:167], v3 offset:17408
ds_read_b128 a[172:175], v3 offset:19456
ds_read_b128 a[180:183], v3 offset:21504
ds_read_b128 a[188:191], v3 offset:23552
v_mov_b32 v240, 0
v_mov_b32 v241, 0
v_mov_b32 v242, 0
v_mov_b32 v243, 0
v_mov_b32 v6, v4
v_cmp_gt_i32 s[40:41], 0, v6
v_cmp_gt_i32 s[42:43], 1, v6
v_cmp_gt_i32 s[44:45], 2, v6
v_cmp_gt_i32 s[46:47], 3, v6
v_cvt_pk_bf16_f32 v188, v144, v145
v_cvt_pk_bf16_f32 v189, v146, v147
v_cvt_pk_bf16_f32 v190, v160, v161
v_cvt_pk_bf16_f32 v191, v162, v163
v_cvt_pk_bf16_f32 v204, v148, v149
v_cvt_pk_bf16_f32 v205, v150, v151
v_cvt_pk_bf16_f32 v206, v164, v165
v_cvt_pk_bf16_f32 v207, v166, v167
v_cvt_pk_bf16_f32 v220, v152, v153
v_cvt_pk_bf16_f32 v221, v154, v155
v_cvt_pk_bf16_f32 v222, v168, v169
v_cvt_pk_bf16_f32 v223, v170, v171
v_cvt_pk_bf16_f32 v236, v156, v157
v_cvt_pk_bf16_f32 v237, v158, v159
v_cvt_pk_bf16_f32 v238, v172, v173
v_cvt_pk_bf16_f32 v239, v174, v175
s_nop 0
s_waitcnt lgkmcnt(15)
v_mfma_f32_16x16x32_bf16 v[48:51], a[128:131], v[176:179], 0
s_waitcnt lgkmcnt(14)
v_mfma_f32_16x16x32_bf16 v[48:51], a[136:139], v[180:183], v[48:51]
s_waitcnt lgkmcnt(13)
v_mfma_f32_16x16x32_bf16 v[48:51], a[144:147], v[184:187], v[48:51]
s_waitcnt lgkmcnt(12)
v_mfma_f32_16x16x32_bf16 v[48:51], a[152:155], v[188:191], v[48:51]
v_mfma_f32_16x16x32_bf16 v[52:55], a[128:131], v[192:195], 0
v_mfma_f32_16x16x32_bf16 v[52:55], a[136:139], v[196:199], v[52:55]
v_mfma_f32_16x16x32_bf16 v[52:55], a[144:147], v[200:203], v[52:55]
v_mfma_f32_16x16x32_bf16 v[52:55], a[152:155], v[204:207], v[52:55]
v_mfma_f32_16x16x32_bf16 v[56:59], a[128:131], v[208:211], 0
v_mfma_f32_16x16x32_bf16 v[56:59], a[136:139], v[212:215], v[56:59]
v_mfma_f32_16x16x32_bf16 v[56:59], a[144:147], v[216:219], v[56:59]
v_mfma_f32_16x16x32_bf16 v[56:59], a[152:155], v[220:223], v[56:59]
v_mfma_f32_16x16x32_bf16 v[60:63], a[128:131], v[224:227], 0
v_mfma_f32_16x16x32_bf16 v[60:63], a[136:139], v[228:231], v[60:63]
v_mfma_f32_16x16x32_bf16 v[60:63], a[144:147], v[232:235], v[60:63]
v_mfma_f32_16x16x32_bf16 v[60:63], a[152:155], v[236:239], v[60:63]
s_waitcnt lgkmcnt(11)
v_mfma_f32_16x16x32_bf16 v[64:67], a[160:163], v[176:179], 0
s_waitcnt lgkmcnt(10)
v_mfma_f32_16x16x32_bf16 v[64:67], a[168:171], v[180:183], v[64:67]
s_waitcnt lgkmcnt(9)
v_mfma_f32_16x16x32_bf16 v[64:67], a[176:179], v[184:187], v[64:67]
s_waitcnt lgkmcnt(8)
v_mfma_f32_16x16x32_bf16 v[64:67], a[184:187], v[188:191], v[64:67]
v_mfma_f32_16x16x32_bf16 v[68:71], a[160:163], v[192:195], 0
v_mfma_f32_16x16x32_bf16 v[68:71], a[168:171], v[196:199], v[68:71]
v_mfma_f32_16x16x32_bf16 v[68:71], a[176:179], v[200:203], v[68:71]
v_mfma_f32_16x16x32_bf16 v[68:71], a[184:187], v[204:207], v[68:71]
v_mfma_f32_16x16x32_bf16 v[72:75], a[160:163], v[208:211], 0
v_mfma_f32_16x16x32_bf16 v[72:75], a[168:171], v[212:215], v[72:75]
v_mfma_f32_16x16x32_bf16 v[72:75], a[176:179], v[216:219], v[72:75]
v_mfma_f32_16x16x32_bf16 v[72:75], a[184:187], v[220:223], v[72:75]
v_mfma_f32_16x16x32_bf16 v[76:79], a[160:163], v[224:227], 0
v_mfma_f32_16x16x32_bf16 v[76:79], a[168:171], v[228:231], v[76:79]
v_mfma_f32_16x16x32_bf16 v[76:79], a[176:179], v[232:235], v[76:79]
v_mfma_f32_16x16x32_bf16 v[76:79], a[184:187], v[236:239], v[76:79]
v_mfma_f32_32x32x16_bf16 a[0:15], v[240:243], v[240:243], 0
v_mfma_f32_32x32x16_bf16 a[16:31], v[240:243], v[240:243], 0
v_mfma_f32_32x32x16_bf16 a[32:47], v[240:243], v[240:243], 0
v_mfma_f32_32x32x16_bf16 a[48:63], v[240:243], v[240:243], 0
v_mfma_f32_32x32x16_bf16 a[64:79], v[240:243], v[240:243], 0
v_mfma_f32_32x32x16_bf16 a[80:95], v[240:243], v[240:243], 0
v_mfma_f32_32x32x16_bf16 a[96:111], v[240:243], v[240:243], 0
v_mfma_f32_32x32x16_bf16 a[112:127], v[240:243], v[240:243], 0
s_cmp_eq_u32 s22, 0
s_cselect_b32 s29, 0, -4096
s_call_b64 s[78:79], K2_MASK_0c
v_max_f32 v36, v48, v49
v_max_f32 v37, v52, v53
v_max_f32 v38, v56, v57
v_max_f32 v39, v60, v61
v_max3_f32 v36, v36, v50, v51
v_max3_f32 v37, v37, v54, v55
v_max3_f32 v38, v38, v58, v59
v_max3_f32 v39, v39, v62, v63
v_max3_f32 v36, v36, v64, v65
v_max3_f32 v37, v37, v68, v69
v_max3_f32 v38, v38, v72, v73
v_max3_f32 v39, v39, v76, v77
v_max3_f32 v36, v36, v66, v67
v_max3_f32 v37, v37, v70, v71
v_max3_f32 v38, v38, v74, v75
v_max3_f32 v39, v39, v78, v79
v_mov_b32 v40, v36
v_mov_b32 v41, v37
v_mov_b32 v42, v38
v_mov_b32 v43, v39
v_permlane32_swap_b32 v36, v40
v_permlane32_swap_b32 v37, v41
v_permlane32_swap_b32 v38, v42
v_permlane32_swap_b32 v39, v43
v_max_f32 v36, v36, v40
v_max_f32 v37, v37, v41
v_max_f32 v38, v38, v42
v_max_f32 v39, v39, v43
v_mov_b32 v40, v36
v_mov_b32 v41, v37
v_mov_b32 v42, v38
v_mov_b32 v43, v39
v_permlane16_swap_b32 v36, v40
v_permlane16_swap_b32 v37, v41
v_permlane16_swap_b32 v38, v42
v_permlane16_swap_b32 v39, v43
v_max_f32 v36, v36, v40
v_max_f32 v37, v37, v41
v_max_f32 v38, v38, v42
v_max_f32 v39, v39, v43
v_ceil_f32 v36, v36
v_ceil_f32 v37, v37
v_ceil_f32 v38, v38
v_ceil_f32 v39, v39
v_sub_f32 v20, 0, v36
v_sub_f32 v21, 0, v36
v_sub_f32 v22, 0, v36
v_sub_f32 v23, 0, v36
v_sub_f32 v24, 0, v37
v_sub_f32 v25, 0, v37
v_sub_f32 v26, 0, v37
v_sub_f32 v27, 0, v37
v_sub_f32 v28, 0, v38
v_sub_f32 v29, 0, v38
v_sub_f32 v30, 0, v38
v_sub_f32 v31, 0, v38
v_sub_f32 v32, 0, v39
v_sub_f32 v33, 0, v39
v_sub_f32 v34, 0, v39
v_sub_f32 v35, 0, v39
v_mov_b32 v2, v1
s_waitcnt lgkmcnt(0)
s_barrier
v_mfma_f32_16x16x32_bf16 v[80:83], a[132:135], v[176:179], v[20:23]
v_mov_b32 v8, 0
v_mov_b32 v9, 0
v_mov_b32 v10, 0
v_mfma_f32_16x16x32_bf16 v[80:83], a[140:143], v[180:183], v[80:83]
v_mov_b32 v11, 0
v_sub_f32 v48, v48, v36
v_sub_f32 v49, v49, v36
v_sub_f32 v50, v50, v36
v_mfma_f32_16x16x32_bf16 v[80:83], a[148:151], v[184:187], v[80:83]
v_sub_f32 v51, v51, v36
v_sub_f32 v52, v52, v37
v_sub_f32 v53, v53, v37
v_mfma_f32_16x16x32_bf16 v[80:83], a[156:159], v[188:191], v[80:83]
v_sub_f32 v54, v54, v37
v_sub_f32 v55, v55, v37
v_sub_f32 v56, v56, v38
v_sub_f32 v57, v57, v38
v_mfma_f32_16x16x32_bf16 v[84:87], a[132:135], v[192:195], v[24:27]
v_sub_f32 v58, v58, v38
v_sub_f32 v59, v59, v38
v_sub_f32 v60, v60, v39
v_mfma_f32_16x16x32_bf16 v[84:87], a[140:143], v[196:199], v[84:87]
v_sub_f32 v61, v61, v39
v_sub_f32 v62, v62, v39
v_sub_f32 v63, v63, v39
v_sub_f32 v64, v64, v36
v_mfma_f32_16x16x32_bf16 v[84:87], a[148:151], v[200:203], v[84:87]
v_sub_f32 v65, v65, v36
v_sub_f32 v66, v66, v36
v_sub_f32 v67, v67, v36
v_mfma_f32_16x16x32_bf16 v[84:87], a[156:159], v[204:207], v[84:87]
v_sub_f32 v68, v68, v37
v_sub_f32 v69, v69, v37
v_sub_f32 v70, v70, v37
v_sub_f32 v71, v71, v37
v_mfma_f32_16x16x32_bf16 v[88:91], a[132:135], v[208:211], v[28:31]
v_sub_f32 v72, v72, v38
v_sub_f32 v73, v73, v38
v_sub_f32 v74, v74, v38
v_mfma_f32_16x16x32_bf16 v[88:91], a[140:143], v[212:215], v[88:91]
v_sub_f32 v75, v75, v38
v_sub_f32 v76, v76, v39
v_sub_f32 v77, v77, v39
v_sub_f32 v78, v78, v39
v_mfma_f32_16x16x32_bf16 v[88:91], a[148:151], v[216:219], v[88:91]
v_sub_f32 v79, v79, v39
v_exp_f32 v48, v48
v_exp_f32 v49, v49
v_mfma_f32_16x16x32_bf16 v[88:91], a[156:159], v[220:223], v[88:91]
v_exp_f32 v50, v50
v_exp_f32 v51, v51
v_exp_f32 v52, v52
v_add_f32 v12, v48, v49
v_mfma_f32_16x16x32_bf16 v[92:95], a[132:135], v[224:227], v[32:35]
v_cvt_pk_bf16_f32 v112, v48, v49
v_exp_f32 v53, v53
v_add_f32 v12, v12, v50
v_mfma_f32_16x16x32_bf16 v[92:95], a[140:143], v[228:231], v[92:95]
v_add_f32 v12, v12, v51
v_exp_f32 v54, v54
v_cvt_pk_bf16_f32 v113, v50, v51
v_exp_f32 v55, v55
v_mfma_f32_16x16x32_bf16 v[92:95], a[148:151], v[232:235], v[92:95]
v_exp_f32 v56, v56
v_add_f32 v13, v52, v53
v_cvt_pk_bf16_f32 v116, v52, v53
v_mfma_f32_16x16x32_bf16 v[92:95], a[156:159], v[236:239], v[92:95]
v_exp_f32 v57, v57
v_add_f32 v13, v13, v54
v_add_f32 v13, v13, v55
v_exp_f32 v58, v58
v_mfma_f32_16x16x32_bf16 v[96:99], a[164:167], v[176:179], v[20:23]
v_cvt_pk_bf16_f32 v117, v54, v55
v_exp_f32 v59, v59
v_exp_f32 v60, v60
v_add_f32 v14, v56, v57
v_mfma_f32_16x16x32_bf16 v[96:99], a[172:175], v[180:183], v[96:99]
v_cvt_pk_bf16_f32 v120, v56, v57
v_exp_f32 v61, v61
v_add_f32 v14, v14, v58
v_mfma_f32_16x16x32_bf16 v[96:99], a[180:183], v[184:187], v[96:99]
v_add_f32 v14, v14, v59
v_exp_f32 v62, v62
v_cvt_pk_bf16_f32 v121, v58, v59
v_exp_f32 v63, v63
v_mfma_f32_16x16x32_bf16 v[96:99], a[188:191], v[188:191], v[96:99]
v_exp_f32 v64, v64
v_add_f32 v15, v60, v61
v_cvt_pk_bf16_f32 v124, v60, v61
v_mfma_f32_16x16x32_bf16 v[100:103], a[164:167], v[192:195], v[24:27]
ds_read_b128 a[128:131], v2 offset:0
v_exp_f32 v65, v65
v_add_f32 v15, v15, v62
v_add_f32 v15, v15, v63
v_exp_f32 v66, v66
v_mfma_f32_16x16x32_bf16 v[100:103], a[172:175], v[196:199], v[100:103]
v_cvt_pk_bf16_f32 v125, v62, v63
v_exp_f32 v67, v67
v_exp_f32 v68, v68
v_mfma_f32_16x16x32_bf16 v[100:103], a[180:183], v[200:203], v[100:103]
ds_read_b128 a[136:139], v2 offset:1024
v_add_f32 v12, v12, v64
v_add_f32 v12, v12, v65
v_exp_f32 v69, v69
v_cvt_pk_bf16_f32 v114, v64, v65
v_mfma_f32_16x16x32_bf16 v[100:103], a[188:191], v[204:207], v[100:103]
v_add_f32 v12, v12, v66
v_exp_f32 v70, v70
v_add_f32 v12, v12, v67
v_mfma_f32_16x16x32_bf16 v[104:107], a[164:167], v[208:211], v[28:31]
ds_read_b128 a[144:147], v2 offset:2048
v_cvt_pk_bf16_f32 v115, v66, v67
v_exp_f32 v71, v71
v_exp_f32 v72, v72
v_add_f32 v13, v13, v68
v_mfma_f32_16x16x32_bf16 v[104:107], a[172:175], v[212:215], v[104:107]
v_add_f32 v13, v13, v69
v_exp_f32 v73, v73
v_cvt_pk_bf16_f32 v118, v68, v69
v_mfma_f32_16x16x32_bf16 v[104:107], a[180:183], v[216:219], v[104:107]
ds_read_b128 a[152:155], v2 offset:3072
v_add_f32 v13, v13, v70
v_exp_f32 v74, v74
v_add_f32 v13, v13, v71
v_cvt_pk_bf16_f32 v119, v70, v71
v_mfma_f32_16x16x32_bf16 v[104:107], a[188:191], v[220:223], v[104:107]
v_exp_f32 v75, v75
v_exp_f32 v76, v76
v_add_f32 v14, v14, v72
v_mfma_f32_16x16x32_bf16 v[108:111], a[164:167], v[224:227], v[32:35]
ds_read_b128 a[160:163], v2 offset:4096
v_add_f32 v14, v14, v73
v_exp_f32 v77, v77
v_cvt_pk_bf16_f32 v122, v72, v73
v_add_f32 v14, v14, v74
v_mfma_f32_16x16x32_bf16 v[108:111], a[172:175], v[228:231], v[108:111]
v_exp_f32 v78, v78
v_add_f32 v14, v14, v75
v_cvt_pk_bf16_f32 v123, v74, v75
v_mfma_f32_16x16x32_bf16 v[108:111], a[180:183], v[232:235], v[108:111]
ds_read_b128 a[168:171], v2 offset:5120
v_exp_f32 v79, v79
s_nop 0
v_add_f32 v15, v15, v76
v_add_f32 v15, v15, v77
v_mfma_f32_16x16x32_bf16 v[108:111], a[188:191], v[236:239], v[108:111]
v_cvt_pk_bf16_f32 v126, v76, v77
v_add_f32 v15, v15, v78
v_add_f32 v15, v15, v79
v_cvt_pk_bf16_f32 v127, v78, v79
s_cmp_eq_u32 s22, 0
s_cbranch_scc1 K2_X2
s_lshl_b32 s27, s22, 1
s_sub_u32 s27, s27, 1
.p2align 6
K2_CC:
s_waitcnt lgkmcnt(4)
v_mfma_f32_16x16x32_bf16 a[0:3], a[128:131], v[112:115], a[0:3]
ds_read_b128 a[176:179], v2 offset:6144
v_exp_f32 v80, v80
v_mfma_f32_16x16x32_bf16 a[32:35], a[128:131], v[116:119], a[32:35]
s_add_u32 m0, s26, s48
v_exp_f32 v81, v81
v_mfma_f32_16x16x32_bf16 a[64:67], a[128:131], v[120:123], a[64:67]
global_load_lds_dwordx4 v1, s[86:87] offset:0 sc1
v_add_u32 v3, s25, v1
v_mfma_f32_16x16x32_bf16 a[96:99], a[128:131], v[124:127], a[96:99]
v_exp_f32 v82, v82
v_mfma_f32_16x16x32_bf16 a[4:7], a[136:139], v[112:115], a[4:7]
ds_read_b128 a[184:187], v2 offset:7168
v_add_f32 v8, v8, v12
v_mfma_f32_16x16x32_bf16 a[36:39], a[136:139], v[116:119], a[36:39]
global_load_lds_dwordx4 v1, s[86:87] offset:1024 sc1
v_exp_f32 v83, v83
v_mfma_f32_16x16x32_bf16 a[68:71], a[136:139], v[120:123], a[68:71]
s_add_u32 s86, s86, 8192
s_addc_u32 s87, s87, 0
v_add_f32 v9, v9, v13
v_mfma_f32_16x16x32_bf16 a[100:103], a[136:139], v[124:127], a[100:103]
s_waitcnt lgkmcnt(4)
v_exp_f32 v84, v84
v_mfma_f32_16x16x32_bf16 a[8:11], a[144:147], v[112:115], a[8:11]
s_add_u32 m0, s26, s58
v_exp_f32 v85, v85
v_mfma_f32_16x16x32_bf16 a[40:43], a[144:147], v[116:119], a[40:43]
global_load_lds_dwordx4 v1, s[84:85] offset:0 sc1
v_add_f32 v10, v10, v14
v_mfma_f32_16x16x32_bf16 a[72:75], a[144:147], v[120:123], a[72:75]
ds_read_b128 a[132:135], v2 offset:16384
v_add_f32 v11, v11, v15
v_mfma_f32_16x16x32_bf16 a[104:107], a[144:147], v[124:127], a[104:107]
v_exp_f32 v86, v86
v_add_f32 v12, v80, v81
v_mfma_f32_16x16x32_bf16 a[12:15], a[152:155], v[112:115], a[12:15]
global_load_lds_dwordx4 v1, s[84:85] offset:1024 sc1
v_cvt_pk_bf16_f32 v128, v80, v81
v_mfma_f32_16x16x32_bf16 a[44:47], a[152:155], v[116:119], a[44:47]
s_add_u32 s84, s84, 8192
s_addc_u32 s85, s85, 0
v_add_f32 v12, v12, v82
v_mfma_f32_16x16x32_bf16 a[76:79], a[152:155], v[120:123], a[76:79]
ds_read_b128 a[140:143], v2 offset:18432
v_add_f32 v12, v12, v83
v_mfma_f32_16x16x32_bf16 a[108:111], a[152:155], v[124:127], a[108:111]
s_waitcnt lgkmcnt(4)
v_exp_f32 v87, v87
v_mfma_f32_16x16x32_bf16 a[16:19], a[160:163], v[112:115], a[16:19]
s_add_u32 s25, s25, 32768
v_exp_f32 v88, v88
v_mfma_f32_16x16x32_bf16 a[48:51], a[160:163], v[116:119], a[48:51]
s_and_b32 s25, s25, 0x1ffff
v_exp_f32 v89, v89
v_cvt_pk_bf16_f32 v129, v82, v83
v_mfma_f32_16x16x32_bf16 a[80:83], a[160:163], v[120:123], a[80:83]
ds_read_b128 a[148:151], v2 offset:20480
v_add_f32 v13, v84, v85
v_mfma_f32_16x16x32_bf16 a[112:115], a[160:163], v[124:127], a[112:115]
s_add_u32 s26, s26, 32768
v_exp_f32 v90, v90
v_mfma_f32_16x16x32_bf16 a[20:23], a[168:171], v[112:115], a[20:23]
s_and_b32 s26, s26, 0x1ffff
v_exp_f32 v91, v91
v_mfma_f32_16x16x32_bf16 a[52:55], a[168:171], v[116:119], a[52:55]
s_add_u32 s28, s28, 8192
v_exp_f32 v92, v92
v_mfma_f32_16x16x32_bf16 a[84:87], a[168:171], v[120:123], a[84:87]
ds_read_b128 a[156:159], v2 offset:22528
v_cvt_pk_bf16_f32 v132, v84, v85
v_mfma_f32_16x16x32_bf16 a[116:119], a[168:171], v[124:127], a[116:119]
s_waitcnt lgkmcnt(4)
v_exp_f32 v93, v93
v_add_f32 v13, v13, v86
v_mfma_f32_16x16x32_bf16 a[24:27], a[176:179], v[112:115], a[24:27]
s_mov_b32 s29, -4096
v_exp_f32 v94, v94
v_mfma_f32_16x16x32_bf16 a[56:59], a[176:179], v[116:119], a[56:59]
v_exp_f32 v95, v95
v_mfma_f32_16x16x32_bf16 a[88:91], a[176:179], v[120:123], a[88:91]
ds_read_b128 a[164:167], v2 offset:17408
v_add_f32 v13, v13, v87
v_mfma_f32_16x16x32_bf16 a[120:123], a[176:179], v[124:127], a[120:123]
v_exp_f32 v96, v96
v_mfma_f32_16x16x32_bf16 a[28:31], a[184:187], v[112:115], a[28:31]
v_exp_f32 v97, v97
v_mfma_f32_16x16x32_bf16 a[60:63], a[184:187], v[116:119], a[60:63]
v_exp_f32 v98, v98
v_cvt_pk_bf16_f32 v133, v86, v87
v_mfma_f32_16x16x32_bf16 a[92:95], a[184:187], v[120:123], a[92:95]
ds_read_b128 a[172:175], v2 offset:19456
v_add_f32 v14, v88, v89
v_mfma_f32_16x16x32_bf16 a[124:127], a[184:187], v[124:127], a[124:127]
s_waitcnt lgkmcnt(2)
v_exp_f32 v99, v99
v_mfma_f32_16x16x32_bf16 v[48:51], a[132:135], v[176:179], v[20:23]
v_exp_f32 v100, v100
v_mfma_f32_16x16x32_bf16 v[48:51], a[140:143], v[180:183], v[48:51]
v_exp_f32 v101, v101
v_mfma_f32_16x16x32_bf16 v[48:51], a[148:151], v[184:187], v[48:51]
ds_read_b128 a[180:183], v2 offset:21504
v_exp_f32 v102, v102
v_mfma_f32_16x16x32_bf16 v[48:51], a[156:159], v[188:191], v[48:51]
v_exp_f32 v103, v103
v_mfma_f32_16x16x32_bf16 v[52:55], a[132:135], v[192:195], v[24:27]
v_exp_f32 v104, v104
v_mfma_f32_16x16x32_bf16 v[52:55], a[140:143], v[196:199], v[52:55]
s_waitcnt vmcnt(4)
s_barrier
v_cvt_pk_bf16_f32 v136, v88, v89
v_mfma_f32_16x16x32_bf16 v[52:55], a[148:151], v[200:203], v[52:55]
ds_read_b128 a[188:191], v2 offset:23552
v_add_f32 v14, v14, v90
v_mfma_f32_16x16x32_bf16 v[52:55], a[156:159], v[204:207], v[52:55]
v_exp_f32 v105, v105
v_mfma_f32_16x16x32_bf16 v[56:59], a[132:135], v[208:211], v[28:31]
ds_read_b128 a[128:131], v3 offset:0
v_exp_f32 v106, v106
v_mfma_f32_16x16x32_bf16 v[56:59], a[140:143], v[212:215], v[56:59]
v_exp_f32 v107, v107
v_mfma_f32_16x16x32_bf16 v[56:59], a[148:151], v[216:219], v[56:59]
v_exp_f32 v108, v108
v_mfma_f32_16x16x32_bf16 v[56:59], a[156:159], v[220:223], v[56:59]
v_exp_f32 v109, v109
v_mfma_f32_16x16x32_bf16 v[60:63], a[132:135], v[224:227], v[32:35]
ds_read_b128 a[136:139], v3 offset:1024
v_add_f32 v14, v14, v91
v_mfma_f32_16x16x32_bf16 v[60:63], a[140:143], v[228:231], v[60:63]
v_exp_f32 v110, v110
v_mfma_f32_16x16x32_bf16 v[60:63], a[148:151], v[232:235], v[60:63]
v_exp_f32 v111, v111
v_cvt_pk_bf16_f32 v137, v90, v91
v_mfma_f32_16x16x32_bf16 v[60:63], a[156:159], v[236:239], v[60:63]
s_waitcnt lgkmcnt(2)
v_add_f32 v15, v92, v93
v_cvt_pk_bf16_f32 v140, v92, v93
v_mfma_f32_16x16x32_bf16 v[64:67], a[164:167], v[176:179], v[20:23]
ds_read_b128 a[144:147], v3 offset:2048
v_add_f32 v15, v15, v94
v_mfma_f32_16x16x32_bf16 v[64:67], a[172:175], v[180:183], v[64:67]
v_add_f32 v15, v15, v95
v_cvt_pk_bf16_f32 v141, v94, v95
v_mfma_f32_16x16x32_bf16 v[64:67], a[180:183], v[184:187], v[64:67]
v_add_f32 v12, v12, v96
v_add_f32 v12, v12, v97
v_mfma_f32_16x16x32_bf16 v[64:67], a[188:191], v[188:191], v[64:67]
v_cvt_pk_bf16_f32 v130, v96, v97
v_add_f32 v12, v12, v98
v_mfma_f32_16x16x32_bf16 v[68:71], a[164:167], v[192:195], v[24:27]
ds_read_b128 a[152:155], v3 offset:3072
v_add_f32 v12, v12, v99
v_cvt_pk_bf16_f32 v131, v98, v99
v_mfma_f32_16x16x32_bf16 v[68:71], a[172:175], v[196:199], v[68:71]
v_add_f32 v13, v13, v100
v_add_f32 v13, v13, v101
v_mfma_f32_16x16x32_bf16 v[68:71], a[180:183], v[200:203], v[68:71]
v_add_f32 v13, v13, v102
v_add_f32 v13, v13, v103
v_mfma_f32_16x16x32_bf16 v[68:71], a[188:191], v[204:207], v[68:71]
v_add_f32 v14, v14, v104
v_add_f32 v14, v14, v105
v_mfma_f32_16x16x32_bf16 v[72:75], a[164:167], v[208:211], v[28:31]
ds_read_b128 a[160:163], v3 offset:4096
v_add_f32 v14, v14, v106
v_mfma_f32_16x16x32_bf16 v[72:75], a[172:175], v[212:215], v[72:75]
v_add_f32 v14, v14, v107
v_add_f32 v15, v15, v108
v_mfma_f32_16x16x32_bf16 v[72:75], a[180:183], v[216:219], v[72:75]
v_add_f32 v15, v15, v109
v_add_f32 v15, v15, v110
v_add_f32 v15, v15, v111
v_mfma_f32_16x16x32_bf16 v[72:75], a[188:191], v[220:223], v[72:75]
v_max3_f32 v16, v12, v13, v14
v_max_f32 v16, v16, v15
v_mfma_f32_16x16x32_bf16 v[76:79], a[164:167], v[224:227], v[32:35]
ds_read_b128 a[168:171], v3 offset:5120
v_cmp_nge_f32 vcc, 0x53800000, v16
v_mfma_f32_16x16x32_bf16 v[76:79], a[172:175], v[228:231], v[76:79]
v_cvt_pk_bf16_f32 v134, v100, v101
v_cvt_pk_bf16_f32 v135, v102, v103
v_mfma_f32_16x16x32_bf16 v[76:79], a[180:183], v[232:235], v[76:79]
v_cvt_pk_bf16_f32 v138, v104, v105
v_cvt_pk_bf16_f32 v139, v106, v107
v_mfma_f32_16x16x32_bf16 v[76:79], a[188:191], v[236:239], v[76:79]
s_cbranch_vccnz K2_S_CCa
K2_R_CCa:
v_cvt_pk_bf16_f32 v142, v108, v109
v_cvt_pk_bf16_f32 v143, v110, v111
s_waitcnt lgkmcnt(4)
v_mfma_f32_16x16x32_bf16 a[0:3], a[128:131], v[128:131], a[0:3]
ds_read_b128 a[176:179], v3 offset:6144
v_exp_f32 v48, v48
v_mfma_f32_16x16x32_bf16 a[32:35], a[128:131], v[132:135], a[32:35]
s_add_u32 m0, s26, s48
v_exp_f32 v49, v49
v_mfma_f32_16x16x32_bf16 a[64:67], a[128:131], v[136:139], a[64:67]
global_load_lds_dwordx4 v1, s[86:87] offset:0 sc1
v_add_u32 v2, s25, v1
v_mfma_f32_16x16x32_bf16 a[96:99], a[128:131], v[140:143], a[96:99]
v_exp_f32 v50, v50
v_mfma_f32_16x16x32_bf16 a[4:7], a[136:139], v[128:131], a[4:7]
ds_read_b128 a[184:187], v3 offset:7168
v_add_f32 v8, v8, v12
v_mfma_f32_16x16x32_bf16 a[36:39], a[136:139], v[132:135], a[36:39]
global_load_lds_dwordx4 v1, s[86:87] offset:1024 sc1
v_exp_f32 v51, v51
v_mfma_f32_16x16x32_bf16 a[68:71], a[136:139], v[136:139], a[68:71]
s_add_u32 s86, s86, 8192
s_addc_u32 s87, s87, 0
v_add_f32 v9, v9, v13
v_mfma_f32_16x16x32_bf16 a[100:103], a[136:139], v[140:143], a[100:103]
s_waitcnt lgkmcnt(4)
v_exp_f32 v52, v52
v_mfma_f32_16x16x32_bf16 a[8:11], a[144:147], v[128:131], a[8:11]
s_add_u32 m0, s26, s58
v_exp_f32 v53, v53
v_mfma_f32_16x16x32_bf16 a[40:43], a[144:147], v[132:135], a[40:43]
global_load_lds_dwordx4 v1, s[84:85] offset:0 sc1
v_add_f32 v10, v10, v14
v_mfma_f32_16x16x32_bf16 a[72:75], a[144:147], v[136:139], a[72:75]
ds_read_b128 a[132:135], v3 offset:16384
v_add_f32 v11, v11, v15
v_mfma_f32_16x16x32_bf16 a[104:107], a[144:147], v[140:143], a[104:107]
v_exp_f32 v54, v54
v_add_f32 v12, v48, v49
v_mfma_f32_16x16x32_bf16 a[12:15], a[152:155], v[128:131], a[12:15]
global_load_lds_dwordx4 v1, s[84:85] offset:1024 sc1
v_cvt_pk_bf16_f32 v112, v48, v49
v_mfma_f32_16x16x32_bf16 a[44:47], a[152:155], v[132:135], a[44:47]
s_add_u32 s84, s84, 8192
s_addc_u32 s85, s85, 0
v_add_f32 v12, v12, v50
v_mfma_f32_16x16x32_bf16 a[76:79], a[152:155], v[136:139], a[76:79]
ds_read_b128 a[140:143], v3 offset:18432
v_add_f32 v12, v12, v51
v_mfma_f32_16x16x32_bf16 a[108:111], a[152:155], v[140:143], a[108:111]
s_waitcnt lgkmcnt(4)
v_exp_f32 v55, v55
v_mfma_f32_16x16x32_bf16 a[16:19], a[160:163], v[128:131], a[16:19]
s_add_u32 s25, s25, 32768
v_exp_f32 v56, v56
v_mfma_f32_16x16x32_bf16 a[48:51], a[160:163], v[132:135], a[48:51]
s_and_b32 s25, s25, 0x1ffff
v_exp_f32 v57, v57
v_cvt_pk_bf16_f32 v113, v50, v51
v_mfma_f32_16x16x32_bf16 a[80:83], a[160:163], v[136:139], a[80:83]
ds_read_b128 a[148:151], v3 offset:20480
v_add_f32 v13, v52, v53
v_mfma_f32_16x16x32_bf16 a[112:115], a[160:163], v[140:143], a[112:115]
s_add_u32 s26, s26, 32768
v_exp_f32 v58, v58
v_mfma_f32_16x16x32_bf16 a[20:23], a[168:171], v[128:131], a[20:23]
s_and_b32 s26, s26, 0x1ffff
v_exp_f32 v59, v59
v_mfma_f32_16x16x32_bf16 a[52:55], a[168:171], v[132:135], a[52:55]
s_add_u32 s28, s28, 8192
v_exp_f32 v60, v60
v_mfma_f32_16x16x32_bf16 a[84:87], a[168:171], v[136:139], a[84:87]
ds_read_b128 a[156:159], v3 offset:22528
v_cvt_pk_bf16_f32 v116, v52, v53
v_mfma_f32_16x16x32_bf16 a[116:119], a[168:171], v[140:143], a[116:119]
s_waitcnt lgkmcnt(4)
v_exp_f32 v61, v61
v_add_f32 v13, v13, v54
v_mfma_f32_16x16x32_bf16 a[24:27], a[176:179], v[128:131], a[24:27]
s_mov_b32 s29, -4096
v_exp_f32 v62, v62
v_mfma_f32_16x16x32_bf16 a[56:59], a[176:179], v[132:135], a[56:59]
v_exp_f32 v63, v63
v_mfma_f32_16x16x32_bf16 a[88:91], a[176:179], v[136:139], a[88:91]
ds_read_b128 a[164:167], v3 offset:17408
v_add_f32 v13, v13, v55
v_mfma_f32_16x16x32_bf16 a[120:123], a[176:179], v[140:143], a[120:123]
v_exp_f32 v64, v64
v_mfma_f32_16x16x32_bf16 a[28:31], a[184:187], v[128:131], a[28:31]
v_exp_f32 v65, v65
v_mfma_f32_16x16x32_bf16 a[60:63], a[184:187], v[132:135], a[60:63]
v_exp_f32 v66, v66
v_cvt_pk_bf16_f32 v117, v54, v55
v_mfma_f32_16x16x32_bf16 a[92:95], a[184:187], v[136:139], a[92:95]
ds_read_b128 a[172:175], v3 offset:19456
v_add_f32 v14, v56, v57
v_mfma_f32_16x16x32_bf16 a[124:127], a[184:187], v[140:143], a[124:127]
s_waitcnt lgkmcnt(2)
v_exp_f32 v67, v67
v_mfma_f32_16x16x32_bf16 v[80:83], a[132:135], v[176:179], v[20:23]
v_exp_f32 v68, v68
v_mfma_f32_16x16x32_bf16 v[80:83], a[140:143], v[180:183], v[80:83]
v_exp_f32 v69, v69
v_mfma_f32_16x16x32_bf16 v[80:83], a[148:151], v[184:187], v[80:83]
ds_read_b128 a[180:183], v3 offset:21504
v_exp_f32 v70, v70
v_mfma_f32_16x16x32_bf16 v[80:83], a[156:159], v[188:191], v[80:83]
v_exp_f32 v71, v71
v_mfma_f32_16x16x32_bf16 v[84:87], a[132:135], v[192:195], v[24:27]
v_exp_f32 v72, v72
v_mfma_f32_16x16x32_bf16 v[84:87], a[140:143], v[196:199], v[84:87]
s_waitcnt vmcnt(4)
s_barrier
v_cvt_pk_bf16_f32 v120, v56, v57
v_mfma_f32_16x16x32_bf16 v[84:87], a[148:151], v[200:203], v[84:87]
ds_read_b128 a[188:191], v3 offset:23552
v_add_f32 v14, v14, v58
v_mfma_f32_16x16x32_bf16 v[84:87], a[156:159], v[204:207], v[84:87]
v_exp_f32 v73, v73
v_mfma_f32_16x16x32_bf16 v[88:91], a[132:135], v[208:211], v[28:31]
ds_read_b128 a[128:131], v2 offset:0
v_exp_f32 v74, v74
v_mfma_f32_16x16x32_bf16 v[88:91], a[140:143], v[212:215], v[88:91]
v_exp_f32 v75, v75
v_mfma_f32_16x16x32_bf16 v[88:91], a[148:151], v[216:219], v[88:91]
v_exp_f32 v76, v76
v_mfma_f32_16x16x32_bf16 v[88:91], a[156:159], v[220:223], v[88:91]
v_exp_f32 v77, v77
v_mfma_f32_16x16x32_bf16 v[92:95], a[132:135], v[224:227], v[32:35]
ds_read_b128 a[136:139], v2 offset:1024
v_add_f32 v14, v14, v59
v_mfma_f32_16x16x32_bf16 v[92:95], a[140:143], v[228:231], v[92:95]
v_exp_f32 v78, v78
v_mfma_f32_16x16x32_bf16 v[92:95], a[148:151], v[232:235], v[92:95]
v_exp_f32 v79, v79
v_cvt_pk_bf16_f32 v121, v58, v59
v_mfma_f32_16x16x32_bf16 v[92:95], a[156:159], v[236:239], v[92:95]
s_waitcnt lgkmcnt(2)
v_add_f32 v15, v60, v61
v_cvt_pk_bf16_f32 v124, v60, v61
v_mfma_f32_16x16x32_bf16 v[96:99], a[164:167], v[176:179], v[20:23]
ds_read_b128 a[144:147], v2 offset:2048
v_add_f32 v15, v15, v62
v_mfma_f32_16x16x32_bf16 v[96:99], a[172:175], v[180:183], v[96:99]
v_add_f32 v15, v15, v63
v_cvt_pk_bf16_f32 v125, v62, v63
v_mfma_f32_16x16x32_bf16 v[96:99], a[180:183], v[184:187], v[96:99]
v_add_f32 v12, v12, v64
v_add_f32 v12, v12, v65
v_mfma_f32_16x16x32_bf16 v[96:99], a[188:191], v[188:191], v[96:99]
v_cvt_pk_bf16_f32 v114, v64, v65
v_add_f32 v12, v12, v66
v_mfma_f32_16x16x32_bf16 v[100:103], a[164:167], v[192:195], v[24:27]
ds_read_b128 a[152:155], v2 offset:3072
v_add_f32 v12, v12, v67
v_cvt_pk_bf16_f32 v115, v66, v67
v_mfma_f32_16x16x32_bf16 v[100:103], a[172:175], v[196:199], v[100:103]
v_add_f32 v13, v13, v68
v_add_f32 v13, v13, v69
v_mfma_f32_16x16x32_bf16 v[100:103], a[180:183], v[200:203], v[100:103]
v_add_f32 v13, v13, v70
v_add_f32 v13, v13, v71
v_mfma_f32_16x16x32_bf16 v[100:103], a[188:191], v[204:207], v[100:103]
v_add_f32 v14, v14, v72
v_add_f32 v14, v14, v73
v_mfma_f32_16x16x32_bf16 v[104:107], a[164:167], v[208:211], v[28:31]
ds_read_b128 a[160:163], v2 offset:4096
v_add_f32 v14, v14, v74
v_mfma_f32_16x16x32_bf16 v[104:107], a[172:175], v[212:215], v[104:107]
v_add_f32 v14, v14, v75
v_add_f32 v15, v15, v76
v_mfma_f32_16x16x32_bf16 v[104:107], a[180:183], v[216:219], v[104:107]
v_add_f32 v15, v15, v77
v_add_f32 v15, v15, v78
v_add_f32 v15, v15, v79
v_mfma_f32_16x16x32_bf16 v[104:107], a[188:191], v[220:223], v[104:107]
v_max3_f32 v16, v12, v13, v14
v_max_f32 v16, v16, v15
v_mfma_f32_16x16x32_bf16 v[108:111], a[164:167], v[224:227], v[32:35]
ds_read_b128 a[168:171], v2 offset:5120
v_cmp_nge_f32 vcc, 0x53800000, v16
v_mfma_f32_16x16x32_bf16 v[108:111], a[172:175], v[228:231], v[108:111]
v_cvt_pk_bf16_f32 v118, v68, v69
v_cvt_pk_bf16_f32 v119, v70, v71
v_mfma_f32_16x16x32_bf16 v[108:111], a[180:183], v[232:235], v[108:111]
v_cvt_pk_bf16_f32 v122, v72, v73
v_cvt_pk_bf16_f32 v123, v74, v75
v_mfma_f32_16x16x32_bf16 v[108:111], a[188:191], v[236:239], v[108:111]
s_cbranch_vccnz K2_S_CCb
K2_R_CCb:
v_cvt_pk_bf16_f32 v126, v76, v77
v_cvt_pk_bf16_f32 v127, v78, v79
s_sub_u32 s27, s27, 1
s_cmp_lg_u32 s27, 0
s_cbranch_scc1 K2_CC
s_waitcnt lgkmcnt(4)
v_mfma_f32_16x16x32_bf16 a[0:3], a[128:131], v[112:115], a[0:3]
ds_read_b128 a[176:179], v2 offset:6144
v_exp_f32 v80, v80
v_mfma_f32_16x16x32_bf16 a[32:35], a[128:131], v[116:119], a[32:35]
s_add_u32 m0, s26, s48
v_exp_f32 v81, v81
v_mfma_f32_16x16x32_bf16 a[64:67], a[128:131], v[120:123], a[64:67]
global_load_lds_dwordx4 v1, s[86:87] offset:0 sc1
v_add_u32 v3, s25, v1
v_mfma_f32_16x16x32_bf16 a[96:99], a[128:131], v[124:127], a[96:99]
v_exp_f32 v82, v82
v_mfma_f32_16x16x32_bf16 a[4:7], a[136:139], v[112:115], a[4:7]
ds_read_b128 a[184:187], v2 offset:7168
v_add_f32 v8, v8, v12
v_mfma_f32_16x16x32_bf16 a[36:39], a[136:139], v[116:119], a[36:39]
global_load_lds_dwordx4 v1, s[86:87] offset:1024 sc1
v_exp_f32 v83, v83
v_mfma_f32_16x16x32_bf16 a[68:71], a[136:139], v[120:123], a[68:71]
s_add_u32 s86, s86, 8192
s_addc_u32 s87, s87, 0
v_add_f32 v9, v9, v13
v_mfma_f32_16x16x32_bf16 a[100:103], a[136:139], v[124:127], a[100:103]
s_waitcnt lgkmcnt(4)
v_exp_f32 v84, v84
v_mfma_f32_16x16x32_bf16 a[8:11], a[144:147], v[112:115], a[8:11]
s_add_u32 m0, s26, s58
v_exp_f32 v85, v85
v_mfma_f32_16x16x32_bf16 a[40:43], a[144:147], v[116:119], a[40:43]
global_load_lds_dwordx4 v1, s[84:85] offset:0 sc1
v_add_f32 v10, v10, v14
v_mfma_f32_16x16x32_bf16 a[72:75], a[144:147], v[120:123], a[72:75]
ds_read_b128 a[132:135], v2 offset:16384
v_add_f32 v11, v11, v15
v_mfma_f32_16x16x32_bf16 a[104:107], a[144:147], v[124:127], a[104:107]
v_exp_f32 v86, v86
v_add_f32 v12, v80, v81
v_mfma_f32_16x16x32_bf16 a[12:15], a[152:155], v[112:115], a[12:15]
global_load_lds_dwordx4 v1, s[84:85] offset:1024 sc1
v_cvt_pk_bf16_f32 v128, v80, v81
v_mfma_f32_16x16x32_bf16 a[44:47], a[152:155], v[116:119], a[44:47]
s_add_u32 s84, s84, 8192
s_addc_u32 s85, s85, 0
v_add_f32 v12, v12, v82
v_mfma_f32_16x16x32_bf16 a[76:79], a[152:155], v[120:123], a[76:79]
ds_read_b128 a[140:143], v2 offset:18432
v_add_f32 v12, v12, v83
v_mfma_f32_16x16x32_bf16 a[108:111], a[152:155], v[124:127], a[108:111]
s_waitcnt lgkmcnt(4)
v_exp_f32 v87, v87
v_mfma_f32_16x16x32_bf16 a[16:19], a[160:163], v[112:115], a[16:19]
s_add_u32 s25, s25, 32768
v_exp_f32 v88, v88
v_mfma_f32_16x16x32_bf16 a[48:51], a[160:163], v[116:119], a[48:51]
s_and_b32 s25, s25, 0x1ffff
v_exp_f32 v89, v89
v_cvt_pk_bf16_f32 v129, v82, v83
v_mfma_f32_16x16x32_bf16 a[80:83], a[160:163], v[120:123], a[80:83]
ds_read_b128 a[148:151], v2 offset:20480
v_add_f32 v13, v84, v85
v_mfma_f32_16x16x32_bf16 a[112:115], a[160:163], v[124:127], a[112:115]
s_add_u32 s26, s26, 32768
v_exp_f32 v90, v90
v_mfma_f32_16x16x32_bf16 a[20:23], a[168:171], v[112:115], a[20:23]
s_and_b32 s26, s26, 0x1ffff
v_exp_f32 v91, v91
v_mfma_f32_16x16x32_bf16 a[52:55], a[168:171], v[116:119], a[52:55]
s_add_u32 s28, s28, 8192
v_exp_f32 v92, v92
v_mfma_f32_16x16x32_bf16 a[84:87], a[168:171], v[120:123], a[84:87]
ds_read_b128 a[156:159], v2 offset:22528
v_cvt_pk_bf16_f32 v132, v84, v85
v_mfma_f32_16x16x32_bf16 a[116:119], a[168:171], v[124:127], a[116:119]
s_waitcnt lgkmcnt(4)
v_exp_f32 v93, v93
v_add_f32 v13, v13, v86
v_mfma_f32_16x16x32_bf16 a[24:27], a[176:179], v[112:115], a[24:27]
s_mov_b32 s29, -4096
v_exp_f32 v94, v94
v_mfma_f32_16x16x32_bf16 a[56:59], a[176:179], v[116:119], a[56:59]
v_exp_f32 v95, v95
v_mfma_f32_16x16x32_bf16 a[88:91], a[176:179], v[120:123], a[88:91]
ds_read_b128 a[164:167], v2 offset:17408
v_add_f32 v13, v13, v87
v_mfma_f32_16x16x32_bf16 a[120:123], a[176:179], v[124:127], a[120:123]
v_exp_f32 v96, v96
v_mfma_f32_16x16x32_bf16 a[28:31], a[184:187], v[112:115], a[28:31]
v_exp_f32 v97, v97
v_mfma_f32_16x16x32_bf16 a[60:63], a[184:187], v[116:119], a[60:63]
v_exp_f32 v98, v98
v_cvt_pk_bf16_f32 v133, v86, v87
v_mfma_f32_16x16x32_bf16 a[92:95], a[184:187], v[120:123], a[92:95]
ds_read_b128 a[172:175], v2 offset:19456
v_add_f32 v14, v88, v89
v_mfma_f32_16x16x32_bf16 a[124:127], a[184:187], v[124:127], a[124:127]
s_waitcnt lgkmcnt(2)
v_exp_f32 v99, v99
v_mfma_f32_16x16x32_bf16 v[48:51], a[132:135], v[176:179], v[20:23]
v_exp_f32 v100, v100
v_mfma_f32_16x16x32_bf16 v[48:51], a[140:143], v[180:183], v[48:51]
v_exp_f32 v101, v101
v_mfma_f32_16x16x32_bf16 v[48:51], a[148:151], v[184:187], v[48:51]
ds_read_b128 a[180:183], v2 offset:21504
v_exp_f32 v102, v102
v_mfma_f32_16x16x32_bf16 v[48:51], a[156:159], v[188:191], v[48:51]
v_exp_f32 v103, v103
v_mfma_f32_16x16x32_bf16 v[52:55], a[132:135], v[192:195], v[24:27]
v_exp_f32 v104, v104
v_mfma_f32_16x16x32_bf16 v[52:55], a[140:143], v[196:199], v[52:55]
s_waitcnt vmcnt(4)
s_barrier
v_cvt_pk_bf16_f32 v136, v88, v89
v_mfma_f32_16x16x32_bf16 v[52:55], a[148:151], v[200:203], v[52:55]
ds_read_b128 a[188:191], v2 offset:23552
v_add_f32 v14, v14, v90
v_mfma_f32_16x16x32_bf16 v[52:55], a[156:159], v[204:207], v[52:55]
v_exp_f32 v105, v105
v_mfma_f32_16x16x32_bf16 v[56:59], a[132:135], v[208:211], v[28:31]
ds_read_b128 a[128:131], v3 offset:0
v_exp_f32 v106, v106
v_mfma_f32_16x16x32_bf16 v[56:59], a[140:143], v[212:215], v[56:59]
v_exp_f32 v107, v107
v_mfma_f32_16x16x32_bf16 v[56:59], a[148:151], v[216:219], v[56:59]
v_exp_f32 v108, v108
v_mfma_f32_16x16x32_bf16 v[56:59], a[156:159], v[220:223], v[56:59]
v_exp_f32 v109, v109
v_mfma_f32_16x16x32_bf16 v[60:63], a[132:135], v[224:227], v[32:35]
ds_read_b128 a[136:139], v3 offset:1024
v_add_f32 v14, v14, v91
v_mfma_f32_16x16x32_bf16 v[60:63], a[140:143], v[228:231], v[60:63]
v_exp_f32 v110, v110
v_mfma_f32_16x16x32_bf16 v[60:63], a[148:151], v[232:235], v[60:63]
v_exp_f32 v111, v111
v_cvt_pk_bf16_f32 v137, v90, v91
v_mfma_f32_16x16x32_bf16 v[60:63], a[156:159], v[236:239], v[60:63]
s_waitcnt lgkmcnt(2)
v_add_f32 v15, v92, v93
v_cvt_pk_bf16_f32 v140, v92, v93
v_mfma_f32_16x16x32_bf16 v[64:67], a[164:167], v[176:179], v[20:23]
ds_read_b128 a[144:147], v3 offset:2048
v_add_f32 v15, v15, v94
v_mfma_f32_16x16x32_bf16 v[64:67], a[172:175], v[180:183], v[64:67]
v_add_f32 v15, v15, v95
v_cvt_pk_bf16_f32 v141, v94, v95
v_mfma_f32_16x16x32_bf16 v[64:67], a[180:183], v[184:187], v[64:67]
v_add_f32 v12, v12, v96
v_add_f32 v12, v12, v97
v_mfma_f32_16x16x32_bf16 v[64:67], a[188:191], v[188:191], v[64:67]
v_cvt_pk_bf16_f32 v130, v96, v97
v_add_f32 v12, v12, v98
v_mfma_f32_16x16x32_bf16 v[68:71], a[164:167], v[192:195], v[24:27]
ds_read_b128 a[152:155], v3 offset:3072
v_add_f32 v12, v12, v99
v_cvt_pk_bf16_f32 v131, v98, v99
v_mfma_f32_16x16x32_bf16 v[68:71], a[172:175], v[196:199], v[68:71]
v_add_f32 v13, v13, v100
v_add_f32 v13, v13, v101
v_mfma_f32_16x16x32_bf16 v[68:71], a[180:183], v[200:203], v[68:71]
v_add_f32 v13, v13, v102
v_add_f32 v13, v13, v103
v_mfma_f32_16x16x32_bf16 v[68:71], a[188:191], v[204:207], v[68:71]
v_add_f32 v14, v14, v104
v_add_f32 v14, v14, v105
v_mfma_f32_16x16x32_bf16 v[72:75], a[164:167], v[208:211], v[28:31]
ds_read_b128 a[160:163], v3 offset:4096
v_add_f32 v14, v14, v106
v_mfma_f32_16x16x32_bf16 v[72:75], a[172:175], v[212:215], v[72:75]
v_add_f32 v14, v14, v107
v_add_f32 v15, v15, v108
v_mfma_f32_16x16x32_bf16 v[72:75], a[180:183], v[216:219], v[72:75]
v_add_f32 v15, v15, v109
v_add_f32 v15, v15, v110
v_add_f32 v15, v15, v111
v_mfma_f32_16x16x32_bf16 v[72:75], a[188:191], v[220:223], v[72:75]
v_max3_f32 v16, v12, v13, v14
v_max_f32 v16, v16, v15
v_mfma_f32_16x16x32_bf16 v[76:79], a[164:167], v[224:227], v[32:35]
ds_read_b128 a[168:171], v3 offset:5120
v_cmp_nge_f32 vcc, 0x53800000, v16
v_mfma_f32_16x16x32_bf16 v[76:79], a[172:175], v[228:231], v[76:79]
v_cvt_pk_bf16_f32 v134, v100, v101
v_cvt_pk_bf16_f32 v135, v102, v103
v_mfma_f32_16x16x32_bf16 v[76:79], a[180:183], v[232:235], v[76:79]
v_cvt_pk_bf16_f32 v138, v104, v105
v_cvt_pk_bf16_f32 v139, v106, v107
v_mfma_f32_16x16x32_bf16 v[76:79], a[188:191], v[236:239], v[76:79]
s_cbranch_vccnz K2_S_X1a
K2_R_X1a:
v_cvt_pk_bf16_f32 v142, v108, v109
v_cvt_pk_bf16_f32 v143, v110, v111
s_waitcnt lgkmcnt(4)
v_mfma_f32_16x16x32_bf16 a[0:3], a[128:131], v[128:131], a[0:3]
ds_read_b128 a[176:179], v3 offset:6144
v_add_u32 v2, s25, v1
v_add_f32 v8, v8, v12
v_mfma_f32_16x16x32_bf16 a[32:35], a[128:131], v[132:135], a[32:35]
s_add_u32 m0, s26, s48
v_add_f32 v9, v9, v13
v_add_f32 v10, v10, v14
v_mfma_f32_16x16x32_bf16 a[64:67], a[128:131], v[136:139], a[64:67]
global_load_lds_dwordx4 v1, s[86:87] offset:0 sc1
v_add_f32 v11, v11, v15
v_mfma_f32_16x16x32_bf16 a[96:99], a[128:131], v[140:143], a[96:99]
s_mov_b32 s29, 0
s_call_b64 s[78:79], K2_MASK_0c
v_mfma_f32_16x16x32_bf16 a[4:7], a[136:139], v[128:131], a[4:7]
ds_read_b128 a[184:187], v3 offset:7168
v_exp_f32 v48, v48
v_mfma_f32_16x16x32_bf16 a[36:39], a[136:139], v[132:135], a[36:39]
global_load_lds_dwordx4 v1, s[86:87] offset:1024 sc1
v_mfma_f32_16x16x32_bf16 a[68:71], a[136:139], v[136:139], a[68:71]
s_add_u32 s86, s86, 8192
s_addc_u32 s87, s87, 0
v_mfma_f32_16x16x32_bf16 a[100:103], a[136:139], v[140:143], a[100:103]
s_waitcnt lgkmcnt(4)
v_exp_f32 v49, v49
v_mfma_f32_16x16x32_bf16 a[8:11], a[144:147], v[128:131], a[8:11]
s_add_u32 m0, s26, s58
v_exp_f32 v50, v50
v_add_f32 v12, v48, v49
v_mfma_f32_16x16x32_bf16 a[40:43], a[144:147], v[132:135], a[40:43]
global_load_lds_dwordx4 v1, s[84:85] offset:0 sc1
v_cvt_pk_bf16_f32 v112, v48, v49
v_mfma_f32_16x16x32_bf16 a[72:75], a[144:147], v[136:139], a[72:75]
ds_read_b128 a[132:135], v3 offset:16384
v_add_f32 v12, v12, v50
v_mfma_f32_16x16x32_bf16 a[104:107], a[144:147], v[140:143], a[104:107]
v_exp_f32 v51, v51
v_mfma_f32_16x16x32_bf16 a[12:15], a[152:155], v[128:131], a[12:15]
global_load_lds_dwordx4 v1, s[84:85] offset:1024 sc1
v_exp_f32 v52, v52
v_mfma_f32_16x16x32_bf16 a[44:47], a[152:155], v[132:135], a[44:47]
s_add_u32 s84, s84, 8192
s_addc_u32 s85, s85, 0
v_add_f32 v12, v12, v51
v_mfma_f32_16x16x32_bf16 a[76:79], a[152:155], v[136:139], a[76:79]
ds_read_b128 a[140:143], v3 offset:18432
v_cvt_pk_bf16_f32 v113, v50, v51
v_mfma_f32_16x16x32_bf16 a[108:111], a[152:155], v[140:143], a[108:111]
s_waitcnt lgkmcnt(4)
v_exp_f32 v53, v53
v_mfma_f32_16x16x32_bf16 a[16:19], a[160:163], v[128:131], a[16:19]
s_add_u32 s25, s25, 32768
v_exp_f32 v54, v54
v_mfma_f32_16x16x32_bf16 a[48:51], a[160:163], v[132:135], a[48:51]
s_and_b32 s25, s25, 0x1ffff
v_exp_f32 v55, v55
v_add_f32 v13, v52, v53
v_mfma_f32_16x16x32_bf16 a[80:83], a[160:163], v[136:139], a[80:83]
ds_read_b128 a[148:151], v3 offset:20480
v_cvt_pk_bf16_f32 v116, v52, v53
v_mfma_f32_16x16x32_bf16 a[112:115], a[160:163], v[140:143], a[112:115]
s_add_u32 s26, s26, 32768
v_exp_f32 v56, v56
v_mfma_f32_16x16x32_bf16 a[20:23], a[168:171], v[128:131], a[20:23]
s_and_b32 s26, s26, 0x1ffff
v_exp_f32 v57, v57
v_mfma_f32_16x16x32_bf16 a[52:55], a[168:171], v[132:135], a[52:55]
s_add_u32 s28, s28, 8192
v_exp_f32 v58, v58
v_add_f32 v13, v13, v54
v_mfma_f32_16x16x32_bf16 a[84:87], a[168:171], v[136:139], a[84:87]
ds_read_b128 a[156:159], v3 offset:22528
v_add_f32 v13, v13, v55
v_mfma_f32_16x16x32_bf16 a[116:119], a[168:171], v[140:143], a[116:119]
s_waitcnt lgkmcnt(4)
v_exp_f32 v59, v59
v_mfma_f32_16x16x32_bf16 a[24:27], a[176:179], v[128:131], a[24:27]
v_exp_f32 v60, v60
v_mfma_f32_16x16x32_bf16 a[56:59], a[176:179], v[132:135], a[56:59]
v_exp_f32 v61, v61
v_cvt_pk_bf16_f32 v117, v54, v55
v_mfma_f32_16x16x32_bf16 a[88:91], a[176:179], v[136:139], a[88:91]
ds_read_b128 a[164:167], v3 offset:17408
v_add_f32 v14, v56, v57
v_mfma_f32_16x16x32_bf16 a[120:123], a[176:179], v[140:143], a[120:123]
v_exp_f32 v62, v62
v_mfma_f32_16x16x32_bf16 a[28:31], a[184:187], v[128:131], a[28:31]
v_exp_f32 v63, v63
v_mfma_f32_16x16x32_bf16 a[60:63], a[184:187], v[132:135], a[60:63]
v_exp_f32 v64, v64
v_cvt_pk_bf16_f32 v120, v56, v57
v_mfma_f32_16x16x32_bf16 a[92:95], a[184:187], v[136:139], a[92:95]
ds_read_b128 a[172:175], v3 offset:19456
v_add_f32 v14, v14, v58
v_mfma_f32_16x16x32_bf16 a[124:127], a[184:187], v[140:143], a[124:127]
s_waitcnt lgkmcnt(2)
v_exp_f32 v65, v65
v_mfma_f32_16x16x32_bf16 v[80:83], a[132:135], v[176:179], v[20:23]
v_exp_f32 v66, v66
v_mfma_f32_16x16x32_bf16 v[80:83], a[140:143], v[180:183], v[80:83]
v_exp_f32 v67, v67
v_mfma_f32_16x16x32_bf16 v[80:83], a[148:151], v[184:187], v[80:83]
ds_read_b128 a[180:183], v3 offset:21504
v_exp_f32 v68, v68
v_mfma_f32_16x16x32_bf16 v[80:83], a[156:159], v[188:191], v[80:83]
v_exp_f32 v69, v69
v_mfma_f32_16x16x32_bf16 v[84:87], a[132:135], v[192:195], v[24:27]
v_exp_f32 v70, v70
v_mfma_f32_16x16x32_bf16 v[84:87], a[140:143], v[196:199], v[84:87]
s_waitcnt vmcnt(4)
s_barrier
v_add_f32 v14, v14, v59
v_mfma_f32_16x16x32_bf16 v[84:87], a[148:151], v[200:203], v[84:87]
ds_read_b128 a[188:191], v3 offset:23552
v_exp_f32 v71, v71
v_mfma_f32_16x16x32_bf16 v[84:87], a[156:159], v[204:207], v[84:87]
v_exp_f32 v72, v72
v_mfma_f32_16x16x32_bf16 v[88:91], a[132:135], v[208:211], v[28:31]
ds_read_b128 a[128:131], v2 offset:0
v_cvt_pk_bf16_f32 v121, v58, v59
v_mfma_f32_16x16x32_bf16 v[88:91], a[140:143], v[212:215], v[88:91]
v_exp_f32 v73, v73
v_mfma_f32_16x16x32_bf16 v[88:91], a[148:151], v[216:219], v[88:91]
v_exp_f32 v74, v74
v_add_f32 v15, v60, v61
v_mfma_f32_16x16x32_bf16 v[88:91], a[156:159], v[220:223], v[88:91]
v_exp_f32 v75, v75
v_mfma_f32_16x16x32_bf16 v[92:95], a[132:135], v[224:227], v[32:35]
ds_read_b128 a[136:139], v2 offset:1024
v_cvt_pk_bf16_f32 v124, v60, v61
v_mfma_f32_16x16x32_bf16 v[92:95], a[140:143], v[228:231], v[92:95]
v_exp_f32 v76, v76
v_mfma_f32_16x16x32_bf16 v[92:95], a[148:151], v[232:235], v[92:95]
v_exp_f32 v77, v77
v_add_f32 v15, v15, v62
v_mfma_f32_16x16x32_bf16 v[92:95], a[156:159], v[236:239], v[92:95]
s_waitcnt lgkmcnt(2)
v_exp_f32 v78, v78
v_mfma_f32_16x16x32_bf16 v[96:99], a[164:167], v[176:179], v[20:23]
ds_read_b128 a[144:147], v2 offset:2048
v_add_f32 v15, v15, v63
v_mfma_f32_16x16x32_bf16 v[96:99], a[172:175], v[180:183], v[96:99]
v_exp_f32 v79, v79
v_mfma_f32_16x16x32_bf16 v[96:99], a[180:183], v[184:187], v[96:99]
v_cvt_pk_bf16_f32 v125, v62, v63
v_add_f32 v12, v12, v64
v_mfma_f32_16x16x32_bf16 v[96:99], a[188:191], v[188:191], v[96:99]
v_add_f32 v12, v12, v65
v_cvt_pk_bf16_f32 v114, v64, v65
v_add_f32 v12, v12, v66
v_mfma_f32_16x16x32_bf16 v[100:103], a[164:167], v[192:195], v[24:27]
ds_read_b128 a[152:155], v2 offset:3072
v_add_f32 v12, v12, v67
v_mfma_f32_16x16x32_bf16 v[100:103], a[172:175], v[196:199], v[100:103]
v_cvt_pk_bf16_f32 v115, v66, v67
v_add_f32 v13, v13, v68
v_mfma_f32_16x16x32_bf16 v[100:103], a[180:183], v[200:203], v[100:103]
v_add_f32 v13, v13, v69
v_add_f32 v13, v13, v70
v_mfma_f32_16x16x32_bf16 v[100:103], a[188:191], v[204:207], v[100:103]
v_add_f32 v13, v13, v71
v_add_f32 v14, v14, v72
v_add_f32 v14, v14, v73
v_mfma_f32_16x16x32_bf16 v[104:107], a[164:167], v[208:211], v[28:31]
ds_read_b128 a[160:163], v2 offset:4096
v_add_f32 v14, v14, v74
v_mfma_f32_16x16x32_bf16 v[104:107], a[172:175], v[212:215], v[104:107]
v_add_f32 v14, v14, v75
v_add_f32 v15, v15, v76
v_mfma_f32_16x16x32_bf16 v[104:107], a[180:183], v[216:219], v[104:107]
v_add_f32 v15, v15, v77
v_add_f32 v15, v15, v78
v_mfma_f32_16x16x32_bf16 v[104:107], a[188:191], v[220:223], v[104:107]
v_add_f32 v15, v15, v79
v_max3_f32 v16, v12, v13, v14
v_max_f32 v16, v16, v15
v_mfma_f32_16x16x32_bf16 v[108:111], a[164:167], v[224:227], v[32:35]
ds_read_b128 a[168:171], v2 offset:5120
v_cmp_nge_f32 vcc, 0x53800000, v16
v_mfma_f32_16x16x32_bf16 v[108:111], a[172:175], v[228:231], v[108:111]
v_cvt_pk_bf16_f32 v118, v68, v69
v_cvt_pk_bf16_f32 v119, v70, v71
v_mfma_f32_16x16x32_bf16 v[108:111], a[180:183], v[232:235], v[108:111]
v_cvt_pk_bf16_f32 v122, v72, v73
v_cvt_pk_bf16_f32 v123, v74, v75
v_mfma_f32_16x16x32_bf16 v[108:111], a[188:191], v[236:239], v[108:111]
s_cbranch_vccnz K2_S_X1b
K2_R_X1b:
v_cvt_pk_bf16_f32 v126, v76, v77
v_cvt_pk_bf16_f32 v127, v78, v79
K2_X2:
s_add_u32 s84, s84, s48
s_addc_u32 s85, s85, 0
s_waitcnt lgkmcnt(4)
v_mfma_f32_16x16x32_bf16 a[0:3], a[128:131], v[112:115], a[0:3]
ds_read_b128 a[176:179], v2 offset:6144
v_add_u32 v3, s25, v1
v_add_f32 v8, v8, v12
v_mfma_f32_16x16x32_bf16 a[32:35], a[128:131], v[116:119], a[32:35]
s_add_u32 m0, s26, s48
v_add_f32 v9, v9, v13
v_add_f32 v10, v10, v14
v_mfma_f32_16x16x32_bf16 a[64:67], a[128:131], v[120:123], a[64:67]
global_load_lds_dwordx4 v1, s[86:87] offset:0 sc1
v_add_f32 v11, v11, v15
v_mfma_f32_16x16x32_bf16 a[96:99], a[128:131], v[124:127], a[96:99]
s_mov_b32 s29, 32
s_call_b64 s[78:79], K2_MASK_1c
v_exp_f32 v80, v80
v_mfma_f32_16x16x32_bf16 a[4:7], a[136:139], v[112:115], a[4:7]
ds_read_b128 a[184:187], v2 offset:7168
v_mfma_f32_16x16x32_bf16 a[36:39], a[136:139], v[116:119], a[36:39]
global_load_lds_dwordx4 v1, s[86:87] offset:1024 sc1
v_mfma_f32_16x16x32_bf16 a[68:71], a[136:139], v[120:123], a[68:71]
s_add_u32 s86, s86, 8192
s_addc_u32 s87, s87, 0
v_mfma_f32_16x16x32_bf16 a[100:103], a[136:139], v[124:127], a[100:103]
s_waitcnt lgkmcnt(4)
v_exp_f32 v81, v81
v_mfma_f32_16x16x32_bf16 a[8:11], a[144:147], v[112:115], a[8:11]
s_add_u32 m0, s26, s59
v_exp_f32 v82, v82
v_mfma_f32_16x16x32_bf16 a[40:43], a[144:147], v[116:119], a[40:43]
global_load_lds_dwordx4 v1, s[84:85] offset:0 sc1
v_add_f32 v12, v80, v81
v_mfma_f32_16x16x32_bf16 a[72:75], a[144:147], v[120:123], a[72:75]
ds_read_b128 a[132:135], v2 offset:16384
v_exp_f32 v83, v83
v_mfma_f32_16x16x32_bf16 a[104:107], a[144:147], v[124:127], a[104:107]
v_exp_f32 v84, v84
v_mfma_f32_16x16x32_bf16 a[12:15], a[152:155], v[112:115], a[12:15]
global_load_lds_dwordx4 v1, s[84:85] offset:1024 sc1
v_cvt_pk_bf16_f32 v128, v80, v81
v_mfma_f32_16x16x32_bf16 a[44:47], a[152:155], v[116:119], a[44:47]
v_exp_f32 v85, v85
v_mfma_f32_16x16x32_bf16 a[76:79], a[152:155], v[120:123], a[76:79]
ds_read_b128 a[140:143], v2 offset:18432
v_exp_f32 v86, v86
v_mfma_f32_16x16x32_bf16 a[108:111], a[152:155], v[124:127], a[108:111]
s_waitcnt lgkmcnt(4)
v_exp_f32 v87, v87
v_mfma_f32_16x16x32_bf16 a[16:19], a[160:163], v[112:115], a[16:19]
global_load_lds_dwordx4 v1, s[84:85] offset:2048 sc1
v_add_f32 v12, v12, v82
v_mfma_f32_16x16x32_bf16 a[48:51], a[160:163], v[116:119], a[48:51]
v_exp_f32 v88, v88
v_add_f32 v12, v12, v83
v_mfma_f32_16x16x32_bf16 a[80:83], a[160:163], v[120:123], a[80:83]
ds_read_b128 a[148:151], v2 offset:20480
v_cvt_pk_bf16_f32 v129, v82, v83
v_mfma_f32_16x16x32_bf16 a[112:115], a[160:163], v[124:127], a[112:115]
global_load_lds_dwordx4 v1, s[84:85] offset:3072 sc1
v_add_f32 v13, v84, v85
v_mfma_f32_16x16x32_bf16 a[20:23], a[168:171], v[112:115], a[20:23]
s_add_u32 s84, s84, 16384
s_addc_u32 s85, s85, 0
v_cvt_pk_bf16_f32 v132, v84, v85
v_mfma_f32_16x16x32_bf16 a[52:55], a[168:171], v[116:119], a[52:55]
s_add_u32 s25, s25, 32768
v_exp_f32 v89, v89
v_add_f32 v13, v13, v86
v_mfma_f32_16x16x32_bf16 a[84:87], a[168:171], v[120:123], a[84:87]
ds_read_b128 a[156:159], v2 offset:22528
v_add_f32 v13, v13, v87
v_mfma_f32_16x16x32_bf16 a[116:119], a[168:171], v[124:127], a[116:119]
s_waitcnt lgkmcnt(4)
v_exp_f32 v90, v90
v_mfma_f32_16x16x32_bf16 a[24:27], a[176:179], v[112:115], a[24:27]
s_and_b32 s25, s25, 0x1ffff
v_exp_f32 v91, v91
v_cvt_pk_bf16_f32 v133, v86, v87
v_mfma_f32_16x16x32_bf16 a[56:59], a[176:179], v[116:119], a[56:59]
s_add_u32 s26, s26, 32768
v_exp_f32 v92, v92
v_mfma_f32_16x16x32_bf16 a[88:91], a[176:179], v[120:123], a[88:91]
ds_read_b128 a[164:167], v2 offset:17408
v_add_f32 v14, v88, v89
v_mfma_f32_16x16x32_bf16 a[120:123], a[176:179], v[124:127], a[120:123]
s_and_b32 s26, s26, 0x1ffff
v_exp_f32 v93, v93
v_mfma_f32_16x16x32_bf16 a[28:31], a[184:187], v[112:115], a[28:31]
s_add_u32 s28, s28, 8192
v_exp_f32 v94, v94
v_cvt_pk_bf16_f32 v136, v88, v89
v_mfma_f32_16x16x32_bf16 a[60:63], a[184:187], v[116:119], a[60:63]
v_exp_f32 v95, v95
v_mfma_f32_16x16x32_bf16 a[92:95], a[184:187], v[120:123], a[92:95]
ds_read_b128 a[172:175], v2 offset:19456
v_add_f32 v14, v14, v90
v_mfma_f32_16x16x32_bf16 a[124:127], a[184:187], v[124:127], a[124:127]
s_waitcnt lgkmcnt(2)
v_exp_f32 v96, v96
v_mfma_f32_16x16x32_bf16 v[48:51], a[132:135], v[176:179], v[20:23]
v_exp_f32 v97, v97
v_add_f32 v14, v14, v91
v_mfma_f32_16x16x32_bf16 v[48:51], a[140:143], v[180:183], v[48:51]
v_exp_f32 v98, v98
v_mfma_f32_16x16x32_bf16 v[48:51], a[148:151], v[184:187], v[48:51]
ds_read_b128 a[180:183], v2 offset:21504
v_cvt_pk_bf16_f32 v137, v90, v91
v_mfma_f32_16x16x32_bf16 v[48:51], a[156:159], v[188:191], v[48:51]
v_exp_f32 v99, v99
v_add_f32 v15, v92, v93
v_mfma_f32_16x16x32_bf16 v[52:55], a[132:135], v[192:195], v[24:27]
v_exp_f32 v100, v100
v_mfma_f32_16x16x32_bf16 v[52:55], a[140:143], v[196:199], v[52:55]
s_waitcnt vmcnt(6)
s_barrier
v_cvt_pk_bf16_f32 v140, v92, v93
v_mfma_f32_16x16x32_bf16 v[52:55], a[148:151], v[200:203], v[52:55]
ds_read_b128 a[188:191], v2 offset:23552
v_add_f32 v15, v15, v94
v_mfma_f32_16x16x32_bf16 v[52:55], a[156:159], v[204:207], v[52:55]
v_exp_f32 v101, v101
v_add_f32 v15, v15, v95
v_mfma_f32_16x16x32_bf16 v[56:59], a[132:135], v[208:211], v[28:31]
ds_read_b128 a[128:131], v3 offset:0
v_cvt_pk_bf16_f32 v141, v94, v95
v_mfma_f32_16x16x32_bf16 v[56:59], a[140:143], v[212:215], v[56:59]
v_exp_f32 v102, v102
v_mfma_f32_16x16x32_bf16 v[56:59], a[148:151], v[216:219], v[56:59]
v_exp_f32 v103, v103
v_add_f32 v12, v12, v96
v_mfma_f32_16x16x32_bf16 v[56:59], a[156:159], v[220:223], v[56:59]
v_exp_f32 v104, v104
v_mfma_f32_16x16x32_bf16 v[60:63], a[132:135], v[224:227], v[32:35]
ds_read_b128 a[136:139], v3 offset:1024
v_add_f32 v12, v12, v97
v_mfma_f32_16x16x32_bf16 v[60:63], a[140:143], v[228:231], v[60:63]
v_exp_f32 v105, v105
v_mfma_f32_16x16x32_bf16 v[60:63], a[148:151], v[232:235], v[60:63]
v_exp_f32 v106, v106
v_cvt_pk_bf16_f32 v130, v96, v97
v_mfma_f32_16x16x32_bf16 v[60:63], a[156:159], v[236:239], v[60:63]
s_waitcnt lgkmcnt(2)
v_exp_f32 v107, v107
v_mfma_f32_16x16x32_bf16 v[64:67], a[164:167], v[176:179], v[20:23]
ds_read_b128 a[144:147], v3 offset:2048
v_add_f32 v12, v12, v98
v_mfma_f32_16x16x32_bf16 v[64:67], a[172:175], v[180:183], v[64:67]
v_exp_f32 v108, v108
v_add_f32 v12, v12, v99
v_mfma_f32_16x16x32_bf16 v[64:67], a[180:183], v[184:187], v[64:67]
v_exp_f32 v109, v109
v_mfma_f32_16x16x32_bf16 v[64:67], a[188:191], v[188:191], v[64:67]
v_exp_f32 v110, v110
v_mfma_f32_16x16x32_bf16 v[68:71], a[164:167], v[192:195], v[24:27]
ds_read_b128 a[152:155], v3 offset:3072
v_cvt_pk_bf16_f32 v131, v98, v99
v_mfma_f32_16x16x32_bf16 v[68:71], a[172:175], v[196:199], v[68:71]
v_exp_f32 v111, v111
v_add_f32 v13, v13, v100
v_mfma_f32_16x16x32_bf16 v[68:71], a[180:183], v[200:203], v[68:71]
v_add_f32 v13, v13, v101
v_add_f32 v13, v13, v102
v_mfma_f32_16x16x32_bf16 v[68:71], a[188:191], v[204:207], v[68:71]
v_add_f32 v13, v13, v103
v_add_f32 v14, v14, v104
v_mfma_f32_16x16x32_bf16 v[72:75], a[164:167], v[208:211], v[28:31]
ds_read_b128 a[160:163], v3 offset:4096
v_add_f32 v14, v14, v105
v_add_f32 v14, v14, v106
v_mfma_f32_16x16x32_bf16 v[72:75], a[172:175], v[212:215], v[72:75]
v_add_f32 v14, v14, v107
v_add_f32 v15, v15, v108
v_mfma_f32_16x16x32_bf16 v[72:75], a[180:183], v[216:219], v[72:75]
v_add_f32 v15, v15, v109
v_add_f32 v15, v15, v110
v_mfma_f32_16x16x32_bf16 v[72:75], a[188:191], v[220:223], v[72:75]
v_add_f32 v15, v15, v111
v_max3_f32 v16, v12, v13, v14
v_mfma_f32_16x16x32_bf16 v[76:79], a[164:167], v[224:227], v[32:35]
ds_read_b128 a[168:171], v3 offset:5120
v_max_f32 v16, v16, v15
v_cmp_nge_f32 vcc, 0x53800000, v16
v_mfma_f32_16x16x32_bf16 v[76:79], a[172:175], v[228:231], v[76:79]
v_cvt_pk_bf16_f32 v134, v100, v101
v_cvt_pk_bf16_f32 v135, v102, v103
v_mfma_f32_16x16x32_bf16 v[76:79], a[180:183], v[232:235], v[76:79]
v_cvt_pk_bf16_f32 v138, v104, v105
v_cvt_pk_bf16_f32 v139, v106, v107
v_mfma_f32_16x16x32_bf16 v[76:79], a[188:191], v[236:239], v[76:79]
s_cbranch_vccnz K2_S_X2a
K2_R_X2a:
v_cvt_pk_bf16_f32 v142, v108, v109
v_cvt_pk_bf16_f32 v143, v110, v111
s_waitcnt lgkmcnt(4)
v_mfma_f32_16x16x32_bf16 a[0:3], a[128:131], v[128:131], a[0:3]
ds_read_b128 a[176:179], v3 offset:6144
v_add_u32 v2, s25, v1
v_add_f32 v8, v8, v12
v_mfma_f32_16x16x32_bf16 a[32:35], a[128:131], v[132:135], a[32:35]
s_add_u32 m0, s26, s48
v_add_f32 v9, v9, v13
v_add_f32 v10, v10, v14
v_mfma_f32_16x16x32_bf16 a[64:67], a[128:131], v[136:139], a[64:67]
global_load_lds_dwordx4 v1, s[86:87] offset:0 sc1
v_add_f32 v11, v11, v15
v_mfma_f32_16x16x32_bf16 a[96:99], a[128:131], v[140:143], a[96:99]
s_mov_b32 s29, 64
s_call_b64 s[78:79], K2_MASK_0c
v_exp_f32 v48, v48
v_mfma_f32_16x16x32_bf16 a[4:7], a[136:139], v[128:131], a[4:7]
ds_read_b128 a[184:187], v3 offset:7168
v_mfma_f32_16x16x32_bf16 a[36:39], a[136:139], v[132:135], a[36:39]
global_load_lds_dwordx4 v1, s[86:87] offset:1024 sc1
v_mfma_f32_16x16x32_bf16 a[68:71], a[136:139], v[136:139], a[68:71]
s_add_u32 s86, s86, 8192
s_addc_u32 s87, s87, 0
v_mfma_f32_16x16x32_bf16 a[100:103], a[136:139], v[140:143], a[100:103]
s_waitcnt lgkmcnt(4)
v_exp_f32 v49, v49
v_mfma_f32_16x16x32_bf16 a[8:11], a[144:147], v[128:131], a[8:11]
s_add_u32 m0, s26, s59
v_exp_f32 v50, v50
v_mfma_f32_16x16x32_bf16 a[40:43], a[144:147], v[132:135], a[40:43]
global_load_lds_dwordx4 v1, s[84:85] offset:0 sc1
v_add_f32 v12, v48, v49
v_mfma_f32_16x16x32_bf16 a[72:75], a[144:147], v[136:139], a[72:75]
ds_read_b128 a[132:135], v3 offset:16384
v_exp_f32 v51, v51
v_mfma_f32_16x16x32_bf16 a[104:107], a[144:147], v[140:143], a[104:107]
v_exp_f32 v52, v52
v_mfma_f32_16x16x32_bf16 a[12:15], a[152:155], v[128:131], a[12:15]
global_load_lds_dwordx4 v1, s[84:85] offset:1024 sc1
v_cvt_pk_bf16_f32 v112, v48, v49
v_mfma_f32_16x16x32_bf16 a[44:47], a[152:155], v[132:135], a[44:47]
v_exp_f32 v53, v53
v_mfma_f32_16x16x32_bf16 a[76:79], a[152:155], v[136:139], a[76:79]
ds_read_b128 a[140:143], v3 offset:18432
v_exp_f32 v54, v54
v_mfma_f32_16x16x32_bf16 a[108:111], a[152:155], v[140:143], a[108:111]
s_waitcnt lgkmcnt(4)
v_exp_f32 v55, v55
v_mfma_f32_16x16x32_bf16 a[16:19], a[160:163], v[128:131], a[16:19]
global_load_lds_dwordx4 v1, s[84:85] offset:2048 sc1
v_add_f32 v12, v12, v50
v_mfma_f32_16x16x32_bf16 a[48:51], a[160:163], v[132:135], a[48:51]
v_exp_f32 v56, v56
v_add_f32 v12, v12, v51
v_mfma_f32_16x16x32_bf16 a[80:83], a[160:163], v[136:139], a[80:83]
ds_read_b128 a[148:151], v3 offset:20480
v_cvt_pk_bf16_f32 v113, v50, v51
v_mfma_f32_16x16x32_bf16 a[112:115], a[160:163], v[140:143], a[112:115]
global_load_lds_dwordx4 v1, s[84:85] offset:3072 sc1
v_add_f32 v13, v52, v53
v_mfma_f32_16x16x32_bf16 a[20:23], a[168:171], v[128:131], a[20:23]
s_add_u32 s84, s84, 16384
s_addc_u32 s85, s85, 0
v_cvt_pk_bf16_f32 v116, v52, v53
v_mfma_f32_16x16x32_bf16 a[52:55], a[168:171], v[132:135], a[52:55]
s_add_u32 s25, s25, 32768
v_exp_f32 v57, v57
v_add_f32 v13, v13, v54
v_mfma_f32_16x16x32_bf16 a[84:87], a[168:171], v[136:139], a[84:87]
ds_read_b128 a[156:159], v3 offset:22528
v_add_f32 v13, v13, v55
v_mfma_f32_16x16x32_bf16 a[116:119], a[168:171], v[140:143], a[116:119]
s_waitcnt lgkmcnt(4)
v_exp_f32 v58, v58
v_mfma_f32_16x16x32_bf16 a[24:27], a[176:179], v[128:131], a[24:27]
s_and_b32 s25, s25, 0x1ffff
v_exp_f32 v59, v59
v_cvt_pk_bf16_f32 v117, v54, v55
v_mfma_f32_16x16x32_bf16 a[56:59], a[176:179], v[132:135], a[56:59]
s_add_u32 s26, s26, 32768
v_exp_f32 v60, v60
v_mfma_f32_16x16x32_bf16 a[88:91], a[176:179], v[136:139], a[88:91]
ds_read_b128 a[164:167], v3 offset:17408
v_add_f32 v14, v56, v57
v_mfma_f32_16x16x32_bf16 a[120:123], a[176:179], v[140:143], a[120:123]
s_and_b32 s26, s26, 0x1ffff
v_exp_f32 v61, v61
v_mfma_f32_16x16x32_bf16 a[28:31], a[184:187], v[128:131], a[28:31]
s_add_u32 s28, s28, 8192
v_exp_f32 v62, v62
v_cvt_pk_bf16_f32 v120, v56, v57
v_mfma_f32_16x16x32_bf16 a[60:63], a[184:187], v[132:135], a[60:63]
v_exp_f32 v63, v63
v_mfma_f32_16x16x32_bf16 a[92:95], a[184:187], v[136:139], a[92:95]
ds_read_b128 a[172:175], v3 offset:19456
v_add_f32 v14, v14, v58
v_mfma_f32_16x16x32_bf16 a[124:127], a[184:187], v[140:143], a[124:127]
s_waitcnt lgkmcnt(2)
v_exp_f32 v64, v64
v_mfma_f32_16x16x32_bf16 v[80:83], a[132:135], v[176:179], v[20:23]
v_exp_f32 v65, v65
v_add_f32 v14, v14, v59
v_mfma_f32_16x16x32_bf16 v[80:83], a[140:143], v[180:183], v[80:83]
v_exp_f32 v66, v66
v_mfma_f32_16x16x32_bf16 v[80:83], a[148:151], v[184:187], v[80:83]
ds_read_b128 a[180:183], v3 offset:21504
v_cvt_pk_bf16_f32 v121, v58, v59
v_mfma_f32_16x16x32_bf16 v[80:83], a[156:159], v[188:191], v[80:83]
v_exp_f32 v67, v67
v_add_f32 v15, v60, v61
v_mfma_f32_16x16x32_bf16 v[84:87], a[132:135], v[192:195], v[24:27]
v_exp_f32 v68, v68
v_mfma_f32_16x16x32_bf16 v[84:87], a[140:143], v[196:199], v[84:87]
s_waitcnt vmcnt(6)
s_barrier
v_cvt_pk_bf16_f32 v124, v60, v61
v_mfma_f32_16x16x32_bf16 v[84:87], a[148:151], v[200:203], v[84:87]
ds_read_b128 a[188:191], v3 offset:23552
v_add_f32 v15, v15, v62
v_mfma_f32_16x16x32_bf16 v[84:87], a[156:159], v[204:207], v[84:87]
v_exp_f32 v69, v69
v_add_f32 v15, v15, v63
v_mfma_f32_16x16x32_bf16 v[88:91], a[132:135], v[208:211], v[28:31]
ds_read_b128 a[128:131], v2 offset:0
v_cvt_pk_bf16_f32 v125, v62, v63
v_mfma_f32_16x16x32_bf16 v[88:91], a[140:143], v[212:215], v[88:91]
v_exp_f32 v70, v70
v_mfma_f32_16x16x32_bf16 v[88:91], a[148:151], v[216:219], v[88:91]
v_exp_f32 v71, v71
v_add_f32 v12, v12, v64
v_mfma_f32_16x16x32_bf16 v[88:91], a[156:159], v[220:223], v[88:91]
v_exp_f32 v72, v72
v_mfma_f32_16x16x32_bf16 v[92:95], a[132:135], v[224:227], v[32:35]
ds_read_b128 a[136:139], v2 offset:1024
v_add_f32 v12, v12, v65
v_mfma_f32_16x16x32_bf16 v[92:95], a[140:143], v[228:231], v[92:95]
v_exp_f32 v73, v73
v_mfma_f32_16x16x32_bf16 v[92:95], a[148:151], v[232:235], v[92:95]
v_exp_f32 v74, v74
v_cvt_pk_bf16_f32 v114, v64, v65
v_mfma_f32_16x16x32_bf16 v[92:95], a[156:159], v[236:239], v[92:95]
s_waitcnt lgkmcnt(2)
v_exp_f32 v75, v75
v_mfma_f32_16x16x32_bf16 v[96:99], a[164:167], v[176:179], v[20:23]
ds_read_b128 a[144:147], v2 offset:2048
v_add_f32 v12, v12, v66
v_mfma_f32_16x16x32_bf16 v[96:99], a[172:175], v[180:183], v[96:99]
v_exp_f32 v76, v76
v_add_f32 v12, v12, v67
v_mfma_f32_16x16x32_bf16 v[96:99], a[180:183], v[184:187], v[96:99]
v_exp_f32 v77, v77
v_mfma_f32_16x16x32_bf16 v[96:99], a[188:191], v[188:191], v[96:99]
v_exp_f32 v78, v78
v_mfma_f32_16x16x32_bf16 v[100:103], a[164:167], v[192:195], v[24:27]
ds_read_b128 a[152:155], v2 offset:3072
v_cvt_pk_bf16_f32 v115, v66, v67
v_mfma_f32_16x16x32_bf16 v[100:103], a[172:175], v[196:199], v[100:103]
v_exp_f32 v79, v79
v_add_f32 v13, v13, v68
v_mfma_f32_16x16x32_bf16 v[100:103], a[180:183], v[200:203], v[100:103]
v_add_f32 v13, v13, v69
v_add_f32 v13, v13, v70
v_mfma_f32_16x16x32_bf16 v[100:103], a[188:191], v[204:207], v[100:103]
v_add_f32 v13, v13, v71
v_add_f32 v14, v14, v72
v_mfma_f32_16x16x32_bf16 v[104:107], a[164:167], v[208:211], v[28:31]
ds_read_b128 a[160:163], v2 offset:4096
v_add_f32 v14, v14, v73
v_add_f32 v14, v14, v74
v_mfma_f32_16x16x32_bf16 v[104:107], a[172:175], v[212:215], v[104:107]
v_add_f32 v14, v14, v75
v_add_f32 v15, v15, v76
v_mfma_f32_16x16x32_bf16 v[104:107], a[180:183], v[216:219], v[104:107]
v_add_f32 v15, v15, v77
v_add_f32 v15, v15, v78
v_mfma_f32_16x16x32_bf16 v[104:107], a[188:191], v[220:223], v[104:107]
v_add_f32 v15, v15, v79
v_max3_f32 v16, v12, v13, v14
v_mfma_f32_16x16x32_bf16 v[108:111], a[164:167], v[224:227], v[32:35]
ds_read_b128 a[168:171], v2 offset:5120
v_max_f32 v16, v16, v15
v_cmp_nge_f32 vcc, 0x53800000, v16
v_mfma_f32_16x16x32_bf16 v[108:111], a[172:175], v[228:231], v[108:111]
v_cvt_pk_bf16_f32 v118, v68, v69
v_cvt_pk_bf16_f32 v119, v70, v71
v_mfma_f32_16x16x32_bf16 v[108:111], a[180:183], v[232:235], v[108:111]
v_cvt_pk_bf16_f32 v122, v72, v73
v_cvt_pk_bf16_f32 v123, v74, v75
v_mfma_f32_16x16x32_bf16 v[108:111], a[188:191], v[236:239], v[108:111]
s_cbranch_vccnz K2_S_X2b
K2_R_X2b:
v_cvt_pk_bf16_f32 v126, v76, v77
v_cvt_pk_bf16_f32 v127, v78, v79
s_add_u32 s86, s86, s48
s_addc_u32 s87, s87, 0
s_cmp_eq_u32 s22, 7
s_cbranch_scc1 K2_X3b
s_waitcnt lgkmcnt(4)
v_mfma_f32_16x16x32_bf16 a[0:3], a[128:131], v[112:115], a[0:3]
ds_read_b128 a[176:179], v2 offset:6144
v_add_u32 v3, s25, v1
v_add_f32 v8, v8, v12
v_mfma_f32_16x16x32_bf16 a[32:35], a[128:131], v[116:119], a[32:35]
s_add_u32 m0, s26, s49
v_add_f32 v9, v9, v13
v_add_f32 v10, v10, v14
v_mfma_f32_16x16x32_bf16 a[64:67], a[128:131], v[120:123], a[64:67]
global_load_lds_dwordx4 v1, s[86:87] offset:0 sc1
v_add_f32 v11, v11, v15
v_mfma_f32_16x16x32_bf16 a[96:99], a[128:131], v[124:127], a[96:99]
s_mov_b32 s29, 96
s_call_b64 s[78:79], K2_MASK_1c
v_mfma_f32_16x16x32_bf16 a[4:7], a[136:139], v[112:115], a[4:7]
ds_read_b128 a[184:187], v2 offset:7168
v_exp_f32 v80, v80
v_mfma_f32_16x16x32_bf16 a[36:39], a[136:139], v[116:119], a[36:39]
global_load_lds_dwordx4 v1, s[86:87] offset:1024 sc1
v_mfma_f32_16x16x32_bf16 a[68:71], a[136:139], v[120:123], a[68:71]
v_exp_f32 v81, v81
v_mfma_f32_16x16x32_bf16 a[100:103], a[136:139], v[124:127], a[100:103]
s_waitcnt lgkmcnt(4)
v_exp_f32 v82, v82
v_mfma_f32_16x16x32_bf16 a[8:11], a[144:147], v[112:115], a[8:11]
ds_read_b128 a[128:131], v2 offset:16384
v_add_f32 v12, v80, v81
v_mfma_f32_16x16x32_bf16 a[40:43], a[144:147], v[116:119], a[40:43]
global_load_lds_dwordx4 v1, s[86:87] offset:2048 sc1
v_exp_f32 v83, v83
v_mfma_f32_16x16x32_bf16 a[72:75], a[144:147], v[120:123], a[72:75]
ds_read_b128 a[132:135], v2 offset:18432
v_cvt_pk_bf16_f32 v128, v80, v81
v_mfma_f32_16x16x32_bf16 a[104:107], a[144:147], v[124:127], a[104:107]
v_exp_f32 v84, v84
v_add_f32 v12, v12, v82
v_mfma_f32_16x16x32_bf16 a[12:15], a[152:155], v[112:115], a[12:15]
ds_read_b128 a[136:139], v2 offset:20480
v_add_f32 v12, v12, v83
v_mfma_f32_16x16x32_bf16 a[44:47], a[152:155], v[116:119], a[44:47]
global_load_lds_dwordx4 v1, s[86:87] offset:3072 sc1
v_exp_f32 v85, v85
v_mfma_f32_16x16x32_bf16 a[76:79], a[152:155], v[120:123], a[76:79]
ds_read_b128 a[140:143], v2 offset:22528
v_cvt_pk_bf16_f32 v129, v82, v83
v_mfma_f32_16x16x32_bf16 a[108:111], a[152:155], v[124:127], a[108:111]
s_waitcnt lgkmcnt(6)
v_exp_f32 v86, v86
v_mfma_f32_16x16x32_bf16 a[16:19], a[160:163], v[112:115], a[16:19]
ds_read_b128 a[144:147], v2 offset:17408
v_exp_f32 v87, v87
v_mfma_f32_16x16x32_bf16 a[48:51], a[160:163], v[116:119], a[48:51]
s_add_u32 s86, s86, 16384
s_addc_u32 s87, s87, 0
v_add_f32 v13, v84, v85
v_mfma_f32_16x16x32_bf16 a[80:83], a[160:163], v[120:123], a[80:83]
ds_read_b128 a[148:151], v2 offset:19456
v_exp_f32 v88, v88
v_mfma_f32_16x16x32_bf16 a[112:115], a[160:163], v[124:127], a[112:115]
s_add_u32 m0, s26, s59
v_exp_f32 v89, v89
v_mfma_f32_16x16x32_bf16 a[20:23], a[168:171], v[112:115], a[20:23]
ds_read_b128 a[152:155], v2 offset:21504
v_exp_f32 v90, v90
v_mfma_f32_16x16x32_bf16 a[52:55], a[168:171], v[116:119], a[52:55]
global_load_lds_dwordx4 v1, s[84:85] offset:0 sc1
v_cvt_pk_bf16_f32 v132, v84, v85
v_mfma_f32_16x16x32_bf16 a[84:87], a[168:171], v[120:123], a[84:87]
ds_read_b128 a[156:159], v2 offset:23552
v_exp_f32 v91, v91
v_mfma_f32_16x16x32_bf16 a[116:119], a[168:171], v[124:127], a[116:119]
s_waitcnt lgkmcnt(8)
v_exp_f32 v92, v92
v_mfma_f32_16x16x32_bf16 a[24:27], a[176:179], v[112:115], a[24:27]
ds_read_b128 a[160:163], v2 offset:24576
v_add_f32 v13, v13, v86
v_mfma_f32_16x16x32_bf16 a[56:59], a[176:179], v[116:119], a[56:59]
global_load_lds_dwordx4 v1, s[84:85] offset:1024 sc1
v_exp_f32 v93, v93
v_mfma_f32_16x16x32_bf16 a[88:91], a[176:179], v[120:123], a[88:91]
ds_read_b128 a[164:167], v2 offset:26624
v_add_f32 v13, v13, v87
v_mfma_f32_16x16x32_bf16 a[120:123], a[176:179], v[124:127], a[120:123]
v_exp_f32 v94, v94
v_cvt_pk_bf16_f32 v133, v86, v87
v_mfma_f32_16x16x32_bf16 a[28:31], a[184:187], v[112:115], a[28:31]
ds_read_b128 a[168:171], v2 offset:28672
v_add_f32 v14, v88, v89
v_mfma_f32_16x16x32_bf16 a[60:63], a[184:187], v[116:119], a[60:63]
global_load_lds_dwordx4 v1, s[84:85] offset:2048 sc1
v_exp_f32 v95, v95
v_mfma_f32_16x16x32_bf16 a[92:95], a[184:187], v[120:123], a[92:95]
ds_read_b128 a[172:175], v2 offset:30720
v_cvt_pk_bf16_f32 v136, v88, v89
v_mfma_f32_16x16x32_bf16 a[124:127], a[184:187], v[124:127], a[124:127]
s_waitcnt lgkmcnt(8)
v_exp_f32 v96, v96
v_mfma_f32_16x16x32_bf16 v[48:51], a[128:131], v[208:211], v[28:31]
ds_read_b128 a[176:179], v2 offset:25600
v_exp_f32 v97, v97
v_mfma_f32_16x16x32_bf16 v[48:51], a[132:135], v[212:215], v[48:51]
global_load_lds_dwordx4 v1, s[84:85] offset:3072 sc1
v_add_f32 v14, v14, v90
v_mfma_f32_16x16x32_bf16 v[48:51], a[136:139], v[216:219], v[48:51]
ds_read_b128 a[180:183], v2 offset:27648
v_exp_f32 v98, v98
v_mfma_f32_16x16x32_bf16 v[48:51], a[140:143], v[220:223], v[48:51]
s_add_u32 s84, s84, 16384
s_addc_u32 s85, s85, 0
v_add_f32 v14, v14, v91
v_mfma_f32_16x16x32_bf16 v[52:55], a[128:131], v[224:227], v[32:35]
ds_read_b128 a[184:187], v2 offset:29696
v_exp_f32 v99, v99
v_mfma_f32_16x16x32_bf16 v[52:55], a[132:135], v[228:231], v[52:55]
s_waitcnt vmcnt(8)
s_barrier
v_cvt_pk_bf16_f32 v137, v90, v91
v_mfma_f32_16x16x32_bf16 v[52:55], a[136:139], v[232:235], v[52:55]
ds_read_b128 a[188:191], v2 offset:31744
v_exp_f32 v100, v100
v_mfma_f32_16x16x32_bf16 v[52:55], a[140:143], v[236:239], v[52:55]
s_waitcnt lgkmcnt(8)
v_exp_f32 v101, v101
v_mfma_f32_16x16x32_bf16 v[56:59], a[144:147], v[208:211], v[28:31]
ds_read_b128 a[128:131], v3 offset:0
v_add_f32 v15, v92, v93
v_mfma_f32_16x16x32_bf16 v[56:59], a[148:151], v[212:215], v[56:59]
s_add_u32 s25, s25, 32768
v_exp_f32 v102, v102
v_cvt_pk_bf16_f32 v140, v92, v93
v_mfma_f32_16x16x32_bf16 v[56:59], a[152:155], v[216:219], v[56:59]
s_and_b32 s25, s25, 0x1ffff
v_exp_f32 v103, v103
v_mfma_f32_16x16x32_bf16 v[56:59], a[156:159], v[220:223], v[56:59]
s_add_u32 s26, s26, 32768
v_exp_f32 v104, v104
v_add_f32 v15, v15, v94
v_mfma_f32_16x16x32_bf16 v[60:63], a[144:147], v[224:227], v[32:35]
ds_read_b128 a[136:139], v3 offset:1024
v_add_f32 v15, v15, v95
v_mfma_f32_16x16x32_bf16 v[60:63], a[148:151], v[228:231], v[60:63]
s_and_b32 s26, s26, 0x1ffff
v_exp_f32 v105, v105
v_cvt_pk_bf16_f32 v141, v94, v95
v_mfma_f32_16x16x32_bf16 v[60:63], a[152:155], v[232:235], v[60:63]
s_add_u32 s28, s28, 8192
v_exp_f32 v106, v106
v_mfma_f32_16x16x32_bf16 v[60:63], a[156:159], v[236:239], v[60:63]
s_waitcnt lgkmcnt(6)
v_exp_f32 v107, v107
v_mfma_f32_16x16x32_bf16 v[64:67], a[160:163], v[208:211], v[28:31]
ds_read_b128 a[144:147], v3 offset:2048
v_exp_f32 v108, v108
v_mfma_f32_16x16x32_bf16 v[64:67], a[164:167], v[212:215], v[64:67]
v_exp_f32 v109, v109
v_mfma_f32_16x16x32_bf16 v[64:67], a[168:171], v[216:219], v[64:67]
v_exp_f32 v110, v110
v_add_f32 v12, v12, v96
v_mfma_f32_16x16x32_bf16 v[64:67], a[172:175], v[220:223], v[64:67]
v_exp_f32 v111, v111
v_mfma_f32_16x16x32_bf16 v[68:71], a[160:163], v[224:227], v[32:35]
ds_read_b128 a[152:155], v3 offset:3072
v_add_f32 v12, v12, v97
v_cvt_pk_bf16_f32 v130, v96, v97
v_mfma_f32_16x16x32_bf16 v[68:71], a[164:167], v[228:231], v[68:71]
v_add_f32 v12, v12, v98
v_add_f32 v12, v12, v99
v_mfma_f32_16x16x32_bf16 v[68:71], a[168:171], v[232:235], v[68:71]
v_cvt_pk_bf16_f32 v131, v98, v99
v_add_f32 v13, v13, v100
v_add_f32 v13, v13, v101
v_mfma_f32_16x16x32_bf16 v[68:71], a[172:175], v[236:239], v[68:71]
s_waitcnt lgkmcnt(4)
v_add_f32 v13, v13, v102
v_add_f32 v13, v13, v103
v_mfma_f32_16x16x32_bf16 v[72:75], a[176:179], v[208:211], v[28:31]
ds_read_b128 a[160:163], v3 offset:4096
v_add_f32 v14, v14, v104
v_mfma_f32_16x16x32_bf16 v[72:75], a[180:183], v[212:215], v[72:75]
v_add_f32 v14, v14, v105
v_add_f32 v14, v14, v106
v_add_f32 v14, v14, v107
v_mfma_f32_16x16x32_bf16 v[72:75], a[184:187], v[216:219], v[72:75]
v_add_f32 v15, v15, v108
v_add_f32 v15, v15, v109
v_mfma_f32_16x16x32_bf16 v[72:75], a[188:191], v[220:223], v[72:75]
v_add_f32 v15, v15, v110
v_add_f32 v15, v15, v111
v_max3_f32 v16, v12, v13, v14
v_mfma_f32_16x16x32_bf16 v[76:79], a[176:179], v[224:227], v[32:35]
ds_read_b128 a[168:171], v3 offset:5120
v_max_f32 v16, v16, v15
v_mfma_f32_16x16x32_bf16 v[76:79], a[180:183], v[228:231], v[76:79]
v_cmp_nge_f32 vcc, 0x53800000, v16
v_cvt_pk_bf16_f32 v134, v100, v101
v_cvt_pk_bf16_f32 v135, v102, v103
v_mfma_f32_16x16x32_bf16 v[76:79], a[184:187], v[232:235], v[76:79]
v_cvt_pk_bf16_f32 v138, v104, v105
v_cvt_pk_bf16_f32 v139, v106, v107
v_mfma_f32_16x16x32_bf16 v[76:79], a[188:191], v[236:239], v[76:79]
s_cbranch_vccnz K2_S_X3a
K2_R_X3a:
v_cvt_pk_bf16_f32 v142, v108, v109
v_cvt_pk_bf16_f32 v143, v110, v111
s_waitcnt lgkmcnt(4)
v_mfma_f32_16x16x32_bf16 a[0:3], a[128:131], v[128:131], a[0:3]
ds_read_b128 a[176:179], v3 offset:6144
v_exp_f32 v48, v48
v_mfma_f32_16x16x32_bf16 a[32:35], a[128:131], v[132:135], a[32:35]
s_add_u32 m0, s26, s49
v_exp_f32 v49, v49
v_mfma_f32_16x16x32_bf16 a[64:67], a[128:131], v[136:139], a[64:67]
global_load_lds_dwordx4 v1, s[86:87] offset:0 sc1
v_exp_f32 v50, v50
v_mfma_f32_16x16x32_bf16 a[96:99], a[128:131], v[140:143], a[96:99]
v_exp_f32 v51, v51
v_mfma_f32_16x16x32_bf16 a[4:7], a[136:139], v[128:131], a[4:7]
ds_read_b128 a[184:187], v3 offset:7168
v_exp_f32 v52, v52
v_mfma_f32_16x16x32_bf16 a[36:39], a[136:139], v[132:135], a[36:39]
global_load_lds_dwordx4 v1, s[86:87] offset:1024 sc1
v_add_u32 v2, s25, v1
v_mfma_f32_16x16x32_bf16 a[68:71], a[136:139], v[136:139], a[68:71]
v_exp_f32 v53, v53
v_add_f32 v8, v8, v12
v_mfma_f32_16x16x32_bf16 a[100:103], a[136:139], v[140:143], a[100:103]
s_waitcnt lgkmcnt(4)
v_exp_f32 v54, v54
v_mfma_f32_16x16x32_bf16 a[8:11], a[144:147], v[128:131], a[8:11]
ds_read_b128 a[128:131], v3 offset:16384
v_exp_f32 v55, v55
v_mfma_f32_16x16x32_bf16 a[40:43], a[144:147], v[132:135], a[40:43]
global_load_lds_dwordx4 v1, s[86:87] offset:2048 sc1
v_add_f32 v9, v9, v13
v_mfma_f32_16x16x32_bf16 a[72:75], a[144:147], v[136:139], a[72:75]
ds_read_b128 a[132:135], v3 offset:18432
v_exp_f32 v56, v56
v_mfma_f32_16x16x32_bf16 a[104:107], a[144:147], v[140:143], a[104:107]
v_exp_f32 v57, v57
v_mfma_f32_16x16x32_bf16 a[12:15], a[152:155], v[128:131], a[12:15]
ds_read_b128 a[136:139], v3 offset:20480
v_exp_f32 v58, v58
v_mfma_f32_16x16x32_bf16 a[44:47], a[152:155], v[132:135], a[44:47]
global_load_lds_dwordx4 v1, s[86:87] offset:3072 sc1
v_add_f32 v10, v10, v14
v_mfma_f32_16x16x32_bf16 a[76:79], a[152:155], v[136:139], a[76:79]
ds_read_b128 a[140:143], v3 offset:22528
v_exp_f32 v59, v59
v_mfma_f32_16x16x32_bf16 a[108:111], a[152:155], v[140:143], a[108:111]
s_waitcnt lgkmcnt(6)
v_exp_f32 v60, v60
v_mfma_f32_16x16x32_bf16 a[16:19], a[160:163], v[128:131], a[16:19]
ds_read_b128 a[144:147], v3 offset:17408
v_add_f32 v11, v11, v15
v_mfma_f32_16x16x32_bf16 a[48:51], a[160:163], v[132:135], a[48:51]
s_add_u32 s86, s86, 16384
s_addc_u32 s87, s87, 0
v_exp_f32 v61, v61
v_mfma_f32_16x16x32_bf16 a[80:83], a[160:163], v[136:139], a[80:83]
ds_read_b128 a[148:151], v3 offset:19456
v_add_f32 v14, v48, v49
v_mfma_f32_16x16x32_bf16 a[112:115], a[160:163], v[140:143], a[112:115]
s_add_u32 m0, s26, s59
v_exp_f32 v62, v62
v_cvt_pk_bf16_f32 v112, v48, v49
v_mfma_f32_16x16x32_bf16 a[20:23], a[168:171], v[128:131], a[20:23]
ds_read_b128 a[152:155], v3 offset:21504
v_add_f32 v14, v14, v50
v_mfma_f32_16x16x32_bf16 a[52:55], a[168:171], v[132:135], a[52:55]
global_load_lds_dwordx4 v1, s[84:85] offset:0 sc1
v_exp_f32 v63, v63
v_mfma_f32_16x16x32_bf16 a[84:87], a[168:171], v[136:139], a[84:87]
ds_read_b128 a[156:159], v3 offset:23552
v_add_f32 v14, v14, v51
v_mfma_f32_16x16x32_bf16 a[116:119], a[168:171], v[140:143], a[116:119]
s_waitcnt lgkmcnt(8)
v_exp_f32 v64, v64
v_cvt_pk_bf16_f32 v113, v50, v51
v_mfma_f32_16x16x32_bf16 a[24:27], a[176:179], v[128:131], a[24:27]
ds_read_b128 a[160:163], v3 offset:24576
v_add_f32 v15, v52, v53
v_mfma_f32_16x16x32_bf16 a[56:59], a[176:179], v[132:135], a[56:59]
global_load_lds_dwordx4 v1, s[84:85] offset:1024 sc1
v_exp_f32 v65, v65
v_mfma_f32_16x16x32_bf16 a[88:91], a[176:179], v[136:139], a[88:91]
ds_read_b128 a[164:167], v3 offset:26624
v_cvt_pk_bf16_f32 v116, v52, v53
v_mfma_f32_16x16x32_bf16 a[120:123], a[176:179], v[140:143], a[120:123]
v_exp_f32 v66, v66
v_add_f32 v15, v15, v54
v_mfma_f32_16x16x32_bf16 a[28:31], a[184:187], v[128:131], a[28:31]
ds_read_b128 a[168:171], v3 offset:28672
v_add_f32 v15, v15, v55
v_mfma_f32_16x16x32_bf16 a[60:63], a[184:187], v[132:135], a[60:63]
global_load_lds_dwordx4 v1, s[84:85] offset:2048 sc1
v_exp_f32 v67, v67
v_mfma_f32_16x16x32_bf16 a[92:95], a[184:187], v[136:139], a[92:95]
ds_read_b128 a[172:175], v3 offset:30720
v_cvt_pk_bf16_f32 v117, v54, v55
v_mfma_f32_16x16x32_bf16 a[124:127], a[184:187], v[140:143], a[124:127]
s_waitcnt lgkmcnt(8)
v_exp_f32 v68, v68
v_mfma_f32_16x16x32_bf16 v[80:83], a[128:131], v[208:211], v[28:31]
ds_read_b128 a[176:179], v3 offset:25600
v_exp_f32 v69, v69
v_mfma_f32_16x16x32_bf16 v[80:83], a[132:135], v[212:215], v[80:83]
global_load_lds_dwordx4 v1, s[84:85] offset:3072 sc1
v_add_f32 v14, v14, v56
v_mfma_f32_16x16x32_bf16 v[80:83], a[136:139], v[216:219], v[80:83]
ds_read_b128 a[180:183], v3 offset:27648
v_exp_f32 v70, v70
v_mfma_f32_16x16x32_bf16 v[80:83], a[140:143], v[220:223], v[80:83]
s_add_u32 s84, s84, 16384
s_addc_u32 s85, s85, 0
v_add_f32 v14, v14, v57
v_mfma_f32_16x16x32_bf16 v[84:87], a[128:131], v[224:227], v[32:35]
ds_read_b128 a[184:187], v3 offset:29696
v_exp_f32 v71, v71
v_mfma_f32_16x16x32_bf16 v[84:87], a[132:135], v[228:231], v[84:87]
s_waitcnt vmcnt(8)
s_barrier
v_cvt_pk_bf16_f32 v114, v56, v57
v_mfma_f32_16x16x32_bf16 v[84:87], a[136:139], v[232:235], v[84:87]
ds_read_b128 a[188:191], v3 offset:31744
v_exp_f32 v72, v72
v_mfma_f32_16x16x32_bf16 v[84:87], a[140:143], v[236:239], v[84:87]
s_waitcnt lgkmcnt(8)
v_exp_f32 v73, v73
v_mfma_f32_16x16x32_bf16 v[88:91], a[144:147], v[208:211], v[28:31]
ds_read_b128 a[128:131], v2 offset:0
v_exp_f32 v74, v74
v_mfma_f32_16x16x32_bf16 v[88:91], a[148:151], v[212:215], v[88:91]
s_add_u32 s25, s25, 32768
v_exp_f32 v75, v75
v_mfma_f32_16x16x32_bf16 v[88:91], a[152:155], v[216:219], v[88:91]
ds_read_b128 a[132:135], v2 offset:8192
v_exp_f32 v76, v76
v_mfma_f32_16x16x32_bf16 v[88:91], a[156:159], v[220:223], v[88:91]
s_and_b32 s25, s25, 0x1ffff
v_exp_f32 v77, v77
v_mfma_f32_16x16x32_bf16 v[92:95], a[144:147], v[224:227], v[32:35]
ds_read_b128 a[136:139], v2 offset:1024
v_exp_f32 v78, v78
v_mfma_f32_16x16x32_bf16 v[92:95], a[148:151], v[228:231], v[92:95]
s_add_u32 s26, s26, 32768
v_exp_f32 v79, v79
v_mfma_f32_16x16x32_bf16 v[92:95], a[152:155], v[232:235], v[92:95]
ds_read_b128 a[140:143], v2 offset:9216
v_add_f32 v14, v14, v58
v_add_f32 v14, v14, v59
v_mfma_f32_16x16x32_bf16 v[92:95], a[156:159], v[236:239], v[92:95]
s_waitcnt lgkmcnt(8)
v_cvt_pk_bf16_f32 v115, v58, v59
v_add_f32 v15, v15, v60
v_mfma_f32_16x16x32_bf16 v[96:99], a[160:163], v[208:211], v[28:31]
ds_read_b128 a[144:147], v2 offset:2048
v_add_f32 v15, v15, v61
v_mfma_f32_16x16x32_bf16 v[96:99], a[164:167], v[212:215], v[96:99]
s_and_b32 s26, s26, 0x1ffff
v_cvt_pk_bf16_f32 v118, v60, v61
v_add_f32 v15, v15, v62
v_add_f32 v15, v15, v63
v_mfma_f32_16x16x32_bf16 v[96:99], a[168:171], v[216:219], v[96:99]
ds_read_b128 a[148:151], v2 offset:10240
v_cvt_pk_bf16_f32 v119, v62, v63
v_mfma_f32_16x16x32_bf16 v[96:99], a[172:175], v[220:223], v[96:99]
s_add_u32 s28, s28, 8192
v_add_f32 v14, v14, v64
v_add_f32 v14, v14, v65
v_cvt_pk_bf16_f32 v120, v64, v65
v_mfma_f32_16x16x32_bf16 v[100:103], a[160:163], v[224:227], v[32:35]
ds_read_b128 a[152:155], v2 offset:3072
v_add_f32 v14, v14, v66
v_mfma_f32_16x16x32_bf16 v[100:103], a[164:167], v[228:231], v[100:103]
s_mov_b32 s29, -4096
v_add_f32 v14, v14, v67
v_cvt_pk_bf16_f32 v121, v66, v67
v_add_f32 v15, v15, v68
v_mfma_f32_16x16x32_bf16 v[100:103], a[168:171], v[232:235], v[100:103]
ds_read_b128 a[156:159], v2 offset:11264
v_add_f32 v15, v15, v69
v_mfma_f32_16x16x32_bf16 v[100:103], a[172:175], v[236:239], v[100:103]
s_waitcnt lgkmcnt(8)
v_add_f32 v15, v15, v70
v_add_f32 v15, v15, v71
v_add_f32 v14, v14, v72
v_mfma_f32_16x16x32_bf16 v[104:107], a[176:179], v[208:211], v[28:31]
ds_read_b128 a[160:163], v2 offset:4096
v_add_f32 v14, v14, v73
v_mfma_f32_16x16x32_bf16 v[104:107], a[180:183], v[212:215], v[104:107]
v_add_f32 v14, v14, v74
v_add_f32 v14, v14, v75
v_add_f32 v15, v15, v76
v_mfma_f32_16x16x32_bf16 v[104:107], a[184:187], v[216:219], v[104:107]
ds_read_b128 a[164:167], v2 offset:12288
v_add_f32 v15, v15, v77
v_mfma_f32_16x16x32_bf16 v[104:107], a[188:191], v[220:223], v[104:107]
v_add_f32 v15, v15, v78
v_add_f32 v15, v15, v79
v_max_f32 v16, v14, v15
v_mfma_f32_16x16x32_bf16 v[108:111], a[176:179], v[224:227], v[32:35]
ds_read_b128 a[168:171], v2 offset:5120
v_cmp_nge_f32 vcc, 0x53800000, v16
v_mfma_f32_16x16x32_bf16 v[108:111], a[180:183], v[228:231], v[108:111]
v_cvt_pk_bf16_f32 v124, v68, v69
v_cvt_pk_bf16_f32 v125, v70, v71
v_cvt_pk_bf16_f32 v122, v72, v73
v_mfma_f32_16x16x32_bf16 v[108:111], a[184:187], v[232:235], v[108:111]
ds_read_b128 a[172:175], v2 offset:13312
v_cvt_pk_bf16_f32 v123, v74, v75
v_mfma_f32_16x16x32_bf16 v[108:111], a[188:191], v[236:239], v[108:111]
s_cbranch_vccnz K2_S_X3b
K2_R_X3b:
v_cvt_pk_bf16_f32 v126, v76, v77
v_cvt_pk_bf16_f32 v127, v78, v79
v_lshrrev_b32 v164, 2, v0
v_and_b32 v165, 3, v0
v_lshlrev_b32 v165, 3, v165
v_lshl_add_u32 v166, v164, 6, v165
v_lshl_add_u32 v165, v164, 9, v165
v_add_u32 v165, 131072, v165
v_and_b32 v164, 7, v164
s_lshl_b32 s36, s20, 2
v_xor_b32 v164, s36, v164
s_and_b32 s36, s20, 1
s_lshl_b32 s36, s36, 5
s_add_u32 s36, s36, 147456
v_add_u32 v166, s36, v166
v_xor_b32 v168, 0, v164
v_lshl_add_u32 v168, v168, 5, v165
ds_read_b64_tr_b16 v[144:145], v168 offset:0
ds_read_b64_tr_b16 v[146:147], v168 offset:8192
v_xor_b32 v169, 1, v164
v_lshl_add_u32 v169, v169, 5, v165
ds_read_b64_tr_b16 v[148:149], v169 offset:0
ds_read_b64_tr_b16 v[150:151], v169 offset:8192
v_xor_b32 v170, 2, v164
v_lshl_add_u32 v170, v170, 5, v165
ds_read_b64_tr_b16 v[152:153], v170 offset:0
ds_read_b64_tr_b16 v[154:155], v170 offset:8192
v_xor_b32 v171, 3, v164
v_lshl_add_u32 v171, v171, 5, v165
ds_read_b64_tr_b16 v[156:157], v171 offset:0
ds_read_b64_tr_b16 v[158:159], v171 offset:8192
ds_read_b64_tr_b16 v[160:161], v166 offset:0
ds_read_b64_tr_b16 v[162:163], v166 offset:1024
s_and_b32 s36, s2, 1
s_lshl_b32 s36, s36, 2
s_add_u32 s36, s36, s20
s_mul_i32 s36, s36, 589824
s_lshr_b32 s37, s2, 1
s_lshl_b32 s37, s37, 12
s_add_u32 s36, s36, s37
s_add_u32 s36, s36, 83886080
s_waitcnt lgkmcnt(8)
buffer_store_dwordx4 v[144:147], v1, s[8:11], s36 offen offset:0 sc1
s_waitcnt lgkmcnt(6)
buffer_store_dwordx4 v[148:151], v1, s[8:11], s36 offen offset:1024 sc1
s_waitcnt lgkmcnt(4)
buffer_store_dwordx4 v[152:155], v1, s[8:11], s36 offen offset:2048 sc1
s_waitcnt lgkmcnt(2)
buffer_store_dwordx4 v[156:159], v1, s[8:11], s36 offen offset:3072 sc1
s_bfe_u32 s36, s2, 0x30001
s_mul_i32 s36, s36, 589824
s_and_b32 s37, s2, 1
s_lshl_b32 s37, s37, 11
s_add_u32 s36, s36, s37
s_and_b32 s37, s20, 1
s_lshl_b32 s37, s37, 10
s_add_u32 s36, s36, s37
s_lshr_b32 s37, s2, 4
s_lshl_b32 s37, s37, 12
s_add_u32 s36, s36, s37
s_add_u32 s36, s36, 84410368
s_waitcnt lgkmcnt(0)
buffer_store_dwordx4 v[160:163], v1, s[8:11], s36 offen sc1
s_nop 0
s_lshl_b32 s36, s21, 14
s_add_u32 s36, s36, 58720256
s_and_b32 s37, s20, 1
s_lshl_b32 s37, s37, 11
s_add_u32 s36, s36, s37
s_lshr_b32 s37, s20, 1
s_mul_i32 s37, s37, 589824
s_add_u32 s36, s36, s37
s_mul_i32 s37, s22, 1179648
s_add_u32 s36, s36, s37
s_add_u32 s37, s36, 4096
s_add_u32 s38, s36, 8192
s_add_u32 s39, s36, 12288
v_mov_b32 v16, v8
s_nop 1
v_permlane32_swap_b32 v8, v16
v_add_f32 v8, v8, v16
v_mov_b32 v16, v8
s_nop 1
v_permlane16_swap_b32 v8, v16
v_add_f32 v8, v8, v16
v_rcp_f32 v8, v8
v_mov_b32 v16, v9
s_nop 1
v_permlane32_swap_b32 v9, v16
v_add_f32 v9, v9, v16
v_mov_b32 v16, v9
s_nop 1
v_permlane16_swap_b32 v9, v16
v_add_f32 v9, v9, v16
v_rcp_f32 v9, v9
v_accvgpr_read_b32 v144, a0
v_accvgpr_read_b32 v145, a1
v_accvgpr_read_b32 v146, a2
v_accvgpr_read_b32 v147, a3
v_accvgpr_read_b32 v148, a4
v_accvgpr_read_b32 v149, a5
v_accvgpr_read_b32 v150, a6
v_accvgpr_read_b32 v151, a7
v_accvgpr_read_b32 v152, a8
v_accvgpr_read_b32 v153, a9
v_accvgpr_read_b32 v154, a10
v_accvgpr_read_b32 v155, a11
v_accvgpr_read_b32 v156, a12
v_accvgpr_read_b32 v157, a13
v_accvgpr_read_b32 v158, a14
v_accvgpr_read_b32 v159, a15
v_mul_f32 v144, v144, v8
v_mul_f32 v145, v145, v8
v_mul_f32 v146, v146, v8
v_mul_f32 v147, v147, v8
v_mul_f32 v148, v148, v8
v_mul_f32 v149, v149, v8
v_mul_f32 v150, v150, v8
v_mul_f32 v151, v151, v8
v_mul_f32 v152, v152, v8
v_mul_f32 v153, v153, v8
v_mul_f32 v154, v154, v8
v_mul_f32 v155, v155, v8
v_mul_f32 v156, v156, v8
v_mul_f32 v157, v157, v8
v_mul_f32 v158, v158, v8
v_mul_f32 v159, v159, v8
v_cvt_pk_bf16_f32 v240, v144, v145
v_cvt_pk_bf16_f32 v241, v146, v147
v_cvt_pk_bf16_f32 v242, v148, v149
v_cvt_pk_bf16_f32 v243, v150, v151
v_cvt_pk_bf16_f32 v244, v152, v153
v_cvt_pk_bf16_f32 v245, v154, v155
v_cvt_pk_bf16_f32 v246, v156, v157
v_cvt_pk_bf16_f32 v247, v158, v159
buffer_store_dwordx4 v[240:243], v1, s[8:11], s36 offen offset:0 sc1
buffer_store_dwordx4 v[244:247], v1, s[8:11], s37 offen offset:0 sc1
v_accvgpr_read_b32 v160, a16
v_accvgpr_read_b32 v161, a17
v_accvgpr_read_b32 v162, a18
v_accvgpr_read_b32 v163, a19
v_accvgpr_read_b32 v164, a20
v_accvgpr_read_b32 v165, a21
v_accvgpr_read_b32 v166, a22
v_accvgpr_read_b32 v167, a23
v_accvgpr_read_b32 v168, a24
v_accvgpr_read_b32 v169, a25
v_accvgpr_read_b32 v170, a26
v_accvgpr_read_b32 v171, a27
v_accvgpr_read_b32 v172, a28
v_accvgpr_read_b32 v173, a29
v_accvgpr_read_b32 v174, a30
v_accvgpr_read_b32 v175, a31
v_mul_f32 v160, v160, v8
v_mul_f32 v161, v161, v8
v_mul_f32 v162, v162, v8
v_mul_f32 v163, v163, v8
v_mul_f32 v164, v164, v8
v_mul_f32 v165, v165, v8
v_mul_f32 v166, v166, v8
v_mul_f32 v167, v167, v8
v_mul_f32 v168, v168, v8
v_mul_f32 v169, v169, v8
v_mul_f32 v170, v170, v8
v_mul_f32 v171, v171, v8
v_mul_f32 v172, v172, v8
v_mul_f32 v173, v173, v8
v_mul_f32 v174, v174, v8
v_mul_f32 v175, v175, v8
v_cvt_pk_bf16_f32 v248, v160, v161
v_cvt_pk_bf16_f32 v249, v162, v163
v_cvt_pk_bf16_f32 v250, v164, v165
v_cvt_pk_bf16_f32 v251, v166, v167
v_cvt_pk_bf16_f32 v252, v168, v169
v_cvt_pk_bf16_f32 v253, v170, v171
v_cvt_pk_bf16_f32 v254, v172, v173
v_cvt_pk_bf16_f32 v255, v174, v175
buffer_store_dwordx4 v[248:251], v1, s[8:11], s38 offen offset:0 sc1
buffer_store_dwordx4 v[252:255], v1, s[8:11], s39 offen offset:0 sc1
v_accvgpr_read_b32 v144, a32
v_accvgpr_read_b32 v145, a33
v_accvgpr_read_b32 v146, a34
v_accvgpr_read_b32 v147, a35
v_accvgpr_read_b32 v148, a36
v_accvgpr_read_b32 v149, a37
v_accvgpr_read_b32 v150, a38
v_accvgpr_read_b32 v151, a39
v_accvgpr_read_b32 v152, a40
v_accvgpr_read_b32 v153, a41
v_accvgpr_read_b32 v154, a42
v_accvgpr_read_b32 v155, a43
v_accvgpr_read_b32 v156, a44
v_accvgpr_read_b32 v157, a45
v_accvgpr_read_b32 v158, a46
v_accvgpr_read_b32 v159, a47
v_mul_f32 v144, v144, v9
v_mul_f32 v145, v145, v9
v_mul_f32 v146, v146, v9
v_mul_f32 v147, v147, v9
v_mul_f32 v148, v148, v9
v_mul_f32 v149, v149, v9
v_mul_f32 v150, v150, v9
v_mul_f32 v151, v151, v9
v_mul_f32 v152, v152, v9
v_mul_f32 v153, v153, v9
v_mul_f32 v154, v154, v9
v_mul_f32 v155, v155, v9
v_mul_f32 v156, v156, v9
v_mul_f32 v157, v157, v9
v_mul_f32 v158, v158, v9
v_mul_f32 v159, v159, v9
v_cvt_pk_bf16_f32 v240, v144, v145
v_cvt_pk_bf16_f32 v241, v146, v147
v_cvt_pk_bf16_f32 v242, v148, v149
v_cvt_pk_bf16_f32 v243, v150, v151
v_cvt_pk_bf16_f32 v244, v152, v153
v_cvt_pk_bf16_f32 v245, v154, v155
v_cvt_pk_bf16_f32 v246, v156, v157
v_cvt_pk_bf16_f32 v247, v158, v159
buffer_store_dwordx4 v[240:243], v1, s[8:11], s36 offen offset:1024 sc1
buffer_store_dwordx4 v[244:247], v1, s[8:11], s37 offen offset:1024 sc1
v_accvgpr_read_b32 v160, a48
v_accvgpr_read_b32 v161, a49
v_accvgpr_read_b32 v162, a50
v_accvgpr_read_b32 v163, a51
v_accvgpr_read_b32 v164, a52
v_accvgpr_read_b32 v165, a53
v_accvgpr_read_b32 v166, a54
v_accvgpr_read_b32 v167, a55
v_accvgpr_read_b32 v168, a56
v_accvgpr_read_b32 v169, a57
v_accvgpr_read_b32 v170, a58
v_accvgpr_read_b32 v171, a59
v_accvgpr_read_b32 v172, a60
v_accvgpr_read_b32 v173, a61
v_accvgpr_read_b32 v174, a62
v_accvgpr_read_b32 v175, a63
v_mul_f32 v160, v160, v9
v_mul_f32 v161, v161, v9
v_mul_f32 v162, v162, v9
v_mul_f32 v163, v163, v9
v_mul_f32 v164, v164, v9
v_mul_f32 v165, v165, v9
v_mul_f32 v166, v166, v9
v_mul_f32 v167, v167, v9
v_mul_f32 v168, v168, v9
v_mul_f32 v169, v169, v9
v_mul_f32 v170, v170, v9
v_mul_f32 v171, v171, v9
v_mul_f32 v172, v172, v9
v_mul_f32 v173, v173, v9
v_mul_f32 v174, v174, v9
v_mul_f32 v175, v175, v9
v_cvt_pk_bf16_f32 v248, v160, v161
v_cvt_pk_bf16_f32 v249, v162, v163
v_cvt_pk_bf16_f32 v250, v164, v165
v_cvt_pk_bf16_f32 v251, v166, v167
v_cvt_pk_bf16_f32 v252, v168, v169
v_cvt_pk_bf16_f32 v253, v170, v171
v_cvt_pk_bf16_f32 v254, v172, v173
v_cvt_pk_bf16_f32 v255, v174, v175
buffer_store_dwordx4 v[248:251], v1, s[8:11], s38 offen offset:1024 sc1
buffer_store_dwordx4 v[252:255], v1, s[8:11], s39 offen offset:1024 sc1
s_lshl_b32 s27, s22, 1
s_sub_u32 s27, 13, s27
.p2align 6
K2_SS:
s_waitcnt lgkmcnt(8)
v_mfma_f32_16x16x32_bf16 a[64:67], a[128:131], v[112:115], a[64:67]
ds_read_b128 a[176:179], v2 offset:6144
v_exp_f32 v80, v80
v_mfma_f32_16x16x32_bf16 a[64:67], a[132:135], v[120:123], a[64:67]
s_add_u32 m0, s26, s49
v_exp_f32 v81, v81
v_mfma_f32_16x16x32_bf16 a[96:99], a[128:131], v[116:119], a[96:99]
ds_read_b128 a[180:183], v2 offset:14336
v_exp_f32 v82, v82
v_mfma_f32_16x16x32_bf16 a[96:99], a[132:135], v[124:127], a[96:99]
global_load_lds_dwordx4 v1, s[86:87] offset:0 sc1
v_add_u32 v3, s25, v1
v_mfma_f32_16x16x32_bf16 a[68:71], a[136:139], v[112:115], a[68:71]
ds_read_b128 a[184:187], v2 offset:7168
v_exp_f32 v83, v83
v_mfma_f32_16x16x32_bf16 a[68:71], a[140:143], v[120:123], a[68:71]
v_exp_f32 v84, v84
v_mfma_f32_16x16x32_bf16 a[100:103], a[136:139], v[116:119], a[100:103]
ds_read_b128 a[188:191], v2 offset:15360
v_exp_f32 v85, v85
v_mfma_f32_16x16x32_bf16 a[100:103], a[140:143], v[124:127], a[100:103]
s_waitcnt lgkmcnt(8)
v_exp_f32 v86, v86
v_mfma_f32_16x16x32_bf16 a[72:75], a[144:147], v[112:115], a[72:75]
ds_read_b128 a[128:131], v2 offset:16384
v_exp_f32 v87, v87
v_mfma_f32_16x16x32_bf16 a[72:75], a[148:151], v[120:123], a[72:75]
global_load_lds_dwordx4 v1, s[86:87] offset:1024 sc1
v_add_f32 v10, v10, v14
v_mfma_f32_16x16x32_bf16 a[104:107], a[144:147], v[116:119], a[104:107]
ds_read_b128 a[132:135], v2 offset:18432
v_exp_f32 v88, v88
v_mfma_f32_16x16x32_bf16 a[104:107], a[148:151], v[124:127], a[104:107]
v_exp_f32 v89, v89
v_mfma_f32_16x16x32_bf16 a[76:79], a[152:155], v[112:115], a[76:79]
ds_read_b128 a[136:139], v2 offset:20480
v_exp_f32 v90, v90
v_mfma_f32_16x16x32_bf16 a[76:79], a[156:159], v[120:123], a[76:79]
global_load_lds_dwordx4 v1, s[86:87] offset:2048 sc1
v_add_f32 v11, v11, v15
v_mfma_f32_16x16x32_bf16 a[108:111], a[152:155], v[116:119], a[108:111]
ds_read_b128 a[140:143], v2 offset:22528
v_exp_f32 v91, v91
v_mfma_f32_16x16x32_bf16 a[108:111], a[156:159], v[124:127], a[108:111]
s_waitcnt lgkmcnt(8)
v_exp_f32 v92, v92
v_mfma_f32_16x16x32_bf16 a[80:83], a[160:163], v[112:115], a[80:83]
ds_read_b128 a[144:147], v2 offset:17408
v_add_f32 v14, v80, v81
v_mfma_f32_16x16x32_bf16 a[80:83], a[164:167], v[120:123], a[80:83]
global_load_lds_dwordx4 v1, s[86:87] offset:3072 sc1
v_exp_f32 v93, v93
v_mfma_f32_16x16x32_bf16 a[112:115], a[160:163], v[116:119], a[112:115]
ds_read_b128 a[148:151], v2 offset:19456
v_cvt_pk_bf16_f32 v128, v80, v81
v_mfma_f32_16x16x32_bf16 a[112:115], a[164:167], v[124:127], a[112:115]
s_add_u32 s86, s86, 16384
s_addc_u32 s87, s87, 0
v_exp_f32 v94, v94
v_mfma_f32_16x16x32_bf16 a[84:87], a[168:171], v[112:115], a[84:87]
ds_read_b128 a[152:155], v2 offset:21504
v_add_f32 v14, v14, v82
v_mfma_f32_16x16x32_bf16 a[84:87], a[172:175], v[120:123], a[84:87]
s_add_u32 m0, s26, s59
v_exp_f32 v95, v95
v_add_f32 v14, v14, v83
v_mfma_f32_16x16x32_bf16 a[116:119], a[168:171], v[116:119], a[116:119]
ds_read_b128 a[156:159], v2 offset:23552
v_cvt_pk_bf16_f32 v129, v82, v83
v_mfma_f32_16x16x32_bf16 a[116:119], a[172:175], v[124:127], a[116:119]
s_waitcnt lgkmcnt(8)
v_exp_f32 v96, v96
v_add_f32 v15, v84, v85
v_mfma_f32_16x16x32_bf16 a[88:91], a[176:179], v[112:115], a[88:91]
ds_read_b128 a[160:163], v2 offset:24576
v_cvt_pk_bf16_f32 v132, v84, v85
v_mfma_f32_16x16x32_bf16 a[88:91], a[180:183], v[120:123], a[88:91]
global_load_lds_dwordx4 v1, s[84:85] offset:0 sc1
v_exp_f32 v97, v97
v_mfma_f32_16x16x32_bf16 a[120:123], a[176:179], v[116:119], a[120:123]
ds_read_b128 a[164:167], v2 offset:26624
v_add_f32 v15, v15, v86
v_mfma_f32_16x16x32_bf16 a[120:123], a[180:183], v[124:127], a[120:123]
v_exp_f32 v98, v98
v_add_f32 v15, v15, v87
v_mfma_f32_16x16x32_bf16 a[92:95], a[184:187], v[112:115], a[92:95]
ds_read_b128 a[168:171], v2 offset:28672
v_cvt_pk_bf16_f32 v133, v86, v87
v_mfma_f32_16x16x32_bf16 a[92:95], a[188:191], v[120:123], a[92:95]
global_load_lds_dwordx4 v1, s[84:85] offset:1024 sc1
v_exp_f32 v99, v99
v_mfma_f32_16x16x32_bf16 a[124:127], a[184:187], v[116:119], a[124:127]
ds_read_b128 a[172:175], v2 offset:30720
v_add_f32 v14, v14, v88
v_mfma_f32_16x16x32_bf16 a[124:127], a[188:191], v[124:127], a[124:127]
s_waitcnt lgkmcnt(8)
v_exp_f32 v100, v100
v_mfma_f32_16x16x32_bf16 v[48:51], a[128:131], v[208:211], v[28:31]
ds_read_b128 a[176:179], v2 offset:25600
v_exp_f32 v101, v101
v_mfma_f32_16x16x32_bf16 v[48:51], a[132:135], v[212:215], v[48:51]
global_load_lds_dwordx4 v1, s[84:85] offset:2048 sc1
v_add_f32 v14, v14, v89
v_mfma_f32_16x16x32_bf16 v[48:51], a[136:139], v[216:219], v[48:51]
ds_read_b128 a[180:183], v2 offset:27648
v_exp_f32 v102, v102
v_mfma_f32_16x16x32_bf16 v[48:51], a[140:143], v[220:223], v[48:51]
v_exp_f32 v103, v103
v_mfma_f32_16x16x32_bf16 v[52:55], a[128:131], v[224:227], v[32:35]
ds_read_b128 a[184:187], v2 offset:29696
v_exp_f32 v104, v104
v_mfma_f32_16x16x32_bf16 v[52:55], a[132:135], v[228:231], v[52:55]
s_waitcnt vmcnt(7)
s_barrier
v_cvt_pk_bf16_f32 v130, v88, v89
v_mfma_f32_16x16x32_bf16 v[52:55], a[136:139], v[232:235], v[52:55]
ds_read_b128 a[188:191], v2 offset:31744
v_exp_f32 v105, v105
v_mfma_f32_16x16x32_bf16 v[52:55], a[140:143], v[236:239], v[52:55]
s_waitcnt lgkmcnt(8)
v_exp_f32 v106, v106
v_mfma_f32_16x16x32_bf16 v[56:59], a[144:147], v[208:211], v[28:31]
ds_read_b128 a[128:131], v3 offset:0
v_exp_f32 v107, v107
v_mfma_f32_16x16x32_bf16 v[56:59], a[148:151], v[212:215], v[56:59]
global_load_lds_dwordx4 v1, s[84:85] offset:3072 sc1
v_add_f32 v14, v14, v90
v_mfma_f32_16x16x32_bf16 v[56:59], a[152:155], v[216:219], v[56:59]
ds_read_b128 a[132:135], v3 offset:8192
v_exp_f32 v108, v108
v_mfma_f32_16x16x32_bf16 v[56:59], a[156:159], v[220:223], v[56:59]
s_add_u32 s84, s84, 16384
s_addc_u32 s85, s85, 0
v_add_f32 v14, v14, v91
v_mfma_f32_16x16x32_bf16 v[60:63], a[144:147], v[224:227], v[32:35]
ds_read_b128 a[136:139], v3 offset:1024
v_exp_f32 v109, v109
v_mfma_f32_16x16x32_bf16 v[60:63], a[148:151], v[228:231], v[60:63]
s_add_u32 s25, s25, 32768
v_exp_f32 v110, v110
v_mfma_f32_16x16x32_bf16 v[60:63], a[152:155], v[232:235], v[60:63]
ds_read_b128 a[140:143], v3 offset:9216
v_exp_f32 v111, v111
v_mfma_f32_16x16x32_bf16 v[60:63], a[156:159], v[236:239], v[60:63]
s_waitcnt lgkmcnt(8)
v_cvt_pk_bf16_f32 v131, v90, v91
v_add_f32 v15, v15, v92
v_mfma_f32_16x16x32_bf16 v[64:67], a[160:163], v[208:211], v[28:31]
ds_read_b128 a[144:147], v3 offset:2048
v_add_f32 v15, v15, v93
v_mfma_f32_16x16x32_bf16 v[64:67], a[164:167], v[212:215], v[64:67]
s_and_b32 s25, s25, 0x1ffff
v_cvt_pk_bf16_f32 v134, v92, v93
v_add_f32 v15, v15, v94
v_add_f32 v15, v15, v95
v_mfma_f32_16x16x32_bf16 v[64:67], a[168:171], v[216:219], v[64:67]
ds_read_b128 a[148:151], v3 offset:10240
v_cvt_pk_bf16_f32 v135, v94, v95
v_mfma_f32_16x16x32_bf16 v[64:67], a[172:175], v[220:223], v[64:67]
s_add_u32 s26, s26, 32768
v_add_f32 v14, v14, v96
v_add_f32 v14, v14, v97
v_cvt_pk_bf16_f32 v136, v96, v97
v_mfma_f32_16x16x32_bf16 v[68:71], a[160:163], v[224:227], v[32:35]
ds_read_b128 a[152:155], v3 offset:3072
v_add_f32 v14, v14, v98
v_mfma_f32_16x16x32_bf16 v[68:71], a[164:167], v[228:231], v[68:71]
s_and_b32 s26, s26, 0x1ffff
v_add_f32 v14, v14, v99
v_cvt_pk_bf16_f32 v137, v98, v99
v_add_f32 v15, v15, v100
v_mfma_f32_16x16x32_bf16 v[68:71], a[168:171], v[232:235], v[68:71]
ds_read_b128 a[156:159], v3 offset:11264
v_add_f32 v15, v15, v101
v_mfma_f32_16x16x32_bf16 v[68:71], a[172:175], v[236:239], v[68:71]
s_waitcnt lgkmcnt(8)
v_add_f32 v15, v15, v102
v_add_f32 v15, v15, v103
v_add_f32 v14, v14, v104
v_mfma_f32_16x16x32_bf16 v[72:75], a[176:179], v[208:211], v[28:31]
ds_read_b128 a[160:163], v3 offset:4096
v_add_f32 v14, v14, v105
v_mfma_f32_16x16x32_bf16 v[72:75], a[180:183], v[212:215], v[72:75]
s_add_u32 s28, s28, 16384
v_add_f32 v14, v14, v106
v_add_f32 v14, v14, v107
v_add_f32 v15, v15, v108
v_mfma_f32_16x16x32_bf16 v[72:75], a[184:187], v[216:219], v[72:75]
ds_read_b128 a[164:167], v3 offset:12288
v_add_f32 v15, v15, v109
v_mfma_f32_16x16x32_bf16 v[72:75], a[188:191], v[220:223], v[72:75]
s_mov_b32 s29, -4096
v_add_f32 v15, v15, v110
v_add_f32 v15, v15, v111
v_max_f32 v16, v14, v15
v_mfma_f32_16x16x32_bf16 v[76:79], a[176:179], v[224:227], v[32:35]
ds_read_b128 a[168:171], v3 offset:5120
v_cmp_nge_f32 vcc, 0x53800000, v16
v_mfma_f32_16x16x32_bf16 v[76:79], a[180:183], v[228:231], v[76:79]
v_cvt_pk_bf16_f32 v140, v100, v101
v_cvt_pk_bf16_f32 v141, v102, v103
v_cvt_pk_bf16_f32 v138, v104, v105
v_mfma_f32_16x16x32_bf16 v[76:79], a[184:187], v[232:235], v[76:79]
ds_read_b128 a[172:175], v3 offset:13312
v_cvt_pk_bf16_f32 v139, v106, v107
v_mfma_f32_16x16x32_bf16 v[76:79], a[188:191], v[236:239], v[76:79]
s_cbranch_vccnz K2_S_SSa
K2_R_SSa:
v_cvt_pk_bf16_f32 v142, v108, v109
v_cvt_pk_bf16_f32 v143, v110, v111
s_waitcnt lgkmcnt(8)
v_mfma_f32_16x16x32_bf16 a[64:67], a[128:131], v[128:131], a[64:67]
ds_read_b128 a[176:179], v3 offset:6144
v_exp_f32 v48, v48
v_mfma_f32_16x16x32_bf16 a[64:67], a[132:135], v[136:139], a[64:67]
s_add_u32 m0, s26, s49
v_exp_f32 v49, v49
v_mfma_f32_16x16x32_bf16 a[96:99], a[128:131], v[132:135], a[96:99]
ds_read_b128 a[180:183], v3 offset:14336
v_exp_f32 v50, v50
v_mfma_f32_16x16x32_bf16 a[96:99], a[132:135], v[140:143], a[96:99]
global_load_lds_dwordx4 v1, s[86:87] offset:0 sc1
v_add_u32 v2, s25, v1
v_mfma_f32_16x16x32_bf16 a[68:71], a[136:139], v[128:131], a[68:71]
ds_read_b128 a[184:187], v3 offset:7168
v_exp_f32 v51, v51
v_mfma_f32_16x16x32_bf16 a[68:71], a[140:143], v[136:139], a[68:71]
v_exp_f32 v52, v52
v_mfma_f32_16x16x32_bf16 a[100:103], a[136:139], v[132:135], a[100:103]
ds_read_b128 a[188:191], v3 offset:15360
v_exp_f32 v53, v53
v_mfma_f32_16x16x32_bf16 a[100:103], a[140:143], v[140:143], a[100:103]
s_waitcnt lgkmcnt(8)
v_exp_f32 v54, v54
v_mfma_f32_16x16x32_bf16 a[72:75], a[144:147], v[128:131], a[72:75]
ds_read_b128 a[128:131], v3 offset:16384
v_exp_f32 v55, v55
v_mfma_f32_16x16x32_bf16 a[72:75], a[148:151], v[136:139], a[72:75]
global_load_lds_dwordx4 v1, s[86:87] offset:1024 sc1
v_add_f32 v10, v10, v14
v_mfma_f32_16x16x32_bf16 a[104:107], a[144:147], v[132:135], a[104:107]
ds_read_b128 a[132:135], v3 offset:18432
v_exp_f32 v56, v56
v_mfma_f32_16x16x32_bf16 a[104:107], a[148:151], v[140:143], a[104:107]
v_exp_f32 v57, v57
v_mfma_f32_16x16x32_bf16 a[76:79], a[152:155], v[128:131], a[76:79]
ds_read_b128 a[136:139], v3 offset:20480
v_exp_f32 v58, v58
v_mfma_f32_16x16x32_bf16 a[76:79], a[156:159], v[136:139], a[76:79]
global_load_lds_dwordx4 v1, s[86:87] offset:2048 sc1
v_add_f32 v11, v11, v15
v_mfma_f32_16x16x32_bf16 a[108:111], a[152:155], v[132:135], a[108:111]
ds_read_b128 a[140:143], v3 offset:22528
v_exp_f32 v59, v59
v_mfma_f32_16x16x32_bf16 a[108:111], a[156:159], v[140:143], a[108:111]
s_waitcnt lgkmcnt(8)
v_exp_f32 v60, v60
v_mfma_f32_16x16x32_bf16 a[80:83], a[160:163], v[128:131], a[80:83]
ds_read_b128 a[144:147], v3 offset:17408
v_add_f32 v14, v48, v49
v_mfma_f32_16x16x32_bf16 a[80:83], a[164:167], v[136:139], a[80:83]
global_load_lds_dwordx4 v1, s[86:87] offset:3072 sc1
v_exp_f32 v61, v61
v_mfma_f32_16x16x32_bf16 a[112:115], a[160:163], v[132:135], a[112:115]
ds_read_b128 a[148:151], v3 offset:19456
v_cvt_pk_bf16_f32 v112, v48, v49
v_mfma_f32_16x16x32_bf16 a[112:115], a[164:167], v[140:143], a[112:115]
s_add_u32 s86, s86, 16384
s_addc_u32 s87, s87, 0
v_exp_f32 v62, v62
v_mfma_f32_16x16x32_bf16 a[84:87], a[168:171], v[128:131], a[84:87]
ds_read_b128 a[152:155], v3 offset:21504
v_add_f32 v14, v14, v50
v_mfma_f32_16x16x32_bf16 a[84:87], a[172:175], v[136:139], a[84:87]
s_add_u32 m0, s26, s59
v_exp_f32 v63, v63
v_add_f32 v14, v14, v51
v_mfma_f32_16x16x32_bf16 a[116:119], a[168:171], v[132:135], a[116:119]
ds_read_b128 a[156:159], v3 offset:23552
v_cvt_pk_bf16_f32 v113, v50, v51
v_mfma_f32_16x16x32_bf16 a[116:119], a[172:175], v[140:143], a[116:119]
s_waitcnt lgkmcnt(8)
v_exp_f32 v64, v64
v_add_f32 v15, v52, v53
v_mfma_f32_16x16x32_bf16 a[88:91], a[176:179], v[128:131], a[88:91]
ds_read_b128 a[160:163], v3 offset:24576
v_cvt_pk_bf16_f32 v116, v52, v53
v_mfma_f32_16x16x32_bf16 a[88:91], a[180:183], v[136:139], a[88:91]
global_load_lds_dwordx4 v1, s[84:85] offset:0 sc1
v_exp_f32 v65, v65
v_mfma_f32_16x16x32_bf16 a[120:123], a[176:179], v[132:135], a[120:123]
ds_read_b128 a[164:167], v3 offset:26624
v_add_f32 v15, v15, v54
v_mfma_f32_16x16x32_bf16 a[120:123], a[180:183], v[140:143], a[120:123]
v_exp_f32 v66, v66
v_add_f32 v15, v15, v55
v_mfma_f32_16x16x32_bf16 a[92:95], a[184:187], v[128:131], a[92:95]
ds_read_b128 a[168:171], v3 offset:28672
v_cvt_pk_bf16_f32 v117, v54, v55
v_mfma_f32_16x16x32_bf16 a[92:95], a[188:191], v[136:139], a[92:95]
global_load_lds_dwordx4 v1, s[84:85] offset:1024 sc1
v_exp_f32 v67, v67
v_mfma_f32_16x16x32_bf16 a[124:127], a[184:187], v[132:135], a[124:127]
ds_read_b128 a[172:175], v3 offset:30720
v_add_f32 v14, v14, v56
v_mfma_f32_16x16x32_bf16 a[124:127], a[188:191], v[140:143], a[124:127]
s_waitcnt lgkmcnt(8)
v_exp_f32 v68, v68
v_mfma_f32_16x16x32_bf16 v[80:83], a[128:131], v[208:211], v[28:31]
ds_read_b128 a[176:179], v3 offset:25600
v_exp_f32 v69, v69
v_mfma_f32_16x16x32_bf16 v[80:83], a[132:135], v[212:215], v[80:83]
global_load_lds_dwordx4 v1, s[84:85] offset:2048 sc1
v_add_f32 v14, v14, v57
v_mfma_f32_16x16x32_bf16 v[80:83], a[136:139], v[216:219], v[80:83]
ds_read_b128 a[180:183], v3 offset:27648
v_exp_f32 v70, v70
v_mfma_f32_16x16x32_bf16 v[80:83], a[140:143], v[220:223], v[80:83]
v_exp_f32 v71, v71
v_mfma_f32_16x16x32_bf16 v[84:87], a[128:131], v[224:227], v[32:35]
ds_read_b128 a[184:187], v3 offset:29696
v_exp_f32 v72, v72
v_mfma_f32_16x16x32_bf16 v[84:87], a[132:135], v[228:231], v[84:87]
s_waitcnt vmcnt(7)
s_barrier
v_cvt_pk_bf16_f32 v114, v56, v57
v_mfma_f32_16x16x32_bf16 v[84:87], a[136:139], v[232:235], v[84:87]
ds_read_b128 a[188:191], v3 offset:31744
v_exp_f32 v73, v73
v_mfma_f32_16x16x32_bf16 v[84:87], a[140:143], v[236:239], v[84:87]
s_waitcnt lgkmcnt(8)
v_exp_f32 v74, v74
v_mfma_f32_16x16x32_bf16 v[88:91], a[144:147], v[208:211], v[28:31]
ds_read_b128 a[128:131], v2 offset:0
v_exp_f32 v75, v75
v_mfma_f32_16x16x32_bf16 v[88:91], a[148:151], v[212:215], v[88:91]
global_load_lds_dwordx4 v1, s[84:85] offset:3072 sc1
v_add_f32 v14, v14, v58
v_mfma_f32_16x16x32_bf16 v[88:91], a[152:155], v[216:219], v[88:91]
ds_read_b128 a[132:135], v2 offset:8192
v_exp_f32 v76, v76
v_mfma_f32_16x16x32_bf16 v[88:91], a[156:159], v[220:223], v[88:91]
s_add_u32 s84, s84, 16384
s_addc_u32 s85, s85, 0
v_add_f32 v14, v14, v59
v_mfma_f32_16x16x32_bf16 v[92:95], a[144:147], v[224:227], v[32:35]
ds_read_b128 a[136:139], v2 offset:1024
v_exp_f32 v77, v77
v_mfma_f32_16x16x32_bf16 v[92:95], a[148:151], v[228:231], v[92:95]
s_add_u32 s25, s25, 32768
v_exp_f32 v78, v78
v_mfma_f32_16x16x32_bf16 v[92:95], a[152:155], v[232:235], v[92:95]
ds_read_b128 a[140:143], v2 offset:9216
v_exp_f32 v79, v79
v_mfma_f32_16x16x32_bf16 v[92:95], a[156:159], v[236:239], v[92:95]
s_waitcnt lgkmcnt(8)
v_cvt_pk_bf16_f32 v115, v58, v59
v_add_f32 v15, v15, v60
v_mfma_f32_16x16x32_bf16 v[96:99], a[160:163], v[208:211], v[28:31]
ds_read_b128 a[144:147], v2 offset:2048
v_add_f32 v15, v15, v61
v_mfma_f32_16x16x32_bf16 v[96:99], a[164:167], v[212:215], v[96:99]
s_and_b32 s25, s25, 0x1ffff
v_cvt_pk_bf16_f32 v118, v60, v61
v_add_f32 v15, v15, v62
v_add_f32 v15, v15, v63
v_mfma_f32_16x16x32_bf16 v[96:99], a[168:171], v[216:219], v[96:99]
ds_read_b128 a[148:151], v2 offset:10240
v_cvt_pk_bf16_f32 v119, v62, v63
v_mfma_f32_16x16x32_bf16 v[96:99], a[172:175], v[220:223], v[96:99]
s_add_u32 s26, s26, 32768
v_add_f32 v14, v14, v64
v_add_f32 v14, v14, v65
v_cvt_pk_bf16_f32 v120, v64, v65
v_mfma_f32_16x16x32_bf16 v[100:103], a[160:163], v[224:227], v[32:35]
ds_read_b128 a[152:155], v2 offset:3072
v_add_f32 v14, v14, v66
v_mfma_f32_16x16x32_bf16 v[100:103], a[164:167], v[228:231], v[100:103]
s_and_b32 s26, s26, 0x1ffff
v_add_f32 v14, v14, v67
v_cvt_pk_bf16_f32 v121, v66, v67
v_add_f32 v15, v15, v68
v_mfma_f32_16x16x32_bf16 v[100:103], a[168:171], v[232:235], v[100:103]
ds_read_b128 a[156:159], v2 offset:11264
v_add_f32 v15, v15, v69
v_mfma_f32_16x16x32_bf16 v[100:103], a[172:175], v[236:239], v[100:103]
s_waitcnt lgkmcnt(8)
v_add_f32 v15, v15, v70
v_add_f32 v15, v15, v71
v_add_f32 v14, v14, v72
v_mfma_f32_16x16x32_bf16 v[104:107], a[176:179], v[208:211], v[28:31]
ds_read_b128 a[160:163], v2 offset:4096
v_add_f32 v14, v14, v73
v_mfma_f32_16x16x32_bf16 v[104:107], a[180:183], v[212:215], v[104:107]
s_add_u32 s28, s28, 16384
v_add_f32 v14, v14, v74
v_add_f32 v14, v14, v75
v_add_f32 v15, v15, v76
v_mfma_f32_16x16x32_bf16 v[104:107], a[184:187], v[216:219], v[104:107]
ds_read_b128 a[164:167], v2 offset:12288
v_add_f32 v15, v15, v77
v_mfma_f32_16x16x32_bf16 v[104:107], a[188:191], v[220:223], v[104:107]
s_mov_b32 s29, -4096
v_add_f32 v15, v15, v78
v_add_f32 v15, v15, v79
v_max_f32 v16, v14, v15
v_mfma_f32_16x16x32_bf16 v[108:111], a[176:179], v[224:227], v[32:35]
ds_read_b128 a[168:171], v2 offset:5120
v_cmp_nge_f32 vcc, 0x53800000, v16
v_mfma_f32_16x16x32_bf16 v[108:111], a[180:183], v[228:231], v[108:111]
v_cvt_pk_bf16_f32 v124, v68, v69
v_cvt_pk_bf16_f32 v125, v70, v71
v_cvt_pk_bf16_f32 v122, v72, v73
v_mfma_f32_16x16x32_bf16 v[108:111], a[184:187], v[232:235], v[108:111]
ds_read_b128 a[172:175], v2 offset:13312
v_cvt_pk_bf16_f32 v123, v74, v75
v_mfma_f32_16x16x32_bf16 v[108:111], a[188:191], v[236:239], v[108:111]
s_cbranch_vccnz K2_S_SSb
K2_R_SSb:
v_cvt_pk_bf16_f32 v126, v76, v77
v_cvt_pk_bf16_f32 v127, v78, v79
s_sub_u32 s27, s27, 1
s_cmp_lg_u32 s27, 0
s_cbranch_scc1 K2_SS
s_waitcnt lgkmcnt(8)
v_mfma_f32_16x16x32_bf16 a[64:67], a[128:131], v[112:115], a[64:67]
ds_read_b128 a[176:179], v2 offset:6144
v_exp_f32 v80, v80
v_mfma_f32_16x16x32_bf16 a[64:67], a[132:135], v[120:123], a[64:67]
s_add_u32 m0, s26, s49
v_exp_f32 v81, v81
v_mfma_f32_16x16x32_bf16 a[96:99], a[128:131], v[116:119], a[96:99]
ds_read_b128 a[180:183], v2 offset:14336
v_exp_f32 v82, v82
v_mfma_f32_16x16x32_bf16 a[96:99], a[132:135], v[124:127], a[96:99]
global_load_lds_dwordx4 v1, s[86:87] offset:0 sc1
v_add_u32 v3, s25, v1
v_mfma_f32_16x16x32_bf16 a[68:71], a[136:139], v[112:115], a[68:71]
ds_read_b128 a[184:187], v2 offset:7168
v_add_f32 v10, v10, v14
v_mfma_f32_16x16x32_bf16 a[68:71], a[140:143], v[120:123], a[68:71]
v_exp_f32 v83, v83
v_add_f32 v11, v11, v15
v_mfma_f32_16x16x32_bf16 a[100:103], a[136:139], v[116:119], a[100:103]
ds_read_b128 a[188:191], v2 offset:15360
v_add_f32 v14, v80, v81
v_mfma_f32_16x16x32_bf16 a[100:103], a[140:143], v[124:127], a[100:103]
s_waitcnt lgkmcnt(8)
v_exp_f32 v84, v84
v_cvt_pk_bf16_f32 v128, v80, v81
v_mfma_f32_16x16x32_bf16 a[72:75], a[144:147], v[112:115], a[72:75]
ds_read_b128 a[128:131], v2 offset:16384
v_add_f32 v14, v14, v82
v_mfma_f32_16x16x32_bf16 a[72:75], a[148:151], v[120:123], a[72:75]
global_load_lds_dwordx4 v1, s[86:87] offset:1024 sc1
v_add_f32 v14, v14, v83
v_mfma_f32_16x16x32_bf16 a[104:107], a[144:147], v[116:119], a[104:107]
ds_read_b128 a[132:135], v2 offset:18432
v_exp_f32 v85, v85
v_mfma_f32_16x16x32_bf16 a[104:107], a[148:151], v[124:127], a[104:107]
v_exp_f32 v86, v86
v_mfma_f32_16x16x32_bf16 a[76:79], a[152:155], v[112:115], a[76:79]
ds_read_b128 a[136:139], v2 offset:20480
v_exp_f32 v87, v87
v_mfma_f32_16x16x32_bf16 a[76:79], a[156:159], v[120:123], a[76:79]
global_load_lds_dwordx4 v1, s[86:87] offset:2048 sc1
v_cvt_pk_bf16_f32 v129, v82, v83
v_mfma_f32_16x16x32_bf16 a[108:111], a[152:155], v[116:119], a[108:111]
ds_read_b128 a[140:143], v2 offset:22528
v_add_f32 v15, v84, v85
v_mfma_f32_16x16x32_bf16 a[108:111], a[156:159], v[124:127], a[108:111]
s_waitcnt lgkmcnt(8)
v_exp_f32 v88, v88
v_cvt_pk_bf16_f32 v132, v84, v85
v_mfma_f32_16x16x32_bf16 a[80:83], a[160:163], v[112:115], a[80:83]
ds_read_b128 a[144:147], v2 offset:17408
v_add_f32 v15, v15, v86
v_mfma_f32_16x16x32_bf16 a[80:83], a[164:167], v[120:123], a[80:83]
global_load_lds_dwordx4 v1, s[86:87] offset:3072 sc1
v_exp_f32 v89, v89
v_mfma_f32_16x16x32_bf16 a[112:115], a[160:163], v[116:119], a[112:115]
ds_read_b128 a[148:151], v2 offset:19456
v_add_f32 v15, v15, v87
v_mfma_f32_16x16x32_bf16 a[112:115], a[164:167], v[124:127], a[112:115]
s_add_u32 s86, s86, 16384
s_addc_u32 s87, s87, 0
v_cvt_pk_bf16_f32 v133, v86, v87
v_mfma_f32_16x16x32_bf16 a[84:87], a[168:171], v[112:115], a[84:87]
ds_read_b128 a[152:155], v2 offset:21504
v_exp_f32 v90, v90
v_mfma_f32_16x16x32_bf16 a[84:87], a[172:175], v[120:123], a[84:87]
s_add_u32 s25, s25, 32768
v_exp_f32 v91, v91
v_mfma_f32_16x16x32_bf16 a[116:119], a[168:171], v[116:119], a[116:119]
ds_read_b128 a[156:159], v2 offset:23552
v_add_f32 v14, v14, v88
v_mfma_f32_16x16x32_bf16 a[116:119], a[172:175], v[124:127], a[116:119]
s_waitcnt lgkmcnt(8)
v_exp_f32 v92, v92
v_add_f32 v14, v14, v89
v_mfma_f32_16x16x32_bf16 a[88:91], a[176:179], v[112:115], a[88:91]
ds_read_b128 a[160:163], v2 offset:24576
v_cvt_pk_bf16_f32 v130, v88, v89
v_mfma_f32_16x16x32_bf16 a[88:91], a[180:183], v[120:123], a[88:91]
s_and_b32 s25, s25, 0x1ffff
v_exp_f32 v93, v93
v_add_f32 v14, v14, v90
v_mfma_f32_16x16x32_bf16 a[120:123], a[176:179], v[116:119], a[120:123]
ds_read_b128 a[164:167], v2 offset:26624
v_add_f32 v14, v14, v91
v_mfma_f32_16x16x32_bf16 a[120:123], a[180:183], v[124:127], a[120:123]
s_add_u32 s26, s26, 32768
v_exp_f32 v94, v94
v_mfma_f32_16x16x32_bf16 a[92:95], a[184:187], v[112:115], a[92:95]
ds_read_b128 a[168:171], v2 offset:28672
v_exp_f32 v95, v95
v_mfma_f32_16x16x32_bf16 a[92:95], a[188:191], v[120:123], a[92:95]
s_and_b32 s26, s26, 0x1ffff
v_exp_f32 v96, v96
v_mfma_f32_16x16x32_bf16 a[124:127], a[184:187], v[116:119], a[124:127]
ds_read_b128 a[172:175], v2 offset:30720
v_exp_f32 v97, v97
v_mfma_f32_16x16x32_bf16 a[124:127], a[188:191], v[124:127], a[124:127]
s_waitcnt lgkmcnt(8)
v_exp_f32 v98, v98
v_mfma_f32_16x16x32_bf16 v[48:51], a[128:131], v[208:211], v[28:31]
ds_read_b128 a[176:179], v2 offset:25600
v_cvt_pk_bf16_f32 v131, v90, v91
v_mfma_f32_16x16x32_bf16 v[48:51], a[132:135], v[212:215], v[48:51]
s_add_u32 s28, s28, 16384
v_exp_f32 v99, v99
v_add_f32 v15, v15, v92
v_mfma_f32_16x16x32_bf16 v[48:51], a[136:139], v[216:219], v[48:51]
ds_read_b128 a[180:183], v2 offset:27648
v_add_f32 v15, v15, v93
v_mfma_f32_16x16x32_bf16 v[48:51], a[140:143], v[220:223], v[48:51]
s_mov_b32 s29, -4096
v_exp_f32 v100, v100
v_cvt_pk_bf16_f32 v134, v92, v93
v_mfma_f32_16x16x32_bf16 v[52:55], a[128:131], v[224:227], v[32:35]
ds_read_b128 a[184:187], v2 offset:29696
v_add_f32 v15, v15, v94
v_mfma_f32_16x16x32_bf16 v[52:55], a[132:135], v[228:231], v[52:55]
s_waitcnt vmcnt(4)
s_barrier
v_add_f32 v15, v15, v95
v_mfma_f32_16x16x32_bf16 v[52:55], a[136:139], v[232:235], v[52:55]
ds_read_b128 a[188:191], v2 offset:31744
v_exp_f32 v101, v101
v_mfma_f32_16x16x32_bf16 v[52:55], a[140:143], v[236:239], v[52:55]
s_waitcnt lgkmcnt(8)
v_exp_f32 v102, v102
v_mfma_f32_16x16x32_bf16 v[56:59], a[144:147], v[208:211], v[28:31]
ds_read_b128 a[128:131], v3 offset:0
v_exp_f32 v103, v103
v_mfma_f32_16x16x32_bf16 v[56:59], a[148:151], v[212:215], v[56:59]
v_exp_f32 v104, v104
v_mfma_f32_16x16x32_bf16 v[56:59], a[152:155], v[216:219], v[56:59]
ds_read_b128 a[132:135], v3 offset:8192
v_cvt_pk_bf16_f32 v135, v94, v95
v_mfma_f32_16x16x32_bf16 v[56:59], a[156:159], v[220:223], v[56:59]
v_exp_f32 v105, v105
v_add_f32 v14, v14, v96
v_mfma_f32_16x16x32_bf16 v[60:63], a[144:147], v[224:227], v[32:35]
ds_read_b128 a[136:139], v3 offset:1024
v_add_f32 v14, v14, v97
v_mfma_f32_16x16x32_bf16 v[60:63], a[148:151], v[228:231], v[60:63]
v_exp_f32 v106, v106
v_mfma_f32_16x16x32_bf16 v[60:63], a[152:155], v[232:235], v[60:63]
ds_read_b128 a[140:143], v3 offset:9216
v_exp_f32 v107, v107
v_mfma_f32_16x16x32_bf16 v[60:63], a[156:159], v[236:239], v[60:63]
s_waitcnt lgkmcnt(8)
v_exp_f32 v108, v108
v_mfma_f32_16x16x32_bf16 v[64:67], a[160:163], v[208:211], v[28:31]
ds_read_b128 a[144:147], v3 offset:2048
v_exp_f32 v109, v109
v_mfma_f32_16x16x32_bf16 v[64:67], a[164:167], v[212:215], v[64:67]
v_exp_f32 v110, v110
v_mfma_f32_16x16x32_bf16 v[64:67], a[168:171], v[216:219], v[64:67]
ds_read_b128 a[148:151], v3 offset:10240
v_cvt_pk_bf16_f32 v136, v96, v97
v_mfma_f32_16x16x32_bf16 v[64:67], a[172:175], v[220:223], v[64:67]
v_exp_f32 v111, v111
v_add_f32 v14, v14, v98
v_mfma_f32_16x16x32_bf16 v[68:71], a[160:163], v[224:227], v[32:35]
ds_read_b128 a[152:155], v3 offset:3072
v_add_f32 v14, v14, v99
v_mfma_f32_16x16x32_bf16 v[68:71], a[164:167], v[228:231], v[68:71]
v_cvt_pk_bf16_f32 v137, v98, v99
v_add_f32 v15, v15, v100
v_add_f32 v15, v15, v101
v_mfma_f32_16x16x32_bf16 v[68:71], a[168:171], v[232:235], v[68:71]
ds_read_b128 a[156:159], v3 offset:11264
v_add_f32 v15, v15, v102
v_mfma_f32_16x16x32_bf16 v[68:71], a[172:175], v[236:239], v[68:71]
s_waitcnt lgkmcnt(8)
v_add_f32 v15, v15, v103
v_add_f32 v14, v14, v104
v_mfma_f32_16x16x32_bf16 v[72:75], a[176:179], v[208:211], v[28:31]
ds_read_b128 a[160:163], v3 offset:4096
v_add_f32 v14, v14, v105
v_add_f32 v14, v14, v106
v_mfma_f32_16x16x32_bf16 v[72:75], a[180:183], v[212:215], v[72:75]
v_add_f32 v14, v14, v107
v_add_f32 v15, v15, v108
v_mfma_f32_16x16x32_bf16 v[72:75], a[184:187], v[216:219], v[72:75]
ds_read_b128 a[164:167], v3 offset:12288
v_add_f32 v15, v15, v109
v_add_f32 v15, v15, v110
v_mfma_f32_16x16x32_bf16 v[72:75], a[188:191], v[220:223], v[72:75]
v_add_f32 v15, v15, v111
v_max_f32 v16, v14, v15
v_mfma_f32_16x16x32_bf16 v[76:79], a[176:179], v[224:227], v[32:35]
ds_read_b128 a[168:171], v3 offset:5120
v_cmp_nge_f32 vcc, 0x53800000, v16
v_mfma_f32_16x16x32_bf16 v[76:79], a[180:183], v[228:231], v[76:79]
v_cvt_pk_bf16_f32 v140, v100, v101
v_cvt_pk_bf16_f32 v141, v102, v103
v_cvt_pk_bf16_f32 v138, v104, v105
v_mfma_f32_16x16x32_bf16 v[76:79], a[184:187], v[232:235], v[76:79]
ds_read_b128 a[172:175], v3 offset:13312
v_cvt_pk_bf16_f32 v139, v106, v107
v_mfma_f32_16x16x32_bf16 v[76:79], a[188:191], v[236:239], v[76:79]
s_cbranch_vccnz K2_S_X4a
K2_R_X4a:
v_cvt_pk_bf16_f32 v142, v108, v109
v_cvt_pk_bf16_f32 v143, v110, v111
s_waitcnt lgkmcnt(8)
v_mfma_f32_16x16x32_bf16 a[64:67], a[128:131], v[128:131], a[64:67]
ds_read_b128 a[176:179], v3 offset:6144
v_add_u32 v2, s25, v1
v_add_f32 v10, v10, v14
v_mfma_f32_16x16x32_bf16 a[64:67], a[132:135], v[136:139], a[64:67]
s_add_u32 m0, s26, s49
v_add_f32 v11, v11, v15
v_mfma_f32_16x16x32_bf16 a[96:99], a[128:131], v[132:135], a[96:99]
ds_read_b128 a[180:183], v3 offset:14336
v_mfma_f32_16x16x32_bf16 a[96:99], a[132:135], v[140:143], a[96:99]
s_mov_b32 s29, 0
s_call_b64 s[78:79], K2_MASK_0s
v_mfma_f32_16x16x32_bf16 a[68:71], a[136:139], v[128:131], a[68:71]
ds_read_b128 a[184:187], v3 offset:7168
v_exp_f32 v48, v48
v_mfma_f32_16x16x32_bf16 a[68:71], a[140:143], v[136:139], a[68:71]
global_load_lds_dwordx4 v1, s[86:87] offset:0 sc1
v_mfma_f32_16x16x32_bf16 a[100:103], a[136:139], v[132:135], a[100:103]
ds_read_b128 a[188:191], v3 offset:15360
v_exp_f32 v49, v49
v_mfma_f32_16x16x32_bf16 a[100:103], a[140:143], v[140:143], a[100:103]
s_waitcnt lgkmcnt(8)
v_exp_f32 v50, v50
v_mfma_f32_16x16x32_bf16 a[72:75], a[144:147], v[128:131], a[72:75]
ds_read_b128 a[128:131], v3 offset:16384
v_exp_f32 v51, v51
v_mfma_f32_16x16x32_bf16 a[72:75], a[148:151], v[136:139], a[72:75]
global_load_lds_dwordx4 v1, s[86:87] offset:1024 sc1
v_add_f32 v14, v48, v49
v_mfma_f32_16x16x32_bf16 a[104:107], a[144:147], v[132:135], a[104:107]
ds_read_b128 a[132:135], v3 offset:18432
v_exp_f32 v52, v52
v_mfma_f32_16x16x32_bf16 a[104:107], a[148:151], v[140:143], a[104:107]
v_exp_f32 v53, v53
v_mfma_f32_16x16x32_bf16 a[76:79], a[152:155], v[128:131], a[76:79]
ds_read_b128 a[136:139], v3 offset:20480
v_exp_f32 v54, v54
v_mfma_f32_16x16x32_bf16 a[76:79], a[156:159], v[136:139], a[76:79]
global_load_lds_dwordx4 v1, s[86:87] offset:2048 sc1
v_cvt_pk_bf16_f32 v112, v48, v49
v_mfma_f32_16x16x32_bf16 a[108:111], a[152:155], v[132:135], a[108:111]
ds_read_b128 a[140:143], v3 offset:22528
v_exp_f32 v55, v55
v_mfma_f32_16x16x32_bf16 a[108:111], a[156:159], v[140:143], a[108:111]
s_waitcnt lgkmcnt(8)
v_exp_f32 v56, v56
v_mfma_f32_16x16x32_bf16 a[80:83], a[160:163], v[128:131], a[80:83]
ds_read_b128 a[144:147], v3 offset:17408
v_exp_f32 v57, v57
v_mfma_f32_16x16x32_bf16 a[80:83], a[164:167], v[136:139], a[80:83]
global_load_lds_dwordx4 v1, s[86:87] offset:3072 sc1
v_add_f32 v14, v14, v50
v_mfma_f32_16x16x32_bf16 a[112:115], a[160:163], v[132:135], a[112:115]
ds_read_b128 a[148:151], v3 offset:19456
v_exp_f32 v58, v58
v_mfma_f32_16x16x32_bf16 a[112:115], a[164:167], v[140:143], a[112:115]
s_add_u32 s86, s86, 16384
s_addc_u32 s87, s87, 0
v_add_f32 v14, v14, v51
v_mfma_f32_16x16x32_bf16 a[84:87], a[168:171], v[128:131], a[84:87]
ds_read_b128 a[152:155], v3 offset:21504
v_exp_f32 v59, v59
v_mfma_f32_16x16x32_bf16 a[84:87], a[172:175], v[136:139], a[84:87]
s_add_u32 s25, s25, 32768
v_exp_f32 v60, v60
v_mfma_f32_16x16x32_bf16 a[116:119], a[168:171], v[132:135], a[116:119]
ds_read_b128 a[156:159], v3 offset:23552
v_exp_f32 v61, v61
v_mfma_f32_16x16x32_bf16 a[116:119], a[172:175], v[140:143], a[116:119]
s_waitcnt lgkmcnt(8)
v_exp_f32 v62, v62
v_mfma_f32_16x16x32_bf16 a[88:91], a[176:179], v[128:131], a[88:91]
ds_read_b128 a[160:163], v3 offset:24576
v_exp_f32 v63, v63
v_mfma_f32_16x16x32_bf16 a[88:91], a[180:183], v[136:139], a[88:91]
s_and_b32 s25, s25, 0x1ffff
v_exp_f32 v64, v64
v_mfma_f32_16x16x32_bf16 a[120:123], a[176:179], v[132:135], a[120:123]
ds_read_b128 a[164:167], v3 offset:26624
v_exp_f32 v65, v65
v_mfma_f32_16x16x32_bf16 a[120:123], a[180:183], v[140:143], a[120:123]
s_add_u32 s26, s26, 32768
v_exp_f32 v66, v66
v_mfma_f32_16x16x32_bf16 a[92:95], a[184:187], v[128:131], a[92:95]
ds_read_b128 a[168:171], v3 offset:28672
v_exp_f32 v67, v67
v_mfma_f32_16x16x32_bf16 a[92:95], a[188:191], v[136:139], a[92:95]
s_and_b32 s26, s26, 0x1ffff
v_exp_f32 v68, v68
v_mfma_f32_16x16x32_bf16 a[124:127], a[184:187], v[132:135], a[124:127]
ds_read_b128 a[172:175], v3 offset:30720
v_exp_f32 v69, v69
v_mfma_f32_16x16x32_bf16 a[124:127], a[188:191], v[140:143], a[124:127]
s_waitcnt lgkmcnt(8)
v_exp_f32 v70, v70
v_mfma_f32_16x16x32_bf16 v[80:83], a[128:131], v[208:211], v[28:31]
ds_read_b128 a[176:179], v3 offset:25600
v_cvt_pk_bf16_f32 v113, v50, v51
v_mfma_f32_16x16x32_bf16 v[80:83], a[132:135], v[212:215], v[80:83]
s_add_u32 s28, s28, 16384
v_exp_f32 v71, v71
v_add_f32 v15, v52, v53
v_mfma_f32_16x16x32_bf16 v[80:83], a[136:139], v[216:219], v[80:83]
ds_read_b128 a[180:183], v3 offset:27648
v_cvt_pk_bf16_f32 v116, v52, v53
v_mfma_f32_16x16x32_bf16 v[80:83], a[140:143], v[220:223], v[80:83]
v_exp_f32 v72, v72
v_add_f32 v15, v15, v54
v_mfma_f32_16x16x32_bf16 v[84:87], a[128:131], v[224:227], v[32:35]
ds_read_b128 a[184:187], v3 offset:29696
v_add_f32 v15, v15, v55
v_mfma_f32_16x16x32_bf16 v[84:87], a[132:135], v[228:231], v[84:87]
s_waitcnt vmcnt(4)
s_barrier
v_exp_f32 v73, v73
v_mfma_f32_16x16x32_bf16 v[84:87], a[136:139], v[232:235], v[84:87]
ds_read_b128 a[188:191], v3 offset:31744
v_cvt_pk_bf16_f32 v117, v54, v55
v_mfma_f32_16x16x32_bf16 v[84:87], a[140:143], v[236:239], v[84:87]
s_waitcnt lgkmcnt(8)
v_exp_f32 v74, v74
v_add_f32 v14, v14, v56
v_mfma_f32_16x16x32_bf16 v[88:91], a[144:147], v[208:211], v[28:31]
ds_read_b128 a[128:131], v2 offset:0
v_add_f32 v14, v14, v57
v_mfma_f32_16x16x32_bf16 v[88:91], a[148:151], v[212:215], v[88:91]
v_exp_f32 v75, v75
v_cvt_pk_bf16_f32 v114, v56, v57
v_mfma_f32_16x16x32_bf16 v[88:91], a[152:155], v[216:219], v[88:91]
ds_read_b128 a[132:135], v2 offset:8192
v_add_f32 v14, v14, v58
v_mfma_f32_16x16x32_bf16 v[88:91], a[156:159], v[220:223], v[88:91]
v_exp_f32 v76, v76
v_add_f32 v14, v14, v59
v_mfma_f32_16x16x32_bf16 v[92:95], a[144:147], v[224:227], v[32:35]
ds_read_b128 a[136:139], v2 offset:1024
v_cvt_pk_bf16_f32 v115, v58, v59
v_mfma_f32_16x16x32_bf16 v[92:95], a[148:151], v[228:231], v[92:95]
v_exp_f32 v77, v77
v_add_f32 v15, v15, v60
v_mfma_f32_16x16x32_bf16 v[92:95], a[152:155], v[232:235], v[92:95]
ds_read_b128 a[140:143], v2 offset:9216
v_add_f32 v15, v15, v61
v_mfma_f32_16x16x32_bf16 v[92:95], a[156:159], v[236:239], v[92:95]
s_waitcnt lgkmcnt(8)
v_exp_f32 v78, v78
v_cvt_pk_bf16_f32 v118, v60, v61
v_mfma_f32_16x16x32_bf16 v[96:99], a[160:163], v[208:211], v[28:31]
ds_read_b128 a[144:147], v2 offset:2048
v_add_f32 v15, v15, v62
v_mfma_f32_16x16x32_bf16 v[96:99], a[164:167], v[212:215], v[96:99]
v_exp_f32 v79, v79
v_add_f32 v15, v15, v63
v_mfma_f32_16x16x32_bf16 v[96:99], a[168:171], v[216:219], v[96:99]
ds_read_b128 a[148:151], v2 offset:10240
v_cvt_pk_bf16_f32 v119, v62, v63
v_mfma_f32_16x16x32_bf16 v[96:99], a[172:175], v[220:223], v[96:99]
v_add_f32 v14, v14, v64
v_add_f32 v14, v14, v65
v_cvt_pk_bf16_f32 v120, v64, v65
v_mfma_f32_16x16x32_bf16 v[100:103], a[160:163], v[224:227], v[32:35]
ds_read_b128 a[152:155], v2 offset:3072
v_add_f32 v14, v14, v66
v_mfma_f32_16x16x32_bf16 v[100:103], a[164:167], v[228:231], v[100:103]
v_add_f32 v14, v14, v67
v_cvt_pk_bf16_f32 v121, v66, v67
v_add_f32 v15, v15, v68
v_mfma_f32_16x16x32_bf16 v[100:103], a[168:171], v[232:235], v[100:103]
ds_read_b128 a[156:159], v2 offset:11264
v_add_f32 v15, v15, v69
v_mfma_f32_16x16x32_bf16 v[100:103], a[172:175], v[236:239], v[100:103]
s_waitcnt lgkmcnt(8)
v_add_f32 v15, v15, v70
v_add_f32 v15, v15, v71
v_add_f32 v14, v14, v72
v_mfma_f32_16x16x32_bf16 v[104:107], a[176:179], v[208:211], v[28:31]
ds_read_b128 a[160:163], v2 offset:4096
v_add_f32 v14, v14, v73
v_mfma_f32_16x16x32_bf16 v[104:107], a[180:183], v[212:215], v[104:107]
v_add_f32 v14, v14, v74
v_add_f32 v14, v14, v75
v_add_f32 v15, v15, v76
v_mfma_f32_16x16x32_bf16 v[104:107], a[184:187], v[216:219], v[104:107]
ds_read_b128 a[164:167], v2 offset:12288
v_add_f32 v15, v15, v77
v_mfma_f32_16x16x32_bf16 v[104:107], a[188:191], v[220:223], v[104:107]
v_add_f32 v15, v15, v78
v_add_f32 v15, v15, v79
v_max_f32 v16, v14, v15
v_mfma_f32_16x16x32_bf16 v[108:111], a[176:179], v[224:227], v[32:35]
ds_read_b128 a[168:171], v2 offset:5120
v_cmp_nge_f32 vcc, 0x53800000, v16
v_mfma_f32_16x16x32_bf16 v[108:111], a[180:183], v[228:231], v[108:111]
v_cvt_pk_bf16_f32 v124, v68, v69
v_cvt_pk_bf16_f32 v125, v70, v71
v_cvt_pk_bf16_f32 v122, v72, v73
v_mfma_f32_16x16x32_bf16 v[108:111], a[184:187], v[232:235], v[108:111]
ds_read_b128 a[172:175], v2 offset:13312
v_cvt_pk_bf16_f32 v123, v74, v75
v_mfma_f32_16x16x32_bf16 v[108:111], a[188:191], v[236:239], v[108:111]
s_cbranch_vccnz K2_S_X4b
K2_R_X4b:
v_cvt_pk_bf16_f32 v126, v76, v77
v_cvt_pk_bf16_f32 v127, v78, v79
K2_TL:
s_waitcnt lgkmcnt(8)
v_mfma_f32_16x16x32_bf16 a[64:67], a[128:131], v[112:115], a[64:67]
ds_read_b128 a[176:179], v2 offset:6144
v_add_u32 v3, s25, v1
v_add_f32 v10, v10, v14
v_add_f32 v11, v11, v15
v_mfma_f32_16x16x32_bf16 a[64:67], a[132:135], v[120:123], a[64:67]
s_add_u32 s25, s25, 32768
v_mfma_f32_16x16x32_bf16 a[96:99], a[128:131], v[116:119], a[96:99]
ds_read_b128 a[180:183], v2 offset:14336
v_mfma_f32_16x16x32_bf16 a[96:99], a[132:135], v[124:127], a[96:99]
s_mov_b32 s29, 64
s_call_b64 s[78:79], K2_MASK_1s
v_exp_f32 v80, v80
v_exp_f32 v81, v81
v_mfma_f32_16x16x32_bf16 a[68:71], a[136:139], v[112:115], a[68:71]
ds_read_b128 a[184:187], v2 offset:7168
v_exp_f32 v82, v82
v_add_f32 v14, v80, v81
v_mfma_f32_16x16x32_bf16 a[68:71], a[140:143], v[120:123], a[68:71]
s_waitcnt vmcnt(0)
s_barrier
v_exp_f32 v83, v83
v_exp_f32 v84, v84
v_mfma_f32_16x16x32_bf16 a[100:103], a[136:139], v[116:119], a[100:103]
ds_read_b128 a[188:191], v2 offset:15360
v_exp_f32 v85, v85
v_exp_f32 v86, v86
v_mfma_f32_16x16x32_bf16 a[100:103], a[140:143], v[124:127], a[100:103]
s_waitcnt lgkmcnt(8)
v_exp_f32 v87, v87
v_exp_f32 v88, v88
v_mfma_f32_16x16x32_bf16 a[72:75], a[144:147], v[112:115], a[72:75]
ds_read_b128 a[128:131], v3 offset:0
v_exp_f32 v89, v89
v_exp_f32 v90, v90
v_mfma_f32_16x16x32_bf16 a[72:75], a[148:151], v[120:123], a[72:75]
s_and_b32 s25, s25, 0x1ffff
v_exp_f32 v91, v91
v_exp_f32 v92, v92
v_mfma_f32_16x16x32_bf16 a[104:107], a[144:147], v[116:119], a[104:107]
ds_read_b128 a[132:135], v3 offset:8192
v_exp_f32 v93, v93
v_exp_f32 v94, v94
v_mfma_f32_16x16x32_bf16 a[104:107], a[148:151], v[124:127], a[104:107]
s_add_u32 s28, s28, 16384
v_exp_f32 v95, v95
v_exp_f32 v96, v96
v_mfma_f32_16x16x32_bf16 a[76:79], a[152:155], v[112:115], a[76:79]
ds_read_b128 a[136:139], v3 offset:1024
v_exp_f32 v97, v97
v_exp_f32 v98, v98
v_mfma_f32_16x16x32_bf16 a[76:79], a[156:159], v[120:123], a[76:79]
v_exp_f32 v99, v99
v_exp_f32 v100, v100
v_cvt_pk_bf16_f32 v128, v80, v81
v_mfma_f32_16x16x32_bf16 a[108:111], a[152:155], v[116:119], a[108:111]
ds_read_b128 a[140:143], v3 offset:9216
v_exp_f32 v101, v101
v_add_f32 v14, v14, v82
v_mfma_f32_16x16x32_bf16 a[108:111], a[156:159], v[124:127], a[108:111]
s_waitcnt lgkmcnt(8)
v_exp_f32 v102, v102
v_exp_f32 v103, v103
v_add_f32 v14, v14, v83
v_mfma_f32_16x16x32_bf16 a[80:83], a[160:163], v[112:115], a[80:83]
ds_read_b128 a[144:147], v3 offset:2048
v_exp_f32 v104, v104
v_cvt_pk_bf16_f32 v129, v82, v83
v_mfma_f32_16x16x32_bf16 a[80:83], a[164:167], v[120:123], a[80:83]
v_exp_f32 v105, v105
v_exp_f32 v106, v106
v_add_f32 v15, v84, v85
v_mfma_f32_16x16x32_bf16 a[112:115], a[160:163], v[116:119], a[112:115]
ds_read_b128 a[148:151], v3 offset:10240
v_exp_f32 v107, v107
v_exp_f32 v108, v108
v_mfma_f32_16x16x32_bf16 a[112:115], a[164:167], v[124:127], a[112:115]
v_exp_f32 v109, v109
v_exp_f32 v110, v110
v_mfma_f32_16x16x32_bf16 a[84:87], a[168:171], v[112:115], a[84:87]
ds_read_b128 a[152:155], v3 offset:3072
v_exp_f32 v111, v111
v_cvt_pk_bf16_f32 v132, v84, v85
v_add_f32 v15, v15, v86
v_mfma_f32_16x16x32_bf16 a[84:87], a[172:175], v[120:123], a[84:87]
v_add_f32 v15, v15, v87
v_cvt_pk_bf16_f32 v133, v86, v87
v_add_f32 v14, v14, v88
v_add_f32 v14, v14, v89
v_mfma_f32_16x16x32_bf16 a[116:119], a[168:171], v[116:119], a[116:119]
ds_read_b128 a[156:159], v3 offset:11264
v_cvt_pk_bf16_f32 v130, v88, v89
v_add_f32 v14, v14, v90
v_add_f32 v14, v14, v91
v_cvt_pk_bf16_f32 v131, v90, v91
v_mfma_f32_16x16x32_bf16 a[116:119], a[172:175], v[124:127], a[116:119]
s_waitcnt lgkmcnt(8)
v_add_f32 v15, v15, v92
v_add_f32 v15, v15, v93
v_cvt_pk_bf16_f32 v134, v92, v93
v_add_f32 v15, v15, v94
v_mfma_f32_16x16x32_bf16 a[88:91], a[176:179], v[112:115], a[88:91]
ds_read_b128 a[160:163], v3 offset:4096
v_add_f32 v15, v15, v95
v_cvt_pk_bf16_f32 v135, v94, v95
v_add_f32 v14, v14, v96
v_add_f32 v14, v14, v97
v_mfma_f32_16x16x32_bf16 a[88:91], a[180:183], v[120:123], a[88:91]
v_cvt_pk_bf16_f32 v136, v96, v97
v_add_f32 v14, v14, v98
v_add_f32 v14, v14, v99
v_cvt_pk_bf16_f32 v137, v98, v99
v_add_f32 v15, v15, v100
v_mfma_f32_16x16x32_bf16 a[120:123], a[176:179], v[116:119], a[120:123]
ds_read_b128 a[164:167], v3 offset:12288
v_add_f32 v15, v15, v101
v_add_f32 v15, v15, v102
v_add_f32 v15, v15, v103
v_mfma_f32_16x16x32_bf16 a[120:123], a[180:183], v[124:127], a[120:123]
v_add_f32 v14, v14, v104
v_add_f32 v14, v14, v105
v_add_f32 v14, v14, v106
v_add_f32 v14, v14, v107
v_add_f32 v15, v15, v108
v_mfma_f32_16x16x32_bf16 a[92:95], a[184:187], v[112:115], a[92:95]
ds_read_b128 a[168:171], v3 offset:5120
v_add_f32 v15, v15, v109
v_add_f32 v15, v15, v110
v_add_f32 v15, v15, v111
v_mfma_f32_16x16x32_bf16 a[92:95], a[188:191], v[120:123], a[92:95]
v_max_f32 v16, v14, v15
v_cmp_nge_f32 vcc, 0x53800000, v16
v_cvt_pk_bf16_f32 v140, v100, v101
v_cvt_pk_bf16_f32 v141, v102, v103
v_cvt_pk_bf16_f32 v138, v104, v105
v_mfma_f32_16x16x32_bf16 a[124:127], a[184:187], v[116:119], a[124:127]
ds_read_b128 a[172:175], v3 offset:13312
v_cvt_pk_bf16_f32 v139, v106, v107
v_cvt_pk_bf16_f32 v142, v108, v109
v_cvt_pk_bf16_f32 v143, v110, v111
v_mfma_f32_16x16x32_bf16 a[124:127], a[188:191], v[124:127], a[124:127]
s_cbranch_vccnz K2_S_TLa
K2_R_TLa:
s_waitcnt lgkmcnt(8)
v_mfma_f32_16x16x32_bf16 a[64:67], a[128:131], v[128:131], a[64:67]
ds_read_b128 a[176:179], v3 offset:6144
v_add_f32 v10, v10, v14
v_add_f32 v11, v11, v15
s_lshl_b32 s36, s21, 14
s_add_u32 s36, s36, 58720256
s_and_b32 s37, s20, 1
v_mfma_f32_16x16x32_bf16 a[64:67], a[132:135], v[136:139], a[64:67]
s_lshl_b32 s37, s37, 11
s_add_u32 s36, s36, s37
s_lshr_b32 s37, s20, 1
s_mul_i32 s37, s37, 589824
s_add_u32 s36, s36, s37
v_mfma_f32_16x16x32_bf16 a[96:99], a[128:131], v[132:135], a[96:99]
ds_read_b128 a[180:183], v3 offset:14336
s_mul_i32 s37, s22, 1179648
s_sub_u32 s36, s36, s37
s_add_u32 s36, s36, 17694720
s_add_u32 s37, s36, 4096
s_add_u32 s38, s36, 8192
v_mfma_f32_16x16x32_bf16 a[96:99], a[132:135], v[140:143], a[96:99]
s_add_u32 s39, s36, 12288
v_mov_b32 v16, v10
v_mov_b32 v17, v11
s_nop 0
v_permlane32_swap_b32 v10, v16
v_mfma_f32_16x16x32_bf16 a[68:71], a[136:139], v[128:131], a[68:71]
ds_read_b128 a[184:187], v3 offset:7168
v_permlane32_swap_b32 v11, v17
v_add_f32 v10, v10, v16
v_add_f32 v11, v11, v17
v_mov_b32 v16, v10
v_mov_b32 v17, v11
v_mfma_f32_16x16x32_bf16 a[68:71], a[140:143], v[136:139], a[68:71]
s_nop 0
v_permlane16_swap_b32 v10, v16
v_permlane16_swap_b32 v11, v17
v_add_f32 v10, v10, v16
v_add_f32 v11, v11, v17
v_mfma_f32_16x16x32_bf16 a[100:103], a[136:139], v[132:135], a[100:103]
ds_read_b128 a[188:191], v3 offset:15360
v_rcp_f32 v10, v10
v_rcp_f32 v11, v11
v_mfma_f32_16x16x32_bf16 a[100:103], a[140:143], v[140:143], a[100:103]
s_waitcnt lgkmcnt(8)
v_mfma_f32_16x16x32_bf16 a[72:75], a[144:147], v[128:131], a[72:75]
v_mfma_f32_16x16x32_bf16 a[72:75], a[148:151], v[136:139], a[72:75]
v_mfma_f32_16x16x32_bf16 a[104:107], a[144:147], v[132:135], a[104:107]
v_accvgpr_read_b32 v144, a64
v_accvgpr_read_b32 v145, a65
v_accvgpr_read_b32 v146, a66
v_accvgpr_read_b32 v147, a67
v_accvgpr_read_b32 v148, a68
v_mfma_f32_16x16x32_bf16 a[104:107], a[148:151], v[140:143], a[104:107]
v_accvgpr_read_b32 v149, a69
v_accvgpr_read_b32 v150, a70
v_accvgpr_read_b32 v151, a71
v_mul_f32 v144, v144, v10
v_mul_f32 v145, v145, v10
v_mfma_f32_16x16x32_bf16 a[76:79], a[152:155], v[128:131], a[76:79]
v_mul_f32 v146, v146, v10
v_mul_f32 v147, v147, v10
v_mul_f32 v148, v148, v10
v_mul_f32 v149, v149, v10
v_mul_f32 v150, v150, v10
v_mfma_f32_16x16x32_bf16 a[76:79], a[156:159], v[136:139], a[76:79]
v_mul_f32 v151, v151, v10
v_cvt_pk_bf16_f32 v240, v144, v145
v_cvt_pk_bf16_f32 v241, v146, v147
v_cvt_pk_bf16_f32 v242, v148, v149
v_cvt_pk_bf16_f32 v243, v150, v151
v_mfma_f32_16x16x32_bf16 a[108:111], a[152:155], v[132:135], a[108:111]
buffer_store_dwordx4 v[240:243], v1, s[8:11], s36 offen offset:0 sc1
v_accvgpr_read_b32 v152, a96
v_accvgpr_read_b32 v153, a97
v_accvgpr_read_b32 v154, a98
v_accvgpr_read_b32 v155, a99
v_mfma_f32_16x16x32_bf16 a[108:111], a[156:159], v[140:143], a[108:111]
v_accvgpr_read_b32 v156, a100
v_accvgpr_read_b32 v157, a101
v_accvgpr_read_b32 v158, a102
v_accvgpr_read_b32 v159, a103
v_mul_f32 v152, v152, v11
s_waitcnt lgkmcnt(4)
v_mfma_f32_16x16x32_bf16 a[80:83], a[160:163], v[128:131], a[80:83]
v_mul_f32 v153, v153, v11
v_mul_f32 v154, v154, v11
v_mul_f32 v155, v155, v11
v_mul_f32 v156, v156, v11
v_mul_f32 v157, v157, v11
v_mfma_f32_16x16x32_bf16 a[80:83], a[164:167], v[136:139], a[80:83]
v_mul_f32 v158, v158, v11
v_mul_f32 v159, v159, v11
v_cvt_pk_bf16_f32 v244, v152, v153
v_cvt_pk_bf16_f32 v245, v154, v155
v_cvt_pk_bf16_f32 v246, v156, v157
v_mfma_f32_16x16x32_bf16 a[112:115], a[160:163], v[132:135], a[112:115]
v_cvt_pk_bf16_f32 v247, v158, v159
buffer_store_dwordx4 v[244:247], v1, s[8:11], s36 offen offset:1024 sc1
v_accvgpr_read_b32 v160, a72
v_accvgpr_read_b32 v161, a73
v_accvgpr_read_b32 v162, a74
v_mfma_f32_16x16x32_bf16 a[112:115], a[164:167], v[140:143], a[112:115]
v_accvgpr_read_b32 v163, a75
v_accvgpr_read_b32 v164, a76
v_accvgpr_read_b32 v165, a77
v_accvgpr_read_b32 v166, a78
v_accvgpr_read_b32 v167, a79
v_mfma_f32_16x16x32_bf16 a[84:87], a[168:171], v[128:131], a[84:87]
v_mul_f32 v160, v160, v10
v_mul_f32 v161, v161, v10
v_mul_f32 v162, v162, v10
v_mul_f32 v163, v163, v10
v_mul_f32 v164, v164, v10
v_mfma_f32_16x16x32_bf16 a[84:87], a[172:175], v[136:139], a[84:87]
v_mul_f32 v165, v165, v10
v_mul_f32 v166, v166, v10
v_mul_f32 v167, v167, v10
v_cvt_pk_bf16_f32 v248, v160, v161
v_cvt_pk_bf16_f32 v249, v162, v163
v_mfma_f32_16x16x32_bf16 a[116:119], a[168:171], v[132:135], a[116:119]
v_cvt_pk_bf16_f32 v250, v164, v165
v_cvt_pk_bf16_f32 v251, v166, v167
buffer_store_dwordx4 v[248:251], v1, s[8:11], s37 offen offset:0 sc1
v_accvgpr_read_b32 v168, a104
v_accvgpr_read_b32 v169, a105
v_mfma_f32_16x16x32_bf16 a[116:119], a[172:175], v[140:143], a[116:119]
v_accvgpr_read_b32 v170, a106
v_accvgpr_read_b32 v171, a107
v_accvgpr_read_b32 v172, a108
v_accvgpr_read_b32 v173, a109
v_accvgpr_read_b32 v174, a110
s_waitcnt lgkmcnt(0)
v_mfma_f32_16x16x32_bf16 a[88:91], a[176:179], v[128:131], a[88:91]
v_accvgpr_read_b32 v175, a111
v_mul_f32 v168, v168, v11
v_mul_f32 v169, v169, v11
v_mul_f32 v170, v170, v11
v_mul_f32 v171, v171, v11
v_mfma_f32_16x16x32_bf16 a[88:91], a[180:183], v[136:139], a[88:91]
v_mul_f32 v172, v172, v11
v_mul_f32 v173, v173, v11
v_mul_f32 v174, v174, v11
v_mul_f32 v175, v175, v11
v_cvt_pk_bf16_f32 v252, v168, v169
v_mfma_f32_16x16x32_bf16 a[120:123], a[176:179], v[132:135], a[120:123]
v_cvt_pk_bf16_f32 v253, v170, v171
v_cvt_pk_bf16_f32 v254, v172, v173
v_cvt_pk_bf16_f32 v255, v174, v175
buffer_store_dwordx4 v[252:255], v1, s[8:11], s37 offen offset:1024 sc1
v_accvgpr_read_b32 v144, a80
v_mfma_f32_16x16x32_bf16 a[120:123], a[180:183], v[140:143], a[120:123]
v_accvgpr_read_b32 v145, a81
v_accvgpr_read_b32 v146, a82
v_accvgpr_read_b32 v147, a83
v_accvgpr_read_b32 v148, a84
v_accvgpr_read_b32 v149, a85
v_mfma_f32_16x16x32_bf16 a[92:95], a[184:187], v[128:131], a[92:95]
v_accvgpr_read_b32 v150, a86
v_accvgpr_read_b32 v151, a87
v_mul_f32 v144, v144, v10
v_mul_f32 v145, v145, v10
v_mul_f32 v146, v146, v10
v_mfma_f32_16x16x32_bf16 a[92:95], a[188:191], v[136:139], a[92:95]
v_mul_f32 v147, v147, v10
v_mul_f32 v148, v148, v10
v_mul_f32 v149, v149, v10
v_mul_f32 v150, v150, v10
v_mul_f32 v151, v151, v10
v_mfma_f32_16x16x32_bf16 a[124:127], a[184:187], v[132:135], a[124:127]
v_cvt_pk_bf16_f32 v240, v144, v145
v_cvt_pk_bf16_f32 v241, v146, v147
v_cvt_pk_bf16_f32 v242, v148, v149
v_cvt_pk_bf16_f32 v243, v150, v151
buffer_store_dwordx4 v[240:243], v1, s[8:11], s38 offen offset:0 sc1
v_mfma_f32_16x16x32_bf16 a[124:127], a[188:191], v[140:143], a[124:127]
v_accvgpr_read_b32 v152, a112
v_accvgpr_read_b32 v153, a113
v_accvgpr_read_b32 v154, a114
v_accvgpr_read_b32 v155, a115
v_accvgpr_read_b32 v156, a116
v_accvgpr_read_b32 v157, a117
v_accvgpr_read_b32 v158, a118
v_accvgpr_read_b32 v159, a119
v_mul_f32 v152, v152, v11
v_mul_f32 v153, v153, v11
v_mul_f32 v154, v154, v11
v_mul_f32 v155, v155, v11
v_mul_f32 v156, v156, v11
v_mul_f32 v157, v157, v11
v_mul_f32 v158, v158, v11
v_mul_f32 v159, v159, v11
v_cvt_pk_bf16_f32 v244, v152, v153
v_cvt_pk_bf16_f32 v245, v154, v155
v_cvt_pk_bf16_f32 v246, v156, v157
v_cvt_pk_bf16_f32 v247, v158, v159
buffer_store_dwordx4 v[244:247], v1, s[8:11], s38 offen offset:1024 sc1
s_nop 3
v_accvgpr_read_b32 v160, a88
v_accvgpr_read_b32 v161, a89
v_accvgpr_read_b32 v162, a90
v_accvgpr_read_b32 v163, a91
v_accvgpr_read_b32 v164, a92
v_accvgpr_read_b32 v165, a93
v_accvgpr_read_b32 v166, a94
v_accvgpr_read_b32 v167, a95
v_mul_f32 v160, v160, v10
v_mul_f32 v161, v161, v10
v_mul_f32 v162, v162, v10
v_mul_f32 v163, v163, v10
v_mul_f32 v164, v164, v10
v_mul_f32 v165, v165, v10
v_mul_f32 v166, v166, v10
v_mul_f32 v167, v167, v10
v_cvt_pk_bf16_f32 v248, v160, v161
v_cvt_pk_bf16_f32 v249, v162, v163
v_cvt_pk_bf16_f32 v250, v164, v165
v_cvt_pk_bf16_f32 v251, v166, v167
buffer_store_dwordx4 v[248:251], v1, s[8:11], s39 offen offset:0 sc1
v_accvgpr_read_b32 v168, a120
v_accvgpr_read_b32 v169, a121
v_accvgpr_read_b32 v170, a122
v_accvgpr_read_b32 v171, a123
v_accvgpr_read_b32 v172, a124
v_accvgpr_read_b32 v173, a125
v_accvgpr_read_b32 v174, a126
v_accvgpr_read_b32 v175, a127
v_mul_f32 v168, v168, v11
v_mul_f32 v169, v169, v11
v_mul_f32 v170, v170, v11
v_mul_f32 v171, v171, v11
v_mul_f32 v172, v172, v11
v_mul_f32 v173, v173, v11
v_mul_f32 v174, v174, v11
v_mul_f32 v175, v175, v11
v_cvt_pk_bf16_f32 v252, v168, v169
v_cvt_pk_bf16_f32 v253, v170, v171
v_cvt_pk_bf16_f32 v254, v172, v173
v_cvt_pk_bf16_f32 v255, v174, v175
buffer_store_dwordx4 v[252:255], v1, s[8:11], s39 offen offset:1024 sc1
K2_END:
s_endpgm
K2_X3b:
s_waitcnt lgkmcnt(4)
v_mfma_f32_16x16x32_bf16 a[0:3], a[128:131], v[112:115], a[0:3]
ds_read_b128 a[176:179], v2 offset:6144
v_add_u32 v3, s25, v1
v_add_f32 v8, v8, v12
v_mfma_f32_16x16x32_bf16 a[32:35], a[128:131], v[116:119], a[32:35]
s_add_u32 m0, s26, s49
v_add_f32 v9, v9, v13
v_add_f32 v10, v10, v14
v_mfma_f32_16x16x32_bf16 a[64:67], a[128:131], v[120:123], a[64:67]
global_load_lds_dwordx4 v1, s[86:87] offset:0 sc1
v_add_f32 v11, v11, v15
v_mfma_f32_16x16x32_bf16 a[96:99], a[128:131], v[124:127], a[96:99]
s_mov_b32 s29, 96
s_call_b64 s[78:79], K2_MASK_1c
v_mfma_f32_16x16x32_bf16 a[4:7], a[136:139], v[112:115], a[4:7]
ds_read_b128 a[184:187], v2 offset:7168
v_mfma_f32_16x16x32_bf16 a[36:39], a[136:139], v[116:119], a[36:39]
global_load_lds_dwordx4 v1, s[86:87] offset:1024 sc1
v_exp_f32 v80, v80
v_mfma_f32_16x16x32_bf16 a[68:71], a[136:139], v[120:123], a[68:71]
v_exp_f32 v81, v81
v_mfma_f32_16x16x32_bf16 a[100:103], a[136:139], v[124:127], a[100:103]
s_waitcnt lgkmcnt(4)
v_exp_f32 v82, v82
v_mfma_f32_16x16x32_bf16 a[8:11], a[144:147], v[112:115], a[8:11]
ds_read_b128 a[128:131], v2 offset:16384
v_exp_f32 v83, v83
v_mfma_f32_16x16x32_bf16 a[40:43], a[144:147], v[116:119], a[40:43]
global_load_lds_dwordx4 v1, s[86:87] offset:2048 sc1
v_add_f32 v12, v80, v81
v_mfma_f32_16x16x32_bf16 a[72:75], a[144:147], v[120:123], a[72:75]
ds_read_b128 a[132:135], v2 offset:18432
v_cvt_pk_bf16_f32 v128, v80, v81
v_mfma_f32_16x16x32_bf16 a[104:107], a[144:147], v[124:127], a[104:107]
v_exp_f32 v84, v84
v_add_f32 v12, v12, v82
v_mfma_f32_16x16x32_bf16 a[12:15], a[152:155], v[112:115], a[12:15]
ds_read_b128 a[136:139], v2 offset:20480
v_add_f32 v12, v12, v83
v_mfma_f32_16x16x32_bf16 a[44:47], a[152:155], v[116:119], a[44:47]
global_load_lds_dwordx4 v1, s[86:87] offset:3072 sc1
v_cvt_pk_bf16_f32 v129, v82, v83
v_mfma_f32_16x16x32_bf16 a[76:79], a[152:155], v[120:123], a[76:79]
ds_read_b128 a[140:143], v2 offset:22528
v_exp_f32 v85, v85
v_mfma_f32_16x16x32_bf16 a[108:111], a[152:155], v[124:127], a[108:111]
s_waitcnt lgkmcnt(6)
v_exp_f32 v86, v86
v_mfma_f32_16x16x32_bf16 a[16:19], a[160:163], v[112:115], a[16:19]
ds_read_b128 a[144:147], v2 offset:17408
v_add_f32 v13, v84, v85
v_mfma_f32_16x16x32_bf16 a[48:51], a[160:163], v[116:119], a[48:51]
s_add_u32 s86, s86, 16384
s_addc_u32 s87, s87, 0
v_exp_f32 v87, v87
v_mfma_f32_16x16x32_bf16 a[80:83], a[160:163], v[120:123], a[80:83]
ds_read_b128 a[148:151], v2 offset:19456
v_cvt_pk_bf16_f32 v132, v84, v85
v_mfma_f32_16x16x32_bf16 a[112:115], a[160:163], v[124:127], a[112:115]
s_add_u32 s25, s25, 32768
v_exp_f32 v88, v88
v_mfma_f32_16x16x32_bf16 a[20:23], a[168:171], v[112:115], a[20:23]
ds_read_b128 a[152:155], v2 offset:21504
v_exp_f32 v89, v89
v_mfma_f32_16x16x32_bf16 a[52:55], a[168:171], v[116:119], a[52:55]
s_and_b32 s25, s25, 0x1ffff
v_exp_f32 v90, v90
v_mfma_f32_16x16x32_bf16 a[84:87], a[168:171], v[120:123], a[84:87]
ds_read_b128 a[156:159], v2 offset:23552
v_add_f32 v13, v13, v86
v_mfma_f32_16x16x32_bf16 a[116:119], a[168:171], v[124:127], a[116:119]
s_waitcnt lgkmcnt(8)
v_exp_f32 v91, v91
v_add_f32 v13, v13, v87
v_mfma_f32_16x16x32_bf16 a[24:27], a[176:179], v[112:115], a[24:27]
ds_read_b128 a[160:163], v2 offset:24576
v_cvt_pk_bf16_f32 v133, v86, v87
v_mfma_f32_16x16x32_bf16 a[56:59], a[176:179], v[116:119], a[56:59]
s_add_u32 s26, s26, 32768
v_exp_f32 v92, v92
v_mfma_f32_16x16x32_bf16 a[88:91], a[176:179], v[120:123], a[88:91]
ds_read_b128 a[164:167], v2 offset:26624
v_exp_f32 v93, v93
v_mfma_f32_16x16x32_bf16 a[120:123], a[176:179], v[124:127], a[120:123]
s_and_b32 s26, s26, 0x1ffff
v_exp_f32 v94, v94
v_mfma_f32_16x16x32_bf16 a[28:31], a[184:187], v[112:115], a[28:31]
ds_read_b128 a[168:171], v2 offset:28672
v_add_f32 v14, v88, v89
v_mfma_f32_16x16x32_bf16 a[60:63], a[184:187], v[116:119], a[60:63]
s_add_u32 s28, s28, 8192
v_exp_f32 v95, v95
v_cvt_pk_bf16_f32 v136, v88, v89
v_mfma_f32_16x16x32_bf16 a[92:95], a[184:187], v[120:123], a[92:95]
ds_read_b128 a[172:175], v2 offset:30720
v_add_f32 v14, v14, v90
v_mfma_f32_16x16x32_bf16 a[124:127], a[184:187], v[124:127], a[124:127]
s_waitcnt lgkmcnt(8)
v_exp_f32 v96, v96
v_mfma_f32_16x16x32_bf16 v[48:51], a[128:131], v[208:211], v[28:31]
ds_read_b128 a[176:179], v2 offset:25600
v_exp_f32 v97, v97
v_mfma_f32_16x16x32_bf16 v[48:51], a[132:135], v[212:215], v[48:51]
v_exp_f32 v98, v98
v_mfma_f32_16x16x32_bf16 v[48:51], a[136:139], v[216:219], v[48:51]
ds_read_b128 a[180:183], v2 offset:27648
v_exp_f32 v99, v99
v_mfma_f32_16x16x32_bf16 v[48:51], a[140:143], v[220:223], v[48:51]
v_exp_f32 v100, v100
v_mfma_f32_16x16x32_bf16 v[52:55], a[128:131], v[224:227], v[32:35]
ds_read_b128 a[184:187], v2 offset:29696
v_add_f32 v14, v14, v91
v_mfma_f32_16x16x32_bf16 v[52:55], a[132:135], v[228:231], v[52:55]
s_waitcnt vmcnt(4)
s_barrier
v_exp_f32 v101, v101
v_mfma_f32_16x16x32_bf16 v[52:55], a[136:139], v[232:235], v[52:55]
ds_read_b128 a[188:191], v2 offset:31744
v_cvt_pk_bf16_f32 v137, v90, v91
v_mfma_f32_16x16x32_bf16 v[52:55], a[140:143], v[236:239], v[52:55]
s_waitcnt lgkmcnt(8)
v_exp_f32 v102, v102
v_mfma_f32_16x16x32_bf16 v[56:59], a[144:147], v[208:211], v[28:31]
ds_read_b128 a[128:131], v3 offset:0
v_exp_f32 v103, v103
v_mfma_f32_16x16x32_bf16 v[56:59], a[148:151], v[212:215], v[56:59]
v_exp_f32 v104, v104
v_mfma_f32_16x16x32_bf16 v[56:59], a[152:155], v[216:219], v[56:59]
v_exp_f32 v105, v105
v_mfma_f32_16x16x32_bf16 v[56:59], a[156:159], v[220:223], v[56:59]
v_exp_f32 v106, v106
v_add_f32 v15, v92, v93
v_mfma_f32_16x16x32_bf16 v[60:63], a[144:147], v[224:227], v[32:35]
ds_read_b128 a[136:139], v3 offset:1024
v_cvt_pk_bf16_f32 v140, v92, v93
v_mfma_f32_16x16x32_bf16 v[60:63], a[148:151], v[228:231], v[60:63]
v_exp_f32 v107, v107
v_mfma_f32_16x16x32_bf16 v[60:63], a[152:155], v[232:235], v[60:63]
v_exp_f32 v108, v108
v_add_f32 v15, v15, v94
v_mfma_f32_16x16x32_bf16 v[60:63], a[156:159], v[236:239], v[60:63]
s_waitcnt lgkmcnt(6)
v_exp_f32 v109, v109
v_mfma_f32_16x16x32_bf16 v[64:67], a[160:163], v[208:211], v[28:31]
ds_read_b128 a[144:147], v3 offset:2048
v_add_f32 v15, v15, v95
v_mfma_f32_16x16x32_bf16 v[64:67], a[164:167], v[212:215], v[64:67]
v_exp_f32 v110, v110
v_cvt_pk_bf16_f32 v141, v94, v95
v_mfma_f32_16x16x32_bf16 v[64:67], a[168:171], v[216:219], v[64:67]
v_exp_f32 v111, v111
v_mfma_f32_16x16x32_bf16 v[64:67], a[172:175], v[220:223], v[64:67]
v_add_f32 v12, v12, v96
v_add_f32 v12, v12, v97
v_mfma_f32_16x16x32_bf16 v[68:71], a[160:163], v[224:227], v[32:35]
ds_read_b128 a[152:155], v3 offset:3072
v_cvt_pk_bf16_f32 v130, v96, v97
v_add_f32 v12, v12, v98
v_mfma_f32_16x16x32_bf16 v[68:71], a[164:167], v[228:231], v[68:71]
v_add_f32 v12, v12, v99
v_cvt_pk_bf16_f32 v131, v98, v99
v_mfma_f32_16x16x32_bf16 v[68:71], a[168:171], v[232:235], v[68:71]
v_add_f32 v13, v13, v100
v_add_f32 v13, v13, v101
v_mfma_f32_16x16x32_bf16 v[68:71], a[172:175], v[236:239], v[68:71]
s_waitcnt lgkmcnt(4)
v_add_f32 v13, v13, v102
v_add_f32 v13, v13, v103
v_add_f32 v14, v14, v104
v_mfma_f32_16x16x32_bf16 v[72:75], a[176:179], v[208:211], v[28:31]
ds_read_b128 a[160:163], v3 offset:4096
v_add_f32 v14, v14, v105
v_mfma_f32_16x16x32_bf16 v[72:75], a[180:183], v[212:215], v[72:75]
v_add_f32 v14, v14, v106
v_add_f32 v14, v14, v107
v_mfma_f32_16x16x32_bf16 v[72:75], a[184:187], v[216:219], v[72:75]
v_add_f32 v15, v15, v108
v_add_f32 v15, v15, v109
v_add_f32 v15, v15, v110
v_mfma_f32_16x16x32_bf16 v[72:75], a[188:191], v[220:223], v[72:75]
v_add_f32 v15, v15, v111
v_max3_f32 v16, v12, v13, v14
v_mfma_f32_16x16x32_bf16 v[76:79], a[176:179], v[224:227], v[32:35]
ds_read_b128 a[168:171], v3 offset:5120
v_max_f32 v16, v16, v15
v_mfma_f32_16x16x32_bf16 v[76:79], a[180:183], v[228:231], v[76:79]
v_cmp_nge_f32 vcc, 0x53800000, v16
v_cvt_pk_bf16_f32 v134, v100, v101
v_cvt_pk_bf16_f32 v135, v102, v103
v_mfma_f32_16x16x32_bf16 v[76:79], a[184:187], v[232:235], v[76:79]
v_cvt_pk_bf16_f32 v138, v104, v105
v_cvt_pk_bf16_f32 v139, v106, v107
v_mfma_f32_16x16x32_bf16 v[76:79], a[188:191], v[236:239], v[76:79]
s_cbranch_vccnz K2_S_X3ba
K2_R_X3ba:
v_cvt_pk_bf16_f32 v142, v108, v109
v_cvt_pk_bf16_f32 v143, v110, v111
s_waitcnt lgkmcnt(4)
v_mfma_f32_16x16x32_bf16 a[0:3], a[128:131], v[128:131], a[0:3]
ds_read_b128 a[176:179], v3 offset:6144
v_add_u32 v2, s25, v1
v_add_f32 v8, v8, v12
v_mfma_f32_16x16x32_bf16 a[32:35], a[128:131], v[132:135], a[32:35]
s_add_u32 m0, s26, s49
v_add_f32 v9, v9, v13
v_add_f32 v10, v10, v14
v_mfma_f32_16x16x32_bf16 a[64:67], a[128:131], v[136:139], a[64:67]
global_load_lds_dwordx4 v1, s[86:87] offset:0 sc1
v_add_f32 v11, v11, v15
v_mfma_f32_16x16x32_bf16 a[96:99], a[128:131], v[140:143], a[96:99]
s_mov_b32 s29, 0
s_call_b64 s[78:79], K2_MASK_0s
v_mfma_f32_16x16x32_bf16 a[4:7], a[136:139], v[128:131], a[4:7]
ds_read_b128 a[184:187], v3 offset:7168
v_exp_f32 v48, v48
v_mfma_f32_16x16x32_bf16 a[36:39], a[136:139], v[132:135], a[36:39]
global_load_lds_dwordx4 v1, s[86:87] offset:1024 sc1
v_mfma_f32_16x16x32_bf16 a[68:71], a[136:139], v[136:139], a[68:71]
v_exp_f32 v49, v49
v_mfma_f32_16x16x32_bf16 a[100:103], a[136:139], v[140:143], a[100:103]
s_waitcnt lgkmcnt(4)
v_exp_f32 v50, v50
v_mfma_f32_16x16x32_bf16 a[8:11], a[144:147], v[128:131], a[8:11]
ds_read_b128 a[128:131], v3 offset:16384
v_exp_f32 v51, v51
v_mfma_f32_16x16x32_bf16 a[40:43], a[144:147], v[132:135], a[40:43]
global_load_lds_dwordx4 v1, s[86:87] offset:2048 sc1
v_add_f32 v14, v48, v49
v_mfma_f32_16x16x32_bf16 a[72:75], a[144:147], v[136:139], a[72:75]
ds_read_b128 a[132:135], v3 offset:18432
v_exp_f32 v52, v52
v_mfma_f32_16x16x32_bf16 a[104:107], a[144:147], v[140:143], a[104:107]
v_exp_f32 v53, v53
v_mfma_f32_16x16x32_bf16 a[12:15], a[152:155], v[128:131], a[12:15]
ds_read_b128 a[136:139], v3 offset:20480
v_exp_f32 v54, v54
v_mfma_f32_16x16x32_bf16 a[44:47], a[152:155], v[132:135], a[44:47]
global_load_lds_dwordx4 v1, s[86:87] offset:3072 sc1
v_cvt_pk_bf16_f32 v112, v48, v49
v_mfma_f32_16x16x32_bf16 a[76:79], a[152:155], v[136:139], a[76:79]
ds_read_b128 a[140:143], v3 offset:22528
v_exp_f32 v55, v55
v_mfma_f32_16x16x32_bf16 a[108:111], a[152:155], v[140:143], a[108:111]
s_waitcnt lgkmcnt(6)
v_exp_f32 v56, v56
v_mfma_f32_16x16x32_bf16 a[16:19], a[160:163], v[128:131], a[16:19]
ds_read_b128 a[144:147], v3 offset:17408
v_add_f32 v14, v14, v50
v_mfma_f32_16x16x32_bf16 a[48:51], a[160:163], v[132:135], a[48:51]
s_add_u32 s86, s86, 16384
s_addc_u32 s87, s87, 0
v_exp_f32 v57, v57
v_mfma_f32_16x16x32_bf16 a[80:83], a[160:163], v[136:139], a[80:83]
ds_read_b128 a[148:151], v3 offset:19456
v_add_f32 v14, v14, v51
v_mfma_f32_16x16x32_bf16 a[112:115], a[160:163], v[140:143], a[112:115]
s_add_u32 s25, s25, 32768
v_exp_f32 v58, v58
v_cvt_pk_bf16_f32 v113, v50, v51
v_mfma_f32_16x16x32_bf16 a[20:23], a[168:171], v[128:131], a[20:23]
ds_read_b128 a[152:155], v3 offset:21504
v_add_f32 v15, v52, v53
v_mfma_f32_16x16x32_bf16 a[52:55], a[168:171], v[132:135], a[52:55]
s_and_b32 s25, s25, 0x1ffff
v_exp_f32 v59, v59
v_cvt_pk_bf16_f32 v116, v52, v53
v_mfma_f32_16x16x32_bf16 a[84:87], a[168:171], v[136:139], a[84:87]
ds_read_b128 a[156:159], v3 offset:23552
v_add_f32 v15, v15, v54
v_mfma_f32_16x16x32_bf16 a[116:119], a[168:171], v[140:143], a[116:119]
s_waitcnt lgkmcnt(8)
v_exp_f32 v60, v60
v_add_f32 v15, v15, v55
v_mfma_f32_16x16x32_bf16 a[24:27], a[176:179], v[128:131], a[24:27]
ds_read_b128 a[160:163], v3 offset:24576
v_cvt_pk_bf16_f32 v117, v54, v55
v_mfma_f32_16x16x32_bf16 a[56:59], a[176:179], v[132:135], a[56:59]
s_add_u32 s26, s26, 32768
v_exp_f32 v61, v61
v_add_f32 v14, v14, v56
v_mfma_f32_16x16x32_bf16 a[88:91], a[176:179], v[136:139], a[88:91]
ds_read_b128 a[164:167], v3 offset:26624
v_add_f32 v14, v14, v57
v_mfma_f32_16x16x32_bf16 a[120:123], a[176:179], v[140:143], a[120:123]
s_and_b32 s26, s26, 0x1ffff
v_exp_f32 v62, v62
v_cvt_pk_bf16_f32 v114, v56, v57
v_mfma_f32_16x16x32_bf16 a[28:31], a[184:187], v[128:131], a[28:31]
ds_read_b128 a[168:171], v3 offset:28672
v_add_f32 v14, v14, v58
v_mfma_f32_16x16x32_bf16 a[60:63], a[184:187], v[132:135], a[60:63]
s_add_u32 s28, s28, 8192
v_exp_f32 v63, v63
v_add_f32 v14, v14, v59
v_mfma_f32_16x16x32_bf16 a[92:95], a[184:187], v[136:139], a[92:95]
ds_read_b128 a[172:175], v3 offset:30720
v_cvt_pk_bf16_f32 v115, v58, v59
v_mfma_f32_16x16x32_bf16 a[124:127], a[184:187], v[140:143], a[124:127]
s_waitcnt lgkmcnt(8)
v_exp_f32 v64, v64
v_mfma_f32_16x16x32_bf16 v[80:83], a[128:131], v[208:211], v[28:31]
ds_read_b128 a[176:179], v3 offset:25600
v_exp_f32 v65, v65
v_mfma_f32_16x16x32_bf16 v[80:83], a[132:135], v[212:215], v[80:83]
v_exp_f32 v66, v66
v_mfma_f32_16x16x32_bf16 v[80:83], a[136:139], v[216:219], v[80:83]
ds_read_b128 a[180:183], v3 offset:27648
v_exp_f32 v67, v67
v_mfma_f32_16x16x32_bf16 v[80:83], a[140:143], v[220:223], v[80:83]
v_exp_f32 v68, v68
v_mfma_f32_16x16x32_bf16 v[84:87], a[128:131], v[224:227], v[32:35]
ds_read_b128 a[184:187], v3 offset:29696
v_exp_f32 v69, v69
v_mfma_f32_16x16x32_bf16 v[84:87], a[132:135], v[228:231], v[84:87]
s_waitcnt vmcnt(4)
s_barrier
v_add_f32 v15, v15, v60
v_mfma_f32_16x16x32_bf16 v[84:87], a[136:139], v[232:235], v[84:87]
ds_read_b128 a[188:191], v3 offset:31744
v_exp_f32 v70, v70
v_mfma_f32_16x16x32_bf16 v[84:87], a[140:143], v[236:239], v[84:87]
s_waitcnt lgkmcnt(8)
v_exp_f32 v71, v71
v_mfma_f32_16x16x32_bf16 v[88:91], a[144:147], v[208:211], v[28:31]
ds_read_b128 a[128:131], v2 offset:0
v_exp_f32 v72, v72
v_mfma_f32_16x16x32_bf16 v[88:91], a[148:151], v[212:215], v[88:91]
v_exp_f32 v73, v73
v_mfma_f32_16x16x32_bf16 v[88:91], a[152:155], v[216:219], v[88:91]
ds_read_b128 a[132:135], v2 offset:8192
v_exp_f32 v74, v74
v_mfma_f32_16x16x32_bf16 v[88:91], a[156:159], v[220:223], v[88:91]
v_exp_f32 v75, v75
v_mfma_f32_16x16x32_bf16 v[92:95], a[144:147], v[224:227], v[32:35]
ds_read_b128 a[136:139], v2 offset:1024
v_exp_f32 v76, v76
v_mfma_f32_16x16x32_bf16 v[92:95], a[148:151], v[228:231], v[92:95]
v_exp_f32 v77, v77
v_mfma_f32_16x16x32_bf16 v[92:95], a[152:155], v[232:235], v[92:95]
ds_read_b128 a[140:143], v2 offset:9216
v_exp_f32 v78, v78
v_mfma_f32_16x16x32_bf16 v[92:95], a[156:159], v[236:239], v[92:95]
s_waitcnt lgkmcnt(8)
v_exp_f32 v79, v79
v_mfma_f32_16x16x32_bf16 v[96:99], a[160:163], v[208:211], v[28:31]
ds_read_b128 a[144:147], v2 offset:2048
v_add_f32 v15, v15, v61
v_mfma_f32_16x16x32_bf16 v[96:99], a[164:167], v[212:215], v[96:99]
v_cvt_pk_bf16_f32 v118, v60, v61
v_add_f32 v15, v15, v62
v_add_f32 v15, v15, v63
v_mfma_f32_16x16x32_bf16 v[96:99], a[168:171], v[216:219], v[96:99]
ds_read_b128 a[148:151], v2 offset:10240
v_cvt_pk_bf16_f32 v119, v62, v63
v_mfma_f32_16x16x32_bf16 v[96:99], a[172:175], v[220:223], v[96:99]
v_add_f32 v14, v14, v64
v_add_f32 v14, v14, v65
v_cvt_pk_bf16_f32 v120, v64, v65
v_mfma_f32_16x16x32_bf16 v[100:103], a[160:163], v[224:227], v[32:35]
ds_read_b128 a[152:155], v2 offset:3072
v_add_f32 v14, v14, v66
v_mfma_f32_16x16x32_bf16 v[100:103], a[164:167], v[228:231], v[100:103]
v_add_f32 v14, v14, v67
v_cvt_pk_bf16_f32 v121, v66, v67
v_add_f32 v15, v15, v68
v_mfma_f32_16x16x32_bf16 v[100:103], a[168:171], v[232:235], v[100:103]
ds_read_b128 a[156:159], v2 offset:11264
v_add_f32 v15, v15, v69
v_mfma_f32_16x16x32_bf16 v[100:103], a[172:175], v[236:239], v[100:103]
s_waitcnt lgkmcnt(8)
v_add_f32 v15, v15, v70
v_add_f32 v15, v15, v71
v_add_f32 v14, v14, v72
v_mfma_f32_16x16x32_bf16 v[104:107], a[176:179], v[208:211], v[28:31]
ds_read_b128 a[160:163], v2 offset:4096
v_add_f32 v14, v14, v73
v_mfma_f32_16x16x32_bf16 v[104:107], a[180:183], v[212:215], v[104:107]
v_add_f32 v14, v14, v74
v_add_f32 v14, v14, v75
v_add_f32 v15, v15, v76
v_mfma_f32_16x16x32_bf16 v[104:107], a[184:187], v[216:219], v[104:107]
ds_read_b128 a[164:167], v2 offset:12288
v_add_f32 v15, v15, v77
v_mfma_f32_16x16x32_bf16 v[104:107], a[188:191], v[220:223], v[104:107]
v_add_f32 v15, v15, v78
v_add_f32 v15, v15, v79
v_max_f32 v16, v14, v15
v_mfma_f32_16x16x32_bf16 v[108:111], a[176:179], v[224:227], v[32:35]
ds_read_b128 a[168:171], v2 offset:5120
v_cmp_nge_f32 vcc, 0x53800000, v16
v_mfma_f32_16x16x32_bf16 v[108:111], a[180:183], v[228:231], v[108:111]
v_cvt_pk_bf16_f32 v124, v68, v69
v_cvt_pk_bf16_f32 v125, v70, v71
v_cvt_pk_bf16_f32 v122, v72, v73
v_mfma_f32_16x16x32_bf16 v[108:111], a[184:187], v[232:235], v[108:111]
ds_read_b128 a[172:175], v2 offset:13312
v_cvt_pk_bf16_f32 v123, v74, v75
v_mfma_f32_16x16x32_bf16 v[108:111], a[188:191], v[236:239], v[108:111]
s_cbranch_vccnz K2_S_X3bb
K2_R_X3bb:
v_cvt_pk_bf16_f32 v126, v76, v77
v_cvt_pk_bf16_f32 v127, v78, v79
v_lshrrev_b32 v164, 2, v0
v_and_b32 v165, 3, v0
v_lshlrev_b32 v165, 3, v165
v_lshl_add_u32 v166, v164, 6, v165
v_lshl_add_u32 v165, v164, 9, v165
v_add_u32 v165, 131072, v165
v_and_b32 v164, 7, v164
s_lshl_b32 s36, s20, 2
v_xor_b32 v164, s36, v164
s_and_b32 s36, s20, 1
s_lshl_b32 s36, s36, 5
s_add_u32 s36, s36, 147456
v_add_u32 v166, s36, v166
v_xor_b32 v168, 0, v164
v_lshl_add_u32 v168, v168, 5, v165
ds_read_b64_tr_b16 v[144:145], v168 offset:0
ds_read_b64_tr_b16 v[146:147], v168 offset:8192
v_xor_b32 v169, 1, v164
v_lshl_add_u32 v169, v169, 5, v165
ds_read_b64_tr_b16 v[148:149], v169 offset:0
ds_read_b64_tr_b16 v[150:151], v169 offset:8192
v_xor_b32 v170, 2, v164
v_lshl_add_u32 v170, v170, 5, v165
ds_read_b64_tr_b16 v[152:153], v170 offset:0
ds_read_b64_tr_b16 v[154:155], v170 offset:8192
v_xor_b32 v171, 3, v164
v_lshl_add_u32 v171, v171, 5, v165
ds_read_b64_tr_b16 v[156:157], v171 offset:0
ds_read_b64_tr_b16 v[158:159], v171 offset:8192
ds_read_b64_tr_b16 v[160:161], v166 offset:0
ds_read_b64_tr_b16 v[162:163], v166 offset:1024
s_and_b32 s36, s2, 1
s_lshl_b32 s36, s36, 2
s_add_u32 s36, s36, s20
s_mul_i32 s36, s36, 589824
s_lshr_b32 s37, s2, 1
s_lshl_b32 s37, s37, 12
s_add_u32 s36, s36, s37
s_add_u32 s36, s36, 83886080
s_waitcnt lgkmcnt(8)
buffer_store_dwordx4 v[144:147], v1, s[8:11], s36 offen offset:0 sc1
s_waitcnt lgkmcnt(6)
buffer_store_dwordx4 v[148:151], v1, s[8:11], s36 offen offset:1024 sc1
s_waitcnt lgkmcnt(4)
buffer_store_dwordx4 v[152:155], v1, s[8:11], s36 offen offset:2048 sc1
s_waitcnt lgkmcnt(2)
buffer_store_dwordx4 v[156:159], v1, s[8:11], s36 offen offset:3072 sc1
s_bfe_u32 s36, s2, 0x30001
s_mul_i32 s36, s36, 589824
s_and_b32 s37, s2, 1
s_lshl_b32 s37, s37, 11
s_add_u32 s36, s36, s37
s_and_b32 s37, s20, 1
s_lshl_b32 s37, s37, 10
s_add_u32 s36, s36, s37
s_lshr_b32 s37, s2, 4
s_lshl_b32 s37, s37, 12
s_add_u32 s36, s36, s37
s_add_u32 s36, s36, 84410368
s_waitcnt lgkmcnt(0)
buffer_store_dwordx4 v[160:163], v1, s[8:11], s36 offen sc1
s_nop 0
s_lshl_b32 s36, s21, 14
s_add_u32 s36, s36, 58720256
s_and_b32 s37, s20, 1
s_lshl_b32 s37, s37, 11
s_add_u32 s36, s36, s37
s_lshr_b32 s37, s20, 1
s_mul_i32 s37, s37, 589824
s_add_u32 s36, s36, s37
s_mul_i32 s37, s22, 1179648
s_add_u32 s36, s36, s37
s_add_u32 s37, s36, 4096
s_add_u32 s38, s36, 8192
s_add_u32 s39, s36, 12288
v_mov_b32 v16, v8
s_nop 1
v_permlane32_swap_b32 v8, v16
v_add_f32 v8, v8, v16
v_mov_b32 v16, v8
s_nop 1
v_permlane16_swap_b32 v8, v16
v_add_f32 v8, v8, v16
v_rcp_f32 v8, v8
v_mov_b32 v16, v9
s_nop 1
v_permlane32_swap_b32 v9, v16
v_add_f32 v9, v9, v16
v_mov_b32 v16, v9
s_nop 1
v_permlane16_swap_b32 v9, v16
v_add_f32 v9, v9, v16
v_rcp_f32 v9, v9
v_accvgpr_read_b32 v144, a0
v_accvgpr_read_b32 v145, a1
v_accvgpr_read_b32 v146, a2
v_accvgpr_read_b32 v147, a3
v_accvgpr_read_b32 v148, a4
v_accvgpr_read_b32 v149, a5
v_accvgpr_read_b32 v150, a6
v_accvgpr_read_b32 v151, a7
v_accvgpr_read_b32 v152, a8
v_accvgpr_read_b32 v153, a9
v_accvgpr_read_b32 v154, a10
v_accvgpr_read_b32 v155, a11
v_accvgpr_read_b32 v156, a12
v_accvgpr_read_b32 v157, a13
v_accvgpr_read_b32 v158, a14
v_accvgpr_read_b32 v159, a15
v_mul_f32 v144, v144, v8
v_mul_f32 v145, v145, v8
v_mul_f32 v146, v146, v8
v_mul_f32 v147, v147, v8
v_mul_f32 v148, v148, v8
v_mul_f32 v149, v149, v8
v_mul_f32 v150, v150, v8
v_mul_f32 v151, v151, v8
v_mul_f32 v152, v152, v8
v_mul_f32 v153, v153, v8
v_mul_f32 v154, v154, v8
v_mul_f32 v155, v155, v8
v_mul_f32 v156, v156, v8
v_mul_f32 v157, v157, v8
v_mul_f32 v158, v158, v8
v_mul_f32 v159, v159, v8
v_cvt_pk_bf16_f32 v240, v144, v145
v_cvt_pk_bf16_f32 v241, v146, v147
v_cvt_pk_bf16_f32 v242, v148, v149
v_cvt_pk_bf16_f32 v243, v150, v151
v_cvt_pk_bf16_f32 v244, v152, v153
v_cvt_pk_bf16_f32 v245, v154, v155
v_cvt_pk_bf16_f32 v246, v156, v157
v_cvt_pk_bf16_f32 v247, v158, v159
buffer_store_dwordx4 v[240:243], v1, s[8:11], s36 offen offset:0 sc1
buffer_store_dwordx4 v[244:247], v1, s[8:11], s37 offen offset:0 sc1
v_accvgpr_read_b32 v160, a16
v_accvgpr_read_b32 v161, a17
v_accvgpr_read_b32 v162, a18
v_accvgpr_read_b32 v163, a19
v_accvgpr_read_b32 v164, a20
v_accvgpr_read_b32 v165, a21
v_accvgpr_read_b32 v166, a22
v_accvgpr_read_b32 v167, a23
v_accvgpr_read_b32 v168, a24
v_accvgpr_read_b32 v169, a25
v_accvgpr_read_b32 v170, a26
v_accvgpr_read_b32 v171, a27
v_accvgpr_read_b32 v172, a28
v_accvgpr_read_b32 v173, a29
v_accvgpr_read_b32 v174, a30
v_accvgpr_read_b32 v175, a31
v_mul_f32 v160, v160, v8
v_mul_f32 v161, v161, v8
v_mul_f32 v162, v162, v8
v_mul_f32 v163, v163, v8
v_mul_f32 v164, v164, v8
v_mul_f32 v165, v165, v8
v_mul_f32 v166, v166, v8
v_mul_f32 v167, v167, v8
v_mul_f32 v168, v168, v8
v_mul_f32 v169, v169, v8
v_mul_f32 v170, v170, v8
v_mul_f32 v171, v171, v8
v_mul_f32 v172, v172, v8
v_mul_f32 v173, v173, v8
v_mul_f32 v174, v174, v8
v_mul_f32 v175, v175, v8
v_cvt_pk_bf16_f32 v248, v160, v161
v_cvt_pk_bf16_f32 v249, v162, v163
v_cvt_pk_bf16_f32 v250, v164, v165
v_cvt_pk_bf16_f32 v251, v166, v167
v_cvt_pk_bf16_f32 v252, v168, v169
v_cvt_pk_bf16_f32 v253, v170, v171
v_cvt_pk_bf16_f32 v254, v172, v173
v_cvt_pk_bf16_f32 v255, v174, v175
buffer_store_dwordx4 v[248:251], v1, s[8:11], s38 offen offset:0 sc1
buffer_store_dwordx4 v[252:255], v1, s[8:11], s39 offen offset:0 sc1
v_accvgpr_read_b32 v144, a32
v_accvgpr_read_b32 v145, a33
v_accvgpr_read_b32 v146, a34
v_accvgpr_read_b32 v147, a35
v_accvgpr_read_b32 v148, a36
v_accvgpr_read_b32 v149, a37
v_accvgpr_read_b32 v150, a38
v_accvgpr_read_b32 v151, a39
v_accvgpr_read_b32 v152, a40
v_accvgpr_read_b32 v153, a41
v_accvgpr_read_b32 v154, a42
v_accvgpr_read_b32 v155, a43
v_accvgpr_read_b32 v156, a44
v_accvgpr_read_b32 v157, a45
v_accvgpr_read_b32 v158, a46
v_accvgpr_read_b32 v159, a47
v_mul_f32 v144, v144, v9
v_mul_f32 v145, v145, v9
v_mul_f32 v146, v146, v9
v_mul_f32 v147, v147, v9
v_mul_f32 v148, v148, v9
v_mul_f32 v149, v149, v9
v_mul_f32 v150, v150, v9
v_mul_f32 v151, v151, v9
v_mul_f32 v152, v152, v9
v_mul_f32 v153, v153, v9
v_mul_f32 v154, v154, v9
v_mul_f32 v155, v155, v9
v_mul_f32 v156, v156, v9
v_mul_f32 v157, v157, v9
v_mul_f32 v158, v158, v9
v_mul_f32 v159, v159, v9
v_cvt_pk_bf16_f32 v240, v144, v145
v_cvt_pk_bf16_f32 v241, v146, v147
v_cvt_pk_bf16_f32 v242, v148, v149
v_cvt_pk_bf16_f32 v243, v150, v151
v_cvt_pk_bf16_f32 v244, v152, v153
v_cvt_pk_bf16_f32 v245, v154, v155
v_cvt_pk_bf16_f32 v246, v156, v157
v_cvt_pk_bf16_f32 v247, v158, v159
buffer_store_dwordx4 v[240:243], v1, s[8:11], s36 offen offset:1024 sc1
buffer_store_dwordx4 v[244:247], v1, s[8:11], s37 offen offset:1024 sc1
v_accvgpr_read_b32 v160, a48
v_accvgpr_read_b32 v161, a49
v_accvgpr_read_b32 v162, a50
v_accvgpr_read_b32 v163, a51
v_accvgpr_read_b32 v164, a52
v_accvgpr_read_b32 v165, a53
v_accvgpr_read_b32 v166, a54
v_accvgpr_read_b32 v167, a55
v_accvgpr_read_b32 v168, a56
v_accvgpr_read_b32 v169, a57
v_accvgpr_read_b32 v170, a58
v_accvgpr_read_b32 v171, a59
v_accvgpr_read_b32 v172, a60
v_accvgpr_read_b32 v173, a61
v_accvgpr_read_b32 v174, a62
v_accvgpr_read_b32 v175, a63
v_mul_f32 v160, v160, v9
v_mul_f32 v161, v161, v9
v_mul_f32 v162, v162, v9
v_mul_f32 v163, v163, v9
v_mul_f32 v164, v164, v9
v_mul_f32 v165, v165, v9
v_mul_f32 v166, v166, v9
v_mul_f32 v167, v167, v9
v_mul_f32 v168, v168, v9
v_mul_f32 v169, v169, v9
v_mul_f32 v170, v170, v9
v_mul_f32 v171, v171, v9
v_mul_f32 v172, v172, v9
v_mul_f32 v173, v173, v9
v_mul_f32 v174, v174, v9
v_mul_f32 v175, v175, v9
v_cvt_pk_bf16_f32 v248, v160, v161
v_cvt_pk_bf16_f32 v249, v162, v163
v_cvt_pk_bf16_f32 v250, v164, v165
v_cvt_pk_bf16_f32 v251, v166, v167
v_cvt_pk_bf16_f32 v252, v168, v169
v_cvt_pk_bf16_f32 v253, v170, v171
v_cvt_pk_bf16_f32 v254, v172, v173
v_cvt_pk_bf16_f32 v255, v174, v175
buffer_store_dwordx4 v[248:251], v1, s[8:11], s38 offen offset:1024 sc1
buffer_store_dwordx4 v[252:255], v1, s[8:11], s39 offen offset:1024 sc1
s_branch K2_TL
K2_SLOWP:
s_mov_b32 s36, 0x80000
s_nop 0
K2_SP1:
buffer_load_dword v247, v246, s[80:83], 0 offen sc1
s_waitcnt vmcnt(0)
v_cmp_gt_u32 vcc, 8, v247
s_cbranch_vccz K2_POLLED
s_sleep 64
s_sub_u32 s36, s36, 1
s_cmp_lg_u32 s36, 0
s_cbranch_scc1 K2_SP1
s_branch K2_POLLED
K2_S_CCa:
s_call_b64 s[30:31], K2_RARE_1cc
s_branch K2_R_CCa
K2_S_CCb:
s_call_b64 s[30:31], K2_RARE_0cc
s_branch K2_R_CCb
K2_S_X1a:
s_call_b64 s[30:31], K2_RARE_1cc
s_branch K2_R_X1a
K2_S_X1b:
s_call_b64 s[30:31], K2_RARE_0cc
s_branch K2_R_X1b
K2_S_X2a:
s_call_b64 s[30:31], K2_RARE_1cc
s_branch K2_R_X2a
K2_S_X2b:
s_call_b64 s[30:31], K2_RARE_0cc
s_branch K2_R_X2b
K2_S_X3a:
s_call_b64 s[30:31], K2_RARE_1cs
s_branch K2_R_X3a
K2_S_X3b:
s_call_b64 s[30:31], K2_RARE_0ss
s_branch K2_R_X3b
K2_S_X3ba:
s_call_b64 s[30:31], K2_RARE_1cs
s_branch K2_R_X3ba
K2_S_X3bb:
s_call_b64 s[30:31], K2_RARE_0ss
s_branch K2_R_X3bb
K2_S_SSa:
s_call_b64 s[30:31], K2_RARE_1ss
s_branch K2_R_SSa
K2_S_SSb:
s_call_b64 s[30:31], K2_RARE_0ss
s_branch K2_R_SSb
K2_S_X4a:
s_call_b64 s[30:31], K2_RARE_1ss
s_branch K2_R_X4a
K2_S_X4b:
s_call_b64 s[30:31], K2_RARE_0ss
s_branch K2_R_X4b
K2_S_TLa:
s_call_b64 s[30:31], K2_RARE_1sn
s_branch K2_R_TLa
K2_RARE_0cc:
s_nop 7
s_nop 7
s_add_u32 s36, s28, 0
s_add_u32 s37, s36, 4096
buffer_load_dwordx4 v[144:147], v1, s[8:11], s36 offen offset:0 sc1
buffer_load_dwordx4 v[148:151], v1, s[8:11], s36 offen offset:2048 sc1
buffer_load_dwordx4 v[152:155], v1, s[8:11], s37 offen offset:0 sc1
buffer_load_dwordx4 v[156:159], v1, s[8:11], s37 offen offset:2048 sc1
buffer_load_dwordx4 v[160:163], v1, s[8:11], s36 offen offset:1024 sc1
buffer_load_dwordx4 v[164:167], v1, s[8:11], s36 offen offset:3072 sc1
buffer_load_dwordx4 v[168:171], v1, s[8:11], s37 offen offset:1024 sc1
buffer_load_dwordx4 v[172:175], v1, s[8:11], s37 offen offset:3072 sc1
s_waitcnt vmcnt(0)
v_mfma_f32_16x16x32_bf16 v[48:51], v[144:147], v[176:179], v[20:23]
v_mfma_f32_16x16x32_bf16 v[48:51], v[148:151], v[180:183], v[48:51]
v_mfma_f32_16x16x32_bf16 v[48:51], v[152:155], v[184:187], v[48:51]
v_mfma_f32_16x16x32_bf16 v[48:51], v[156:159], v[188:191], v[48:51]
v_mfma_f32_16x16x32_bf16 v[52:55], v[144:147], v[192:195], v[24:27]
v_mfma_f32_16x16x32_bf16 v[52:55], v[148:151], v[196:199], v[52:55]
v_mfma_f32_16x16x32_bf16 v[52:55], v[152:155], v[200:203], v[52:55]
v_mfma_f32_16x16x32_bf16 v[52:55], v[156:159], v[204:207], v[52:55]
v_mfma_f32_16x16x32_bf16 v[56:59], v[144:147], v[208:211], v[28:31]
v_mfma_f32_16x16x32_bf16 v[56:59], v[148:151], v[212:215], v[56:59]
v_mfma_f32_16x16x32_bf16 v[56:59], v[152:155], v[216:219], v[56:59]
v_mfma_f32_16x16x32_bf16 v[56:59], v[156:159], v[220:223], v[56:59]
v_mfma_f32_16x16x32_bf16 v[60:63], v[144:147], v[224:227], v[32:35]
v_mfma_f32_16x16x32_bf16 v[60:63], v[148:151], v[228:231], v[60:63]
v_mfma_f32_16x16x32_bf16 v[60:63], v[152:155], v[232:235], v[60:63]
v_mfma_f32_16x16x32_bf16 v[60:63], v[156:159], v[236:239], v[60:63]
v_mfma_f32_16x16x32_bf16 v[64:67], v[160:163], v[176:179], v[20:23]
v_mfma_f32_16x16x32_bf16 v[64:67], v[164:167], v[180:183], v[64:67]
v_mfma_f32_16x16x32_bf16 v[64:67], v[168:171], v[184:187], v[64:67]
v_mfma_f32_16x16x32_bf16 v[64:67], v[172:175], v[188:191], v[64:67]
v_mfma_f32_16x16x32_bf16 v[68:71], v[160:163], v[192:195], v[24:27]
v_mfma_f32_16x16x32_bf16 v[68:71], v[164:167], v[196:199], v[68:71]
v_mfma_f32_16x16x32_bf16 v[68:71], v[168:171], v[200:203], v[68:71]
v_mfma_f32_16x16x32_bf16 v[68:71], v[172:175], v[204:207], v[68:71]
v_mfma_f32_16x16x32_bf16 v[72:75], v[160:163], v[208:211], v[28:31]
v_mfma_f32_16x16x32_bf16 v[72:75], v[164:167], v[212:215], v[72:75]
v_mfma_f32_16x16x32_bf16 v[72:75], v[168:171], v[216:219], v[72:75]
v_mfma_f32_16x16x32_bf16 v[72:75], v[172:175], v[220:223], v[72:75]
v_mfma_f32_16x16x32_bf16 v[76:79], v[160:163], v[224:227], v[32:35]
v_mfma_f32_16x16x32_bf16 v[76:79], v[164:167], v[228:231], v[76:79]
v_mfma_f32_16x16x32_bf16 v[76:79], v[168:171], v[232:235], v[76:79]
v_mfma_f32_16x16x32_bf16 v[76:79], v[172:175], v[236:239], v[76:79]
s_nop 7
s_call_b64 s[78:79], K2_MASK_0c
v_max_f32 v36, v48, v49
v_max_f32 v37, v52, v53
v_max_f32 v38, v56, v57
v_max_f32 v39, v60, v61
v_max3_f32 v36, v36, v50, v51
v_max3_f32 v37, v37, v54, v55
v_max3_f32 v38, v38, v58, v59
v_max3_f32 v39, v39, v62, v63
v_max3_f32 v36, v36, v64, v65
v_max3_f32 v37, v37, v68, v69
v_max3_f32 v38, v38, v72, v73
v_max3_f32 v39, v39, v76, v77
v_max3_f32 v36, v36, v66, v67
v_max3_f32 v37, v37, v70, v71
v_max3_f32 v38, v38, v74, v75
v_max3_f32 v39, v39, v78, v79
v_mov_b32 v40, v36
v_mov_b32 v41, v37
v_mov_b32 v42, v38
v_mov_b32 v43, v39
v_permlane32_swap_b32 v36, v40
v_permlane32_swap_b32 v37, v41
v_permlane32_swap_b32 v38, v42
v_permlane32_swap_b32 v39, v43
v_max_f32 v36, v36, v40
v_max_f32 v37, v37, v41
v_max_f32 v38, v38, v42
v_max_f32 v39, v39, v43
v_mov_b32 v40, v36
v_mov_b32 v41, v37
v_mov_b32 v42, v38
v_mov_b32 v43, v39
v_permlane16_swap_b32 v36, v40
v_permlane16_swap_b32 v37, v41
v_permlane16_swap_b32 v38, v42
v_permlane16_swap_b32 v39, v43
v_max_f32 v36, v36, v40
v_max_f32 v37, v37, v41
v_max_f32 v38, v38, v42
v_max_f32 v39, v39, v43
v_ceil_f32 v36, v36
v_ceil_f32 v37, v37
v_ceil_f32 v38, v38
v_ceil_f32 v39, v39
v_max_f32 v36, 0, v36
v_max_f32 v37, 0, v37
v_max_f32 v38, 0, v38
v_max_f32 v39, 0, v39
v_sub_f32 v48, v48, v36
v_sub_f32 v49, v49, v36
v_sub_f32 v50, v50, v36
v_sub_f32 v51, v51, v36
v_sub_f32 v52, v52, v37
v_sub_f32 v53, v53, v37
v_sub_f32 v54, v54, v37
v_sub_f32 v55, v55, v37
v_sub_f32 v56, v56, v38
v_sub_f32 v57, v57, v38
v_sub_f32 v58, v58, v38
v_sub_f32 v59, v59, v38
v_sub_f32 v60, v60, v39
v_sub_f32 v61, v61, v39
v_sub_f32 v62, v62, v39
v_sub_f32 v63, v63, v39
v_sub_f32 v64, v64, v36
v_sub_f32 v65, v65, v36
v_sub_f32 v66, v66, v36
v_sub_f32 v67, v67, v36
v_sub_f32 v68, v68, v37
v_sub_f32 v69, v69, v37
v_sub_f32 v70, v70, v37
v_sub_f32 v71, v71, v37
v_sub_f32 v72, v72, v38
v_sub_f32 v73, v73, v38
v_sub_f32 v74, v74, v38
v_sub_f32 v75, v75, v38
v_sub_f32 v76, v76, v39
v_sub_f32 v77, v77, v39
v_sub_f32 v78, v78, v39
v_sub_f32 v79, v79, v39
v_sub_f32 v80, v80, v36
v_sub_f32 v81, v81, v36
v_sub_f32 v82, v82, v36
v_sub_f32 v83, v83, v36
v_sub_f32 v84, v84, v37
v_sub_f32 v85, v85, v37
v_sub_f32 v86, v86, v37
v_sub_f32 v87, v87, v37
v_sub_f32 v88, v88, v38
v_sub_f32 v89, v89, v38
v_sub_f32 v90, v90, v38
v_sub_f32 v91, v91, v38
v_sub_f32 v92, v92, v39
v_sub_f32 v93, v93, v39
v_sub_f32 v94, v94, v39
v_sub_f32 v95, v95, v39
v_sub_f32 v96, v96, v36
v_sub_f32 v97, v97, v36
v_sub_f32 v98, v98, v36
v_sub_f32 v99, v99, v36
v_sub_f32 v100, v100, v37
v_sub_f32 v101, v101, v37
v_sub_f32 v102, v102, v37
v_sub_f32 v103, v103, v37
v_sub_f32 v104, v104, v38
v_sub_f32 v105, v105, v38
v_sub_f32 v106, v106, v38
v_sub_f32 v107, v107, v38
v_sub_f32 v108, v108, v39
v_sub_f32 v109, v109, v39
v_sub_f32 v110, v110, v39
v_sub_f32 v111, v111, v39
v_sub_f32 v20, v20, v36
v_sub_f32 v21, v21, v36
v_sub_f32 v22, v22, v36
v_sub_f32 v23, v23, v36
v_exp_f32 v40, -v36
v_sub_f32 v24, v24, v37
v_sub_f32 v25, v25, v37
v_sub_f32 v26, v26, v37
v_sub_f32 v27, v27, v37
v_exp_f32 v41, -v37
v_sub_f32 v28, v28, v38
v_sub_f32 v29, v29, v38
v_sub_f32 v30, v30, v38
v_sub_f32 v31, v31, v38
v_exp_f32 v42, -v38
v_sub_f32 v32, v32, v39
v_sub_f32 v33, v33, v39
v_sub_f32 v34, v34, v39
v_sub_f32 v35, v35, v39
v_exp_f32 v43, -v39
v_exp_f32 v48, v48
v_exp_f32 v49, v49
v_exp_f32 v50, v50
v_exp_f32 v51, v51
v_exp_f32 v52, v52
v_add_f32 v12, v48, v49
v_cvt_pk_bf16_f32 v112, v48, v49
v_exp_f32 v53, v53
v_add_f32 v12, v12, v50
v_add_f32 v12, v12, v51
v_exp_f32 v54, v54
v_cvt_pk_bf16_f32 v113, v50, v51
v_exp_f32 v55, v55
v_exp_f32 v56, v56
v_add_f32 v13, v52, v53
v_cvt_pk_bf16_f32 v116, v52, v53
v_exp_f32 v57, v57
v_add_f32 v13, v13, v54
v_add_f32 v13, v13, v55
v_exp_f32 v58, v58
v_cvt_pk_bf16_f32 v117, v54, v55
v_exp_f32 v59, v59
v_exp_f32 v60, v60
v_add_f32 v14, v56, v57
v_cvt_pk_bf16_f32 v120, v56, v57
v_exp_f32 v61, v61
v_add_f32 v14, v14, v58
v_add_f32 v14, v14, v59
v_exp_f32 v62, v62
v_cvt_pk_bf16_f32 v121, v58, v59
v_exp_f32 v63, v63
v_exp_f32 v64, v64
v_add_f32 v15, v60, v61
v_cvt_pk_bf16_f32 v124, v60, v61
v_exp_f32 v65, v65
v_add_f32 v15, v15, v62
v_add_f32 v15, v15, v63
v_exp_f32 v66, v66
v_cvt_pk_bf16_f32 v125, v62, v63
v_exp_f32 v67, v67
v_exp_f32 v68, v68
v_add_f32 v12, v12, v64
v_add_f32 v12, v12, v65
v_exp_f32 v69, v69
v_cvt_pk_bf16_f32 v114, v64, v65
v_add_f32 v12, v12, v66
v_exp_f32 v70, v70
v_add_f32 v12, v12, v67
v_cvt_pk_bf16_f32 v115, v66, v67
v_exp_f32 v71, v71
v_exp_f32 v72, v72
v_add_f32 v13, v13, v68
v_add_f32 v13, v13, v69
v_exp_f32 v73, v73
v_cvt_pk_bf16_f32 v118, v68, v69
v_add_f32 v13, v13, v70
v_exp_f32 v74, v74
v_add_f32 v13, v13, v71
v_cvt_pk_bf16_f32 v119, v70, v71
v_exp_f32 v75, v75
v_exp_f32 v76, v76
v_add_f32 v14, v14, v72
v_add_f32 v14, v14, v73
v_exp_f32 v77, v77
v_cvt_pk_bf16_f32 v122, v72, v73
v_add_f32 v14, v14, v74
v_exp_f32 v78, v78
v_add_f32 v14, v14, v75
v_cvt_pk_bf16_f32 v123, v74, v75
v_exp_f32 v79, v79
s_nop 0
v_add_f32 v15, v15, v76
v_add_f32 v15, v15, v77
v_cvt_pk_bf16_f32 v126, v76, v77
v_add_f32 v15, v15, v78
v_add_f32 v15, v15, v79
v_cvt_pk_bf16_f32 v127, v78, v79
v_mul_f32 v8, v8, v40
v_mul_f32 v9, v9, v41
v_mul_f32 v10, v10, v42
v_mul_f32 v11, v11, v43
s_branch K2_RESC_c
K2_RARE_0ss:
s_nop 7
s_nop 7
s_add_u32 s36, s28, 0
s_add_u32 s37, s36, 4096
buffer_load_dwordx4 v[144:147], v1, s[8:11], s36 offen offset:0 sc1
buffer_load_dwordx4 v[148:151], v1, s[8:11], s36 offen offset:2048 sc1
buffer_load_dwordx4 v[152:155], v1, s[8:11], s37 offen offset:0 sc1
buffer_load_dwordx4 v[156:159], v1, s[8:11], s37 offen offset:2048 sc1
buffer_load_dwordx4 v[160:163], v1, s[8:11], s36 offen offset:1024 sc1
buffer_load_dwordx4 v[164:167], v1, s[8:11], s36 offen offset:3072 sc1
buffer_load_dwordx4 v[168:171], v1, s[8:11], s37 offen offset:1024 sc1
buffer_load_dwordx4 v[172:175], v1, s[8:11], s37 offen offset:3072 sc1
s_waitcnt vmcnt(0)
v_mfma_f32_16x16x32_bf16 v[48:51], v[144:147], v[208:211], v[28:31]
v_mfma_f32_16x16x32_bf16 v[48:51], v[148:151], v[212:215], v[48:51]
v_mfma_f32_16x16x32_bf16 v[48:51], v[152:155], v[216:219], v[48:51]
v_mfma_f32_16x16x32_bf16 v[48:51], v[156:159], v[220:223], v[48:51]
v_mfma_f32_16x16x32_bf16 v[52:55], v[144:147], v[224:227], v[32:35]
v_mfma_f32_16x16x32_bf16 v[52:55], v[148:151], v[228:231], v[52:55]
v_mfma_f32_16x16x32_bf16 v[52:55], v[152:155], v[232:235], v[52:55]
v_mfma_f32_16x16x32_bf16 v[52:55], v[156:159], v[236:239], v[52:55]
v_mfma_f32_16x16x32_bf16 v[56:59], v[160:163], v[208:211], v[28:31]
v_mfma_f32_16x16x32_bf16 v[56:59], v[164:167], v[212:215], v[56:59]
v_mfma_f32_16x16x32_bf16 v[56:59], v[168:171], v[216:219], v[56:59]
v_mfma_f32_16x16x32_bf16 v[56:59], v[172:175], v[220:223], v[56:59]
v_mfma_f32_16x16x32_bf16 v[60:63], v[160:163], v[224:227], v[32:35]
v_mfma_f32_16x16x32_bf16 v[60:63], v[164:167], v[228:231], v[60:63]
v_mfma_f32_16x16x32_bf16 v[60:63], v[168:171], v[232:235], v[60:63]
v_mfma_f32_16x16x32_bf16 v[60:63], v[172:175], v[236:239], v[60:63]
s_nop 7
s_add_u32 s36, s28, 8192
s_add_u32 s37, s36, 4096
buffer_load_dwordx4 v[144:147], v1, s[8:11], s36 offen offset:0 sc1
buffer_load_dwordx4 v[148:151], v1, s[8:11], s36 offen offset:2048 sc1
buffer_load_dwordx4 v[152:155], v1, s[8:11], s37 offen offset:0 sc1
buffer_load_dwordx4 v[156:159], v1, s[8:11], s37 offen offset:2048 sc1
buffer_load_dwordx4 v[160:163], v1, s[8:11], s36 offen offset:1024 sc1
buffer_load_dwordx4 v[164:167], v1, s[8:11], s36 offen offset:3072 sc1
buffer_load_dwordx4 v[168:171], v1, s[8:11], s37 offen offset:1024 sc1
buffer_load_dwordx4 v[172:175], v1, s[8:11], s37 offen offset:3072 sc1
s_waitcnt vmcnt(0)
v_mfma_f32_16x16x32_bf16 v[64:67], v[144:147], v[208:211], v[28:31]
v_mfma_f32_16x16x32_bf16 v[64:67], v[148:151], v[212:215], v[64:67]
v_mfma_f32_16x16x32_bf16 v[64:67], v[152:155], v[216:219], v[64:67]
v_mfma_f32_16x16x32_bf16 v[64:67], v[156:159], v[220:223], v[64:67]
v_mfma_f32_16x16x32_bf16 v[68:71], v[144:147], v[224:227], v[32:35]
v_mfma_f32_16x16x32_bf16 v[68:71], v[148:151], v[228:231], v[68:71]
v_mfma_f32_16x16x32_bf16 v[68:71], v[152:155], v[232:235], v[68:71]
v_mfma_f32_16x16x32_bf16 v[68:71], v[156:159], v[236:239], v[68:71]
v_mfma_f32_16x16x32_bf16 v[72:75], v[160:163], v[208:211], v[28:31]
v_mfma_f32_16x16x32_bf16 v[72:75], v[164:167], v[212:215], v[72:75]
v_mfma_f32_16x16x32_bf16 v[72:75], v[168:171], v[216:219], v[72:75]
v_mfma_f32_16x16x32_bf16 v[72:75], v[172:175], v[220:223], v[72:75]
v_mfma_f32_16x16x32_bf16 v[76:79], v[160:163], v[224:227], v[32:35]
v_mfma_f32_16x16x32_bf16 v[76:79], v[164:167], v[228:231], v[76:79]
v_mfma_f32_16x16x32_bf16 v[76:79], v[168:171], v[232:235], v[76:79]
v_mfma_f32_16x16x32_bf16 v[76:79], v[172:175], v[236:239], v[76:79]
s_nop 7
s_call_b64 s[78:79], K2_MASK_0s
v_max_f32 v38, v48, v49
v_max_f32 v39, v52, v53
v_max3_f32 v38, v38, v50, v51
v_max3_f32 v39, v39, v54, v55
v_max3_f32 v38, v38, v56, v57
v_max3_f32 v39, v39, v60, v61
v_max3_f32 v38, v38, v58, v59
v_max3_f32 v39, v39, v62, v63
v_max3_f32 v38, v38, v64, v65
v_max3_f32 v39, v39, v68, v69
v_max3_f32 v38, v38, v66, v67
v_max3_f32 v39, v39, v70, v71
v_max3_f32 v38, v38, v72, v73
v_max3_f32 v39, v39, v76, v77
v_max3_f32 v38, v38, v74, v75
v_max3_f32 v39, v39, v78, v79
v_mov_b32 v42, v38
v_mov_b32 v43, v39
s_nop 0
v_permlane32_swap_b32 v38, v42
v_permlane32_swap_b32 v39, v43
v_max_f32 v38, v38, v42
v_max_f32 v39, v39, v43
v_mov_b32 v42, v38
v_mov_b32 v43, v39
s_nop 0
v_permlane16_swap_b32 v38, v42
v_permlane16_swap_b32 v39, v43
v_max_f32 v38, v38, v42
v_max_f32 v39, v39, v43
v_ceil_f32 v38, v38
v_ceil_f32 v39, v39
v_max_f32 v38, 0, v38
v_max_f32 v39, 0, v39
v_mov_b32 v36, 0
v_mov_b32 v37, 0
v_sub_f32 v48, v48, v38
v_sub_f32 v49, v49, v38
v_sub_f32 v50, v50, v38
v_sub_f32 v51, v51, v38
v_sub_f32 v52, v52, v39
v_sub_f32 v53, v53, v39
v_sub_f32 v54, v54, v39
v_sub_f32 v55, v55, v39
v_sub_f32 v56, v56, v38
v_sub_f32 v57, v57, v38
v_sub_f32 v58, v58, v38
v_sub_f32 v59, v59, v38
v_sub_f32 v60, v60, v39
v_sub_f32 v61, v61, v39
v_sub_f32 v62, v62, v39
v_sub_f32 v63, v63, v39
v_sub_f32 v64, v64, v38
v_sub_f32 v65, v65, v38
v_sub_f32 v66, v66, v38
v_sub_f32 v67, v67, v38
v_sub_f32 v68, v68, v39
v_sub_f32 v69, v69, v39
v_sub_f32 v70, v70, v39
v_sub_f32 v71, v71, v39
v_sub_f32 v72, v72, v38
v_sub_f32 v73, v73, v38
v_sub_f32 v74, v74, v38
v_sub_f32 v75, v75, v38
v_sub_f32 v76, v76, v39
v_sub_f32 v77, v77, v39
v_sub_f32 v78, v78, v39
v_sub_f32 v79, v79, v39
v_sub_f32 v80, v80, v38
v_sub_f32 v81, v81, v38
v_sub_f32 v82, v82, v38
v_sub_f32 v83, v83, v38
v_sub_f32 v84, v84, v39
v_sub_f32 v85, v85, v39
v_sub_f32 v86, v86, v39
v_sub_f32 v87, v87, v39
v_sub_f32 v88, v88, v38
v_sub_f32 v89, v89, v38
v_sub_f32 v90, v90, v38
v_sub_f32 v91, v91, v38
v_sub_f32 v92, v92, v39
v_sub_f32 v93, v93, v39
v_sub_f32 v94, v94, v39
v_sub_f32 v95, v95, v39
v_sub_f32 v96, v96, v38
v_sub_f32 v97, v97, v38
v_sub_f32 v98, v98, v38
v_sub_f32 v99, v99, v38
v_sub_f32 v100, v100, v39
v_sub_f32 v101, v101, v39
v_sub_f32 v102, v102, v39
v_sub_f32 v103, v103, v39
v_sub_f32 v104, v104, v38
v_sub_f32 v105, v105, v38
v_sub_f32 v106, v106, v38
v_sub_f32 v107, v107, v38
v_sub_f32 v108, v108, v39
v_sub_f32 v109, v109, v39
v_sub_f32 v110, v110, v39
v_sub_f32 v111, v111, v39
v_sub_f32 v20, v20, v36
v_sub_f32 v21, v21, v36
v_sub_f32 v22, v22, v36
v_sub_f32 v23, v23, v36
v_exp_f32 v40, -v36
v_sub_f32 v24, v24, v37
v_sub_f32 v25, v25, v37
v_sub_f32 v26, v26, v37
v_sub_f32 v27, v27, v37
v_exp_f32 v41, -v37
v_sub_f32 v28, v28, v38
v_sub_f32 v29, v29, v38
v_sub_f32 v30, v30, v38
v_sub_f32 v31, v31, v38
v_exp_f32 v42, -v38
v_sub_f32 v32, v32, v39
v_sub_f32 v33, v33, v39
v_sub_f32 v34, v34, v39
v_sub_f32 v35, v35, v39
v_exp_f32 v43, -v39
v_exp_f32 v48, v48
v_exp_f32 v49, v49
v_exp_f32 v50, v50
v_exp_f32 v51, v51
v_exp_f32 v52, v52
v_add_f32 v14, v48, v49
v_cvt_pk_bf16_f32 v112, v48, v49
v_exp_f32 v53, v53
v_add_f32 v14, v14, v50
v_add_f32 v14, v14, v51
v_exp_f32 v54, v54
v_cvt_pk_bf16_f32 v113, v50, v51
v_exp_f32 v55, v55
v_exp_f32 v56, v56
v_add_f32 v15, v52, v53
v_cvt_pk_bf16_f32 v116, v52, v53
v_exp_f32 v57, v57
v_add_f32 v15, v15, v54
v_add_f32 v15, v15, v55
v_exp_f32 v58, v58
v_cvt_pk_bf16_f32 v117, v54, v55
v_exp_f32 v59, v59
v_exp_f32 v60, v60
v_add_f32 v14, v14, v56
v_add_f32 v14, v14, v57
v_exp_f32 v61, v61
v_cvt_pk_bf16_f32 v114, v56, v57
v_add_f32 v14, v14, v58
v_exp_f32 v62, v62
v_add_f32 v14, v14, v59
v_cvt_pk_bf16_f32 v115, v58, v59
v_exp_f32 v63, v63
v_exp_f32 v64, v64
v_add_f32 v15, v15, v60
v_add_f32 v15, v15, v61
v_exp_f32 v65, v65
v_cvt_pk_bf16_f32 v118, v60, v61
v_add_f32 v15, v15, v62
v_exp_f32 v66, v66
v_add_f32 v15, v15, v63
v_cvt_pk_bf16_f32 v119, v62, v63
v_exp_f32 v67, v67
v_exp_f32 v68, v68
v_add_f32 v14, v14, v64
v_add_f32 v14, v14, v65
v_exp_f32 v69, v69
v_cvt_pk_bf16_f32 v120, v64, v65
v_add_f32 v14, v14, v66
v_exp_f32 v70, v70
v_add_f32 v14, v14, v67
v_cvt_pk_bf16_f32 v121, v66, v67
v_exp_f32 v71, v71
v_exp_f32 v72, v72
v_add_f32 v15, v15, v68
v_add_f32 v15, v15, v69
v_exp_f32 v73, v73
v_cvt_pk_bf16_f32 v124, v68, v69
v_add_f32 v15, v15, v70
v_exp_f32 v74, v74
v_add_f32 v15, v15, v71
v_cvt_pk_bf16_f32 v125, v70, v71
v_exp_f32 v75, v75
v_exp_f32 v76, v76
v_add_f32 v14, v14, v72
v_add_f32 v14, v14, v73
v_exp_f32 v77, v77
v_cvt_pk_bf16_f32 v122, v72, v73
v_add_f32 v14, v14, v74
v_exp_f32 v78, v78
v_add_f32 v14, v14, v75
v_cvt_pk_bf16_f32 v123, v74, v75
v_exp_f32 v79, v79
s_nop 0
v_add_f32 v15, v15, v76
v_add_f32 v15, v15, v77
v_cvt_pk_bf16_f32 v126, v76, v77
v_add_f32 v15, v15, v78
v_add_f32 v15, v15, v79
v_cvt_pk_bf16_f32 v127, v78, v79
v_mul_f32 v8, v8, v40
v_mul_f32 v9, v9, v41
v_mul_f32 v10, v10, v42
v_mul_f32 v11, v11, v43
s_branch K2_RESC_s
K2_RARE_1cc:
s_nop 7
s_nop 7
s_add_u32 s36, s28, 0
s_add_u32 s37, s36, 4096
buffer_load_dwordx4 v[144:147], v1, s[8:11], s36 offen offset:0 sc1
buffer_load_dwordx4 v[148:151], v1, s[8:11], s36 offen offset:2048 sc1
buffer_load_dwordx4 v[152:155], v1, s[8:11], s37 offen offset:0 sc1
buffer_load_dwordx4 v[156:159], v1, s[8:11], s37 offen offset:2048 sc1
buffer_load_dwordx4 v[160:163], v1, s[8:11], s36 offen offset:1024 sc1
buffer_load_dwordx4 v[164:167], v1, s[8:11], s36 offen offset:3072 sc1
buffer_load_dwordx4 v[168:171], v1, s[8:11], s37 offen offset:1024 sc1
buffer_load_dwordx4 v[172:175], v1, s[8:11], s37 offen offset:3072 sc1
s_waitcnt vmcnt(0)
v_mfma_f32_16x16x32_bf16 v[80:83], v[144:147], v[176:179], v[20:23]
v_mfma_f32_16x16x32_bf16 v[80:83], v[148:151], v[180:183], v[80:83]
v_mfma_f32_16x16x32_bf16 v[80:83], v[152:155], v[184:187], v[80:83]
v_mfma_f32_16x16x32_bf16 v[80:83], v[156:159], v[188:191], v[80:83]
v_mfma_f32_16x16x32_bf16 v[84:87], v[144:147], v[192:195], v[24:27]
v_mfma_f32_16x16x32_bf16 v[84:87], v[148:151], v[196:199], v[84:87]
v_mfma_f32_16x16x32_bf16 v[84:87], v[152:155], v[200:203], v[84:87]
v_mfma_f32_16x16x32_bf16 v[84:87], v[156:159], v[204:207], v[84:87]
v_mfma_f32_16x16x32_bf16 v[88:91], v[144:147], v[208:211], v[28:31]
v_mfma_f32_16x16x32_bf16 v[88:91], v[148:151], v[212:215], v[88:91]
v_mfma_f32_16x16x32_bf16 v[88:91], v[152:155], v[216:219], v[88:91]
v_mfma_f32_16x16x32_bf16 v[88:91], v[156:159], v[220:223], v[88:91]
v_mfma_f32_16x16x32_bf16 v[92:95], v[144:147], v[224:227], v[32:35]
v_mfma_f32_16x16x32_bf16 v[92:95], v[148:151], v[228:231], v[92:95]
v_mfma_f32_16x16x32_bf16 v[92:95], v[152:155], v[232:235], v[92:95]
v_mfma_f32_16x16x32_bf16 v[92:95], v[156:159], v[236:239], v[92:95]
v_mfma_f32_16x16x32_bf16 v[96:99], v[160:163], v[176:179], v[20:23]
v_mfma_f32_16x16x32_bf16 v[96:99], v[164:167], v[180:183], v[96:99]
v_mfma_f32_16x16x32_bf16 v[96:99], v[168:171], v[184:187], v[96:99]
v_mfma_f32_16x16x32_bf16 v[96:99], v[172:175], v[188:191], v[96:99]
v_mfma_f32_16x16x32_bf16 v[100:103], v[160:163], v[192:195], v[24:27]
v_mfma_f32_16x16x32_bf16 v[100:103], v[164:167], v[196:199], v[100:103]
v_mfma_f32_16x16x32_bf16 v[100:103], v[168:171], v[200:203], v[100:103]
v_mfma_f32_16x16x32_bf16 v[100:103], v[172:175], v[204:207], v[100:103]
v_mfma_f32_16x16x32_bf16 v[104:107], v[160:163], v[208:211], v[28:31]
v_mfma_f32_16x16x32_bf16 v[104:107], v[164:167], v[212:215], v[104:107]
v_mfma_f32_16x16x32_bf16 v[104:107], v[168:171], v[216:219], v[104:107]
v_mfma_f32_16x16x32_bf16 v[104:107], v[172:175], v[220:223], v[104:107]
v_mfma_f32_16x16x32_bf16 v[108:111], v[160:163], v[224:227], v[32:35]
v_mfma_f32_16x16x32_bf16 v[108:111], v[164:167], v[228:231], v[108:111]
v_mfma_f32_16x16x32_bf16 v[108:111], v[168:171], v[232:235], v[108:111]
v_mfma_f32_16x16x32_bf16 v[108:111], v[172:175], v[236:239], v[108:111]
s_nop 7
s_call_b64 s[78:79], K2_MASK_1c
v_max_f32 v36, v80, v81
v_max_f32 v37, v84, v85
v_max_f32 v38, v88, v89
v_max_f32 v39, v92, v93
v_max3_f32 v36, v36, v82, v83
v_max3_f32 v37, v37, v86, v87
v_max3_f32 v38, v38, v90, v91
v_max3_f32 v39, v39, v94, v95
v_max3_f32 v36, v36, v96, v97
v_max3_f32 v37, v37, v100, v101
v_max3_f32 v38, v38, v104, v105
v_max3_f32 v39, v39, v108, v109
v_max3_f32 v36, v36, v98, v99
v_max3_f32 v37, v37, v102, v103
v_max3_f32 v38, v38, v106, v107
v_max3_f32 v39, v39, v110, v111
v_mov_b32 v40, v36
v_mov_b32 v41, v37
v_mov_b32 v42, v38
v_mov_b32 v43, v39
v_permlane32_swap_b32 v36, v40
v_permlane32_swap_b32 v37, v41
v_permlane32_swap_b32 v38, v42
v_permlane32_swap_b32 v39, v43
v_max_f32 v36, v36, v40
v_max_f32 v37, v37, v41
v_max_f32 v38, v38, v42
v_max_f32 v39, v39, v43
v_mov_b32 v40, v36
v_mov_b32 v41, v37
v_mov_b32 v42, v38
v_mov_b32 v43, v39
v_permlane16_swap_b32 v36, v40
v_permlane16_swap_b32 v37, v41
v_permlane16_swap_b32 v38, v42
v_permlane16_swap_b32 v39, v43
v_max_f32 v36, v36, v40
v_max_f32 v37, v37, v41
v_max_f32 v38, v38, v42
v_max_f32 v39, v39, v43
v_ceil_f32 v36, v36
v_ceil_f32 v37, v37
v_ceil_f32 v38, v38
v_ceil_f32 v39, v39
v_max_f32 v36, 0, v36
v_max_f32 v37, 0, v37
v_max_f32 v38, 0, v38
v_max_f32 v39, 0, v39
v_sub_f32 v80, v80, v36
v_sub_f32 v81, v81, v36
v_sub_f32 v82, v82, v36
v_sub_f32 v83, v83, v36
v_sub_f32 v84, v84, v37
v_sub_f32 v85, v85, v37
v_sub_f32 v86, v86, v37
v_sub_f32 v87, v87, v37
v_sub_f32 v88, v88, v38
v_sub_f32 v89, v89, v38
v_sub_f32 v90, v90, v38
v_sub_f32 v91, v91, v38
v_sub_f32 v92, v92, v39
v_sub_f32 v93, v93, v39
v_sub_f32 v94, v94, v39
v_sub_f32 v95, v95, v39
v_sub_f32 v96, v96, v36
v_sub_f32 v97, v97, v36
v_sub_f32 v98, v98, v36
v_sub_f32 v99, v99, v36
v_sub_f32 v100, v100, v37
v_sub_f32 v101, v101, v37
v_sub_f32 v102, v102, v37
v_sub_f32 v103, v103, v37
v_sub_f32 v104, v104, v38
v_sub_f32 v105, v105, v38
v_sub_f32 v106, v106, v38
v_sub_f32 v107, v107, v38
v_sub_f32 v108, v108, v39
v_sub_f32 v109, v109, v39
v_sub_f32 v110, v110, v39
v_sub_f32 v111, v111, v39
v_sub_f32 v48, v48, v36
v_sub_f32 v49, v49, v36
v_sub_f32 v50, v50, v36
v_sub_f32 v51, v51, v36
v_sub_f32 v52, v52, v37
v_sub_f32 v53, v53, v37
v_sub_f32 v54, v54, v37
v_sub_f32 v55, v55, v37
v_sub_f32 v56, v56, v38
v_sub_f32 v57, v57, v38
v_sub_f32 v58, v58, v38
v_sub_f32 v59, v59, v38
v_sub_f32 v60, v60, v39
v_sub_f32 v61, v61, v39
v_sub_f32 v62, v62, v39
v_sub_f32 v63, v63, v39
v_sub_f32 v64, v64, v36
v_sub_f32 v65, v65, v36
v_sub_f32 v66, v66, v36
v_sub_f32 v67, v67, v36
v_sub_f32 v68, v68, v37
v_sub_f32 v69, v69, v37
v_sub_f32 v70, v70, v37
v_sub_f32 v71, v71, v37
v_sub_f32 v72, v72, v38
v_sub_f32 v73, v73, v38
v_sub_f32 v74, v74, v38
v_sub_f32 v75, v75, v38
v_sub_f32 v76, v76, v39
v_sub_f32 v77, v77, v39
v_sub_f32 v78, v78, v39
v_sub_f32 v79, v79, v39
v_sub_f32 v20, v20, v36
v_sub_f32 v21, v21, v36
v_sub_f32 v22, v22, v36
v_sub_f32 v23, v23, v36
v_exp_f32 v40, -v36
v_sub_f32 v24, v24, v37
v_sub_f32 v25, v25, v37
v_sub_f32 v26, v26, v37
v_sub_f32 v27, v27, v37
v_exp_f32 v41, -v37
v_sub_f32 v28, v28, v38
v_sub_f32 v29, v29, v38
v_sub_f32 v30, v30, v38
v_sub_f32 v31, v31, v38
v_exp_f32 v42, -v38
v_sub_f32 v32, v32, v39
v_sub_f32 v33, v33, v39
v_sub_f32 v34, v34, v39
v_sub_f32 v35, v35, v39
v_exp_f32 v43, -v39
v_exp_f32 v80, v80
v_exp_f32 v81, v81
v_exp_f32 v82, v82
v_exp_f32 v83, v83
v_exp_f32 v84, v84
v_add_f32 v12, v80, v81
v_cvt_pk_bf16_f32 v128, v80, v81
v_exp_f32 v85, v85
v_add_f32 v12, v12, v82
v_add_f32 v12, v12, v83
v_exp_f32 v86, v86
v_cvt_pk_bf16_f32 v129, v82, v83
v_exp_f32 v87, v87
v_exp_f32 v88, v88
v_add_f32 v13, v84, v85
v_cvt_pk_bf16_f32 v132, v84, v85
v_exp_f32 v89, v89
v_add_f32 v13, v13, v86
v_add_f32 v13, v13, v87
v_exp_f32 v90, v90
v_cvt_pk_bf16_f32 v133, v86, v87
v_exp_f32 v91, v91
v_exp_f32 v92, v92
v_add_f32 v14, v88, v89
v_cvt_pk_bf16_f32 v136, v88, v89
v_exp_f32 v93, v93
v_add_f32 v14, v14, v90
v_add_f32 v14, v14, v91
v_exp_f32 v94, v94
v_cvt_pk_bf16_f32 v137, v90, v91
v_exp_f32 v95, v95
v_exp_f32 v96, v96
v_add_f32 v15, v92, v93
v_cvt_pk_bf16_f32 v140, v92, v93
v_exp_f32 v97, v97
v_add_f32 v15, v15, v94
v_add_f32 v15, v15, v95
v_exp_f32 v98, v98
v_cvt_pk_bf16_f32 v141, v94, v95
v_exp_f32 v99, v99
v_exp_f32 v100, v100
v_add_f32 v12, v12, v96
v_add_f32 v12, v12, v97
v_exp_f32 v101, v101
v_cvt_pk_bf16_f32 v130, v96, v97
v_add_f32 v12, v12, v98
v_exp_f32 v102, v102
v_add_f32 v12, v12, v99
v_cvt_pk_bf16_f32 v131, v98, v99
v_exp_f32 v103, v103
v_exp_f32 v104, v104
v_add_f32 v13, v13, v100
v_add_f32 v13, v13, v101
v_exp_f32 v105, v105
v_cvt_pk_bf16_f32 v134, v100, v101
v_add_f32 v13, v13, v102
v_exp_f32 v106, v106
v_add_f32 v13, v13, v103
v_cvt_pk_bf16_f32 v135, v102, v103
v_exp_f32 v107, v107
v_exp_f32 v108, v108
v_add_f32 v14, v14, v104
v_add_f32 v14, v14, v105
v_exp_f32 v109, v109
v_cvt_pk_bf16_f32 v138, v104, v105
v_add_f32 v14, v14, v106
v_exp_f32 v110, v110
v_add_f32 v14, v14, v107
v_cvt_pk_bf16_f32 v139, v106, v107
v_exp_f32 v111, v111
s_nop 0
v_add_f32 v15, v15, v108
v_add_f32 v15, v15, v109
v_cvt_pk_bf16_f32 v142, v108, v109
v_add_f32 v15, v15, v110
v_add_f32 v15, v15, v111
v_cvt_pk_bf16_f32 v143, v110, v111
v_mul_f32 v8, v8, v40
v_mul_f32 v9, v9, v41
v_mul_f32 v10, v10, v42
v_mul_f32 v11, v11, v43
s_branch K2_RESC_c
K2_RARE_1cs:
s_nop 7
s_nop 7
s_add_u32 s36, s28, 0
s_add_u32 s37, s36, 4096
buffer_load_dwordx4 v[144:147], v1, s[8:11], s36 offen offset:0 sc1
buffer_load_dwordx4 v[148:151], v1, s[8:11], s36 offen offset:2048 sc1
buffer_load_dwordx4 v[152:155], v1, s[8:11], s37 offen offset:0 sc1
buffer_load_dwordx4 v[156:159], v1, s[8:11], s37 offen offset:2048 sc1
buffer_load_dwordx4 v[160:163], v1, s[8:11], s36 offen offset:1024 sc1
buffer_load_dwordx4 v[164:167], v1, s[8:11], s36 offen offset:3072 sc1
buffer_load_dwordx4 v[168:171], v1, s[8:11], s37 offen offset:1024 sc1
buffer_load_dwordx4 v[172:175], v1, s[8:11], s37 offen offset:3072 sc1
s_waitcnt vmcnt(0)
v_mfma_f32_16x16x32_bf16 v[80:83], v[144:147], v[176:179], v[20:23]
v_mfma_f32_16x16x32_bf16 v[80:83], v[148:151], v[180:183], v[80:83]
v_mfma_f32_16x16x32_bf16 v[80:83], v[152:155], v[184:187], v[80:83]
v_mfma_f32_16x16x32_bf16 v[80:83], v[156:159], v[188:191], v[80:83]
v_mfma_f32_16x16x32_bf16 v[84:87], v[144:147], v[192:195], v[24:27]
v_mfma_f32_16x16x32_bf16 v[84:87], v[148:151], v[196:199], v[84:87]
v_mfma_f32_16x16x32_bf16 v[84:87], v[152:155], v[200:203], v[84:87]
v_mfma_f32_16x16x32_bf16 v[84:87], v[156:159], v[204:207], v[84:87]
v_mfma_f32_16x16x32_bf16 v[88:91], v[144:147], v[208:211], v[28:31]
v_mfma_f32_16x16x32_bf16 v[88:91], v[148:151], v[212:215], v[88:91]
v_mfma_f32_16x16x32_bf16 v[88:91], v[152:155], v[216:219], v[88:91]
v_mfma_f32_16x16x32_bf16 v[88:91], v[156:159], v[220:223], v[88:91]
v_mfma_f32_16x16x32_bf16 v[92:95], v[144:147], v[224:227], v[32:35]
v_mfma_f32_16x16x32_bf16 v[92:95], v[148:151], v[228:231], v[92:95]
v_mfma_f32_16x16x32_bf16 v[92:95], v[152:155], v[232:235], v[92:95]
v_mfma_f32_16x16x32_bf16 v[92:95], v[156:159], v[236:239], v[92:95]
v_mfma_f32_16x16x32_bf16 v[96:99], v[160:163], v[176:179], v[20:23]
v_mfma_f32_16x16x32_bf16 v[96:99], v[164:167], v[180:183], v[96:99]
v_mfma_f32_16x16x32_bf16 v[96:99], v[168:171], v[184:187], v[96:99]
v_mfma_f32_16x16x32_bf16 v[96:99], v[172:175], v[188:191], v[96:99]
v_mfma_f32_16x16x32_bf16 v[100:103], v[160:163], v[192:195], v[24:27]
v_mfma_f32_16x16x32_bf16 v[100:103], v[164:167], v[196:199], v[100:103]
v_mfma_f32_16x16x32_bf16 v[100:103], v[168:171], v[200:203], v[100:103]
v_mfma_f32_16x16x32_bf16 v[100:103], v[172:175], v[204:207], v[100:103]
v_mfma_f32_16x16x32_bf16 v[104:107], v[160:163], v[208:211], v[28:31]
v_mfma_f32_16x16x32_bf16 v[104:107], v[164:167], v[212:215], v[104:107]
v_mfma_f32_16x16x32_bf16 v[104:107], v[168:171], v[216:219], v[104:107]
v_mfma_f32_16x16x32_bf16 v[104:107], v[172:175], v[220:223], v[104:107]
v_mfma_f32_16x16x32_bf16 v[108:111], v[160:163], v[224:227], v[32:35]
v_mfma_f32_16x16x32_bf16 v[108:111], v[164:167], v[228:231], v[108:111]
v_mfma_f32_16x16x32_bf16 v[108:111], v[168:171], v[232:235], v[108:111]
v_mfma_f32_16x16x32_bf16 v[108:111], v[172:175], v[236:239], v[108:111]
s_nop 7
s_call_b64 s[78:79], K2_MASK_1c
v_max_f32 v36, v80, v81
v_max_f32 v37, v84, v85
v_max_f32 v38, v88, v89
v_max_f32 v39, v92, v93
v_max3_f32 v36, v36, v82, v83
v_max3_f32 v37, v37, v86, v87
v_max3_f32 v38, v38, v90, v91
v_max3_f32 v39, v39, v94, v95
v_max3_f32 v36, v36, v96, v97
v_max3_f32 v37, v37, v100, v101
v_max3_f32 v38, v38, v104, v105
v_max3_f32 v39, v39, v108, v109
v_max3_f32 v36, v36, v98, v99
v_max3_f32 v37, v37, v102, v103
v_max3_f32 v38, v38, v106, v107
v_max3_f32 v39, v39, v110, v111
v_mov_b32 v40, v36
v_mov_b32 v41, v37
v_mov_b32 v42, v38
v_mov_b32 v43, v39
v_permlane32_swap_b32 v36, v40
v_permlane32_swap_b32 v37, v41
v_permlane32_swap_b32 v38, v42
v_permlane32_swap_b32 v39, v43
v_max_f32 v36, v36, v40
v_max_f32 v37, v37, v41
v_max_f32 v38, v38, v42
v_max_f32 v39, v39, v43
v_mov_b32 v40, v36
v_mov_b32 v41, v37
v_mov_b32 v42, v38
v_mov_b32 v43, v39
v_permlane16_swap_b32 v36, v40
v_permlane16_swap_b32 v37, v41
v_permlane16_swap_b32 v38, v42
v_permlane16_swap_b32 v39, v43
v_max_f32 v36, v36, v40
v_max_f32 v37, v37, v41
v_max_f32 v38, v38, v42
v_max_f32 v39, v39, v43
v_ceil_f32 v36, v36
v_ceil_f32 v37, v37
v_ceil_f32 v38, v38
v_ceil_f32 v39, v39
v_max_f32 v36, 0, v36
v_max_f32 v37, 0, v37
v_max_f32 v38, 0, v38
v_max_f32 v39, 0, v39
v_sub_f32 v80, v80, v36
v_sub_f32 v81, v81, v36
v_sub_f32 v82, v82, v36
v_sub_f32 v83, v83, v36
v_sub_f32 v84, v84, v37
v_sub_f32 v85, v85, v37
v_sub_f32 v86, v86, v37
v_sub_f32 v87, v87, v37
v_sub_f32 v88, v88, v38
v_sub_f32 v89, v89, v38
v_sub_f32 v90, v90, v38
v_sub_f32 v91, v91, v38
v_sub_f32 v92, v92, v39
v_sub_f32 v93, v93, v39
v_sub_f32 v94, v94, v39
v_sub_f32 v95, v95, v39
v_sub_f32 v96, v96, v36
v_sub_f32 v97, v97, v36
v_sub_f32 v98, v98, v36
v_sub_f32 v99, v99, v36
v_sub_f32 v100, v100, v37
v_sub_f32 v101, v101, v37
v_sub_f32 v102, v102, v37
v_sub_f32 v103, v103, v37
v_sub_f32 v104, v104, v38
v_sub_f32 v105, v105, v38
v_sub_f32 v106, v106, v38
v_sub_f32 v107, v107, v38
v_sub_f32 v108, v108, v39
v_sub_f32 v109, v109, v39
v_sub_f32 v110, v110, v39
v_sub_f32 v111, v111, v39
v_sub_f32 v48, v48, v38
v_sub_f32 v49, v49, v38
v_sub_f32 v50, v50, v38
v_sub_f32 v51, v51, v38
v_sub_f32 v52, v52, v39
v_sub_f32 v53, v53, v39
v_sub_f32 v54, v54, v39
v_sub_f32 v55, v55, v39
v_sub_f32 v56, v56, v38
v_sub_f32 v57, v57, v38
v_sub_f32 v58, v58, v38
v_sub_f32 v59, v59, v38
v_sub_f32 v60, v60, v39
v_sub_f32 v61, v61, v39
v_sub_f32 v62, v62, v39
v_sub_f32 v63, v63, v39
v_sub_f32 v64, v64, v38
v_sub_f32 v65, v65, v38
v_sub_f32 v66, v66, v38
v_sub_f32 v67, v67, v38
v_sub_f32 v68, v68, v39
v_sub_f32 v69, v69, v39
v_sub_f32 v70, v70, v39
v_sub_f32 v71, v71, v39
v_sub_f32 v72, v72, v38
v_sub_f32 v73, v73, v38
v_sub_f32 v74, v74, v38
v_sub_f32 v75, v75, v38
v_sub_f32 v76, v76, v39
v_sub_f32 v77, v77, v39
v_sub_f32 v78, v78, v39
v_sub_f32 v79, v79, v39
v_sub_f32 v20, v20, v36
v_sub_f32 v21, v21, v36
v_sub_f32 v22, v22, v36
v_sub_f32 v23, v23, v36
v_exp_f32 v40, -v36
v_sub_f32 v24, v24, v37
v_sub_f32 v25, v25, v37
v_sub_f32 v26, v26, v37
v_sub_f32 v27, v27, v37
v_exp_f32 v41, -v37
v_sub_f32 v28, v28, v38
v_sub_f32 v29, v29, v38
v_sub_f32 v30, v30, v38
v_sub_f32 v31, v31, v38
v_exp_f32 v42, -v38
v_sub_f32 v32, v32, v39
v_sub_f32 v33, v33, v39
v_sub_f32 v34, v34, v39
v_sub_f32 v35, v35, v39
v_exp_f32 v43, -v39
v_exp_f32 v80, v80
v_exp_f32 v81, v81
v_exp_f32 v82, v82
v_exp_f32 v83, v83
v_exp_f32 v84, v84
v_add_f32 v12, v80, v81
v_cvt_pk_bf16_f32 v128, v80, v81
v_exp_f32 v85, v85
v_add_f32 v12, v12, v82
v_add_f32 v12, v12, v83
v_exp_f32 v86, v86
v_cvt_pk_bf16_f32 v129, v82, v83
v_exp_f32 v87, v87
v_exp_f32 v88, v88
v_add_f32 v13, v84, v85
v_cvt_pk_bf16_f32 v132, v84, v85
v_exp_f32 v89, v89
v_add_f32 v13, v13, v86
v_add_f32 v13, v13, v87
v_exp_f32 v90, v90
v_cvt_pk_bf16_f32 v133, v86, v87
v_exp_f32 v91, v91
v_exp_f32 v92, v92
v_add_f32 v14, v88, v89
v_cvt_pk_bf16_f32 v136, v88, v89
v_exp_f32 v93, v93
v_add_f32 v14, v14, v90
v_add_f32 v14, v14, v91
v_exp_f32 v94, v94
v_cvt_pk_bf16_f32 v137, v90, v91
v_exp_f32 v95, v95
v_exp_f32 v96, v96
v_add_f32 v15, v92, v93
v_cvt_pk_bf16_f32 v140, v92, v93
v_exp_f32 v97, v97
v_add_f32 v15, v15, v94
v_add_f32 v15, v15, v95
v_exp_f32 v98, v98
v_cvt_pk_bf16_f32 v141, v94, v95
v_exp_f32 v99, v99
v_exp_f32 v100, v100
v_add_f32 v12, v12, v96
v_add_f32 v12, v12, v97
v_exp_f32 v101, v101
v_cvt_pk_bf16_f32 v130, v96, v97
v_add_f32 v12, v12, v98
v_exp_f32 v102, v102
v_add_f32 v12, v12, v99
v_cvt_pk_bf16_f32 v131, v98, v99
v_exp_f32 v103, v103
v_exp_f32 v104, v104
v_add_f32 v13, v13, v100
v_add_f32 v13, v13, v101
v_exp_f32 v105, v105
v_cvt_pk_bf16_f32 v134, v100, v101
v_add_f32 v13, v13, v102
v_exp_f32 v106, v106
v_add_f32 v13, v13, v103
v_cvt_pk_bf16_f32 v135, v102, v103
v_exp_f32 v107, v107
v_exp_f32 v108, v108
v_add_f32 v14, v14, v104
v_add_f32 v14, v14, v105
v_exp_f32 v109, v109
v_cvt_pk_bf16_f32 v138, v104, v105
v_add_f32 v14, v14, v106
v_exp_f32 v110, v110
v_add_f32 v14, v14, v107
v_cvt_pk_bf16_f32 v139, v106, v107
v_exp_f32 v111, v111
s_nop 0
v_add_f32 v15, v15, v108
v_add_f32 v15, v15, v109
v_cvt_pk_bf16_f32 v142, v108, v109
v_add_f32 v15, v15, v110
v_add_f32 v15, v15, v111
v_cvt_pk_bf16_f32 v143, v110, v111
v_mul_f32 v8, v8, v40
v_mul_f32 v9, v9, v41
v_mul_f32 v10, v10, v42
v_mul_f32 v11, v11, v43
s_branch K2_RESC_c
K2_RARE_1sn:
s_nop 7
s_nop 7
s_add_u32 s36, s28, 0
s_add_u32 s37, s36, 4096
buffer_load_dwordx4 v[144:147], v1, s[8:11], s36 offen offset:0 sc1
buffer_load_dwordx4 v[148:151], v1, s[8:11], s36 offen offset:2048 sc1
buffer_load_dwordx4 v[152:155], v1, s[8:11], s37 offen offset:0 sc1
buffer_load_dwordx4 v[156:159], v1, s[8:11], s37 offen offset:2048 sc1
buffer_load_dwordx4 v[160:163], v1, s[8:11], s36 offen offset:1024 sc1
buffer_load_dwordx4 v[164:167], v1, s[8:11], s36 offen offset:3072 sc1
buffer_load_dwordx4 v[168:171], v1, s[8:11], s37 offen offset:1024 sc1
buffer_load_dwordx4 v[172:175], v1, s[8:11], s37 offen offset:3072 sc1
s_waitcnt vmcnt(0)
v_mfma_f32_16x16x32_bf16 v[80:83], v[144:147], v[208:211], v[28:31]
v_mfma_f32_16x16x32_bf16 v[80:83], v[148:151], v[212:215], v[80:83]
v_mfma_f32_16x16x32_bf16 v[80:83], v[152:155], v[216:219], v[80:83]
v_mfma_f32_16x16x32_bf16 v[80:83], v[156:159], v[220:223], v[80:83]
v_mfma_f32_16x16x32_bf16 v[84:87], v[144:147], v[224:227], v[32:35]
v_mfma_f32_16x16x32_bf16 v[84:87], v[148:151], v[228:231], v[84:87]
v_mfma_f32_16x16x32_bf16 v[84:87], v[152:155], v[232:235], v[84:87]
v_mfma_f32_16x16x32_bf16 v[84:87], v[156:159], v[236:239], v[84:87]
v_mfma_f32_16x16x32_bf16 v[88:91], v[160:163], v[208:211], v[28:31]
v_mfma_f32_16x16x32_bf16 v[88:91], v[164:167], v[212:215], v[88:91]
v_mfma_f32_16x16x32_bf16 v[88:91], v[168:171], v[216:219], v[88:91]
v_mfma_f32_16x16x32_bf16 v[88:91], v[172:175], v[220:223], v[88:91]
v_mfma_f32_16x16x32_bf16 v[92:95], v[160:163], v[224:227], v[32:35]
v_mfma_f32_16x16x32_bf16 v[92:95], v[164:167], v[228:231], v[92:95]
v_mfma_f32_16x16x32_bf16 v[92:95], v[168:171], v[232:235], v[92:95]
v_mfma_f32_16x16x32_bf16 v[92:95], v[172:175], v[236:239], v[92:95]
s_nop 7
s_add_u32 s36, s28, 8192
s_add_u32 s37, s36, 4096
buffer_load_dwordx4 v[144:147], v1, s[8:11], s36 offen offset:0 sc1
buffer_load_dwordx4 v[148:151], v1, s[8:11], s36 offen offset:2048 sc1
buffer_load_dwordx4 v[152:155], v1, s[8:11], s37 offen offset:0 sc1
buffer_load_dwordx4 v[156:159], v1, s[8:11], s37 offen offset:2048 sc1
buffer_load_dwordx4 v[160:163], v1, s[8:11], s36 offen offset:1024 sc1
buffer_load_dwordx4 v[164:167], v1, s[8:11], s36 offen offset:3072 sc1
buffer_load_dwordx4 v[168:171], v1, s[8:11], s37 offen offset:1024 sc1
buffer_load_dwordx4 v[172:175], v1, s[8:11], s37 offen offset:3072 sc1
s_waitcnt vmcnt(0)
v_mfma_f32_16x16x32_bf16 v[96:99], v[144:147], v[208:211], v[28:31]
v_mfma_f32_16x16x32_bf16 v[96:99], v[148:151], v[212:215], v[96:99]
v_mfma_f32_16x16x32_bf16 v[96:99], v[152:155], v[216:219], v[96:99]
v_mfma_f32_16x16x32_bf16 v[96:99], v[156:159], v[220:223], v[96:99]
v_mfma_f32_16x16x32_bf16 v[100:103], v[144:147], v[224:227], v[32:35]
v_mfma_f32_16x16x32_bf16 v[100:103], v[148:151], v[228:231], v[100:103]
v_mfma_f32_16x16x32_bf16 v[100:103], v[152:155], v[232:235], v[100:103]
v_mfma_f32_16x16x32_bf16 v[100:103], v[156:159], v[236:239], v[100:103]
v_mfma_f32_16x16x32_bf16 v[104:107], v[160:163], v[208:211], v[28:31]
v_mfma_f32_16x16x32_bf16 v[104:107], v[164:167], v[212:215], v[104:107]
v_mfma_f32_16x16x32_bf16 v[104:107], v[168:171], v[216:219], v[104:107]
v_mfma_f32_16x16x32_bf16 v[104:107], v[172:175], v[220:223], v[104:107]
v_mfma_f32_16x16x32_bf16 v[108:111], v[160:163], v[224:227], v[32:35]
v_mfma_f32_16x16x32_bf16 v[108:111], v[164:167], v[228:231], v[108:111]
v_mfma_f32_16x16x32_bf16 v[108:111], v[168:171], v[232:235], v[108:111]
v_mfma_f32_16x16x32_bf16 v[108:111], v[172:175], v[236:239], v[108:111]
s_nop 7
s_call_b64 s[78:79], K2_MASK_1s
v_max_f32 v38, v80, v81
v_max_f32 v39, v84, v85
v_max3_f32 v38, v38, v82, v83
v_max3_f32 v39, v39, v86, v87
v_max3_f32 v38, v38, v88, v89
v_max3_f32 v39, v39, v92, v93
v_max3_f32 v38, v38, v90, v91
v_max3_f32 v39, v39, v94, v95
v_max3_f32 v38, v38, v96, v97
v_max3_f32 v39, v39, v100, v101
v_max3_f32 v38, v38, v98, v99
v_max3_f32 v39, v39, v102, v103
v_max3_f32 v38, v38, v104, v105
v_max3_f32 v39, v39, v108, v109
v_max3_f32 v38, v38, v106, v107
v_max3_f32 v39, v39, v110, v111
v_mov_b32 v42, v38
v_mov_b32 v43, v39
s_nop 0
v_permlane32_swap_b32 v38, v42
v_permlane32_swap_b32 v39, v43
v_max_f32 v38, v38, v42
v_max_f32 v39, v39, v43
v_mov_b32 v42, v38
v_mov_b32 v43, v39
s_nop 0
v_permlane16_swap_b32 v38, v42
v_permlane16_swap_b32 v39, v43
v_max_f32 v38, v38, v42
v_max_f32 v39, v39, v43
v_ceil_f32 v38, v38
v_ceil_f32 v39, v39
v_max_f32 v38, 0, v38
v_max_f32 v39, 0, v39
v_mov_b32 v36, 0
v_mov_b32 v37, 0
v_sub_f32 v80, v80, v38
v_sub_f32 v81, v81, v38
v_sub_f32 v82, v82, v38
v_sub_f32 v83, v83, v38
v_sub_f32 v84, v84, v39
v_sub_f32 v85, v85, v39
v_sub_f32 v86, v86, v39
v_sub_f32 v87, v87, v39
v_sub_f32 v88, v88, v38
v_sub_f32 v89, v89, v38
v_sub_f32 v90, v90, v38
v_sub_f32 v91, v91, v38
v_sub_f32 v92, v92, v39
v_sub_f32 v93, v93, v39
v_sub_f32 v94, v94, v39
v_sub_f32 v95, v95, v39
v_sub_f32 v96, v96, v38
v_sub_f32 v97, v97, v38
v_sub_f32 v98, v98, v38
v_sub_f32 v99, v99, v38
v_sub_f32 v100, v100, v39
v_sub_f32 v101, v101, v39
v_sub_f32 v102, v102, v39
v_sub_f32 v103, v103, v39
v_sub_f32 v104, v104, v38
v_sub_f32 v105, v105, v38
v_sub_f32 v106, v106, v38
v_sub_f32 v107, v107, v38
v_sub_f32 v108, v108, v39
v_sub_f32 v109, v109, v39
v_sub_f32 v110, v110, v39
v_sub_f32 v111, v111, v39
v_sub_f32 v20, v20, v36
v_sub_f32 v21, v21, v36
v_sub_f32 v22, v22, v36
v_sub_f32 v23, v23, v36
v_exp_f32 v40, -v36
v_sub_f32 v24, v24, v37
v_sub_f32 v25, v25, v37
v_sub_f32 v26, v26, v37
v_sub_f32 v27, v27, v37
v_exp_f32 v41, -v37
v_sub_f32 v28, v28, v38
v_sub_f32 v29, v29, v38
v_sub_f32 v30, v30, v38
v_sub_f32 v31, v31, v38
v_exp_f32 v42, -v38
v_sub_f32 v32, v32, v39
v_sub_f32 v33, v33, v39
v_sub_f32 v34, v34, v39
v_sub_f32 v35, v35, v39
v_exp_f32 v43, -v39
v_exp_f32 v80, v80
v_exp_f32 v81, v81
v_exp_f32 v82, v82
v_exp_f32 v83, v83
v_exp_f32 v84, v84
v_add_f32 v14, v80, v81
v_cvt_pk_bf16_f32 v128, v80, v81
v_exp_f32 v85, v85
v_add_f32 v14, v14, v82
v_add_f32 v14, v14, v83
v_exp_f32 v86, v86
v_cvt_pk_bf16_f32 v129, v82, v83
v_exp_f32 v87, v87
v_exp_f32 v88, v88
v_add_f32 v15, v84, v85
v_cvt_pk_bf16_f32 v132, v84, v85
v_exp_f32 v89, v89
v_add_f32 v15, v15, v86
v_add_f32 v15, v15, v87
v_exp_f32 v90, v90
v_cvt_pk_bf16_f32 v133, v86, v87
v_exp_f32 v91, v91
v_exp_f32 v92, v92
v_add_f32 v14, v14, v88
v_add_f32 v14, v14, v89
v_exp_f32 v93, v93
v_cvt_pk_bf16_f32 v130, v88, v89
v_add_f32 v14, v14, v90
v_exp_f32 v94, v94
v_add_f32 v14, v14, v91
v_cvt_pk_bf16_f32 v131, v90, v91
v_exp_f32 v95, v95
v_exp_f32 v96, v96
v_add_f32 v15, v15, v92
v_add_f32 v15, v15, v93
v_exp_f32 v97, v97
v_cvt_pk_bf16_f32 v134, v92, v93
v_add_f32 v15, v15, v94
v_exp_f32 v98, v98
v_add_f32 v15, v15, v95
v_cvt_pk_bf16_f32 v135, v94, v95
v_exp_f32 v99, v99
v_exp_f32 v100, v100
v_add_f32 v14, v14, v96
v_add_f32 v14, v14, v97
v_exp_f32 v101, v101
v_cvt_pk_bf16_f32 v136, v96, v97
v_add_f32 v14, v14, v98
v_exp_f32 v102, v102
v_add_f32 v14, v14, v99
v_cvt_pk_bf16_f32 v137, v98, v99
v_exp_f32 v103, v103
v_exp_f32 v104, v104
v_add_f32 v15, v15, v100
v_add_f32 v15, v15, v101
v_exp_f32 v105, v105
v_cvt_pk_bf16_f32 v140, v100, v101
v_add_f32 v15, v15, v102
v_exp_f32 v106, v106
v_add_f32 v15, v15, v103
v_cvt_pk_bf16_f32 v141, v102, v103
v_exp_f32 v107, v107
v_exp_f32 v108, v108
v_add_f32 v14, v14, v104
v_add_f32 v14, v14, v105
v_exp_f32 v109, v109
v_cvt_pk_bf16_f32 v138, v104, v105
v_add_f32 v14, v14, v106
v_exp_f32 v110, v110
v_add_f32 v14, v14, v107
v_cvt_pk_bf16_f32 v139, v106, v107
v_exp_f32 v111, v111
s_nop 0
v_add_f32 v15, v15, v108
v_add_f32 v15, v15, v109
v_cvt_pk_bf16_f32 v142, v108, v109
v_add_f32 v15, v15, v110
v_add_f32 v15, v15, v111
v_cvt_pk_bf16_f32 v143, v110, v111
v_mul_f32 v8, v8, v40
v_mul_f32 v9, v9, v41
v_mul_f32 v10, v10, v42
v_mul_f32 v11, v11, v43
s_branch K2_RESC_s
K2_RARE_1ss:
s_nop 7
s_nop 7
s_add_u32 s36, s28, 0
s_add_u32 s37, s36, 4096
buffer_load_dwordx4 v[144:147], v1, s[8:11], s36 offen offset:0 sc1
buffer_load_dwordx4 v[148:151], v1, s[8:11], s36 offen offset:2048 sc1
buffer_load_dwordx4 v[152:155], v1, s[8:11], s37 offen offset:0 sc1
buffer_load_dwordx4 v[156:159], v1, s[8:11], s37 offen offset:2048 sc1
buffer_load_dwordx4 v[160:163], v1, s[8:11], s36 offen offset:1024 sc1
buffer_load_dwordx4 v[164:167], v1, s[8:11], s36 offen offset:3072 sc1
buffer_load_dwordx4 v[168:171], v1, s[8:11], s37 offen offset:1024 sc1
buffer_load_dwordx4 v[172:175], v1, s[8:11], s37 offen offset:3072 sc1
s_waitcnt vmcnt(0)
v_mfma_f32_16x16x32_bf16 v[80:83], v[144:147], v[208:211], v[28:31]
v_mfma_f32_16x16x32_bf16 v[80:83], v[148:151], v[212:215], v[80:83]
v_mfma_f32_16x16x32_bf16 v[80:83], v[152:155], v[216:219], v[80:83]
v_mfma_f32_16x16x32_bf16 v[80:83], v[156:159], v[220:223], v[80:83]
v_mfma_f32_16x16x32_bf16 v[84:87], v[144:147], v[224:227], v[32:35]
v_mfma_f32_16x16x32_bf16 v[84:87], v[148:151], v[228:231], v[84:87]
v_mfma_f32_16x16x32_bf16 v[84:87], v[152:155], v[232:235], v[84:87]
v_mfma_f32_16x16x32_bf16 v[84:87], v[156:159], v[236:239], v[84:87]
v_mfma_f32_16x16x32_bf16 v[88:91], v[160:163], v[208:211], v[28:31]
v_mfma_f32_16x16x32_bf16 v[88:91], v[164:167], v[212:215], v[88:91]
v_mfma_f32_16x16x32_bf16 v[88:91], v[168:171], v[216:219], v[88:91]
v_mfma_f32_16x16x32_bf16 v[88:91], v[172:175], v[220:223], v[88:91]
v_mfma_f32_16x16x32_bf16 v[92:95], v[160:163], v[224:227], v[32:35]
v_mfma_f32_16x16x32_bf16 v[92:95], v[164:167], v[228:231], v[92:95]
v_mfma_f32_16x16x32_bf16 v[92:95], v[168:171], v[232:235], v[92:95]
v_mfma_f32_16x16x32_bf16 v[92:95], v[172:175], v[236:239], v[92:95]
s_nop 7
s_add_u32 s36, s28, 8192
s_add_u32 s37, s36, 4096
buffer_load_dwordx4 v[144:147], v1, s[8:11], s36 offen offset:0 sc1
buffer_load_dwordx4 v[148:151], v1, s[8:11], s36 offen offset:2048 sc1
buffer_load_dwordx4 v[152:155], v1, s[8:11], s37 offen offset:0 sc1
buffer_load_dwordx4 v[156:159], v1, s[8:11], s37 offen offset:2048 sc1
buffer_load_dwordx4 v[160:163], v1, s[8:11], s36 offen offset:1024 sc1
buffer_load_dwordx4 v[164:167], v1, s[8:11], s36 offen offset:3072 sc1
buffer_load_dwordx4 v[168:171], v1, s[8:11], s37 offen offset:1024 sc1
buffer_load_dwordx4 v[172:175], v1, s[8:11], s37 offen offset:3072 sc1
s_waitcnt vmcnt(0)
v_mfma_f32_16x16x32_bf16 v[96:99], v[144:147], v[208:211], v[28:31]
v_mfma_f32_16x16x32_bf16 v[96:99], v[148:151], v[212:215], v[96:99]
v_mfma_f32_16x16x32_bf16 v[96:99], v[152:155], v[216:219], v[96:99]
v_mfma_f32_16x16x32_bf16 v[96:99], v[156:159], v[220:223], v[96:99]
v_mfma_f32_16x16x32_bf16 v[100:103], v[144:147], v[224:227], v[32:35]
v_mfma_f32_16x16x32_bf16 v[100:103], v[148:151], v[228:231], v[100:103]
v_mfma_f32_16x16x32_bf16 v[100:103], v[152:155], v[232:235], v[100:103]
v_mfma_f32_16x16x32_bf16 v[100:103], v[156:159], v[236:239], v[100:103]
v_mfma_f32_16x16x32_bf16 v[104:107], v[160:163], v[208:211], v[28:31]
v_mfma_f32_16x16x32_bf16 v[104:107], v[164:167], v[212:215], v[104:107]
v_mfma_f32_16x16x32_bf16 v[104:107], v[168:171], v[216:219], v[104:107]
v_mfma_f32_16x16x32_bf16 v[104:107], v[172:175], v[220:223], v[104:107]
v_mfma_f32_16x16x32_bf16 v[108:111], v[160:163], v[224:227], v[32:35]
v_mfma_f32_16x16x32_bf16 v[108:111], v[164:167], v[228:231], v[108:111]
v_mfma_f32_16x16x32_bf16 v[108:111], v[168:171], v[232:235], v[108:111]
v_mfma_f32_16x16x32_bf16 v[108:111], v[172:175], v[236:239], v[108:111]
s_nop 7
s_call_b64 s[78:79], K2_MASK_1s
v_max_f32 v38, v80, v81
v_max_f32 v39, v84, v85
v_max3_f32 v38, v38, v82, v83
v_max3_f32 v39, v39, v86, v87
v_max3_f32 v38, v38, v88, v89
v_max3_f32 v39, v39, v92, v93
v_max3_f32 v38, v38, v90, v91
v_max3_f32 v39, v39, v94, v95
v_max3_f32 v38, v38, v96, v97
v_max3_f32 v39, v39, v100, v101
v_max3_f32 v38, v38, v98, v99
v_max3_f32 v39, v39, v102, v103
v_max3_f32 v38, v38, v104, v105
v_max3_f32 v39, v39, v108, v109
v_max3_f32 v38, v38, v106, v107
v_max3_f32 v39, v39, v110, v111
v_mov_b32 v42, v38
v_mov_b32 v43, v39
s_nop 0
v_permlane32_swap_b32 v38, v42
v_permlane32_swap_b32 v39, v43
v_max_f32 v38, v38, v42
v_max_f32 v39, v39, v43
v_mov_b32 v42, v38
v_mov_b32 v43, v39
s_nop 0
v_permlane16_swap_b32 v38, v42
v_permlane16_swap_b32 v39, v43
v_max_f32 v38, v38, v42
v_max_f32 v39, v39, v43
v_ceil_f32 v38, v38
v_ceil_f32 v39, v39
v_max_f32 v38, 0, v38
v_max_f32 v39, 0, v39
v_mov_b32 v36, 0
v_mov_b32 v37, 0
v_sub_f32 v80, v80, v38
v_sub_f32 v81, v81, v38
v_sub_f32 v82, v82, v38
v_sub_f32 v83, v83, v38
v_sub_f32 v84, v84, v39
v_sub_f32 v85, v85, v39
v_sub_f32 v86, v86, v39
v_sub_f32 v87, v87, v39
v_sub_f32 v88, v88, v38
v_sub_f32 v89, v89, v38
v_sub_f32 v90, v90, v38
v_sub_f32 v91, v91, v38
v_sub_f32 v92, v92, v39
v_sub_f32 v93, v93, v39
v_sub_f32 v94, v94, v39
v_sub_f32 v95, v95, v39
v_sub_f32 v96, v96, v38
v_sub_f32 v97, v97, v38
v_sub_f32 v98, v98, v38
v_sub_f32 v99, v99, v38
v_sub_f32 v100, v100, v39
v_sub_f32 v101, v101, v39
v_sub_f32 v102, v102, v39
v_sub_f32 v103, v103, v39
v_sub_f32 v104, v104, v38
v_sub_f32 v105, v105, v38
v_sub_f32 v106, v106, v38
v_sub_f32 v107, v107, v38
v_sub_f32 v108, v108, v39
v_sub_f32 v109, v109, v39
v_sub_f32 v110, v110, v39
v_sub_f32 v111, v111, v39
v_sub_f32 v48, v48, v38
v_sub_f32 v49, v49, v38
v_sub_f32 v50, v50, v38
v_sub_f32 v51, v51, v38
v_sub_f32 v52, v52, v39
v_sub_f32 v53, v53, v39
v_sub_f32 v54, v54, v39
v_sub_f32 v55, v55, v39
v_sub_f32 v56, v56, v38
v_sub_f32 v57, v57, v38
v_sub_f32 v58, v58, v38
v_sub_f32 v59, v59, v38
v_sub_f32 v60, v60, v39
v_sub_f32 v61, v61, v39
v_sub_f32 v62, v62, v39
v_sub_f32 v63, v63, v39
v_sub_f32 v64, v64, v38
v_sub_f32 v65, v65, v38
v_sub_f32 v66, v66, v38
v_sub_f32 v67, v67, v38
v_sub_f32 v68, v68, v39
v_sub_f32 v69, v69, v39
v_sub_f32 v70, v70, v39
v_sub_f32 v71, v71, v39
v_sub_f32 v72, v72, v38
v_sub_f32 v73, v73, v38
v_sub_f32 v74, v74, v38
v_sub_f32 v75, v75, v38
v_sub_f32 v76, v76, v39
v_sub_f32 v77, v77, v39
v_sub_f32 v78, v78, v39
v_sub_f32 v79, v79, v39
v_sub_f32 v20, v20, v36
v_sub_f32 v21, v21, v36
v_sub_f32 v22, v22, v36
v_sub_f32 v23, v23, v36
v_exp_f32 v40, -v36
v_sub_f32 v24, v24, v37
v_sub_f32 v25, v25, v37
v_sub_f32 v26, v26, v37
v_sub_f32 v27, v27, v37
v_exp_f32 v41, -v37
v_sub_f32 v28, v28, v38
v_sub_f32 v29, v29, v38
v_sub_f32 v30, v30, v38
v_sub_f32 v31, v31, v38
v_exp_f32 v42, -v38
v_sub_f32 v32, v32, v39
v_sub_f32 v33, v33, v39
v_sub_f32 v34, v34, v39
v_sub_f32 v35, v35, v39
v_exp_f32 v43, -v39
v_exp_f32 v80, v80
v_exp_f32 v81, v81
v_exp_f32 v82, v82
v_exp_f32 v83, v83
v_exp_f32 v84, v84
v_add_f32 v14, v80, v81
v_cvt_pk_bf16_f32 v128, v80, v81
v_exp_f32 v85, v85
v_add_f32 v14, v14, v82
v_add_f32 v14, v14, v83
v_exp_f32 v86, v86
v_cvt_pk_bf16_f32 v129, v82, v83
v_exp_f32 v87, v87
v_exp_f32 v88, v88
v_add_f32 v15, v84, v85
v_cvt_pk_bf16_f32 v132, v84, v85
v_exp_f32 v89, v89
v_add_f32 v15, v15, v86
v_add_f32 v15, v15, v87
v_exp_f32 v90, v90
v_cvt_pk_bf16_f32 v133, v86, v87
v_exp_f32 v91, v91
v_exp_f32 v92, v92
v_add_f32 v14, v14, v88
v_add_f32 v14, v14, v89
v_exp_f32 v93, v93
v_cvt_pk_bf16_f32 v130, v88, v89
v_add_f32 v14, v14, v90
v_exp_f32 v94, v94
v_add_f32 v14, v14, v91
v_cvt_pk_bf16_f32 v131, v90, v91
v_exp_f32 v95, v95
v_exp_f32 v96, v96
v_add_f32 v15, v15, v92
v_add_f32 v15, v15, v93
v_exp_f32 v97, v97
v_cvt_pk_bf16_f32 v134, v92, v93
v_add_f32 v15, v15, v94
v_exp_f32 v98, v98
v_add_f32 v15, v15, v95
v_cvt_pk_bf16_f32 v135, v94, v95
v_exp_f32 v99, v99
v_exp_f32 v100, v100
v_add_f32 v14, v14, v96
v_add_f32 v14, v14, v97
v_exp_f32 v101, v101
v_cvt_pk_bf16_f32 v136, v96, v97
v_add_f32 v14, v14, v98
v_exp_f32 v102, v102
v_add_f32 v14, v14, v99
v_cvt_pk_bf16_f32 v137, v98, v99
v_exp_f32 v103, v103
v_exp_f32 v104, v104
v_add_f32 v15, v15, v100
v_add_f32 v15, v15, v101
v_exp_f32 v105, v105
v_cvt_pk_bf16_f32 v140, v100, v101
v_add_f32 v15, v15, v102
v_exp_f32 v106, v106
v_add_f32 v15, v15, v103
v_cvt_pk_bf16_f32 v141, v102, v103
v_exp_f32 v107, v107
v_exp_f32 v108, v108
v_add_f32 v14, v14, v104
v_add_f32 v14, v14, v105
v_exp_f32 v109, v109
v_cvt_pk_bf16_f32 v138, v104, v105
v_add_f32 v14, v14, v106
v_exp_f32 v110, v110
v_add_f32 v14, v14, v107
v_cvt_pk_bf16_f32 v139, v106, v107
v_exp_f32 v111, v111
s_nop 0
v_add_f32 v15, v15, v108
v_add_f32 v15, v15, v109
v_cvt_pk_bf16_f32 v142, v108, v109
v_add_f32 v15, v15, v110
v_add_f32 v15, v15, v111
v_cvt_pk_bf16_f32 v143, v110, v111
v_mul_f32 v8, v8, v40
v_mul_f32 v9, v9, v41
v_mul_f32 v10, v10, v42
v_mul_f32 v11, v11, v43
s_branch K2_RESC_s
K2_RESC_c:
v_accvgpr_read_b32 v144, a0
v_accvgpr_read_b32 v145, a1
v_accvgpr_read_b32 v146, a2
v_accvgpr_read_b32 v147, a3
v_accvgpr_read_b32 v148, a4
v_accvgpr_read_b32 v149, a5
v_accvgpr_read_b32 v150, a6
v_accvgpr_read_b32 v151, a7
v_mul_f32 v144, v144, v40
v_mul_f32 v145, v145, v40
v_mul_f32 v146, v146, v40
v_mul_f32 v147, v147, v40
v_mul_f32 v148, v148, v40
v_mul_f32 v149, v149, v40
v_mul_f32 v150, v150, v40
v_mul_f32 v151, v151, v40
v_accvgpr_write_b32 a0, v144
v_accvgpr_write_b32 a1, v145
v_accvgpr_write_b32 a2, v146
v_accvgpr_write_b32 a3, v147
v_accvgpr_write_b32 a4, v148
v_accvgpr_write_b32 a5, v149
v_accvgpr_write_b32 a6, v150
v_accvgpr_write_b32 a7, v151
v_accvgpr_read_b32 v144, a8
v_accvgpr_read_b32 v145, a9
v_accvgpr_read_b32 v146, a10
v_accvgpr_read_b32 v147, a11
v_accvgpr_read_b32 v148, a12
v_accvgpr_read_b32 v149, a13
v_accvgpr_read_b32 v150, a14
v_accvgpr_read_b32 v151, a15
v_mul_f32 v144, v144, v40
v_mul_f32 v145, v145, v40
v_mul_f32 v146, v146, v40
v_mul_f32 v147, v147, v40
v_mul_f32 v148, v148, v40
v_mul_f32 v149, v149, v40
v_mul_f32 v150, v150, v40
v_mul_f32 v151, v151, v40
v_accvgpr_write_b32 a8, v144
v_accvgpr_write_b32 a9, v145
v_accvgpr_write_b32 a10, v146
v_accvgpr_write_b32 a11, v147
v_accvgpr_write_b32 a12, v148
v_accvgpr_write_b32 a13, v149
v_accvgpr_write_b32 a14, v150
v_accvgpr_write_b32 a15, v151
v_accvgpr_read_b32 v144, a16
v_accvgpr_read_b32 v145, a17
v_accvgpr_read_b32 v146, a18
v_accvgpr_read_b32 v147, a19
v_accvgpr_read_b32 v148, a20
v_accvgpr_read_b32 v149, a21
v_accvgpr_read_b32 v150, a22
v_accvgpr_read_b32 v151, a23
v_mul_f32 v144, v144, v40
v_mul_f32 v145, v145, v40
v_mul_f32 v146, v146, v40
v_mul_f32 v147, v147, v40
v_mul_f32 v148, v148, v40
v_mul_f32 v149, v149, v40
v_mul_f32 v150, v150, v40
v_mul_f32 v151, v151, v40
v_accvgpr_write_b32 a16, v144
v_accvgpr_write_b32 a17, v145
v_accvgpr_write_b32 a18, v146
v_accvgpr_write_b32 a19, v147
v_accvgpr_write_b32 a20, v148
v_accvgpr_write_b32 a21, v149
v_accvgpr_write_b32 a22, v150
v_accvgpr_write_b32 a23, v151
v_accvgpr_read_b32 v144, a24
v_accvgpr_read_b32 v145, a25
v_accvgpr_read_b32 v146, a26
v_accvgpr_read_b32 v147, a27
v_accvgpr_read_b32 v148, a28
v_accvgpr_read_b32 v149, a29
v_accvgpr_read_b32 v150, a30
v_accvgpr_read_b32 v151, a31
v_mul_f32 v144, v144, v40
v_mul_f32 v145, v145, v40
v_mul_f32 v146, v146, v40
v_mul_f32 v147, v147, v40
v_mul_f32 v148, v148, v40
v_mul_f32 v149, v149, v40
v_mul_f32 v150, v150, v40
v_mul_f32 v151, v151, v40
v_accvgpr_write_b32 a24, v144
v_accvgpr_write_b32 a25, v145
v_accvgpr_write_b32 a26, v146
v_accvgpr_write_b32 a27, v147
v_accvgpr_write_b32 a28, v148
v_accvgpr_write_b32 a29, v149
v_accvgpr_write_b32 a30, v150
v_accvgpr_write_b32 a31, v151
v_accvgpr_read_b32 v144, a32
v_accvgpr_read_b32 v145, a33
v_accvgpr_read_b32 v146, a34
v_accvgpr_read_b32 v147, a35
v_accvgpr_read_b32 v148, a36
v_accvgpr_read_b32 v149, a37
v_accvgpr_read_b32 v150, a38
v_accvgpr_read_b32 v151, a39
v_mul_f32 v144, v144, v41
v_mul_f32 v145, v145, v41
v_mul_f32 v146, v146, v41
v_mul_f32 v147, v147, v41
v_mul_f32 v148, v148, v41
v_mul_f32 v149, v149, v41
v_mul_f32 v150, v150, v41
v_mul_f32 v151, v151, v41
v_accvgpr_write_b32 a32, v144
v_accvgpr_write_b32 a33, v145
v_accvgpr_write_b32 a34, v146
v_accvgpr_write_b32 a35, v147
v_accvgpr_write_b32 a36, v148
v_accvgpr_write_b32 a37, v149
v_accvgpr_write_b32 a38, v150
v_accvgpr_write_b32 a39, v151
v_accvgpr_read_b32 v144, a40
v_accvgpr_read_b32 v145, a41
v_accvgpr_read_b32 v146, a42
v_accvgpr_read_b32 v147, a43
v_accvgpr_read_b32 v148, a44
v_accvgpr_read_b32 v149, a45
v_accvgpr_read_b32 v150, a46
v_accvgpr_read_b32 v151, a47
v_mul_f32 v144, v144, v41
v_mul_f32 v145, v145, v41
v_mul_f32 v146, v146, v41
v_mul_f32 v147, v147, v41
v_mul_f32 v148, v148, v41
v_mul_f32 v149, v149, v41
v_mul_f32 v150, v150, v41
v_mul_f32 v151, v151, v41
v_accvgpr_write_b32 a40, v144
v_accvgpr_write_b32 a41, v145
v_accvgpr_write_b32 a42, v146
v_accvgpr_write_b32 a43, v147
v_accvgpr_write_b32 a44, v148
v_accvgpr_write_b32 a45, v149
v_accvgpr_write_b32 a46, v150
v_accvgpr_write_b32 a47, v151
v_accvgpr_read_b32 v144, a48
v_accvgpr_read_b32 v145, a49
v_accvgpr_read_b32 v146, a50
v_accvgpr_read_b32 v147, a51
v_accvgpr_read_b32 v148, a52
v_accvgpr_read_b32 v149, a53
v_accvgpr_read_b32 v150, a54
v_accvgpr_read_b32 v151, a55
v_mul_f32 v144, v144, v41
v_mul_f32 v145, v145, v41
v_mul_f32 v146, v146, v41
v_mul_f32 v147, v147, v41
v_mul_f32 v148, v148, v41
v_mul_f32 v149, v149, v41
v_mul_f32 v150, v150, v41
v_mul_f32 v151, v151, v41
v_accvgpr_write_b32 a48, v144
v_accvgpr_write_b32 a49, v145
v_accvgpr_write_b32 a50, v146
v_accvgpr_write_b32 a51, v147
v_accvgpr_write_b32 a52, v148
v_accvgpr_write_b32 a53, v149
v_accvgpr_write_b32 a54, v150
v_accvgpr_write_b32 a55, v151
v_accvgpr_read_b32 v144, a56
v_accvgpr_read_b32 v145, a57
v_accvgpr_read_b32 v146, a58
v_accvgpr_read_b32 v147, a59
v_accvgpr_read_b32 v148, a60
v_accvgpr_read_b32 v149, a61
v_accvgpr_read_b32 v150, a62
v_accvgpr_read_b32 v151, a63
v_mul_f32 v144, v144, v41
v_mul_f32 v145, v145, v41
v_mul_f32 v146, v146, v41
v_mul_f32 v147, v147, v41
v_mul_f32 v148, v148, v41
v_mul_f32 v149, v149, v41
v_mul_f32 v150, v150, v41
v_mul_f32 v151, v151, v41
v_accvgpr_write_b32 a56, v144
v_accvgpr_write_b32 a57, v145
v_accvgpr_write_b32 a58, v146
v_accvgpr_write_b32 a59, v147
v_accvgpr_write_b32 a60, v148
v_accvgpr_write_b32 a61, v149
v_accvgpr_write_b32 a62, v150
v_accvgpr_write_b32 a63, v151
K2_RESC_s:
v_accvgpr_read_b32 v144, a64
v_accvgpr_read_b32 v145, a65
v_accvgpr_read_b32 v146, a66
v_accvgpr_read_b32 v147, a67
v_accvgpr_read_b32 v148, a68
v_accvgpr_read_b32 v149, a69
v_accvgpr_read_b32 v150, a70
v_accvgpr_read_b32 v151, a71
v_mul_f32 v144, v144, v42
v_mul_f32 v145, v145, v42
v_mul_f32 v146, v146, v42
v_mul_f32 v147, v147, v42
v_mul_f32 v148, v148, v42
v_mul_f32 v149, v149, v42
v_mul_f32 v150, v150, v42
v_mul_f32 v151, v151, v42
v_accvgpr_write_b32 a64, v144
v_accvgpr_write_b32 a65, v145
v_accvgpr_write_b32 a66, v146
v_accvgpr_write_b32 a67, v147
v_accvgpr_write_b32 a68, v148
v_accvgpr_write_b32 a69, v149
v_accvgpr_write_b32 a70, v150
v_accvgpr_write_b32 a71, v151
v_accvgpr_read_b32 v144, a72
v_accvgpr_read_b32 v145, a73
v_accvgpr_read_b32 v146, a74
v_accvgpr_read_b32 v147, a75
v_accvgpr_read_b32 v148, a76
v_accvgpr_read_b32 v149, a77
v_accvgpr_read_b32 v150, a78
v_accvgpr_read_b32 v151, a79
v_mul_f32 v144, v144, v42
v_mul_f32 v145, v145, v42
v_mul_f32 v146, v146, v42
v_mul_f32 v147, v147, v42
v_mul_f32 v148, v148, v42
v_mul_f32 v149, v149, v42
v_mul_f32 v150, v150, v42
v_mul_f32 v151, v151, v42
v_accvgpr_write_b32 a72, v144
v_accvgpr_write_b32 a73, v145
v_accvgpr_write_b32 a74, v146
v_accvgpr_write_b32 a75, v147
v_accvgpr_write_b32 a76, v148
v_accvgpr_write_b32 a77, v149
v_accvgpr_write_b32 a78, v150
v_accvgpr_write_b32 a79, v151
v_accvgpr_read_b32 v144, a80
v_accvgpr_read_b32 v145, a81
v_accvgpr_read_b32 v146, a82
v_accvgpr_read_b32 v147, a83
v_accvgpr_read_b32 v148, a84
v_accvgpr_read_b32 v149, a85
v_accvgpr_read_b32 v150, a86
v_accvgpr_read_b32 v151, a87
v_mul_f32 v144, v144, v42
v_mul_f32 v145, v145, v42
v_mul_f32 v146, v146, v42
v_mul_f32 v147, v147, v42
v_mul_f32 v148, v148, v42
v_mul_f32 v149, v149, v42
v_mul_f32 v150, v150, v42
v_mul_f32 v151, v151, v42
v_accvgpr_write_b32 a80, v144
v_accvgpr_write_b32 a81, v145
v_accvgpr_write_b32 a82, v146
v_accvgpr_write_b32 a83, v147
v_accvgpr_write_b32 a84, v148
v_accvgpr_write_b32 a85, v149
v_accvgpr_write_b32 a86, v150
v_accvgpr_write_b32 a87, v151
v_accvgpr_read_b32 v144, a88
v_accvgpr_read_b32 v145, a89
v_accvgpr_read_b32 v146, a90
v_accvgpr_read_b32 v147, a91
v_accvgpr_read_b32 v148, a92
v_accvgpr_read_b32 v149, a93
v_accvgpr_read_b32 v150, a94
v_accvgpr_read_b32 v151, a95
v_mul_f32 v144, v144, v42
v_mul_f32 v145, v145, v42
v_mul_f32 v146, v146, v42
v_mul_f32 v147, v147, v42
v_mul_f32 v148, v148, v42
v_mul_f32 v149, v149, v42
v_mul_f32 v150, v150, v42
v_mul_f32 v151, v151, v42
v_accvgpr_write_b32 a88, v144
v_accvgpr_write_b32 a89, v145
v_accvgpr_write_b32 a90, v146
v_accvgpr_write_b32 a91, v147
v_accvgpr_write_b32 a92, v148
v_accvgpr_write_b32 a93, v149
v_accvgpr_write_b32 a94, v150
v_accvgpr_write_b32 a95, v151
v_accvgpr_read_b32 v144, a96
v_accvgpr_read_b32 v145, a97
v_accvgpr_read_b32 v146, a98
v_accvgpr_read_b32 v147, a99
v_accvgpr_read_b32 v148, a100
v_accvgpr_read_b32 v149, a101
v_accvgpr_read_b32 v150, a102
v_accvgpr_read_b32 v151, a103
v_mul_f32 v144, v144, v43
v_mul_f32 v145, v145, v43
v_mul_f32 v146, v146, v43
v_mul_f32 v147, v147, v43
v_mul_f32 v148, v148, v43
v_mul_f32 v149, v149, v43
v_mul_f32 v150, v150, v43
v_mul_f32 v151, v151, v43
v_accvgpr_write_b32 a96, v144
v_accvgpr_write_b32 a97, v145
v_accvgpr_write_b32 a98, v146
v_accvgpr_write_b32 a99, v147
v_accvgpr_write_b32 a100, v148
v_accvgpr_write_b32 a101, v149
v_accvgpr_write_b32 a102, v150
v_accvgpr_write_b32 a103, v151
v_accvgpr_read_b32 v144, a104
v_accvgpr_read_b32 v145, a105
v_accvgpr_read_b32 v146, a106
v_accvgpr_read_b32 v147, a107
v_accvgpr_read_b32 v148, a108
v_accvgpr_read_b32 v149, a109
v_accvgpr_read_b32 v150, a110
v_accvgpr_read_b32 v151, a111
v_mul_f32 v144, v144, v43
v_mul_f32 v145, v145, v43
v_mul_f32 v146, v146, v43
v_mul_f32 v147, v147, v43
v_mul_f32 v148, v148, v43
v_mul_f32 v149, v149, v43
v_mul_f32 v150, v150, v43
v_mul_f32 v151, v151, v43
v_accvgpr_write_b32 a104, v144
v_accvgpr_write_b32 a105, v145
v_accvgpr_write_b32 a106, v146
v_accvgpr_write_b32 a107, v147
v_accvgpr_write_b32 a108, v148
v_accvgpr_write_b32 a109, v149
v_accvgpr_write_b32 a110, v150
v_accvgpr_write_b32 a111, v151
v_accvgpr_read_b32 v144, a112
v_accvgpr_read_b32 v145, a113
v_accvgpr_read_b32 v146, a114
v_accvgpr_read_b32 v147, a115
v_accvgpr_read_b32 v148, a116
v_accvgpr_read_b32 v149, a117
v_accvgpr_read_b32 v150, a118
v_accvgpr_read_b32 v151, a119
v_mul_f32 v144, v144, v43
v_mul_f32 v145, v145, v43
v_mul_f32 v146, v146, v43
v_mul_f32 v147, v147, v43
v_mul_f32 v148, v148, v43
v_mul_f32 v149, v149, v43
v_mul_f32 v150, v150, v43
v_mul_f32 v151, v151, v43
v_accvgpr_write_b32 a112, v144
v_accvgpr_write_b32 a113, v145
v_accvgpr_write_b32 a114, v146
v_accvgpr_write_b32 a115, v147
v_accvgpr_write_b32 a116, v148
v_accvgpr_write_b32 a117, v149
v_accvgpr_write_b32 a118, v150
v_accvgpr_write_b32 a119, v151
v_accvgpr_read_b32 v144, a120
v_accvgpr_read_b32 v145, a121
v_accvgpr_read_b32 v146, a122
v_accvgpr_read_b32 v147, a123
v_accvgpr_read_b32 v148, a124
v_accvgpr_read_b32 v149, a125
v_accvgpr_read_b32 v150, a126
v_accvgpr_read_b32 v151, a127
v_mul_f32 v144, v144, v43
v_mul_f32 v145, v145, v43
v_mul_f32 v146, v146, v43
v_mul_f32 v147, v147, v43
v_mul_f32 v148, v148, v43
v_mul_f32 v149, v149, v43
v_mul_f32 v150, v150, v43
v_mul_f32 v151, v151, v43
v_accvgpr_write_b32 a120, v144
v_accvgpr_write_b32 a121, v145
v_accvgpr_write_b32 a122, v146
v_accvgpr_write_b32 a123, v147
v_accvgpr_write_b32 a124, v148
v_accvgpr_write_b32 a125, v149
v_accvgpr_write_b32 a126, v150
v_accvgpr_write_b32 a127, v151
s_nop 1
s_setpc_b64 s[30:31]
K2_MASK_0c:
s_ashr_i32 s36, s29, 5
s_sub_i32 s36, s36, s20
s_cmp_lt_i32 s36, 0
s_cbranch_scc1 K2_MASK_0c_e0
s_cmp_eq_i32 s36, 0
s_cbranch_scc1 K2_MASK_0c_d0
v_mov_b32 v48, v5
v_mov_b32 v49, v5
v_mov_b32 v50, v5
v_mov_b32 v51, v5
v_mov_b32 v52, v5
v_mov_b32 v53, v5
v_mov_b32 v54, v5
v_mov_b32 v55, v5
v_mov_b32 v68, v5
v_mov_b32 v69, v5
v_mov_b32 v70, v5
v_mov_b32 v71, v5
s_branch K2_MASK_0c_f0
K2_MASK_0c_d0:
v_cndmask_b32 v48, v48, v5, s[40:41]
v_cndmask_b32 v49, v49, v5, s[42:43]
v_cndmask_b32 v50, v50, v5, s[44:45]
v_cndmask_b32 v51, v51, v5, s[46:47]
v_cndmask_b32 v68, v68, v5, s[40:41]
v_cndmask_b32 v69, v69, v5, s[42:43]
v_cndmask_b32 v70, v70, v5, s[44:45]
v_cndmask_b32 v71, v71, v5, s[46:47]
K2_MASK_0c_f0:
v_mov_b32 v64, v5
v_mov_b32 v65, v5
v_mov_b32 v66, v5
v_mov_b32 v67, v5
K2_MASK_0c_e0:
s_setpc_b64 s[78:79]
K2_MASK_0s:
s_ashr_i32 s36, s29, 5
s_sub_i32 s36, s36, s20
s_cmp_lt_i32 s36, 0
s_cbranch_scc1 K2_MASK_0s_e0
s_cmp_eq_i32 s36, 0
s_cbranch_scc1 K2_MASK_0s_d0
v_mov_b32 v48, v5
v_mov_b32 v49, v5
v_mov_b32 v50, v5
v_mov_b32 v51, v5
v_mov_b32 v52, v5
v_mov_b32 v53, v5
v_mov_b32 v54, v5
v_mov_b32 v55, v5
v_mov_b32 v60, v5
v_mov_b32 v61, v5
v_mov_b32 v62, v5
v_mov_b32 v63, v5
s_branch K2_MASK_0s_f0
K2_MASK_0s_d0:
v_cndmask_b32 v48, v48, v5, s[40:41]
v_cndmask_b32 v49, v49, v5, s[42:43]
v_cndmask_b32 v50, v50, v5, s[44:45]
v_cndmask_b32 v51, v51, v5, s[46:47]
v_cndmask_b32 v60, v60, v5, s[40:41]
v_cndmask_b32 v61, v61, v5, s[42:43]
v_cndmask_b32 v62, v62, v5, s[44:45]
v_cndmask_b32 v63, v63, v5, s[46:47]
K2_MASK_0s_f0:
v_mov_b32 v56, v5
v_mov_b32 v57, v5
v_mov_b32 v58, v5
v_mov_b32 v59, v5
K2_MASK_0s_e0:
s_cmp_lt_i32 s36, -1
s_cbranch_scc1 K2_MASK_0s_e1
s_cmp_eq_i32 s36, -1
s_cbranch_scc1 K2_MASK_0s_d1
v_mov_b32 v64, v5
v_mov_b32 v65, v5
v_mov_b32 v66, v5
v_mov_b32 v67, v5
v_mov_b32 v68, v5
v_mov_b32 v69, v5
v_mov_b32 v70, v5
v_mov_b32 v71, v5
v_mov_b32 v76, v5
v_mov_b32 v77, v5
v_mov_b32 v78, v5
v_mov_b32 v79, v5
s_branch K2_MASK_0s_f1
K2_MASK_0s_d1:
v_cndmask_b32 v64, v64, v5, s[40:41]
v_cndmask_b32 v65, v65, v5, s[42:43]
v_cndmask_b32 v66, v66, v5, s[44:45]
v_cndmask_b32 v67, v67, v5, s[46:47]
v_cndmask_b32 v76, v76, v5, s[40:41]
v_cndmask_b32 v77, v77, v5, s[42:43]
v_cndmask_b32 v78, v78, v5, s[44:45]
v_cndmask_b32 v79, v79, v5, s[46:47]
K2_MASK_0s_f1:
v_mov_b32 v72, v5
v_mov_b32 v73, v5
v_mov_b32 v74, v5
v_mov_b32 v75, v5
K2_MASK_0s_e1:
s_setpc_b64 s[78:79]
K2_MASK_1c:
s_ashr_i32 s36, s29, 5
s_sub_i32 s36, s36, s20
s_cmp_lt_i32 s36, 0
s_cbranch_scc1 K2_MASK_1c_e0
s_cmp_eq_i32 s36, 0
s_cbranch_scc1 K2_MASK_1c_d0
v_mov_b32 v80, v5
v_mov_b32 v81, v5
v_mov_b32 v82, v5
v_mov_b32 v83, v5
v_mov_b32 v84, v5
v_mov_b32 v85, v5
v_mov_b32 v86, v5
v_mov_b32 v87, v5
v_mov_b32 v100, v5
v_mov_b32 v101, v5
v_mov_b32 v102, v5
v_mov_b32 v103, v5
s_branch K2_MASK_1c_f0
K2_MASK_1c_d0:
v_cndmask_b32 v80, v80, v5, s[40:41]
v_cndmask_b32 v81, v81, v5, s[42:43]
v_cndmask_b32 v82, v82, v5, s[44:45]
v_cndmask_b32 v83, v83, v5, s[46:47]
v_cndmask_b32 v100, v100, v5, s[40:41]
v_cndmask_b32 v101, v101, v5, s[42:43]
v_cndmask_b32 v102, v102, v5, s[44:45]
v_cndmask_b32 v103, v103, v5, s[46:47]
K2_MASK_1c_f0:
v_mov_b32 v96, v5
v_mov_b32 v97, v5
v_mov_b32 v98, v5
v_mov_b32 v99, v5
K2_MASK_1c_e0:
s_setpc_b64 s[78:79]
K2_MASK_1s:
s_ashr_i32 s36, s29, 5
s_sub_i32 s36, s36, s20
s_cmp_lt_i32 s36, 0
s_cbranch_scc1 K2_MASK_1s_e0
s_cmp_eq_i32 s36, 0
s_cbranch_scc1 K2_MASK_1s_d0
v_mov_b32 v80, v5
v_mov_b32 v81, v5
v_mov_b32 v82, v5
v_mov_b32 v83, v5
v_mov_b32 v84, v5
v_mov_b32 v85, v5
v_mov_b32 v86, v5
v_mov_b32 v87, v5
v_mov_b32 v92, v5
v_mov_b32 v93, v5
v_mov_b32 v94, v5
v_mov_b32 v95, v5
s_branch K2_MASK_1s_f0
K2_MASK_1s_d0:
v_cndmask_b32 v80, v80, v5, s[40:41]
v_cndmask_b32 v81, v81, v5, s[42:43]
v_cndmask_b32 v82, v82, v5, s[44:45]
v_cndmask_b32 v83, v83, v5, s[46:47]
v_cndmask_b32 v92, v92, v5, s[40:41]
v_cndmask_b32 v93, v93, v5, s[42:43]
v_cndmask_b32 v94, v94, v5, s[44:45]
v_cndmask_b32 v95, v95, v5, s[46:47]
K2_MASK_1s_f0:
v_mov_b32 v88, v5
v_mov_b32 v89, v5
v_mov_b32 v90, v5
v_mov_b32 v91, v5
K2_MASK_1s_e0:
s_cmp_lt_i32 s36, -1
s_cbranch_scc1 K2_MASK_1s_e1
s_cmp_eq_i32 s36, -1
s_cbranch_scc1 K2_MASK_1s_d1
v_mov_b32 v96, v5
v_mov_b32 v97, v5
v_mov_b32 v98, v5
v_mov_b32 v99, v5
v_mov_b32 v100, v5
v_mov_b32 v101, v5
v_mov_b32 v102, v5
v_mov_b32 v103, v5
v_mov_b32 v108, v5
v_mov_b32 v109, v5
v_mov_b32 v110, v5
v_mov_b32 v111, v5
s_branch K2_MASK_1s_f1
K2_MASK_1s_d1:
v_cndmask_b32 v96, v96, v5, s[40:41]
v_cndmask_b32 v97, v97, v5, s[42:43]
v_cndmask_b32 v98, v98, v5, s[44:45]
v_cndmask_b32 v99, v99, v5, s[46:47]
v_cndmask_b32 v108, v108, v5, s[40:41]
v_cndmask_b32 v109, v109, v5, s[42:43]
v_cndmask_b32 v110, v110, v5, s[44:45]
v_cndmask_b32 v111, v111, v5, s[46:47]
K2_MASK_1s_f1:
v_mov_b32 v104, v5
v_mov_b32 v105, v5
v_mov_b32 v106, v5
v_mov_b32 v107, v5
K2_MASK_1s_e1:
s_setpc_b64 s[78:79]
.p2align 8
.type k3_kernel,@function
k3_kernel:
s_cmp_ge_u32 s2, 512
s_cbranch_scc1 K3_END
s_getpc_b64 s[90:91]
K3_PC:
s_sub_u32 s90, s90, K3_PC-k3_kernel
s_subb_u32 s91, s91, 0
s_lshr_b32 s92, s2, 3
s_and_b32 s92, s92, 3
s_lshl_b32 s92, s92, 13
v_and_b32 v100, 63, v0
v_lshlrev_b32 v100, 7, v100
v_add_u32 v100, s92, v100
v_min_u32 v100, CODE_END-k3_kernel-4, v100
global_load_dword v100, v100, s[90:91]
s_load_dwordx2 s[4:5], s[0:1], 88
s_load_dwordx2 s[6:7], s[0:1], 72
v_lshrrev_b32 v1, 6, v0
v_and_b32 v0, 63, v0
v_readfirstlane_b32 s16, v1
v_lshlrev_b32 v1, 4, v0
s_waitcnt lgkmcnt(0)
s_mov_b32 s8, s4
s_mov_b32 s9, s5
s_mov_b32 s10, 0x10000000
s_mov_b32 s11, 0x20000
s_mov_b32 s12, s6
s_mov_b32 s13, s7
s_mov_b32 s14, 0x400000
s_mov_b32 s15, 0x20000
s_cmp_ge_u32 s2, 256
s_cbranch_scc1 K3_G
s_and_b32 s17, s2, 15
s_lshr_b32 s18, s2, 4
s_lshl_b32 s18, s18, 2
s_add_u32 s18, s18, s16
s_lshr_b32 s20, s17, 2
s_lshl_b32 s20, s20, 19
s_and_b32 s21, s17, 3
s_lshl_b32 s21, s21, 11
s_add_u32 s20, s20, s21
s_add_u32 s20, s20, 33554432
s_lshl_b32 s21, s18, 13
s_add_u32 s21, s21, s20
buffer_load_dwordx4 a[144:147], v1, s[8:11], s21 offen offset:0
buffer_load_dwordx4 a[148:151], v1, s[8:11], s21 offen offset:1024
s_lshl_b32 s22, s16, 1
s_add_u32 s22, s22, s18
s_mul_i32 s21, s16, 12288
s_sub_i32 s30, s22, 8
s_max_i32 s30, s30, 0
s_lshl_b32 s30, s30, 13
s_add_u32 s30, s30, s20
s_add_u32 s30, s30, 2097152
s_add_u32 m0, s21, 0
s_nop 0
buffer_load_dwordx4 v1, s[8:11], s30 offen offset:0 lds
buffer_load_dwordx4 v1, s[8:11], s30 offen offset:1024 lds
s_sub_i32 s31, s22, 7
s_max_i32 s31, s31, 0
s_lshl_b32 s31, s31, 13
s_add_u32 s31, s31, s20
s_add_u32 s31, s31, 2097152
s_add_u32 m0, s21, 4096
s_nop 0
buffer_load_dwordx4 v1, s[8:11], s31 offen offset:0 lds
buffer_load_dwordx4 v1, s[8:11], s31 offen offset:1024 lds
s_sub_i32 s32, s22, 6
s_max_i32 s32, s32, 0
s_lshl_b32 s32, s32, 13
s_add_u32 s32, s32, s20
s_add_u32 s32, s32, 2097152
s_add_u32 m0, s21, 8192
s_nop 0
buffer_load_dwordx4 v1, s[8:11], s32 offen offset:0 lds
buffer_load_dwordx4 v1, s[8:11], s32 offen offset:1024 lds
s_add_u32 s30, s30, 2097152
s_add_u32 m0, s21, 2048
s_nop 0
buffer_load_dwordx4 v1, s[8:11], s30 offen offset:0 lds
buffer_load_dwordx4 v1, s[8:11], s30 offen offset:1024 lds
s_add_u32 s31, s31, 2097152
s_add_u32 m0, s21, 6144
s_nop 0
buffer_load_dwordx4 v1, s[8:11], s31 offen offset:0 lds
buffer_load_dwordx4 v1, s[8:11], s31 offen offset:1024 lds
s_add_u32 s32, s32, 2097152
s_add_u32 m0, s21, 10240
s_nop 0
buffer_load_dwordx4 v1, s[8:11], s32 offen offset:0 lds
buffer_load_dwordx4 v1, s[8:11], s32 offen offset:1024 lds
s_lshl_b32 s21, s16, 12
v_add_u32 v2, s21, v1
s_waitcnt vmcnt(0)
s_barrier
ds_read_b128 a[0:3], v2 offset:0
ds_read_b128 a[4:7], v2 offset:1024
ds_read_b128 a[8:11], v2 offset:4096
ds_read_b128 a[12:15], v2 offset:5120
ds_read_b128 a[16:19], v2 offset:8192
ds_read_b128 a[20:23], v2 offset:9216
ds_read_b128 a[24:27], v2 offset:12288
ds_read_b128 a[28:31], v2 offset:13312
ds_read_b128 a[32:35], v2 offset:16384
ds_read_b128 a[36:39], v2 offset:17408
ds_read_b128 a[40:43], v2 offset:20480
ds_read_b128 a[44:47], v2 offset:21504
ds_read_b128 a[48:51], v2 offset:24576
ds_read_b128 a[52:55], v2 offset:25600
ds_read_b128 a[56:59], v2 offset:28672
ds_read_b128 a[60:63], v2 offset:29696
ds_read_b128 a[64:67], v2 offset:32768
ds_read_b128 a[68:71], v2 offset:33792
ds_read_b128 a[72:75], v2 offset:2048
ds_read_b128 a[76:79], v2 offset:3072
ds_read_b128 a[80:83], v2 offset:6144
ds_read_b128 a[84:87], v2 offset:7168
ds_read_b128 a[88:91], v2 offset:10240
ds_read_b128 a[92:95], v2 offset:11264
ds_read_b128 a[96:99], v2 offset:14336
ds_read_b128 a[100:103], v2 offset:15360
ds_read_b128 a[104:107], v2 offset:18432
ds_read_b128 a[108:111], v2 offset:19456
ds_read_b128 a[112:115], v2 offset:22528
ds_read_b128 a[116:119], v2 offset:23552
ds_read_b128 a[120:123], v2 offset:26624
ds_read_b128 a[124:127], v2 offset:27648
ds_read_b128 a[128:131], v2 offset:30720
ds_read_b128 a[132:135], v2 offset:31744
ds_read_b128 a[136:139], v2 offset:34816
ds_read_b128 a[140:143], v2 offset:35840
v_and_b32 v2, 15, v0
v_lshrrev_b32 v3, 4, v0
v_lshlrev_b32 v3, 2, v3
v_sub_u32 v2, v2, v3
v_mov_b32 v3, 0xf149f2ca
v_mov_b32 v4, 0
s_mov_b32 s30, 0xf149f2ca
s_mov_b32 s19, 0x3eb8aa3b
v_cmp_gt_i32 s[40:41], 0, v2
v_cmp_gt_i32 s[42:43], 1, v2
v_cmp_gt_i32 s[44:45], 2, v2
v_cmp_gt_i32 s[46:47], 3, v2
v_cndmask_b32 v84, v4, v3, s[40:41]
v_cndmask_b32 v80, v3, v4, s[40:41]
v_mov_b32 v88, 0x3f803f80
v_cndmask_b32 v85, v4, v3, s[42:43]
v_cndmask_b32 v81, v3, v4, s[42:43]
v_mov_b32 v89, 0x3f803f80
v_cndmask_b32 v86, v4, v3, s[44:45]
v_cndmask_b32 v82, v3, v4, s[44:45]
v_mov_b32 v90, 0x3f803f80
v_cndmask_b32 v87, v4, v3, s[46:47]
v_cndmask_b32 v83, v3, v4, s[46:47]
v_mov_b32 v91, 0x3f803f80
s_cmp_lt_u32 s18, 8
s_cbranch_scc1 K3_BI0_0
s_waitcnt lgkmcnt(15)
v_mfma_f32_16x16x16_bf16 v[8:11], a[0:1], a[144:145], v[80:83]
K3_BR0_0:
s_cmp_lt_u32 s18, 8
s_cbranch_scc1 K3_BI0_1
v_mfma_f32_16x16x16_bf16 v[12:15], a[4:5], a[144:145], 0
K3_BR0_1:
s_cmp_lt_u32 s18, 7
s_cbranch_scc1 K3_BI0_2
v_mfma_f32_16x16x16_bf16 v[16:19], a[8:9], a[144:145], 0
K3_BR0_2:
s_cmp_lt_u32 s18, 7
s_cbranch_scc1 K3_BI0_3
v_mfma_f32_16x16x16_bf16 v[20:23], a[12:13], a[144:145], 0
K3_BR0_3:
v_max3_f32 v2, v8, v9, v10
v_max_f32 v2, v2, v11
s_cmp_lt_u32 s18, 6
s_cbranch_scc1 K3_BI0_4
v_mfma_f32_16x16x16_bf16 v[24:27], a[16:17], a[144:145], 0
K3_BR0_4:
v_max3_f32 v2, v2, v12, v13
v_max3_f32 v2, v2, v14, v15
s_cmp_lt_u32 s18, 6
s_cbranch_scc1 K3_BI0_5
v_mfma_f32_16x16x16_bf16 v[28:31], a[20:21], a[144:145], 0
K3_BR0_5:
v_max3_f32 v2, v2, v16, v17
v_max3_f32 v2, v2, v18, v19
s_cmp_lt_u32 s18, 5
s_cbranch_scc1 K3_BI0_6
v_mfma_f32_16x16x16_bf16 v[32:35], a[24:25], a[144:145], 0
K3_BR0_6:
v_max3_f32 v2, v2, v20, v21
v_max3_f32 v2, v2, v22, v23
s_cmp_lt_u32 s18, 5
s_cbranch_scc1 K3_BI0_7
v_mfma_f32_16x16x16_bf16 v[36:39], a[28:29], a[144:145], 0
K3_BR0_7:
v_max3_f32 v2, v2, v24, v25
v_max3_f32 v2, v2, v26, v27
s_cmp_lt_u32 s18, 4
s_cbranch_scc1 K3_BI0_8
v_mfma_f32_16x16x16_bf16 v[40:43], a[32:33], a[144:145], 0
K3_BR0_8:
v_max3_f32 v2, v2, v28, v29
v_max3_f32 v2, v2, v30, v31
s_cmp_lt_u32 s18, 4
s_cbranch_scc1 K3_BI0_9
v_mfma_f32_16x16x16_bf16 v[44:47], a[36:37], a[144:145], 0
K3_BR0_9:
v_max3_f32 v2, v2, v32, v33
v_max3_f32 v2, v2, v34, v35
s_cmp_lt_u32 s18, 3
s_cbranch_scc1 K3_BI0_10
v_mfma_f32_16x16x16_bf16 v[48:51], a[40:41], a[144:145], 0
K3_BR0_10:
v_max3_f32 v2, v2, v36, v37
v_max3_f32 v2, v2, v38, v39
s_cmp_lt_u32 s18, 3
s_cbranch_scc1 K3_BI0_11
v_mfma_f32_16x16x16_bf16 v[52:55], a[44:45], a[144:145], 0
K3_BR0_11:
v_max3_f32 v2, v2, v40, v41
v_max3_f32 v2, v2, v42, v43
s_cmp_lt_u32 s18, 2
s_cbranch_scc1 K3_BI0_12
v_mfma_f32_16x16x16_bf16 v[56:59], a[48:49], a[144:145], 0
K3_BR0_12:
v_max3_f32 v2, v2, v44, v45
v_max3_f32 v2, v2, v46, v47
s_cmp_lt_u32 s18, 2
s_cbranch_scc1 K3_BI0_13
v_mfma_f32_16x16x16_bf16 v[60:63], a[52:53], a[144:145], 0
K3_BR0_13:
v_max3_f32 v2, v2, v48, v49
v_max3_f32 v2, v2, v50, v51
s_cmp_lt_u32 s18, 1
s_cbranch_scc1 K3_BI0_14
v_mfma_f32_16x16x16_bf16 v[64:67], a[56:57], a[144:145], 0
K3_BR0_14:
v_max3_f32 v2, v2, v52, v53
v_max3_f32 v2, v2, v54, v55
s_cmp_lt_u32 s18, 1
s_cbranch_scc1 K3_BI0_15
v_mfma_f32_16x16x16_bf16 v[68:71], a[60:61], a[144:145], 0
K3_BR0_15:
v_max3_f32 v2, v2, v56, v57
v_max3_f32 v2, v2, v58, v59
v_mfma_f32_16x16x16_bf16 v[72:75], a[64:65], a[144:145], v[84:87]
v_max3_f32 v2, v2, v60, v61
v_max3_f32 v2, v2, v62, v63
s_nop 0
v_max3_f32 v2, v2, v64, v65
v_max3_f32 v2, v2, v66, v67
s_nop 0
v_max3_f32 v2, v2, v68, v69
v_max3_f32 v2, v2, v70, v71
s_nop 3
v_max3_f32 v2, v2, v72, v73
v_max3_f32 v2, v2, v74, v75
v_mov_b32 v3, v2
s_nop 1
v_permlane32_swap_b32 v2, v3
v_max_f32 v2, v2, v3
v_mov_b32 v3, v2
s_nop 1
v_permlane16_swap_b32 v2, v3
v_max_f32 v2, v2, v3
v_mul_f32 v2, s19, v2
v_fma_f32 v8, v8, s19, -v2
v_fma_f32 v9, v9, s19, -v2
v_fma_f32 v10, v10, s19, -v2
v_fma_f32 v11, v11, s19, -v2
v_fma_f32 v12, v12, s19, -v2
v_fma_f32 v13, v13, s19, -v2
v_fma_f32 v14, v14, s19, -v2
v_fma_f32 v15, v15, s19, -v2
v_exp_f32 v8, v8
v_exp_f32 v9, v9
v_exp_f32 v10, v10
v_exp_f32 v11, v11
v_exp_f32 v12, v12
v_exp_f32 v13, v13
v_exp_f32 v14, v14
v_exp_f32 v15, v15
v_fma_f32 v16, v16, s19, -v2
v_fma_f32 v17, v17, s19, -v2
v_fma_f32 v18, v18, s19, -v2
v_fma_f32 v19, v19, s19, -v2
v_fma_f32 v20, v20, s19, -v2
v_fma_f32 v21, v21, s19, -v2
v_fma_f32 v22, v22, s19, -v2
v_fma_f32 v23, v23, s19, -v2
v_cvt_pk_bf16_f32 v8, v8, v9
v_cvt_pk_bf16_f32 v9, v10, v11
v_cvt_pk_bf16_f32 v10, v12, v13
v_cvt_pk_bf16_f32 v11, v14, v15
v_exp_f32 v16, v16
v_exp_f32 v17, v17
v_mfma_f32_16x16x32_bf16 v[92:95], a[72:75], v[8:11], 0
v_exp_f32 v18, v18
v_exp_f32 v19, v19
v_mfma_f32_16x16x32_bf16 v[96:99], v[88:91], v[8:11], 0
v_exp_f32 v20, v20
v_exp_f32 v21, v21
s_cmp_lt_u32 s18, 8
s_cbranch_scc1 K3_BI1_0
v_mfma_f32_16x16x16_bf16 v[8:11], a[2:3], a[146:147], v[80:83]
K3_BR1_0:
s_cmp_lt_u32 s18, 8
s_cbranch_scc1 K3_BI1_1
v_mfma_f32_16x16x16_bf16 v[12:15], a[6:7], a[146:147], 0
K3_BR1_1:
v_exp_f32 v22, v22
v_exp_f32 v23, v23
v_fma_f32 v24, v24, s19, -v2
v_fma_f32 v25, v25, s19, -v2
v_fma_f32 v26, v26, s19, -v2
v_fma_f32 v27, v27, s19, -v2
v_fma_f32 v28, v28, s19, -v2
v_fma_f32 v29, v29, s19, -v2
v_fma_f32 v30, v30, s19, -v2
v_fma_f32 v31, v31, s19, -v2
v_cvt_pk_bf16_f32 v16, v16, v17
v_cvt_pk_bf16_f32 v17, v18, v19
v_cvt_pk_bf16_f32 v18, v20, v21
v_cvt_pk_bf16_f32 v19, v22, v23
v_exp_f32 v24, v24
v_exp_f32 v25, v25
v_mfma_f32_16x16x32_bf16 v[92:95], a[80:83], v[16:19], v[92:95]
v_exp_f32 v26, v26
v_exp_f32 v27, v27
v_mfma_f32_16x16x32_bf16 v[96:99], v[88:91], v[16:19], v[96:99]
v_exp_f32 v28, v28
v_exp_f32 v29, v29
s_cmp_lt_u32 s18, 7
s_cbranch_scc1 K3_BI1_2
v_mfma_f32_16x16x16_bf16 v[16:19], a[10:11], a[146:147], 0
K3_BR1_2:
s_cmp_lt_u32 s18, 7
s_cbranch_scc1 K3_BI1_3
v_mfma_f32_16x16x16_bf16 v[20:23], a[14:15], a[146:147], 0
K3_BR1_3:
v_exp_f32 v30, v30
v_exp_f32 v31, v31
v_max3_f32 v100, v8, v9, v10
v_max_f32 v100, v100, v11
v_max3_f32 v100, v100, v12, v13
v_max3_f32 v100, v100, v14, v15
v_fma_f32 v32, v32, s19, -v2
v_fma_f32 v33, v33, s19, -v2
v_fma_f32 v34, v34, s19, -v2
v_fma_f32 v35, v35, s19, -v2
v_fma_f32 v36, v36, s19, -v2
v_fma_f32 v37, v37, s19, -v2
v_fma_f32 v38, v38, s19, -v2
v_fma_f32 v39, v39, s19, -v2
v_cvt_pk_bf16_f32 v24, v24, v25
v_cvt_pk_bf16_f32 v25, v26, v27
v_cvt_pk_bf16_f32 v26, v28, v29
v_cvt_pk_bf16_f32 v27, v30, v31
v_exp_f32 v32, v32
v_exp_f32 v33, v33
s_waitcnt lgkmcnt(13)
v_mfma_f32_16x16x32_bf16 v[92:95], a[88:91], v[24:27], v[92:95]
v_exp_f32 v34, v34
v_exp_f32 v35, v35
v_mfma_f32_16x16x32_bf16 v[96:99], v[88:91], v[24:27], v[96:99]
v_exp_f32 v36, v36
v_exp_f32 v37, v37
s_cmp_lt_u32 s18, 6
s_cbranch_scc1 K3_BI1_4
v_mfma_f32_16x16x16_bf16 v[24:27], a[18:19], a[146:147], 0
K3_BR1_4:
s_cmp_lt_u32 s18, 6
s_cbranch_scc1 K3_BI1_5
v_mfma_f32_16x16x16_bf16 v[28:31], a[22:23], a[146:147], 0
K3_BR1_5:
v_exp_f32 v38, v38
v_exp_f32 v39, v39
v_max3_f32 v100, v100, v16, v17
v_max3_f32 v100, v100, v18, v19
v_max3_f32 v100, v100, v20, v21
v_max3_f32 v100, v100, v22, v23
v_fma_f32 v40, v40, s19, -v2
v_fma_f32 v41, v41, s19, -v2
v_fma_f32 v42, v42, s19, -v2
v_fma_f32 v43, v43, s19, -v2
v_fma_f32 v44, v44, s19, -v2
v_fma_f32 v45, v45, s19, -v2
v_fma_f32 v46, v46, s19, -v2
v_fma_f32 v47, v47, s19, -v2
v_cvt_pk_bf16_f32 v32, v32, v33
v_cvt_pk_bf16_f32 v33, v34, v35
v_cvt_pk_bf16_f32 v34, v36, v37
v_cvt_pk_bf16_f32 v35, v38, v39
v_exp_f32 v40, v40
v_exp_f32 v41, v41
s_waitcnt lgkmcnt(11)
v_mfma_f32_16x16x32_bf16 v[92:95], a[96:99], v[32:35], v[92:95]
v_exp_f32 v42, v42
v_exp_f32 v43, v43
v_mfma_f32_16x16x32_bf16 v[96:99], v[88:91], v[32:35], v[96:99]
v_exp_f32 v44, v44
v_exp_f32 v45, v45
s_cmp_lt_u32 s18, 5
s_cbranch_scc1 K3_BI1_6
v_mfma_f32_16x16x16_bf16 v[32:35], a[26:27], a[146:147], 0
K3_BR1_6:
s_cmp_lt_u32 s18, 5
s_cbranch_scc1 K3_BI1_7
v_mfma_f32_16x16x16_bf16 v[36:39], a[30:31], a[146:147], 0
K3_BR1_7:
v_exp_f32 v46, v46
v_exp_f32 v47, v47
v_max3_f32 v100, v100, v24, v25
v_max3_f32 v100, v100, v26, v27
v_max3_f32 v100, v100, v28, v29
v_max3_f32 v100, v100, v30, v31
v_fma_f32 v48, v48, s19, -v2
v_fma_f32 v49, v49, s19, -v2
v_fma_f32 v50, v50, s19, -v2
v_fma_f32 v51, v51, s19, -v2
v_fma_f32 v52, v52, s19, -v2
v_fma_f32 v53, v53, s19, -v2
v_fma_f32 v54, v54, s19, -v2
v_fma_f32 v55, v55, s19, -v2
v_cvt_pk_bf16_f32 v40, v40, v41
v_cvt_pk_bf16_f32 v41, v42, v43
v_cvt_pk_bf16_f32 v42, v44, v45
v_cvt_pk_bf16_f32 v43, v46, v47
v_exp_f32 v48, v48
v_exp_f32 v49, v49
s_waitcnt lgkmcnt(9)
v_mfma_f32_16x16x32_bf16 v[92:95], a[104:107], v[40:43], v[92:95]
v_exp_f32 v50, v50
v_exp_f32 v51, v51
v_mfma_f32_16x16x32_bf16 v[96:99], v[88:91], v[40:43], v[96:99]
v_exp_f32 v52, v52
v_exp_f32 v53, v53
s_cmp_lt_u32 s18, 4
s_cbranch_scc1 K3_BI1_8
v_mfma_f32_16x16x16_bf16 v[40:43], a[34:35], a[146:147], 0
K3_BR1_8:
s_cmp_lt_u32 s18, 4
s_cbranch_scc1 K3_BI1_9
v_mfma_f32_16x16x16_bf16 v[44:47], a[38:39], a[146:147], 0
K3_BR1_9:
v_exp_f32 v54, v54
v_exp_f32 v55, v55
v_max3_f32 v100, v100, v32, v33
v_max3_f32 v100, v100, v34, v35
v_max3_f32 v100, v100, v36, v37
v_max3_f32 v100, v100, v38, v39
v_fma_f32 v56, v56, s19, -v2
v_fma_f32 v57, v57, s19, -v2
v_fma_f32 v58, v58, s19, -v2
v_fma_f32 v59, v59, s19, -v2
v_fma_f32 v60, v60, s19, -v2
v_fma_f32 v61, v61, s19, -v2
v_fma_f32 v62, v62, s19, -v2
v_fma_f32 v63, v63, s19, -v2
v_cvt_pk_bf16_f32 v48, v48, v49
v_cvt_pk_bf16_f32 v49, v50, v51
v_cvt_pk_bf16_f32 v50, v52, v53
v_cvt_pk_bf16_f32 v51, v54, v55
v_exp_f32 v56, v56
v_exp_f32 v57, v57
s_waitcnt lgkmcnt(7)
v_mfma_f32_16x16x32_bf16 v[92:95], a[112:115], v[48:51], v[92:95]
v_exp_f32 v58, v58
v_exp_f32 v59, v59
v_mfma_f32_16x16x32_bf16 v[96:99], v[88:91], v[48:51], v[96:99]
v_exp_f32 v60, v60
v_exp_f32 v61, v61
s_cmp_lt_u32 s18, 3
s_cbranch_scc1 K3_BI1_10
v_mfma_f32_16x16x16_bf16 v[48:51], a[42:43], a[146:147], 0
K3_BR1_10:
s_cmp_lt_u32 s18, 3
s_cbranch_scc1 K3_BI1_11
v_mfma_f32_16x16x16_bf16 v[52:55], a[46:47], a[146:147], 0
K3_BR1_11:
v_exp_f32 v62, v62
v_exp_f32 v63, v63
v_max3_f32 v100, v100, v40, v41
v_max3_f32 v100, v100, v42, v43
v_max3_f32 v100, v100, v44, v45
v_max3_f32 v100, v100, v46, v47
v_fma_f32 v64, v64, s19, -v2
v_fma_f32 v65, v65, s19, -v2
v_fma_f32 v66, v66, s19, -v2
v_fma_f32 v67, v67, s19, -v2
v_fma_f32 v68, v68, s19, -v2
v_fma_f32 v69, v69, s19, -v2
v_fma_f32 v70, v70, s19, -v2
v_fma_f32 v71, v71, s19, -v2
v_cvt_pk_bf16_f32 v56, v56, v57
v_cvt_pk_bf16_f32 v57, v58, v59
v_cvt_pk_bf16_f32 v58, v60, v61
v_cvt_pk_bf16_f32 v59, v62, v63
v_exp_f32 v64, v64
v_exp_f32 v65, v65
s_waitcnt lgkmcnt(5)
v_mfma_f32_16x16x32_bf16 v[92:95], a[120:123], v[56:59], v[92:95]
v_exp_f32 v66, v66
v_exp_f32 v67, v67
v_mfma_f32_16x16x32_bf16 v[96:99], v[88:91], v[56:59], v[96:99]
v_exp_f32 v68, v68
v_exp_f32 v69, v69
s_cmp_lt_u32 s18, 2
s_cbranch_scc1 K3_BI1_12
v_mfma_f32_16x16x16_bf16 v[56:59], a[50:51], a[146:147], 0
K3_BR1_12:
s_cmp_lt_u32 s18, 2
s_cbranch_scc1 K3_BI1_13
v_mfma_f32_16x16x16_bf16 v[60:63], a[54:55], a[146:147], 0
K3_BR1_13:
v_exp_f32 v70, v70
v_exp_f32 v71, v71
v_max3_f32 v100, v100, v48, v49
v_max3_f32 v100, v100, v50, v51
v_max3_f32 v100, v100, v52, v53
v_max3_f32 v100, v100, v54, v55
v_fma_f32 v72, v72, s19, -v2
v_fma_f32 v73, v73, s19, -v2
v_fma_f32 v74, v74, s19, -v2
v_fma_f32 v75, v75, s19, -v2
v_cvt_pk_bf16_f32 v64, v64, v65
v_cvt_pk_bf16_f32 v65, v66, v67
v_cvt_pk_bf16_f32 v66, v68, v69
v_cvt_pk_bf16_f32 v67, v70, v71
v_exp_f32 v72, v72
v_exp_f32 v73, v73
s_waitcnt lgkmcnt(3)
v_mfma_f32_16x16x32_bf16 v[92:95], a[128:131], v[64:67], v[92:95]
v_exp_f32 v74, v74
v_exp_f32 v75, v75
v_mfma_f32_16x16x32_bf16 v[96:99], v[88:91], v[64:67], v[96:99]
s_cmp_lt_u32 s18, 1
s_cbranch_scc1 K3_BI1_14
v_mfma_f32_16x16x16_bf16 v[64:67], a[58:59], a[146:147], 0
K3_BR1_14:
s_cmp_lt_u32 s18, 1
s_cbranch_scc1 K3_BI1_15
v_mfma_f32_16x16x16_bf16 v[68:71], a[62:63], a[146:147], 0
K3_BR1_15:
v_max3_f32 v100, v100, v56, v57
v_max3_f32 v100, v100, v58, v59
v_max3_f32 v100, v100, v60, v61
v_max3_f32 v100, v100, v62, v63
s_nop 0
v_cvt_pk_bf16_f32 v72, v72, v73
v_cvt_pk_bf16_f32 v73, v74, v75
v_mov_b32 v74, 0
v_mov_b32 v75, 0
s_nop 1
s_waitcnt lgkmcnt(1)
v_mfma_f32_16x16x32_bf16 v[92:95], a[136:139], v[72:75], v[92:95]
v_mfma_f32_16x16x32_bf16 v[96:99], v[88:91], v[72:75], v[96:99]
v_mfma_f32_16x16x16_bf16 v[72:75], a[66:67], a[146:147], v[84:87]
v_max3_f32 v100, v100, v64, v65
v_max3_f32 v100, v100, v66, v67
v_max3_f32 v100, v100, v68, v69
v_max3_f32 v100, v100, v70, v71
s_nop 3
v_max3_f32 v100, v100, v72, v73
v_max3_f32 v100, v100, v74, v75
v_mov_b32 v3, v100
s_nop 1
v_permlane32_swap_b32 v100, v3
v_max_f32 v100, v100, v3
v_mov_b32 v3, v100
s_nop 1
v_permlane16_swap_b32 v100, v3
v_max_f32 v100, v100, v3
v_mul_f32 v100, s19, v100
v_rcp_f32 v3, v96
s_nop 0
v_mul_f32 v92, v92, v3
v_mul_f32 v93, v93, v3
v_mul_f32 v94, v94, v3
v_mul_f32 v95, v95, v3
v_cvt_pk_bf16_f32 v4, v92, v93
v_cvt_pk_bf16_f32 v5, v94, v95
v_fma_f32 v8, v8, s19, -v100
v_fma_f32 v9, v9, s19, -v100
v_fma_f32 v10, v10, s19, -v100
v_fma_f32 v11, v11, s19, -v100
v_fma_f32 v12, v12, s19, -v100
v_fma_f32 v13, v13, s19, -v100
v_fma_f32 v14, v14, s19, -v100
v_fma_f32 v15, v15, s19, -v100
v_exp_f32 v8, v8
v_exp_f32 v9, v9
v_exp_f32 v10, v10
v_exp_f32 v11, v11
v_exp_f32 v12, v12
v_exp_f32 v13, v13
v_exp_f32 v14, v14
v_exp_f32 v15, v15
v_fma_f32 v16, v16, s19, -v100
v_fma_f32 v17, v17, s19, -v100
v_fma_f32 v18, v18, s19, -v100
v_fma_f32 v19, v19, s19, -v100
v_fma_f32 v20, v20, s19, -v100
v_fma_f32 v21, v21, s19, -v100
v_fma_f32 v22, v22, s19, -v100
v_fma_f32 v23, v23, s19, -v100
v_cvt_pk_bf16_f32 v8, v8, v9
v_cvt_pk_bf16_f32 v9, v10, v11
v_cvt_pk_bf16_f32 v10, v12, v13
v_cvt_pk_bf16_f32 v11, v14, v15
v_exp_f32 v16, v16
v_exp_f32 v17, v17
v_mfma_f32_16x16x32_bf16 v[92:95], a[76:79], v[8:11], 0
v_exp_f32 v18, v18
v_exp_f32 v19, v19
v_mfma_f32_16x16x32_bf16 v[96:99], v[88:91], v[8:11], 0
v_exp_f32 v20, v20
v_exp_f32 v21, v21
s_cmp_lt_u32 s18, 8
s_cbranch_scc1 K3_BI2_1
v_mfma_f32_16x16x16_bf16 v[12:15], a[4:5], a[148:149], v[80:83]
K3_BR2_1:
v_exp_f32 v22, v22
v_exp_f32 v23, v23
v_fma_f32 v24, v24, s19, -v100
v_fma_f32 v25, v25, s19, -v100
v_fma_f32 v26, v26, s19, -v100
v_fma_f32 v27, v27, s19, -v100
v_fma_f32 v28, v28, s19, -v100
v_fma_f32 v29, v29, s19, -v100
v_fma_f32 v30, v30, s19, -v100
v_fma_f32 v31, v31, s19, -v100
v_cvt_pk_bf16_f32 v16, v16, v17
v_cvt_pk_bf16_f32 v17, v18, v19
v_cvt_pk_bf16_f32 v18, v20, v21
v_cvt_pk_bf16_f32 v19, v22, v23
v_exp_f32 v24, v24
v_exp_f32 v25, v25
v_mfma_f32_16x16x32_bf16 v[92:95], a[84:87], v[16:19], v[92:95]
v_exp_f32 v26, v26
v_exp_f32 v27, v27
v_mfma_f32_16x16x32_bf16 v[96:99], v[88:91], v[16:19], v[96:99]
v_exp_f32 v28, v28
v_exp_f32 v29, v29
s_cmp_lt_u32 s18, 7
s_cbranch_scc1 K3_BI2_2
v_mfma_f32_16x16x16_bf16 v[16:19], a[8:9], a[148:149], 0
K3_BR2_2:
s_cmp_lt_u32 s18, 7
s_cbranch_scc1 K3_BI2_3
v_mfma_f32_16x16x16_bf16 v[20:23], a[12:13], a[148:149], 0
K3_BR2_3:
v_exp_f32 v30, v30
v_exp_f32 v31, v31
v_max3_f32 v2, v12, v13, v14
v_max_f32 v2, v2, v15
v_fma_f32 v32, v32, s19, -v100
v_fma_f32 v33, v33, s19, -v100
v_fma_f32 v34, v34, s19, -v100
v_fma_f32 v35, v35, s19, -v100
v_fma_f32 v36, v36, s19, -v100
v_fma_f32 v37, v37, s19, -v100
v_fma_f32 v38, v38, s19, -v100
v_fma_f32 v39, v39, s19, -v100
v_cvt_pk_bf16_f32 v24, v24, v25
v_cvt_pk_bf16_f32 v25, v26, v27
v_cvt_pk_bf16_f32 v26, v28, v29
v_cvt_pk_bf16_f32 v27, v30, v31
v_exp_f32 v32, v32
v_exp_f32 v33, v33
v_mfma_f32_16x16x32_bf16 v[92:95], a[92:95], v[24:27], v[92:95]
v_exp_f32 v34, v34
v_exp_f32 v35, v35
v_mfma_f32_16x16x32_bf16 v[96:99], v[88:91], v[24:27], v[96:99]
v_exp_f32 v36, v36
v_exp_f32 v37, v37
s_cmp_lt_u32 s18, 6
s_cbranch_scc1 K3_BI2_4
v_mfma_f32_16x16x16_bf16 v[24:27], a[16:17], a[148:149], 0
K3_BR2_4:
s_cmp_lt_u32 s18, 6
s_cbranch_scc1 K3_BI2_5
v_mfma_f32_16x16x16_bf16 v[28:31], a[20:21], a[148:149], 0
K3_BR2_5:
v_exp_f32 v38, v38
v_exp_f32 v39, v39
v_max3_f32 v2, v2, v16, v17
v_max3_f32 v2, v2, v18, v19
v_max3_f32 v2, v2, v20, v21
v_max3_f32 v2, v2, v22, v23
v_fma_f32 v40, v40, s19, -v100
v_fma_f32 v41, v41, s19, -v100
v_fma_f32 v42, v42, s19, -v100
v_fma_f32 v43, v43, s19, -v100
v_fma_f32 v44, v44, s19, -v100
v_fma_f32 v45, v45, s19, -v100
v_fma_f32 v46, v46, s19, -v100
v_fma_f32 v47, v47, s19, -v100
v_cvt_pk_bf16_f32 v32, v32, v33
v_cvt_pk_bf16_f32 v33, v34, v35
v_cvt_pk_bf16_f32 v34, v36, v37
v_cvt_pk_bf16_f32 v35, v38, v39
v_exp_f32 v40, v40
v_exp_f32 v41, v41
v_mfma_f32_16x16x32_bf16 v[92:95], a[100:103], v[32:35], v[92:95]
v_exp_f32 v42, v42
v_exp_f32 v43, v43
v_mfma_f32_16x16x32_bf16 v[96:99], v[88:91], v[32:35], v[96:99]
v_exp_f32 v44, v44
v_exp_f32 v45, v45
s_cmp_lt_u32 s18, 5
s_cbranch_scc1 K3_BI2_6
v_mfma_f32_16x16x16_bf16 v[32:35], a[24:25], a[148:149], 0
K3_BR2_6:
s_cmp_lt_u32 s18, 5
s_cbranch_scc1 K3_BI2_7
v_mfma_f32_16x16x16_bf16 v[36:39], a[28:29], a[148:149], 0
K3_BR2_7:
v_exp_f32 v46, v46
v_exp_f32 v47, v47
v_max3_f32 v2, v2, v24, v25
v_max3_f32 v2, v2, v26, v27
v_max3_f32 v2, v2, v28, v29
v_max3_f32 v2, v2, v30, v31
v_fma_f32 v48, v48, s19, -v100
v_fma_f32 v49, v49, s19, -v100
v_fma_f32 v50, v50, s19, -v100
v_fma_f32 v51, v51, s19, -v100
v_fma_f32 v52, v52, s19, -v100
v_fma_f32 v53, v53, s19, -v100
v_fma_f32 v54, v54, s19, -v100
v_fma_f32 v55, v55, s19, -v100
v_cvt_pk_bf16_f32 v40, v40, v41
v_cvt_pk_bf16_f32 v41, v42, v43
v_cvt_pk_bf16_f32 v42, v44, v45
v_cvt_pk_bf16_f32 v43, v46, v47
v_exp_f32 v48, v48
v_exp_f32 v49, v49
v_mfma_f32_16x16x32_bf16 v[92:95], a[108:111], v[40:43], v[92:95]
v_exp_f32 v50, v50
v_exp_f32 v51, v51
v_mfma_f32_16x16x32_bf16 v[96:99], v[88:91], v[40:43], v[96:99]
v_exp_f32 v52, v52
v_exp_f32 v53, v53
s_cmp_lt_u32 s18, 4
s_cbranch_scc1 K3_BI2_8
v_mfma_f32_16x16x16_bf16 v[40:43], a[32:33], a[148:149], 0
K3_BR2_8:
s_cmp_lt_u32 s18, 4
s_cbranch_scc1 K3_BI2_9
v_mfma_f32_16x16x16_bf16 v[44:47], a[36:37], a[148:149], 0
K3_BR2_9:
v_exp_f32 v54, v54
v_exp_f32 v55, v55
v_max3_f32 v2, v2, v32, v33
v_max3_f32 v2, v2, v34, v35
v_max3_f32 v2, v2, v36, v37
v_max3_f32 v2, v2, v38, v39
v_fma_f32 v56, v56, s19, -v100
v_fma_f32 v57, v57, s19, -v100
v_fma_f32 v58, v58, s19, -v100
v_fma_f32 v59, v59, s19, -v100
v_fma_f32 v60, v60, s19, -v100
v_fma_f32 v61, v61, s19, -v100
v_fma_f32 v62, v62, s19, -v100
v_fma_f32 v63, v63, s19, -v100
v_cvt_pk_bf16_f32 v48, v48, v49
v_cvt_pk_bf16_f32 v49, v50, v51
v_cvt_pk_bf16_f32 v50, v52, v53
v_cvt_pk_bf16_f32 v51, v54, v55
v_exp_f32 v56, v56
v_exp_f32 v57, v57
v_mfma_f32_16x16x32_bf16 v[92:95], a[116:119], v[48:51], v[92:95]
v_exp_f32 v58, v58
v_exp_f32 v59, v59
v_mfma_f32_16x16x32_bf16 v[96:99], v[88:91], v[48:51], v[96:99]
v_exp_f32 v60, v60
v_exp_f32 v61, v61
s_cmp_lt_u32 s18, 3
s_cbranch_scc1 K3_BI2_10
v_mfma_f32_16x16x16_bf16 v[48:51], a[40:41], a[148:149], 0
K3_BR2_10:
s_cmp_lt_u32 s18, 3
s_cbranch_scc1 K3_BI2_11
v_mfma_f32_16x16x16_bf16 v[52:55], a[44:45], a[148:149], 0
K3_BR2_11:
v_exp_f32 v62, v62
v_exp_f32 v63, v63
v_max3_f32 v2, v2, v40, v41
v_max3_f32 v2, v2, v42, v43
v_max3_f32 v2, v2, v44, v45
v_max3_f32 v2, v2, v46, v47
v_fma_f32 v64, v64, s19, -v100
v_fma_f32 v65, v65, s19, -v100
v_fma_f32 v66, v66, s19, -v100
v_fma_f32 v67, v67, s19, -v100
v_fma_f32 v68, v68, s19, -v100
v_fma_f32 v69, v69, s19, -v100
v_fma_f32 v70, v70, s19, -v100
v_fma_f32 v71, v71, s19, -v100
v_cvt_pk_bf16_f32 v56, v56, v57
v_cvt_pk_bf16_f32 v57, v58, v59
v_cvt_pk_bf16_f32 v58, v60, v61
v_cvt_pk_bf16_f32 v59, v62, v63
v_exp_f32 v64, v64
v_exp_f32 v65, v65
v_mfma_f32_16x16x32_bf16 v[92:95], a[124:127], v[56:59], v[92:95]
v_exp_f32 v66, v66
v_exp_f32 v67, v67
v_mfma_f32_16x16x32_bf16 v[96:99], v[88:91], v[56:59], v[96:99]
v_exp_f32 v68, v68
v_exp_f32 v69, v69
s_cmp_lt_u32 s18, 2
s_cbranch_scc1 K3_BI2_12
v_mfma_f32_16x16x16_bf16 v[56:59], a[48:49], a[148:149], 0
K3_BR2_12:
s_cmp_lt_u32 s18, 2
s_cbranch_scc1 K3_BI2_13
v_mfma_f32_16x16x16_bf16 v[60:63], a[52:53], a[148:149], 0
K3_BR2_13:
v_exp_f32 v70, v70
v_exp_f32 v71, v71
v_max3_f32 v2, v2, v48, v49
v_max3_f32 v2, v2, v50, v51
v_max3_f32 v2, v2, v52, v53
v_max3_f32 v2, v2, v54, v55
v_fma_f32 v72, v72, s19, -v100
v_fma_f32 v73, v73, s19, -v100
v_fma_f32 v74, v74, s19, -v100
v_fma_f32 v75, v75, s19, -v100
v_cvt_pk_bf16_f32 v64, v64, v65
v_cvt_pk_bf16_f32 v65, v66, v67
v_cvt_pk_bf16_f32 v66, v68, v69
v_cvt_pk_bf16_f32 v67, v70, v71
v_exp_f32 v72, v72
v_exp_f32 v73, v73
v_mfma_f32_16x16x32_bf16 v[92:95], a[132:135], v[64:67], v[92:95]
v_exp_f32 v74, v74
v_exp_f32 v75, v75
v_mfma_f32_16x16x32_bf16 v[96:99], v[88:91], v[64:67], v[96:99]
s_cmp_lt_u32 s18, 1
s_cbranch_scc1 K3_BI2_14
v_mfma_f32_16x16x16_bf16 v[64:67], a[56:57], a[148:149], 0
K3_BR2_14:
s_cmp_lt_u32 s18, 1
s_cbranch_scc1 K3_BI2_15
v_mfma_f32_16x16x16_bf16 v[68:71], a[60:61], a[148:149], 0
K3_BR2_15:
v_max3_f32 v2, v2, v56, v57
v_max3_f32 v2, v2, v58, v59
v_max3_f32 v2, v2, v60, v61
v_max3_f32 v2, v2, v62, v63
s_nop 0
v_cvt_pk_bf16_f32 v72, v72, v73
v_cvt_pk_bf16_f32 v73, v74, v75
v_mov_b32 v74, 0
v_mov_b32 v75, 0
s_nop 1
s_waitcnt lgkmcnt(0)
v_mfma_f32_16x16x32_bf16 v[92:95], a[140:143], v[72:75], v[92:95]
v_mfma_f32_16x16x32_bf16 v[96:99], v[88:91], v[72:75], v[96:99]
v_mfma_f32_16x16x16_bf16 v[72:75], a[64:65], a[148:149], 0
v_mfma_f32_16x16x16_bf16 v[76:79], a[68:69], a[148:149], v[84:87]
v_max3_f32 v2, v2, v64, v65
v_max3_f32 v2, v2, v66, v67
v_max3_f32 v2, v2, v68, v69
v_max3_f32 v2, v2, v70, v71
s_nop 3
v_max3_f32 v2, v2, v72, v73
v_max3_f32 v2, v2, v74, v75
v_max3_f32 v2, v2, v76, v77
v_max3_f32 v2, v2, v78, v79
v_mov_b32 v3, v2
s_nop 1
v_permlane32_swap_b32 v2, v3
v_max_f32 v2, v2, v3
v_mov_b32 v3, v2
s_nop 1
v_permlane16_swap_b32 v2, v3
v_max_f32 v2, v2, v3
v_mul_f32 v2, s19, v2
v_rcp_f32 v3, v96
s_nop 0
v_mul_f32 v92, v92, v3
v_mul_f32 v93, v93, v3
v_mul_f32 v94, v94, v3
v_mul_f32 v95, v95, v3
v_cvt_pk_bf16_f32 v6, v92, v93
v_cvt_pk_bf16_f32 v7, v94, v95
s_lshr_b32 s20, s18, 1
s_mul_i32 s20, s20, 589824
s_and_b32 s21, s18, 1
s_lshl_b32 s21, s21, 11
s_add_u32 s20, s20, s21
s_lshl_b32 s21, s17, 12
s_add_u32 s20, s20, s21
s_add_u32 s20, s20, 59244544
buffer_store_dwordx4 v[4:7], v1, s[8:11], s20 offen sc1
s_nop 0
v_fma_f32 v12, v12, s19, -v2
v_fma_f32 v13, v13, s19, -v2
v_fma_f32 v14, v14, s19, -v2
v_fma_f32 v15, v15, s19, -v2
v_exp_f32 v12, v12
v_exp_f32 v13, v13
v_exp_f32 v14, v14
v_exp_f32 v15, v15
v_fma_f32 v16, v16, s19, -v2
v_fma_f32 v17, v17, s19, -v2
v_fma_f32 v18, v18, s19, -v2
v_fma_f32 v19, v19, s19, -v2
v_fma_f32 v20, v20, s19, -v2
v_fma_f32 v21, v21, s19, -v2
v_fma_f32 v22, v22, s19, -v2
v_fma_f32 v23, v23, s19, -v2
v_mov_b32 v8, 0
v_mov_b32 v9, 0
v_cvt_pk_bf16_f32 v10, v12, v13
v_cvt_pk_bf16_f32 v11, v14, v15
v_exp_f32 v16, v16
v_exp_f32 v17, v17
v_mfma_f32_16x16x32_bf16 v[92:95], a[72:75], v[8:11], 0
v_exp_f32 v18, v18
v_exp_f32 v19, v19
v_mfma_f32_16x16x32_bf16 v[96:99], v[88:91], v[8:11], 0
v_exp_f32 v20, v20
v_exp_f32 v21, v21
s_cmp_lt_u32 s18, 8
s_cbranch_scc1 K3_BI3_1
v_mfma_f32_16x16x16_bf16 v[12:15], a[6:7], a[150:151], v[80:83]
K3_BR3_1:
v_exp_f32 v22, v22
v_exp_f32 v23, v23
v_fma_f32 v24, v24, s19, -v2
v_fma_f32 v25, v25, s19, -v2
v_fma_f32 v26, v26, s19, -v2
v_fma_f32 v27, v27, s19, -v2
v_fma_f32 v28, v28, s19, -v2
v_fma_f32 v29, v29, s19, -v2
v_fma_f32 v30, v30, s19, -v2
v_fma_f32 v31, v31, s19, -v2
v_cvt_pk_bf16_f32 v16, v16, v17
v_cvt_pk_bf16_f32 v17, v18, v19
v_cvt_pk_bf16_f32 v18, v20, v21
v_cvt_pk_bf16_f32 v19, v22, v23
v_exp_f32 v24, v24
v_exp_f32 v25, v25
v_mfma_f32_16x16x32_bf16 v[92:95], a[80:83], v[16:19], v[92:95]
v_exp_f32 v26, v26
v_exp_f32 v27, v27
v_mfma_f32_16x16x32_bf16 v[96:99], v[88:91], v[16:19], v[96:99]
v_exp_f32 v28, v28
v_exp_f32 v29, v29
s_cmp_lt_u32 s18, 7
s_cbranch_scc1 K3_BI3_2
v_mfma_f32_16x16x16_bf16 v[16:19], a[10:11], a[150:151], 0
K3_BR3_2:
s_cmp_lt_u32 s18, 7
s_cbranch_scc1 K3_BI3_3
v_mfma_f32_16x16x16_bf16 v[20:23], a[14:15], a[150:151], 0
K3_BR3_3:
v_exp_f32 v30, v30
v_exp_f32 v31, v31
v_max3_f32 v100, v12, v13, v14
v_max_f32 v100, v100, v15
v_fma_f32 v32, v32, s19, -v2
v_fma_f32 v33, v33, s19, -v2
v_fma_f32 v34, v34, s19, -v2
v_fma_f32 v35, v35, s19, -v2
v_fma_f32 v36, v36, s19, -v2
v_fma_f32 v37, v37, s19, -v2
v_fma_f32 v38, v38, s19, -v2
v_fma_f32 v39, v39, s19, -v2
v_cvt_pk_bf16_f32 v24, v24, v25
v_cvt_pk_bf16_f32 v25, v26, v27
v_cvt_pk_bf16_f32 v26, v28, v29
v_cvt_pk_bf16_f32 v27, v30, v31
v_exp_f32 v32, v32
v_exp_f32 v33, v33
v_mfma_f32_16x16x32_bf16 v[92:95], a[88:91], v[24:27], v[92:95]
v_exp_f32 v34, v34
v_exp_f32 v35, v35
v_mfma_f32_16x16x32_bf16 v[96:99], v[88:91], v[24:27], v[96:99]
v_exp_f32 v36, v36
v_exp_f32 v37, v37
s_cmp_lt_u32 s18, 6
s_cbranch_scc1 K3_BI3_4
v_mfma_f32_16x16x16_bf16 v[24:27], a[18:19], a[150:151], 0
K3_BR3_4:
s_cmp_lt_u32 s18, 6
s_cbranch_scc1 K3_BI3_5
v_mfma_f32_16x16x16_bf16 v[28:31], a[22:23], a[150:151], 0
K3_BR3_5:
v_exp_f32 v38, v38
v_exp_f32 v39, v39
v_max3_f32 v100, v100, v16, v17
v_max3_f32 v100, v100, v18, v19
v_max3_f32 v100, v100, v20, v21
v_max3_f32 v100, v100, v22, v23
v_fma_f32 v40, v40, s19, -v2
v_fma_f32 v41, v41, s19, -v2
v_fma_f32 v42, v42, s19, -v2
v_fma_f32 v43, v43, s19, -v2
v_fma_f32 v44, v44, s19, -v2
v_fma_f32 v45, v45, s19, -v2
v_fma_f32 v46, v46, s19, -v2
v_fma_f32 v47, v47, s19, -v2
v_cvt_pk_bf16_f32 v32, v32, v33
v_cvt_pk_bf16_f32 v33, v34, v35
v_cvt_pk_bf16_f32 v34, v36, v37
v_cvt_pk_bf16_f32 v35, v38, v39
v_exp_f32 v40, v40
v_exp_f32 v41, v41
v_mfma_f32_16x16x32_bf16 v[92:95], a[96:99], v[32:35], v[92:95]
v_exp_f32 v42, v42
v_exp_f32 v43, v43
v_mfma_f32_16x16x32_bf16 v[96:99], v[88:91], v[32:35], v[96:99]
v_exp_f32 v44, v44
v_exp_f32 v45, v45
s_cmp_lt_u32 s18, 5
s_cbranch_scc1 K3_BI3_6
v_mfma_f32_16x16x16_bf16 v[32:35], a[26:27], a[150:151], 0
K3_BR3_6:
s_cmp_lt_u32 s18, 5
s_cbranch_scc1 K3_BI3_7
v_mfma_f32_16x16x16_bf16 v[36:39], a[30:31], a[150:151], 0
K3_BR3_7:
v_exp_f32 v46, v46
v_exp_f32 v47, v47
v_max3_f32 v100, v100, v24, v25
v_max3_f32 v100, v100, v26, v27
v_max3_f32 v100, v100, v28, v29
v_max3_f32 v100, v100, v30, v31
v_fma_f32 v48, v48, s19, -v2
v_fma_f32 v49, v49, s19, -v2
v_fma_f32 v50, v50, s19, -v2
v_fma_f32 v51, v51, s19, -v2
v_fma_f32 v52, v52, s19, -v2
v_fma_f32 v53, v53, s19, -v2
v_fma_f32 v54, v54, s19, -v2
v_fma_f32 v55, v55, s19, -v2
v_cvt_pk_bf16_f32 v40, v40, v41
v_cvt_pk_bf16_f32 v41, v42, v43
v_cvt_pk_bf16_f32 v42, v44, v45
v_cvt_pk_bf16_f32 v43, v46, v47
v_exp_f32 v48, v48
v_exp_f32 v49, v49
v_mfma_f32_16x16x32_bf16 v[92:95], a[104:107], v[40:43], v[92:95]
v_exp_f32 v50, v50
v_exp_f32 v51, v51
v_mfma_f32_16x16x32_bf16 v[96:99], v[88:91], v[40:43], v[96:99]
v_exp_f32 v52, v52
v_exp_f32 v53, v53
s_cmp_lt_u32 s18, 4
s_cbranch_scc1 K3_BI3_8
v_mfma_f32_16x16x16_bf16 v[40:43], a[34:35], a[150:151], 0
K3_BR3_8:
s_cmp_lt_u32 s18, 4
s_cbranch_scc1 K3_BI3_9
v_mfma_f32_16x16x16_bf16 v[44:47], a[38:39], a[150:151], 0
K3_BR3_9:
v_exp_f32 v54, v54
v_exp_f32 v55, v55
v_max3_f32 v100, v100, v32, v33
v_max3_f32 v100, v100, v34, v35
v_max3_f32 v100, v100, v36, v37
v_max3_f32 v100, v100, v38, v39
v_fma_f32 v56, v56, s19, -v2
v_fma_f32 v57, v57, s19, -v2
v_fma_f32 v58, v58, s19, -v2
v_fma_f32 v59, v59, s19, -v2
v_fma_f32 v60, v60, s19, -v2
v_fma_f32 v61, v61, s19, -v2
v_fma_f32 v62, v62, s19, -v2
v_fma_f32 v63, v63, s19, -v2
v_cvt_pk_bf16_f32 v48, v48, v49
v_cvt_pk_bf16_f32 v49, v50, v51
v_cvt_pk_bf16_f32 v50, v52, v53
v_cvt_pk_bf16_f32 v51, v54, v55
v_exp_f32 v56, v56
v_exp_f32 v57, v57
v_mfma_f32_16x16x32_bf16 v[92:95], a[112:115], v[48:51], v[92:95]
v_exp_f32 v58, v58
v_exp_f32 v59, v59
v_mfma_f32_16x16x32_bf16 v[96:99], v[88:91], v[48:51], v[96:99]
v_exp_f32 v60, v60
v_exp_f32 v61, v61
s_cmp_lt_u32 s18, 3
s_cbranch_scc1 K3_BI3_10
v_mfma_f32_16x16x16_bf16 v[48:51], a[42:43], a[150:151], 0
K3_BR3_10:
s_cmp_lt_u32 s18, 3
s_cbranch_scc1 K3_BI3_11
v_mfma_f32_16x16x16_bf16 v[52:55], a[46:47], a[150:151], 0
K3_BR3_11:
v_exp_f32 v62, v62
v_exp_f32 v63, v63
v_max3_f32 v100, v100, v40, v41
v_max3_f32 v100, v100, v42, v43
v_max3_f32 v100, v100, v44, v45
v_max3_f32 v100, v100, v46, v47
v_fma_f32 v64, v64, s19, -v2
v_fma_f32 v65, v65, s19, -v2
v_fma_f32 v66, v66, s19, -v2
v_fma_f32 v67, v67, s19, -v2
v_fma_f32 v68, v68, s19, -v2
v_fma_f32 v69, v69, s19, -v2
v_fma_f32 v70, v70, s19, -v2
v_fma_f32 v71, v71, s19, -v2
v_cvt_pk_bf16_f32 v56, v56, v57
v_cvt_pk_bf16_f32 v57, v58, v59
v_cvt_pk_bf16_f32 v58, v60, v61
v_cvt_pk_bf16_f32 v59, v62, v63
v_exp_f32 v64, v64
v_exp_f32 v65, v65
v_mfma_f32_16x16x32_bf16 v[92:95], a[120:123], v[56:59], v[92:95]
v_exp_f32 v66, v66
v_exp_f32 v67, v67
v_mfma_f32_16x16x32_bf16 v[96:99], v[88:91], v[56:59], v[96:99]
v_exp_f32 v68, v68
v_exp_f32 v69, v69
s_cmp_lt_u32 s18, 2
s_cbranch_scc1 K3_BI3_12
v_mfma_f32_16x16x16_bf16 v[56:59], a[50:51], a[150:151], 0
K3_BR3_12:
s_cmp_lt_u32 s18, 2
s_cbranch_scc1 K3_BI3_13
v_mfma_f32_16x16x16_bf16 v[60:63], a[54:55], a[150:151], 0
K3_BR3_13:
v_exp_f32 v70, v70
v_exp_f32 v71, v71
v_max3_f32 v100, v100, v48, v49
v_max3_f32 v100, v100, v50, v51
v_max3_f32 v100, v100, v52, v53
v_max3_f32 v100, v100, v54, v55
v_fma_f32 v72, v72, s19, -v2
v_fma_f32 v73, v73, s19, -v2
v_fma_f32 v74, v74, s19, -v2
v_fma_f32 v75, v75, s19, -v2
v_fma_f32 v76, v76, s19, -v2
v_fma_f32 v77, v77, s19, -v2
v_fma_f32 v78, v78, s19, -v2
v_fma_f32 v79, v79, s19, -v2
v_cvt_pk_bf16_f32 v64, v64, v65
v_cvt_pk_bf16_f32 v65, v66, v67
v_cvt_pk_bf16_f32 v66, v68, v69
v_cvt_pk_bf16_f32 v67, v70, v71
v_exp_f32 v72, v72
v_exp_f32 v73, v73
v_mfma_f32_16x16x32_bf16 v[92:95], a[128:131], v[64:67], v[92:95]
v_exp_f32 v74, v74
v_exp_f32 v75, v75
v_mfma_f32_16x16x32_bf16 v[96:99], v[88:91], v[64:67], v[96:99]
v_exp_f32 v76, v76
v_exp_f32 v77, v77
s_cmp_lt_u32 s18, 1
s_cbranch_scc1 K3_BI3_14
v_mfma_f32_16x16x16_bf16 v[64:67], a[58:59], a[150:151], 0
K3_BR3_14:
s_cmp_lt_u32 s18, 1
s_cbranch_scc1 K3_BI3_15
v_mfma_f32_16x16x16_bf16 v[68:71], a[62:63], a[150:151], 0
K3_BR3_15:
v_exp_f32 v78, v78
v_exp_f32 v79, v79
v_max3_f32 v100, v100, v56, v57
v_max3_f32 v100, v100, v58, v59
v_max3_f32 v100, v100, v60, v61
v_max3_f32 v100, v100, v62, v63
s_nop 0
v_cvt_pk_bf16_f32 v72, v72, v73
v_cvt_pk_bf16_f32 v73, v74, v75
v_cvt_pk_bf16_f32 v74, v76, v77
v_cvt_pk_bf16_f32 v75, v78, v79
s_nop 1
v_mfma_f32_16x16x32_bf16 v[92:95], a[136:139], v[72:75], v[92:95]
v_mfma_f32_16x16x32_bf16 v[96:99], v[88:91], v[72:75], v[96:99]
v_mfma_f32_16x16x16_bf16 v[72:75], a[66:67], a[150:151], 0
v_mfma_f32_16x16x16_bf16 v[76:79], a[70:71], a[150:151], v[84:87]
v_max3_f32 v100, v100, v64, v65
v_max3_f32 v100, v100, v66, v67
v_max3_f32 v100, v100, v68, v69
v_max3_f32 v100, v100, v70, v71
s_nop 3
v_max3_f32 v100, v100, v72, v73
v_max3_f32 v100, v100, v74, v75
v_max3_f32 v100, v100, v76, v77
v_max3_f32 v100, v100, v78, v79
v_mov_b32 v3, v100
s_nop 1
v_permlane32_swap_b32 v100, v3
v_max_f32 v100, v100, v3
v_mov_b32 v3, v100
s_nop 1
v_permlane16_swap_b32 v100, v3
v_max_f32 v100, v100, v3
v_mul_f32 v100, s19, v100
v_rcp_f32 v3, v96
s_nop 0
v_mul_f32 v92, v92, v3
v_mul_f32 v93, v93, v3
v_mul_f32 v94, v94, v3
v_mul_f32 v95, v95, v3
v_cvt_pk_bf16_f32 v4, v92, v93
v_cvt_pk_bf16_f32 v5, v94, v95
v_fma_f32 v12, v12, s19, -v100
v_fma_f32 v13, v13, s19, -v100
v_fma_f32 v14, v14, s19, -v100
v_fma_f32 v15, v15, s19, -v100
v_exp_f32 v12, v12
v_exp_f32 v13, v13
v_exp_f32 v14, v14
v_exp_f32 v15, v15
v_fma_f32 v16, v16, s19, -v100
v_fma_f32 v17, v17, s19, -v100
v_fma_f32 v18, v18, s19, -v100
v_fma_f32 v19, v19, s19, -v100
v_fma_f32 v20, v20, s19, -v100
v_fma_f32 v21, v21, s19, -v100
v_fma_f32 v22, v22, s19, -v100
v_fma_f32 v23, v23, s19, -v100
v_mov_b32 v8, 0
v_mov_b32 v9, 0
v_cvt_pk_bf16_f32 v10, v12, v13
v_cvt_pk_bf16_f32 v11, v14, v15
v_exp_f32 v16, v16
v_exp_f32 v17, v17
v_mfma_f32_16x16x32_bf16 v[92:95], a[76:79], v[8:11], 0
v_exp_f32 v18, v18
v_exp_f32 v19, v19
v_mfma_f32_16x16x32_bf16 v[96:99], v[88:91], v[8:11], 0
v_exp_f32 v20, v20
v_exp_f32 v21, v21
v_exp_f32 v22, v22
v_exp_f32 v23, v23
v_fma_f32 v24, v24, s19, -v100
v_fma_f32 v25, v25, s19, -v100
v_fma_f32 v26, v26, s19, -v100
v_fma_f32 v27, v27, s19, -v100
v_fma_f32 v28, v28, s19, -v100
v_fma_f32 v29, v29, s19, -v100
v_fma_f32 v30, v30, s19, -v100
v_fma_f32 v31, v31, s19, -v100
v_cvt_pk_bf16_f32 v16, v16, v17
v_cvt_pk_bf16_f32 v17, v18, v19
v_cvt_pk_bf16_f32 v18, v20, v21
v_cvt_pk_bf16_f32 v19, v22, v23
v_exp_f32 v24, v24
v_exp_f32 v25, v25
v_mfma_f32_16x16x32_bf16 v[92:95], a[84:87], v[16:19], v[92:95]
v_exp_f32 v26, v26
v_exp_f32 v27, v27
v_mfma_f32_16x16x32_bf16 v[96:99], v[88:91], v[16:19], v[96:99]
v_exp_f32 v28, v28
v_exp_f32 v29, v29
v_exp_f32 v30, v30
v_exp_f32 v31, v31
v_fma_f32 v32, v32, s19, -v100
v_fma_f32 v33, v33, s19, -v100
v_fma_f32 v34, v34, s19, -v100
v_fma_f32 v35, v35, s19, -v100
v_fma_f32 v36, v36, s19, -v100
v_fma_f32 v37, v37, s19, -v100
v_fma_f32 v38, v38, s19, -v100
v_fma_f32 v39, v39, s19, -v100
v_cvt_pk_bf16_f32 v24, v24, v25
v_cvt_pk_bf16_f32 v25, v26, v27
v_cvt_pk_bf16_f32 v26, v28, v29
v_cvt_pk_bf16_f32 v27, v30, v31
v_exp_f32 v32, v32
v_exp_f32 v33, v33
v_mfma_f32_16x16x32_bf16 v[92:95], a[92:95], v[24:27], v[92:95]
v_exp_f32 v34, v34
v_exp_f32 v35, v35
v_mfma_f32_16x16x32_bf16 v[96:99], v[88:91], v[24:27], v[96:99]
v_exp_f32 v36, v36
v_exp_f32 v37, v37
v_exp_f32 v38, v38
v_exp_f32 v39, v39
v_fma_f32 v40, v40, s19, -v100
v_fma_f32 v41, v41, s19, -v100
v_fma_f32 v42, v42, s19, -v100
v_fma_f32 v43, v43, s19, -v100
v_fma_f32 v44, v44, s19, -v100
v_fma_f32 v45, v45, s19, -v100
v_fma_f32 v46, v46, s19, -v100
v_fma_f32 v47, v47, s19, -v100
v_cvt_pk_bf16_f32 v32, v32, v33
v_cvt_pk_bf16_f32 v33, v34, v35
v_cvt_pk_bf16_f32 v34, v36, v37
v_cvt_pk_bf16_f32 v35, v38, v39
v_exp_f32 v40, v40
v_exp_f32 v41, v41
v_mfma_f32_16x16x32_bf16 v[92:95], a[100:103], v[32:35], v[92:95]
v_exp_f32 v42, v42
v_exp_f32 v43, v43
v_mfma_f32_16x16x32_bf16 v[96:99], v[88:91], v[32:35], v[96:99]
v_exp_f32 v44, v44
v_exp_f32 v45, v45
v_exp_f32 v46, v46
v_exp_f32 v47, v47
v_fma_f32 v48, v48, s19, -v100
v_fma_f32 v49, v49, s19, -v100
v_fma_f32 v50, v50, s19, -v100
v_fma_f32 v51, v51, s19, -v100
v_fma_f32 v52, v52, s19, -v100
v_fma_f32 v53, v53, s19, -v100
v_fma_f32 v54, v54, s19, -v100
v_fma_f32 v55, v55, s19, -v100
v_cvt_pk_bf16_f32 v40, v40, v41
v_cvt_pk_bf16_f32 v41, v42, v43
v_cvt_pk_bf16_f32 v42, v44, v45
v_cvt_pk_bf16_f32 v43, v46, v47
v_exp_f32 v48, v48
v_exp_f32 v49, v49
v_mfma_f32_16x16x32_bf16 v[92:95], a[108:111], v[40:43], v[92:95]
v_exp_f32 v50, v50
v_exp_f32 v51, v51
v_mfma_f32_16x16x32_bf16 v[96:99], v[88:91], v[40:43], v[96:99]
v_exp_f32 v52, v52
v_exp_f32 v53, v53
v_exp_f32 v54, v54
v_exp_f32 v55, v55
v_fma_f32 v56, v56, s19, -v100
v_fma_f32 v57, v57, s19, -v100
v_fma_f32 v58, v58, s19, -v100
v_fma_f32 v59, v59, s19, -v100
v_fma_f32 v60, v60, s19, -v100
v_fma_f32 v61, v61, s19, -v100
v_fma_f32 v62, v62, s19, -v100
v_fma_f32 v63, v63, s19, -v100
v_cvt_pk_bf16_f32 v48, v48, v49
v_cvt_pk_bf16_f32 v49, v50, v51
v_cvt_pk_bf16_f32 v50, v52, v53
v_cvt_pk_bf16_f32 v51, v54, v55
v_exp_f32 v56, v56
v_exp_f32 v57, v57
v_mfma_f32_16x16x32_bf16 v[92:95], a[116:119], v[48:51], v[92:95]
v_exp_f32 v58, v58
v_exp_f32 v59, v59
v_mfma_f32_16x16x32_bf16 v[96:99], v[88:91], v[48:51], v[96:99]
v_exp_f32 v60, v60
v_exp_f32 v61, v61
v_exp_f32 v62, v62
v_exp_f32 v63, v63
v_fma_f32 v64, v64, s19, -v100
v_fma_f32 v65, v65, s19, -v100
v_fma_f32 v66, v66, s19, -v100
v_fma_f32 v67, v67, s19, -v100
v_fma_f32 v68, v68, s19, -v100
v_fma_f32 v69, v69, s19, -v100
v_fma_f32 v70, v70, s19, -v100
v_fma_f32 v71, v71, s19, -v100
v_cvt_pk_bf16_f32 v56, v56, v57
v_cvt_pk_bf16_f32 v57, v58, v59
v_cvt_pk_bf16_f32 v58, v60, v61
v_cvt_pk_bf16_f32 v59, v62, v63
v_exp_f32 v64, v64
v_exp_f32 v65, v65
v_mfma_f32_16x16x32_bf16 v[92:95], a[124:127], v[56:59], v[92:95]
v_exp_f32 v66, v66
v_exp_f32 v67, v67
v_mfma_f32_16x16x32_bf16 v[96:99], v[88:91], v[56:59], v[96:99]
v_exp_f32 v68, v68
v_exp_f32 v69, v69
v_exp_f32 v70, v70
v_exp_f32 v71, v71
v_fma_f32 v72, v72, s19, -v100
v_fma_f32 v73, v73, s19, -v100
v_fma_f32 v74, v74, s19, -v100
v_fma_f32 v75, v75, s19, -v100
v_fma_f32 v76, v76, s19, -v100
v_fma_f32 v77, v77, s19, -v100
v_fma_f32 v78, v78, s19, -v100
v_fma_f32 v79, v79, s19, -v100
v_cvt_pk_bf16_f32 v64, v64, v65
v_cvt_pk_bf16_f32 v65, v66, v67
v_cvt_pk_bf16_f32 v66, v68, v69
v_cvt_pk_bf16_f32 v67, v70, v71
v_exp_f32 v72, v72
v_exp_f32 v73, v73
v_mfma_f32_16x16x32_bf16 v[92:95], a[132:135], v[64:67], v[92:95]
v_exp_f32 v74, v74
v_exp_f32 v75, v75
v_mfma_f32_16x16x32_bf16 v[96:99], v[88:91], v[64:67], v[96:99]
v_exp_f32 v76, v76
v_exp_f32 v77, v77
v_exp_f32 v78, v78
v_exp_f32 v79, v79
s_nop 0
v_cvt_pk_bf16_f32 v72, v72, v73
v_cvt_pk_bf16_f32 v73, v74, v75
v_cvt_pk_bf16_f32 v74, v76, v77
v_cvt_pk_bf16_f32 v75, v78, v79
s_nop 1
v_mfma_f32_16x16x32_bf16 v[92:95], a[140:143], v[72:75], v[92:95]
v_mfma_f32_16x16x32_bf16 v[96:99], v[88:91], v[72:75], v[96:99]
s_nop 7
v_rcp_f32 v3, v96
s_nop 0
v_mul_f32 v92, v92, v3
v_mul_f32 v93, v93, v3
v_mul_f32 v94, v94, v3
v_mul_f32 v95, v95, v3
v_cvt_pk_bf16_f32 v6, v92, v93
v_cvt_pk_bf16_f32 v7, v94, v95
s_lshr_b32 s20, s18, 1
s_mul_i32 s20, s20, 589824
s_and_b32 s21, s18, 1
s_lshl_b32 s21, s21, 11
s_add_u32 s20, s20, s21
s_lshl_b32 s21, s17, 12
s_add_u32 s20, s20, s21
s_add_u32 s20, s20, 59245568
buffer_store_dwordx4 v[4:7], v1, s[8:11], s20 offen sc1
s_nop 0
s_waitcnt vmcnt(0)
s_barrier
s_cmp_lg_u32 s16, 0
s_cbranch_scc1 K3_BEND
s_lshl_b32 s20, s2, 2
s_add_u32 s20, s20, 115343360
v_mov_b32 v2, 1
v_mov_b32 v3, 0
s_mov_b64 exec, 1
buffer_store_dword v2, v3, s[8:11], s20 offen sc1
s_mov_b64 exec, -1
K3_BEND:
s_endpgm
K3_G:
s_sub_u32 s22, s2, 256
s_and_b32 s20, s22, 7
s_lshr_b32 s22, s22, 3
s_lshr_b32 s17, s20, 1
s_lshl_b32 s17, s17, 3
s_and_b32 s21, s22, 7
s_add_u32 s17, s17, s21
s_and_b32 s18, s20, 1
s_lshl_b32 s18, s18, 2
s_lshr_b32 s21, s22, 3
s_add_u32 s18, s18, s21
s_mul_i32 s44, s17, 589824
s_add_u32 s44, s44, 58720256
s_mul_i32 s45, s18, 589824
s_add_u32 s45, s45, 83886080
s_lshl_b32 s20, s16, 14
s_add_u32 s20, s20, 524288
s_add_u32 s46, s44, s20
s_add_u32 s47, s45, s20
s_lshl_b32 s20, s16, 17
s_add_u32 s44, s44, s20
s_add_u32 s45, s45, s20
buffer_load_dwordx4 v[28:31], v1, s[8:11], s45 offen offset:0
buffer_load_dwordx4 v[32:35], v1, s[8:11], s45 offen offset:1024
buffer_load_dwordx4 v[36:39], v1, s[8:11], s45 offen offset:2048
buffer_load_dwordx4 v[40:43], v1, s[8:11], s45 offen offset:3072
buffer_load_dwordx4 v[12:15], v1, s[8:11], s44 offen offset:0
buffer_load_dwordx4 v[16:19], v1, s[8:11], s44 offen offset:1024
buffer_load_dwordx4 v[20:23], v1, s[8:11], s44 offen offset:2048
buffer_load_dwordx4 v[24:27], v1, s[8:11], s44 offen offset:3072
s_add_u32 s44, s44, 4096
s_add_u32 s45, s45, 4096
buffer_load_dwordx4 v[60:63], v1, s[8:11], s45 offen offset:0
buffer_load_dwordx4 v[64:67], v1, s[8:11], s45 offen offset:1024
buffer_load_dwordx4 v[68:71], v1, s[8:11], s45 offen offset:2048
buffer_load_dwordx4 v[72:75], v1, s[8:11], s45 offen offset:3072
buffer_load_dwordx4 v[44:47], v1, s[8:11], s44 offen offset:0
buffer_load_dwordx4 v[48:51], v1, s[8:11], s44 offen offset:1024
buffer_load_dwordx4 v[52:55], v1, s[8:11], s44 offen offset:2048
buffer_load_dwordx4 v[56:59], v1, s[8:11], s44 offen offset:3072
s_add_u32 s44, s44, 4096
s_add_u32 s45, s45, 4096
buffer_load_dwordx4 a[144:147], v1, s[8:11], s45 offen offset:0
buffer_load_dwordx4 a[148:151], v1, s[8:11], s45 offen offset:1024
buffer_load_dwordx4 v[92:95], v1, s[8:11], s45 offen offset:2048
buffer_load_dwordx4 v[96:99], v1, s[8:11], s45 offen offset:3072
buffer_load_dwordx4 a[128:131], v1, s[8:11], s44 offen offset:0
buffer_load_dwordx4 a[132:135], v1, s[8:11], s44 offen offset:1024
buffer_load_dwordx4 a[136:139], v1, s[8:11], s44 offen offset:2048
buffer_load_dwordx4 a[140:143], v1, s[8:11], s44 offen offset:3072
s_add_u32 s44, s44, 4096
s_add_u32 s45, s45, 4096
buffer_load_dwordx4 a[80:83], v1, s[8:11], s45 offen offset:0
buffer_load_dwordx4 a[84:87], v1, s[8:11], s45 offen offset:1024
buffer_load_dwordx4 a[88:91], v1, s[8:11], s45 offen offset:2048
buffer_load_dwordx4 a[92:95], v1, s[8:11], s45 offen offset:3072
buffer_load_dwordx4 a[64:67], v1, s[8:11], s44 offen offset:0
buffer_load_dwordx4 a[68:71], v1, s[8:11], s44 offen offset:1024
buffer_load_dwordx4 a[72:75], v1, s[8:11], s44 offen offset:2048
buffer_load_dwordx4 a[76:79], v1, s[8:11], s44 offen offset:3072
s_add_u32 s44, s44, 4096
s_add_u32 s45, s45, 4096
buffer_load_dwordx4 a[112:115], v1, s[8:11], s45 offen offset:0
buffer_load_dwordx4 a[116:119], v1, s[8:11], s45 offen offset:1024
buffer_load_dwordx4 a[120:123], v1, s[8:11], s45 offen offset:2048
buffer_load_dwordx4 a[124:127], v1, s[8:11], s45 offen offset:3072
buffer_load_dwordx4 a[96:99], v1, s[8:11], s44 offen offset:0
buffer_load_dwordx4 a[100:103], v1, s[8:11], s44 offen offset:1024
buffer_load_dwordx4 a[104:107], v1, s[8:11], s44 offen offset:2048
buffer_load_dwordx4 a[108:111], v1, s[8:11], s44 offen offset:3072
s_add_u32 s44, s44, 4096
s_add_u32 s45, s45, 4096
v_and_b32 v2, 15, v0
v_lshlrev_b32 v2, 2, v2
s_lshr_b32 s22, s17, 1
s_lshl_b32 s22, s22, 6
s_add_u32 s22, s22, 115343360
s_waitcnt vmcnt(35)
v_mfma_f32_16x16x32_bf16 a[0:3], v[28:31], v[12:15], 0
s_waitcnt vmcnt(34)
v_mfma_f32_16x16x32_bf16 a[4:7], v[28:31], v[16:19], 0
s_waitcnt vmcnt(33)
v_mfma_f32_16x16x32_bf16 a[8:11], v[28:31], v[20:23], 0
s_waitcnt vmcnt(32)
v_mfma_f32_16x16x32_bf16 a[12:15], v[28:31], v[24:27], 0
v_mfma_f32_16x16x32_bf16 a[16:19], v[32:35], v[12:15], 0
v_mfma_f32_16x16x32_bf16 a[20:23], v[32:35], v[16:19], 0
v_mfma_f32_16x16x32_bf16 a[24:27], v[32:35], v[20:23], 0
v_mfma_f32_16x16x32_bf16 a[28:31], v[32:35], v[24:27], 0
v_mfma_f32_16x16x32_bf16 a[32:35], v[36:39], v[12:15], 0
v_mfma_f32_16x16x32_bf16 a[36:39], v[36:39], v[16:19], 0
v_mfma_f32_16x16x32_bf16 a[40:43], v[36:39], v[20:23], 0
v_mfma_f32_16x16x32_bf16 a[44:47], v[36:39], v[24:27], 0
v_mfma_f32_16x16x32_bf16 a[48:51], v[40:43], v[12:15], 0
v_mfma_f32_16x16x32_bf16 a[52:55], v[40:43], v[16:19], 0
v_mfma_f32_16x16x32_bf16 a[56:59], v[40:43], v[20:23], 0
v_mfma_f32_16x16x32_bf16 a[60:63], v[40:43], v[24:27], 0
buffer_load_dwordx4 v[28:31], v1, s[8:11], s45 offen offset:0
buffer_load_dwordx4 v[32:35], v1, s[8:11], s45 offen offset:1024
buffer_load_dwordx4 v[36:39], v1, s[8:11], s45 offen offset:2048
buffer_load_dwordx4 v[40:43], v1, s[8:11], s45 offen offset:3072
buffer_load_dwordx4 v[12:15], v1, s[8:11], s44 offen offset:0
buffer_load_dwordx4 v[16:19], v1, s[8:11], s44 offen offset:1024
buffer_load_dwordx4 v[20:23], v1, s[8:11], s44 offen offset:2048
buffer_load_dwordx4 v[24:27], v1, s[8:11], s44 offen offset:3072
s_add_u32 s44, s44, 4096
s_add_u32 s45, s45, 4096
s_waitcnt vmcnt(35)
v_mfma_f32_16x16x32_bf16 a[0:3], v[60:63], v[44:47], a[0:3]
s_waitcnt vmcnt(34)
v_mfma_f32_16x16x32_bf16 a[4:7], v[60:63], v[48:51], a[4:7]
s_waitcnt vmcnt(33)
v_mfma_f32_16x16x32_bf16 a[8:11], v[60:63], v[52:55], a[8:11]
s_waitcnt vmcnt(32)
v_mfma_f32_16x16x32_bf16 a[12:15], v[60:63], v[56:59], a[12:15]
v_mfma_f32_16x16x32_bf16 a[16:19], v[64:67], v[44:47], a[16:19]
v_mfma_f32_16x16x32_bf16 a[20:23], v[64:67], v[48:51], a[20:23]
v_mfma_f32_16x16x32_bf16 a[24:27], v[64:67], v[52:55], a[24:27]
v_mfma_f32_16x16x32_bf16 a[28:31], v[64:67], v[56:59], a[28:31]
v_mfma_f32_16x16x32_bf16 a[32:35], v[68:71], v[44:47], a[32:35]
v_mfma_f32_16x16x32_bf16 a[36:39], v[68:71], v[48:51], a[36:39]
v_mfma_f32_16x16x32_bf16 a[40:43], v[68:71], v[52:55], a[40:43]
v_mfma_f32_16x16x32_bf16 a[44:47], v[68:71], v[56:59], a[44:47]
v_mfma_f32_16x16x32_bf16 a[48:51], v[72:75], v[44:47], a[48:51]
v_mfma_f32_16x16x32_bf16 a[52:55], v[72:75], v[48:51], a[52:55]
v_mfma_f32_16x16x32_bf16 a[56:59], v[72:75], v[52:55], a[56:59]
v_mfma_f32_16x16x32_bf16 a[60:63], v[72:75], v[56:59], a[60:63]
buffer_load_dwordx4 v[60:63], v1, s[8:11], s45 offen offset:0
buffer_load_dwordx4 v[64:67], v1, s[8:11], s45 offen offset:1024
buffer_load_dwordx4 v[68:71], v1, s[8:11], s45 offen offset:2048
buffer_load_dwordx4 v[72:75], v1, s[8:11], s45 offen offset:3072
buffer_load_dwordx4 v[44:47], v1, s[8:11], s44 offen offset:0
buffer_load_dwordx4 v[48:51], v1, s[8:11], s44 offen offset:1024
buffer_load_dwordx4 v[52:55], v1, s[8:11], s44 offen offset:2048
buffer_load_dwordx4 v[56:59], v1, s[8:11], s44 offen offset:3072
s_add_u32 s44, s44, 4096
s_add_u32 s45, s45, 4096
s_waitcnt vmcnt(35)
v_mfma_f32_16x16x32_bf16 a[0:3], a[144:147], a[128:131], a[0:3]
s_waitcnt vmcnt(34)
v_mfma_f32_16x16x32_bf16 a[4:7], a[144:147], a[132:135], a[4:7]
s_waitcnt vmcnt(33)
v_mfma_f32_16x16x32_bf16 a[8:11], a[144:147], a[136:139], a[8:11]
s_waitcnt vmcnt(32)
v_mfma_f32_16x16x32_bf16 a[12:15], a[144:147], a[140:143], a[12:15]
v_mfma_f32_16x16x32_bf16 a[16:19], a[148:151], a[128:131], a[16:19]
v_mfma_f32_16x16x32_bf16 a[20:23], a[148:151], a[132:135], a[20:23]
v_mfma_f32_16x16x32_bf16 a[24:27], a[148:151], a[136:139], a[24:27]
v_mfma_f32_16x16x32_bf16 a[28:31], a[148:151], a[140:143], a[28:31]
v_mfma_f32_16x16x32_bf16 a[32:35], v[92:95], a[128:131], a[32:35]
v_mfma_f32_16x16x32_bf16 a[36:39], v[92:95], a[132:135], a[36:39]
v_mfma_f32_16x16x32_bf16 a[40:43], v[92:95], a[136:139], a[40:43]
v_mfma_f32_16x16x32_bf16 a[44:47], v[92:95], a[140:143], a[44:47]
v_mfma_f32_16x16x32_bf16 a[48:51], v[96:99], a[128:131], a[48:51]
v_mfma_f32_16x16x32_bf16 a[52:55], v[96:99], a[132:135], a[52:55]
v_mfma_f32_16x16x32_bf16 a[56:59], v[96:99], a[136:139], a[56:59]
v_mfma_f32_16x16x32_bf16 a[60:63], v[96:99], a[140:143], a[60:63]
buffer_load_dwordx4 a[144:147], v1, s[8:11], s45 offen offset:0
buffer_load_dwordx4 a[148:151], v1, s[8:11], s45 offen offset:1024
buffer_load_dwordx4 v[92:95], v1, s[8:11], s45 offen offset:2048
buffer_load_dwordx4 v[96:99], v1, s[8:11], s45 offen offset:3072
buffer_load_dwordx4 a[128:131], v1, s[8:11], s44 offen offset:0
buffer_load_dwordx4 a[132:135], v1, s[8:11], s44 offen offset:1024
buffer_load_dwordx4 a[136:139], v1, s[8:11], s44 offen offset:2048
buffer_load_dwordx4 a[140:143], v1, s[8:11], s44 offen offset:3072
s_add_u32 s44, s44, 4096
s_add_u32 s45, s45, 4096
s_waitcnt vmcnt(35)
v_mfma_f32_16x16x32_bf16 a[0:3], a[80:83], a[64:67], a[0:3]
s_waitcnt vmcnt(34)
v_mfma_f32_16x16x32_bf16 a[4:7], a[80:83], a[68:71], a[4:7]
s_waitcnt vmcnt(33)
v_mfma_f32_16x16x32_bf16 a[8:11], a[80:83], a[72:75], a[8:11]
s_waitcnt vmcnt(32)
v_mfma_f32_16x16x32_bf16 a[12:15], a[80:83], a[76:79], a[12:15]
v_mfma_f32_16x16x32_bf16 a[16:19], a[84:87], a[64:67], a[16:19]
v_mfma_f32_16x16x32_bf16 a[20:23], a[84:87], a[68:71], a[20:23]
v_mfma_f32_16x16x32_bf16 a[24:27], a[84:87], a[72:75], a[24:27]
v_mfma_f32_16x16x32_bf16 a[28:31], a[84:87], a[76:79], a[28:31]
v_mfma_f32_16x16x32_bf16 a[32:35], a[88:91], a[64:67], a[32:35]
v_mfma_f32_16x16x32_bf16 a[36:39], a[88:91], a[68:71], a[36:39]
v_mfma_f32_16x16x32_bf16 a[40:43], a[88:91], a[72:75], a[40:43]
v_mfma_f32_16x16x32_bf16 a[44:47], a[88:91], a[76:79], a[44:47]
v_mfma_f32_16x16x32_bf16 a[48:51], a[92:95], a[64:67], a[48:51]
v_mfma_f32_16x16x32_bf16 a[52:55], a[92:95], a[68:71], a[52:55]
v_mfma_f32_16x16x32_bf16 a[56:59], a[92:95], a[72:75], a[56:59]
v_mfma_f32_16x16x32_bf16 a[60:63], a[92:95], a[76:79], a[60:63]
buffer_load_dwordx4 a[80:83], v1, s[8:11], s45 offen offset:0
buffer_load_dwordx4 a[84:87], v1, s[8:11], s45 offen offset:1024
buffer_load_dwordx4 a[88:91], v1, s[8:11], s45 offen offset:2048
buffer_load_dwordx4 a[92:95], v1, s[8:11], s45 offen offset:3072
buffer_load_dwordx4 a[64:67], v1, s[8:11], s44 offen offset:0
buffer_load_dwordx4 a[68:71], v1, s[8:11], s44 offen offset:1024
buffer_load_dwordx4 a[72:75], v1, s[8:11], s44 offen offset:2048
buffer_load_dwordx4 a[76:79], v1, s[8:11], s44 offen offset:3072
s_add_u32 s44, s44, 4096
s_add_u32 s45, s45, 4096
s_waitcnt vmcnt(35)
v_mfma_f32_16x16x32_bf16 a[0:3], a[112:115], a[96:99], a[0:3]
s_waitcnt vmcnt(34)
v_mfma_f32_16x16x32_bf16 a[4:7], a[112:115], a[100:103], a[4:7]
s_waitcnt vmcnt(33)
v_mfma_f32_16x16x32_bf16 a[8:11], a[112:115], a[104:107], a[8:11]
s_waitcnt vmcnt(32)
v_mfma_f32_16x16x32_bf16 a[12:15], a[112:115], a[108:111], a[12:15]
v_mfma_f32_16x16x32_bf16 a[16:19], a[116:119], a[96:99], a[16:19]
v_mfma_f32_16x16x32_bf16 a[20:23], a[116:119], a[100:103], a[20:23]
v_mfma_f32_16x16x32_bf16 a[24:27], a[116:119], a[104:107], a[24:27]
v_mfma_f32_16x16x32_bf16 a[28:31], a[116:119], a[108:111], a[28:31]
v_mfma_f32_16x16x32_bf16 a[32:35], a[120:123], a[96:99], a[32:35]
v_mfma_f32_16x16x32_bf16 a[36:39], a[120:123], a[100:103], a[36:39]
v_mfma_f32_16x16x32_bf16 a[40:43], a[120:123], a[104:107], a[40:43]
v_mfma_f32_16x16x32_bf16 a[44:47], a[120:123], a[108:111], a[44:47]
v_mfma_f32_16x16x32_bf16 a[48:51], a[124:127], a[96:99], a[48:51]
v_mfma_f32_16x16x32_bf16 a[52:55], a[124:127], a[100:103], a[52:55]
v_mfma_f32_16x16x32_bf16 a[56:59], a[124:127], a[104:107], a[56:59]
v_mfma_f32_16x16x32_bf16 a[60:63], a[124:127], a[108:111], a[60:63]
buffer_load_dwordx4 a[112:115], v1, s[8:11], s45 offen offset:0
buffer_load_dwordx4 a[116:119], v1, s[8:11], s45 offen offset:1024
buffer_load_dwordx4 a[120:123], v1, s[8:11], s45 offen offset:2048
buffer_load_dwordx4 a[124:127], v1, s[8:11], s45 offen offset:3072
buffer_load_dwordx4 a[96:99], v1, s[8:11], s44 offen offset:0
buffer_load_dwordx4 a[100:103], v1, s[8:11], s44 offen offset:1024
buffer_load_dwordx4 a[104:107], v1, s[8:11], s44 offen offset:2048
buffer_load_dwordx4 a[108:111], v1, s[8:11], s44 offen offset:3072
s_add_u32 s44, s44, 4096
s_add_u32 s45, s45, 4096
s_waitcnt vmcnt(35)
v_mfma_f32_16x16x32_bf16 a[0:3], v[28:31], v[12:15], a[0:3]
s_waitcnt vmcnt(34)
v_mfma_f32_16x16x32_bf16 a[4:7], v[28:31], v[16:19], a[4:7]
s_waitcnt vmcnt(33)
v_mfma_f32_16x16x32_bf16 a[8:11], v[28:31], v[20:23], a[8:11]
s_waitcnt vmcnt(32)
v_mfma_f32_16x16x32_bf16 a[12:15], v[28:31], v[24:27], a[12:15]
v_mfma_f32_16x16x32_bf16 a[16:19], v[32:35], v[12:15], a[16:19]
v_mfma_f32_16x16x32_bf16 a[20:23], v[32:35], v[16:19], a[20:23]
v_mfma_f32_16x16x32_bf16 a[24:27], v[32:35], v[20:23], a[24:27]
v_mfma_f32_16x16x32_bf16 a[28:31], v[32:35], v[24:27], a[28:31]
v_mfma_f32_16x16x32_bf16 a[32:35], v[36:39], v[12:15], a[32:35]
v_mfma_f32_16x16x32_bf16 a[36:39], v[36:39], v[16:19], a[36:39]
v_mfma_f32_16x16x32_bf16 a[40:43], v[36:39], v[20:23], a[40:43]
v_mfma_f32_16x16x32_bf16 a[44:47], v[36:39], v[24:27], a[44:47]
v_mfma_f32_16x16x32_bf16 a[48:51], v[40:43], v[12:15], a[48:51]
v_mfma_f32_16x16x32_bf16 a[52:55], v[40:43], v[16:19], a[52:55]
v_mfma_f32_16x16x32_bf16 a[56:59], v[40:43], v[20:23], a[56:59]
v_mfma_f32_16x16x32_bf16 a[60:63], v[40:43], v[24:27], a[60:63]
buffer_load_dwordx4 v[28:31], v1, s[8:11], s45 offen offset:0
buffer_load_dwordx4 v[32:35], v1, s[8:11], s45 offen offset:1024
buffer_load_dwordx4 v[36:39], v1, s[8:11], s45 offen offset:2048
buffer_load_dwordx4 v[40:43], v1, s[8:11], s45 offen offset:3072
buffer_load_dwordx4 v[12:15], v1, s[8:11], s44 offen offset:0
buffer_load_dwordx4 v[16:19], v1, s[8:11], s44 offen offset:1024
buffer_load_dwordx4 v[20:23], v1, s[8:11], s44 offen offset:2048
buffer_load_dwordx4 v[24:27], v1, s[8:11], s44 offen offset:3072
s_add_u32 s44, s44, 4096
s_add_u32 s45, s45, 4096
s_waitcnt vmcnt(35)
v_mfma_f32_16x16x32_bf16 a[0:3], v[60:63], v[44:47], a[0:3]
s_waitcnt vmcnt(34)
v_mfma_f32_16x16x32_bf16 a[4:7], v[60:63], v[48:51], a[4:7]
s_waitcnt vmcnt(33)
v_mfma_f32_16x16x32_bf16 a[8:11], v[60:63], v[52:55], a[8:11]
s_waitcnt vmcnt(32)
v_mfma_f32_16x16x32_bf16 a[12:15], v[60:63], v[56:59], a[12:15]
v_mfma_f32_16x16x32_bf16 a[16:19], v[64:67], v[44:47], a[16:19]
v_mfma_f32_16x16x32_bf16 a[20:23], v[64:67], v[48:51], a[20:23]
v_mfma_f32_16x16x32_bf16 a[24:27], v[64:67], v[52:55], a[24:27]
v_mfma_f32_16x16x32_bf16 a[28:31], v[64:67], v[56:59], a[28:31]
v_mfma_f32_16x16x32_bf16 a[32:35], v[68:71], v[44:47], a[32:35]
v_mfma_f32_16x16x32_bf16 a[36:39], v[68:71], v[48:51], a[36:39]
v_mfma_f32_16x16x32_bf16 a[40:43], v[68:71], v[52:55], a[40:43]
v_mfma_f32_16x16x32_bf16 a[44:47], v[68:71], v[56:59], a[44:47]
v_mfma_f32_16x16x32_bf16 a[48:51], v[72:75], v[44:47], a[48:51]
v_mfma_f32_16x16x32_bf16 a[52:55], v[72:75], v[48:51], a[52:55]
v_mfma_f32_16x16x32_bf16 a[56:59], v[72:75], v[52:55], a[56:59]
v_mfma_f32_16x16x32_bf16 a[60:63], v[72:75], v[56:59], a[60:63]
buffer_load_dwordx4 v[60:63], v1, s[8:11], s45 offen offset:0
buffer_load_dwordx4 v[64:67], v1, s[8:11], s45 offen offset:1024
buffer_load_dwordx4 v[68:71], v1, s[8:11], s45 offen offset:2048
buffer_load_dwordx4 v[72:75], v1, s[8:11], s45 offen offset:3072
buffer_load_dwordx4 v[44:47], v1, s[8:11], s44 offen offset:0
buffer_load_dwordx4 v[48:51], v1, s[8:11], s44 offen offset:1024
buffer_load_dwordx4 v[52:55], v1, s[8:11], s44 offen offset:2048
buffer_load_dwordx4 v[56:59], v1, s[8:11], s44 offen offset:3072
s_add_u32 s44, s44, 4096
s_add_u32 s45, s45, 4096
s_waitcnt vmcnt(35)
v_mfma_f32_16x16x32_bf16 a[0:3], a[144:147], a[128:131], a[0:3]
s_waitcnt vmcnt(34)
v_mfma_f32_16x16x32_bf16 a[4:7], a[144:147], a[132:135], a[4:7]
s_waitcnt vmcnt(33)
v_mfma_f32_16x16x32_bf16 a[8:11], a[144:147], a[136:139], a[8:11]
s_waitcnt vmcnt(32)
v_mfma_f32_16x16x32_bf16 a[12:15], a[144:147], a[140:143], a[12:15]
v_mfma_f32_16x16x32_bf16 a[16:19], a[148:151], a[128:131], a[16:19]
v_mfma_f32_16x16x32_bf16 a[20:23], a[148:151], a[132:135], a[20:23]
v_mfma_f32_16x16x32_bf16 a[24:27], a[148:151], a[136:139], a[24:27]
v_mfma_f32_16x16x32_bf16 a[28:31], a[148:151], a[140:143], a[28:31]
v_mfma_f32_16x16x32_bf16 a[32:35], v[92:95], a[128:131], a[32:35]
v_mfma_f32_16x16x32_bf16 a[36:39], v[92:95], a[132:135], a[36:39]
v_mfma_f32_16x16x32_bf16 a[40:43], v[92:95], a[136:139], a[40:43]
v_mfma_f32_16x16x32_bf16 a[44:47], v[92:95], a[140:143], a[44:47]
v_mfma_f32_16x16x32_bf16 a[48:51], v[96:99], a[128:131], a[48:51]
v_mfma_f32_16x16x32_bf16 a[52:55], v[96:99], a[132:135], a[52:55]
v_mfma_f32_16x16x32_bf16 a[56:59], v[96:99], a[136:139], a[56:59]
v_mfma_f32_16x16x32_bf16 a[60:63], v[96:99], a[140:143], a[60:63]
buffer_load_dwordx4 a[144:147], v1, s[8:11], s45 offen offset:0
buffer_load_dwordx4 a[148:151], v1, s[8:11], s45 offen offset:1024
buffer_load_dwordx4 v[92:95], v1, s[8:11], s45 offen offset:2048
buffer_load_dwordx4 v[96:99], v1, s[8:11], s45 offen offset:3072
buffer_load_dwordx4 a[128:131], v1, s[8:11], s44 offen offset:0
buffer_load_dwordx4 a[132:135], v1, s[8:11], s44 offen offset:1024
buffer_load_dwordx4 a[136:139], v1, s[8:11], s44 offen offset:2048
buffer_load_dwordx4 a[140:143], v1, s[8:11], s44 offen offset:3072
s_add_u32 s44, s44, 4096
s_add_u32 s45, s45, 4096
s_waitcnt vmcnt(35)
v_mfma_f32_16x16x32_bf16 a[0:3], a[80:83], a[64:67], a[0:3]
s_waitcnt vmcnt(34)
v_mfma_f32_16x16x32_bf16 a[4:7], a[80:83], a[68:71], a[4:7]
s_waitcnt vmcnt(33)
v_mfma_f32_16x16x32_bf16 a[8:11], a[80:83], a[72:75], a[8:11]
s_waitcnt vmcnt(32)
v_mfma_f32_16x16x32_bf16 a[12:15], a[80:83], a[76:79], a[12:15]
v_mfma_f32_16x16x32_bf16 a[16:19], a[84:87], a[64:67], a[16:19]
v_mfma_f32_16x16x32_bf16 a[20:23], a[84:87], a[68:71], a[20:23]
v_mfma_f32_16x16x32_bf16 a[24:27], a[84:87], a[72:75], a[24:27]
v_mfma_f32_16x16x32_bf16 a[28:31], a[84:87], a[76:79], a[28:31]
v_mfma_f32_16x16x32_bf16 a[32:35], a[88:91], a[64:67], a[32:35]
v_mfma_f32_16x16x32_bf16 a[36:39], a[88:91], a[68:71], a[36:39]
v_mfma_f32_16x16x32_bf16 a[40:43], a[88:91], a[72:75], a[40:43]
v_mfma_f32_16x16x32_bf16 a[44:47], a[88:91], a[76:79], a[44:47]
v_mfma_f32_16x16x32_bf16 a[48:51], a[92:95], a[64:67], a[48:51]
v_mfma_f32_16x16x32_bf16 a[52:55], a[92:95], a[68:71], a[52:55]
v_mfma_f32_16x16x32_bf16 a[56:59], a[92:95], a[72:75], a[56:59]
v_mfma_f32_16x16x32_bf16 a[60:63], a[92:95], a[76:79], a[60:63]
buffer_load_dwordx4 a[80:83], v1, s[8:11], s45 offen offset:0
buffer_load_dwordx4 a[84:87], v1, s[8:11], s45 offen offset:1024
buffer_load_dwordx4 a[88:91], v1, s[8:11], s45 offen offset:2048
buffer_load_dwordx4 a[92:95], v1, s[8:11], s45 offen offset:3072
buffer_load_dwordx4 a[64:67], v1, s[8:11], s44 offen offset:0
buffer_load_dwordx4 a[68:71], v1, s[8:11], s44 offen offset:1024
buffer_load_dwordx4 a[72:75], v1, s[8:11], s44 offen offset:2048
buffer_load_dwordx4 a[76:79], v1, s[8:11], s44 offen offset:3072
s_add_u32 s44, s44, 4096
s_add_u32 s45, s45, 4096
s_waitcnt vmcnt(35)
v_mfma_f32_16x16x32_bf16 a[0:3], a[112:115], a[96:99], a[0:3]
s_waitcnt vmcnt(34)
v_mfma_f32_16x16x32_bf16 a[4:7], a[112:115], a[100:103], a[4:7]
s_waitcnt vmcnt(33)
v_mfma_f32_16x16x32_bf16 a[8:11], a[112:115], a[104:107], a[8:11]
s_waitcnt vmcnt(32)
v_mfma_f32_16x16x32_bf16 a[12:15], a[112:115], a[108:111], a[12:15]
v_mfma_f32_16x16x32_bf16 a[16:19], a[116:119], a[96:99], a[16:19]
v_mfma_f32_16x16x32_bf16 a[20:23], a[116:119], a[100:103], a[20:23]
v_mfma_f32_16x16x32_bf16 a[24:27], a[116:119], a[104:107], a[24:27]
v_mfma_f32_16x16x32_bf16 a[28:31], a[116:119], a[108:111], a[28:31]
v_mfma_f32_16x16x32_bf16 a[32:35], a[120:123], a[96:99], a[32:35]
v_mfma_f32_16x16x32_bf16 a[36:39], a[120:123], a[100:103], a[36:39]
v_mfma_f32_16x16x32_bf16 a[40:43], a[120:123], a[104:107], a[40:43]
v_mfma_f32_16x16x32_bf16 a[44:47], a[120:123], a[108:111], a[44:47]
v_mfma_f32_16x16x32_bf16 a[48:51], a[124:127], a[96:99], a[48:51]
v_mfma_f32_16x16x32_bf16 a[52:55], a[124:127], a[100:103], a[52:55]
v_mfma_f32_16x16x32_bf16 a[56:59], a[124:127], a[104:107], a[56:59]
v_mfma_f32_16x16x32_bf16 a[60:63], a[124:127], a[108:111], a[60:63]
buffer_load_dwordx4 a[112:115], v1, s[8:11], s45 offen offset:0
buffer_load_dwordx4 a[116:119], v1, s[8:11], s45 offen offset:1024
buffer_load_dwordx4 a[120:123], v1, s[8:11], s45 offen offset:2048
buffer_load_dwordx4 a[124:127], v1, s[8:11], s45 offen offset:3072
buffer_load_dwordx4 a[96:99], v1, s[8:11], s44 offen offset:0
buffer_load_dwordx4 a[100:103], v1, s[8:11], s44 offen offset:1024
buffer_load_dwordx4 a[104:107], v1, s[8:11], s44 offen offset:2048
buffer_load_dwordx4 a[108:111], v1, s[8:11], s44 offen offset:3072
s_add_u32 s44, s44, 4096
s_add_u32 s45, s45, 4096
s_waitcnt vmcnt(35)
v_mfma_f32_16x16x32_bf16 a[0:3], v[28:31], v[12:15], a[0:3]
s_waitcnt vmcnt(34)
v_mfma_f32_16x16x32_bf16 a[4:7], v[28:31], v[16:19], a[4:7]
s_waitcnt vmcnt(33)
v_mfma_f32_16x16x32_bf16 a[8:11], v[28:31], v[20:23], a[8:11]
s_waitcnt vmcnt(32)
v_mfma_f32_16x16x32_bf16 a[12:15], v[28:31], v[24:27], a[12:15]
v_mfma_f32_16x16x32_bf16 a[16:19], v[32:35], v[12:15], a[16:19]
v_mfma_f32_16x16x32_bf16 a[20:23], v[32:35], v[16:19], a[20:23]
v_mfma_f32_16x16x32_bf16 a[24:27], v[32:35], v[20:23], a[24:27]
v_mfma_f32_16x16x32_bf16 a[28:31], v[32:35], v[24:27], a[28:31]
v_mfma_f32_16x16x32_bf16 a[32:35], v[36:39], v[12:15], a[32:35]
v_mfma_f32_16x16x32_bf16 a[36:39], v[36:39], v[16:19], a[36:39]
v_mfma_f32_16x16x32_bf16 a[40:43], v[36:39], v[20:23], a[40:43]
v_mfma_f32_16x16x32_bf16 a[44:47], v[36:39], v[24:27], a[44:47]
v_mfma_f32_16x16x32_bf16 a[48:51], v[40:43], v[12:15], a[48:51]
v_mfma_f32_16x16x32_bf16 a[52:55], v[40:43], v[16:19], a[52:55]
v_mfma_f32_16x16x32_bf16 a[56:59], v[40:43], v[20:23], a[56:59]
v_mfma_f32_16x16x32_bf16 a[60:63], v[40:43], v[24:27], a[60:63]
buffer_load_dwordx4 v[28:31], v1, s[8:11], s45 offen offset:0
buffer_load_dwordx4 v[32:35], v1, s[8:11], s45 offen offset:1024
buffer_load_dwordx4 v[36:39], v1, s[8:11], s45 offen offset:2048
buffer_load_dwordx4 v[40:43], v1, s[8:11], s45 offen offset:3072
buffer_load_dwordx4 v[12:15], v1, s[8:11], s44 offen offset:0
buffer_load_dwordx4 v[16:19], v1, s[8:11], s44 offen offset:1024
buffer_load_dwordx4 v[20:23], v1, s[8:11], s44 offen offset:2048
buffer_load_dwordx4 v[24:27], v1, s[8:11], s44 offen offset:3072
s_add_u32 s44, s44, 4096
s_add_u32 s45, s45, 4096
s_waitcnt vmcnt(35)
v_mfma_f32_16x16x32_bf16 a[0:3], v[60:63], v[44:47], a[0:3]
s_waitcnt vmcnt(34)
v_mfma_f32_16x16x32_bf16 a[4:7], v[60:63], v[48:51], a[4:7]
s_waitcnt vmcnt(33)
v_mfma_f32_16x16x32_bf16 a[8:11], v[60:63], v[52:55], a[8:11]
s_waitcnt vmcnt(32)
v_mfma_f32_16x16x32_bf16 a[12:15], v[60:63], v[56:59], a[12:15]
v_mfma_f32_16x16x32_bf16 a[16:19], v[64:67], v[44:47], a[16:19]
v_mfma_f32_16x16x32_bf16 a[20:23], v[64:67], v[48:51], a[20:23]
v_mfma_f32_16x16x32_bf16 a[24:27], v[64:67], v[52:55], a[24:27]
v_mfma_f32_16x16x32_bf16 a[28:31], v[64:67], v[56:59], a[28:31]
v_mfma_f32_16x16x32_bf16 a[32:35], v[68:71], v[44:47], a[32:35]
v_mfma_f32_16x16x32_bf16 a[36:39], v[68:71], v[48:51], a[36:39]
v_mfma_f32_16x16x32_bf16 a[40:43], v[68:71], v[52:55], a[40:43]
v_mfma_f32_16x16x32_bf16 a[44:47], v[68:71], v[56:59], a[44:47]
v_mfma_f32_16x16x32_bf16 a[48:51], v[72:75], v[44:47], a[48:51]
v_mfma_f32_16x16x32_bf16 a[52:55], v[72:75], v[48:51], a[52:55]
v_mfma_f32_16x16x32_bf16 a[56:59], v[72:75], v[52:55], a[56:59]
v_mfma_f32_16x16x32_bf16 a[60:63], v[72:75], v[56:59], a[60:63]
buffer_load_dwordx4 v[60:63], v1, s[8:11], s45 offen offset:0
buffer_load_dwordx4 v[64:67], v1, s[8:11], s45 offen offset:1024
buffer_load_dwordx4 v[68:71], v1, s[8:11], s45 offen offset:2048
buffer_load_dwordx4 v[72:75], v1, s[8:11], s45 offen offset:3072
buffer_load_dwordx4 v[44:47], v1, s[8:11], s44 offen offset:0
buffer_load_dwordx4 v[48:51], v1, s[8:11], s44 offen offset:1024
buffer_load_dwordx4 v[52:55], v1, s[8:11], s44 offen offset:2048
buffer_load_dwordx4 v[56:59], v1, s[8:11], s44 offen offset:3072
s_add_u32 s44, s44, 4096
s_add_u32 s45, s45, 4096
s_waitcnt vmcnt(35)
v_mfma_f32_16x16x32_bf16 a[0:3], a[144:147], a[128:131], a[0:3]
s_waitcnt vmcnt(34)
v_mfma_f32_16x16x32_bf16 a[4:7], a[144:147], a[132:135], a[4:7]
s_waitcnt vmcnt(33)
v_mfma_f32_16x16x32_bf16 a[8:11], a[144:147], a[136:139], a[8:11]
s_waitcnt vmcnt(32)
v_mfma_f32_16x16x32_bf16 a[12:15], a[144:147], a[140:143], a[12:15]
v_mfma_f32_16x16x32_bf16 a[16:19], a[148:151], a[128:131], a[16:19]
v_mfma_f32_16x16x32_bf16 a[20:23], a[148:151], a[132:135], a[20:23]
v_mfma_f32_16x16x32_bf16 a[24:27], a[148:151], a[136:139], a[24:27]
v_mfma_f32_16x16x32_bf16 a[28:31], a[148:151], a[140:143], a[28:31]
v_mfma_f32_16x16x32_bf16 a[32:35], v[92:95], a[128:131], a[32:35]
v_mfma_f32_16x16x32_bf16 a[36:39], v[92:95], a[132:135], a[36:39]
v_mfma_f32_16x16x32_bf16 a[40:43], v[92:95], a[136:139], a[40:43]
v_mfma_f32_16x16x32_bf16 a[44:47], v[92:95], a[140:143], a[44:47]
v_mfma_f32_16x16x32_bf16 a[48:51], v[96:99], a[128:131], a[48:51]
v_mfma_f32_16x16x32_bf16 a[52:55], v[96:99], a[132:135], a[52:55]
v_mfma_f32_16x16x32_bf16 a[56:59], v[96:99], a[136:139], a[56:59]
v_mfma_f32_16x16x32_bf16 a[60:63], v[96:99], a[140:143], a[60:63]
buffer_load_dwordx4 a[144:147], v1, s[8:11], s45 offen offset:0
buffer_load_dwordx4 a[148:151], v1, s[8:11], s45 offen offset:1024
buffer_load_dwordx4 v[92:95], v1, s[8:11], s45 offen offset:2048
buffer_load_dwordx4 v[96:99], v1, s[8:11], s45 offen offset:3072
buffer_load_dwordx4 a[128:131], v1, s[8:11], s44 offen offset:0
buffer_load_dwordx4 a[132:135], v1, s[8:11], s44 offen offset:1024
buffer_load_dwordx4 a[136:139], v1, s[8:11], s44 offen offset:2048
buffer_load_dwordx4 a[140:143], v1, s[8:11], s44 offen offset:3072
s_add_u32 s44, s44, 4096
s_add_u32 s45, s45, 4096
s_waitcnt vmcnt(35)
v_mfma_f32_16x16x32_bf16 a[0:3], a[80:83], a[64:67], a[0:3]
s_waitcnt vmcnt(34)
v_mfma_f32_16x16x32_bf16 a[4:7], a[80:83], a[68:71], a[4:7]
s_waitcnt vmcnt(33)
v_mfma_f32_16x16x32_bf16 a[8:11], a[80:83], a[72:75], a[8:11]
s_waitcnt vmcnt(32)
v_mfma_f32_16x16x32_bf16 a[12:15], a[80:83], a[76:79], a[12:15]
v_mfma_f32_16x16x32_bf16 a[16:19], a[84:87], a[64:67], a[16:19]
v_mfma_f32_16x16x32_bf16 a[20:23], a[84:87], a[68:71], a[20:23]
v_mfma_f32_16x16x32_bf16 a[24:27], a[84:87], a[72:75], a[24:27]
v_mfma_f32_16x16x32_bf16 a[28:31], a[84:87], a[76:79], a[28:31]
v_mfma_f32_16x16x32_bf16 a[32:35], a[88:91], a[64:67], a[32:35]
v_mfma_f32_16x16x32_bf16 a[36:39], a[88:91], a[68:71], a[36:39]
v_mfma_f32_16x16x32_bf16 a[40:43], a[88:91], a[72:75], a[40:43]
v_mfma_f32_16x16x32_bf16 a[44:47], a[88:91], a[76:79], a[44:47]
v_mfma_f32_16x16x32_bf16 a[48:51], a[92:95], a[64:67], a[48:51]
v_mfma_f32_16x16x32_bf16 a[52:55], a[92:95], a[68:71], a[52:55]
v_mfma_f32_16x16x32_bf16 a[56:59], a[92:95], a[72:75], a[56:59]
v_mfma_f32_16x16x32_bf16 a[60:63], a[92:95], a[76:79], a[60:63]
buffer_load_dwordx4 a[80:83], v1, s[8:11], s45 offen offset:0
buffer_load_dwordx4 a[84:87], v1, s[8:11], s45 offen offset:1024
buffer_load_dwordx4 a[88:91], v1, s[8:11], s45 offen offset:2048
buffer_load_dwordx4 a[92:95], v1, s[8:11], s45 offen offset:3072
buffer_load_dwordx4 a[64:67], v1, s[8:11], s44 offen offset:0
buffer_load_dwordx4 a[68:71], v1, s[8:11], s44 offen offset:1024
buffer_load_dwordx4 a[72:75], v1, s[8:11], s44 offen offset:2048
buffer_load_dwordx4 a[76:79], v1, s[8:11], s44 offen offset:3072
s_add_u32 s44, s44, 4096
s_add_u32 s45, s45, 4096
s_waitcnt vmcnt(35)
v_mfma_f32_16x16x32_bf16 a[0:3], a[112:115], a[96:99], a[0:3]
s_waitcnt vmcnt(34)
v_mfma_f32_16x16x32_bf16 a[4:7], a[112:115], a[100:103], a[4:7]
s_waitcnt vmcnt(33)
v_mfma_f32_16x16x32_bf16 a[8:11], a[112:115], a[104:107], a[8:11]
s_waitcnt vmcnt(32)
v_mfma_f32_16x16x32_bf16 a[12:15], a[112:115], a[108:111], a[12:15]
v_mfma_f32_16x16x32_bf16 a[16:19], a[116:119], a[96:99], a[16:19]
v_mfma_f32_16x16x32_bf16 a[20:23], a[116:119], a[100:103], a[20:23]
v_mfma_f32_16x16x32_bf16 a[24:27], a[116:119], a[104:107], a[24:27]
v_mfma_f32_16x16x32_bf16 a[28:31], a[116:119], a[108:111], a[28:31]
v_mfma_f32_16x16x32_bf16 a[32:35], a[120:123], a[96:99], a[32:35]
v_mfma_f32_16x16x32_bf16 a[36:39], a[120:123], a[100:103], a[36:39]
v_mfma_f32_16x16x32_bf16 a[40:43], a[120:123], a[104:107], a[40:43]
v_mfma_f32_16x16x32_bf16 a[44:47], a[120:123], a[108:111], a[44:47]
v_mfma_f32_16x16x32_bf16 a[48:51], a[124:127], a[96:99], a[48:51]
v_mfma_f32_16x16x32_bf16 a[52:55], a[124:127], a[100:103], a[52:55]
v_mfma_f32_16x16x32_bf16 a[56:59], a[124:127], a[104:107], a[56:59]
v_mfma_f32_16x16x32_bf16 a[60:63], a[124:127], a[108:111], a[60:63]
buffer_load_dwordx4 a[112:115], v1, s[8:11], s45 offen offset:0
buffer_load_dwordx4 a[116:119], v1, s[8:11], s45 offen offset:1024
buffer_load_dwordx4 a[120:123], v1, s[8:11], s45 offen offset:2048
buffer_load_dwordx4 a[124:127], v1, s[8:11], s45 offen offset:3072
buffer_load_dwordx4 a[96:99], v1, s[8:11], s44 offen offset:0
buffer_load_dwordx4 a[100:103], v1, s[8:11], s44 offen offset:1024
buffer_load_dwordx4 a[104:107], v1, s[8:11], s44 offen offset:2048
buffer_load_dwordx4 a[108:111], v1, s[8:11], s44 offen offset:3072
s_add_u32 s44, s44, 4096
s_add_u32 s45, s45, 4096
s_waitcnt vmcnt(35)
v_mfma_f32_16x16x32_bf16 a[0:3], v[28:31], v[12:15], a[0:3]
s_waitcnt vmcnt(34)
v_mfma_f32_16x16x32_bf16 a[4:7], v[28:31], v[16:19], a[4:7]
s_waitcnt vmcnt(33)
v_mfma_f32_16x16x32_bf16 a[8:11], v[28:31], v[20:23], a[8:11]
s_waitcnt vmcnt(32)
v_mfma_f32_16x16x32_bf16 a[12:15], v[28:31], v[24:27], a[12:15]
v_mfma_f32_16x16x32_bf16 a[16:19], v[32:35], v[12:15], a[16:19]
v_mfma_f32_16x16x32_bf16 a[20:23], v[32:35], v[16:19], a[20:23]
v_mfma_f32_16x16x32_bf16 a[24:27], v[32:35], v[20:23], a[24:27]
v_mfma_f32_16x16x32_bf16 a[28:31], v[32:35], v[24:27], a[28:31]
v_mfma_f32_16x16x32_bf16 a[32:35], v[36:39], v[12:15], a[32:35]
v_mfma_f32_16x16x32_bf16 a[36:39], v[36:39], v[16:19], a[36:39]
v_mfma_f32_16x16x32_bf16 a[40:43], v[36:39], v[20:23], a[40:43]
v_mfma_f32_16x16x32_bf16 a[44:47], v[36:39], v[24:27], a[44:47]
v_mfma_f32_16x16x32_bf16 a[48:51], v[40:43], v[12:15], a[48:51]
v_mfma_f32_16x16x32_bf16 a[52:55], v[40:43], v[16:19], a[52:55]
v_mfma_f32_16x16x32_bf16 a[56:59], v[40:43], v[20:23], a[56:59]
v_mfma_f32_16x16x32_bf16 a[60:63], v[40:43], v[24:27], a[60:63]
buffer_load_dwordx4 v[28:31], v1, s[8:11], s45 offen offset:0
buffer_load_dwordx4 v[32:35], v1, s[8:11], s45 offen offset:1024
buffer_load_dwordx4 v[36:39], v1, s[8:11], s45 offen offset:2048
buffer_load_dwordx4 v[40:43], v1, s[8:11], s45 offen offset:3072
buffer_load_dwordx4 v[12:15], v1, s[8:11], s44 offen offset:0
buffer_load_dwordx4 v[16:19], v1, s[8:11], s44 offen offset:1024
buffer_load_dwordx4 v[20:23], v1, s[8:11], s44 offen offset:2048
buffer_load_dwordx4 v[24:27], v1, s[8:11], s44 offen offset:3072
s_add_u32 s44, s44, 4096
s_add_u32 s45, s45, 4096
s_waitcnt vmcnt(35)
v_mfma_f32_16x16x32_bf16 a[0:3], v[60:63], v[44:47], a[0:3]
s_waitcnt vmcnt(34)
v_mfma_f32_16x16x32_bf16 a[4:7], v[60:63], v[48:51], a[4:7]
s_waitcnt vmcnt(33)
v_mfma_f32_16x16x32_bf16 a[8:11], v[60:63], v[52:55], a[8:11]
s_waitcnt vmcnt(32)
v_mfma_f32_16x16x32_bf16 a[12:15], v[60:63], v[56:59], a[12:15]
v_mfma_f32_16x16x32_bf16 a[16:19], v[64:67], v[44:47], a[16:19]
v_mfma_f32_16x16x32_bf16 a[20:23], v[64:67], v[48:51], a[20:23]
v_mfma_f32_16x16x32_bf16 a[24:27], v[64:67], v[52:55], a[24:27]
v_mfma_f32_16x16x32_bf16 a[28:31], v[64:67], v[56:59], a[28:31]
v_mfma_f32_16x16x32_bf16 a[32:35], v[68:71], v[44:47], a[32:35]
v_mfma_f32_16x16x32_bf16 a[36:39], v[68:71], v[48:51], a[36:39]
v_mfma_f32_16x16x32_bf16 a[40:43], v[68:71], v[52:55], a[40:43]
v_mfma_f32_16x16x32_bf16 a[44:47], v[68:71], v[56:59], a[44:47]
v_mfma_f32_16x16x32_bf16 a[48:51], v[72:75], v[44:47], a[48:51]
v_mfma_f32_16x16x32_bf16 a[52:55], v[72:75], v[48:51], a[52:55]
v_mfma_f32_16x16x32_bf16 a[56:59], v[72:75], v[52:55], a[56:59]
v_mfma_f32_16x16x32_bf16 a[60:63], v[72:75], v[56:59], a[60:63]
buffer_load_dwordx4 v[60:63], v1, s[8:11], s45 offen offset:0
buffer_load_dwordx4 v[64:67], v1, s[8:11], s45 offen offset:1024
buffer_load_dwordx4 v[68:71], v1, s[8:11], s45 offen offset:2048
buffer_load_dwordx4 v[72:75], v1, s[8:11], s45 offen offset:3072
buffer_load_dwordx4 v[44:47], v1, s[8:11], s44 offen offset:0
buffer_load_dwordx4 v[48:51], v1, s[8:11], s44 offen offset:1024
buffer_load_dwordx4 v[52:55], v1, s[8:11], s44 offen offset:2048
buffer_load_dwordx4 v[56:59], v1, s[8:11], s44 offen offset:3072
s_add_u32 s44, s44, 4096
s_add_u32 s45, s45, 4096
s_waitcnt vmcnt(35)
v_mfma_f32_16x16x32_bf16 a[0:3], a[144:147], a[128:131], a[0:3]
s_waitcnt vmcnt(34)
v_mfma_f32_16x16x32_bf16 a[4:7], a[144:147], a[132:135], a[4:7]
s_waitcnt vmcnt(33)
v_mfma_f32_16x16x32_bf16 a[8:11], a[144:147], a[136:139], a[8:11]
s_waitcnt vmcnt(32)
v_mfma_f32_16x16x32_bf16 a[12:15], a[144:147], a[140:143], a[12:15]
v_mfma_f32_16x16x32_bf16 a[16:19], a[148:151], a[128:131], a[16:19]
v_mfma_f32_16x16x32_bf16 a[20:23], a[148:151], a[132:135], a[20:23]
v_mfma_f32_16x16x32_bf16 a[24:27], a[148:151], a[136:139], a[24:27]
v_mfma_f32_16x16x32_bf16 a[28:31], a[148:151], a[140:143], a[28:31]
v_mfma_f32_16x16x32_bf16 a[32:35], v[92:95], a[128:131], a[32:35]
v_mfma_f32_16x16x32_bf16 a[36:39], v[92:95], a[132:135], a[36:39]
v_mfma_f32_16x16x32_bf16 a[40:43], v[92:95], a[136:139], a[40:43]
v_mfma_f32_16x16x32_bf16 a[44:47], v[92:95], a[140:143], a[44:47]
v_mfma_f32_16x16x32_bf16 a[48:51], v[96:99], a[128:131], a[48:51]
v_mfma_f32_16x16x32_bf16 a[52:55], v[96:99], a[132:135], a[52:55]
v_mfma_f32_16x16x32_bf16 a[56:59], v[96:99], a[136:139], a[56:59]
v_mfma_f32_16x16x32_bf16 a[60:63], v[96:99], a[140:143], a[60:63]
buffer_load_dwordx4 a[144:147], v1, s[8:11], s45 offen offset:0
buffer_load_dwordx4 a[148:151], v1, s[8:11], s45 offen offset:1024
buffer_load_dwordx4 v[92:95], v1, s[8:11], s45 offen offset:2048
buffer_load_dwordx4 v[96:99], v1, s[8:11], s45 offen offset:3072
buffer_load_dwordx4 a[128:131], v1, s[8:11], s44 offen offset:0
buffer_load_dwordx4 a[132:135], v1, s[8:11], s44 offen offset:1024
buffer_load_dwordx4 a[136:139], v1, s[8:11], s44 offen offset:2048
buffer_load_dwordx4 a[140:143], v1, s[8:11], s44 offen offset:3072
s_add_u32 s44, s44, 4096
s_add_u32 s45, s45, 4096
s_waitcnt vmcnt(35)
v_mfma_f32_16x16x32_bf16 a[0:3], a[80:83], a[64:67], a[0:3]
s_waitcnt vmcnt(34)
v_mfma_f32_16x16x32_bf16 a[4:7], a[80:83], a[68:71], a[4:7]
s_waitcnt vmcnt(33)
v_mfma_f32_16x16x32_bf16 a[8:11], a[80:83], a[72:75], a[8:11]
s_waitcnt vmcnt(32)
v_mfma_f32_16x16x32_bf16 a[12:15], a[80:83], a[76:79], a[12:15]
v_mfma_f32_16x16x32_bf16 a[16:19], a[84:87], a[64:67], a[16:19]
v_mfma_f32_16x16x32_bf16 a[20:23], a[84:87], a[68:71], a[20:23]
v_mfma_f32_16x16x32_bf16 a[24:27], a[84:87], a[72:75], a[24:27]
v_mfma_f32_16x16x32_bf16 a[28:31], a[84:87], a[76:79], a[28:31]
v_mfma_f32_16x16x32_bf16 a[32:35], a[88:91], a[64:67], a[32:35]
v_mfma_f32_16x16x32_bf16 a[36:39], a[88:91], a[68:71], a[36:39]
v_mfma_f32_16x16x32_bf16 a[40:43], a[88:91], a[72:75], a[40:43]
v_mfma_f32_16x16x32_bf16 a[44:47], a[88:91], a[76:79], a[44:47]
v_mfma_f32_16x16x32_bf16 a[48:51], a[92:95], a[64:67], a[48:51]
v_mfma_f32_16x16x32_bf16 a[52:55], a[92:95], a[68:71], a[52:55]
v_mfma_f32_16x16x32_bf16 a[56:59], a[92:95], a[72:75], a[56:59]
v_mfma_f32_16x16x32_bf16 a[60:63], a[92:95], a[76:79], a[60:63]
buffer_load_dwordx4 a[80:83], v1, s[8:11], s45 offen offset:0
buffer_load_dwordx4 a[84:87], v1, s[8:11], s45 offen offset:1024
buffer_load_dwordx4 a[88:91], v1, s[8:11], s45 offen offset:2048
buffer_load_dwordx4 a[92:95], v1, s[8:11], s45 offen offset:3072
buffer_load_dwordx4 a[64:67], v1, s[8:11], s44 offen offset:0
buffer_load_dwordx4 a[68:71], v1, s[8:11], s44 offen offset:1024
buffer_load_dwordx4 a[72:75], v1, s[8:11], s44 offen offset:2048
buffer_load_dwordx4 a[76:79], v1, s[8:11], s44 offen offset:3072
s_add_u32 s44, s44, 4096
s_add_u32 s45, s45, 4096
s_waitcnt vmcnt(35)
v_mfma_f32_16x16x32_bf16 a[0:3], a[112:115], a[96:99], a[0:3]
s_waitcnt vmcnt(34)
v_mfma_f32_16x16x32_bf16 a[4:7], a[112:115], a[100:103], a[4:7]
s_waitcnt vmcnt(33)
v_mfma_f32_16x16x32_bf16 a[8:11], a[112:115], a[104:107], a[8:11]
s_waitcnt vmcnt(32)
v_mfma_f32_16x16x32_bf16 a[12:15], a[112:115], a[108:111], a[12:15]
v_mfma_f32_16x16x32_bf16 a[16:19], a[116:119], a[96:99], a[16:19]
v_mfma_f32_16x16x32_bf16 a[20:23], a[116:119], a[100:103], a[20:23]
v_mfma_f32_16x16x32_bf16 a[24:27], a[116:119], a[104:107], a[24:27]
v_mfma_f32_16x16x32_bf16 a[28:31], a[116:119], a[108:111], a[28:31]
v_mfma_f32_16x16x32_bf16 a[32:35], a[120:123], a[96:99], a[32:35]
v_mfma_f32_16x16x32_bf16 a[36:39], a[120:123], a[100:103], a[36:39]
v_mfma_f32_16x16x32_bf16 a[40:43], a[120:123], a[104:107], a[40:43]
v_mfma_f32_16x16x32_bf16 a[44:47], a[120:123], a[108:111], a[44:47]
v_mfma_f32_16x16x32_bf16 a[48:51], a[124:127], a[96:99], a[48:51]
v_mfma_f32_16x16x32_bf16 a[52:55], a[124:127], a[100:103], a[52:55]
v_mfma_f32_16x16x32_bf16 a[56:59], a[124:127], a[104:107], a[56:59]
v_mfma_f32_16x16x32_bf16 a[60:63], a[124:127], a[108:111], a[60:63]
buffer_load_dwordx4 a[112:115], v1, s[8:11], s45 offen offset:0
buffer_load_dwordx4 a[116:119], v1, s[8:11], s45 offen offset:1024
buffer_load_dwordx4 a[120:123], v1, s[8:11], s45 offen offset:2048
buffer_load_dwordx4 a[124:127], v1, s[8:11], s45 offen offset:3072
buffer_load_dwordx4 a[96:99], v1, s[8:11], s44 offen offset:0
buffer_load_dwordx4 a[100:103], v1, s[8:11], s44 offen offset:1024
buffer_load_dwordx4 a[104:107], v1, s[8:11], s44 offen offset:2048
buffer_load_dwordx4 a[108:111], v1, s[8:11], s44 offen offset:3072
s_add_u32 s44, s44, 4096
s_add_u32 s45, s45, 4096
s_waitcnt vmcnt(35)
v_mfma_f32_16x16x32_bf16 a[0:3], v[28:31], v[12:15], a[0:3]
s_waitcnt vmcnt(34)
v_mfma_f32_16x16x32_bf16 a[4:7], v[28:31], v[16:19], a[4:7]
s_waitcnt vmcnt(33)
v_mfma_f32_16x16x32_bf16 a[8:11], v[28:31], v[20:23], a[8:11]
s_waitcnt vmcnt(32)
v_mfma_f32_16x16x32_bf16 a[12:15], v[28:31], v[24:27], a[12:15]
v_mfma_f32_16x16x32_bf16 a[16:19], v[32:35], v[12:15], a[16:19]
v_mfma_f32_16x16x32_bf16 a[20:23], v[32:35], v[16:19], a[20:23]
v_mfma_f32_16x16x32_bf16 a[24:27], v[32:35], v[20:23], a[24:27]
v_mfma_f32_16x16x32_bf16 a[28:31], v[32:35], v[24:27], a[28:31]
v_mfma_f32_16x16x32_bf16 a[32:35], v[36:39], v[12:15], a[32:35]
v_mfma_f32_16x16x32_bf16 a[36:39], v[36:39], v[16:19], a[36:39]
v_mfma_f32_16x16x32_bf16 a[40:43], v[36:39], v[20:23], a[40:43]
v_mfma_f32_16x16x32_bf16 a[44:47], v[36:39], v[24:27], a[44:47]
v_mfma_f32_16x16x32_bf16 a[48:51], v[40:43], v[12:15], a[48:51]
v_mfma_f32_16x16x32_bf16 a[52:55], v[40:43], v[16:19], a[52:55]
v_mfma_f32_16x16x32_bf16 a[56:59], v[40:43], v[20:23], a[56:59]
v_mfma_f32_16x16x32_bf16 a[60:63], v[40:43], v[24:27], a[60:63]
buffer_load_dwordx4 v[28:31], v1, s[8:11], s45 offen offset:0
buffer_load_dwordx4 v[32:35], v1, s[8:11], s45 offen offset:1024
buffer_load_dwordx4 v[36:39], v1, s[8:11], s45 offen offset:2048
buffer_load_dwordx4 v[40:43], v1, s[8:11], s45 offen offset:3072
buffer_load_dwordx4 v[12:15], v1, s[8:11], s44 offen offset:0
buffer_load_dwordx4 v[16:19], v1, s[8:11], s44 offen offset:1024
buffer_load_dwordx4 v[20:23], v1, s[8:11], s44 offen offset:2048
buffer_load_dwordx4 v[24:27], v1, s[8:11], s44 offen offset:3072
s_add_u32 s44, s44, 4096
s_add_u32 s45, s45, 4096
s_waitcnt vmcnt(35)
v_mfma_f32_16x16x32_bf16 a[0:3], v[60:63], v[44:47], a[0:3]
s_waitcnt vmcnt(34)
v_mfma_f32_16x16x32_bf16 a[4:7], v[60:63], v[48:51], a[4:7]
s_waitcnt vmcnt(33)
v_mfma_f32_16x16x32_bf16 a[8:11], v[60:63], v[52:55], a[8:11]
s_waitcnt vmcnt(32)
v_mfma_f32_16x16x32_bf16 a[12:15], v[60:63], v[56:59], a[12:15]
v_mfma_f32_16x16x32_bf16 a[16:19], v[64:67], v[44:47], a[16:19]
v_mfma_f32_16x16x32_bf16 a[20:23], v[64:67], v[48:51], a[20:23]
v_mfma_f32_16x16x32_bf16 a[24:27], v[64:67], v[52:55], a[24:27]
v_mfma_f32_16x16x32_bf16 a[28:31], v[64:67], v[56:59], a[28:31]
v_mfma_f32_16x16x32_bf16 a[32:35], v[68:71], v[44:47], a[32:35]
v_mfma_f32_16x16x32_bf16 a[36:39], v[68:71], v[48:51], a[36:39]
v_mfma_f32_16x16x32_bf16 a[40:43], v[68:71], v[52:55], a[40:43]
v_mfma_f32_16x16x32_bf16 a[44:47], v[68:71], v[56:59], a[44:47]
v_mfma_f32_16x16x32_bf16 a[48:51], v[72:75], v[44:47], a[48:51]
v_mfma_f32_16x16x32_bf16 a[52:55], v[72:75], v[48:51], a[52:55]
v_mfma_f32_16x16x32_bf16 a[56:59], v[72:75], v[52:55], a[56:59]
v_mfma_f32_16x16x32_bf16 a[60:63], v[72:75], v[56:59], a[60:63]
buffer_load_dwordx4 v[60:63], v1, s[8:11], s45 offen offset:0
buffer_load_dwordx4 v[64:67], v1, s[8:11], s45 offen offset:1024
buffer_load_dwordx4 v[68:71], v1, s[8:11], s45 offen offset:2048
buffer_load_dwordx4 v[72:75], v1, s[8:11], s45 offen offset:3072
buffer_load_dwordx4 v[44:47], v1, s[8:11], s44 offen offset:0
buffer_load_dwordx4 v[48:51], v1, s[8:11], s44 offen offset:1024
buffer_load_dwordx4 v[52:55], v1, s[8:11], s44 offen offset:2048
buffer_load_dwordx4 v[56:59], v1, s[8:11], s44 offen offset:3072
s_add_u32 s44, s44, 4096
s_add_u32 s45, s45, 4096
s_waitcnt vmcnt(35)
v_mfma_f32_16x16x32_bf16 a[0:3], a[144:147], a[128:131], a[0:3]
s_waitcnt vmcnt(34)
v_mfma_f32_16x16x32_bf16 a[4:7], a[144:147], a[132:135], a[4:7]
s_waitcnt vmcnt(33)
v_mfma_f32_16x16x32_bf16 a[8:11], a[144:147], a[136:139], a[8:11]
s_waitcnt vmcnt(32)
v_mfma_f32_16x16x32_bf16 a[12:15], a[144:147], a[140:143], a[12:15]
v_mfma_f32_16x16x32_bf16 a[16:19], a[148:151], a[128:131], a[16:19]
v_mfma_f32_16x16x32_bf16 a[20:23], a[148:151], a[132:135], a[20:23]
v_mfma_f32_16x16x32_bf16 a[24:27], a[148:151], a[136:139], a[24:27]
v_mfma_f32_16x16x32_bf16 a[28:31], a[148:151], a[140:143], a[28:31]
v_mfma_f32_16x16x32_bf16 a[32:35], v[92:95], a[128:131], a[32:35]
v_mfma_f32_16x16x32_bf16 a[36:39], v[92:95], a[132:135], a[36:39]
v_mfma_f32_16x16x32_bf16 a[40:43], v[92:95], a[136:139], a[40:43]
v_mfma_f32_16x16x32_bf16 a[44:47], v[92:95], a[140:143], a[44:47]
v_mfma_f32_16x16x32_bf16 a[48:51], v[96:99], a[128:131], a[48:51]
v_mfma_f32_16x16x32_bf16 a[52:55], v[96:99], a[132:135], a[52:55]
v_mfma_f32_16x16x32_bf16 a[56:59], v[96:99], a[136:139], a[56:59]
v_mfma_f32_16x16x32_bf16 a[60:63], v[96:99], a[140:143], a[60:63]
buffer_load_dwordx4 a[144:147], v1, s[8:11], s45 offen offset:0
buffer_load_dwordx4 a[148:151], v1, s[8:11], s45 offen offset:1024
buffer_load_dwordx4 v[92:95], v1, s[8:11], s45 offen offset:2048
buffer_load_dwordx4 v[96:99], v1, s[8:11], s45 offen offset:3072
buffer_load_dwordx4 a[128:131], v1, s[8:11], s44 offen offset:0
buffer_load_dwordx4 a[132:135], v1, s[8:11], s44 offen offset:1024
buffer_load_dwordx4 a[136:139], v1, s[8:11], s44 offen offset:2048
buffer_load_dwordx4 a[140:143], v1, s[8:11], s44 offen offset:3072
s_add_u32 s44, s44, 4096
s_add_u32 s45, s45, 4096
s_waitcnt vmcnt(35)
v_mfma_f32_16x16x32_bf16 a[0:3], a[80:83], a[64:67], a[0:3]
s_waitcnt vmcnt(34)
v_mfma_f32_16x16x32_bf16 a[4:7], a[80:83], a[68:71], a[4:7]
s_waitcnt vmcnt(33)
v_mfma_f32_16x16x32_bf16 a[8:11], a[80:83], a[72:75], a[8:11]
s_waitcnt vmcnt(32)
v_mfma_f32_16x16x32_bf16 a[12:15], a[80:83], a[76:79], a[12:15]
v_mfma_f32_16x16x32_bf16 a[16:19], a[84:87], a[64:67], a[16:19]
v_mfma_f32_16x16x32_bf16 a[20:23], a[84:87], a[68:71], a[20:23]
v_mfma_f32_16x16x32_bf16 a[24:27], a[84:87], a[72:75], a[24:27]
v_mfma_f32_16x16x32_bf16 a[28:31], a[84:87], a[76:79], a[28:31]
v_mfma_f32_16x16x32_bf16 a[32:35], a[88:91], a[64:67], a[32:35]
v_mfma_f32_16x16x32_bf16 a[36:39], a[88:91], a[68:71], a[36:39]
v_mfma_f32_16x16x32_bf16 a[40:43], a[88:91], a[72:75], a[40:43]
v_mfma_f32_16x16x32_bf16 a[44:47], a[88:91], a[76:79], a[44:47]
v_mfma_f32_16x16x32_bf16 a[48:51], a[92:95], a[64:67], a[48:51]
v_mfma_f32_16x16x32_bf16 a[52:55], a[92:95], a[68:71], a[52:55]
v_mfma_f32_16x16x32_bf16 a[56:59], a[92:95], a[72:75], a[56:59]
v_mfma_f32_16x16x32_bf16 a[60:63], a[92:95], a[76:79], a[60:63]
s_cmp_lg_u32 s16, 0
s_cbranch_scc1 K3_NP
buffer_load_dword v3, v2, s[8:11], s22 offen sc1
K3_NP:
buffer_load_dwordx4 a[80:83], v1, s[8:11], s45 offen offset:0
buffer_load_dwordx4 a[84:87], v1, s[8:11], s45 offen offset:1024
buffer_load_dwordx4 a[88:91], v1, s[8:11], s45 offen offset:2048
buffer_load_dwordx4 a[92:95], v1, s[8:11], s45 offen offset:3072
buffer_load_dwordx4 a[64:67], v1, s[8:11], s44 offen offset:0
buffer_load_dwordx4 a[68:71], v1, s[8:11], s44 offen offset:1024
buffer_load_dwordx4 a[72:75], v1, s[8:11], s44 offen offset:2048
buffer_load_dwordx4 a[76:79], v1, s[8:11], s44 offen offset:3072
s_add_u32 s44, s44, 4096
s_add_u32 s45, s45, 4096
s_waitcnt vmcnt(35)
v_mfma_f32_16x16x32_bf16 a[0:3], a[112:115], a[96:99], a[0:3]
s_waitcnt vmcnt(34)
v_mfma_f32_16x16x32_bf16 a[4:7], a[112:115], a[100:103], a[4:7]
s_waitcnt vmcnt(33)
v_mfma_f32_16x16x32_bf16 a[8:11], a[112:115], a[104:107], a[8:11]
s_waitcnt vmcnt(32)
v_mfma_f32_16x16x32_bf16 a[12:15], a[112:115], a[108:111], a[12:15]
v_mfma_f32_16x16x32_bf16 a[16:19], a[116:119], a[96:99], a[16:19]
v_mfma_f32_16x16x32_bf16 a[20:23], a[116:119], a[100:103], a[20:23]
v_mfma_f32_16x16x32_bf16 a[24:27], a[116:119], a[104:107], a[24:27]
v_mfma_f32_16x16x32_bf16 a[28:31], a[116:119], a[108:111], a[28:31]
v_mfma_f32_16x16x32_bf16 a[32:35], a[120:123], a[96:99], a[32:35]
v_mfma_f32_16x16x32_bf16 a[36:39], a[120:123], a[100:103], a[36:39]
v_mfma_f32_16x16x32_bf16 a[40:43], a[120:123], a[104:107], a[40:43]
v_mfma_f32_16x16x32_bf16 a[44:47], a[120:123], a[108:111], a[44:47]
v_mfma_f32_16x16x32_bf16 a[48:51], a[124:127], a[96:99], a[48:51]
v_mfma_f32_16x16x32_bf16 a[52:55], a[124:127], a[100:103], a[52:55]
v_mfma_f32_16x16x32_bf16 a[56:59], a[124:127], a[104:107], a[56:59]
v_mfma_f32_16x16x32_bf16 a[60:63], a[124:127], a[108:111], a[60:63]
buffer_load_dwordx4 a[112:115], v1, s[8:11], s45 offen offset:0
buffer_load_dwordx4 a[116:119], v1, s[8:11], s45 offen offset:1024
buffer_load_dwordx4 a[120:123], v1, s[8:11], s45 offen offset:2048
buffer_load_dwordx4 a[124:127], v1, s[8:11], s45 offen offset:3072
buffer_load_dwordx4 a[96:99], v1, s[8:11], s44 offen offset:0
buffer_load_dwordx4 a[100:103], v1, s[8:11], s44 offen offset:1024
buffer_load_dwordx4 a[104:107], v1, s[8:11], s44 offen offset:2048
buffer_load_dwordx4 a[108:111], v1, s[8:11], s44 offen offset:3072
s_add_u32 s44, s44, 4096
s_add_u32 s45, s45, 4096
s_waitcnt vmcnt(35)
v_mfma_f32_16x16x32_bf16 a[0:3], v[28:31], v[12:15], a[0:3]
s_waitcnt vmcnt(34)
v_mfma_f32_16x16x32_bf16 a[4:7], v[28:31], v[16:19], a[4:7]
s_waitcnt vmcnt(33)
v_mfma_f32_16x16x32_bf16 a[8:11], v[28:31], v[20:23], a[8:11]
s_waitcnt vmcnt(32)
v_mfma_f32_16x16x32_bf16 a[12:15], v[28:31], v[24:27], a[12:15]
v_mfma_f32_16x16x32_bf16 a[16:19], v[32:35], v[12:15], a[16:19]
v_mfma_f32_16x16x32_bf16 a[20:23], v[32:35], v[16:19], a[20:23]
v_mfma_f32_16x16x32_bf16 a[24:27], v[32:35], v[20:23], a[24:27]
v_mfma_f32_16x16x32_bf16 a[28:31], v[32:35], v[24:27], a[28:31]
v_mfma_f32_16x16x32_bf16 a[32:35], v[36:39], v[12:15], a[32:35]
v_mfma_f32_16x16x32_bf16 a[36:39], v[36:39], v[16:19], a[36:39]
v_mfma_f32_16x16x32_bf16 a[40:43], v[36:39], v[20:23], a[40:43]
v_mfma_f32_16x16x32_bf16 a[44:47], v[36:39], v[24:27], a[44:47]
v_mfma_f32_16x16x32_bf16 a[48:51], v[40:43], v[12:15], a[48:51]
v_mfma_f32_16x16x32_bf16 a[52:55], v[40:43], v[16:19], a[52:55]
v_mfma_f32_16x16x32_bf16 a[56:59], v[40:43], v[20:23], a[56:59]
v_mfma_f32_16x16x32_bf16 a[60:63], v[40:43], v[24:27], a[60:63]
buffer_load_dwordx4 v[28:31], v1, s[8:11], s45 offen offset:0
buffer_load_dwordx4 v[32:35], v1, s[8:11], s45 offen offset:1024
buffer_load_dwordx4 v[36:39], v1, s[8:11], s45 offen offset:2048
buffer_load_dwordx4 v[40:43], v1, s[8:11], s45 offen offset:3072
buffer_load_dwordx4 v[12:15], v1, s[8:11], s44 offen offset:0
buffer_load_dwordx4 v[16:19], v1, s[8:11], s44 offen offset:1024
buffer_load_dwordx4 v[20:23], v1, s[8:11], s44 offen offset:2048
buffer_load_dwordx4 v[24:27], v1, s[8:11], s44 offen offset:3072
s_add_u32 s44, s44, 4096
s_add_u32 s45, s45, 4096
s_waitcnt vmcnt(35)
v_mfma_f32_16x16x32_bf16 a[0:3], v[60:63], v[44:47], a[0:3]
s_waitcnt vmcnt(34)
v_mfma_f32_16x16x32_bf16 a[4:7], v[60:63], v[48:51], a[4:7]
s_waitcnt vmcnt(33)
v_mfma_f32_16x16x32_bf16 a[8:11], v[60:63], v[52:55], a[8:11]
s_waitcnt vmcnt(32)
v_mfma_f32_16x16x32_bf16 a[12:15], v[60:63], v[56:59], a[12:15]
v_mfma_f32_16x16x32_bf16 a[16:19], v[64:67], v[44:47], a[16:19]
v_mfma_f32_16x16x32_bf16 a[20:23], v[64:67], v[48:51], a[20:23]
v_mfma_f32_16x16x32_bf16 a[24:27], v[64:67], v[52:55], a[24:27]
v_mfma_f32_16x16x32_bf16 a[28:31], v[64:67], v[56:59], a[28:31]
v_mfma_f32_16x16x32_bf16 a[32:35], v[68:71], v[44:47], a[32:35]
v_mfma_f32_16x16x32_bf16 a[36:39], v[68:71], v[48:51], a[36:39]
v_mfma_f32_16x16x32_bf16 a[40:43], v[68:71], v[52:55], a[40:43]
v_mfma_f32_16x16x32_bf16 a[44:47], v[68:71], v[56:59], a[44:47]
v_mfma_f32_16x16x32_bf16 a[48:51], v[72:75], v[44:47], a[48:51]
v_mfma_f32_16x16x32_bf16 a[52:55], v[72:75], v[48:51], a[52:55]
v_mfma_f32_16x16x32_bf16 a[56:59], v[72:75], v[52:55], a[56:59]
v_mfma_f32_16x16x32_bf16 a[60:63], v[72:75], v[56:59], a[60:63]
buffer_load_dwordx4 v[60:63], v1, s[8:11], s45 offen offset:0
buffer_load_dwordx4 v[64:67], v1, s[8:11], s45 offen offset:1024
buffer_load_dwordx4 v[68:71], v1, s[8:11], s45 offen offset:2048
buffer_load_dwordx4 v[72:75], v1, s[8:11], s45 offen offset:3072
buffer_load_dwordx4 v[44:47], v1, s[8:11], s44 offen offset:0
buffer_load_dwordx4 v[48:51], v1, s[8:11], s44 offen offset:1024
buffer_load_dwordx4 v[52:55], v1, s[8:11], s44 offen offset:2048
buffer_load_dwordx4 v[56:59], v1, s[8:11], s44 offen offset:3072
s_add_u32 s44, s44, 4096
s_add_u32 s45, s45, 4096
s_waitcnt vmcnt(35)
v_mfma_f32_16x16x32_bf16 a[0:3], a[144:147], a[128:131], a[0:3]
s_waitcnt vmcnt(34)
v_mfma_f32_16x16x32_bf16 a[4:7], a[144:147], a[132:135], a[4:7]
s_waitcnt vmcnt(33)
v_mfma_f32_16x16x32_bf16 a[8:11], a[144:147], a[136:139], a[8:11]
s_waitcnt vmcnt(32)
v_mfma_f32_16x16x32_bf16 a[12:15], a[144:147], a[140:143], a[12:15]
v_mfma_f32_16x16x32_bf16 a[16:19], a[148:151], a[128:131], a[16:19]
v_mfma_f32_16x16x32_bf16 a[20:23], a[148:151], a[132:135], a[20:23]
v_mfma_f32_16x16x32_bf16 a[24:27], a[148:151], a[136:139], a[24:27]
v_mfma_f32_16x16x32_bf16 a[28:31], a[148:151], a[140:143], a[28:31]
v_mfma_f32_16x16x32_bf16 a[32:35], v[92:95], a[128:131], a[32:35]
v_mfma_f32_16x16x32_bf16 a[36:39], v[92:95], a[132:135], a[36:39]
v_mfma_f32_16x16x32_bf16 a[40:43], v[92:95], a[136:139], a[40:43]
v_mfma_f32_16x16x32_bf16 a[44:47], v[92:95], a[140:143], a[44:47]
v_mfma_f32_16x16x32_bf16 a[48:51], v[96:99], a[128:131], a[48:51]
v_mfma_f32_16x16x32_bf16 a[52:55], v[96:99], a[132:135], a[52:55]
v_mfma_f32_16x16x32_bf16 a[56:59], v[96:99], a[136:139], a[56:59]
v_mfma_f32_16x16x32_bf16 a[60:63], v[96:99], a[140:143], a[60:63]
s_cmp_lg_u32 s16, 0
s_cbranch_scc1 K3_POLLED
s_waitcnt vmcnt(32)
v_cmp_eq_u32 vcc, 0, v3
s_cbranch_vccnz K3_SLOWPOLL
K3_POLLED:
s_barrier
buffer_load_dwordx4 a[144:147], v1, s[8:11], s47 offen offset:0
buffer_load_dwordx4 a[148:151], v1, s[8:11], s47 offen offset:1024
buffer_load_dwordx4 v[92:95], v1, s[8:11], s47 offen offset:2048
buffer_load_dwordx4 v[96:99], v1, s[8:11], s47 offen offset:3072
buffer_load_dwordx4 a[128:131], v1, s[8:11], s46 offen offset:0 sc1
buffer_load_dwordx4 a[132:135], v1, s[8:11], s46 offen offset:1024 sc1
buffer_load_dwordx4 a[136:139], v1, s[8:11], s46 offen offset:2048 sc1
buffer_load_dwordx4 a[140:143], v1, s[8:11], s46 offen offset:3072 sc1
s_add_u32 s46, s46, 4096
s_add_u32 s47, s47, 4096
s_waitcnt vmcnt(35)
v_mfma_f32_16x16x32_bf16 a[0:3], a[80:83], a[64:67], a[0:3]
s_waitcnt vmcnt(34)
v_mfma_f32_16x16x32_bf16 a[4:7], a[80:83], a[68:71], a[4:7]
s_waitcnt vmcnt(33)
v_mfma_f32_16x16x32_bf16 a[8:11], a[80:83], a[72:75], a[8:11]
s_waitcnt vmcnt(32)
v_mfma_f32_16x16x32_bf16 a[12:15], a[80:83], a[76:79], a[12:15]
v_mfma_f32_16x16x32_bf16 a[16:19], a[84:87], a[64:67], a[16:19]
v_mfma_f32_16x16x32_bf16 a[20:23], a[84:87], a[68:71], a[20:23]
v_mfma_f32_16x16x32_bf16 a[24:27], a[84:87], a[72:75], a[24:27]
v_mfma_f32_16x16x32_bf16 a[28:31], a[84:87], a[76:79], a[28:31]
v_mfma_f32_16x16x32_bf16 a[32:35], a[88:91], a[64:67], a[32:35]
v_mfma_f32_16x16x32_bf16 a[36:39], a[88:91], a[68:71], a[36:39]
v_mfma_f32_16x16x32_bf16 a[40:43], a[88:91], a[72:75], a[40:43]
v_mfma_f32_16x16x32_bf16 a[44:47], a[88:91], a[76:79], a[44:47]
v_mfma_f32_16x16x32_bf16 a[48:51], a[92:95], a[64:67], a[48:51]
v_mfma_f32_16x16x32_bf16 a[52:55], a[92:95], a[68:71], a[52:55]
v_mfma_f32_16x16x32_bf16 a[56:59], a[92:95], a[72:75], a[56:59]
v_mfma_f32_16x16x32_bf16 a[60:63], a[92:95], a[76:79], a[60:63]
s_waitcnt vmcnt(27)
v_mfma_f32_16x16x32_bf16 a[0:3], a[112:115], a[96:99], a[0:3]
s_waitcnt vmcnt(26)
v_mfma_f32_16x16x32_bf16 a[4:7], a[112:115], a[100:103], a[4:7]
s_waitcnt vmcnt(25)
v_mfma_f32_16x16x32_bf16 a[8:11], a[112:115], a[104:107], a[8:11]
s_waitcnt vmcnt(24)
v_mfma_f32_16x16x32_bf16 a[12:15], a[112:115], a[108:111], a[12:15]
v_mfma_f32_16x16x32_bf16 a[16:19], a[116:119], a[96:99], a[16:19]
v_mfma_f32_16x16x32_bf16 a[20:23], a[116:119], a[100:103], a[20:23]
v_mfma_f32_16x16x32_bf16 a[24:27], a[116:119], a[104:107], a[24:27]
v_mfma_f32_16x16x32_bf16 a[28:31], a[116:119], a[108:111], a[28:31]
v_mfma_f32_16x16x32_bf16 a[32:35], a[120:123], a[96:99], a[32:35]
v_mfma_f32_16x16x32_bf16 a[36:39], a[120:123], a[100:103], a[36:39]
v_mfma_f32_16x16x32_bf16 a[40:43], a[120:123], a[104:107], a[40:43]
v_mfma_f32_16x16x32_bf16 a[44:47], a[120:123], a[108:111], a[44:47]
v_mfma_f32_16x16x32_bf16 a[48:51], a[124:127], a[96:99], a[48:51]
v_mfma_f32_16x16x32_bf16 a[52:55], a[124:127], a[100:103], a[52:55]
v_mfma_f32_16x16x32_bf16 a[56:59], a[124:127], a[104:107], a[56:59]
v_mfma_f32_16x16x32_bf16 a[60:63], a[124:127], a[108:111], a[60:63]
s_waitcnt vmcnt(19)
v_mfma_f32_16x16x32_bf16 a[0:3], v[28:31], v[12:15], a[0:3]
s_waitcnt vmcnt(18)
v_mfma_f32_16x16x32_bf16 a[4:7], v[28:31], v[16:19], a[4:7]
s_waitcnt vmcnt(17)
v_mfma_f32_16x16x32_bf16 a[8:11], v[28:31], v[20:23], a[8:11]
s_waitcnt vmcnt(16)
v_mfma_f32_16x16x32_bf16 a[12:15], v[28:31], v[24:27], a[12:15]
v_mfma_f32_16x16x32_bf16 a[16:19], v[32:35], v[12:15], a[16:19]
v_mfma_f32_16x16x32_bf16 a[20:23], v[32:35], v[16:19], a[20:23]
v_mfma_f32_16x16x32_bf16 a[24:27], v[32:35], v[20:23], a[24:27]
v_mfma_f32_16x16x32_bf16 a[28:31], v[32:35], v[24:27], a[28:31]
v_mfma_f32_16x16x32_bf16 a[32:35], v[36:39], v[12:15], a[32:35]
v_mfma_f32_16x16x32_bf16 a[36:39], v[36:39], v[16:19], a[36:39]
v_mfma_f32_16x16x32_bf16 a[40:43], v[36:39], v[20:23], a[40:43]
v_mfma_f32_16x16x32_bf16 a[44:47], v[36:39], v[24:27], a[44:47]
v_mfma_f32_16x16x32_bf16 a[48:51], v[40:43], v[12:15], a[48:51]
v_mfma_f32_16x16x32_bf16 a[52:55], v[40:43], v[16:19], a[52:55]
v_mfma_f32_16x16x32_bf16 a[56:59], v[40:43], v[20:23], a[56:59]
v_mfma_f32_16x16x32_bf16 a[60:63], v[40:43], v[24:27], a[60:63]
buffer_load_dwordx4 v[28:31], v1, s[8:11], s47 offen offset:0
buffer_load_dwordx4 v[32:35], v1, s[8:11], s47 offen offset:1024
buffer_load_dwordx4 v[36:39], v1, s[8:11], s47 offen offset:2048
buffer_load_dwordx4 v[40:43], v1, s[8:11], s47 offen offset:3072
buffer_load_dwordx4 v[12:15], v1, s[8:11], s46 offen offset:0 sc1
buffer_load_dwordx4 v[16:19], v1, s[8:11], s46 offen offset:1024 sc1
buffer_load_dwordx4 v[20:23], v1, s[8:11], s46 offen offset:2048 sc1
buffer_load_dwordx4 v[24:27], v1, s[8:11], s46 offen offset:3072 sc1
s_add_u32 s46, s46, 4096
s_add_u32 s47, s47, 4096
s_waitcnt vmcnt(19)
v_mfma_f32_16x16x32_bf16 a[0:3], v[60:63], v[44:47], a[0:3]
s_waitcnt vmcnt(18)
v_mfma_f32_16x16x32_bf16 a[4:7], v[60:63], v[48:51], a[4:7]
s_waitcnt vmcnt(17)
v_mfma_f32_16x16x32_bf16 a[8:11], v[60:63], v[52:55], a[8:11]
s_waitcnt vmcnt(16)
v_mfma_f32_16x16x32_bf16 a[12:15], v[60:63], v[56:59], a[12:15]
v_mfma_f32_16x16x32_bf16 a[16:19], v[64:67], v[44:47], a[16:19]
v_mfma_f32_16x16x32_bf16 a[20:23], v[64:67], v[48:51], a[20:23]
v_mfma_f32_16x16x32_bf16 a[24:27], v[64:67], v[52:55], a[24:27]
v_mfma_f32_16x16x32_bf16 a[28:31], v[64:67], v[56:59], a[28:31]
v_mfma_f32_16x16x32_bf16 a[32:35], v[68:71], v[44:47], a[32:35]
v_mfma_f32_16x16x32_bf16 a[36:39], v[68:71], v[48:51], a[36:39]
v_mfma_f32_16x16x32_bf16 a[40:43], v[68:71], v[52:55], a[40:43]
v_mfma_f32_16x16x32_bf16 a[44:47], v[68:71], v[56:59], a[44:47]
v_mfma_f32_16x16x32_bf16 a[48:51], v[72:75], v[44:47], a[48:51]
v_mfma_f32_16x16x32_bf16 a[52:55], v[72:75], v[48:51], a[52:55]
v_mfma_f32_16x16x32_bf16 a[56:59], v[72:75], v[52:55], a[56:59]
v_mfma_f32_16x16x32_bf16 a[60:63], v[72:75], v[56:59], a[60:63]
buffer_load_dwordx4 v[60:63], v1, s[8:11], s47 offen offset:0
buffer_load_dwordx4 v[64:67], v1, s[8:11], s47 offen offset:1024
buffer_load_dwordx4 v[68:71], v1, s[8:11], s47 offen offset:2048
buffer_load_dwordx4 v[72:75], v1, s[8:11], s47 offen offset:3072
buffer_load_dwordx4 v[44:47], v1, s[8:11], s46 offen offset:0 sc1
buffer_load_dwordx4 v[48:51], v1, s[8:11], s46 offen offset:1024 sc1
buffer_load_dwordx4 v[52:55], v1, s[8:11], s46 offen offset:2048 sc1
buffer_load_dwordx4 v[56:59], v1, s[8:11], s46 offen offset:3072 sc1
s_add_u32 s46, s46, 4096
s_add_u32 s47, s47, 4096
s_waitcnt vmcnt(19)
v_mfma_f32_16x16x32_bf16 a[64:67], a[144:147], a[128:131], 0
s_waitcnt vmcnt(18)
v_mfma_f32_16x16x32_bf16 a[68:71], a[144:147], a[132:135], 0
s_waitcnt vmcnt(17)
v_mfma_f32_16x16x32_bf16 a[72:75], a[144:147], a[136:139], 0
s_waitcnt vmcnt(16)
v_mfma_f32_16x16x32_bf16 a[76:79], a[144:147], a[140:143], 0
v_mfma_f32_16x16x32_bf16 a[80:83], a[148:151], a[128:131], 0
v_mfma_f32_16x16x32_bf16 a[84:87], a[148:151], a[132:135], 0
v_mfma_f32_16x16x32_bf16 a[88:91], a[148:151], a[136:139], 0
v_mfma_f32_16x16x32_bf16 a[92:95], a[148:151], a[140:143], 0
v_mfma_f32_16x16x32_bf16 a[96:99], v[92:95], a[128:131], 0
v_mfma_f32_16x16x32_bf16 a[100:103], v[92:95], a[132:135], 0
v_mfma_f32_16x16x32_bf16 a[104:107], v[92:95], a[136:139], 0
v_mfma_f32_16x16x32_bf16 a[108:111], v[92:95], a[140:143], 0
v_mfma_f32_16x16x32_bf16 a[112:115], v[96:99], a[128:131], 0
v_mfma_f32_16x16x32_bf16 a[116:119], v[96:99], a[132:135], 0
v_mfma_f32_16x16x32_bf16 a[120:123], v[96:99], a[136:139], 0
v_mfma_f32_16x16x32_bf16 a[124:127], v[96:99], a[140:143], 0
buffer_load_dwordx4 a[144:147], v1, s[8:11], s47 offen offset:0
buffer_load_dwordx4 a[148:151], v1, s[8:11], s47 offen offset:1024
buffer_load_dwordx4 v[92:95], v1, s[8:11], s47 offen offset:2048
buffer_load_dwordx4 v[96:99], v1, s[8:11], s47 offen offset:3072
buffer_load_dwordx4 a[128:131], v1, s[8:11], s46 offen offset:0 sc1
buffer_load_dwordx4 a[132:135], v1, s[8:11], s46 offen offset:1024 sc1
buffer_load_dwordx4 a[136:139], v1, s[8:11], s46 offen offset:2048 sc1
buffer_load_dwordx4 a[140:143], v1, s[8:11], s46 offen offset:3072 sc1
s_add_u32 s46, s46, 4096
s_add_u32 s47, s47, 4096
s_waitcnt vmcnt(19)
v_mfma_f32_16x16x32_bf16 a[64:67], v[28:31], v[12:15], a[64:67]
s_waitcnt vmcnt(18)
v_mfma_f32_16x16x32_bf16 a[68:71], v[28:31], v[16:19], a[68:71]
s_waitcnt vmcnt(17)
v_mfma_f32_16x16x32_bf16 a[72:75], v[28:31], v[20:23], a[72:75]
s_waitcnt vmcnt(16)
v_mfma_f32_16x16x32_bf16 a[76:79], v[28:31], v[24:27], a[76:79]
v_mfma_f32_16x16x32_bf16 a[80:83], v[32:35], v[12:15], a[80:83]
v_mfma_f32_16x16x32_bf16 a[84:87], v[32:35], v[16:19], a[84:87]
v_mfma_f32_16x16x32_bf16 a[88:91], v[32:35], v[20:23], a[88:91]
v_mfma_f32_16x16x32_bf16 a[92:95], v[32:35], v[24:27], a[92:95]
v_mfma_f32_16x16x32_bf16 a[96:99], v[36:39], v[12:15], a[96:99]
v_mfma_f32_16x16x32_bf16 a[100:103], v[36:39], v[16:19], a[100:103]
v_mfma_f32_16x16x32_bf16 a[104:107], v[36:39], v[20:23], a[104:107]
v_mfma_f32_16x16x32_bf16 a[108:111], v[36:39], v[24:27], a[108:111]
v_mfma_f32_16x16x32_bf16 a[112:115], v[40:43], v[12:15], a[112:115]
v_mfma_f32_16x16x32_bf16 a[116:119], v[40:43], v[16:19], a[116:119]
v_mfma_f32_16x16x32_bf16 a[120:123], v[40:43], v[20:23], a[120:123]
v_mfma_f32_16x16x32_bf16 a[124:127], v[40:43], v[24:27], a[124:127]
s_waitcnt vmcnt(11)
v_mfma_f32_16x16x32_bf16 a[64:67], v[60:63], v[44:47], a[64:67]
s_waitcnt vmcnt(10)
v_mfma_f32_16x16x32_bf16 a[68:71], v[60:63], v[48:51], a[68:71]
s_waitcnt vmcnt(9)
v_mfma_f32_16x16x32_bf16 a[72:75], v[60:63], v[52:55], a[72:75]
s_waitcnt vmcnt(8)
v_mfma_f32_16x16x32_bf16 a[76:79], v[60:63], v[56:59], a[76:79]
v_mfma_f32_16x16x32_bf16 a[80:83], v[64:67], v[44:47], a[80:83]
v_mfma_f32_16x16x32_bf16 a[84:87], v[64:67], v[48:51], a[84:87]
v_mfma_f32_16x16x32_bf16 a[88:91], v[64:67], v[52:55], a[88:91]
v_mfma_f32_16x16x32_bf16 a[92:95], v[64:67], v[56:59], a[92:95]
v_mfma_f32_16x16x32_bf16 a[96:99], v[68:71], v[44:47], a[96:99]
v_mfma_f32_16x16x32_bf16 a[100:103], v[68:71], v[48:51], a[100:103]
v_mfma_f32_16x16x32_bf16 a[104:107], v[68:71], v[52:55], a[104:107]
v_mfma_f32_16x16x32_bf16 a[108:111], v[68:71], v[56:59], a[108:111]
v_mfma_f32_16x16x32_bf16 a[112:115], v[72:75], v[44:47], a[112:115]
v_mfma_f32_16x16x32_bf16 a[116:119], v[72:75], v[48:51], a[116:119]
v_mfma_f32_16x16x32_bf16 a[120:123], v[72:75], v[52:55], a[120:123]
v_mfma_f32_16x16x32_bf16 a[124:127], v[72:75], v[56:59], a[124:127]
s_waitcnt vmcnt(3)
v_mfma_f32_16x16x32_bf16 a[64:67], a[144:147], a[128:131], a[64:67]
s_waitcnt vmcnt(2)
v_mfma_f32_16x16x32_bf16 a[68:71], a[144:147], a[132:135], a[68:71]
s_waitcnt vmcnt(1)
v_mfma_f32_16x16x32_bf16 a[72:75], a[144:147], a[136:139], a[72:75]
s_waitcnt vmcnt(0)
v_mfma_f32_16x16x32_bf16 a[76:79], a[144:147], a[140:143], a[76:79]
v_mfma_f32_16x16x32_bf16 a[80:83], a[148:151], a[128:131], a[80:83]
v_mfma_f32_16x16x32_bf16 a[84:87], a[148:151], a[132:135], a[84:87]
v_mfma_f32_16x16x32_bf16 a[88:91], a[148:151], a[136:139], a[88:91]
v_mfma_f32_16x16x32_bf16 a[92:95], a[148:151], a[140:143], a[92:95]
v_mfma_f32_16x16x32_bf16 a[96:99], v[92:95], a[128:131], a[96:99]
v_mfma_f32_16x16x32_bf16 a[100:103], v[92:95], a[132:135], a[100:103]
v_mfma_f32_16x16x32_bf16 a[104:107], v[92:95], a[136:139], a[104:107]
v_mfma_f32_16x16x32_bf16 a[108:111], v[92:95], a[140:143], a[108:111]
v_mfma_f32_16x16x32_bf16 a[112:115], v[96:99], a[128:131], a[112:115]
v_mfma_f32_16x16x32_bf16 a[116:119], v[96:99], a[132:135], a[116:119]
v_mfma_f32_16x16x32_bf16 a[120:123], v[96:99], a[136:139], a[120:123]
v_mfma_f32_16x16x32_bf16 a[124:127], v[96:99], a[140:143], a[124:127]
s_nop 7
s_lshl_b32 s20, s16, 14
v_add_u32 v76, s20, v1
s_lshl_b32 s20, s16, 10
v_add_u32 v77, s20, v1
v_and_b32 v2, 15, v0
v_lshlrev_b32 v2, 11, v2
v_bfe_u32 v3, v0, 4, 1
v_lshl_add_u32 v2, v3, 5, v2
v_lshrrev_b32 v3, 5, v0
v_lshl_add_u32 v2, v3, 4, v2
s_lshl_b32 s20, s17, 2
s_add_u32 s20, s20, s16
s_lshl_b32 s20, s20, 15
s_lshl_b32 s21, s18, 7
s_add_u32 s20, s20, s21
ds_write_b128 v76, a[0:3] offset:0
ds_write_b128 v76, a[4:7] offset:1024
ds_write_b128 v76, a[8:11] offset:2048
ds_write_b128 v76, a[12:15] offset:3072
ds_write_b128 v76, a[16:19] offset:4096
ds_write_b128 v76, a[20:23] offset:5120
ds_write_b128 v76, a[24:27] offset:6144
ds_write_b128 v76, a[28:31] offset:7168
ds_write_b128 v76, a[32:35] offset:8192
ds_write_b128 v76, a[36:39] offset:9216
ds_write_b128 v76, a[40:43] offset:10240
ds_write_b128 v76, a[44:47] offset:11264
ds_write_b128 v76, a[48:51] offset:12288
ds_write_b128 v76, a[52:55] offset:13312
ds_write_b128 v76, a[56:59] offset:14336
ds_write_b128 v76, a[60:63] offset:15360
s_waitcnt lgkmcnt(0)
s_barrier
ds_read_b128 v[12:15], v77 offset:0
ds_read_b128 v[16:19], v77 offset:4096
ds_read_b128 v[20:23], v77 offset:8192
ds_read_b128 v[24:27], v77 offset:12288
ds_read_b128 v[28:31], v77 offset:16384
ds_read_b128 v[32:35], v77 offset:20480
ds_read_b128 v[36:39], v77 offset:24576
ds_read_b128 v[40:43], v77 offset:28672
ds_read_b128 v[44:47], v77 offset:32768
ds_read_b128 v[48:51], v77 offset:36864
ds_read_b128 v[52:55], v77 offset:40960
ds_read_b128 v[56:59], v77 offset:45056
ds_read_b128 v[60:63], v77 offset:49152
ds_read_b128 v[64:67], v77 offset:53248
ds_read_b128 v[68:71], v77 offset:57344
ds_read_b128 v[72:75], v77 offset:61440
s_waitcnt lgkmcnt(0)
s_barrier
v_add_f32 v12, v12, v28
v_add_f32 v13, v13, v29
v_add_f32 v14, v14, v30
v_add_f32 v15, v15, v31
v_add_f32 v16, v16, v32
v_add_f32 v17, v17, v33
v_add_f32 v18, v18, v34
v_add_f32 v19, v19, v35
v_add_f32 v20, v20, v36
v_add_f32 v21, v21, v37
v_add_f32 v22, v22, v38
v_add_f32 v23, v23, v39
v_add_f32 v24, v24, v40
v_add_f32 v25, v25, v41
v_add_f32 v26, v26, v42
v_add_f32 v27, v27, v43
v_add_f32 v44, v44, v60
v_add_f32 v45, v45, v61
v_add_f32 v46, v46, v62
v_add_f32 v47, v47, v63
v_add_f32 v48, v48, v64
v_add_f32 v49, v49, v65
v_add_f32 v50, v50, v66
v_add_f32 v51, v51, v67
v_add_f32 v52, v52, v68
v_add_f32 v53, v53, v69
v_add_f32 v54, v54, v70
v_add_f32 v55, v55, v71
v_add_f32 v56, v56, v72
v_add_f32 v57, v57, v73
v_add_f32 v58, v58, v74
v_add_f32 v59, v59, v75
v_add_f32 v12, v12, v44
v_add_f32 v13, v13, v45
v_add_f32 v14, v14, v46
v_add_f32 v15, v15, v47
v_add_f32 v16, v16, v48
v_add_f32 v17, v17, v49
v_add_f32 v18, v18, v50
v_add_f32 v19, v19, v51
v_add_f32 v20, v20, v52
v_add_f32 v21, v21, v53
v_add_f32 v22, v22, v54
v_add_f32 v23, v23, v55
v_add_f32 v24, v24, v56
v_add_f32 v25, v25, v57
v_add_f32 v26, v26, v58
v_add_f32 v27, v27, v59
v_cvt_pk_bf16_f32 v80, v12, v13
v_cvt_pk_bf16_f32 v81, v14, v15
v_cvt_pk_bf16_f32 v82, v16, v17
v_cvt_pk_bf16_f32 v83, v18, v19
v_cvt_pk_bf16_f32 v84, v20, v21
v_cvt_pk_bf16_f32 v85, v22, v23
v_cvt_pk_bf16_f32 v86, v24, v25
v_cvt_pk_bf16_f32 v87, v26, v27
s_nop 1
v_permlane16_swap_b32 v80, v82
v_permlane16_swap_b32 v81, v83
v_permlane16_swap_b32 v84, v86
v_permlane16_swap_b32 v85, v87
buffer_store_dwordx4 v[80:83], v2, s[12:15], s20 offen offset:0 sc1
buffer_store_dwordx4 v[84:87], v2, s[12:15], s20 offen offset:64 sc1
ds_write_b128 v76, a[64:67] offset:0
ds_write_b128 v76, a[68:71] offset:1024
ds_write_b128 v76, a[72:75] offset:2048
ds_write_b128 v76, a[76:79] offset:3072
ds_write_b128 v76, a[80:83] offset:4096
ds_write_b128 v76, a[84:87] offset:5120
ds_write_b128 v76, a[88:91] offset:6144
ds_write_b128 v76, a[92:95] offset:7168
ds_write_b128 v76, a[96:99] offset:8192
ds_write_b128 v76, a[100:103] offset:9216
ds_write_b128 v76, a[104:107] offset:10240
ds_write_b128 v76, a[108:111] offset:11264
ds_write_b128 v76, a[112:115] offset:12288
ds_write_b128 v76, a[116:119] offset:13312
ds_write_b128 v76, a[120:123] offset:14336
ds_write_b128 v76, a[124:127] offset:15360
s_waitcnt lgkmcnt(0)
s_barrier
ds_read_b128 v[12:15], v77 offset:0
ds_read_b128 v[16:19], v77 offset:4096
ds_read_b128 v[20:23], v77 offset:8192
ds_read_b128 v[24:27], v77 offset:12288
ds_read_b128 v[28:31], v77 offset:16384
ds_read_b128 v[32:35], v77 offset:20480
ds_read_b128 v[36:39], v77 offset:24576
ds_read_b128 v[40:43], v77 offset:28672
ds_read_b128 v[44:47], v77 offset:32768
ds_read_b128 v[48:51], v77 offset:36864
ds_read_b128 v[52:55], v77 offset:40960
ds_read_b128 v[56:59], v77 offset:45056
ds_read_b128 v[60:63], v77 offset:49152
ds_read_b128 v[64:67], v77 offset:53248
ds_read_b128 v[68:71], v77 offset:57344
ds_read_b128 v[72:75], v77 offset:61440
s_waitcnt lgkmcnt(11)
v_add_f32 v12, v12, v28
v_add_f32 v13, v13, v29
v_add_f32 v14, v14, v30
v_add_f32 v15, v15, v31
s_waitcnt lgkmcnt(10)
v_add_f32 v16, v16, v32
v_add_f32 v17, v17, v33
v_add_f32 v18, v18, v34
v_add_f32 v19, v19, v35
s_waitcnt lgkmcnt(9)
v_add_f32 v20, v20, v36
v_add_f32 v21, v21, v37
v_add_f32 v22, v22, v38
v_add_f32 v23, v23, v39
s_waitcnt lgkmcnt(8)
v_add_f32 v24, v24, v40
v_add_f32 v25, v25, v41
v_add_f32 v26, v26, v42
v_add_f32 v27, v27, v43
s_waitcnt lgkmcnt(3)
v_add_f32 v44, v44, v60
v_add_f32 v45, v45, v61
v_add_f32 v46, v46, v62
v_add_f32 v47, v47, v63
s_waitcnt lgkmcnt(2)
v_add_f32 v48, v48, v64
v_add_f32 v49, v49, v65
v_add_f32 v50, v50, v66
v_add_f32 v51, v51, v67
s_waitcnt lgkmcnt(1)
v_add_f32 v52, v52, v68
v_add_f32 v53, v53, v69
v_add_f32 v54, v54, v70
v_add_f32 v55, v55, v71
s_waitcnt lgkmcnt(0)
v_add_f32 v56, v56, v72
v_add_f32 v57, v57, v73
v_add_f32 v58, v58, v74
v_add_f32 v59, v59, v75
v_add_f32 v12, v12, v44
v_add_f32 v13, v13, v45
v_add_f32 v14, v14, v46
v_add_f32 v15, v15, v47
v_add_f32 v16, v16, v48
v_add_f32 v17, v17, v49
v_add_f32 v18, v18, v50
v_add_f32 v19, v19, v51
v_add_f32 v20, v20, v52
v_add_f32 v21, v21, v53
v_add_f32 v22, v22, v54
v_add_f32 v23, v23, v55
v_add_f32 v24, v24, v56
v_add_f32 v25, v25, v57
v_add_f32 v26, v26, v58
v_add_f32 v27, v27, v59
v_cvt_pk_bf16_f32 v88, v12, v13
v_cvt_pk_bf16_f32 v89, v14, v15
v_cvt_pk_bf16_f32 v90, v16, v17
v_cvt_pk_bf16_f32 v91, v18, v19
v_cvt_pk_bf16_f32 v92, v20, v21
v_cvt_pk_bf16_f32 v93, v22, v23
v_cvt_pk_bf16_f32 v94, v24, v25
v_cvt_pk_bf16_f32 v95, v26, v27
s_nop 1
v_permlane16_swap_b32 v88, v90
v_permlane16_swap_b32 v89, v91
v_permlane16_swap_b32 v92, v94
v_permlane16_swap_b32 v93, v95
buffer_store_dwordx4 v[88:91], v2, s[12:15], s20 offen offset:1024 sc1
buffer_store_dwordx4 v[92:95], v2, s[12:15], s20 offen offset:1088 sc1
s_endpgm
K3_END:
s_endpgm
K3_BI0_0:
v_mov_b32 v8, s30
v_mov_b32 v9, s30
v_mov_b32 v10, s30
v_mov_b32 v11, s30
s_branch K3_BR0_0
K3_BI0_1:
v_mov_b32 v12, s30
v_mov_b32 v13, s30
v_mov_b32 v14, s30
v_mov_b32 v15, s30
s_branch K3_BR0_1
K3_BI0_2:
v_mov_b32 v16, s30
v_mov_b32 v17, s30
v_mov_b32 v18, s30
v_mov_b32 v19, s30
s_branch K3_BR0_2
K3_BI0_3:
v_mov_b32 v20, s30
v_mov_b32 v21, s30
v_mov_b32 v22, s30
v_mov_b32 v23, s30
s_branch K3_BR0_3
K3_BI0_4:
v_mov_b32 v24, s30
v_mov_b32 v25, s30
v_mov_b32 v26, s30
v_mov_b32 v27, s30
s_branch K3_BR0_4
K3_BI0_5:
v_mov_b32 v28, s30
v_mov_b32 v29, s30
v_mov_b32 v30, s30
v_mov_b32 v31, s30
s_branch K3_BR0_5
K3_BI0_6:
v_mov_b32 v32, s30
v_mov_b32 v33, s30
v_mov_b32 v34, s30
v_mov_b32 v35, s30
s_branch K3_BR0_6
K3_BI0_7:
v_mov_b32 v36, s30
v_mov_b32 v37, s30
v_mov_b32 v38, s30
v_mov_b32 v39, s30
s_branch K3_BR0_7
K3_BI0_8:
v_mov_b32 v40, s30
v_mov_b32 v41, s30
v_mov_b32 v42, s30
v_mov_b32 v43, s30
s_branch K3_BR0_8
K3_BI0_9:
v_mov_b32 v44, s30
v_mov_b32 v45, s30
v_mov_b32 v46, s30
v_mov_b32 v47, s30
s_branch K3_BR0_9
K3_BI0_10:
v_mov_b32 v48, s30
v_mov_b32 v49, s30
v_mov_b32 v50, s30
v_mov_b32 v51, s30
s_branch K3_BR0_10
K3_BI0_11:
v_mov_b32 v52, s30
v_mov_b32 v53, s30
v_mov_b32 v54, s30
v_mov_b32 v55, s30
s_branch K3_BR0_11
K3_BI0_12:
v_mov_b32 v56, s30
v_mov_b32 v57, s30
v_mov_b32 v58, s30
v_mov_b32 v59, s30
s_branch K3_BR0_12
K3_BI0_13:
v_mov_b32 v60, s30
v_mov_b32 v61, s30
v_mov_b32 v62, s30
v_mov_b32 v63, s30
s_branch K3_BR0_13
K3_BI0_14:
v_mov_b32 v64, s30
v_mov_b32 v65, s30
v_mov_b32 v66, s30
v_mov_b32 v67, s30
s_branch K3_BR0_14
K3_BI0_15:
v_mov_b32 v68, s30
v_mov_b32 v69, s30
v_mov_b32 v70, s30
v_mov_b32 v71, s30
s_branch K3_BR0_15
K3_BI1_0:
v_mov_b32 v8, s30
v_mov_b32 v9, s30
v_mov_b32 v10, s30
v_mov_b32 v11, s30
s_branch K3_BR1_0
K3_BI1_1:
v_mov_b32 v12, s30
v_mov_b32 v13, s30
v_mov_b32 v14, s30
v_mov_b32 v15, s30
s_branch K3_BR1_1
K3_BI1_2:
v_mov_b32 v16, s30
v_mov_b32 v17, s30
v_mov_b32 v18, s30
v_mov_b32 v19, s30
s_branch K3_BR1_2
K3_BI1_3:
v_mov_b32 v20, s30
v_mov_b32 v21, s30
v_mov_b32 v22, s30
v_mov_b32 v23, s30
s_branch K3_BR1_3
K3_BI1_4:
v_mov_b32 v24, s30
v_mov_b32 v25, s30
v_mov_b32 v26, s30
v_mov_b32 v27, s30
s_branch K3_BR1_4
K3_BI1_5:
v_mov_b32 v28, s30
v_mov_b32 v29, s30
v_mov_b32 v30, s30
v_mov_b32 v31, s30
s_branch K3_BR1_5
K3_BI1_6:
v_mov_b32 v32, s30
v_mov_b32 v33, s30
v_mov_b32 v34, s30
v_mov_b32 v35, s30
s_branch K3_BR1_6
K3_BI1_7:
v_mov_b32 v36, s30
v_mov_b32 v37, s30
v_mov_b32 v38, s30
v_mov_b32 v39, s30
s_branch K3_BR1_7
K3_BI1_8:
v_mov_b32 v40, s30
v_mov_b32 v41, s30
v_mov_b32 v42, s30
v_mov_b32 v43, s30
s_branch K3_BR1_8
K3_BI1_9:
v_mov_b32 v44, s30
v_mov_b32 v45, s30
v_mov_b32 v46, s30
v_mov_b32 v47, s30
s_branch K3_BR1_9
K3_BI1_10:
v_mov_b32 v48, s30
v_mov_b32 v49, s30
v_mov_b32 v50, s30
v_mov_b32 v51, s30
s_branch K3_BR1_10
K3_BI1_11:
v_mov_b32 v52, s30
v_mov_b32 v53, s30
v_mov_b32 v54, s30
v_mov_b32 v55, s30
s_branch K3_BR1_11
K3_BI1_12:
v_mov_b32 v56, s30
v_mov_b32 v57, s30
v_mov_b32 v58, s30
v_mov_b32 v59, s30
s_branch K3_BR1_12
K3_BI1_13:
v_mov_b32 v60, s30
v_mov_b32 v61, s30
v_mov_b32 v62, s30
v_mov_b32 v63, s30
s_branch K3_BR1_13
K3_BI1_14:
v_mov_b32 v64, s30
v_mov_b32 v65, s30
v_mov_b32 v66, s30
v_mov_b32 v67, s30
s_branch K3_BR1_14
K3_BI1_15:
v_mov_b32 v68, s30
v_mov_b32 v69, s30
v_mov_b32 v70, s30
v_mov_b32 v71, s30
s_branch K3_BR1_15
K3_BI2_1:
v_mov_b32 v12, s30
v_mov_b32 v13, s30
v_mov_b32 v14, s30
v_mov_b32 v15, s30
s_branch K3_BR2_1
K3_BI2_2:
v_mov_b32 v16, s30
v_mov_b32 v17, s30
v_mov_b32 v18, s30
v_mov_b32 v19, s30
s_branch K3_BR2_2
K3_BI2_3:
v_mov_b32 v20, s30
v_mov_b32 v21, s30
v_mov_b32 v22, s30
v_mov_b32 v23, s30
s_branch K3_BR2_3
K3_BI2_4:
v_mov_b32 v24, s30
v_mov_b32 v25, s30
v_mov_b32 v26, s30
v_mov_b32 v27, s30
s_branch K3_BR2_4
K3_BI2_5:
v_mov_b32 v28, s30
v_mov_b32 v29, s30
v_mov_b32 v30, s30
v_mov_b32 v31, s30
s_branch K3_BR2_5
K3_BI2_6:
v_mov_b32 v32, s30
v_mov_b32 v33, s30
v_mov_b32 v34, s30
v_mov_b32 v35, s30
s_branch K3_BR2_6
K3_BI2_7:
v_mov_b32 v36, s30
v_mov_b32 v37, s30
v_mov_b32 v38, s30
v_mov_b32 v39, s30
s_branch K3_BR2_7
K3_BI2_8:
v_mov_b32 v40, s30
v_mov_b32 v41, s30
v_mov_b32 v42, s30
v_mov_b32 v43, s30
s_branch K3_BR2_8
K3_BI2_9:
v_mov_b32 v44, s30
v_mov_b32 v45, s30
v_mov_b32 v46, s30
v_mov_b32 v47, s30
s_branch K3_BR2_9
K3_BI2_10:
v_mov_b32 v48, s30
v_mov_b32 v49, s30
v_mov_b32 v50, s30
v_mov_b32 v51, s30
s_branch K3_BR2_10
K3_BI2_11:
v_mov_b32 v52, s30
v_mov_b32 v53, s30
v_mov_b32 v54, s30
v_mov_b32 v55, s30
s_branch K3_BR2_11
K3_BI2_12:
v_mov_b32 v56, s30
v_mov_b32 v57, s30
v_mov_b32 v58, s30
v_mov_b32 v59, s30
s_branch K3_BR2_12
K3_BI2_13:
v_mov_b32 v60, s30
v_mov_b32 v61, s30
v_mov_b32 v62, s30
v_mov_b32 v63, s30
s_branch K3_BR2_13
K3_BI2_14:
v_mov_b32 v64, s30
v_mov_b32 v65, s30
v_mov_b32 v66, s30
v_mov_b32 v67, s30
s_branch K3_BR2_14
K3_BI2_15:
v_mov_b32 v68, s30
v_mov_b32 v69, s30
v_mov_b32 v70, s30
v_mov_b32 v71, s30
s_branch K3_BR2_15
K3_BI3_1:
v_mov_b32 v12, s30
v_mov_b32 v13, s30
v_mov_b32 v14, s30
v_mov_b32 v15, s30
s_branch K3_BR3_1
K3_BI3_2:
v_mov_b32 v16, s30
v_mov_b32 v17, s30
v_mov_b32 v18, s30
v_mov_b32 v19, s30
s_branch K3_BR3_2
K3_BI3_3:
v_mov_b32 v20, s30
v_mov_b32 v21, s30
v_mov_b32 v22, s30
v_mov_b32 v23, s30
s_branch K3_BR3_3
K3_BI3_4:
v_mov_b32 v24, s30
v_mov_b32 v25, s30
v_mov_b32 v26, s30
v_mov_b32 v27, s30
s_branch K3_BR3_4
K3_BI3_5:
v_mov_b32 v28, s30
v_mov_b32 v29, s30
v_mov_b32 v30, s30
v_mov_b32 v31, s30
s_branch K3_BR3_5
K3_BI3_6:
v_mov_b32 v32, s30
v_mov_b32 v33, s30
v_mov_b32 v34, s30
v_mov_b32 v35, s30
s_branch K3_BR3_6
K3_BI3_7:
v_mov_b32 v36, s30
v_mov_b32 v37, s30
v_mov_b32 v38, s30
v_mov_b32 v39, s30
s_branch K3_BR3_7
K3_BI3_8:
v_mov_b32 v40, s30
v_mov_b32 v41, s30
v_mov_b32 v42, s30
v_mov_b32 v43, s30
s_branch K3_BR3_8
K3_BI3_9:
v_mov_b32 v44, s30
v_mov_b32 v45, s30
v_mov_b32 v46, s30
v_mov_b32 v47, s30
s_branch K3_BR3_9
K3_BI3_10:
v_mov_b32 v48, s30
v_mov_b32 v49, s30
v_mov_b32 v50, s30
v_mov_b32 v51, s30
s_branch K3_BR3_10
K3_BI3_11:
v_mov_b32 v52, s30
v_mov_b32 v53, s30
v_mov_b32 v54, s30
v_mov_b32 v55, s30
s_branch K3_BR3_11
K3_BI3_12:
v_mov_b32 v56, s30
v_mov_b32 v57, s30
v_mov_b32 v58, s30
v_mov_b32 v59, s30
s_branch K3_BR3_12
K3_BI3_13:
v_mov_b32 v60, s30
v_mov_b32 v61, s30
v_mov_b32 v62, s30
v_mov_b32 v63, s30
s_branch K3_BR3_13
K3_BI3_14:
v_mov_b32 v64, s30
v_mov_b32 v65, s30
v_mov_b32 v66, s30
v_mov_b32 v67, s30
s_branch K3_BR3_14
K3_BI3_15:
v_mov_b32 v68, s30
v_mov_b32 v69, s30
v_mov_b32 v70, s30
v_mov_b32 v71, s30
s_branch K3_BR3_15
K3_SLOWPOLL:
s_mov_b32 s28, 0x40000
s_mov_b64 exec, 0xffff
K3_PL1:
buffer_load_dword v3, v2, s[8:11], s22 offen sc1
s_waitcnt vmcnt(0)
v_cmp_eq_u32 vcc, 0, v3
s_cbranch_vccz K3_PD1
s_sleep 8
s_sub_u32 s28, s28, 1
s_cmp_lg_u32 s28, 0
s_cbranch_scc1 K3_PL1
K3_PD1:
s_mov_b64 exec, -1
s_branch K3_POLLED
CODE_END:
.section .rodata,"a"
.p2align 6
.amdhsa_kernel k1_kernel
  .amdhsa_next_free_vgpr 512
  .amdhsa_next_free_sgpr 102
  .amdhsa_accum_offset 256
  .amdhsa_group_segment_fixed_size 0
  .amdhsa_kernarg_size 96
  .amdhsa_user_sgpr_count 2
  .amdhsa_user_sgpr_kernarg_segment_ptr 1
  .amdhsa_system_sgpr_workgroup_id_x 1
  .amdhsa_float_denorm_mode_32 3
.end_amdhsa_kernel
.p2align 6
.amdhsa_kernel k3_kernel
  .amdhsa_next_free_vgpr 256
  .amdhsa_next_free_sgpr 102
  .amdhsa_accum_offset 104
  .amdhsa_group_segment_fixed_size 0
  .amdhsa_kernarg_size 96
  .amdhsa_user_sgpr_count 2
  .amdhsa_user_sgpr_kernarg_segment_ptr 1
  .amdhsa_system_sgpr_workgroup_id_x 1
  .amdhsa_float_denorm_mode_32 3
.end_amdhsa_kernel
```
